```python
import torch

def _softmax(x, axis=-1):
    return torch.softmax(x, dim=axis)

def _gelu(x):
    return torch.nn.functional.gelu(x, approximate='tanh')

def _silu(x):
    return torch.nn.functional.silu(x)

def _sigmoid(x):
    return torch.sigmoid(x)

def _layernorm(x, axis=-1, eps=1e-05):
    m = x.mean(dim=axis, keepdim=True)
    v = x.var(dim=axis, keepdim=True, unbiased=False)
    return (x - m) / torch.sqrt(v + eps)

def _scatter_add(tgt, idx, src, axis=0):
    return tgt.clone().index_add_(axis, idx, src)

def _segment_sum(src, seg, n):
    out = torch.zeros((n,) + src.shape[1:], dtype=src.dtype)
    return out.index_add_(0, seg, src)

def _pad(x, pw):
    flat = tuple((v for pair in reversed(pw) for v in pair))
    return torch.nn.functional.pad(x, flat)
kernel_name = 'adaLN_cond__compressed_kv_cla__mixer_gmlp__prompt'

def setup_inputs():

    _w = lambda a: (lambda t: t.to(torch.bfloat16) if t.is_floating_point() else t)(torch.as_tensor(a))

    def _A_setup():
        B, H, Sq, Sk, D, M = (1, 32, 2048, 2048, 128, 640)
        Dc = 4 * D
        return {'x': _w((lambda *s: torch.randn(*s, dtype=torch.bfloat16) * 0.05)(B, Sq, M)), 'c_kv': _w((lambda *s: torch.randn(*s, dtype=torch.bfloat16) * 1.6)(B, Sk, Dc)), 'w_q': _w((lambda *s: torch.randn(*s, dtype=torch.bfloat16) * 0.8)(M, H, D) * M ** (-0.5)), 'w_uk': _w((lambda *s: torch.randn(*s, dtype=torch.bfloat16) * 0.8)(Dc, H, D) * Dc ** (-0.5)), 'w_uv': _w((lambda *s: torch.randn(*s, dtype=torch.bfloat16) * 1.6)(Dc, H, D) * Dc ** (-0.5)), 'w_o': _w((lambda *s: torch.randn(*s, dtype=torch.bfloat16) * 1.6)(H, D, M) * (H * D) ** (-0.5))}
    _A_in = _A_setup()

    def _B_setup():
        B, S, D, F = (1, 2048, 640, 1728)
        Fh = F // 2
        return {'x': _w((lambda *s: torch.randn(*s, dtype=torch.bfloat16) * 0.05)(B, S, D)), 'w_in': _w((lambda *s: torch.randn(*s, dtype=torch.bfloat16) * 0.4)(D, 2 * Fh)), 'w_sp': _w(0.01 * (lambda *s: torch.randn(*s, dtype=torch.bfloat16) * 0.4)(S, S)), 'b_sp': _w(1.0 + 0.01 * (lambda *s: torch.randn(*s, dtype=torch.bfloat16) * 0.05)(S)), 'w_out': _w((lambda *s: torch.randn(*s, dtype=torch.bfloat16) * 0.05)(Fh, D))}
    _B_in = _B_setup()
    return {'A_x': _A_in['x'], 'A_c_kv': _A_in['c_kv'], 'A_w_q': _A_in['w_q'], 'A_w_uk': _A_in['w_uk'], 'A_w_uv': _A_in['w_uv'], 'A_w_o': _A_in['w_o'], 'B_x': _B_in['x'], 'B_w_in': _B_in['w_in'], 'B_w_sp': _B_in['w_sp'], 'B_b_sp': _B_in['b_sp'], 'B_w_out': _B_in['w_out'], 'c': _w((lambda *s: torch.randn(*s, dtype=torch.bfloat16) * 0.1)(1, 640) * 8.0), 'w_mod': _w((lambda *s: torch.randn(*s, dtype=torch.bfloat16) * 0.1)(640, 6 * 640) * 640 ** (-0.5) * 8.0)}

def reference(A_x, A_c_kv, A_w_q, A_w_uk, A_w_uv, A_w_o, B_x, B_w_in, B_w_sp, B_b_sp, B_w_out, c, w_mod):

    def _A_ref(x, c_kv, w_q, w_uk, w_uv, w_o):
        B, Sq, M = (x.shape[0], x.shape[1], x.shape[2])
        Sk = c_kv.shape[1]
        H, D = (w_q.shape[1], w_q.shape[2])
        q = torch.einsum('bqm,mhd->bhqd', x, w_q)
        k = torch.einsum('bkc,chd->bhkd', c_kv, w_uk)
        v = torch.einsum('bkc,chd->bhkd', c_kv, w_uv)
        scores = torch.einsum('bhqd,bhkd->bhqk', q, k) * D ** (-0.5)
        off = Sk - Sq
        qi = torch.arange(Sq)[:, None]
        kj = torch.arange(Sk)[None, :]
        cmask = kj <= qi + off
        scores = torch.where(cmask[None, None], scores, -1000000000.0)
        p = _softmax(scores, axis=-1)
        ctx = torch.einsum('bhqk,bhkd->bhqd', p, v)
        return torch.einsum('bhqd,hdm->bqm', ctx, w_o)

    def _B_ref(x, w_in, w_sp, b_sp, w_out):
        B, S, D = x.shape
        F = w_in.shape[-1]
        Fh = F // 2
        z = _gelu(torch.einsum('bsd,df->bsf', x, w_in))
        z1 = z[..., :Fh].clone()
        z2 = _layernorm(z[..., Fh:], axis=-1)
        g = torch.einsum('ts,bsf->btf', w_sp, z2) + b_sp[None, :, None]
        return torch.einsum('bsf,fd->bsd', z1 * g, w_out)
    x = A_x
    mod = (_silu(c) @ w_mod).reshape(c.shape[0], 6, 1, -1)
    sa, ca, ga, sb, cb, gb = (mod[:, 0].clone(), mod[:, 1].clone(), mod[:, 2].clone(), mod[:, 3].clone(), mod[:, 4].clone(), mod[:, 5].clone())
    h = _layernorm(x, axis=-1) * (1 + ca) + sa
    x = x + ga * _A_ref(h, A_c_kv, A_w_q, A_w_uk, A_w_uv, A_w_o)
    h = _layernorm(x, axis=-1) * (1 + cb) + sb
    x = x + gb * _B_ref(h, B_w_in, B_w_sp, B_b_sp, B_w_out)
    return x
```

```asm
; @launch grid=(256,1,1) block=(256,1,1) lds=163840
.amdgcn_target "amdgcn-amd-amdhsa--gfx950"
.text
.globl adaLN_cond__compressed_kv_cla__mixer_gmlp__prompt_kernel
.p2align 8
.type adaLN_cond__compressed_kv_cla__mixer_gmlp__prompt_kernel,@function
adaLN_cond__compressed_kv_cla__mixer_gmlp__prompt_kernel:
  s_cmp_ge_u32 s2, 256
  s_cbranch_scc1 L_adaL_end
  s_load_dwordx2 s[24:25], s[0:1], 88
  s_load_dwordx2 s[28:29], s[0:1], 96
  s_load_dwordx2 s[36:37], s[0:1], 112
  s_load_dwordx2 s[12:13], s[0:1], 8
  s_load_dwordx2 s[16:17], s[0:1], 24
  s_load_dwordx2 s[4:5], s[0:1], 120
  s_load_dwordx2 s[20:21], s[0:1], 32
  s_load_dwordx2 s[40:41], s[0:1], 16
  s_load_dwordx2 s[96:97], s[0:1], 0
  s_load_dwordx2 s[98:99], s[0:1], 40
  s_load_dwordx2 s[100:101], s[0:1], 64
  v_lshrrev_b32 v2, 6, v0
  v_and_b32 v1, 63, v0
  v_readfirstlane_b32 s3, v2
  s_and_b32 s6, s2, 7
  s_lshl_b32 s6, s6, 2
  s_bfe_u32 s44, s2, 0x20003
  s_add_u32 s6, s6, s44
  s_lshr_b32 s7, s2, 5
  v_mov_b32 v224, v1
  v_lshlrev_b32 v225, 4, v1
  s_lshl_b32 s48, s3, 13
  s_lshl_b32 s49, s3, 12
  s_lshl_b32 s53, s3, 17
  s_lshl_b32 s54, s3, 18
  s_cmp_lt_u32 s2, 240
  s_cselect_b32 s30, 4915200, 0
  s_mov_b32 s31, 0x20000
  s_movk_i32 s26, 1280
  s_mov_b32 s27, 0x20000
  s_and_b32 s44, s2, 3
  s_lshl_b32 s44, s44, 2
  s_add_u32 s44, s44, s3
  s_mul_i32 s44, s44, 40
  v_lshrrev_b32 v2, 3, v224
  v_and_b32 v3, 7, v224
  v_mad_u32_u24 v2, v2, 5, s44
  v_mul_u32_u24 v5, 7680, v2
  v_lshl_add_u32 v5, v3, 4, v5
  v_lshlrev_b32 v4, 1, v2
  s_lshr_b32 s45, s2, 2
  s_lshl_b32 s45, s45, 7
  v_lshrrev_b32 v240, 3, v224
  v_and_b32 v241, 7, v224
  v_lshrrev_b32 v242, 4, v224
  v_xor_b32 v243, 0, v242
  v_xor_b32 v243, v243, v241
  v_lshlrev_b32 v243, 4, v243
  v_lshl_add_u32 v243, v240, 10, v243
  v_add_u32 v140, 0, v243
  v_add_u32 v142, 14336, v243
  v_xor_b32 v243, 4, v242
  v_xor_b32 v243, v243, v241
  v_lshlrev_b32 v243, 4, v243
  v_lshl_add_u32 v243, v240, 10, v243
  v_add_u32 v141, 7168, v243
  v_add_u32 v143, 21504, v243
  v_bfe_u32 v243, v224, 2, 2
  v_and_b32 v244, 3, v224
  v_lshlrev_b32 v245, 4, v244
  v_lshl_add_u32 v245, v243, 13, v245
  v_lshl_add_u32 v248, v242, 6, v245
  v_xor_b32 v246, 32, v248
  v_add_u32 v249, 31744, v248
  v_add_u32 v250, 63488, v246
  v_add_u32 v251, 95232, v246
  s_lshl_b32 s55, s7, 18
  s_lshl_b32 s56, s3, 16
  s_add_u32 s55, s55, s56
  s_lshl_b32 s56, s6, 8
  s_sub_u32 s57, 4194304, s56
  s_waitcnt lgkmcnt(0)
  buffer_load_dwordx4 v[16:19], v5, s[28:31], s45 offen nt
  s_add_u32 s45, s45, 7680
  buffer_load_dwordx4 v[20:23], v5, s[28:31], s45 offen nt
  s_add_u32 s45, s45, 7680
  buffer_load_dwordx4 v[24:27], v5, s[28:31], s45 offen nt
  s_add_u32 s45, s45, 7680
  buffer_load_dwordx4 v[28:31], v5, s[28:31], s45 offen nt
  s_add_u32 s45, s45, 7680
  buffer_load_dwordx4 v[32:35], v5, s[28:31], s45 offen nt
  s_add_u32 s45, s45, 7680
  buffer_load_ushort v8, v4, s[24:27], 0 offen offset:0
  buffer_load_ushort v9, v4, s[24:27], 0 offen offset:2
  buffer_load_ushort v10, v4, s[24:27], 0 offen offset:4
  buffer_load_ushort v11, v4, s[24:27], 0 offen offset:6
  buffer_load_ushort v12, v4, s[24:27], 0 offen offset:8
  s_add_u32 s16, s16, s56
  s_addc_u32 s17, s17, 0
  s_mov_b32 s18, s57
  s_mov_b32 s19, 0x20000
  s_add_u32 s12, s12, s55
  s_addc_u32 s13, s13, 0
  s_mov_b32 s14, 65536
  s_mov_b32 s15, 0x20000
  s_add_u32 m0, s49, 32768
  s_add_u32 s46, s53, 0
  buffer_load_dwordx4 v248, s[16:19], s46 offen offset:0 nt lds
  buffer_load_dwordx4 v249, s[16:19], s46 offen offset:1024 nt lds
  buffer_load_dwordx4 v250, s[16:19], s46 offen offset:2048 nt lds
  buffer_load_dwordx4 v251, s[16:19], s46 offen offset:3072 nt lds
  s_lshl_b32 s51, s7, 2
  s_add_u32 s51, s51, s3
  s_mul_i32 s51, s51, 114688
  s_add_u32 s51, s51, 524288
  v_min_u32 v60, 27, v224
  v_and_b32 v61, 1, v60
  v_lshrrev_b32 v60, 1, v60
  v_lshlrev_b32 v60, 13, v60
  v_lshl_add_u32 v60, v61, 7, v60
  buffer_load_dword v227, v60, s[16:19], s51 offen
  s_lshl_b32 s51, s6, 11
  v_and_b32 v62, 7, v224
  v_max_u32 v62, 1, v62
  v_bfe_u32 v63, v224, 3, 1
  v_lshlrev_b32 v62, 7, v62
  v_lshl_add_u32 v62, v63, 10, v62
  buffer_load_dword v227, v62, s[12:15], s51 offen
  s_lshr_b32 s64, s2, 3
  s_lshl_b32 s64, s64, 2
  s_add_u32 s64, s64, s3
  s_mul_i32 s64, s64, 6
  v_min_u32 v60, 5, v224
  v_add_u32 v60, s64, v60
  s_getpc_b64 s[64:65]
L_adaL_pc_1:
  s_add_u32 s64, s64, L_c0-L_adaL_pc_1
  s_addc_u32 s65, s65, 0
  v_lshlrev_b32 v60, 7, v60
  v_min_u32 v60, L_c1-L_c0, v60
  v_mov_b32 v61, s65
  v_add_co_u32 v60, vcc, s64, v60
  s_nop 1
  v_addc_co_u32 v61, vcc, 0, v61, vcc
  global_load_dword v227, v[60:61], off
L_c0:
  s_add_u32 s20, s20, s56
  s_addc_u32 s21, s21, 0
  s_mov_b32 s22, s57
  s_mov_b32 s23, 0x20000
  s_sub_u32 s57, 5242880, s56
  s_add_u32 s40, s40, s56
  s_addc_u32 s41, s41, 0
  s_mov_b32 s42, s57
  s_mov_b32 s43, 0x20000
  s_add_u32 s8, s4, 524288
  s_addc_u32 s9, s5, 0
  s_mov_b32 s10, 262144
  s_mov_b32 s11, 0x20000
  s_cmp_lt_u32 s2, 64
  s_cselect_b32 s44, 4096, 0
  s_cmp_eq_u32 s3, 0
  s_cselect_b32 s44, s44, 0
  s_lshl_b32 s45, s2, 12
  s_add_u32 s45, s45, 524288
  s_add_u32 s28, s4, s45
  s_addc_u32 s29, s5, 0
  s_mov_b32 s30, s44
  s_mov_b32 s31, 0x20000
  s_cmp_eq_u32 s44, 0
  s_cbranch_scc1 L_adaL_noz_2
  v_mov_b32 v48, 0
  v_mov_b32 v49, 0
  v_mov_b32 v50, 0
  v_mov_b32 v51, 0
  buffer_store_dwordx4 v[48:51], v225, s[28:31], 0 offen offset:0 sc1
  buffer_store_dwordx4 v[48:51], v225, s[28:31], 0 offen offset:1024 sc1
  buffer_store_dwordx4 v[48:51], v225, s[28:31], 0 offen offset:2048 sc1
  buffer_store_dwordx4 v[48:51], v225, s[28:31], 0 offen offset:3072 sc1
L_adaL_noz_2:
  s_movk_i32 s55, 4096
  s_movk_i32 s56, 8192
  s_movk_i32 s57, 12288
  s_mov_b32 s52, 0x3e0293ee
  s_lshl_b32 s44, s7, 2
  s_add_u32 s47, s44, s3
  s_sub_u32 s50, 60, s44
  s_add_u32 s50, s50, s3
  v_lshrrev_b32 v247, 5, v224
  v_and_b32 v246, 1, v242
  v_lshl_add_u32 v252, v246, 6, v245
  v_lshl_add_u32 v252, v247, 15, v252
  v_xor_b32 v247, 32, v252
  v_add_u32 v253, 64512, v247
  v_add_u32 v254, 129024, v252
  v_add_u32 v255, 193536, v247
  v_lshlrev_b32 v245, 3, v244
  v_lshl_add_u32 v245, v243, 6, v245
  v_lshl_add_u32 v245, v246, 5, v245
  v_lshl_add_u32 v234, v242, 11, v245
  v_lshl_add_u32 v228, v242, 10, v245
  v_xor_b32 v235, 32, v234
  v_xor_b32 v229, 32, v228
  v_add_u32 v238, 65536, v234
  v_add_u32 v232, 65536, v228
  v_add_u32 v239, 65536, v235
  v_add_u32 v233, 65536, v229
  v_add_u32 v236, 131072, v234
  v_add_u32 v230, 131072, v228
  v_add_u32 v237, 131072, v235
  v_add_u32 v231, 131072, v229
  v_and_b32 v245, 15, v224
  v_bfe_u32 v246, v224, 1, 3
  v_lshlrev_b32 v245, 7, v245
  v_add_u32 v245, s48, v245
  v_xor_b32 v246, v246, v242
  v_lshl_add_u32 v128, v246, 4, v245
  v_xor_b32 v129, 64, v128
  v_add_u32 v130, 65536, v128
  v_add_u32 v131, 65536, v129
  s_lshr_b32 s60, s2, 4
  s_sub_u32 s60, 15, s60
  s_lshl_b32 s60, s60, 6
  s_and_b32 s61, s2, 7
  s_lshl_b32 s61, s61, 3
  s_add_u32 s59, s60, s61
  s_bfe_u32 s61, s2, 0x10003
  s_lshl_b32 s61, s61, 2
  s_add_u32 s59, s59, s61
  s_add_u32 s59, s59, s3
  s_cmp_lt_u32 s59, 640
  s_cselect_b32 s60, 56, 80
  s_load_dwordx2 s[66:67], s[0:1], s60
  s_and_b32 s61, s59, 7
  s_cmp_ge_u32 s59, 640
  s_cbranch_scc1 L_adaL_j2_3
  s_lshr_b32 s60, s59, 5
  s_bfe_u32 s61, s59, 0x40001
  s_mul_i32 s71, s61, 20
  s_add_u32 s71, s71, s60
  s_mul_i32 s71, s71, 7168
  s_and_b32 s62, s59, 1
  s_lshl_b32 s63, s62, 12
  s_add_u32 s71, s71, s63
  s_add_u32 s71, s71, 28311552
  s_lshl_b32 s63, s62, 10
  s_sub_u32 s73, 4096, s63
  s_lshr_b32 s70, s73, 5
  s_and_b32 s63, s59, 15
  s_cmp_eq_u32 s63, 15
  s_cselect_b32 s70, 32, s70
  s_mul_i32 s69, s61, 224
  s_cmp_ge_u32 s61, 8
  s_cselect_b32 s63, 64, 0
  s_sub_u32 s69, s69, s63
  s_lshl_b32 s62, s62, 7
  s_add_u32 s69, s69, s62
  s_mov_b32 s68, 2211840
  s_mul_i32 s61, s60, 13108
  s_lshr_b32 s61, s61, 16
  s_mul_i32 s62, s61, 5
  s_sub_u32 s62, s60, s62
  s_mul_i32 s61, s61, 160
  s_cmp_ge_u32 s62, 2
  s_cselect_b32 s63, 16, 0
  s_add_u32 s61, s61, s63
  s_cmp_eq_u32 s62, 4
  s_cselect_b32 s63, 80, 0
  s_lshl_b32 s62, s62, 5
  s_add_u32 s61, s61, s62
  s_sub_u32 s61, s61, s63
  s_max_u32 s63, s63, 16
  s_mul_i32 s61, s61, 3456
  s_add_u32 s69, s69, s61
  s_movk_i32 s62, 3456
  s_branch L_adaL_j2_4
L_adaL_j2_3:
  s_sub_u32 s60, s59, 640
  s_lshr_b32 s60, s60, 3
  s_mul_i32 s71, s61, 28
  s_add_u32 s71, s71, s60
  s_mul_i32 s71, s71, 5120
  s_add_u32 s71, s71, 31457280
  s_mul_i32 s69, s61, 160
  s_movk_i32 s70, 160
  s_cmp_lt_u32 s59, 864
  s_cselect_b32 s73, 5120, 0
  s_cselect_b32 s68, 1105920, 0
  s_mul_i32 s61, s60, 9363
  s_lshr_b32 s61, s61, 16
  s_mul_i32 s62, s61, 7
  s_sub_u32 s62, s60, s62
  s_mul_i32 s61, s61, 224
  s_cmp_ge_u32 s62, 3
  s_cselect_b32 s63, 16, 0
  s_add_u32 s61, s61, s63
  s_cmp_eq_u32 s62, 6
  s_cselect_b32 s63, 112, 0
  s_lshl_b32 s62, s62, 5
  s_add_u32 s61, s61, s62
  s_sub_u32 s61, s61, s63
  s_max_u32 s63, s63, 16
  s_mul_i32 s61, s61, 1280
  s_add_u32 s69, s69, s61
  s_movk_i32 s62, 1280
L_adaL_j2_4:
  s_add_u32 s70, s70, s69
  s_add_u32 s71, s4, s71
  s_addc_u32 s72, s5, 0
  s_mov_b32 s64, s36
  s_mov_b32 s65, s37
  s_sub_u32 s60, 14, s7
  s_cmp_lt_u32 s6, 16
  s_cselect_b32 s60, s7, s60
  s_lshl_b32 s60, s60, 4
  s_add_u32 s60, s60, s6
  s_mul_i32 s44, s60, 10240
  s_mul_i32 s45, s3, 2560
  s_add_u32 s44, s44, s45
  s_add_u32 s24, s96, s44
  s_addc_u32 s25, s97, 0
  s_mov_b32 s26, 2560
  s_mov_b32 s27, 0x20000
  v_lshrrev_b32 v136, 5, v224
  v_and_b32 v137, 31, v224
  v_mul_u32_u24 v136, 1280, v136
  v_lshl_add_u32 v136, v137, 4, v136
  v_cmp_gt_u32 vcc, 16, v137
  v_mov_b32 v138, 0x10000
  s_nop 0
  v_cndmask_b32 v138, v138, v136, vcc
  s_add_u32 m0, s48, 0
  s_mov_b32 s46, 0
  buffer_load_dwordx4 v140, s[12:15], s46 offen offset:0 lds
  buffer_load_dwordx4 v141, s[12:15], s46 offen offset:1024 lds
  buffer_load_dwordx4 v142, s[12:15], s46 offen offset:2048 lds
  buffer_load_dwordx4 v143, s[12:15], s46 offen offset:3072 lds
  s_waitcnt vmcnt(11)
  v_lshlrev_b32 v8, 16, v8
  s_add_u32 m0, s48, 4096
  s_mov_b32 s46, 32768
  buffer_load_dwordx4 v140, s[12:15], s46 offen offset:0 lds
  v_lshlrev_b32 v9, 16, v9
  v_lshlrev_b32 v10, 16, v10
  v_lshlrev_b32 v11, 16, v11
  v_lshlrev_b32 v12, 16, v12
  v_mul_f32 v52, 0xbfb8aa3b, v8
  v_mul_f32 v53, 0xbfb8aa3b, v9
  v_mul_f32 v54, 0xbfb8aa3b, v10
  v_mul_f32 v55, 0xbfb8aa3b, v11
  v_mul_f32 v56, 0xbfb8aa3b, v12
  v_exp_f32 v52, v52
  buffer_load_dwordx4 v141, s[12:15], s46 offen offset:1024 lds
  v_exp_f32 v53, v53
  v_exp_f32 v54, v54
  v_exp_f32 v55, v55
  v_exp_f32 v56, v56
  v_add_f32 v52, 1.0, v52
  v_add_f32 v53, 1.0, v53
  v_add_f32 v54, 1.0, v54
  v_add_f32 v55, 1.0, v55
  v_add_f32 v56, 1.0, v56
  v_rcp_f32 v52, v52
  buffer_load_dwordx4 v142, s[12:15], s46 offen offset:2048 lds
  v_rcp_f32 v53, v53
  v_rcp_f32 v54, v54
  v_rcp_f32 v55, v55
  v_rcp_f32 v56, v56
  v_mul_f32 v8, v8, v52
  v_mul_f32 v9, v9, v53
  v_mul_f32 v10, v10, v54
  v_mul_f32 v11, v11, v55
  v_mul_f32 v12, v12, v56
  v_cvt_pk_bf16_f32 v8, v8, v8
  buffer_load_dwordx4 v143, s[12:15], s46 offen offset:3072 lds
  v_cvt_pk_bf16_f32 v9, v9, v9
  v_cvt_pk_bf16_f32 v10, v10, v10
  v_cvt_pk_bf16_f32 v11, v11, v11
  v_cvt_pk_bf16_f32 v12, v12, v12
  v_lshlrev_b32 v8, 16, v8
  v_lshlrev_b32 v9, 16, v9
  v_lshlrev_b32 v10, 16, v10
  v_lshlrev_b32 v11, 16, v11
  v_lshlrev_b32 v12, 16, v12
  v_lshlrev_b32 v6, 16, v16
  s_add_u32 m0, s49, 81920
  s_add_u32 s46, s53, 524288
  buffer_load_dwordx4 v248, s[16:19], s46 offen offset:0 nt lds
  v_and_b32 v7, 0xffff0000, v16
  v_pk_mul_f32 v[40:41], v[6:7], v[8:9] op_sel:[0,0] op_sel_hi:[1,0]
  v_lshlrev_b32 v6, 16, v17
  v_and_b32 v7, 0xffff0000, v17
  v_pk_mul_f32 v[42:43], v[6:7], v[8:9] op_sel:[0,0] op_sel_hi:[1,0]
  v_lshlrev_b32 v6, 16, v18
  v_and_b32 v7, 0xffff0000, v18
  v_pk_mul_f32 v[44:45], v[6:7], v[8:9] op_sel:[0,0] op_sel_hi:[1,0]
  v_lshlrev_b32 v6, 16, v19
  v_and_b32 v7, 0xffff0000, v19
  buffer_load_dwordx4 v249, s[16:19], s46 offen offset:1024 nt lds
  v_pk_mul_f32 v[46:47], v[6:7], v[8:9] op_sel:[0,0] op_sel_hi:[1,0]
  v_lshlrev_b32 v6, 16, v20
  v_and_b32 v7, 0xffff0000, v20
  v_pk_fma_f32 v[40:41], v[6:7], v[8:9], v[40:41] op_sel:[0,1,0] op_sel_hi:[1,1,1]
  v_lshlrev_b32 v6, 16, v21
  v_and_b32 v7, 0xffff0000, v21
  v_pk_fma_f32 v[42:43], v[6:7], v[8:9], v[42:43] op_sel:[0,1,0] op_sel_hi:[1,1,1]
  v_lshlrev_b32 v6, 16, v22
  v_and_b32 v7, 0xffff0000, v22
  v_pk_fma_f32 v[44:45], v[6:7], v[8:9], v[44:45] op_sel:[0,1,0] op_sel_hi:[1,1,1]
  buffer_load_dwordx4 v250, s[16:19], s46 offen offset:2048 nt lds
  v_lshlrev_b32 v6, 16, v23
  v_and_b32 v7, 0xffff0000, v23
  v_pk_fma_f32 v[46:47], v[6:7], v[8:9], v[46:47] op_sel:[0,1,0] op_sel_hi:[1,1,1]
  v_lshlrev_b32 v6, 16, v24
  v_and_b32 v7, 0xffff0000, v24
  v_pk_fma_f32 v[40:41], v[6:7], v[10:11], v[40:41] op_sel:[0,0,0] op_sel_hi:[1,0,1]
  v_lshlrev_b32 v6, 16, v25
  v_and_b32 v7, 0xffff0000, v25
  v_pk_fma_f32 v[42:43], v[6:7], v[10:11], v[42:43] op_sel:[0,0,0] op_sel_hi:[1,0,1]
  v_lshlrev_b32 v6, 16, v26
  buffer_load_dwordx4 v251, s[16:19], s46 offen offset:3072 nt lds
  v_and_b32 v7, 0xffff0000, v26
  v_pk_fma_f32 v[44:45], v[6:7], v[10:11], v[44:45] op_sel:[0,0,0] op_sel_hi:[1,0,1]
  v_lshlrev_b32 v6, 16, v27
  v_and_b32 v7, 0xffff0000, v27
  v_pk_fma_f32 v[46:47], v[6:7], v[10:11], v[46:47] op_sel:[0,0,0] op_sel_hi:[1,0,1]
  v_lshlrev_b32 v6, 16, v28
  v_and_b32 v7, 0xffff0000, v28
  v_pk_fma_f32 v[40:41], v[6:7], v[10:11], v[40:41] op_sel:[0,1,0] op_sel_hi:[1,1,1]
  v_lshlrev_b32 v6, 16, v29
  v_and_b32 v7, 0xffff0000, v29
  s_add_u32 m0, s48, 49152
  s_mov_b32 s46, 128
  buffer_load_dwordx4 v140, s[12:15], s46 offen offset:0 lds
  v_pk_fma_f32 v[42:43], v[6:7], v[10:11], v[42:43] op_sel:[0,1,0] op_sel_hi:[1,1,1]
  v_lshlrev_b32 v6, 16, v30
  v_and_b32 v7, 0xffff0000, v30
  v_pk_fma_f32 v[44:45], v[6:7], v[10:11], v[44:45] op_sel:[0,1,0] op_sel_hi:[1,1,1]
  v_lshlrev_b32 v6, 16, v31
  v_and_b32 v7, 0xffff0000, v31
  v_pk_fma_f32 v[46:47], v[6:7], v[10:11], v[46:47] op_sel:[0,1,0] op_sel_hi:[1,1,1]
  v_lshlrev_b32 v6, 16, v32
  v_and_b32 v7, 0xffff0000, v32
  v_pk_fma_f32 v[40:41], v[6:7], v[12:13], v[40:41] op_sel:[0,0,0] op_sel_hi:[1,0,1]
  buffer_load_dwordx4 v141, s[12:15], s46 offen offset:1024 lds
  v_lshlrev_b32 v6, 16, v33
  v_and_b32 v7, 0xffff0000, v33
  v_pk_fma_f32 v[42:43], v[6:7], v[12:13], v[42:43] op_sel:[0,0,0] op_sel_hi:[1,0,1]
  v_lshlrev_b32 v6, 16, v34
  v_and_b32 v7, 0xffff0000, v34
  v_pk_fma_f32 v[44:45], v[6:7], v[12:13], v[44:45] op_sel:[0,0,0] op_sel_hi:[1,0,1]
  v_lshlrev_b32 v6, 16, v35
  v_and_b32 v7, 0xffff0000, v35
  v_pk_fma_f32 v[46:47], v[6:7], v[12:13], v[46:47] op_sel:[0,0,0] op_sel_hi:[1,0,1]
  v_lshrrev_b32 v6, 4, v224
  buffer_load_dwordx4 v142, s[12:15], s46 offen offset:2048 lds
  v_lshlrev_b32 v6, 3, v6
  v_permlane32_swap_b32 v40, v44
  v_permlane32_swap_b32 v41, v45
  v_permlane32_swap_b32 v42, v46
  v_permlane32_swap_b32 v43, v47
  v_lshl_add_u32 v6, v3, 5, v6
  s_lshl_b32 s44, s3, 8
  s_add_u32 s44, s44, 160256
  v_add_f32 v40, v40, v44
  v_add_f32 v41, v41, v45
  buffer_load_dwordx4 v143, s[12:15], s46 offen offset:3072 lds
  v_add_f32 v42, v42, v46
  v_add_f32 v43, v43, v47
  v_add_u32 v6, s44, v6
  s_nop 0
  v_permlane16_swap_b32 v40, v42
  v_permlane16_swap_b32 v41, v43
  s_nop 1
  v_add_f32 v40, v40, v42
  v_add_f32 v41, v41, v43
  s_nop 1
  v_add_f32_dpp v40, v40, v40 row_ror:8 row_mask:0xf bank_mask:0xf
  v_add_f32_dpp v41, v41, v41 row_ror:8 row_mask:0xf bank_mask:0xf
  ds_write_b64 v6, v[40:41]
  s_cmp_lt_u32 s2, 240
  s_cselect_b32 s61, 61440, 0
  s_cmp_eq_u32 s3, 0
  s_cselect_b32 s61, s61, 0
  s_add_u32 s32, s4, 327680
  s_addc_u32 s33, s5, 0
  s_mov_b32 s34, s61
  s_mov_b32 s35, 0x20000
  s_movk_i32 s38, 256
  s_mov_b32 s39, 0x20000
  s_waitcnt vmcnt(8)
  s_waitcnt lgkmcnt(0)
  s_barrier
  ds_read_b64_tr_b16 v[192:193], v234 offset:32768
  ds_read_b64_tr_b16 v[194:195], v234 offset:33792
  ds_read_b128 a[128:131], v128 offset:0
  ds_read_b128 a[132:135], v128 offset:2048
  ds_read_b128 a[136:139], v128 offset:4096
  ds_read_b128 a[140:143], v128 offset:6144
  ds_read_b64_tr_b16 v[196:197], v235 offset:32768
  ds_read_b64_tr_b16 v[198:199], v235 offset:33792
  ds_read_b64_tr_b16 v[200:201], v234 offset:33024
  ds_read_b64_tr_b16 v[202:203], v234 offset:34048
  ds_read_b64_tr_b16 v[204:205], v235 offset:33024
  ds_read_b64_tr_b16 v[206:207], v235 offset:34048
  s_waitcnt lgkmcnt(0)
  v_mfma_f32_16x16x32_bf16 v[0:3], v[192:195], a[128:131], 0
  s_add_u32 m0, s48, 53248
  s_mov_b32 s46, 32896
  ds_read_b64_tr_b16 v[208:209], v234 offset:33280
  ds_read_b64_tr_b16 v[210:211], v234 offset:34304
  v_mfma_f32_16x16x32_bf16 v[32:35], v[192:195], a[132:135], 0
  buffer_load_dwordx4 v140, s[12:15], s46 offen offset:0 lds
  v_lshlrev_b32 v180, 2, v224
  v_mfma_f32_16x16x32_bf16 v[64:67], v[192:195], a[136:139], 0
  ds_read_b64_tr_b16 v[212:213], v235 offset:33280
  ds_read_b64_tr_b16 v[214:215], v235 offset:34304
  v_mfma_f32_16x16x32_bf16 v[96:99], v[192:195], a[140:143], 0
  buffer_load_dwordx4 v141, s[12:15], s46 offen offset:1024 lds
  v_add_u32 v180, 160256, v180
  v_mfma_f32_16x16x32_bf16 v[4:7], v[196:199], a[128:131], 0
  ds_read_b32 v181, v180 offset:0
  ds_read_b64_tr_b16 v[216:217], v234 offset:33536
  ds_read_b64_tr_b16 v[218:219], v234 offset:34560
  v_mfma_f32_16x16x32_bf16 v[36:39], v[196:199], a[132:135], 0
  buffer_load_dwordx4 v142, s[12:15], s46 offen offset:2048 lds
  v_mfma_f32_16x16x32_bf16 v[68:71], v[196:199], a[136:139], 0
  ds_read_b32 v182, v180 offset:256
  ds_read_b64_tr_b16 v[220:221], v235 offset:33536
  ds_read_b64_tr_b16 v[222:223], v235 offset:34560
  v_mfma_f32_16x16x32_bf16 v[100:103], v[196:199], a[140:143], 0
  buffer_load_dwordx4 v143, s[12:15], s46 offen offset:3072 lds
  v_mfma_f32_16x16x32_bf16 v[8:11], v[200:203], a[128:131], 0
  ds_read_b32 v183, v180 offset:512
  v_mfma_f32_16x16x32_bf16 v[40:43], v[200:203], a[132:135], 0
  buffer_load_dwordx4 v[144:147], v136, s[24:27], 0 offen offset:0
  v_mfma_f32_16x16x32_bf16 v[72:75], v[200:203], a[136:139], 0
  ds_read_b32 v184, v180 offset:768
  s_lshr_b32 s44, s2, 2
  v_mfma_f32_16x16x32_bf16 v[104:107], v[200:203], a[140:143], 0
  buffer_load_dwordx4 v[148:151], v136, s[24:27], 0 offen offset:512
  s_lshl_b32 s44, s44, 10
  v_mfma_f32_16x16x32_bf16 v[12:15], v[204:207], a[128:131], 0
  s_and_b32 s45, s2, 3
  s_lshl_b32 s45, s45, 2
  v_mfma_f32_16x16x32_bf16 v[44:47], v[204:207], a[132:135], 0
  buffer_load_dwordx4 v[152:155], v138, s[24:27], 0 offen offset:1024
  s_add_u32 s59, s44, s45
  v_mfma_f32_16x16x32_bf16 v[76:79], v[204:207], a[136:139], 0
  s_add_u32 m0, s49, 131072
  s_add_u32 s46, s53, 1048576
  v_mfma_f32_16x16x32_bf16 v[108:111], v[204:207], a[140:143], 0
  s_waitcnt lgkmcnt(0)
  buffer_load_dwordx4 v248, s[16:19], s46 offen offset:0 nt lds
  v_mfma_f32_16x16x32_bf16 v[16:19], v[208:211], a[128:131], 0
  ds_read_b64_tr_b16 v[192:193], v234 offset:40960
  ds_read_b64_tr_b16 v[194:195], v234 offset:41984
  v_mfma_f32_16x16x32_bf16 v[48:51], v[208:211], a[132:135], 0
  buffer_load_dwordx4 v249, s[16:19], s46 offen offset:1024 nt lds
  v_add_f32 v181, v181, v182
  v_mfma_f32_16x16x32_bf16 v[80:83], v[208:211], a[136:139], 0
  ds_read_b128 a[144:147], v129 offset:0
  ds_read_b128 a[148:151], v129 offset:2048
  v_mfma_f32_16x16x32_bf16 v[112:115], v[208:211], a[140:143], 0
  buffer_load_dwordx4 v250, s[16:19], s46 offen offset:2048 nt lds
  v_add_f32 v183, v183, v184
  v_mfma_f32_16x16x32_bf16 v[20:23], v[212:215], a[128:131], 0
  ds_read_b128 a[152:155], v129 offset:4096
  v_add_f32 v181, v181, v183
  v_mfma_f32_16x16x32_bf16 v[52:55], v[212:215], a[132:135], 0
  ds_read_b128 a[156:159], v129 offset:6144
  v_mfma_f32_16x16x32_bf16 v[84:87], v[212:215], a[136:139], 0
  ds_read_b64_tr_b16 v[196:197], v235 offset:40960
  ds_read_b64_tr_b16 v[198:199], v235 offset:41984
  v_mfma_f32_16x16x32_bf16 v[116:119], v[212:215], a[140:143], 0
  buffer_load_dwordx4 v251, s[16:19], s46 offen offset:3072 nt lds
  v_mfma_f32_16x16x32_bf16 v[24:27], v[216:219], a[128:131], 0
  s_add_u32 m0, s48, 98304
  s_mov_b32 s46, 256
  ds_read_b64_tr_b16 v[200:201], v234 offset:41216
  ds_read_b64_tr_b16 v[202:203], v234 offset:42240
  v_mfma_f32_16x16x32_bf16 v[56:59], v[216:219], a[132:135], 0
  buffer_load_dwordx4 v140, s[12:15], s46 offen offset:0 lds
  v_mfma_f32_16x16x32_bf16 v[88:91], v[216:219], a[136:139], 0
  ds_read_b64_tr_b16 v[204:205], v235 offset:41216
  ds_read_b64_tr_b16 v[206:207], v235 offset:42240
  v_mfma_f32_16x16x32_bf16 v[120:123], v[216:219], a[140:143], 0
  buffer_load_dwordx4 v141, s[12:15], s46 offen offset:1024 lds
  v_mfma_f32_16x16x32_bf16 v[28:31], v[220:223], a[128:131], 0
  v_mfma_f32_16x16x32_bf16 v[60:63], v[220:223], a[132:135], 0
  buffer_store_dword v181, v225, s[32:35], s59 offen sc1
  v_mfma_f32_16x16x32_bf16 v[92:95], v[220:223], a[136:139], 0
  v_mfma_f32_16x16x32_bf16 v[124:127], v[220:223], a[140:143], 0
  s_waitcnt lgkmcnt(0)
  buffer_load_dwordx4 v142, s[12:15], s46 offen offset:2048 lds
  v_mfma_f32_16x16x32_bf16 v[0:3], v[192:195], a[144:147], v[0:3]
  ds_read_b64_tr_b16 v[208:209], v234 offset:41472
  ds_read_b64_tr_b16 v[210:211], v234 offset:42496
  v_mfma_f32_16x16x32_bf16 v[32:35], v[192:195], a[148:151], v[32:35]
  buffer_load_dwordx4 v143, s[12:15], s46 offen offset:3072 lds
  v_mfma_f32_16x16x32_bf16 v[64:67], v[192:195], a[152:155], v[64:67]
  s_add_u32 m0, s48, 102400
  s_mov_b32 s46, 33024
  ds_read_b64_tr_b16 v[212:213], v235 offset:41472
  ds_read_b64_tr_b16 v[214:215], v235 offset:42496
  v_mfma_f32_16x16x32_bf16 v[96:99], v[192:195], a[156:159], v[96:99]
  buffer_load_dwordx4 v140, s[12:15], s46 offen offset:0 lds
  v_mfma_f32_16x16x32_bf16 v[4:7], v[196:199], a[144:147], v[4:7]
  ds_read_b64_tr_b16 v[216:217], v234 offset:41728
  v_mfma_f32_16x16x32_bf16 v[36:39], v[196:199], a[148:151], v[36:39]
  ds_read_b64_tr_b16 v[218:219], v234 offset:42752
  v_mfma_f32_16x16x32_bf16 v[68:71], v[196:199], a[152:155], v[68:71]
  ds_read_b64_tr_b16 v[220:221], v235 offset:41728
  ds_read_b64_tr_b16 v[222:223], v235 offset:42752
  v_mfma_f32_16x16x32_bf16 v[100:103], v[196:199], a[156:159], v[100:103]
  buffer_load_dwordx4 v141, s[12:15], s46 offen offset:1024 lds
  v_mfma_f32_16x16x32_bf16 v[8:11], v[200:203], a[144:147], v[8:11]
  v_mfma_f32_16x16x32_bf16 v[40:43], v[200:203], a[148:151], v[40:43]
  buffer_load_dwordx4 v142, s[12:15], s46 offen offset:2048 lds
  v_mfma_f32_16x16x32_bf16 v[72:75], v[200:203], a[152:155], v[72:75]
  v_mfma_f32_16x16x32_bf16 v[104:107], v[200:203], a[156:159], v[104:107]
  buffer_load_dwordx4 v143, s[12:15], s46 offen offset:3072 lds
  v_mfma_f32_16x16x32_bf16 v[12:15], v[204:207], a[144:147], v[12:15]
  v_mfma_f32_16x16x32_bf16 v[44:47], v[204:207], a[148:151], v[44:47]
  v_mfma_f32_16x16x32_bf16 v[76:79], v[204:207], a[152:155], v[76:79]
  v_mfma_f32_16x16x32_bf16 v[108:111], v[204:207], a[156:159], v[108:111]
  s_waitcnt lgkmcnt(0)
  v_mfma_f32_16x16x32_bf16 v[16:19], v[208:211], a[144:147], v[16:19]
  s_waitcnt vmcnt(16)
  s_barrier
  ds_read_b64_tr_b16 v[192:193], v238 offset:16384
  v_mfma_f32_16x16x32_bf16 v[48:51], v[208:211], a[148:151], v[48:51]
  ds_read_b64_tr_b16 v[194:195], v238 offset:17408
  v_mfma_f32_16x16x32_bf16 v[80:83], v[208:211], a[152:155], v[80:83]
  s_add_u32 m0, s49, 32768
  s_add_u32 s46, s53, 1572864
  ds_read_b128 a[160:163], v128 offset:49152
  ds_read_b128 a[164:167], v128 offset:51200
  v_mfma_f32_16x16x32_bf16 v[112:115], v[208:211], a[156:159], v[112:115]
  buffer_load_dwordx4 v248, s[16:19], s46 offen offset:0 nt lds
  v_mfma_f32_16x16x32_bf16 v[20:23], v[212:215], a[144:147], v[20:23]
  ds_read_b128 a[168:171], v128 offset:53248
  v_mfma_f32_16x16x32_bf16 v[52:55], v[212:215], a[148:151], v[52:55]
  ds_read_b128 a[172:175], v128 offset:55296
  v_mfma_f32_16x16x32_bf16 v[84:87], v[212:215], a[152:155], v[84:87]
  ds_read_b64_tr_b16 v[196:197], v239 offset:16384
  ds_read_b64_tr_b16 v[198:199], v239 offset:17408
  v_mfma_f32_16x16x32_bf16 v[116:119], v[212:215], a[156:159], v[116:119]
  buffer_load_dwordx4 v249, s[16:19], s46 offen offset:1024 nt lds
  v_mfma_f32_16x16x32_bf16 v[24:27], v[216:219], a[144:147], v[24:27]
  ds_read_b64_tr_b16 v[200:201], v238 offset:16640
  v_mfma_f32_16x16x32_bf16 v[56:59], v[216:219], a[148:151], v[56:59]
  ds_read_b64_tr_b16 v[202:203], v238 offset:17664
  v_mfma_f32_16x16x32_bf16 v[88:91], v[216:219], a[152:155], v[88:91]
  ds_read_b64_tr_b16 v[204:205], v239 offset:16640
  v_mfma_f32_16x16x32_bf16 v[120:123], v[216:219], a[156:159], v[120:123]
  ds_read_b64_tr_b16 v[206:207], v239 offset:17664
  v_mfma_f32_16x16x32_bf16 v[28:31], v[220:223], a[144:147], v[28:31]
  v_mfma_f32_16x16x32_bf16 v[60:63], v[220:223], a[148:151], v[60:63]
  buffer_load_dwordx4 v250, s[16:19], s46 offen offset:2048 nt lds
  v_mfma_f32_16x16x32_bf16 v[92:95], v[220:223], a[152:155], v[92:95]
  v_mfma_f32_16x16x32_bf16 v[124:127], v[220:223], a[156:159], v[124:127]
  s_waitcnt lgkmcnt(0)
  v_mfma_f32_16x16x32_bf16 v[0:3], v[192:195], a[160:163], v[0:3]
  ds_read_b64_tr_b16 v[208:209], v238 offset:16896
  ds_read_b64_tr_b16 v[210:211], v238 offset:17920
  v_mfma_f32_16x16x32_bf16 v[32:35], v[192:195], a[164:167], v[32:35]
  buffer_load_dwordx4 v251, s[16:19], s46 offen offset:3072 nt lds
  s_waitcnt vmcnt(17)
  v_mfma_f32_16x16x32_bf16 v[64:67], v[192:195], a[168:171], v[64:67]
  ds_read_b64_tr_b16 v[212:213], v239 offset:16896
  v_lshlrev_b32 v156, 16, v144
  v_mfma_f32_16x16x32_bf16 v[96:99], v[192:195], a[172:175], v[96:99]
  ds_read_b64_tr_b16 v[214:215], v239 offset:17920
  v_and_b32 v157, 0xffff0000, v144
  v_lshlrev_b32 v158, 16, v145
  v_mfma_f32_16x16x32_bf16 v[4:7], v[196:199], a[160:163], v[4:7]
  ds_read_b64_tr_b16 v[216:217], v238 offset:17152
  v_and_b32 v159, 0xffff0000, v145
  v_mfma_f32_16x16x32_bf16 v[36:39], v[196:199], a[164:167], v[36:39]
  ds_read_b64_tr_b16 v[218:219], v238 offset:18176
  v_lshlrev_b32 v160, 16, v146
  v_and_b32 v161, 0xffff0000, v146
  v_mfma_f32_16x16x32_bf16 v[68:71], v[196:199], a[168:171], v[68:71]
  s_add_u32 m0, s48, 0
  s_mov_b32 s46, 384
  ds_read_b64_tr_b16 v[220:221], v239 offset:17152
  ds_read_b64_tr_b16 v[222:223], v239 offset:18176
  v_mfma_f32_16x16x32_bf16 v[100:103], v[196:199], a[172:175], v[100:103]
  buffer_load_dwordx4 v140, s[12:15], s46 offen offset:0 lds
  v_lshlrev_b32 v162, 16, v147
  v_mfma_f32_16x16x32_bf16 v[8:11], v[200:203], a[160:163], v[8:11]
  v_and_b32 v163, 0xffff0000, v147
  v_lshlrev_b32 v164, 16, v148
  v_mfma_f32_16x16x32_bf16 v[40:43], v[200:203], a[164:167], v[40:43]
  v_and_b32 v165, 0xffff0000, v148
  v_lshlrev_b32 v166, 16, v149
  v_mfma_f32_16x16x32_bf16 v[72:75], v[200:203], a[168:171], v[72:75]
  v_and_b32 v167, 0xffff0000, v149
  v_lshlrev_b32 v168, 16, v150
  v_mfma_f32_16x16x32_bf16 v[104:107], v[200:203], a[172:175], v[104:107]
  v_and_b32 v169, 0xffff0000, v150
  v_lshlrev_b32 v170, 16, v151
  v_mfma_f32_16x16x32_bf16 v[12:15], v[204:207], a[160:163], v[12:15]
  v_and_b32 v171, 0xffff0000, v151
  v_lshlrev_b32 v172, 16, v152
  v_mfma_f32_16x16x32_bf16 v[44:47], v[204:207], a[164:167], v[44:47]
  buffer_load_dwordx4 v141, s[12:15], s46 offen offset:1024 lds
  v_and_b32 v173, 0xffff0000, v152
  v_mfma_f32_16x16x32_bf16 v[76:79], v[204:207], a[168:171], v[76:79]
  v_lshlrev_b32 v174, 16, v153
  v_and_b32 v175, 0xffff0000, v153
  v_mfma_f32_16x16x32_bf16 v[108:111], v[204:207], a[172:175], v[108:111]
  s_waitcnt lgkmcnt(0)
  v_lshlrev_b32 v176, 16, v154
  v_and_b32 v177, 0xffff0000, v154
  v_mfma_f32_16x16x32_bf16 v[16:19], v[208:211], a[160:163], v[16:19]
  ds_read_b64_tr_b16 v[192:193], v238 offset:24576
  ds_read_b64_tr_b16 v[194:195], v238 offset:25600
  v_mfma_f32_16x16x32_bf16 v[48:51], v[208:211], a[164:167], v[48:51]
  buffer_load_dwordx4 v142, s[12:15], s46 offen offset:2048 lds
  v_lshlrev_b32 v178, 16, v155
  v_mfma_f32_16x16x32_bf16 v[80:83], v[208:211], a[168:171], v[80:83]
  ds_read_b128 a[176:179], v129 offset:49152
  v_and_b32 v179, 0xffff0000, v155
  v_mfma_f32_16x16x32_bf16 v[112:115], v[208:211], a[172:175], v[112:115]
  ds_read_b128 a[180:183], v129 offset:51200
  v_add_f32 v180, v156, v157
  v_add_f32 v180, v180, v158
  v_mfma_f32_16x16x32_bf16 v[20:23], v[212:215], a[160:163], v[20:23]
  ds_read_b128 a[184:187], v129 offset:53248
  v_add_f32 v180, v180, v159
  v_mfma_f32_16x16x32_bf16 v[52:55], v[212:215], a[164:167], v[52:55]
  ds_read_b128 a[188:191], v129 offset:55296
  v_add_f32 v180, v180, v160
  v_add_f32 v180, v180, v161
  v_mfma_f32_16x16x32_bf16 v[84:87], v[212:215], a[168:171], v[84:87]
  ds_read_b64_tr_b16 v[196:197], v239 offset:24576
  ds_read_b64_tr_b16 v[198:199], v239 offset:25600
  v_mfma_f32_16x16x32_bf16 v[116:119], v[212:215], a[172:175], v[116:119]
  buffer_load_dwordx4 v143, s[12:15], s46 offen offset:3072 lds
  v_add_f32 v180, v180, v162
  v_mfma_f32_16x16x32_bf16 v[24:27], v[216:219], a[160:163], v[24:27]
  ds_read_b64_tr_b16 v[200:201], v238 offset:24832
  v_add_f32 v180, v180, v163
  v_mfma_f32_16x16x32_bf16 v[56:59], v[216:219], a[164:167], v[56:59]
  ds_read_b64_tr_b16 v[202:203], v238 offset:25856
  v_add_f32 v180, v180, v164
  v_add_f32 v180, v180, v165
  v_mfma_f32_16x16x32_bf16 v[88:91], v[216:219], a[168:171], v[88:91]
  s_add_u32 m0, s48, 4096
  s_mov_b32 s46, 33152
  ds_read_b64_tr_b16 v[204:205], v239 offset:24832
  ds_read_b64_tr_b16 v[206:207], v239 offset:25856
  v_mfma_f32_16x16x32_bf16 v[120:123], v[216:219], a[172:175], v[120:123]
  buffer_load_dwordx4 v140, s[12:15], s46 offen offset:0 lds
  v_add_f32 v180, v180, v166
  v_mfma_f32_16x16x32_bf16 v[28:31], v[220:223], a[160:163], v[28:31]
  v_add_f32 v180, v180, v167
  v_add_f32 v180, v180, v168
  v_mfma_f32_16x16x32_bf16 v[60:63], v[220:223], a[164:167], v[60:63]
  v_add_f32 v180, v180, v169
  v_add_f32 v180, v180, v170
  v_mfma_f32_16x16x32_bf16 v[92:95], v[220:223], a[168:171], v[92:95]
  v_add_f32 v180, v180, v171
  v_add_f32 v180, v180, v172
  v_mfma_f32_16x16x32_bf16 v[124:127], v[220:223], a[172:175], v[124:127]
  s_waitcnt lgkmcnt(0)
  v_add_f32 v180, v180, v173
  v_add_f32 v180, v180, v174
  v_mfma_f32_16x16x32_bf16 v[0:3], v[192:195], a[176:179], v[0:3]
  ds_read_b64_tr_b16 v[208:209], v238 offset:25088
  ds_read_b64_tr_b16 v[210:211], v238 offset:26112
  v_mfma_f32_16x16x32_bf16 v[32:35], v[192:195], a[180:183], v[32:35]
  buffer_load_dwordx4 v141, s[12:15], s46 offen offset:1024 lds
  v_add_f32 v180, v180, v175
  v_mfma_f32_16x16x32_bf16 v[64:67], v[192:195], a[184:187], v[64:67]
  ds_read_b64_tr_b16 v[212:213], v239 offset:25088
  v_add_f32 v180, v180, v176
  v_mfma_f32_16x16x32_bf16 v[96:99], v[192:195], a[188:191], v[96:99]
  ds_read_b64_tr_b16 v[214:215], v239 offset:26112
  v_add_f32 v180, v180, v177
  v_add_f32 v180, v180, v178
  v_mfma_f32_16x16x32_bf16 v[4:7], v[196:199], a[176:179], v[4:7]
  ds_read_b64_tr_b16 v[216:217], v238 offset:25344
  v_add_f32 v180, v180, v179
  v_mfma_f32_16x16x32_bf16 v[36:39], v[196:199], a[180:183], v[36:39]
  ds_read_b64_tr_b16 v[218:219], v238 offset:26368
  s_nop 1
  v_add_f32_dpp v180, v180, v180 quad_perm:[1,0,3,2] row_mask:0xf bank_mask:0xf
  v_mfma_f32_16x16x32_bf16 v[68:71], v[196:199], a[184:187], v[68:71]
  ds_read_b64_tr_b16 v[220:221], v239 offset:25344
  ds_read_b64_tr_b16 v[222:223], v239 offset:26368
  v_mfma_f32_16x16x32_bf16 v[100:103], v[196:199], a[188:191], v[100:103]
  buffer_load_dwordx4 v142, s[12:15], s46 offen offset:2048 lds
  s_nop 1
  v_mfma_f32_16x16x32_bf16 v[8:11], v[200:203], a[176:179], v[8:11]
  v_add_f32_dpp v180, v180, v180 quad_perm:[2,3,0,1] row_mask:0xf bank_mask:0xf
  s_nop 1
  v_mfma_f32_16x16x32_bf16 v[40:43], v[200:203], a[180:183], v[40:43]
  v_add_f32_dpp v180, v180, v180 row_half_mirror row_mask:0xf bank_mask:0xf
  s_nop 1
  v_mfma_f32_16x16x32_bf16 v[72:75], v[200:203], a[184:187], v[72:75]
  v_add_f32_dpp v180, v180, v180 row_mirror row_mask:0xf bank_mask:0xf
  v_mov_b32 v191, v180
  v_mfma_f32_16x16x32_bf16 v[104:107], v[200:203], a[188:191], v[104:107]
  buffer_load_dwordx4 v143, s[12:15], s46 offen offset:3072 lds
  s_nop 1
  v_mfma_f32_16x16x32_bf16 v[12:15], v[204:207], a[176:179], v[12:15]
  v_permlane16_swap_b32 v180, v191
  s_nop 1
  v_mfma_f32_16x16x32_bf16 v[44:47], v[204:207], a[180:183], v[44:47]
  v_add_f32 v180, v180, v191
  s_waitcnt vmcnt(18)
  s_cmp_ge_u32 s2, 80
  s_cbranch_scc1 L_adaL_noarr_5
  s_cmp_lg_u32 s3, 0
  s_cbranch_scc1 L_adaL_noarr_5
  s_and_b32 s44, s2, 1
  s_lshl_b32 s44, s44, 7
  v_mov_b32 v184, 0
  v_mov_b32 v185, 1
  s_mov_b64 exec, 1
  buffer_atomic_add v185, v184, s[36:39], s44 offen sc1
  s_mov_b64 exec, -1
L_adaL_noarr_5:
  v_mfma_f32_16x16x32_bf16 v[76:79], v[204:207], a[184:187], v[76:79]
  v_mul_f32 v180, 0x3acccccd, v180
  v_bfe_u32 v183, v224, 4, 1
  v_mfma_f32_16x16x32_bf16 v[108:111], v[204:207], a[188:191], v[108:111]
  s_waitcnt lgkmcnt(0)
  v_cvt_f32_u32 v183, v183
  v_fma_f32 v183, -v183, v180, v180
  v_mfma_f32_16x16x32_bf16 v[16:19], v[208:211], a[176:179], v[16:19]
  s_waitcnt vmcnt(12)
  s_barrier
  ds_read_b64_tr_b16 v[192:193], v236 offset:0
  v_sub_f32 v182, v156, v180
  v_mfma_f32_16x16x32_bf16 v[48:51], v[208:211], a[180:183], v[48:51]
  ds_read_b64_tr_b16 v[194:195], v236 offset:1024
  v_mul_f32 v181, v182, v182
  v_sub_f32 v182, v157, v180
  v_mfma_f32_16x16x32_bf16 v[80:83], v[208:211], a[184:187], v[80:83]
  s_add_u32 m0, s49, 81920
  s_add_u32 s46, s53, 2097152
  ds_read_b128 a[0:3], v130 offset:32768
  ds_read_b128 a[4:7], v130 offset:34816
  v_mfma_f32_16x16x32_bf16 v[112:115], v[208:211], a[188:191], v[112:115]
  buffer_load_dwordx4 v248, s[16:19], s46 offen offset:0 nt lds
  v_fmac_f32 v181, v182, v182
  v_mfma_f32_16x16x32_bf16 v[20:23], v[212:215], a[176:179], v[20:23]
  ds_read_b128 a[8:11], v130 offset:36864
  v_sub_f32 v182, v158, v180
  v_mfma_f32_16x16x32_bf16 v[52:55], v[212:215], a[180:183], v[52:55]
  ds_read_b128 a[12:15], v130 offset:38912
  v_fmac_f32 v181, v182, v182
  v_sub_f32 v182, v159, v180
  v_mfma_f32_16x16x32_bf16 v[84:87], v[212:215], a[184:187], v[84:87]
  ds_read_b64_tr_b16 v[196:197], v237 offset:0
  ds_read_b64_tr_b16 v[198:199], v237 offset:1024
  v_mfma_f32_16x16x32_bf16 v[116:119], v[212:215], a[188:191], v[116:119]
  buffer_load_dwordx4 v249, s[16:19], s46 offen offset:1024 nt lds
  v_fmac_f32 v181, v182, v182
  v_mfma_f32_16x16x32_bf16 v[24:27], v[216:219], a[176:179], v[24:27]
  ds_read_b64_tr_b16 v[200:201], v236 offset:256
  v_sub_f32 v182, v160, v180
  v_mfma_f32_16x16x32_bf16 v[56:59], v[216:219], a[180:183], v[56:59]
  ds_read_b64_tr_b16 v[202:203], v236 offset:1280
  v_fmac_f32 v181, v182, v182
  v_sub_f32 v182, v161, v180
  v_mfma_f32_16x16x32_bf16 v[88:91], v[216:219], a[184:187], v[88:91]
  ds_read_b64_tr_b16 v[204:205], v237 offset:256
  v_fmac_f32 v181, v182, v182
  v_mfma_f32_16x16x32_bf16 v[120:123], v[216:219], a[188:191], v[120:123]
  ds_read_b64_tr_b16 v[206:207], v237 offset:1280
  v_sub_f32 v182, v162, v180
  v_fmac_f32 v181, v182, v182
  v_mfma_f32_16x16x32_bf16 v[28:31], v[220:223], a[176:179], v[28:31]
  v_sub_f32 v182, v163, v180
  v_fmac_f32 v181, v182, v182
  v_mfma_f32_16x16x32_bf16 v[60:63], v[220:223], a[180:183], v[60:63]
  buffer_load_dwordx4 v250, s[16:19], s46 offen offset:2048 nt lds
  v_sub_f32 v182, v164, v180
  v_mfma_f32_16x16x32_bf16 v[92:95], v[220:223], a[184:187], v[92:95]
  v_fmac_f32 v181, v182, v182
  v_sub_f32 v182, v165, v180
  v_mfma_f32_16x16x32_bf16 v[124:127], v[220:223], a[188:191], v[124:127]
  s_waitcnt lgkmcnt(0)
  v_fmac_f32 v181, v182, v182
  v_sub_f32 v182, v166, v180
  v_mfma_f32_16x16x32_bf16 v[0:3], v[192:195], a[0:3], v[0:3]
  ds_read_b64_tr_b16 v[208:209], v236 offset:512
  ds_read_b64_tr_b16 v[210:211], v236 offset:1536
  v_mfma_f32_16x16x32_bf16 v[32:35], v[192:195], a[4:7], v[32:35]
  buffer_load_dwordx4 v251, s[16:19], s46 offen offset:3072 nt lds
  v_fmac_f32 v181, v182, v182
  v_mfma_f32_16x16x32_bf16 v[64:67], v[192:195], a[8:11], v[64:67]
  ds_read_b64_tr_b16 v[212:213], v237 offset:512
  v_sub_f32 v182, v167, v180
  v_mfma_f32_16x16x32_bf16 v[96:99], v[192:195], a[12:15], v[96:99]
  ds_read_b64_tr_b16 v[214:215], v237 offset:1536
  v_fmac_f32 v181, v182, v182
  v_sub_f32 v182, v168, v180
  v_mfma_f32_16x16x32_bf16 v[4:7], v[196:199], a[0:3], v[4:7]
  ds_read_b64_tr_b16 v[216:217], v236 offset:768
  v_fmac_f32 v181, v182, v182
  v_mfma_f32_16x16x32_bf16 v[36:39], v[196:199], a[4:7], v[36:39]
  ds_read_b64_tr_b16 v[218:219], v236 offset:1792
  v_sub_f32 v182, v169, v180
  v_fmac_f32 v181, v182, v182
  v_mfma_f32_16x16x32_bf16 v[68:71], v[196:199], a[8:11], v[68:71]
  s_add_u32 m0, s48, 49152
  s_mov_b32 s46, 512
  ds_read_b64_tr_b16 v[220:221], v237 offset:768
  ds_read_b64_tr_b16 v[222:223], v237 offset:1792
  v_mfma_f32_16x16x32_bf16 v[100:103], v[196:199], a[12:15], v[100:103]
  buffer_load_dwordx4 v140, s[12:15], s46 offen offset:0 lds
  v_sub_f32 v182, v170, v180
  v_mfma_f32_16x16x32_bf16 v[8:11], v[200:203], a[0:3], v[8:11]
  v_fmac_f32 v181, v182, v182
  v_sub_f32 v182, v171, v180
  v_mfma_f32_16x16x32_bf16 v[40:43], v[200:203], a[4:7], v[40:43]
  v_fmac_f32 v181, v182, v182
  v_sub_f32 v182, v172, v183
  v_mfma_f32_16x16x32_bf16 v[72:75], v[200:203], a[8:11], v[72:75]
  v_fmac_f32 v181, v182, v182
  v_sub_f32 v182, v173, v183
  v_mfma_f32_16x16x32_bf16 v[104:107], v[200:203], a[12:15], v[104:107]
  v_fmac_f32 v181, v182, v182
  v_sub_f32 v182, v174, v183
  v_mfma_f32_16x16x32_bf16 v[12:15], v[204:207], a[0:3], v[12:15]
  v_fmac_f32 v181, v182, v182
  v_sub_f32 v182, v175, v183
  v_mfma_f32_16x16x32_bf16 v[44:47], v[204:207], a[4:7], v[44:47]
  buffer_load_dwordx4 v141, s[12:15], s46 offen offset:1024 lds
  v_fmac_f32 v181, v182, v182
  v_mfma_f32_16x16x32_bf16 v[76:79], v[204:207], a[8:11], v[76:79]
  v_sub_f32 v182, v176, v183
  v_fmac_f32 v181, v182, v182
  v_mfma_f32_16x16x32_bf16 v[108:111], v[204:207], a[12:15], v[108:111]
  s_waitcnt lgkmcnt(0)
  v_sub_f32 v182, v177, v183
  v_fmac_f32 v181, v182, v182
  v_mfma_f32_16x16x32_bf16 v[16:19], v[208:211], a[0:3], v[16:19]
  ds_read_b64_tr_b16 v[192:193], v236 offset:8192
  ds_read_b64_tr_b16 v[194:195], v236 offset:9216
  v_mfma_f32_16x16x32_bf16 v[48:51], v[208:211], a[4:7], v[48:51]
  buffer_load_dwordx4 v142, s[12:15], s46 offen offset:2048 lds
  v_sub_f32 v182, v178, v183
  v_mfma_f32_16x16x32_bf16 v[80:83], v[208:211], a[8:11], v[80:83]
  ds_read_b128 a[16:19], v131 offset:32768
  v_fmac_f32 v181, v182, v182
  v_mfma_f32_16x16x32_bf16 v[112:115], v[208:211], a[12:15], v[112:115]
  ds_read_b128 a[20:23], v131 offset:34816
  v_sub_f32 v182, v179, v183
  v_fmac_f32 v181, v182, v182
  v_mfma_f32_16x16x32_bf16 v[20:23], v[212:215], a[0:3], v[20:23]
  ds_read_b128 a[24:27], v131 offset:36864
  s_nop 1
  v_mfma_f32_16x16x32_bf16 v[52:55], v[212:215], a[4:7], v[52:55]
  ds_read_b128 a[28:31], v131 offset:38912
  v_add_f32_dpp v181, v181, v181 quad_perm:[1,0,3,2] row_mask:0xf bank_mask:0xf
  s_nop 1
  v_mfma_f32_16x16x32_bf16 v[84:87], v[212:215], a[8:11], v[84:87]
  ds_read_b64_tr_b16 v[196:197], v237 offset:8192
  ds_read_b64_tr_b16 v[198:199], v237 offset:9216
  v_mfma_f32_16x16x32_bf16 v[116:119], v[212:215], a[12:15], v[116:119]
  buffer_load_dwordx4 v143, s[12:15], s46 offen offset:3072 lds
  v_add_f32_dpp v181, v181, v181 quad_perm:[2,3,0,1] row_mask:0xf bank_mask:0xf
  v_mfma_f32_16x16x32_bf16 v[24:27], v[216:219], a[0:3], v[24:27]
  ds_read_b64_tr_b16 v[200:201], v236 offset:8448
  s_nop 1
  v_mfma_f32_16x16x32_bf16 v[56:59], v[216:219], a[4:7], v[56:59]
  ds_read_b64_tr_b16 v[202:203], v236 offset:9472
  v_add_f32_dpp v181, v181, v181 row_half_mirror row_mask:0xf bank_mask:0xf
  s_nop 1
  v_mfma_f32_16x16x32_bf16 v[88:91], v[216:219], a[8:11], v[88:91]
  s_add_u32 m0, s48, 53248
  s_mov_b32 s46, 33280
  ds_read_b64_tr_b16 v[204:205], v237 offset:8448
  ds_read_b64_tr_b16 v[206:207], v237 offset:9472
  v_mfma_f32_16x16x32_bf16 v[120:123], v[216:219], a[12:15], v[120:123]
  buffer_load_dwordx4 v140, s[12:15], s46 offen offset:0 lds
  v_add_f32_dpp v181, v181, v181 row_mirror row_mask:0xf bank_mask:0xf
  v_mfma_f32_16x16x32_bf16 v[28:31], v[220:223], a[0:3], v[28:31]
  v_mov_b32 v191, v181
  s_nop 1
  v_mfma_f32_16x16x32_bf16 v[60:63], v[220:223], a[4:7], v[60:63]
  v_permlane16_swap_b32 v181, v191
  s_nop 1
  v_mfma_f32_16x16x32_bf16 v[92:95], v[220:223], a[8:11], v[92:95]
  v_add_f32 v181, v181, v191
  v_mul_f32 v181, 0x3acccccd, v181
  v_mfma_f32_16x16x32_bf16 v[124:127], v[220:223], a[12:15], v[124:127]
  s_waitcnt lgkmcnt(0)
  v_cvt_pk_bf16_f32 v181, v181, v181
  v_lshlrev_b32 v181, 16, v181
  v_mfma_f32_16x16x32_bf16 v[0:3], v[192:195], a[16:19], v[0:3]
  ds_read_b64_tr_b16 v[208:209], v236 offset:8704
  ds_read_b64_tr_b16 v[210:211], v236 offset:9728
  v_mfma_f32_16x16x32_bf16 v[32:35], v[192:195], a[20:23], v[32:35]
  buffer_load_dwordx4 v141, s[12:15], s46 offen offset:1024 lds
  v_cvt_pk_bf16_f32 v180, v180, v180
  v_mfma_f32_16x16x32_bf16 v[64:67], v[192:195], a[24:27], v[64:67]
  ds_read_b64_tr_b16 v[212:213], v237 offset:8704
  v_lshlrev_b32 v180, 16, v180
  v_mfma_f32_16x16x32_bf16 v[96:99], v[192:195], a[28:31], v[96:99]
  ds_read_b64_tr_b16 v[214:215], v237 offset:9728
  v_add_f32 v181, 0x3727c5ac, v181
  v_cvt_pk_bf16_f32 v181, v181, v181
  v_mfma_f32_16x16x32_bf16 v[4:7], v[196:199], a[16:19], v[4:7]
  ds_read_b64_tr_b16 v[216:217], v236 offset:8960
  v_lshlrev_b32 v181, 16, v181
  v_mfma_f32_16x16x32_bf16 v[36:39], v[196:199], a[20:23], v[36:39]
  ds_read_b64_tr_b16 v[218:219], v236 offset:9984
  v_sqrt_f32 v181, v181
  s_nop 0
  v_mfma_f32_16x16x32_bf16 v[68:71], v[196:199], a[24:27], v[68:71]
  ds_read_b64_tr_b16 v[220:221], v237 offset:8960
  ds_read_b64_tr_b16 v[222:223], v237 offset:9984
  v_mfma_f32_16x16x32_bf16 v[100:103], v[196:199], a[28:31], v[100:103]
  buffer_load_dwordx4 v142, s[12:15], s46 offen offset:2048 lds
  v_cvt_pk_bf16_f32 v181, v181, v181
  v_mfma_f32_16x16x32_bf16 v[8:11], v[200:203], a[16:19], v[8:11]
  v_lshlrev_b32 v181, 16, v181
  v_rcp_f32 v181, v181
  v_mfma_f32_16x16x32_bf16 v[40:43], v[200:203], a[20:23], v[40:43]
  v_sub_f32 v156, v156, v180
  v_sub_f32 v157, v157, v180
  v_mfma_f32_16x16x32_bf16 v[72:75], v[200:203], a[24:27], v[72:75]
  v_cvt_pk_bf16_f32 v182, v156, v157
  v_lshlrev_b32 v156, 16, v182
  v_mfma_f32_16x16x32_bf16 v[104:107], v[200:203], a[28:31], v[104:107]
  buffer_load_dwordx4 v143, s[12:15], s46 offen offset:3072 lds
  v_and_b32 v157, 0xffff0000, v182
  v_mfma_f32_16x16x32_bf16 v[12:15], v[204:207], a[16:19], v[12:15]
  v_mul_f32 v156, v156, v181
  v_mul_f32 v157, v157, v181
  v_mfma_f32_16x16x32_bf16 v[44:47], v[204:207], a[20:23], v[44:47]
  v_cvt_pk_bf16_f32 v144, v156, v157
  v_sub_f32 v158, v158, v180
  v_mfma_f32_16x16x32_bf16 v[76:79], v[204:207], a[24:27], v[76:79]
  v_sub_f32 v159, v159, v180
  v_cvt_pk_bf16_f32 v182, v158, v159
  v_mfma_f32_16x16x32_bf16 v[108:111], v[204:207], a[28:31], v[108:111]
  s_waitcnt lgkmcnt(0)
  v_lshlrev_b32 v158, 16, v182
  v_and_b32 v159, 0xffff0000, v182
  v_mfma_f32_16x16x32_bf16 v[16:19], v[208:211], a[16:19], v[16:19]
  s_waitcnt vmcnt(12)
  s_barrier
  ds_read_b64_tr_b16 v[192:193], v234 offset:32768
  v_mul_f32 v158, v158, v181
  v_mfma_f32_16x16x32_bf16 v[48:51], v[208:211], a[20:23], v[48:51]
  ds_read_b64_tr_b16 v[194:195], v234 offset:33792
  v_mul_f32 v159, v159, v181
  v_cvt_pk_bf16_f32 v145, v158, v159
  v_mfma_f32_16x16x32_bf16 v[80:83], v[208:211], a[24:27], v[80:83]
  s_add_u32 m0, s49, 131072
  s_add_u32 s46, s53, 2621440
  ds_read_b128 a[32:35], v128 offset:0
  ds_read_b128 a[36:39], v128 offset:2048
  v_mfma_f32_16x16x32_bf16 v[112:115], v[208:211], a[28:31], v[112:115]
  buffer_load_dwordx4 v248, s[16:19], s46 offen offset:0 nt lds
  v_sub_f32 v160, v160, v180
  v_mfma_f32_16x16x32_bf16 v[20:23], v[212:215], a[16:19], v[20:23]
  ds_read_b128 a[40:43], v128 offset:4096
  v_sub_f32 v161, v161, v180
  v_mfma_f32_16x16x32_bf16 v[52:55], v[212:215], a[20:23], v[52:55]
  ds_read_b128 a[44:47], v128 offset:6144
  v_cvt_pk_bf16_f32 v182, v160, v161
  v_lshlrev_b32 v160, 16, v182
  v_mfma_f32_16x16x32_bf16 v[84:87], v[212:215], a[24:27], v[84:87]
  ds_read_b64_tr_b16 v[196:197], v235 offset:32768
  ds_read_b64_tr_b16 v[198:199], v235 offset:33792
  v_mfma_f32_16x16x32_bf16 v[116:119], v[212:215], a[28:31], v[116:119]
  buffer_load_dwordx4 v249, s[16:19], s46 offen offset:1024 nt lds
  v_and_b32 v161, 0xffff0000, v182
  v_mfma_f32_16x16x32_bf16 v[24:27], v[216:219], a[16:19], v[24:27]
  ds_read_b64_tr_b16 v[200:201], v234 offset:33024
  v_mul_f32 v160, v160, v181
  v_mfma_f32_16x16x32_bf16 v[56:59], v[216:219], a[20:23], v[56:59]
  ds_read_b64_tr_b16 v[202:203], v234 offset:34048
  v_mul_f32 v161, v161, v181
  v_cvt_pk_bf16_f32 v146, v160, v161
  v_mfma_f32_16x16x32_bf16 v[88:91], v[216:219], a[24:27], v[88:91]
  ds_read_b64_tr_b16 v[204:205], v235 offset:33024
  v_sub_f32 v162, v162, v180
  v_mfma_f32_16x16x32_bf16 v[120:123], v[216:219], a[28:31], v[120:123]
  ds_read_b64_tr_b16 v[206:207], v235 offset:34048
  v_sub_f32 v163, v163, v180
  v_cvt_pk_bf16_f32 v182, v162, v163
  v_mfma_f32_16x16x32_bf16 v[28:31], v[220:223], a[16:19], v[28:31]
  v_lshlrev_b32 v162, 16, v182
  v_and_b32 v163, 0xffff0000, v182
  v_mfma_f32_16x16x32_bf16 v[60:63], v[220:223], a[20:23], v[60:63]
  buffer_load_dwordx4 v250, s[16:19], s46 offen offset:2048 nt lds
  v_mul_f32 v162, v162, v181
  v_mfma_f32_16x16x32_bf16 v[92:95], v[220:223], a[24:27], v[92:95]
  v_mul_f32 v163, v163, v181
  v_cvt_pk_bf16_f32 v147, v162, v163
  v_mfma_f32_16x16x32_bf16 v[124:127], v[220:223], a[28:31], v[124:127]
  s_waitcnt lgkmcnt(0)
  v_sub_f32 v164, v164, v180
  v_sub_f32 v165, v165, v180
  v_mfma_f32_16x16x32_bf16 v[0:3], v[192:195], a[32:35], v[0:3]
  ds_read_b64_tr_b16 v[208:209], v234 offset:33280
  ds_read_b64_tr_b16 v[210:211], v234 offset:34304
  v_mfma_f32_16x16x32_bf16 v[32:35], v[192:195], a[36:39], v[32:35]
  buffer_load_dwordx4 v251, s[16:19], s46 offen offset:3072 nt lds
  v_cvt_pk_bf16_f32 v182, v164, v165
  v_mfma_f32_16x16x32_bf16 v[64:67], v[192:195], a[40:43], v[64:67]
  ds_read_b64_tr_b16 v[212:213], v235 offset:33280
  v_lshlrev_b32 v164, 16, v182
  v_mfma_f32_16x16x32_bf16 v[96:99], v[192:195], a[44:47], v[96:99]
  ds_read_b64_tr_b16 v[214:215], v235 offset:34304
  v_and_b32 v165, 0xffff0000, v182
  v_mul_f32 v164, v164, v181
  v_mfma_f32_16x16x32_bf16 v[4:7], v[196:199], a[32:35], v[4:7]
  ds_read_b64_tr_b16 v[216:217], v234 offset:33536
  v_mul_f32 v165, v165, v181
  v_mfma_f32_16x16x32_bf16 v[36:39], v[196:199], a[36:39], v[36:39]
  ds_read_b64_tr_b16 v[218:219], v234 offset:34560
  v_cvt_pk_bf16_f32 v148, v164, v165
  v_sub_f32 v166, v166, v180
  v_mfma_f32_16x16x32_bf16 v[68:71], v[196:199], a[40:43], v[68:71]
  s_add_u32 m0, s48, 98304
  s_mov_b32 s46, 640
  ds_read_b64_tr_b16 v[220:221], v235 offset:33536
  ds_read_b64_tr_b16 v[222:223], v235 offset:34560
  v_mfma_f32_16x16x32_bf16 v[100:103], v[196:199], a[44:47], v[100:103]
  buffer_load_dwordx4 v140, s[12:15], s46 offen offset:0 lds
  v_sub_f32 v167, v167, v180
  v_mfma_f32_16x16x32_bf16 v[8:11], v[200:203], a[32:35], v[8:11]
  v_cvt_pk_bf16_f32 v182, v166, v167
  v_lshlrev_b32 v166, 16, v182
  v_mfma_f32_16x16x32_bf16 v[40:43], v[200:203], a[36:39], v[40:43]
  v_and_b32 v167, 0xffff0000, v182
  v_mul_f32 v166, v166, v181
  v_mfma_f32_16x16x32_bf16 v[72:75], v[200:203], a[40:43], v[72:75]
  v_mul_f32 v167, v167, v181
  v_cvt_pk_bf16_f32 v149, v166, v167
  v_mfma_f32_16x16x32_bf16 v[104:107], v[200:203], a[44:47], v[104:107]
  v_sub_f32 v168, v168, v180
  v_sub_f32 v169, v169, v180
  v_mfma_f32_16x16x32_bf16 v[12:15], v[204:207], a[32:35], v[12:15]
  s_lshl_b32 s51, s7, 2
  s_add_u32 s51, s51, s3
  s_mul_i32 s51, s51, 131072
  s_add_u32 s51, s51, 0
  v_min_u32 v240, 31, v224
  v_and_b32 v241, 1, v240
  v_lshrrev_b32 v240, 1, v240
  v_lshlrev_b32 v240, 13, v240
  v_lshl_add_u32 v240, v241, 7, v240
  buffer_load_dword v227, v240, s[20:23], s51 offen
  v_cvt_pk_bf16_f32 v182, v168, v169
  v_lshlrev_b32 v168, 16, v182
  v_mfma_f32_16x16x32_bf16 v[44:47], v[204:207], a[36:39], v[44:47]
  buffer_load_dwordx4 v141, s[12:15], s46 offen offset:1024 lds
  v_and_b32 v169, 0xffff0000, v182
  v_mfma_f32_16x16x32_bf16 v[76:79], v[204:207], a[40:43], v[76:79]
  v_mul_f32 v168, v168, v181
  v_mul_f32 v169, v169, v181
  v_mfma_f32_16x16x32_bf16 v[108:111], v[204:207], a[44:47], v[108:111]
  s_waitcnt lgkmcnt(0)
  v_cvt_pk_bf16_f32 v150, v168, v169
  v_sub_f32 v170, v170, v180
  v_mfma_f32_16x16x32_bf16 v[16:19], v[208:211], a[32:35], v[16:19]
  ds_read_b64_tr_b16 v[192:193], v234 offset:40960
  ds_read_b64_tr_b16 v[194:195], v234 offset:41984
  v_mfma_f32_16x16x32_bf16 v[48:51], v[208:211], a[36:39], v[48:51]
  buffer_load_dwordx4 v142, s[12:15], s46 offen offset:2048 lds
  v_sub_f32 v171, v171, v180
  v_mfma_f32_16x16x32_bf16 v[80:83], v[208:211], a[40:43], v[80:83]
  ds_read_b128 a[48:51], v129 offset:0
  v_cvt_pk_bf16_f32 v182, v170, v171
  v_mfma_f32_16x16x32_bf16 v[112:115], v[208:211], a[44:47], v[112:115]
  ds_read_b128 a[52:55], v129 offset:2048
  v_lshlrev_b32 v170, 16, v182
  v_and_b32 v171, 0xffff0000, v182
  v_mfma_f32_16x16x32_bf16 v[20:23], v[212:215], a[32:35], v[20:23]
  ds_read_b128 a[56:59], v129 offset:4096
  v_mul_f32 v170, v170, v181
  v_mfma_f32_16x16x32_bf16 v[52:55], v[212:215], a[36:39], v[52:55]
  ds_read_b128 a[60:63], v129 offset:6144
  v_mul_f32 v171, v171, v181
  v_cvt_pk_bf16_f32 v151, v170, v171
  v_mfma_f32_16x16x32_bf16 v[84:87], v[212:215], a[40:43], v[84:87]
  ds_read_b64_tr_b16 v[196:197], v235 offset:40960
  ds_read_b64_tr_b16 v[198:199], v235 offset:41984
  v_mfma_f32_16x16x32_bf16 v[116:119], v[212:215], a[44:47], v[116:119]
  buffer_load_dwordx4 v143, s[12:15], s46 offen offset:3072 lds
  v_sub_f32 v172, v172, v180
  v_mfma_f32_16x16x32_bf16 v[24:27], v[216:219], a[32:35], v[24:27]
  ds_read_b64_tr_b16 v[200:201], v234 offset:41216
  v_sub_f32 v173, v173, v180
  v_mfma_f32_16x16x32_bf16 v[56:59], v[216:219], a[36:39], v[56:59]
  ds_read_b64_tr_b16 v[202:203], v234 offset:42240
  v_cvt_pk_bf16_f32 v182, v172, v173
  v_lshlrev_b32 v172, 16, v182
  v_mfma_f32_16x16x32_bf16 v[88:91], v[216:219], a[40:43], v[88:91]
  s_add_u32 m0, s48, 102400
  s_mov_b32 s46, 33408
  ds_read_b64_tr_b16 v[204:205], v235 offset:41216
  ds_read_b64_tr_b16 v[206:207], v235 offset:42240
  v_mfma_f32_16x16x32_bf16 v[120:123], v[216:219], a[44:47], v[120:123]
  buffer_load_dwordx4 v140, s[12:15], s46 offen offset:0 lds
  v_and_b32 v173, 0xffff0000, v182
  v_mfma_f32_16x16x32_bf16 v[28:31], v[220:223], a[32:35], v[28:31]
  v_mul_f32 v172, v172, v181
  v_mul_f32 v173, v173, v181
  v_mfma_f32_16x16x32_bf16 v[60:63], v[220:223], a[36:39], v[60:63]
  v_cvt_pk_bf16_f32 v152, v172, v173
  v_sub_f32 v174, v174, v180
  v_mfma_f32_16x16x32_bf16 v[92:95], v[220:223], a[40:43], v[92:95]
  v_sub_f32 v175, v175, v180
  v_cvt_pk_bf16_f32 v182, v174, v175
  v_mfma_f32_16x16x32_bf16 v[124:127], v[220:223], a[44:47], v[124:127]
  s_waitcnt lgkmcnt(0)
  v_lshlrev_b32 v174, 16, v182
  v_and_b32 v175, 0xffff0000, v182
  v_mfma_f32_16x16x32_bf16 v[0:3], v[192:195], a[48:51], v[0:3]
  ds_read_b64_tr_b16 v[208:209], v234 offset:41472
  ds_read_b64_tr_b16 v[210:211], v234 offset:42496
  v_mfma_f32_16x16x32_bf16 v[32:35], v[192:195], a[52:55], v[32:35]
  buffer_load_dwordx4 v141, s[12:15], s46 offen offset:1024 lds
  v_mul_f32 v174, v174, v181
  v_mfma_f32_16x16x32_bf16 v[64:67], v[192:195], a[56:59], v[64:67]
  ds_read_b64_tr_b16 v[212:213], v235 offset:41472
  v_mul_f32 v175, v175, v181
  v_mfma_f32_16x16x32_bf16 v[96:99], v[192:195], a[60:63], v[96:99]
  ds_read_b64_tr_b16 v[214:215], v235 offset:42496
  v_cvt_pk_bf16_f32 v153, v174, v175
  v_sub_f32 v176, v176, v180
  v_mfma_f32_16x16x32_bf16 v[4:7], v[196:199], a[48:51], v[4:7]
  ds_read_b64_tr_b16 v[216:217], v234 offset:41728
  v_sub_f32 v177, v177, v180
  v_mfma_f32_16x16x32_bf16 v[36:39], v[196:199], a[52:55], v[36:39]
  ds_read_b64_tr_b16 v[218:219], v234 offset:42752
  v_cvt_pk_bf16_f32 v182, v176, v177
  v_lshlrev_b32 v176, 16, v182
  v_mfma_f32_16x16x32_bf16 v[68:71], v[196:199], a[56:59], v[68:71]
  ds_read_b64_tr_b16 v[220:221], v235 offset:41728
  ds_read_b64_tr_b16 v[222:223], v235 offset:42752
  v_mfma_f32_16x16x32_bf16 v[100:103], v[196:199], a[60:63], v[100:103]
  buffer_load_dwordx4 v142, s[12:15], s46 offen offset:2048 lds
  v_and_b32 v177, 0xffff0000, v182
  v_mfma_f32_16x16x32_bf16 v[8:11], v[200:203], a[48:51], v[8:11]
  v_mul_f32 v176, v176, v181
  v_mul_f32 v177, v177, v181
  v_mfma_f32_16x16x32_bf16 v[40:43], v[200:203], a[52:55], v[40:43]
  v_cvt_pk_bf16_f32 v154, v176, v177
  v_sub_f32 v178, v178, v180
  v_mfma_f32_16x16x32_bf16 v[72:75], v[200:203], a[56:59], v[72:75]
  v_sub_f32 v179, v179, v180
  v_cvt_pk_bf16_f32 v182, v178, v179
  v_mfma_f32_16x16x32_bf16 v[104:107], v[200:203], a[60:63], v[104:107]
  buffer_load_dwordx4 v143, s[12:15], s46 offen offset:3072 lds
  v_lshlrev_b32 v178, 16, v182
  v_mfma_f32_16x16x32_bf16 v[12:15], v[204:207], a[48:51], v[12:15]
  v_and_b32 v179, 0xffff0000, v182
  v_mul_f32 v178, v178, v181
  v_mfma_f32_16x16x32_bf16 v[44:47], v[204:207], a[52:55], v[44:47]
  v_mul_f32 v179, v179, v181
  v_cvt_pk_bf16_f32 v155, v178, v179
  v_mfma_f32_16x16x32_bf16 v[76:79], v[204:207], a[56:59], v[76:79]
  s_lshl_b32 s44, s3, 1
  v_lshrrev_b32 v182, 5, v224
  v_mfma_f32_16x16x32_bf16 v[108:111], v[204:207], a[60:63], v[108:111]
  s_waitcnt lgkmcnt(0)
  v_add_u32 v182, s44, v182
  v_and_b32 v183, 7, v224
  v_mfma_f32_16x16x32_bf16 v[16:19], v[208:211], a[48:51], v[16:19]
  s_waitcnt vmcnt(13)
  s_barrier
  ds_read_b64_tr_b16 v[192:193], v238 offset:16384
  v_xor_b32 v182, v182, v183
  v_mfma_f32_16x16x32_bf16 v[48:51], v[208:211], a[52:55], v[48:51]
  ds_read_b64_tr_b16 v[194:195], v238 offset:17408
  v_lshlrev_b32 v183, 7, v137
  v_lshl_add_u32 v183, v182, 4, v183
  v_mfma_f32_16x16x32_bf16 v[80:83], v[208:211], a[56:59], v[80:83]
  s_add_u32 m0, s49, 32768
  s_add_u32 s46, s53, 3145728
  ds_read_b128 a[64:67], v128 offset:49152
  ds_read_b128 a[68:71], v128 offset:51200
  v_mfma_f32_16x16x32_bf16 v[112:115], v[208:211], a[60:63], v[112:115]
  buffer_load_dwordx4 v248, s[16:19], s46 offen offset:0 nt lds
  v_add_u32 v183, 147456, v183
  v_mfma_f32_16x16x32_bf16 v[20:23], v[212:215], a[48:51], v[20:23]
  ds_write_b128 v183, v[144:147] offset:0
  ds_read_b128 a[72:75], v128 offset:53248
  v_mfma_f32_16x16x32_bf16 v[52:55], v[212:215], a[52:55], v[52:55]
  ds_read_b128 a[76:79], v128 offset:55296
  v_mfma_f32_16x16x32_bf16 v[84:87], v[212:215], a[56:59], v[84:87]
  ds_write_b128 v183, v[148:151] offset:4096
  ds_read_b64_tr_b16 v[196:197], v239 offset:16384
  ds_read_b64_tr_b16 v[198:199], v239 offset:17408
  v_mfma_f32_16x16x32_bf16 v[116:119], v[212:215], a[60:63], v[116:119]
  buffer_load_dwordx4 v249, s[16:19], s46 offen offset:1024 nt lds
  v_mfma_f32_16x16x32_bf16 v[24:27], v[216:219], a[48:51], v[24:27]
  ds_write_b128 v183, v[152:155] offset:8192
  ds_read_b64_tr_b16 v[200:201], v238 offset:16640
  v_mfma_f32_16x16x32_bf16 v[56:59], v[216:219], a[52:55], v[56:59]
  ds_read_b64_tr_b16 v[202:203], v238 offset:17664
  v_mfma_f32_16x16x32_bf16 v[88:91], v[216:219], a[56:59], v[88:91]
  ds_read_b64_tr_b16 v[204:205], v239 offset:16640
  v_and_b32 v186, 1, v224
  v_mfma_f32_16x16x32_bf16 v[120:123], v[216:219], a[60:63], v[120:123]
  ds_read_b64_tr_b16 v[206:207], v239 offset:17664
  v_lshlrev_b32 v186, 7, v186
  v_mfma_f32_16x16x32_bf16 v[28:31], v[220:223], a[48:51], v[28:31]
  v_mfma_f32_16x16x32_bf16 v[60:63], v[220:223], a[52:55], v[60:63]
  buffer_load_dwordx4 v250, s[16:19], s46 offen offset:2048 nt lds
  v_mfma_f32_16x16x32_bf16 v[92:95], v[220:223], a[56:59], v[92:95]
  v_mfma_f32_16x16x32_bf16 v[124:127], v[220:223], a[60:63], v[124:127]
  s_waitcnt lgkmcnt(0)
  buffer_load_dword v187, v186, s[36:39], 0 offen sc1
  v_mfma_f32_16x16x32_bf16 v[0:3], v[192:195], a[64:67], v[0:3]
  ds_read_b64_tr_b16 v[208:209], v238 offset:16896
  ds_read_b64_tr_b16 v[210:211], v238 offset:17920
  v_mfma_f32_16x16x32_bf16 v[32:35], v[192:195], a[68:71], v[32:35]
  buffer_load_dwordx4 v251, s[16:19], s46 offen offset:3072 nt lds
  s_mov_b32 s34, 61440
  v_mfma_f32_16x16x32_bf16 v[64:67], v[192:195], a[72:75], v[64:67]
  ds_read_b64_tr_b16 v[212:213], v239 offset:16896
  s_mul_i32 s44, s3, 2560
  v_mfma_f32_16x16x32_bf16 v[96:99], v[192:195], a[76:79], v[96:99]
  ds_read_b64_tr_b16 v[214:215], v239 offset:17920
  s_add_u32 s44, s44, 147456
  s_lshl_b32 s45, s3, 2
  v_mfma_f32_16x16x32_bf16 v[4:7], v[196:199], a[64:67], v[4:7]
  ds_read_b64_tr_b16 v[216:217], v238 offset:17152
  v_lshrrev_b32 v183, 3, v224
  v_mfma_f32_16x16x32_bf16 v[36:39], v[196:199], a[68:71], v[36:39]
  ds_read_b64_tr_b16 v[218:219], v238 offset:18176
  v_add_u32 v183, s45, v183
  v_and_b32 v183, 7, v183
  v_mfma_f32_16x16x32_bf16 v[68:71], v[196:199], a[72:75], v[68:71]
  s_add_u32 m0, s48, 0
  s_mov_b32 s46, 768
  ds_read_b64_tr_b16 v[220:221], v239 offset:17152
  ds_read_b64_tr_b16 v[222:223], v239 offset:18176
  v_mfma_f32_16x16x32_bf16 v[100:103], v[196:199], a[76:79], v[100:103]
  buffer_load_dwordx4 v140, s[12:15], s46 offen offset:0 lds
  v_xor_b32 v183, v183, v224
  v_mfma_f32_16x16x32_bf16 v[8:11], v[200:203], a[64:67], v[8:11]
  v_lshl_add_u32 v183, v183, 4, s44
  v_mfma_f32_16x16x32_bf16 v[40:43], v[200:203], a[68:71], v[40:43]
  v_mfma_f32_16x16x32_bf16 v[72:75], v[200:203], a[72:75], v[72:75]
  v_mfma_f32_16x16x32_bf16 v[104:107], v[200:203], a[76:79], v[104:107]
  v_mfma_f32_16x16x32_bf16 v[12:15], v[204:207], a[64:67], v[12:15]
  v_mfma_f32_16x16x32_bf16 v[44:47], v[204:207], a[68:71], v[44:47]
  buffer_load_dwordx4 v141, s[12:15], s46 offen offset:1024 lds
  v_mfma_f32_16x16x32_bf16 v[76:79], v[204:207], a[72:75], v[76:79]
  v_mfma_f32_16x16x32_bf16 v[108:111], v[204:207], a[76:79], v[108:111]
  s_waitcnt lgkmcnt(0)
  v_mfma_f32_16x16x32_bf16 v[16:19], v[208:211], a[64:67], v[16:19]
  ds_read_b64_tr_b16 v[192:193], v238 offset:24576
  ds_read_b64_tr_b16 v[194:195], v238 offset:25600
  v_mfma_f32_16x16x32_bf16 v[48:51], v[208:211], a[68:71], v[48:51]
  buffer_load_dwordx4 v142, s[12:15], s46 offen offset:2048 lds
  s_barrier
  v_mfma_f32_16x16x32_bf16 v[80:83], v[208:211], a[72:75], v[80:83]
  ds_read_b128 v[144:147], v183 offset:0
  ds_read_b128 a[80:83], v129 offset:49152
  v_mfma_f32_16x16x32_bf16 v[112:115], v[208:211], a[76:79], v[112:115]
  ds_read_b128 a[84:87], v129 offset:51200
  v_mfma_f32_16x16x32_bf16 v[20:23], v[212:215], a[64:67], v[20:23]
  ds_read_b128 v[148:151], v183 offset:1024
  ds_read_b128 a[88:91], v129 offset:53248
  v_mfma_f32_16x16x32_bf16 v[52:55], v[212:215], a[68:71], v[52:55]
  ds_read_b128 a[92:95], v129 offset:55296
  v_mfma_f32_16x16x32_bf16 v[84:87], v[212:215], a[72:75], v[84:87]
  ds_read_b128 v[152:155], v183 offset:2048
  ds_read_b64_tr_b16 v[196:197], v239 offset:24576
  ds_read_b64_tr_b16 v[198:199], v239 offset:25600
  v_mfma_f32_16x16x32_bf16 v[116:119], v[212:215], a[76:79], v[116:119]
  buffer_load_dwordx4 v143, s[12:15], s46 offen offset:3072 lds
  v_mfma_f32_16x16x32_bf16 v[24:27], v[216:219], a[64:67], v[24:27]
  ds_read_b64_tr_b16 v[200:201], v238 offset:24832
  v_mfma_f32_16x16x32_bf16 v[56:59], v[216:219], a[68:71], v[56:59]
  ds_read_b64_tr_b16 v[202:203], v238 offset:25856
  v_mfma_f32_16x16x32_bf16 v[88:91], v[216:219], a[72:75], v[88:91]
  s_add_u32 m0, s48, 4096
  s_mov_b32 s46, 33536
  ds_read_b64_tr_b16 v[204:205], v239 offset:24832
  ds_read_b64_tr_b16 v[206:207], v239 offset:25856
  v_mfma_f32_16x16x32_bf16 v[120:123], v[216:219], a[76:79], v[120:123]
  buffer_load_dwordx4 v140, s[12:15], s46 offen offset:0 lds
  v_mfma_f32_16x16x32_bf16 v[28:31], v[220:223], a[64:67], v[28:31]
  v_mfma_f32_16x16x32_bf16 v[60:63], v[220:223], a[68:71], v[60:63]
  v_mfma_f32_16x16x32_bf16 v[92:95], v[220:223], a[72:75], v[92:95]
  v_mfma_f32_16x16x32_bf16 v[124:127], v[220:223], a[76:79], v[124:127]
  s_waitcnt lgkmcnt(0)
  v_mfma_f32_16x16x32_bf16 v[0:3], v[192:195], a[80:83], v[0:3]
  ds_read_b64_tr_b16 v[208:209], v238 offset:25088
  ds_read_b64_tr_b16 v[210:211], v238 offset:26112
  v_mfma_f32_16x16x32_bf16 v[32:35], v[192:195], a[84:87], v[32:35]
  buffer_load_dwordx4 v141, s[12:15], s46 offen offset:1024 lds
  s_waitcnt vmcnt(7)
  v_cmp_gt_u32 vcc, 40, v187
  s_cbranch_vccnz L_adaL_spin_6
L_adaL_spun_7:
  v_mfma_f32_16x16x32_bf16 v[64:67], v[192:195], a[88:91], v[64:67]
  ds_read_b64_tr_b16 v[212:213], v239 offset:25088
  s_lshl_b32 s59, s3, 10
  v_mfma_f32_16x16x32_bf16 v[96:99], v[192:195], a[92:95], v[96:99]
  ds_read_b64_tr_b16 v[214:215], v239 offset:26112
  v_mfma_f32_16x16x32_bf16 v[4:7], v[196:199], a[80:83], v[4:7]
  ds_read_b64_tr_b16 v[216:217], v238 offset:25344
  ds_read_b64_tr_b16 v[218:219], v238 offset:26368
  v_mfma_f32_16x16x32_bf16 v[36:39], v[196:199], a[84:87], v[36:39]
  buffer_load_dwordx4 v[156:159], v225, s[32:35], s59 offen sc1
  s_add_u32 s59, s59, 4096
  v_mfma_f32_16x16x32_bf16 v[68:71], v[196:199], a[88:91], v[68:71]
  ds_read_b64_tr_b16 v[220:221], v239 offset:25344
  ds_read_b64_tr_b16 v[222:223], v239 offset:26368
  v_mfma_f32_16x16x32_bf16 v[100:103], v[196:199], a[92:95], v[100:103]
  buffer_load_dwordx4 v142, s[12:15], s46 offen offset:2048 lds
  v_mfma_f32_16x16x32_bf16 v[8:11], v[200:203], a[80:83], v[8:11]
  v_mfma_f32_16x16x32_bf16 v[40:43], v[200:203], a[84:87], v[40:43]
  buffer_load_dwordx4 v[160:163], v225, s[32:35], s59 offen sc1
  s_add_u32 s59, s59, 4096
  v_mfma_f32_16x16x32_bf16 v[72:75], v[200:203], a[88:91], v[72:75]
  v_mfma_f32_16x16x32_bf16 v[104:107], v[200:203], a[92:95], v[104:107]
  buffer_load_dwordx4 v143, s[12:15], s46 offen offset:3072 lds
  v_mfma_f32_16x16x32_bf16 v[12:15], v[204:207], a[80:83], v[12:15]
  v_mfma_f32_16x16x32_bf16 v[44:47], v[204:207], a[84:87], v[44:47]
  buffer_load_dwordx4 v[164:167], v225, s[32:35], s59 offen sc1
  s_add_u32 s59, s59, 4096
  v_mfma_f32_16x16x32_bf16 v[76:79], v[204:207], a[88:91], v[76:79]
  v_mfma_f32_16x16x32_bf16 v[108:111], v[204:207], a[92:95], v[108:111]
  s_waitcnt lgkmcnt(0)
  buffer_load_dwordx4 v[168:171], v225, s[32:35], s59 offen sc1
  s_add_u32 s59, s59, 4096
  v_mfma_f32_16x16x32_bf16 v[16:19], v[208:211], a[80:83], v[16:19]
  s_waitcnt vmcnt(17)
  s_barrier
  ds_read_b64_tr_b16 v[192:193], v236 offset:0
  ds_read_b64_tr_b16 v[194:195], v236 offset:1024
  v_mfma_f32_16x16x32_bf16 v[48:51], v[208:211], a[84:87], v[48:51]
  buffer_load_dwordx4 v[172:175], v225, s[32:35], s59 offen sc1
  s_add_u32 s59, s59, 4096
  v_mfma_f32_16x16x32_bf16 v[80:83], v[208:211], a[88:91], v[80:83]
  s_add_u32 m0, s49, 81920
  s_add_u32 s46, s53, 3670016
  ds_read_b128 a[96:99], v130 offset:32768
  ds_read_b128 a[100:103], v130 offset:34816
  v_mfma_f32_16x16x32_bf16 v[112:115], v[208:211], a[92:95], v[112:115]
  buffer_load_dwordx4 v248, s[16:19], s46 offen offset:0 nt lds
  v_mfma_f32_16x16x32_bf16 v[20:23], v[212:215], a[80:83], v[20:23]
  ds_read_b128 a[104:107], v130 offset:36864
  s_lshl_b32 s44, s3, 7
  v_mfma_f32_16x16x32_bf16 v[52:55], v[212:215], a[84:87], v[52:55]
  ds_read_b128 a[108:111], v130 offset:38912
  s_add_u32 s44, s44, 157696
  v_lshlrev_b32 v183, 1, v224
  v_mfma_f32_16x16x32_bf16 v[84:87], v[212:215], a[88:91], v[84:87]
  ds_read_b64_tr_b16 v[196:197], v237 offset:0
  ds_read_b64_tr_b16 v[198:199], v237 offset:1024
  v_mfma_f32_16x16x32_bf16 v[116:119], v[212:215], a[92:95], v[116:119]
  buffer_load_dwordx4 v249, s[16:19], s46 offen offset:1024 nt lds
  v_add_u32 v183, s44, v183
  v_mfma_f32_16x16x32_bf16 v[24:27], v[216:219], a[80:83], v[24:27]
  ds_read_b64_tr_b16 v[200:201], v236 offset:256
  s_cmp_ge_u32 s3, 2
  s_cselect_b32 s59, 1.0, 0
  v_mfma_f32_16x16x32_bf16 v[56:59], v[216:219], a[84:87], v[56:59]
  ds_read_b64_tr_b16 v[202:203], v236 offset:1280
  v_mfma_f32_16x16x32_bf16 v[88:91], v[216:219], a[88:91], v[88:91]
  ds_read_b64_tr_b16 v[204:205], v237 offset:256
  v_mfma_f32_16x16x32_bf16 v[120:123], v[216:219], a[92:95], v[120:123]
  ds_read_b64_tr_b16 v[206:207], v237 offset:1280
  v_mfma_f32_16x16x32_bf16 v[28:31], v[220:223], a[80:83], v[28:31]
  v_mfma_f32_16x16x32_bf16 v[60:63], v[220:223], a[84:87], v[60:63]
  buffer_load_dwordx4 v250, s[16:19], s46 offen offset:2048 nt lds
  v_mfma_f32_16x16x32_bf16 v[92:95], v[220:223], a[88:91], v[92:95]
  v_mfma_f32_16x16x32_bf16 v[124:127], v[220:223], a[92:95], v[124:127]
  s_waitcnt lgkmcnt(0)
  v_mfma_f32_16x16x32_bf16 v[0:3], v[192:195], a[96:99], v[0:3]
  ds_read_b64_tr_b16 v[208:209], v236 offset:512
  ds_read_b64_tr_b16 v[210:211], v236 offset:1536
  v_mfma_f32_16x16x32_bf16 v[32:35], v[192:195], a[100:103], v[32:35]
  buffer_load_dwordx4 v251, s[16:19], s46 offen offset:3072 nt lds
  v_mfma_f32_16x16x32_bf16 v[64:67], v[192:195], a[104:107], v[64:67]
  ds_read_b64_tr_b16 v[212:213], v237 offset:512
  v_mfma_f32_16x16x32_bf16 v[96:99], v[192:195], a[108:111], v[96:99]
  ds_read_b64_tr_b16 v[214:215], v237 offset:1536
  v_mfma_f32_16x16x32_bf16 v[4:7], v[196:199], a[96:99], v[4:7]
  ds_read_b64_tr_b16 v[216:217], v236 offset:768
  v_mfma_f32_16x16x32_bf16 v[36:39], v[196:199], a[100:103], v[36:39]
  ds_read_b64_tr_b16 v[218:219], v236 offset:1792
  v_mfma_f32_16x16x32_bf16 v[68:71], v[196:199], a[104:107], v[68:71]
  s_add_u32 m0, s48, 49152
  s_mov_b32 s46, 896
  ds_read_b64_tr_b16 v[220:221], v237 offset:768
  ds_read_b64_tr_b16 v[222:223], v237 offset:1792
  v_mfma_f32_16x16x32_bf16 v[100:103], v[196:199], a[108:111], v[100:103]
  buffer_load_dwordx4 v140, s[12:15], s46 offen offset:0 lds
  v_mfma_f32_16x16x32_bf16 v[8:11], v[200:203], a[96:99], v[8:11]
  v_mfma_f32_16x16x32_bf16 v[40:43], v[200:203], a[100:103], v[40:43]
  v_mfma_f32_16x16x32_bf16 v[72:75], v[200:203], a[104:107], v[72:75]
  v_mfma_f32_16x16x32_bf16 v[104:107], v[200:203], a[108:111], v[104:107]
  v_mfma_f32_16x16x32_bf16 v[12:15], v[204:207], a[96:99], v[12:15]
  v_mfma_f32_16x16x32_bf16 v[44:47], v[204:207], a[100:103], v[44:47]
  buffer_load_dwordx4 v141, s[12:15], s46 offen offset:1024 lds
  v_mfma_f32_16x16x32_bf16 v[76:79], v[204:207], a[104:107], v[76:79]
  v_mfma_f32_16x16x32_bf16 v[108:111], v[204:207], a[108:111], v[108:111]
  s_waitcnt lgkmcnt(0)
  v_mfma_f32_16x16x32_bf16 v[16:19], v[208:211], a[96:99], v[16:19]
  ds_read_b64_tr_b16 v[192:193], v236 offset:8192
  ds_read_b64_tr_b16 v[194:195], v236 offset:9216
  v_mfma_f32_16x16x32_bf16 v[48:51], v[208:211], a[100:103], v[48:51]
  buffer_load_dwordx4 v142, s[12:15], s46 offen offset:2048 lds
  v_mfma_f32_16x16x32_bf16 v[80:83], v[208:211], a[104:107], v[80:83]
  ds_read_b128 a[112:115], v131 offset:32768
  v_mfma_f32_16x16x32_bf16 v[112:115], v[208:211], a[108:111], v[112:115]
  ds_read_b128 a[116:119], v131 offset:34816
  v_mfma_f32_16x16x32_bf16 v[20:23], v[212:215], a[96:99], v[20:23]
  ds_read_b128 a[120:123], v131 offset:36864
  v_mfma_f32_16x16x32_bf16 v[52:55], v[212:215], a[100:103], v[52:55]
  ds_read_b128 a[124:127], v131 offset:38912
  v_mfma_f32_16x16x32_bf16 v[84:87], v[212:215], a[104:107], v[84:87]
  ds_read_b64_tr_b16 v[196:197], v237 offset:8192
  ds_read_b64_tr_b16 v[198:199], v237 offset:9216
  v_mfma_f32_16x16x32_bf16 v[116:119], v[212:215], a[108:111], v[116:119]
  buffer_load_dwordx4 v143, s[12:15], s46 offen offset:3072 lds
  v_mfma_f32_16x16x32_bf16 v[24:27], v[216:219], a[96:99], v[24:27]
  ds_read_b64_tr_b16 v[200:201], v236 offset:8448
  v_mfma_f32_16x16x32_bf16 v[56:59], v[216:219], a[100:103], v[56:59]
  ds_read_b64_tr_b16 v[202:203], v236 offset:9472
  v_mfma_f32_16x16x32_bf16 v[88:91], v[216:219], a[104:107], v[88:91]
  s_add_u32 m0, s48, 53248
  s_mov_b32 s46, 33664
  ds_read_b64_tr_b16 v[204:205], v237 offset:8448
  ds_read_b64_tr_b16 v[206:207], v237 offset:9472
  v_mfma_f32_16x16x32_bf16 v[120:123], v[216:219], a[108:111], v[120:123]
  buffer_load_dwordx4 v140, s[12:15], s46 offen offset:0 lds
  v_mfma_f32_16x16x32_bf16 v[28:31], v[220:223], a[96:99], v[28:31]
  v_mfma_f32_16x16x32_bf16 v[60:63], v[220:223], a[100:103], v[60:63]
  v_mfma_f32_16x16x32_bf16 v[92:95], v[220:223], a[104:107], v[92:95]
  v_mfma_f32_16x16x32_bf16 v[124:127], v[220:223], a[108:111], v[124:127]
  s_waitcnt lgkmcnt(0)
  v_mfma_f32_16x16x32_bf16 v[0:3], v[192:195], a[112:115], v[0:3]
  ds_read_b64_tr_b16 v[208:209], v236 offset:8704
  ds_read_b64_tr_b16 v[210:211], v236 offset:9728
  s_waitcnt vmcnt(8)
  v_mfma_f32_16x16x32_bf16 v[32:35], v[192:195], a[116:119], v[32:35]
  buffer_load_dwordx4 v141, s[12:15], s46 offen offset:1024 lds
  v_add_f32 v156, v156, v157
  v_add_f32 v158, v158, v159
  v_mfma_f32_16x16x32_bf16 v[64:67], v[192:195], a[120:123], v[64:67]
  ds_read_b64_tr_b16 v[212:213], v237 offset:8704
  v_add_f32 v156, v156, v158
  v_cvt_pk_bf16_f32 v156, v156, v156
  v_mfma_f32_16x16x32_bf16 v[96:99], v[192:195], a[124:127], v[96:99]
  ds_read_b64_tr_b16 v[214:215], v237 offset:9728
  v_mfma_f32_16x16x32_bf16 v[4:7], v[196:199], a[112:115], v[4:7]
  ds_write_b16 v183, v156 offset:0
  ds_read_b64_tr_b16 v[216:217], v236 offset:8960
  v_add_f32 v160, v160, v161
  v_mfma_f32_16x16x32_bf16 v[36:39], v[196:199], a[116:119], v[36:39]
  ds_read_b64_tr_b16 v[218:219], v236 offset:9984
  v_add_f32 v162, v162, v163
  v_add_f32 v160, v160, v162
  v_cvt_pk_bf16_f32 v160, v160, v160
  v_mfma_f32_16x16x32_bf16 v[68:71], v[196:199], a[120:123], v[68:71]
  ds_write_b16 v183, v160 offset:512
  ds_read_b64_tr_b16 v[220:221], v237 offset:8960
  ds_read_b64_tr_b16 v[222:223], v237 offset:9984
  v_add_f32 v164, v164, v165
  v_mfma_f32_16x16x32_bf16 v[100:103], v[196:199], a[124:127], v[100:103]
  buffer_load_dwordx4 v142, s[12:15], s46 offen offset:2048 lds
  v_add_f32 v166, v166, v167
  v_add_f32 v164, v164, v166
  v_mfma_f32_16x16x32_bf16 v[8:11], v[200:203], a[112:115], v[8:11]
  v_cvt_pk_bf16_f32 v164, v164, v164
  v_lshlrev_b32 v164, 16, v164
  v_add_f32 v164, s59, v164
  v_mfma_f32_16x16x32_bf16 v[40:43], v[200:203], a[116:119], v[40:43]
  v_cvt_pk_bf16_f32 v164, v164, v164
  v_mfma_f32_16x16x32_bf16 v[72:75], v[200:203], a[120:123], v[72:75]
  ds_write_b16 v183, v164 offset:1024
  v_add_f32 v168, v168, v169
  v_add_f32 v170, v170, v171
  v_mfma_f32_16x16x32_bf16 v[104:107], v[200:203], a[124:127], v[104:107]
  buffer_load_dwordx4 v143, s[12:15], s46 offen offset:3072 lds
  v_add_f32 v168, v168, v170
  v_cvt_pk_bf16_f32 v168, v168, v168
  v_mfma_f32_16x16x32_bf16 v[12:15], v[204:207], a[112:115], v[12:15]
  s_lshl_b32 s51, s7, 2
  s_add_u32 s51, s51, s3
  s_mul_i32 s51, s51, 163840
  s_add_u32 s51, s51, 0
  v_min_u32 v240, 39, v224
  v_and_b32 v241, 1, v240
  v_lshrrev_b32 v240, 1, v240
  v_lshlrev_b32 v240, 13, v240
  v_lshl_add_u32 v240, v241, 7, v240
  buffer_load_dword v227, v240, s[40:43], s51 offen
  v_lshlrev_b32 v168, 16, v168
  v_add_f32 v168, 1.0, v168
  v_cvt_pk_bf16_f32 v168, v168, v168
  v_mfma_f32_16x16x32_bf16 v[44:47], v[204:207], a[116:119], v[44:47]
  v_mfma_f32_16x16x32_bf16 v[76:79], v[204:207], a[120:123], v[76:79]
  v_mfma_f32_16x16x32_bf16 v[108:111], v[204:207], a[124:127], v[108:111]
  s_waitcnt lgkmcnt(0)
  v_mfma_f32_16x16x32_bf16 v[16:19], v[208:211], a[112:115], v[16:19]
  s_waitcnt vmcnt(16)
  s_barrier
  ds_read_b64_tr_b16 v[192:193], v234 offset:32768
  v_mfma_f32_16x16x32_bf16 v[48:51], v[208:211], a[116:119], v[48:51]
  ds_read_b64_tr_b16 v[194:195], v234 offset:33792
  v_mfma_f32_16x16x32_bf16 v[80:83], v[208:211], a[120:123], v[80:83]
  s_add_u32 m0, s49, 98304
  s_add_u32 s46, s54, 0
  ds_write_b16 v183, v168 offset:1536
  ds_read_b128 a[192:195], v128 offset:0
  ds_read_b128 a[196:199], v128 offset:2048
  v_add_f32 v172, v172, v173
  v_mfma_f32_16x16x32_bf16 v[112:115], v[208:211], a[124:127], v[112:115]
  buffer_load_dwordx4 v252, s[20:23], s46 offen offset:0 nt lds
  v_add_f32 v174, v174, v175
  v_add_f32 v172, v172, v174
  v_mfma_f32_16x16x32_bf16 v[20:23], v[212:215], a[112:115], v[20:23]
  ds_read_b128 a[200:203], v128 offset:4096
  v_cvt_pk_bf16_f32 v172, v172, v172
  v_lshlrev_b32 v172, 16, v172
  v_mfma_f32_16x16x32_bf16 v[52:55], v[212:215], a[116:119], v[52:55]
  ds_read_b128 a[204:207], v128 offset:6144
  v_add_f32 v172, 1.0, v172
  v_cvt_pk_bf16_f32 v172, v172, v172
  v_mfma_f32_16x16x32_bf16 v[84:87], v[212:215], a[120:123], v[84:87]
  ds_write_b16 v183, v172 offset:2048
  ds_read_b64_tr_b16 v[196:197], v235 offset:32768
  s_mul_i32 s44, s3, 320
  v_mfma_f32_16x16x32_bf16 v[116:119], v[212:215], a[124:127], v[116:119]
  ds_read_b64_tr_b16 v[198:199], v235 offset:33792
  s_add_u32 s44, s44, 157696
  v_lshrrev_b32 v184, 3, v224
  v_lshl_add_u32 v183, v184, 4, s44
  v_mfma_f32_16x16x32_bf16 v[24:27], v[216:219], a[112:115], v[24:27]
  ds_read_b64_tr_b16 v[200:201], v234 offset:33024
  s_lshr_b32 s44, s60, 2
  s_mul_i32 s44, s44, 40960
  s_and_b32 s45, s60, 1
  s_lshl_b32 s45, s45, 7
  s_add_u32 s44, s44, s45
  s_and_b32 s45, s60, 2
  s_lshl_b32 s45, s45, 9
  s_add_u32 s44, s44, s45
  s_mul_i32 s45, s3, 10240
  s_add_u32 s44, s44, s45
  s_add_u32 s44, s44, 1048576
  s_add_u32 s24, s4, s44
  s_addc_u32 s25, s5, 0
  s_mov_b32 s26, 9088
  s_mov_b32 s27, 0x20000
  v_mfma_f32_16x16x32_bf16 v[56:59], v[216:219], a[116:119], v[56:59]
  ds_read_b64_tr_b16 v[202:203], v234 offset:34048
  v_and_b32 v185, 7, v224
  v_lshlrev_b32 v185, 4, v185
  v_lshl_add_u32 v185, v184, 8, v185
  v_mfma_f32_16x16x32_bf16 v[88:91], v[216:219], a[120:123], v[88:91]
  ds_read_b64_tr_b16 v[204:205], v235 offset:33024
  ds_read_b64_tr_b16 v[206:207], v235 offset:34048
  v_lshrrev_b32 v184, 5, v224
  v_mfma_f32_16x16x32_bf16 v[120:123], v[216:219], a[124:127], v[120:123]
  buffer_load_dwordx4 v253, s[20:23], s46 offen offset:1024 nt lds
  v_lshl_add_u32 v185, v184, 10, v185
  s_mov_b32 s59, 0
  v_mfma_f32_16x16x32_bf16 v[28:31], v[220:223], a[112:115], v[28:31]
  v_mfma_f32_16x16x32_bf16 v[60:63], v[220:223], a[116:119], v[60:63]
  v_mfma_f32_16x16x32_bf16 v[92:95], v[220:223], a[120:123], v[92:95]
  v_mfma_f32_16x16x32_bf16 v[124:127], v[220:223], a[124:127], v[124:127]
  s_waitcnt lgkmcnt(0)
  v_mfma_f32_16x16x32_bf16 v[0:3], v[192:195], a[192:195], v[0:3]
  ds_read_b64_tr_b16 v[208:209], v234 offset:33280
  s_barrier
  v_mfma_f32_16x16x32_bf16 v[32:35], v[192:195], a[196:199], v[32:35]
  ds_read_b64_tr_b16 v[210:211], v234 offset:34304
  v_mfma_f32_16x16x32_bf16 v[64:67], v[192:195], a[200:203], v[64:67]
  ds_read_b128 v[156:159], v183 offset:0
  ds_read_b64_tr_b16 v[212:213], v235 offset:33280
  ds_read_b64_tr_b16 v[214:215], v235 offset:34304
  v_mfma_f32_16x16x32_bf16 v[96:99], v[192:195], a[204:207], v[96:99]
  buffer_load_dwordx4 v254, s[20:23], s46 offen offset:2048 nt lds
  v_mfma_f32_16x16x32_bf16 v[4:7], v[196:199], a[192:195], v[4:7]
  ds_read_b128 v[160:163], v183 offset:1280
  ds_read_b64_tr_b16 v[216:217], v234 offset:33536
  v_mfma_f32_16x16x32_bf16 v[36:39], v[196:199], a[196:199], v[36:39]
  ds_read_b64_tr_b16 v[218:219], v234 offset:34560
  v_mfma_f32_16x16x32_bf16 v[68:71], v[196:199], a[200:203], v[68:71]
  ds_read_b128 v[164:167], v183 offset:128
  ds_read_b64_tr_b16 v[220:221], v235 offset:33536
  v_mfma_f32_16x16x32_bf16 v[100:103], v[196:199], a[204:207], v[100:103]
  ds_read_b64_tr_b16 v[222:223], v235 offset:34560
  v_mfma_f32_16x16x32_bf16 v[8:11], v[200:203], a[192:195], v[8:11]
  ds_read_b128 v[168:171], v183 offset:1408
  v_mfma_f32_16x16x32_bf16 v[40:43], v[200:203], a[196:199], v[40:43]
  v_mfma_f32_16x16x32_bf16 v[72:75], v[200:203], a[200:203], v[72:75]
  ds_read_b128 v[172:175], v183 offset:256
  v_mfma_f32_16x16x32_bf16 v[104:107], v[200:203], a[204:207], v[104:107]
  buffer_load_dwordx4 v255, s[20:23], s46 offen offset:3072 nt lds
  v_mfma_f32_16x16x32_bf16 v[12:15], v[204:207], a[192:195], v[12:15]
  s_add_u32 m0, s49, 114688
  s_add_u32 s46, s54, 1048576
  ds_read_b128 v[176:179], v183 offset:1536
  v_mfma_f32_16x16x32_bf16 v[44:47], v[204:207], a[196:199], v[44:47]
  buffer_load_dwordx4 v252, s[20:23], s46 offen offset:0 nt lds
  v_mfma_f32_16x16x32_bf16 v[76:79], v[204:207], a[200:203], v[76:79]
  v_mfma_f32_16x16x32_bf16 v[108:111], v[204:207], a[204:207], v[108:111]
  s_waitcnt lgkmcnt(0)
  buffer_load_dwordx4 v253, s[20:23], s46 offen offset:1024 nt lds
  v_mfma_f32_16x16x32_bf16 v[16:19], v[208:211], a[192:195], v[16:19]
  ds_read_b64_tr_b16 v[192:193], v234 offset:40960
  ds_read_b64_tr_b16 v[194:195], v234 offset:41984
  v_lshlrev_b32 v186, 16, v144
  v_mfma_f32_16x16x32_bf16 v[48:51], v[208:211], a[196:199], v[48:51]
  buffer_load_dwordx4 v254, s[20:23], s46 offen offset:2048 nt lds
  v_and_b32 v187, 0xffff0000, v144
  v_lshlrev_b32 v188, 16, v160
  v_mfma_f32_16x16x32_bf16 v[80:83], v[208:211], a[200:203], v[80:83]
  ds_read_b128 a[208:211], v129 offset:0
  ds_read_b128 a[212:215], v129 offset:2048
  v_and_b32 v189, 0xffff0000, v160
  v_mfma_f32_16x16x32_bf16 v[112:115], v[208:211], a[204:207], v[112:115]
  buffer_load_dwordx4 v255, s[20:23], s46 offen offset:3072 nt lds
  v_mul_f32 v186, v186, v188
  v_mul_f32 v187, v187, v189
  v_mfma_f32_16x16x32_bf16 v[20:23], v[212:215], a[192:195], v[20:23]
  ds_read_b128 a[216:219], v129 offset:4096
  v_cvt_pk_bf16_f32 v144, v186, v187
  v_lshlrev_b32 v188, 16, v156
  v_mfma_f32_16x16x32_bf16 v[52:55], v[212:215], a[196:199], v[52:55]
  ds_read_b128 a[220:223], v129 offset:6144
  v_and_b32 v189, 0xffff0000, v156
  v_lshlrev_b32 v186, 16, v144
  v_and_b32 v187, 0xffff0000, v144
  v_mfma_f32_16x16x32_bf16 v[84:87], v[212:215], a[200:203], v[84:87]
  ds_read_b64_tr_b16 v[196:197], v235 offset:40960
  v_add_f32 v186, v186, v188
  v_add_f32 v187, v187, v189
  v_mfma_f32_16x16x32_bf16 v[116:119], v[212:215], a[204:207], v[116:119]
  ds_read_b64_tr_b16 v[198:199], v235 offset:41984
  v_cvt_pk_bf16_f32 v144, v186, v187
  v_lshlrev_b32 v186, 16, v145
  v_and_b32 v187, 0xffff0000, v145
  v_mfma_f32_16x16x32_bf16 v[24:27], v[216:219], a[192:195], v[24:27]
  ds_read_b64_tr_b16 v[200:201], v234 offset:41216
  v_lshlrev_b32 v188, 16, v161
  v_and_b32 v189, 0xffff0000, v161
  v_mfma_f32_16x16x32_bf16 v[56:59], v[216:219], a[196:199], v[56:59]
  ds_read_b64_tr_b16 v[202:203], v234 offset:42240
  v_mul_f32 v186, v186, v188
  v_mul_f32 v187, v187, v189
  v_cvt_pk_bf16_f32 v145, v186, v187
  v_mfma_f32_16x16x32_bf16 v[88:91], v[216:219], a[200:203], v[88:91]
  ds_read_b64_tr_b16 v[204:205], v235 offset:41216
  v_lshlrev_b32 v188, 16, v157
  v_and_b32 v189, 0xffff0000, v157
  v_mfma_f32_16x16x32_bf16 v[120:123], v[216:219], a[204:207], v[120:123]
  ds_read_b64_tr_b16 v[206:207], v235 offset:42240
  v_lshlrev_b32 v186, 16, v145
  v_and_b32 v187, 0xffff0000, v145
  v_add_f32 v186, v186, v188
  v_mfma_f32_16x16x32_bf16 v[28:31], v[220:223], a[192:195], v[28:31]
  v_add_f32 v187, v187, v189
  v_cvt_pk_bf16_f32 v145, v186, v187
  v_lshlrev_b32 v186, 16, v146
  v_mfma_f32_16x16x32_bf16 v[60:63], v[220:223], a[196:199], v[60:63]
  v_and_b32 v187, 0xffff0000, v146
  v_lshlrev_b32 v188, 16, v162
  v_and_b32 v189, 0xffff0000, v162
  v_mfma_f32_16x16x32_bf16 v[92:95], v[220:223], a[200:203], v[92:95]
  v_mul_f32 v186, v186, v188
  v_mul_f32 v187, v187, v189
  v_cvt_pk_bf16_f32 v146, v186, v187
  v_mfma_f32_16x16x32_bf16 v[124:127], v[220:223], a[204:207], v[124:127]
  s_waitcnt lgkmcnt(0)
  v_lshlrev_b32 v188, 16, v158
  v_and_b32 v189, 0xffff0000, v158
  v_lshlrev_b32 v186, 16, v146
  v_mfma_f32_16x16x32_bf16 v[0:3], v[192:195], a[208:211], v[0:3]
  ds_read_b64_tr_b16 v[208:209], v234 offset:41472
  v_and_b32 v187, 0xffff0000, v146
  v_add_f32 v186, v186, v188
  v_mfma_f32_16x16x32_bf16 v[32:35], v[192:195], a[212:215], v[32:35]
  ds_read_b64_tr_b16 v[210:211], v234 offset:42496
  v_add_f32 v187, v187, v189
  v_cvt_pk_bf16_f32 v146, v186, v187
  v_lshlrev_b32 v186, 16, v147
  v_mfma_f32_16x16x32_bf16 v[64:67], v[192:195], a[216:219], v[64:67]
  ds_read_b64_tr_b16 v[212:213], v235 offset:41472
  v_and_b32 v187, 0xffff0000, v147
  v_lshlrev_b32 v188, 16, v163
  v_mfma_f32_16x16x32_bf16 v[96:99], v[192:195], a[220:223], v[96:99]
  ds_read_b64_tr_b16 v[214:215], v235 offset:42496
  v_and_b32 v189, 0xffff0000, v163
  v_mul_f32 v186, v186, v188
  v_mul_f32 v187, v187, v189
  v_mfma_f32_16x16x32_bf16 v[4:7], v[196:199], a[208:211], v[4:7]
  ds_read_b64_tr_b16 v[216:217], v234 offset:41728
  v_cvt_pk_bf16_f32 v147, v186, v187
  v_lshlrev_b32 v188, 16, v159
  v_mfma_f32_16x16x32_bf16 v[36:39], v[196:199], a[212:215], v[36:39]
  ds_read_b64_tr_b16 v[218:219], v234 offset:42752
  v_and_b32 v189, 0xffff0000, v159
  v_lshlrev_b32 v186, 16, v147
  v_and_b32 v187, 0xffff0000, v147
  v_mfma_f32_16x16x32_bf16 v[68:71], v[196:199], a[216:219], v[68:71]
  ds_read_b64_tr_b16 v[220:221], v235 offset:41728
  v_add_f32 v186, v186, v188
  v_add_f32 v187, v187, v189
  v_mfma_f32_16x16x32_bf16 v[100:103], v[196:199], a[220:223], v[100:103]
  ds_read_b64_tr_b16 v[222:223], v235 offset:42752
  v_cvt_pk_bf16_f32 v147, v186, v187
  v_mfma_f32_16x16x32_bf16 v[8:11], v[200:203], a[208:211], v[8:11]
  v_mfma_f32_16x16x32_bf16 v[40:43], v[200:203], a[212:215], v[40:43]
  buffer_store_dwordx4 v[144:147], v185, s[24:27], s59 offen sc1
  s_add_u32 s59, s59, 4096
  v_lshlrev_b32 v186, 16, v148
  v_mfma_f32_16x16x32_bf16 v[72:75], v[200:203], a[216:219], v[72:75]
  v_and_b32 v187, 0xffff0000, v148
  v_lshlrev_b32 v188, 16, v168
  v_and_b32 v189, 0xffff0000, v168
  v_mfma_f32_16x16x32_bf16 v[104:107], v[200:203], a[220:223], v[104:107]
  v_mul_f32 v186, v186, v188
  v_mul_f32 v187, v187, v189
  v_cvt_pk_bf16_f32 v148, v186, v187
  v_mfma_f32_16x16x32_bf16 v[12:15], v[204:207], a[208:211], v[12:15]
  v_lshlrev_b32 v188, 16, v164
  v_and_b32 v189, 0xffff0000, v164
  v_lshlrev_b32 v186, 16, v148
  v_mfma_f32_16x16x32_bf16 v[44:47], v[204:207], a[212:215], v[44:47]
  v_and_b32 v187, 0xffff0000, v148
  v_add_f32 v186, v186, v188
  v_add_f32 v187, v187, v189
  v_mfma_f32_16x16x32_bf16 v[76:79], v[204:207], a[216:219], v[76:79]
  v_cvt_pk_bf16_f32 v148, v186, v187
  v_lshlrev_b32 v186, 16, v149
  v_and_b32 v187, 0xffff0000, v149
  v_mfma_f32_16x16x32_bf16 v[108:111], v[204:207], a[220:223], v[108:111]
  s_waitcnt lgkmcnt(0)
  v_lshlrev_b32 v188, 16, v169
  v_and_b32 v189, 0xffff0000, v169
  v_mul_f32 v186, v186, v188
  v_mfma_f32_16x16x32_bf16 v[16:19], v[208:211], a[208:211], v[16:19]
  s_waitcnt vmcnt(10)
  s_barrier
  ds_read_b64_tr_b16 v[192:193], v238 offset:16384
  v_mul_f32 v187, v187, v189
  v_cvt_pk_bf16_f32 v149, v186, v187
  v_mfma_f32_16x16x32_bf16 v[48:51], v[208:211], a[212:215], v[48:51]
  ds_read_b64_tr_b16 v[194:195], v238 offset:17408
  v_lshlrev_b32 v188, 16, v165
  v_and_b32 v189, 0xffff0000, v165
  v_lshlrev_b32 v186, 16, v149
  v_mfma_f32_16x16x32_bf16 v[80:83], v[208:211], a[216:219], v[80:83]
  ds_read_b128 a[224:227], v128 offset:49152
  v_and_b32 v187, 0xffff0000, v149
  v_add_f32 v186, v186, v188
  v_mfma_f32_16x16x32_bf16 v[112:115], v[208:211], a[220:223], v[112:115]
  ds_read_b128 a[228:231], v128 offset:51200
  v_add_f32 v187, v187, v189
  v_cvt_pk_bf16_f32 v149, v186, v187
  v_lshlrev_b32 v186, 16, v150
  v_mfma_f32_16x16x32_bf16 v[20:23], v[212:215], a[208:211], v[20:23]
  ds_read_b128 a[232:235], v128 offset:53248
  v_and_b32 v187, 0xffff0000, v150
  v_lshlrev_b32 v188, 16, v170
  v_mfma_f32_16x16x32_bf16 v[52:55], v[212:215], a[212:215], v[52:55]
  ds_read_b128 a[236:239], v128 offset:55296
  v_and_b32 v189, 0xffff0000, v170
  v_mul_f32 v186, v186, v188
  v_mul_f32 v187, v187, v189
  v_mfma_f32_16x16x32_bf16 v[84:87], v[212:215], a[216:219], v[84:87]
  ds_read_b64_tr_b16 v[196:197], v239 offset:16384
  v_cvt_pk_bf16_f32 v150, v186, v187
  v_lshlrev_b32 v188, 16, v166
  v_mfma_f32_16x16x32_bf16 v[116:119], v[212:215], a[220:223], v[116:119]
  ds_read_b64_tr_b16 v[198:199], v239 offset:17408
  v_and_b32 v189, 0xffff0000, v166
  v_lshlrev_b32 v186, 16, v150
  v_and_b32 v187, 0xffff0000, v150
  v_mfma_f32_16x16x32_bf16 v[24:27], v[216:219], a[208:211], v[24:27]
  ds_read_b64_tr_b16 v[200:201], v238 offset:16640
  v_add_f32 v186, v186, v188
  v_add_f32 v187, v187, v189
  v_mfma_f32_16x16x32_bf16 v[56:59], v[216:219], a[212:215], v[56:59]
  ds_read_b64_tr_b16 v[202:203], v238 offset:17664
  v_cvt_pk_bf16_f32 v150, v186, v187
  v_lshlrev_b32 v186, 16, v151
  v_and_b32 v187, 0xffff0000, v151
  v_mfma_f32_16x16x32_bf16 v[88:91], v[216:219], a[216:219], v[88:91]
  ds_read_b64_tr_b16 v[204:205], v239 offset:16640
  v_lshlrev_b32 v188, 16, v171
  v_and_b32 v189, 0xffff0000, v171
  v_mfma_f32_16x16x32_bf16 v[120:123], v[216:219], a[220:223], v[120:123]
  ds_read_b64_tr_b16 v[206:207], v239 offset:17664
  v_mul_f32 v186, v186, v188
  v_mul_f32 v187, v187, v189
  v_cvt_pk_bf16_f32 v151, v186, v187
  v_mfma_f32_16x16x32_bf16 v[28:31], v[220:223], a[208:211], v[28:31]
  v_lshlrev_b32 v188, 16, v167
  v_and_b32 v189, 0xffff0000, v167
  v_lshlrev_b32 v186, 16, v151
  v_mfma_f32_16x16x32_bf16 v[60:63], v[220:223], a[212:215], v[60:63]
  v_and_b32 v187, 0xffff0000, v151
  v_add_f32 v186, v186, v188
  v_add_f32 v187, v187, v189
  v_mfma_f32_16x16x32_bf16 v[92:95], v[220:223], a[216:219], v[92:95]
  v_cvt_pk_bf16_f32 v151, v186, v187
  v_mfma_f32_16x16x32_bf16 v[124:127], v[220:223], a[220:223], v[124:127]
  s_waitcnt lgkmcnt(0)
  v_mfma_f32_16x16x32_bf16 v[0:3], v[192:195], a[224:227], v[0:3]
  ds_read_b64_tr_b16 v[208:209], v238 offset:16896
  ds_read_b64_tr_b16 v[210:211], v238 offset:17920
  v_mfma_f32_16x16x32_bf16 v[32:35], v[192:195], a[228:231], v[32:35]
  buffer_store_dwordx4 v[148:151], v185, s[24:27], s59 offen sc1
  s_add_u32 s59, s59, 4096
  v_lshlrev_b32 v186, 16, v152
  v_mfma_f32_16x16x32_bf16 v[64:67], v[192:195], a[232:235], v[64:67]
  ds_read_b64_tr_b16 v[212:213], v239 offset:16896
  v_and_b32 v187, 0xffff0000, v152
  v_lshlrev_b32 v188, 16, v176
  v_mfma_f32_16x16x32_bf16 v[96:99], v[192:195], a[236:239], v[96:99]
  ds_read_b64_tr_b16 v[214:215], v239 offset:17920
  v_and_b32 v189, 0xffff0000, v176
  v_mul_f32 v186, v186, v188
  v_mul_f32 v187, v187, v189
  v_mfma_f32_16x16x32_bf16 v[4:7], v[196:199], a[224:227], v[4:7]
  ds_read_b64_tr_b16 v[216:217], v238 offset:17152
  v_cvt_pk_bf16_f32 v152, v186, v187
  v_lshlrev_b32 v188, 16, v172
  v_mfma_f32_16x16x32_bf16 v[36:39], v[196:199], a[228:231], v[36:39]
  ds_read_b64_tr_b16 v[218:219], v238 offset:18176
  v_and_b32 v189, 0xffff0000, v172
  v_lshlrev_b32 v186, 16, v152
  v_and_b32 v187, 0xffff0000, v152
  v_mfma_f32_16x16x32_bf16 v[68:71], v[196:199], a[232:235], v[68:71]
  ds_read_b64_tr_b16 v[220:221], v239 offset:17152
  v_add_f32 v186, v186, v188
  v_add_f32 v187, v187, v189
  v_mfma_f32_16x16x32_bf16 v[100:103], v[196:199], a[236:239], v[100:103]
  ds_read_b64_tr_b16 v[222:223], v239 offset:18176
  v_cvt_pk_bf16_f32 v152, v186, v187
  v_lshlrev_b32 v186, 16, v153
  v_and_b32 v187, 0xffff0000, v153
  v_mfma_f32_16x16x32_bf16 v[8:11], v[200:203], a[224:227], v[8:11]
  v_lshlrev_b32 v188, 16, v177
  v_and_b32 v189, 0xffff0000, v177
  v_mul_f32 v186, v186, v188
  v_mfma_f32_16x16x32_bf16 v[40:43], v[200:203], a[228:231], v[40:43]
  v_mul_f32 v187, v187, v189
  v_cvt_pk_bf16_f32 v153, v186, v187
  v_lshlrev_b32 v188, 16, v173
  v_mfma_f32_16x16x32_bf16 v[72:75], v[200:203], a[232:235], v[72:75]
  v_and_b32 v189, 0xffff0000, v173
  v_lshlrev_b32 v186, 16, v153
  v_and_b32 v187, 0xffff0000, v153
  v_mfma_f32_16x16x32_bf16 v[104:107], v[200:203], a[236:239], v[104:107]
  v_add_f32 v186, v186, v188
  v_add_f32 v187, v187, v189
  v_cvt_pk_bf16_f32 v153, v186, v187
  v_mfma_f32_16x16x32_bf16 v[12:15], v[204:207], a[224:227], v[12:15]
  v_lshlrev_b32 v186, 16, v154
  v_and_b32 v187, 0xffff0000, v154
  v_lshlrev_b32 v188, 16, v178
  v_mfma_f32_16x16x32_bf16 v[44:47], v[204:207], a[228:231], v[44:47]
  v_and_b32 v189, 0xffff0000, v178
  v_mul_f32 v186, v186, v188
  v_mul_f32 v187, v187, v189
  v_mfma_f32_16x16x32_bf16 v[76:79], v[204:207], a[232:235], v[76:79]
  v_cvt_pk_bf16_f32 v154, v186, v187
  v_lshlrev_b32 v188, 16, v174
  v_and_b32 v189, 0xffff0000, v174
  v_mfma_f32_16x16x32_bf16 v[108:111], v[204:207], a[236:239], v[108:111]
  s_waitcnt lgkmcnt(0)
  v_lshlrev_b32 v186, 16, v154
  v_and_b32 v187, 0xffff0000, v154
  v_add_f32 v186, v186, v188
  v_mfma_f32_16x16x32_bf16 v[16:19], v[208:211], a[224:227], v[16:19]
  s_add_u32 m0, s49, 131072
  s_add_u32 s46, s54, 2097152
  ds_read_b64_tr_b16 v[192:193], v238 offset:24576
  ds_read_b64_tr_b16 v[194:195], v238 offset:25600
  v_add_f32 v187, v187, v189
  v_mfma_f32_16x16x32_bf16 v[48:51], v[208:211], a[228:231], v[48:51]
  buffer_load_dwordx4 v252, s[20:23], s46 offen offset:0 nt lds
  v_cvt_pk_bf16_f32 v154, v186, v187
  v_lshlrev_b32 v186, 16, v155
  v_mfma_f32_16x16x32_bf16 v[80:83], v[208:211], a[232:235], v[80:83]
  ds_read_b128 a[240:243], v129 offset:49152
  v_and_b32 v187, 0xffff0000, v155
  v_lshlrev_b32 v188, 16, v179
  v_mfma_f32_16x16x32_bf16 v[112:115], v[208:211], a[236:239], v[112:115]
  ds_read_b128 a[244:247], v129 offset:51200
  v_and_b32 v189, 0xffff0000, v179
  v_mul_f32 v186, v186, v188
  v_mul_f32 v187, v187, v189
  v_mfma_f32_16x16x32_bf16 v[20:23], v[212:215], a[224:227], v[20:23]
  ds_read_b128 a[248:251], v129 offset:53248
  v_cvt_pk_bf16_f32 v155, v186, v187
  v_lshlrev_b32 v188, 16, v175
  v_mfma_f32_16x16x32_bf16 v[52:55], v[212:215], a[228:231], v[52:55]
  ds_read_b128 a[252:255], v129 offset:55296
  v_and_b32 v189, 0xffff0000, v175
  v_lshlrev_b32 v186, 16, v155
  v_and_b32 v187, 0xffff0000, v155
  v_mfma_f32_16x16x32_bf16 v[84:87], v[212:215], a[232:235], v[84:87]
  ds_read_b64_tr_b16 v[196:197], v239 offset:24576
  v_add_f32 v186, v186, v188
  v_add_f32 v187, v187, v189
  v_mfma_f32_16x16x32_bf16 v[116:119], v[212:215], a[236:239], v[116:119]
  ds_read_b64_tr_b16 v[198:199], v239 offset:25600
  v_cvt_pk_bf16_f32 v155, v186, v187
  v_mfma_f32_16x16x32_bf16 v[24:27], v[216:219], a[224:227], v[24:27]
  ds_read_b64_tr_b16 v[200:201], v238 offset:24832
  ds_read_b64_tr_b16 v[202:203], v238 offset:25856
  v_mfma_f32_16x16x32_bf16 v[56:59], v[216:219], a[228:231], v[56:59]
  buffer_load_dwordx4 v253, s[20:23], s46 offen offset:1024 nt lds
  v_mfma_f32_16x16x32_bf16 v[88:91], v[216:219], a[232:235], v[88:91]
  ds_read_b64_tr_b16 v[204:205], v239 offset:24832
  ds_read_b64_tr_b16 v[206:207], v239 offset:25856
  v_mfma_f32_16x16x32_bf16 v[120:123], v[216:219], a[236:239], v[120:123]
  buffer_store_dwordx4 v[152:155], v185, s[24:27], s59 offen sc1
  s_add_u32 s59, s59, 4096
  v_mfma_f32_16x16x32_bf16 v[28:31], v[220:223], a[224:227], v[28:31]
  v_mfma_f32_16x16x32_bf16 v[60:63], v[220:223], a[228:231], v[60:63]
  v_mfma_f32_16x16x32_bf16 v[92:95], v[220:223], a[232:235], v[92:95]
  v_mfma_f32_16x16x32_bf16 v[124:127], v[220:223], a[236:239], v[124:127]
  s_waitcnt lgkmcnt(0)
  v_mfma_f32_16x16x32_bf16 v[0:3], v[192:195], a[240:243], v[0:3]
  ds_read_b64_tr_b16 v[208:209], v238 offset:25088
  ds_read_b64_tr_b16 v[210:211], v238 offset:26112
  v_mfma_f32_16x16x32_bf16 v[32:35], v[192:195], a[244:247], v[32:35]
  buffer_load_dwordx4 v254, s[20:23], s46 offen offset:2048 nt lds
  v_mfma_f32_16x16x32_bf16 v[64:67], v[192:195], a[248:251], v[64:67]
  ds_read_b64_tr_b16 v[212:213], v239 offset:25088
  v_mfma_f32_16x16x32_bf16 v[96:99], v[192:195], a[252:255], v[96:99]
  ds_read_b64_tr_b16 v[214:215], v239 offset:26112
  v_mfma_f32_16x16x32_bf16 v[4:7], v[196:199], a[240:243], v[4:7]
  ds_read_b64_tr_b16 v[216:217], v238 offset:25344
  v_mfma_f32_16x16x32_bf16 v[36:39], v[196:199], a[244:247], v[36:39]
  ds_read_b64_tr_b16 v[218:219], v238 offset:26368
  v_mfma_f32_16x16x32_bf16 v[68:71], v[196:199], a[248:251], v[68:71]
  ds_read_b64_tr_b16 v[220:221], v239 offset:25344
  v_mfma_f32_16x16x32_bf16 v[100:103], v[196:199], a[252:255], v[100:103]
  ds_read_b64_tr_b16 v[222:223], v239 offset:26368
  v_mfma_f32_16x16x32_bf16 v[8:11], v[200:203], a[240:243], v[8:11]
  v_mfma_f32_16x16x32_bf16 v[40:43], v[200:203], a[244:247], v[40:43]
  buffer_load_dwordx4 v255, s[20:23], s46 offen offset:3072 nt lds
  v_mfma_f32_16x16x32_bf16 v[72:75], v[200:203], a[248:251], v[72:75]
  v_mfma_f32_16x16x32_bf16 v[104:107], v[200:203], a[252:255], v[104:107]
  v_mfma_f32_16x16x32_bf16 v[12:15], v[204:207], a[240:243], v[12:15]
  v_mfma_f32_16x16x32_bf16 v[44:47], v[204:207], a[244:247], v[44:47]
  v_mfma_f32_16x16x32_bf16 v[76:79], v[204:207], a[248:251], v[76:79]
  v_mfma_f32_16x16x32_bf16 v[108:111], v[204:207], a[252:255], v[108:111]
  s_waitcnt lgkmcnt(0)
  v_mfma_f32_16x16x32_bf16 v[16:19], v[208:211], a[240:243], v[16:19]
  s_waitcnt vmcnt(7)
  s_barrier
  s_add_u32 m0, s49, 0
  s_add_u32 s46, s54, 3145728
  ds_read_b64_tr_b16 v[192:193], v232 offset:32768
  ds_read_b64_tr_b16 v[194:195], v232 offset:33280
  v_mfma_f32_16x16x32_bf16 v[48:51], v[208:211], a[244:247], v[48:51]
  buffer_load_dwordx4 v252, s[20:23], s46 offen offset:0 nt lds
  v_mfma_f32_16x16x32_bf16 v[80:83], v[208:211], a[248:251], v[80:83]
  ds_read_b64_tr_b16 v[196:197], v232 offset:36864
  v_mfma_f32_16x16x32_bf16 v[112:115], v[208:211], a[252:255], v[112:115]
  ds_read_b64_tr_b16 v[198:199], v232 offset:37376
  v_mfma_f32_16x16x32_bf16 v[20:23], v[212:215], a[240:243], v[20:23]
  ds_read_b64_tr_b16 v[200:201], v232 offset:40960
  v_mfma_f32_16x16x32_bf16 v[52:55], v[212:215], a[244:247], v[52:55]
  ds_read_b64_tr_b16 v[202:203], v232 offset:41472
  v_mfma_f32_16x16x32_bf16 v[84:87], v[212:215], a[248:251], v[84:87]
  ds_read_b64_tr_b16 v[204:205], v232 offset:45056
  v_mfma_f32_16x16x32_bf16 v[116:119], v[212:215], a[252:255], v[116:119]
  ds_read_b64_tr_b16 v[206:207], v232 offset:45568
  v_mfma_f32_16x16x32_bf16 v[24:27], v[216:219], a[240:243], v[24:27]
  v_mfma_f32_16x16x32_bf16 v[56:59], v[216:219], a[244:247], v[56:59]
  buffer_load_dwordx4 v253, s[20:23], s46 offen offset:1024 nt lds
  v_mfma_f32_16x16x32_bf16 v[88:91], v[216:219], a[248:251], v[88:91]
  v_mfma_f32_16x16x32_bf16 v[120:123], v[216:219], a[252:255], v[120:123]
  v_mfma_f32_16x16x32_bf16 v[28:31], v[220:223], a[240:243], v[28:31]
  v_mfma_f32_16x16x32_bf16 v[60:63], v[220:223], a[244:247], v[60:63]
  v_mfma_f32_16x16x32_bf16 v[92:95], v[220:223], a[248:251], v[92:95]
  v_mfma_f32_16x16x32_bf16 v[124:127], v[220:223], a[252:255], v[124:127]
  s_waitcnt lgkmcnt(0)
  v_mfma_f32_16x16x32_bf16 v[128:131], a[128:131], v[192:195], 0
  ds_read_b64_tr_b16 v[208:209], v233 offset:32768
  ds_read_b64_tr_b16 v[210:211], v233 offset:33280
  v_mfma_f32_16x16x32_bf16 v[128:131], a[144:147], v[196:199], v[128:131]
  buffer_load_dwordx4 v254, s[20:23], s46 offen offset:2048 nt lds
  v_mfma_f32_16x16x32_bf16 v[128:131], a[160:163], v[200:203], v[128:131]
  ds_read_b64_tr_b16 v[212:213], v233 offset:36864
  s_lshl_b32 s44, s6, 19
  s_lshl_b32 s45, s7, 16
  s_add_u32 s44, s44, s45
  v_mfma_f32_16x16x32_bf16 v[128:131], a[176:179], v[204:207], v[128:131]
  ds_read_b64_tr_b16 v[214:215], v233 offset:37376
  s_lshl_b32 s45, s3, 14
  s_add_u32 s44, s44, s45
  s_add_u32 s45, s44, 67108864
  v_mfma_f32_16x16x32_bf16 v[132:135], a[132:135], v[192:195], 0
  ds_read_b64_tr_b16 v[216:217], v233 offset:40960
  s_add_u32 s24, s4, s45
  s_addc_u32 s25, s5, 0
  s_mov_b32 s26, 16384
  s_mov_b32 s27, 0x20000
  v_mfma_f32_16x16x32_bf16 v[132:135], a[148:151], v[196:199], v[132:135]
  ds_read_b64_tr_b16 v[218:219], v233 offset:41472
  s_add_u32 s45, s44, 83886080
  v_mfma_f32_16x16x32_bf16 v[132:135], a[164:167], v[200:203], v[132:135]
  ds_read_b64_tr_b16 v[220:221], v233 offset:45056
  s_add_u32 s28, s4, s45
  s_addc_u32 s29, s5, 0
  s_mov_b32 s30, 16384
  s_mov_b32 s31, 0x20000
  v_mfma_f32_16x16x32_bf16 v[132:135], a[180:183], v[204:207], v[132:135]
  ds_read_b64_tr_b16 v[222:223], v233 offset:45568
  s_mul_i32 s44, s47, 40960
  s_add_u32 s44, s44, 1048576
  v_mfma_f32_16x16x32_bf16 v[160:163], a[136:139], v[192:195], 0
  s_add_u32 s32, s4, s44
  s_addc_u32 s33, s5, 0
  s_mov_b32 s34, 40960
  s_mov_b32 s35, 0x20000
  s_mul_i32 s44, s50, 40960
  s_add_u32 s44, s44, 1048576
  v_mfma_f32_16x16x32_bf16 v[160:163], a[152:155], v[196:199], v[160:163]
  buffer_load_dwordx4 v255, s[20:23], s46 offen offset:3072 nt lds
  v_mfma_f32_16x16x32_bf16 v[160:163], a[168:171], v[200:203], v[160:163]
  s_add_u32 s36, s4, s44
  s_addc_u32 s37, s5, 0
  s_mov_b32 s38, 40960
  s_mov_b32 s39, 0x20000
  v_mfma_f32_16x16x32_bf16 v[160:163], a[184:187], v[204:207], v[160:163]
  v_mfma_f32_16x16x32_bf16 v[164:167], a[140:143], v[192:195], 0
  v_mfma_f32_16x16x32_bf16 v[164:167], a[156:159], v[196:199], v[164:167]
  v_mfma_f32_16x16x32_bf16 v[164:167], a[172:175], v[200:203], v[164:167]
  v_mfma_f32_16x16x32_bf16 v[164:167], a[188:191], v[204:207], v[164:167]
  s_waitcnt lgkmcnt(0)
  v_mfma_f32_16x16x32_bf16 v[136:139], a[128:131], v[208:211], 0
  ds_read_b64_tr_b16 v[192:193], v232 offset:33024
  v_mul_f32 v64, s52, v64
  v_mfma_f32_16x16x32_bf16 v[136:139], a[144:147], v[212:215], v[136:139]
  ds_read_b64_tr_b16 v[194:195], v232 offset:33536
  v_mul_f32 v65, s52, v65
  v_mfma_f32_16x16x32_bf16 v[136:139], a[160:163], v[216:219], v[136:139]
  ds_read_b64_tr_b16 v[196:197], v232 offset:37120
  v_mul_f32 v66, s52, v66
  v_mfma_f32_16x16x32_bf16 v[136:139], a[176:179], v[220:223], v[136:139]
  ds_read_b64_tr_b16 v[198:199], v232 offset:37632
  v_mul_f32 v67, s52, v67
  v_mfma_f32_16x16x32_bf16 v[140:143], a[132:135], v[208:211], 0
  ds_read_b64_tr_b16 v[200:201], v232 offset:41216
  v_mul_f32 v68, s52, v68
  v_mfma_f32_16x16x32_bf16 v[140:143], a[148:151], v[212:215], v[140:143]
  ds_read_b64_tr_b16 v[202:203], v232 offset:41728
  v_mul_f32 v69, s52, v69
  v_mfma_f32_16x16x32_bf16 v[140:143], a[164:167], v[216:219], v[140:143]
  ds_read_b64_tr_b16 v[204:205], v232 offset:45312
  v_mul_f32 v70, s52, v70
  v_mfma_f32_16x16x32_bf16 v[140:143], a[180:183], v[220:223], v[140:143]
  ds_read_b64_tr_b16 v[206:207], v232 offset:45824
  v_mul_f32 v71, s52, v71
  v_mfma_f32_16x16x32_bf16 v[168:171], a[136:139], v[208:211], 0
  v_cvt_pk_bf16_f32 v64, v64, v65
  v_cvt_pk_bf16_f32 v65, v66, v67
  v_mfma_f32_16x16x32_bf16 v[168:171], a[152:155], v[212:215], v[168:171]
  v_cvt_pk_bf16_f32 v66, v68, v69
  v_mfma_f32_16x16x32_bf16 v[168:171], a[168:171], v[216:219], v[168:171]
  v_cvt_pk_bf16_f32 v67, v70, v71
  v_mul_f32 v0, s52, v0
  v_mfma_f32_16x16x32_bf16 v[168:171], a[184:187], v[220:223], v[168:171]
  v_mul_f32 v1, s52, v1
  v_mfma_f32_16x16x32_bf16 v[172:175], a[140:143], v[208:211], 0
  v_mul_f32 v2, s52, v2
  v_mul_f32 v3, s52, v3
  v_mfma_f32_16x16x32_bf16 v[172:175], a[156:159], v[212:215], v[172:175]
  buffer_store_dwordx4 v[64:67], v225, s[24:27], s56 offen offset:0 sc1
  v_mfma_f32_16x16x32_bf16 v[172:175], a[172:175], v[216:219], v[172:175]
  v_mul_f32 v4, s52, v4
  v_mul_f32 v5, s52, v5
  v_mfma_f32_16x16x32_bf16 v[172:175], a[188:191], v[220:223], v[172:175]
  s_waitcnt lgkmcnt(0)
  v_mul_f32 v6, s52, v6
  v_mfma_f32_16x16x32_bf16 v[144:147], a[128:131], v[192:195], 0
  ds_read_b64_tr_b16 v[208:209], v233 offset:33024
  v_mul_f32 v7, s52, v7
  v_mfma_f32_16x16x32_bf16 v[144:147], a[144:147], v[196:199], v[144:147]
  ds_read_b64_tr_b16 v[210:211], v233 offset:33536
  v_cvt_pk_bf16_f32 v68, v0, v1
  v_mfma_f32_16x16x32_bf16 v[144:147], a[160:163], v[200:203], v[144:147]
  ds_read_b64_tr_b16 v[212:213], v233 offset:37120
  v_cvt_pk_bf16_f32 v69, v2, v3
  v_mfma_f32_16x16x32_bf16 v[144:147], a[176:179], v[204:207], v[144:147]
  ds_read_b64_tr_b16 v[214:215], v233 offset:37632
  v_cvt_pk_bf16_f32 v70, v4, v5
  v_mfma_f32_16x16x32_bf16 v[148:151], a[132:135], v[192:195], 0
  ds_read_b64_tr_b16 v[216:217], v233 offset:41216
  v_cvt_pk_bf16_f32 v71, v6, v7
  v_mfma_f32_16x16x32_bf16 v[148:151], a[148:151], v[196:199], v[148:151]
  ds_read_b64_tr_b16 v[218:219], v233 offset:41728
  v_mul_f32 v72, s52, v72
  v_mfma_f32_16x16x32_bf16 v[148:151], a[164:167], v[200:203], v[148:151]
  ds_read_b64_tr_b16 v[220:221], v233 offset:45312
  v_mul_f32 v73, s52, v73
  v_mfma_f32_16x16x32_bf16 v[148:151], a[180:183], v[204:207], v[148:151]
  ds_read_b64_tr_b16 v[222:223], v233 offset:45824
  v_mul_f32 v74, s52, v74
  v_mfma_f32_16x16x32_bf16 v[176:179], a[136:139], v[192:195], 0
  v_mul_f32 v75, s52, v75
  v_mul_f32 v76, s52, v76
  v_mfma_f32_16x16x32_bf16 v[176:179], a[152:155], v[196:199], v[176:179]
  v_mul_f32 v77, s52, v77
  v_mfma_f32_16x16x32_bf16 v[176:179], a[168:171], v[200:203], v[176:179]
  v_mul_f32 v78, s52, v78
  v_mul_f32 v79, s52, v79
  v_mfma_f32_16x16x32_bf16 v[176:179], a[184:187], v[204:207], v[176:179]
  v_cvt_pk_bf16_f32 v72, v72, v73
  v_mfma_f32_16x16x32_bf16 v[180:183], a[140:143], v[192:195], 0
  v_cvt_pk_bf16_f32 v73, v74, v75
  v_cvt_pk_bf16_f32 v74, v76, v77
  v_mfma_f32_16x16x32_bf16 v[180:183], a[156:159], v[196:199], v[180:183]
  buffer_store_dwordx4 v[68:71], v225, s[24:27], 0 offen offset:0 sc1
  v_mfma_f32_16x16x32_bf16 v[180:183], a[172:175], v[200:203], v[180:183]
  v_cvt_pk_bf16_f32 v75, v78, v79
  v_mul_f32 v8, s52, v8
  v_mfma_f32_16x16x32_bf16 v[180:183], a[188:191], v[204:207], v[180:183]
  s_waitcnt lgkmcnt(0)
  v_mul_f32 v9, s52, v9
  v_mfma_f32_16x16x32_bf16 v[152:155], a[128:131], v[208:211], 0
  ds_read_b64_tr_b16 v[192:193], v232 offset:49152
  v_mul_f32 v10, s52, v10
  v_mfma_f32_16x16x32_bf16 v[152:155], a[144:147], v[212:215], v[152:155]
  ds_read_b64_tr_b16 v[194:195], v232 offset:49664
  v_mul_f32 v11, s52, v11
  v_mfma_f32_16x16x32_bf16 v[152:155], a[160:163], v[216:219], v[152:155]
  ds_read_b64_tr_b16 v[196:197], v232 offset:53248
  v_mul_f32 v12, s52, v12
  v_mfma_f32_16x16x32_bf16 v[152:155], a[176:179], v[220:223], v[152:155]
  ds_read_b64_tr_b16 v[198:199], v232 offset:53760
  v_mul_f32 v13, s52, v13
  v_mfma_f32_16x16x32_bf16 v[156:159], a[132:135], v[208:211], 0
  ds_read_b64_tr_b16 v[200:201], v232 offset:57344
  v_mul_f32 v14, s52, v14
  v_mfma_f32_16x16x32_bf16 v[156:159], a[148:151], v[212:215], v[156:159]
  ds_read_b64_tr_b16 v[202:203], v232 offset:57856
  v_mul_f32 v15, s52, v15
  v_mfma_f32_16x16x32_bf16 v[156:159], a[164:167], v[216:219], v[156:159]
  ds_read_b64_tr_b16 v[204:205], v232 offset:61440
  v_cvt_pk_bf16_f32 v76, v8, v9
  v_mfma_f32_16x16x32_bf16 v[156:159], a[180:183], v[220:223], v[156:159]
  ds_read_b64_tr_b16 v[206:207], v232 offset:61952
  v_cvt_pk_bf16_f32 v77, v10, v11
  v_mfma_f32_16x16x32_bf16 v[184:187], a[136:139], v[208:211], 0
  v_cvt_pk_bf16_f32 v78, v12, v13
  v_cvt_pk_bf16_f32 v79, v14, v15
  v_mfma_f32_16x16x32_bf16 v[184:187], a[152:155], v[212:215], v[184:187]
  v_mul_f32 v80, s52, v80
  v_mfma_f32_16x16x32_bf16 v[184:187], a[168:171], v[216:219], v[184:187]
  v_mul_f32 v81, s52, v81
  v_mul_f32 v82, s52, v82
  v_mfma_f32_16x16x32_bf16 v[184:187], a[184:187], v[220:223], v[184:187]
  v_mul_f32 v83, s52, v83
  v_mfma_f32_16x16x32_bf16 v[188:191], a[140:143], v[208:211], 0
  v_mul_f32 v84, s52, v84
  v_mul_f32 v85, s52, v85
  v_mfma_f32_16x16x32_bf16 v[188:191], a[156:159], v[212:215], v[188:191]
  v_mul_f32 v86, s52, v86
  v_mfma_f32_16x16x32_bf16 v[188:191], a[172:175], v[216:219], v[188:191]
  v_mul_f32 v87, s52, v87
  v_cvt_pk_bf16_f32 v80, v80, v81
  v_mfma_f32_16x16x32_bf16 v[188:191], a[188:191], v[220:223], v[188:191]
  s_waitcnt lgkmcnt(0)
  v_cvt_pk_bf16_f32 v81, v82, v83
  v_mfma_f32_16x16x32_bf16 v[128:131], a[0:3], v[192:195], v[128:131]
  ds_read_b64_tr_b16 v[208:209], v233 offset:49152
  ds_read_b64_tr_b16 v[210:211], v233 offset:49664
  v_mfma_f32_16x16x32_bf16 v[128:131], a[16:19], v[196:199], v[128:131]
  buffer_store_dwordx4 v[72:75], v225, s[24:27], s56 offen offset:1024 sc1
  v_mfma_f32_16x16x32_bf16 v[128:131], a[32:35], v[200:203], v[128:131]
  ds_read_b64_tr_b16 v[212:213], v233 offset:53248
  v_cvt_pk_bf16_f32 v82, v84, v85
  v_mfma_f32_16x16x32_bf16 v[128:131], a[48:51], v[204:207], v[128:131]
  ds_read_b64_tr_b16 v[214:215], v233 offset:53760
  v_cvt_pk_bf16_f32 v83, v86, v87
  v_mfma_f32_16x16x32_bf16 v[132:135], a[4:7], v[192:195], v[132:135]
  ds_read_b64_tr_b16 v[216:217], v233 offset:57344
  v_mul_f32 v16, s52, v16
  v_mfma_f32_16x16x32_bf16 v[132:135], a[20:23], v[196:199], v[132:135]
  ds_read_b64_tr_b16 v[218:219], v233 offset:57856
  v_mul_f32 v17, s52, v17
  v_mfma_f32_16x16x32_bf16 v[132:135], a[36:39], v[200:203], v[132:135]
  ds_read_b64_tr_b16 v[220:221], v233 offset:61440
  v_mul_f32 v18, s52, v18
  v_mfma_f32_16x16x32_bf16 v[132:135], a[52:55], v[204:207], v[132:135]
  ds_read_b64_tr_b16 v[222:223], v233 offset:61952
  v_mul_f32 v19, s52, v19
  v_mfma_f32_16x16x32_bf16 v[160:163], a[8:11], v[192:195], v[160:163]
  v_mul_f32 v20, s52, v20
  v_mul_f32 v21, s52, v21
  v_mfma_f32_16x16x32_bf16 v[160:163], a[24:27], v[196:199], v[160:163]
  v_mul_f32 v22, s52, v22
  v_mfma_f32_16x16x32_bf16 v[160:163], a[40:43], v[200:203], v[160:163]
  v_mul_f32 v23, s52, v23
  v_cvt_pk_bf16_f32 v84, v16, v17
  v_mfma_f32_16x16x32_bf16 v[160:163], a[56:59], v[204:207], v[160:163]
  v_cvt_pk_bf16_f32 v85, v18, v19
  v_mfma_f32_16x16x32_bf16 v[164:167], a[12:15], v[192:195], v[164:167]
  v_cvt_pk_bf16_f32 v86, v20, v21
  v_cvt_pk_bf16_f32 v87, v22, v23
  v_mfma_f32_16x16x32_bf16 v[164:167], a[28:31], v[196:199], v[164:167]
  v_mul_f32 v88, s52, v88
  v_mfma_f32_16x16x32_bf16 v[164:167], a[44:47], v[200:203], v[164:167]
  v_mul_f32 v89, s52, v89
  v_mul_f32 v90, s52, v90
  v_mfma_f32_16x16x32_bf16 v[164:167], a[60:63], v[204:207], v[164:167]
  s_waitcnt lgkmcnt(0)
  v_mul_f32 v91, s52, v91
  v_mfma_f32_16x16x32_bf16 v[136:139], a[0:3], v[208:211], v[136:139]
  s_add_u32 m0, s49, 16384
  s_add_u32 s46, s54, 128
  ds_read_b64_tr_b16 v[192:193], v232 offset:49408
  ds_read_b64_tr_b16 v[194:195], v232 offset:49920
  v_mfma_f32_16x16x32_bf16 v[136:139], a[16:19], v[212:215], v[136:139]
  buffer_load_dwordx4 v252, s[20:23], s46 offen offset:0 nt lds
  v_mfma_f32_16x16x32_bf16 v[136:139], a[32:35], v[216:219], v[136:139]
  ds_read_b64_tr_b16 v[196:197], v232 offset:53504
  v_mul_f32 v92, s52, v92
  v_mfma_f32_16x16x32_bf16 v[136:139], a[48:51], v[220:223], v[136:139]
  ds_read_b64_tr_b16 v[198:199], v232 offset:54016
  v_mul_f32 v93, s52, v93
  v_mfma_f32_16x16x32_bf16 v[140:143], a[4:7], v[208:211], v[140:143]
  ds_read_b64_tr_b16 v[200:201], v232 offset:57600
  ds_read_b64_tr_b16 v[202:203], v232 offset:58112
  v_mfma_f32_16x16x32_bf16 v[140:143], a[20:23], v[212:215], v[140:143]
  buffer_store_dwordx4 v[76:79], v225, s[24:27], 0 offen offset:1024 sc1
  v_mfma_f32_16x16x32_bf16 v[140:143], a[36:39], v[216:219], v[140:143]
  ds_read_b64_tr_b16 v[204:205], v232 offset:61696
  v_mul_f32 v94, s52, v94
  v_mfma_f32_16x16x32_bf16 v[140:143], a[52:55], v[220:223], v[140:143]
  ds_read_b64_tr_b16 v[206:207], v232 offset:62208
  v_mul_f32 v95, s52, v95
  v_mfma_f32_16x16x32_bf16 v[168:171], a[8:11], v[208:211], v[168:171]
  v_cvt_pk_bf16_f32 v88, v88, v89
  v_cvt_pk_bf16_f32 v89, v90, v91
  v_mfma_f32_16x16x32_bf16 v[168:171], a[24:27], v[212:215], v[168:171]
  buffer_load_dwordx4 v253, s[20:23], s46 offen offset:1024 nt lds
  v_mfma_f32_16x16x32_bf16 v[168:171], a[40:43], v[216:219], v[168:171]
  v_cvt_pk_bf16_f32 v90, v92, v93
  v_cvt_pk_bf16_f32 v91, v94, v95
  v_mfma_f32_16x16x32_bf16 v[168:171], a[56:59], v[220:223], v[168:171]
  v_mul_f32 v24, s52, v24
  v_mfma_f32_16x16x32_bf16 v[172:175], a[12:15], v[208:211], v[172:175]
  v_mul_f32 v25, s52, v25
  v_mul_f32 v26, s52, v26
  v_mfma_f32_16x16x32_bf16 v[172:175], a[28:31], v[212:215], v[172:175]
  v_mul_f32 v27, s52, v27
  v_mfma_f32_16x16x32_bf16 v[172:175], a[44:47], v[216:219], v[172:175]
  v_mul_f32 v28, s52, v28
  v_mul_f32 v29, s52, v29
  v_mfma_f32_16x16x32_bf16 v[172:175], a[60:63], v[220:223], v[172:175]
  s_waitcnt lgkmcnt(0)
  v_mul_f32 v30, s52, v30
  v_mfma_f32_16x16x32_bf16 v[144:147], a[0:3], v[192:195], v[144:147]
  ds_read_b64_tr_b16 v[208:209], v233 offset:49408
  ds_read_b64_tr_b16 v[210:211], v233 offset:49920
  v_mfma_f32_16x16x32_bf16 v[144:147], a[16:19], v[196:199], v[144:147]
  buffer_load_dwordx4 v254, s[20:23], s46 offen offset:2048 nt lds
  v_mfma_f32_16x16x32_bf16 v[144:147], a[32:35], v[200:203], v[144:147]
  ds_read_b64_tr_b16 v[212:213], v233 offset:53504
  v_mul_f32 v31, s52, v31
  v_mfma_f32_16x16x32_bf16 v[144:147], a[48:51], v[204:207], v[144:147]
  ds_read_b64_tr_b16 v[214:215], v233 offset:54016
  v_cvt_pk_bf16_f32 v92, v24, v25
  v_mfma_f32_16x16x32_bf16 v[148:151], a[4:7], v[192:195], v[148:151]
  ds_read_b64_tr_b16 v[216:217], v233 offset:57600
  v_cvt_pk_bf16_f32 v93, v26, v27
  v_mfma_f32_16x16x32_bf16 v[148:151], a[20:23], v[196:199], v[148:151]
  ds_read_b64_tr_b16 v[218:219], v233 offset:58112
  v_cvt_pk_bf16_f32 v94, v28, v29
  v_mfma_f32_16x16x32_bf16 v[148:151], a[36:39], v[200:203], v[148:151]
  ds_read_b64_tr_b16 v[220:221], v233 offset:61696
  ds_read_b64_tr_b16 v[222:223], v233 offset:62208
  v_mfma_f32_16x16x32_bf16 v[148:151], a[52:55], v[204:207], v[148:151]
  buffer_store_dwordx4 v[80:83], v225, s[24:27], s56 offen offset:2048 sc1
  v_mfma_f32_16x16x32_bf16 v[176:179], a[8:11], v[192:195], v[176:179]
  v_cvt_pk_bf16_f32 v95, v30, v31
  v_mul_f32 v96, s52, v96
  v_mfma_f32_16x16x32_bf16 v[176:179], a[24:27], v[196:199], v[176:179]
  buffer_load_dwordx4 v255, s[20:23], s46 offen offset:3072 nt lds
  v_mfma_f32_16x16x32_bf16 v[176:179], a[40:43], v[200:203], v[176:179]
  v_mul_f32 v97, s52, v97
  v_mul_f32 v98, s52, v98
  v_mfma_f32_16x16x32_bf16 v[176:179], a[56:59], v[204:207], v[176:179]
  v_mul_f32 v99, s52, v99
  v_mfma_f32_16x16x32_bf16 v[180:183], a[12:15], v[192:195], v[180:183]
  v_mul_f32 v100, s52, v100
  v_mul_f32 v101, s52, v101
  v_mfma_f32_16x16x32_bf16 v[180:183], a[28:31], v[196:199], v[180:183]
  v_mul_f32 v102, s52, v102
  v_mfma_f32_16x16x32_bf16 v[180:183], a[44:47], v[200:203], v[180:183]
  v_mul_f32 v103, s52, v103
  v_cvt_pk_bf16_f32 v96, v96, v97
  v_mfma_f32_16x16x32_bf16 v[180:183], a[60:63], v[204:207], v[180:183]
  s_waitcnt lgkmcnt(0)
  v_cvt_pk_bf16_f32 v97, v98, v99
  v_mfma_f32_16x16x32_bf16 v[152:155], a[0:3], v[208:211], v[152:155]
  s_waitcnt vmcnt(9)
  s_barrier
  s_cmp_lg_u32 s3, 0
  s_cbranch_scc1 L_adaL_nopush_9
  s_lshl_b32 s44, s7, 15
  s_lshl_b32 s45, s6, 2
  s_add_u32 s44, s44, s45
  v_lshlrev_b32 v244, 10, v224
  v_mov_b32 v245, 1
  s_mov_b32 exec_hi, 0
  buffer_store_dword v245, v244, s[8:11], s44 offen offset:512 sc1
  s_mov_b64 exec, -1
L_adaL_nopush_9:
  s_add_u32 m0, s49, 32768
  s_add_u32 s46, s54, 1048704
  ds_read_b64_tr_b16 v[192:193], v230 offset:0
  ds_read_b64_tr_b16 v[194:195], v230 offset:512
  v_mfma_f32_16x16x32_bf16 v[152:155], a[16:19], v[212:215], v[152:155]
  buffer_load_dwordx4 v252, s[20:23], s46 offen offset:0 nt lds
  v_mfma_f32_16x16x32_bf16 v[152:155], a[32:35], v[216:219], v[152:155]
  ds_read_b64_tr_b16 v[196:197], v230 offset:4096
  v_cvt_pk_bf16_f32 v98, v100, v101
  v_mfma_f32_16x16x32_bf16 v[152:155], a[48:51], v[220:223], v[152:155]
  ds_read_b64_tr_b16 v[198:199], v230 offset:4608
  v_cvt_pk_bf16_f32 v99, v102, v103
  v_mfma_f32_16x16x32_bf16 v[156:159], a[4:7], v[208:211], v[156:159]
  ds_read_b64_tr_b16 v[200:201], v230 offset:8192
  v_mul_f32 v32, s52, v32
  v_mfma_f32_16x16x32_bf16 v[156:159], a[20:23], v[212:215], v[156:159]
  ds_read_b64_tr_b16 v[202:203], v230 offset:8704
  v_mul_f32 v33, s52, v33
  v_mfma_f32_16x16x32_bf16 v[156:159], a[36:39], v[216:219], v[156:159]
  ds_read_b64_tr_b16 v[204:205], v230 offset:12288
  v_mul_f32 v34, s52, v34
  v_mfma_f32_16x16x32_bf16 v[156:159], a[52:55], v[220:223], v[156:159]
  ds_read_b64_tr_b16 v[206:207], v230 offset:12800
  v_mul_f32 v35, s52, v35
  v_mfma_f32_16x16x32_bf16 v[184:187], a[8:11], v[208:211], v[184:187]
  v_mul_f32 v36, s52, v36
  v_mul_f32 v37, s52, v37
  v_mfma_f32_16x16x32_bf16 v[184:187], a[24:27], v[212:215], v[184:187]
  buffer_load_dwordx4 v253, s[20:23], s46 offen offset:1024 nt lds
  v_mfma_f32_16x16x32_bf16 v[184:187], a[40:43], v[216:219], v[184:187]
  v_mul_f32 v38, s52, v38
  v_mul_f32 v39, s52, v39
  v_mfma_f32_16x16x32_bf16 v[184:187], a[56:59], v[220:223], v[184:187]
  buffer_store_dwordx4 v[84:87], v225, s[24:27], 0 offen offset:2048 sc1
  v_mfma_f32_16x16x32_bf16 v[188:191], a[12:15], v[208:211], v[188:191]
  v_cvt_pk_bf16_f32 v100, v32, v33
  v_cvt_pk_bf16_f32 v101, v34, v35
  v_mfma_f32_16x16x32_bf16 v[188:191], a[28:31], v[212:215], v[188:191]
  v_cvt_pk_bf16_f32 v102, v36, v37
  v_mfma_f32_16x16x32_bf16 v[188:191], a[44:47], v[216:219], v[188:191]
  v_cvt_pk_bf16_f32 v103, v38, v39
  v_mul_f32 v104, s52, v104
  v_mfma_f32_16x16x32_bf16 v[188:191], a[60:63], v[220:223], v[188:191]
  s_waitcnt lgkmcnt(0)
  v_mul_f32 v105, s52, v105
  v_mfma_f32_16x16x32_bf16 v[128:131], a[64:67], v[192:195], v[128:131]
  ds_read_b64_tr_b16 v[208:209], v231 offset:0
  ds_read_b64_tr_b16 v[210:211], v231 offset:512
  v_mfma_f32_16x16x32_bf16 v[128:131], a[80:83], v[196:199], v[128:131]
  buffer_load_dwordx4 v254, s[20:23], s46 offen offset:2048 nt lds
  v_mfma_f32_16x16x32_bf16 v[128:131], a[96:99], v[200:203], v[128:131]
  ds_read_b64_tr_b16 v[212:213], v231 offset:4096
  v_mul_f32 v106, s52, v106
  v_mfma_f32_16x16x32_bf16 v[128:131], a[112:115], v[204:207], v[128:131]
  ds_read_b64_tr_b16 v[214:215], v231 offset:4608
  v_mul_f32 v107, s52, v107
  v_mfma_f32_16x16x32_bf16 v[132:135], a[68:71], v[192:195], v[132:135]
  ds_read_b64_tr_b16 v[216:217], v231 offset:8192
  v_mul_f32 v108, s52, v108
  v_mfma_f32_16x16x32_bf16 v[132:135], a[84:87], v[196:199], v[132:135]
  ds_read_b64_tr_b16 v[218:219], v231 offset:8704
  v_mul_f32 v109, s52, v109
  v_mfma_f32_16x16x32_bf16 v[132:135], a[100:103], v[200:203], v[132:135]
  ds_read_b64_tr_b16 v[220:221], v231 offset:12288
  v_mul_f32 v110, s52, v110
  v_mfma_f32_16x16x32_bf16 v[132:135], a[116:119], v[204:207], v[132:135]
  ds_read_b64_tr_b16 v[222:223], v231 offset:12800
  v_mul_f32 v111, s52, v111
  v_mfma_f32_16x16x32_bf16 v[160:163], a[72:75], v[192:195], v[160:163]
  v_cvt_pk_bf16_f32 v104, v104, v105
  v_cvt_pk_bf16_f32 v105, v106, v107
  v_mfma_f32_16x16x32_bf16 v[160:163], a[88:91], v[196:199], v[160:163]
  buffer_load_dwordx4 v255, s[20:23], s46 offen offset:3072 nt lds
  v_mfma_f32_16x16x32_bf16 v[160:163], a[104:107], v[200:203], v[160:163]
  v_cvt_pk_bf16_f32 v106, v108, v109
  v_cvt_pk_bf16_f32 v107, v110, v111
  v_mfma_f32_16x16x32_bf16 v[160:163], a[120:123], v[204:207], v[160:163]
  v_mul_f32 v40, s52, v40
  v_mfma_f32_16x16x32_bf16 v[164:167], a[76:79], v[192:195], v[164:167]
  v_mul_f32 v41, s52, v41
  v_mul_f32 v42, s52, v42
  v_mfma_f32_16x16x32_bf16 v[164:167], a[92:95], v[196:199], v[164:167]
  v_mul_f32 v43, s52, v43
  v_mfma_f32_16x16x32_bf16 v[164:167], a[108:111], v[200:203], v[164:167]
  v_mul_f32 v44, s52, v44
  v_mul_f32 v45, s52, v45
  v_mfma_f32_16x16x32_bf16 v[164:167], a[124:127], v[204:207], v[164:167]
  s_waitcnt lgkmcnt(0)
  buffer_store_dwordx4 v[88:91], v225, s[24:27], s56 offen offset:3072 sc1
  v_mfma_f32_16x16x32_bf16 v[136:139], a[64:67], v[208:211], v[136:139]
  ds_read_b64_tr_b16 v[192:193], v230 offset:256
  v_mul_f32 v46, s52, v46
  v_mfma_f32_16x16x32_bf16 v[136:139], a[80:83], v[212:215], v[136:139]
  ds_read_b64_tr_b16 v[194:195], v230 offset:768
  v_mul_f32 v47, s52, v47
  v_mfma_f32_16x16x32_bf16 v[136:139], a[96:99], v[216:219], v[136:139]
  ds_read_b64_tr_b16 v[196:197], v230 offset:4352
  v_cvt_pk_bf16_f32 v108, v40, v41
  v_mfma_f32_16x16x32_bf16 v[136:139], a[112:115], v[220:223], v[136:139]
  ds_read_b64_tr_b16 v[198:199], v230 offset:4864
  v_cvt_pk_bf16_f32 v109, v42, v43
  v_mfma_f32_16x16x32_bf16 v[140:143], a[68:71], v[208:211], v[140:143]
  ds_read_b64_tr_b16 v[200:201], v230 offset:8448
  v_cvt_pk_bf16_f32 v110, v44, v45
  v_mfma_f32_16x16x32_bf16 v[140:143], a[84:87], v[212:215], v[140:143]
  ds_read_b64_tr_b16 v[202:203], v230 offset:8960
  v_cvt_pk_bf16_f32 v111, v46, v47
  v_mfma_f32_16x16x32_bf16 v[140:143], a[100:103], v[216:219], v[140:143]
  ds_read_b64_tr_b16 v[204:205], v230 offset:12544
  v_mul_f32 v112, s52, v112
  v_mfma_f32_16x16x32_bf16 v[140:143], a[116:119], v[220:223], v[140:143]
  ds_read_b64_tr_b16 v[206:207], v230 offset:13056
  v_mul_f32 v113, s52, v113
  v_mfma_f32_16x16x32_bf16 v[168:171], a[72:75], v[208:211], v[168:171]
  v_mul_f32 v114, s52, v114
  v_mul_f32 v115, s52, v115
  v_mfma_f32_16x16x32_bf16 v[168:171], a[88:91], v[212:215], v[168:171]
  v_mul_f32 v116, s52, v116
  v_mfma_f32_16x16x32_bf16 v[168:171], a[104:107], v[216:219], v[168:171]
  v_mul_f32 v117, s52, v117
  v_mul_f32 v118, s52, v118
  v_mfma_f32_16x16x32_bf16 v[168:171], a[120:123], v[220:223], v[168:171]
  v_mul_f32 v119, s52, v119
  v_mfma_f32_16x16x32_bf16 v[172:175], a[76:79], v[208:211], v[172:175]
  v_cvt_pk_bf16_f32 v112, v112, v113
  v_cvt_pk_bf16_f32 v113, v114, v115
  v_mfma_f32_16x16x32_bf16 v[172:175], a[92:95], v[212:215], v[172:175]
  v_cvt_pk_bf16_f32 v114, v116, v117
  v_mfma_f32_16x16x32_bf16 v[172:175], a[108:111], v[216:219], v[172:175]
  v_cvt_pk_bf16_f32 v115, v118, v119
  v_mul_f32 v48, s52, v48
  v_mfma_f32_16x16x32_bf16 v[172:175], a[124:127], v[220:223], v[172:175]
  s_waitcnt lgkmcnt(0)
  v_mul_f32 v49, s52, v49
  v_mfma_f32_16x16x32_bf16 v[144:147], a[64:67], v[192:195], v[144:147]
  ds_read_b64_tr_b16 v[208:209], v231 offset:256
  ds_read_b64_tr_b16 v[210:211], v231 offset:768
  v_mfma_f32_16x16x32_bf16 v[144:147], a[80:83], v[196:199], v[144:147]
  buffer_store_dwordx4 v[92:95], v225, s[24:27], 0 offen offset:3072 sc1
  v_mfma_f32_16x16x32_bf16 v[144:147], a[96:99], v[200:203], v[144:147]
  ds_read_b64_tr_b16 v[212:213], v231 offset:4352
  v_mul_f32 v50, s52, v50
  v_mfma_f32_16x16x32_bf16 v[144:147], a[112:115], v[204:207], v[144:147]
  ds_read_b64_tr_b16 v[214:215], v231 offset:4864
  v_mul_f32 v51, s52, v51
  v_mfma_f32_16x16x32_bf16 v[148:151], a[68:71], v[192:195], v[148:151]
  ds_read_b64_tr_b16 v[216:217], v231 offset:8448
  v_mul_f32 v52, s52, v52
  v_mfma_f32_16x16x32_bf16 v[148:151], a[84:87], v[196:199], v[148:151]
  ds_read_b64_tr_b16 v[218:219], v231 offset:8960
  v_mul_f32 v53, s52, v53
  v_mfma_f32_16x16x32_bf16 v[148:151], a[100:103], v[200:203], v[148:151]
  ds_read_b64_tr_b16 v[220:221], v231 offset:12544
  v_mul_f32 v54, s52, v54
  v_mfma_f32_16x16x32_bf16 v[148:151], a[116:119], v[204:207], v[148:151]
  ds_read_b64_tr_b16 v[222:223], v231 offset:13056
  v_mul_f32 v55, s52, v55
  v_mfma_f32_16x16x32_bf16 v[176:179], a[72:75], v[192:195], v[176:179]
  v_cvt_pk_bf16_f32 v116, v48, v49
  v_cvt_pk_bf16_f32 v117, v50, v51
  v_mfma_f32_16x16x32_bf16 v[176:179], a[88:91], v[196:199], v[176:179]
  v_cvt_pk_bf16_f32 v118, v52, v53
  v_mfma_f32_16x16x32_bf16 v[176:179], a[104:107], v[200:203], v[176:179]
  v_cvt_pk_bf16_f32 v119, v54, v55
  v_mul_f32 v120, s52, v120
  v_mfma_f32_16x16x32_bf16 v[176:179], a[120:123], v[204:207], v[176:179]
  v_mul_f32 v121, s52, v121
  v_mfma_f32_16x16x32_bf16 v[180:183], a[76:79], v[192:195], v[180:183]
  v_mul_f32 v122, s52, v122
  v_mul_f32 v123, s52, v123
  v_mfma_f32_16x16x32_bf16 v[180:183], a[92:95], v[196:199], v[180:183]
  v_mul_f32 v124, s52, v124
  v_mfma_f32_16x16x32_bf16 v[180:183], a[108:111], v[200:203], v[180:183]
  v_mul_f32 v125, s52, v125
  v_mul_f32 v126, s52, v126
  v_mfma_f32_16x16x32_bf16 v[180:183], a[124:127], v[204:207], v[180:183]
  s_waitcnt lgkmcnt(0)
  v_mul_f32 v127, s52, v127
  v_mfma_f32_16x16x32_bf16 v[152:155], a[64:67], v[208:211], v[152:155]
  ds_read_b64_tr_b16 v[192:193], v228 offset:0
  v_cvt_pk_bf16_f32 v120, v120, v121
  v_mfma_f32_16x16x32_bf16 v[152:155], a[80:83], v[212:215], v[152:155]
  ds_read_b64_tr_b16 v[194:195], v228 offset:512
  v_cvt_pk_bf16_f32 v121, v122, v123
  v_mfma_f32_16x16x32_bf16 v[152:155], a[96:99], v[216:219], v[152:155]
  ds_read_b64_tr_b16 v[196:197], v228 offset:4096
  v_cvt_pk_bf16_f32 v122, v124, v125
  v_mfma_f32_16x16x32_bf16 v[152:155], a[112:115], v[220:223], v[152:155]
  ds_read_b64_tr_b16 v[198:199], v228 offset:4608
  v_cvt_pk_bf16_f32 v123, v126, v127
  v_mfma_f32_16x16x32_bf16 v[156:159], a[68:71], v[208:211], v[156:159]
  ds_read_b64_tr_b16 v[200:201], v228 offset:8192
  ds_read_b64_tr_b16 v[202:203], v228 offset:8704
  v_mfma_f32_16x16x32_bf16 v[156:159], a[84:87], v[212:215], v[156:159]
  buffer_store_dwordx4 v[96:99], v225, s[24:27], s57 offen offset:0 sc1
  v_mfma_f32_16x16x32_bf16 v[156:159], a[100:103], v[216:219], v[156:159]
  ds_read_b64_tr_b16 v[204:205], v228 offset:12288
  v_mul_f32 v56, s52, v56
  v_mfma_f32_16x16x32_bf16 v[156:159], a[116:119], v[220:223], v[156:159]
  ds_read_b64_tr_b16 v[206:207], v228 offset:12800
  v_mul_f32 v57, s52, v57
  v_mfma_f32_16x16x32_bf16 v[184:187], a[72:75], v[208:211], v[184:187]
  v_mul_f32 v58, s52, v58
  v_mul_f32 v59, s52, v59
  v_mfma_f32_16x16x32_bf16 v[184:187], a[88:91], v[212:215], v[184:187]
  v_mul_f32 v60, s52, v60
  v_mfma_f32_16x16x32_bf16 v[184:187], a[104:107], v[216:219], v[184:187]
  v_mul_f32 v61, s52, v61
  v_mul_f32 v62, s52, v62
  v_mfma_f32_16x16x32_bf16 v[184:187], a[120:123], v[220:223], v[184:187]
  v_mul_f32 v63, s52, v63
  v_mfma_f32_16x16x32_bf16 v[188:191], a[76:79], v[208:211], v[188:191]
  v_cvt_pk_bf16_f32 v124, v56, v57
  v_cvt_pk_bf16_f32 v125, v58, v59
  v_mfma_f32_16x16x32_bf16 v[188:191], a[92:95], v[212:215], v[188:191]
  v_cvt_pk_bf16_f32 v126, v60, v61
  v_mfma_f32_16x16x32_bf16 v[188:191], a[108:111], v[216:219], v[188:191]
  v_cvt_pk_bf16_f32 v127, v62, v63
  v_mfma_f32_16x16x32_bf16 v[188:191], a[124:127], v[220:223], v[188:191]
  s_waitcnt lgkmcnt(0)
  v_mfma_f32_16x16x32_bf16 v[128:131], a[192:195], v[192:195], v[128:131]
  ds_read_b64_tr_b16 v[208:209], v229 offset:0
  v_mfma_f32_16x16x32_bf16 v[128:131], a[208:211], v[196:199], v[128:131]
  ds_read_b64_tr_b16 v[210:211], v229 offset:512
  v_mfma_f32_16x16x32_bf16 v[128:131], a[224:227], v[200:203], v[128:131]
  ds_read_b64_tr_b16 v[212:213], v229 offset:4096
  v_mfma_f32_16x16x32_bf16 v[128:131], a[240:243], v[204:207], v[128:131]
  ds_read_b64_tr_b16 v[214:215], v229 offset:4608
  v_mfma_f32_16x16x32_bf16 v[132:135], a[196:199], v[192:195], v[132:135]
  ds_read_b64_tr_b16 v[216:217], v229 offset:8192
  v_mfma_f32_16x16x32_bf16 v[132:135], a[212:215], v[196:199], v[132:135]
  ds_read_b64_tr_b16 v[218:219], v229 offset:8704
  v_mfma_f32_16x16x32_bf16 v[132:135], a[228:231], v[200:203], v[132:135]
  ds_read_b64_tr_b16 v[220:221], v229 offset:12288
  v_mfma_f32_16x16x32_bf16 v[132:135], a[244:247], v[204:207], v[132:135]
  ds_read_b64_tr_b16 v[222:223], v229 offset:12800
  v_mfma_f32_16x16x32_bf16 v[160:163], a[200:203], v[192:195], v[160:163]
  v_mfma_f32_16x16x32_bf16 v[160:163], a[216:219], v[196:199], v[160:163]
  buffer_store_dwordx4 v[100:103], v225, s[24:27], s55 offen offset:0 sc1
  v_mfma_f32_16x16x32_bf16 v[160:163], a[232:235], v[200:203], v[160:163]
  v_mfma_f32_16x16x32_bf16 v[160:163], a[248:251], v[204:207], v[160:163]
  v_mfma_f32_16x16x32_bf16 v[164:167], a[204:207], v[192:195], v[164:167]
  v_mfma_f32_16x16x32_bf16 v[164:167], a[220:223], v[196:199], v[164:167]
  v_mfma_f32_16x16x32_bf16 v[164:167], a[236:239], v[200:203], v[164:167]
  v_mfma_f32_16x16x32_bf16 v[164:167], a[252:255], v[204:207], v[164:167]
  s_waitcnt lgkmcnt(0)
  v_mfma_f32_16x16x32_bf16 v[136:139], a[192:195], v[208:211], v[136:139]
  s_add_u32 m0, s49, 49152
  s_add_u32 s46, s54, 2097280
  ds_read_b64_tr_b16 v[192:193], v228 offset:256
  ds_read_b64_tr_b16 v[194:195], v228 offset:768
  v_mfma_f32_16x16x32_bf16 v[136:139], a[208:211], v[212:215], v[136:139]
  buffer_load_dwordx4 v252, s[20:23], s46 offen offset:0 nt lds
  v_mfma_f32_16x16x32_bf16 v[136:139], a[224:227], v[216:219], v[136:139]
  ds_read_b64_tr_b16 v[196:197], v228 offset:4352
  v_mfma_f32_16x16x32_bf16 v[136:139], a[240:243], v[220:223], v[136:139]
  ds_read_b64_tr_b16 v[198:199], v228 offset:4864
  v_mfma_f32_16x16x32_bf16 v[140:143], a[196:199], v[208:211], v[140:143]
  ds_read_b64_tr_b16 v[200:201], v228 offset:8448
  v_mfma_f32_16x16x32_bf16 v[140:143], a[212:215], v[212:215], v[140:143]
  ds_read_b64_tr_b16 v[202:203], v228 offset:8960
  v_mfma_f32_16x16x32_bf16 v[140:143], a[228:231], v[216:219], v[140:143]
  ds_read_b64_tr_b16 v[204:205], v228 offset:12544
  v_mfma_f32_16x16x32_bf16 v[140:143], a[244:247], v[220:223], v[140:143]
  ds_read_b64_tr_b16 v[206:207], v228 offset:13056
  v_mfma_f32_16x16x32_bf16 v[168:171], a[200:203], v[208:211], v[168:171]
  v_mfma_f32_16x16x32_bf16 v[168:171], a[216:219], v[212:215], v[168:171]
  buffer_load_dwordx4 v253, s[20:23], s46 offen offset:1024 nt lds
  v_mfma_f32_16x16x32_bf16 v[168:171], a[232:235], v[216:219], v[168:171]
  v_mfma_f32_16x16x32_bf16 v[168:171], a[248:251], v[220:223], v[168:171]
  buffer_store_dwordx4 v[104:107], v225, s[24:27], s57 offen offset:1024 sc1
  v_mfma_f32_16x16x32_bf16 v[172:175], a[204:207], v[208:211], v[172:175]
  v_mfma_f32_16x16x32_bf16 v[172:175], a[220:223], v[212:215], v[172:175]
  v_mfma_f32_16x16x32_bf16 v[172:175], a[236:239], v[216:219], v[172:175]
  v_mfma_f32_16x16x32_bf16 v[172:175], a[252:255], v[220:223], v[172:175]
  s_waitcnt lgkmcnt(0)
  v_mfma_f32_16x16x32_bf16 v[144:147], a[192:195], v[192:195], v[144:147]
  ds_read_b64_tr_b16 v[208:209], v229 offset:256
  ds_read_b64_tr_b16 v[210:211], v229 offset:768
  v_mfma_f32_16x16x32_bf16 v[144:147], a[208:211], v[196:199], v[144:147]
  buffer_load_dwordx4 v254, s[20:23], s46 offen offset:2048 nt lds
  v_mfma_f32_16x16x32_bf16 v[144:147], a[224:227], v[200:203], v[144:147]
  ds_read_b64_tr_b16 v[212:213], v229 offset:4352
  v_mfma_f32_16x16x32_bf16 v[144:147], a[240:243], v[204:207], v[144:147]
  ds_read_b64_tr_b16 v[214:215], v229 offset:4864
  v_mfma_f32_16x16x32_bf16 v[148:151], a[196:199], v[192:195], v[148:151]
  ds_read_b64_tr_b16 v[216:217], v229 offset:8448
  v_mfma_f32_16x16x32_bf16 v[148:151], a[212:215], v[196:199], v[148:151]
  ds_read_b64_tr_b16 v[218:219], v229 offset:8960
  v_mfma_f32_16x16x32_bf16 v[148:151], a[228:231], v[200:203], v[148:151]
  ds_read_b64_tr_b16 v[220:221], v229 offset:12544
  v_mfma_f32_16x16x32_bf16 v[148:151], a[244:247], v[204:207], v[148:151]
  ds_read_b64_tr_b16 v[222:223], v229 offset:13056
  v_mfma_f32_16x16x32_bf16 v[176:179], a[200:203], v[192:195], v[176:179]
  v_mfma_f32_16x16x32_bf16 v[176:179], a[216:219], v[196:199], v[176:179]
  buffer_load_dwordx4 v255, s[20:23], s46 offen offset:3072 nt lds
  v_mfma_f32_16x16x32_bf16 v[176:179], a[232:235], v[200:203], v[176:179]
  v_mfma_f32_16x16x32_bf16 v[176:179], a[248:251], v[204:207], v[176:179]
  v_mfma_f32_16x16x32_bf16 v[180:183], a[204:207], v[192:195], v[180:183]
  v_mfma_f32_16x16x32_bf16 v[180:183], a[220:223], v[196:199], v[180:183]
  v_mfma_f32_16x16x32_bf16 v[180:183], a[236:239], v[200:203], v[180:183]
  v_mfma_f32_16x16x32_bf16 v[180:183], a[252:255], v[204:207], v[180:183]
  s_waitcnt lgkmcnt(0)
  buffer_store_dwordx4 v[108:111], v225, s[24:27], s55 offen offset:1024 sc1
  v_mfma_f32_16x16x32_bf16 v[152:155], a[192:195], v[208:211], v[152:155]
  s_waitcnt vmcnt(10)
  s_barrier
  s_add_u32 m0, s49, 65536
  s_add_u32 s46, s54, 3145856
  ds_read_b64_tr_b16 v[192:193], v228 offset:16384
  ds_read_b64_tr_b16 v[194:195], v228 offset:16896
  v_mfma_f32_16x16x32_bf16 v[152:155], a[208:211], v[212:215], v[152:155]
  buffer_load_dwordx4 v252, s[20:23], s46 offen offset:0 nt lds
  v_mfma_f32_16x16x32_bf16 v[152:155], a[224:227], v[216:219], v[152:155]
  ds_read_b64_tr_b16 v[196:197], v228 offset:20480
  v_mfma_f32_16x16x32_bf16 v[152:155], a[240:243], v[220:223], v[152:155]
  ds_read_b64_tr_b16 v[198:199], v228 offset:20992
  v_mfma_f32_16x16x32_bf16 v[156:159], a[196:199], v[208:211], v[156:159]
  ds_read_b64_tr_b16 v[200:201], v228 offset:24576
  v_mfma_f32_16x16x32_bf16 v[156:159], a[212:215], v[212:215], v[156:159]
  ds_read_b64_tr_b16 v[202:203], v228 offset:25088
  v_mfma_f32_16x16x32_bf16 v[156:159], a[228:231], v[216:219], v[156:159]
  ds_read_b64_tr_b16 v[204:205], v228 offset:28672
  v_mfma_f32_16x16x32_bf16 v[156:159], a[244:247], v[220:223], v[156:159]
  ds_read_b64_tr_b16 v[206:207], v228 offset:29184
  v_mfma_f32_16x16x32_bf16 v[184:187], a[200:203], v[208:211], v[184:187]
  v_mfma_f32_16x16x32_bf16 v[184:187], a[216:219], v[212:215], v[184:187]
  buffer_load_dwordx4 v253, s[20:23], s46 offen offset:1024 nt lds
  v_mfma_f32_16x16x32_bf16 v[184:187], a[232:235], v[216:219], v[184:187]
  v_mfma_f32_16x16x32_bf16 v[184:187], a[248:251], v[220:223], v[184:187]
  v_mfma_f32_16x16x32_bf16 v[188:191], a[204:207], v[208:211], v[188:191]
  v_mfma_f32_16x16x32_bf16 v[188:191], a[220:223], v[212:215], v[188:191]
  v_mfma_f32_16x16x32_bf16 v[188:191], a[236:239], v[216:219], v[188:191]
  v_mfma_f32_16x16x32_bf16 v[188:191], a[252:255], v[220:223], v[188:191]
  s_waitcnt lgkmcnt(0)
  v_mfma_f32_16x16x32_bf16 v[0:3], a[128:131], v[192:195], 0
  ds_read_b64_tr_b16 v[208:209], v229 offset:16384
  ds_read_b64_tr_b16 v[210:211], v229 offset:16896
  v_mfma_f32_16x16x32_bf16 v[0:3], a[144:147], v[196:199], v[0:3]
  buffer_load_dwordx4 v254, s[20:23], s46 offen offset:2048 nt lds
  v_mfma_f32_16x16x32_bf16 v[0:3], a[160:163], v[200:203], v[0:3]
  ds_read_b64_tr_b16 v[212:213], v229 offset:20480
  ds_read_b64_tr_b16 v[214:215], v229 offset:20992
  v_mfma_f32_16x16x32_bf16 v[0:3], a[176:179], v[204:207], v[0:3]
  buffer_store_dwordx4 v[112:115], v225, s[24:27], s57 offen offset:2048 sc1
  v_mfma_f32_16x16x32_bf16 v[4:7], a[132:135], v[192:195], 0
  ds_read_b64_tr_b16 v[216:217], v229 offset:24576
  v_mfma_f32_16x16x32_bf16 v[4:7], a[148:151], v[196:199], v[4:7]
  ds_read_b64_tr_b16 v[218:219], v229 offset:25088
  v_mfma_f32_16x16x32_bf16 v[4:7], a[164:167], v[200:203], v[4:7]
  ds_read_b64_tr_b16 v[220:221], v229 offset:28672
  v_mfma_f32_16x16x32_bf16 v[4:7], a[180:183], v[204:207], v[4:7]
  ds_read_b64_tr_b16 v[222:223], v229 offset:29184
  v_mfma_f32_16x16x32_bf16 v[32:35], a[136:139], v[192:195], 0
  v_mfma_f32_16x16x32_bf16 v[32:35], a[152:155], v[196:199], v[32:35]
  buffer_load_dwordx4 v255, s[20:23], s46 offen offset:3072 nt lds
  v_mfma_f32_16x16x32_bf16 v[32:35], a[168:171], v[200:203], v[32:35]
  v_mfma_f32_16x16x32_bf16 v[32:35], a[184:187], v[204:207], v[32:35]
  v_mfma_f32_16x16x32_bf16 v[36:39], a[140:143], v[192:195], 0
  v_mfma_f32_16x16x32_bf16 v[36:39], a[156:159], v[196:199], v[36:39]
  v_mfma_f32_16x16x32_bf16 v[36:39], a[172:175], v[200:203], v[36:39]
  v_mfma_f32_16x16x32_bf16 v[36:39], a[188:191], v[204:207], v[36:39]
  s_waitcnt lgkmcnt(0)
  v_mfma_f32_16x16x32_bf16 v[8:11], a[128:131], v[208:211], 0
  ds_read_b64_tr_b16 v[192:193], v228 offset:16640
  v_cvt_pk_bf16_f32 v128, v128, v129
  v_mfma_f32_16x16x32_bf16 v[8:11], a[144:147], v[212:215], v[8:11]
  ds_read_b64_tr_b16 v[194:195], v228 offset:17152
  v_cvt_pk_bf16_f32 v129, v130, v131
  v_mfma_f32_16x16x32_bf16 v[8:11], a[160:163], v[216:219], v[8:11]
  ds_read_b64_tr_b16 v[196:197], v228 offset:20736
  v_cvt_pk_bf16_f32 v130, v132, v133
  v_mfma_f32_16x16x32_bf16 v[8:11], a[176:179], v[220:223], v[8:11]
  ds_read_b64_tr_b16 v[198:199], v228 offset:21248
  v_cvt_pk_bf16_f32 v131, v134, v135
  v_mfma_f32_16x16x32_bf16 v[12:15], a[132:135], v[208:211], 0
  ds_read_b64_tr_b16 v[200:201], v228 offset:24832
  v_cvt_pk_bf16_f32 v136, v136, v137
  v_mfma_f32_16x16x32_bf16 v[12:15], a[148:151], v[212:215], v[12:15]
  ds_read_b64_tr_b16 v[202:203], v228 offset:25344
  v_cvt_pk_bf16_f32 v137, v138, v139
  v_mfma_f32_16x16x32_bf16 v[12:15], a[164:167], v[216:219], v[12:15]
  ds_read_b64_tr_b16 v[204:205], v228 offset:28928
  ds_read_b64_tr_b16 v[206:207], v228 offset:29440
  v_mfma_f32_16x16x32_bf16 v[12:15], a[180:183], v[220:223], v[12:15]
  buffer_store_dwordx4 v[116:119], v225, s[24:27], s55 offen offset:2048 sc1
  v_mfma_f32_16x16x32_bf16 v[40:43], a[136:139], v[208:211], 0
  v_cvt_pk_bf16_f32 v138, v140, v141
  v_cvt_pk_bf16_f32 v139, v142, v143
  v_mfma_f32_16x16x32_bf16 v[40:43], a[152:155], v[212:215], v[40:43]
  v_cvt_pk_bf16_f32 v144, v144, v145
  v_mfma_f32_16x16x32_bf16 v[40:43], a[168:171], v[216:219], v[40:43]
  v_cvt_pk_bf16_f32 v145, v146, v147
  v_cvt_pk_bf16_f32 v146, v148, v149
  v_mfma_f32_16x16x32_bf16 v[40:43], a[184:187], v[220:223], v[40:43]
  v_cvt_pk_bf16_f32 v147, v150, v151
  v_mfma_f32_16x16x32_bf16 v[44:47], a[140:143], v[208:211], 0
  v_cvt_pk_bf16_f32 v152, v152, v153
  v_cvt_pk_bf16_f32 v153, v154, v155
  v_mfma_f32_16x16x32_bf16 v[44:47], a[156:159], v[212:215], v[44:47]
  v_cvt_pk_bf16_f32 v154, v156, v157
  v_mfma_f32_16x16x32_bf16 v[44:47], a[172:175], v[216:219], v[44:47]
  v_cvt_pk_bf16_f32 v155, v158, v159
  v_cvt_pk_bf16_f32 v160, v160, v161
  v_mfma_f32_16x16x32_bf16 v[44:47], a[188:191], v[220:223], v[44:47]
  s_waitcnt lgkmcnt(0)
  v_cvt_pk_bf16_f32 v161, v162, v163
  v_mfma_f32_16x16x32_bf16 v[16:19], a[128:131], v[192:195], 0
  ds_read_b64_tr_b16 v[208:209], v229 offset:16640
  v_cvt_pk_bf16_f32 v162, v164, v165
  v_mfma_f32_16x16x32_bf16 v[16:19], a[144:147], v[196:199], v[16:19]
  ds_read_b64_tr_b16 v[210:211], v229 offset:17152
  v_cvt_pk_bf16_f32 v163, v166, v167
  v_mfma_f32_16x16x32_bf16 v[16:19], a[160:163], v[200:203], v[16:19]
  ds_read_b64_tr_b16 v[212:213], v229 offset:20736
  v_cvt_pk_bf16_f32 v168, v168, v169
  v_mfma_f32_16x16x32_bf16 v[16:19], a[176:179], v[204:207], v[16:19]
  ds_read_b64_tr_b16 v[214:215], v229 offset:21248
  v_cvt_pk_bf16_f32 v169, v170, v171
  v_mfma_f32_16x16x32_bf16 v[20:23], a[132:135], v[192:195], 0
  ds_read_b64_tr_b16 v[216:217], v229 offset:24832
  v_cvt_pk_bf16_f32 v170, v172, v173
  v_mfma_f32_16x16x32_bf16 v[20:23], a[148:151], v[196:199], v[20:23]
  ds_read_b64_tr_b16 v[218:219], v229 offset:25344
  v_cvt_pk_bf16_f32 v171, v174, v175
  v_mfma_f32_16x16x32_bf16 v[20:23], a[164:167], v[200:203], v[20:23]
  ds_read_b64_tr_b16 v[220:221], v229 offset:28928
  v_cvt_pk_bf16_f32 v176, v176, v177
  v_mfma_f32_16x16x32_bf16 v[20:23], a[180:183], v[204:207], v[20:23]
  ds_read_b64_tr_b16 v[222:223], v229 offset:29440
  v_cvt_pk_bf16_f32 v177, v178, v179
  v_mfma_f32_16x16x32_bf16 v[48:51], a[136:139], v[192:195], 0
  v_cvt_pk_bf16_f32 v178, v180, v181
  v_cvt_pk_bf16_f32 v179, v182, v183
  v_mfma_f32_16x16x32_bf16 v[48:51], a[152:155], v[196:199], v[48:51]
  buffer_store_dwordx4 v[120:123], v225, s[24:27], s57 offen offset:3072 sc1
  v_mfma_f32_16x16x32_bf16 v[48:51], a[168:171], v[200:203], v[48:51]
  v_cvt_pk_bf16_f32 v184, v184, v185
  v_cvt_pk_bf16_f32 v185, v186, v187
  v_mfma_f32_16x16x32_bf16 v[48:51], a[184:187], v[204:207], v[48:51]
  v_cvt_pk_bf16_f32 v186, v188, v189
  v_mfma_f32_16x16x32_bf16 v[52:55], a[140:143], v[192:195], 0
  v_cvt_pk_bf16_f32 v187, v190, v191
  v_mfma_f32_16x16x32_bf16 v[52:55], a[156:159], v[196:199], v[52:55]
  v_mfma_f32_16x16x32_bf16 v[52:55], a[172:175], v[200:203], v[52:55]
  v_mfma_f32_16x16x32_bf16 v[52:55], a[188:191], v[204:207], v[52:55]
  s_waitcnt lgkmcnt(0)
  v_mfma_f32_16x16x32_bf16 v[24:27], a[128:131], v[208:211], 0
  ds_read_b64_tr_b16 v[192:193], v228 offset:32768
  v_mfma_f32_16x16x32_bf16 v[24:27], a[144:147], v[212:215], v[24:27]
  ds_read_b64_tr_b16 v[194:195], v228 offset:33280
  v_mfma_f32_16x16x32_bf16 v[24:27], a[160:163], v[216:219], v[24:27]
  ds_read_b64_tr_b16 v[196:197], v228 offset:36864
  v_mfma_f32_16x16x32_bf16 v[24:27], a[176:179], v[220:223], v[24:27]
  ds_read_b64_tr_b16 v[198:199], v228 offset:37376
  v_mfma_f32_16x16x32_bf16 v[28:31], a[132:135], v[208:211], 0
  ds_read_b64_tr_b16 v[200:201], v228 offset:40960
  v_mfma_f32_16x16x32_bf16 v[28:31], a[148:151], v[212:215], v[28:31]
  ds_read_b64_tr_b16 v[202:203], v228 offset:41472
  v_mfma_f32_16x16x32_bf16 v[28:31], a[164:167], v[216:219], v[28:31]
  ds_read_b64_tr_b16 v[204:205], v228 offset:45056
  v_mfma_f32_16x16x32_bf16 v[28:31], a[180:183], v[220:223], v[28:31]
  ds_read_b64_tr_b16 v[206:207], v228 offset:45568
  v_mfma_f32_16x16x32_bf16 v[56:59], a[136:139], v[208:211], 0
  s_lshl_b32 s51, s7, 5
  s_add_u32 s51, s51, s6
  s_lshl_b32 s51, s51, 10
  v_and_b32 v246, 31, v224
  v_lshl_add_u32 v246, v246, 2, s51
  buffer_load_dword v247, v246, s[8:11], 0 offen offset:512 sc1
  v_mfma_f32_16x16x32_bf16 v[56:59], a[152:155], v[212:215], v[56:59]
  v_mfma_f32_16x16x32_bf16 v[56:59], a[168:171], v[216:219], v[56:59]
  v_mfma_f32_16x16x32_bf16 v[56:59], a[184:187], v[220:223], v[56:59]
  v_mfma_f32_16x16x32_bf16 v[60:63], a[140:143], v[208:211], 0
  v_mfma_f32_16x16x32_bf16 v[60:63], a[156:159], v[212:215], v[60:63]
  buffer_store_dwordx4 v[124:127], v225, s[24:27], s55 offen offset:3072 sc1
  v_mfma_f32_16x16x32_bf16 v[60:63], a[172:175], v[216:219], v[60:63]
  v_mfma_f32_16x16x32_bf16 v[60:63], a[188:191], v[220:223], v[60:63]
  s_waitcnt lgkmcnt(0)
  v_mfma_f32_16x16x32_bf16 v[0:3], a[0:3], v[192:195], v[0:3]
  s_add_u32 m0, s48, 131072
  s_add_u32 s46, s54, 0
  ds_read_b64_tr_b16 v[208:209], v229 offset:32768
  ds_read_b64_tr_b16 v[210:211], v229 offset:33280
  v_mfma_f32_16x16x32_bf16 v[0:3], a[16:19], v[196:199], v[0:3]
  buffer_load_dwordx4 v248, s[40:43], s46 offen offset:0 nt lds
  v_mfma_f32_16x16x32_bf16 v[0:3], a[32:35], v[200:203], v[0:3]
  ds_read_b64_tr_b16 v[212:213], v229 offset:36864
  v_mfma_f32_16x16x32_bf16 v[0:3], a[48:51], v[204:207], v[0:3]
  ds_read_b64_tr_b16 v[214:215], v229 offset:37376
  v_mfma_f32_16x16x32_bf16 v[4:7], a[4:7], v[192:195], v[4:7]
  ds_read_b64_tr_b16 v[216:217], v229 offset:40960
  v_mfma_f32_16x16x32_bf16 v[4:7], a[20:23], v[196:199], v[4:7]
  ds_read_b64_tr_b16 v[218:219], v229 offset:41472
  v_mfma_f32_16x16x32_bf16 v[4:7], a[36:39], v[200:203], v[4:7]
  ds_read_b64_tr_b16 v[220:221], v229 offset:45056
  ds_read_b64_tr_b16 v[222:223], v229 offset:45568
  v_mfma_f32_16x16x32_bf16 v[4:7], a[52:55], v[204:207], v[4:7]
  buffer_load_dwordx4 v249, s[40:43], s46 offen offset:1024 nt lds
  v_mfma_f32_16x16x32_bf16 v[32:35], a[8:11], v[192:195], v[32:35]
  v_mfma_f32_16x16x32_bf16 v[32:35], a[24:27], v[196:199], v[32:35]
  v_mfma_f32_16x16x32_bf16 v[32:35], a[40:43], v[200:203], v[32:35]
  v_mfma_f32_16x16x32_bf16 v[32:35], a[56:59], v[204:207], v[32:35]
  v_mfma_f32_16x16x32_bf16 v[36:39], a[12:15], v[192:195], v[36:39]
  v_mfma_f32_16x16x32_bf16 v[36:39], a[28:31], v[196:199], v[36:39]
  v_mfma_f32_16x16x32_bf16 v[36:39], a[44:47], v[200:203], v[36:39]
  v_mfma_f32_16x16x32_bf16 v[36:39], a[60:63], v[204:207], v[36:39]
  s_waitcnt lgkmcnt(0)
  buffer_load_dwordx4 v250, s[40:43], s46 offen offset:2048 nt lds
  v_mfma_f32_16x16x32_bf16 v[8:11], a[0:3], v[208:211], v[8:11]
  ds_read_b64_tr_b16 v[192:193], v228 offset:33024
  ds_read_b64_tr_b16 v[194:195], v228 offset:33536
  v_mfma_f32_16x16x32_bf16 v[8:11], a[16:19], v[212:215], v[8:11]
  buffer_store_dwordx4 v[128:131], v225, s[28:31], 0 offen offset:0 sc1
  v_mfma_f32_16x16x32_bf16 v[8:11], a[32:35], v[216:219], v[8:11]
  ds_read_b64_tr_b16 v[196:197], v228 offset:37120
  v_mfma_f32_16x16x32_bf16 v[8:11], a[48:51], v[220:223], v[8:11]
  ds_read_b64_tr_b16 v[198:199], v228 offset:37632
  v_mfma_f32_16x16x32_bf16 v[12:15], a[4:7], v[208:211], v[12:15]
  ds_read_b64_tr_b16 v[200:201], v228 offset:41216
  ds_read_b64_tr_b16 v[202:203], v228 offset:41728
  v_mfma_f32_16x16x32_bf16 v[12:15], a[20:23], v[212:215], v[12:15]
  buffer_load_dwordx4 v251, s[40:43], s46 offen offset:3072 nt lds
  v_mfma_f32_16x16x32_bf16 v[12:15], a[36:39], v[216:219], v[12:15]
  ds_read_b64_tr_b16 v[204:205], v228 offset:45312
  v_mfma_f32_16x16x32_bf16 v[12:15], a[52:55], v[220:223], v[12:15]
  ds_read_b64_tr_b16 v[206:207], v228 offset:45824
  v_mfma_f32_16x16x32_bf16 v[40:43], a[8:11], v[208:211], v[40:43]
  v_mfma_f32_16x16x32_bf16 v[40:43], a[24:27], v[212:215], v[40:43]
  v_mfma_f32_16x16x32_bf16 v[40:43], a[40:43], v[216:219], v[40:43]
  v_mfma_f32_16x16x32_bf16 v[40:43], a[56:59], v[220:223], v[40:43]
  v_mfma_f32_16x16x32_bf16 v[44:47], a[12:15], v[208:211], v[44:47]
  s_add_u32 m0, s48, 135168
  s_add_u32 s46, s54, 131072
  v_mfma_f32_16x16x32_bf16 v[44:47], a[28:31], v[212:215], v[44:47]
  buffer_load_dwordx4 v248, s[40:43], s46 offen offset:0 nt lds
  v_mfma_f32_16x16x32_bf16 v[44:47], a[44:47], v[216:219], v[44:47]
  v_mfma_f32_16x16x32_bf16 v[44:47], a[60:63], v[220:223], v[44:47]
  s_waitcnt lgkmcnt(0)
  v_mfma_f32_16x16x32_bf16 v[16:19], a[0:3], v[192:195], v[16:19]
  ds_read_b64_tr_b16 v[208:209], v229 offset:33024
  v_mfma_f32_16x16x32_bf16 v[16:19], a[16:19], v[196:199], v[16:19]
  ds_read_b64_tr_b16 v[210:211], v229 offset:33536
  v_mfma_f32_16x16x32_bf16 v[16:19], a[32:35], v[200:203], v[16:19]
  ds_read_b64_tr_b16 v[212:213], v229 offset:37120
  ds_read_b64_tr_b16 v[214:215], v229 offset:37632
  v_mfma_f32_16x16x32_bf16 v[16:19], a[48:51], v[204:207], v[16:19]
  buffer_load_dwordx4 v249, s[40:43], s46 offen offset:1024 nt lds
  v_mfma_f32_16x16x32_bf16 v[20:23], a[4:7], v[192:195], v[20:23]
  ds_read_b64_tr_b16 v[216:217], v229 offset:41216
  ds_read_b64_tr_b16 v[218:219], v229 offset:41728
  v_mfma_f32_16x16x32_bf16 v[20:23], a[20:23], v[196:199], v[20:23]
  buffer_store_dwordx4 v[136:139], v225, s[28:31], 0 offen offset:1024 sc1
  v_mfma_f32_16x16x32_bf16 v[20:23], a[36:39], v[200:203], v[20:23]
  ds_read_b64_tr_b16 v[220:221], v229 offset:45312
  v_mfma_f32_16x16x32_bf16 v[20:23], a[52:55], v[204:207], v[20:23]
  ds_read_b64_tr_b16 v[222:223], v229 offset:45824
  v_mfma_f32_16x16x32_bf16 v[48:51], a[8:11], v[192:195], v[48:51]
  v_mfma_f32_16x16x32_bf16 v[48:51], a[24:27], v[196:199], v[48:51]
  v_mfma_f32_16x16x32_bf16 v[48:51], a[40:43], v[200:203], v[48:51]
  v_mfma_f32_16x16x32_bf16 v[48:51], a[56:59], v[204:207], v[48:51]
  buffer_load_dwordx4 v250, s[40:43], s46 offen offset:2048 nt lds
  v_mfma_f32_16x16x32_bf16 v[52:55], a[12:15], v[192:195], v[52:55]
  v_mfma_f32_16x16x32_bf16 v[52:55], a[28:31], v[196:199], v[52:55]
  v_mfma_f32_16x16x32_bf16 v[52:55], a[44:47], v[200:203], v[52:55]
  v_mfma_f32_16x16x32_bf16 v[52:55], a[60:63], v[204:207], v[52:55]
  s_waitcnt lgkmcnt(0)
  v_mfma_f32_16x16x32_bf16 v[24:27], a[0:3], v[208:211], v[24:27]
  s_waitcnt vmcnt(13)
  s_barrier
  ds_read_b64_tr_b16 v[192:193], v228 offset:49152
  ds_read_b64_tr_b16 v[194:195], v228 offset:49664
  v_mfma_f32_16x16x32_bf16 v[24:27], a[16:19], v[212:215], v[24:27]
  buffer_load_dwordx4 v251, s[40:43], s46 offen offset:3072 nt lds
  v_mfma_f32_16x16x32_bf16 v[24:27], a[32:35], v[216:219], v[24:27]
  ds_read_b64_tr_b16 v[196:197], v228 offset:53248
  v_mfma_f32_16x16x32_bf16 v[24:27], a[48:51], v[220:223], v[24:27]
  ds_read_b64_tr_b16 v[198:199], v228 offset:53760
  v_mfma_f32_16x16x32_bf16 v[28:31], a[4:7], v[208:211], v[28:31]
  ds_read_b64_tr_b16 v[200:201], v228 offset:57344
  v_mfma_f32_16x16x32_bf16 v[28:31], a[20:23], v[212:215], v[28:31]
  ds_read_b64_tr_b16 v[202:203], v228 offset:57856
  v_mfma_f32_16x16x32_bf16 v[28:31], a[36:39], v[216:219], v[28:31]
  ds_read_b64_tr_b16 v[204:205], v228 offset:61440
  ds_read_b64_tr_b16 v[206:207], v228 offset:61952
  v_mfma_f32_16x16x32_bf16 v[28:31], a[52:55], v[220:223], v[28:31]
  buffer_store_dwordx4 v[144:147], v225, s[28:31], 0 offen offset:2048 sc1
  v_mfma_f32_16x16x32_bf16 v[56:59], a[8:11], v[208:211], v[56:59]
  v_mfma_f32_16x16x32_bf16 v[56:59], a[24:27], v[212:215], v[56:59]
  v_mfma_f32_16x16x32_bf16 v[56:59], a[40:43], v[216:219], v[56:59]
  v_mfma_f32_16x16x32_bf16 v[56:59], a[56:59], v[220:223], v[56:59]
  v_mfma_f32_16x16x32_bf16 v[60:63], a[12:15], v[208:211], v[60:63]
  s_waitcnt vmcnt(12)
  v_cmp_eq_u32 vcc, 0, v247
  s_cbranch_vccnz L_adaL_spin_10
L_adaL_spun_11:
  v_mfma_f32_16x16x32_bf16 v[60:63], a[28:31], v[212:215], v[60:63]
  v_mfma_f32_16x16x32_bf16 v[60:63], a[44:47], v[216:219], v[60:63]
  v_mfma_f32_16x16x32_bf16 v[60:63], a[60:63], v[220:223], v[60:63]
  s_waitcnt lgkmcnt(0)
  v_mfma_f32_16x16x32_bf16 v[0:3], a[64:67], v[192:195], v[0:3]
  ds_read_b64_tr_b16 v[208:209], v229 offset:49152
  v_mfma_f32_16x16x32_bf16 v[0:3], a[80:83], v[196:199], v[0:3]
  ds_read_b64_tr_b16 v[210:211], v229 offset:49664
  v_mfma_f32_16x16x32_bf16 v[0:3], a[96:99], v[200:203], v[0:3]
  ds_read_b64_tr_b16 v[212:213], v229 offset:53248
  v_mfma_f32_16x16x32_bf16 v[0:3], a[112:115], v[204:207], v[0:3]
  ds_read_b64_tr_b16 v[214:215], v229 offset:53760
  v_mfma_f32_16x16x32_bf16 v[4:7], a[68:71], v[192:195], v[4:7]
  ds_read_b64_tr_b16 v[216:217], v229 offset:57344
  v_mfma_f32_16x16x32_bf16 v[4:7], a[84:87], v[196:199], v[4:7]
  ds_read_b64_tr_b16 v[218:219], v229 offset:57856
  v_mfma_f32_16x16x32_bf16 v[4:7], a[100:103], v[200:203], v[4:7]
  ds_read_b64_tr_b16 v[220:221], v229 offset:61440
  v_mfma_f32_16x16x32_bf16 v[4:7], a[116:119], v[204:207], v[4:7]
  ds_read_b64_tr_b16 v[222:223], v229 offset:61952
  v_mfma_f32_16x16x32_bf16 v[32:35], a[72:75], v[192:195], v[32:35]
  v_mfma_f32_16x16x32_bf16 v[32:35], a[88:91], v[196:199], v[32:35]
  v_mfma_f32_16x16x32_bf16 v[32:35], a[104:107], v[200:203], v[32:35]
  s_add_u32 m0, s48, 98304
  s_add_u32 s46, s54, 1048576
  v_mfma_f32_16x16x32_bf16 v[32:35], a[120:123], v[204:207], v[32:35]
  buffer_load_dwordx4 v248, s[40:43], s46 offen offset:0 nt lds
  v_mfma_f32_16x16x32_bf16 v[36:39], a[76:79], v[192:195], v[36:39]
  v_mfma_f32_16x16x32_bf16 v[36:39], a[92:95], v[196:199], v[36:39]
  buffer_store_dwordx4 v[152:155], v225, s[28:31], 0 offen offset:3072 sc1
  v_mfma_f32_16x16x32_bf16 v[36:39], a[108:111], v[200:203], v[36:39]
  v_mfma_f32_16x16x32_bf16 v[36:39], a[124:127], v[204:207], v[36:39]
  s_waitcnt lgkmcnt(0)
  v_mfma_f32_16x16x32_bf16 v[8:11], a[64:67], v[208:211], v[8:11]
  ds_read_b64_tr_b16 v[192:193], v228 offset:49408
  v_mfma_f32_16x16x32_bf16 v[8:11], a[80:83], v[212:215], v[8:11]
  ds_read_b64_tr_b16 v[194:195], v228 offset:49920
  v_mfma_f32_16x16x32_bf16 v[8:11], a[96:99], v[216:219], v[8:11]
  ds_read_b64_tr_b16 v[196:197], v228 offset:53504
  v_mfma_f32_16x16x32_bf16 v[8:11], a[112:115], v[220:223], v[8:11]
  ds_read_b64_tr_b16 v[198:199], v228 offset:54016
  v_mfma_f32_16x16x32_bf16 v[12:15], a[68:71], v[208:211], v[12:15]
  ds_read_b64_tr_b16 v[200:201], v228 offset:57600
  v_mfma_f32_16x16x32_bf16 v[12:15], a[84:87], v[212:215], v[12:15]
  ds_read_b64_tr_b16 v[202:203], v228 offset:58112
  v_mfma_f32_16x16x32_bf16 v[12:15], a[100:103], v[216:219], v[12:15]
  s_mov_b32 s58, 0
  ds_read_b64_tr_b16 v[204:205], v228 offset:61696
  ds_read_b64_tr_b16 v[206:207], v228 offset:62208
  v_mfma_f32_16x16x32_bf16 v[12:15], a[116:119], v[220:223], v[12:15]
  buffer_load_dwordx4 a[128:131], v225, s[32:35], s58 offen offset:0 sc1
  v_mfma_f32_16x16x32_bf16 v[40:43], a[72:75], v[208:211], v[40:43]
  v_mfma_f32_16x16x32_bf16 v[40:43], a[88:91], v[212:215], v[40:43]
  v_mfma_f32_16x16x32_bf16 v[40:43], a[104:107], v[216:219], v[40:43]
  v_mfma_f32_16x16x32_bf16 v[40:43], a[120:123], v[220:223], v[40:43]
  buffer_load_dwordx4 v249, s[40:43], s46 offen offset:1024 nt lds
  v_mfma_f32_16x16x32_bf16 v[44:47], a[76:79], v[208:211], v[44:47]
  v_mfma_f32_16x16x32_bf16 v[44:47], a[92:95], v[212:215], v[44:47]
  buffer_store_dwordx4 v[160:163], v225, s[28:31], s56 offen offset:0 sc1
  v_mfma_f32_16x16x32_bf16 v[44:47], a[108:111], v[216:219], v[44:47]
  v_mfma_f32_16x16x32_bf16 v[44:47], a[124:127], v[220:223], v[44:47]
  s_waitcnt lgkmcnt(0)
  buffer_load_dwordx4 a[136:139], v225, s[32:35], s58 offen offset:1024 sc1
  v_mfma_f32_16x16x32_bf16 v[16:19], a[64:67], v[192:195], v[16:19]
  ds_read_b64_tr_b16 v[208:209], v229 offset:49408
  v_mfma_f32_16x16x32_bf16 v[16:19], a[80:83], v[196:199], v[16:19]
  ds_read_b64_tr_b16 v[210:211], v229 offset:49920
  v_mfma_f32_16x16x32_bf16 v[16:19], a[96:99], v[200:203], v[16:19]
  ds_read_b64_tr_b16 v[212:213], v229 offset:53504
  v_mfma_f32_16x16x32_bf16 v[16:19], a[112:115], v[204:207], v[16:19]
  ds_read_b64_tr_b16 v[214:215], v229 offset:54016
  v_mfma_f32_16x16x32_bf16 v[20:23], a[68:71], v[192:195], v[20:23]
  ds_read_b64_tr_b16 v[216:217], v229 offset:57600
  v_mfma_f32_16x16x32_bf16 v[20:23], a[84:87], v[196:199], v[20:23]
  ds_read_b64_tr_b16 v[218:219], v229 offset:58112
  v_mfma_f32_16x16x32_bf16 v[20:23], a[100:103], v[200:203], v[20:23]
  ds_read_b64_tr_b16 v[220:221], v229 offset:61696
  ds_read_b64_tr_b16 v[222:223], v229 offset:62208
  v_mfma_f32_16x16x32_bf16 v[20:23], a[116:119], v[204:207], v[20:23]
  buffer_load_dwordx4 a[132:135], v225, s[36:39], s58 offen offset:0 sc1
  v_mfma_f32_16x16x32_bf16 v[48:51], a[72:75], v[192:195], v[48:51]
  v_mfma_f32_16x16x32_bf16 v[48:51], a[88:91], v[196:199], v[48:51]
  v_mfma_f32_16x16x32_bf16 v[48:51], a[104:107], v[200:203], v[48:51]
  v_mfma_f32_16x16x32_bf16 v[48:51], a[120:123], v[204:207], v[48:51]
  buffer_load_dwordx4 v250, s[40:43], s46 offen offset:2048 nt lds
  v_mfma_f32_16x16x32_bf16 v[52:55], a[76:79], v[192:195], v[52:55]
  v_mfma_f32_16x16x32_bf16 v[52:55], a[92:95], v[196:199], v[52:55]
  v_mfma_f32_16x16x32_bf16 v[52:55], a[108:111], v[200:203], v[52:55]
  v_mfma_f32_16x16x32_bf16 v[52:55], a[124:127], v[204:207], v[52:55]
  s_waitcnt lgkmcnt(0)
  buffer_load_dwordx4 a[140:143], v225, s[36:39], s58 offen offset:1024 sc1
  v_mfma_f32_16x16x32_bf16 v[24:27], a[64:67], v[208:211], v[24:27]
  ds_read_b64_tr_b16 v[192:193], v232 offset:0
  ds_read_b64_tr_b16 v[194:195], v232 offset:512
  v_mfma_f32_16x16x32_bf16 v[24:27], a[80:83], v[212:215], v[24:27]
  buffer_store_dwordx4 v[168:171], v225, s[28:31], s56 offen offset:1024 sc1
  v_mfma_f32_16x16x32_bf16 v[24:27], a[96:99], v[216:219], v[24:27]
  ds_read_b64_tr_b16 v[196:197], v232 offset:4096
  v_mfma_f32_16x16x32_bf16 v[24:27], a[112:115], v[220:223], v[24:27]
  ds_read_b64_tr_b16 v[198:199], v232 offset:4608
  v_mfma_f32_16x16x32_bf16 v[28:31], a[68:71], v[208:211], v[28:31]
  ds_read_b64_tr_b16 v[200:201], v232 offset:8192
  v_mfma_f32_16x16x32_bf16 v[28:31], a[84:87], v[212:215], v[28:31]
  ds_read_b64_tr_b16 v[202:203], v232 offset:8704
  v_mfma_f32_16x16x32_bf16 v[28:31], a[100:103], v[216:219], v[28:31]
  ds_read_b64_tr_b16 v[204:205], v232 offset:12288
  ds_read_b64_tr_b16 v[206:207], v232 offset:12800
  v_mfma_f32_16x16x32_bf16 v[28:31], a[116:119], v[220:223], v[28:31]
  buffer_load_dwordx4 a[144:147], v225, s[32:35], s58 offen offset:2048 sc1
  v_mfma_f32_16x16x32_bf16 v[56:59], a[72:75], v[208:211], v[56:59]
  v_mfma_f32_16x16x32_bf16 v[56:59], a[88:91], v[212:215], v[56:59]
  v_mfma_f32_16x16x32_bf16 v[56:59], a[104:107], v[216:219], v[56:59]
  v_mfma_f32_16x16x32_bf16 v[56:59], a[120:123], v[220:223], v[56:59]
  buffer_load_dwordx4 v251, s[40:43], s46 offen offset:3072 nt lds
  v_mfma_f32_16x16x32_bf16 v[60:63], a[76:79], v[208:211], v[60:63]
  v_mfma_f32_16x16x32_bf16 v[60:63], a[92:95], v[212:215], v[60:63]
  v_mfma_f32_16x16x32_bf16 v[60:63], a[108:111], v[216:219], v[60:63]
  v_mfma_f32_16x16x32_bf16 v[60:63], a[124:127], v[220:223], v[60:63]
  s_waitcnt lgkmcnt(0)
  buffer_load_dwordx4 a[152:155], v225, s[32:35], s58 offen offset:3072 sc1
  v_mfma_f32_16x16x32_bf16 v[0:3], a[192:195], v[192:195], v[0:3]
  ds_read_b64_tr_b16 v[208:209], v233 offset:0
  v_accvgpr_write_b32 a0, 0
  v_mfma_f32_16x16x32_bf16 v[0:3], a[208:211], v[196:199], v[0:3]
  ds_read_b64_tr_b16 v[210:211], v233 offset:512
  v_accvgpr_write_b32 a1, 0
  v_mfma_f32_16x16x32_bf16 v[0:3], a[224:227], v[200:203], v[0:3]
  ds_read_b64_tr_b16 v[212:213], v233 offset:4096
  v_accvgpr_write_b32 a2, 0
  v_mfma_f32_16x16x32_bf16 v[0:3], a[240:243], v[204:207], v[0:3]
  ds_read_b64_tr_b16 v[214:215], v233 offset:4608
  v_accvgpr_write_b32 a3, 0
  v_mfma_f32_16x16x32_bf16 v[4:7], a[196:199], v[192:195], v[4:7]
  ds_read_b64_tr_b16 v[216:217], v233 offset:8192
  ds_read_b64_tr_b16 v[218:219], v233 offset:8704
  v_mfma_f32_16x16x32_bf16 v[4:7], a[212:215], v[196:199], v[4:7]
  buffer_store_dwordx4 v[176:179], v225, s[28:31], s56 offen offset:2048 sc1
  v_mfma_f32_16x16x32_bf16 v[4:7], a[228:231], v[200:203], v[4:7]
  ds_read_b64_tr_b16 v[220:221], v233 offset:12288
  ds_read_b64_tr_b16 v[222:223], v233 offset:12800
  v_mfma_f32_16x16x32_bf16 v[4:7], a[244:247], v[204:207], v[4:7]
  buffer_load_dwordx4 a[148:151], v225, s[36:39], s58 offen offset:2048 sc1
  v_mfma_f32_16x16x32_bf16 v[32:35], a[200:203], v[192:195], v[32:35]
  v_accvgpr_write_b32 a4, 0
  v_accvgpr_write_b32 a5, 0
  v_mfma_f32_16x16x32_bf16 v[32:35], a[216:219], v[196:199], v[32:35]
  v_accvgpr_write_b32 a6, 0
  v_mfma_f32_16x16x32_bf16 v[32:35], a[232:235], v[200:203], v[32:35]
  s_add_u32 m0, s48, 102400
  s_add_u32 s46, s54, 1179648
  v_accvgpr_write_b32 a7, 0
  v_accvgpr_write_b32 a8, 0
  v_mfma_f32_16x16x32_bf16 v[32:35], a[248:251], v[204:207], v[32:35]
  buffer_load_dwordx4 v248, s[40:43], s46 offen offset:0 nt lds
  v_mfma_f32_16x16x32_bf16 v[36:39], a[204:207], v[192:195], v[36:39]
  v_accvgpr_write_b32 a9, 0
  v_accvgpr_write_b32 a10, 0
  v_mfma_f32_16x16x32_bf16 v[36:39], a[220:223], v[196:199], v[36:39]
  v_accvgpr_write_b32 a11, 0
  v_mfma_f32_16x16x32_bf16 v[36:39], a[236:239], v[200:203], v[36:39]
  v_accvgpr_write_b32 a12, 0
  v_accvgpr_write_b32 a13, 0
  v_mfma_f32_16x16x32_bf16 v[36:39], a[252:255], v[204:207], v[36:39]
  s_waitcnt lgkmcnt(0)
  buffer_load_dwordx4 a[156:159], v225, s[36:39], s58 offen offset:3072 sc1
  v_mfma_f32_16x16x32_bf16 v[8:11], a[192:195], v[208:211], v[8:11]
  ds_read_b64_tr_b16 v[192:193], v232 offset:256
  v_accvgpr_write_b32 a14, 0
  v_mfma_f32_16x16x32_bf16 v[8:11], a[208:211], v[212:215], v[8:11]
  ds_read_b64_tr_b16 v[194:195], v232 offset:768
  v_accvgpr_write_b32 a15, 0
  v_mfma_f32_16x16x32_bf16 v[8:11], a[224:227], v[216:219], v[8:11]
  ds_read_b64_tr_b16 v[196:197], v232 offset:4352
  v_accvgpr_write_b32 a16, 0
  v_mfma_f32_16x16x32_bf16 v[8:11], a[240:243], v[220:223], v[8:11]
  ds_read_b64_tr_b16 v[198:199], v232 offset:4864
  v_accvgpr_write_b32 a17, 0
  v_mfma_f32_16x16x32_bf16 v[12:15], a[196:199], v[208:211], v[12:15]
  ds_read_b64_tr_b16 v[200:201], v232 offset:8448
  v_accvgpr_write_b32 a18, 0
  v_mfma_f32_16x16x32_bf16 v[12:15], a[212:215], v[212:215], v[12:15]
  ds_read_b64_tr_b16 v[202:203], v232 offset:8960
  v_accvgpr_write_b32 a19, 0
  v_mfma_f32_16x16x32_bf16 v[12:15], a[228:231], v[216:219], v[12:15]
  s_mov_b32 s58, 4096
  ds_read_b64_tr_b16 v[204:205], v232 offset:12544
  ds_read_b64_tr_b16 v[206:207], v232 offset:13056
  v_mfma_f32_16x16x32_bf16 v[12:15], a[244:247], v[220:223], v[12:15]
  buffer_load_dwordx4 a[160:163], v225, s[32:35], s58 offen offset:0 sc1
  v_mfma_f32_16x16x32_bf16 v[40:43], a[200:203], v[208:211], v[40:43]
  v_accvgpr_write_b32 a20, 0
  v_accvgpr_write_b32 a21, 0
  v_mfma_f32_16x16x32_bf16 v[40:43], a[216:219], v[212:215], v[40:43]
  buffer_store_dwordx4 v[184:187], v225, s[28:31], s56 offen offset:3072 sc1
  v_mfma_f32_16x16x32_bf16 v[40:43], a[232:235], v[216:219], v[40:43]
  v_accvgpr_write_b32 a22, 0
  v_accvgpr_write_b32 a23, 0
  v_mfma_f32_16x16x32_bf16 v[40:43], a[248:251], v[220:223], v[40:43]
  buffer_load_dwordx4 v249, s[40:43], s46 offen offset:1024 nt lds
  v_mfma_f32_16x16x32_bf16 v[44:47], a[204:207], v[208:211], v[44:47]
  v_accvgpr_write_b32 a24, 0
  v_accvgpr_write_b32 a25, 0
  v_mfma_f32_16x16x32_bf16 v[44:47], a[220:223], v[212:215], v[44:47]
  v_accvgpr_write_b32 a26, 0
  v_mfma_f32_16x16x32_bf16 v[44:47], a[236:239], v[216:219], v[44:47]
  v_accvgpr_write_b32 a27, 0
  v_accvgpr_write_b32 a28, 0
  v_mfma_f32_16x16x32_bf16 v[44:47], a[252:255], v[220:223], v[44:47]
  s_waitcnt lgkmcnt(0)
  buffer_load_dwordx4 a[168:171], v225, s[32:35], s58 offen offset:1024 sc1
  v_mfma_f32_16x16x32_bf16 v[16:19], a[192:195], v[192:195], v[16:19]
  ds_read_b64_tr_b16 v[208:209], v233 offset:256
  v_accvgpr_write_b32 a29, 0
  v_mfma_f32_16x16x32_bf16 v[16:19], a[208:211], v[196:199], v[16:19]
  ds_read_b64_tr_b16 v[210:211], v233 offset:768
  v_accvgpr_write_b32 a30, 0
  v_mfma_f32_16x16x32_bf16 v[16:19], a[224:227], v[200:203], v[16:19]
  ds_read_b64_tr_b16 v[212:213], v233 offset:4352
  v_accvgpr_write_b32 a31, 0
  v_mfma_f32_16x16x32_bf16 v[16:19], a[240:243], v[204:207], v[16:19]
  ds_read_b64_tr_b16 v[214:215], v233 offset:4864
  v_accvgpr_write_b32 a32, 0
  v_mfma_f32_16x16x32_bf16 v[20:23], a[196:199], v[192:195], v[20:23]
  ds_read_b64_tr_b16 v[216:217], v233 offset:8448
  v_accvgpr_write_b32 a33, 0
  v_mfma_f32_16x16x32_bf16 v[20:23], a[212:215], v[196:199], v[20:23]
  ds_read_b64_tr_b16 v[218:219], v233 offset:8960
  v_accvgpr_write_b32 a34, 0
  v_mfma_f32_16x16x32_bf16 v[20:23], a[228:231], v[200:203], v[20:23]
  ds_read_b64_tr_b16 v[220:221], v233 offset:12544
  ds_read_b64_tr_b16 v[222:223], v233 offset:13056
  v_mfma_f32_16x16x32_bf16 v[20:23], a[244:247], v[204:207], v[20:23]
  buffer_load_dwordx4 a[164:167], v225, s[36:39], s58 offen offset:0 sc1
  v_mfma_f32_16x16x32_bf16 v[48:51], a[200:203], v[192:195], v[48:51]
  v_accvgpr_write_b32 a35, 0
  v_accvgpr_write_b32 a36, 0
  v_mfma_f32_16x16x32_bf16 v[48:51], a[216:219], v[196:199], v[48:51]
  v_accvgpr_write_b32 a37, 0
  v_mfma_f32_16x16x32_bf16 v[48:51], a[232:235], v[200:203], v[48:51]
  v_accvgpr_write_b32 a38, 0
  v_accvgpr_write_b32 a39, 0
  v_mfma_f32_16x16x32_bf16 v[48:51], a[248:251], v[204:207], v[48:51]
  buffer_load_dwordx4 v250, s[40:43], s46 offen offset:2048 nt lds
  v_mfma_f32_16x16x32_bf16 v[52:55], a[204:207], v[192:195], v[52:55]
  v_accvgpr_write_b32 a40, 0
  v_accvgpr_write_b32 a41, 0
  v_mfma_f32_16x16x32_bf16 v[52:55], a[220:223], v[196:199], v[52:55]
  v_accvgpr_write_b32 a42, 0
  v_mfma_f32_16x16x32_bf16 v[52:55], a[236:239], v[200:203], v[52:55]
  v_accvgpr_write_b32 a43, 0
  v_accvgpr_write_b32 a44, 0
  v_mfma_f32_16x16x32_bf16 v[52:55], a[252:255], v[204:207], v[52:55]
  s_waitcnt lgkmcnt(0)
  buffer_load_dwordx4 a[172:175], v225, s[36:39], s58 offen offset:1024 sc1
  v_mfma_f32_16x16x32_bf16 v[24:27], a[192:195], v[208:211], v[24:27]
  s_waitcnt vmcnt(25)
  s_barrier
  ds_read_b64_tr_b16 v[192:193], v236 offset:0
  v_accvgpr_write_b32 a45, 0
  v_mfma_f32_16x16x32_bf16 v[24:27], a[208:211], v[212:215], v[24:27]
  ds_read_b64_tr_b16 v[194:195], v236 offset:1024
  v_accvgpr_write_b32 a46, 0
  v_mfma_f32_16x16x32_bf16 v[24:27], a[224:227], v[216:219], v[24:27]
  ds_read_b64_tr_b16 v[196:197], v237 offset:0
  v_accvgpr_write_b32 a47, 0
  v_mfma_f32_16x16x32_bf16 v[24:27], a[240:243], v[220:223], v[24:27]
  ds_read_b64_tr_b16 v[198:199], v237 offset:1024
  v_accvgpr_write_b32 a48, 0
  v_mfma_f32_16x16x32_bf16 v[28:31], a[196:199], v[208:211], v[28:31]
  ds_read_b64_tr_b16 v[200:201], v236 offset:256
  v_accvgpr_write_b32 a49, 0
  v_mfma_f32_16x16x32_bf16 v[28:31], a[212:215], v[212:215], v[28:31]
  ds_read_b64_tr_b16 v[202:203], v236 offset:1280
  v_accvgpr_write_b32 a50, 0
  v_mfma_f32_16x16x32_bf16 v[28:31], a[228:231], v[216:219], v[28:31]
  ds_read_b64_tr_b16 v[204:205], v237 offset:256
  ds_read_b64_tr_b16 v[206:207], v237 offset:1280
  v_mfma_f32_16x16x32_bf16 v[28:31], a[244:247], v[220:223], v[28:31]
  buffer_load_dwordx4 a[176:179], v225, s[32:35], s58 offen offset:2048 sc1
  v_mfma_f32_16x16x32_bf16 v[56:59], a[200:203], v[208:211], v[56:59]
  v_accvgpr_write_b32 a51, 0
  v_accvgpr_write_b32 a52, 0
  v_mfma_f32_16x16x32_bf16 v[56:59], a[216:219], v[212:215], v[56:59]
  v_accvgpr_write_b32 a53, 0
  v_mfma_f32_16x16x32_bf16 v[56:59], a[232:235], v[216:219], v[56:59]
  v_accvgpr_write_b32 a54, 0
  v_accvgpr_write_b32 a55, 0
  v_mfma_f32_16x16x32_bf16 v[56:59], a[248:251], v[220:223], v[56:59]
  buffer_load_dwordx4 v251, s[40:43], s46 offen offset:3072 nt lds
  v_mfma_f32_16x16x32_bf16 v[60:63], a[204:207], v[208:211], v[60:63]
  v_accvgpr_write_b32 a56, 0
  v_accvgpr_write_b32 a57, 0
  v_mfma_f32_16x16x32_bf16 v[60:63], a[220:223], v[212:215], v[60:63]
  v_accvgpr_write_b32 a58, 0
  v_mfma_f32_16x16x32_bf16 v[60:63], a[236:239], v[216:219], v[60:63]
  v_accvgpr_write_b32 a59, 0
  v_accvgpr_write_b32 a60, 0
  v_mfma_f32_16x16x32_bf16 v[60:63], a[252:255], v[220:223], v[60:63]
  s_waitcnt lgkmcnt(0)
  s_waitcnt vmcnt(17)
  buffer_load_dwordx4 a[184:187], v225, s[32:35], s58 offen offset:3072 sc1
  v_mfma_f32_16x16x32_bf16 v[128:131], v[192:195], a[128:131], 0
  ds_read_b64_tr_b16 v[208:209], v236 offset:512
  v_accvgpr_write_b32 a61, 0
  v_mfma_f32_16x16x32_bf16 v[132:135], v[196:199], a[128:131], 0
  ds_read_b64_tr_b16 v[210:211], v236 offset:1536
  v_accvgpr_write_b32 a62, 0
  v_mfma_f32_16x16x32_bf16 v[136:139], v[200:203], a[128:131], 0
  ds_read_b64_tr_b16 v[212:213], v237 offset:512
  v_accvgpr_write_b32 a63, 0
  v_mfma_f32_16x16x32_bf16 v[140:143], v[204:207], a[128:131], 0
  ds_read_b64_tr_b16 v[214:215], v237 offset:1536
  v_accvgpr_write_b32 a64, 0
  v_mfma_f32_16x16x32_bf16 v[160:163], v[192:195], a[136:139], 0
  ds_read_b64_tr_b16 v[216:217], v236 offset:768
  v_accvgpr_write_b32 a65, 0
  v_mfma_f32_16x16x32_bf16 v[164:167], v[196:199], a[136:139], 0
  ds_read_b64_tr_b16 v[218:219], v236 offset:1792
  v_accvgpr_write_b32 a66, 0
  v_mfma_f32_16x16x32_bf16 v[168:171], v[200:203], a[136:139], 0
  ds_read_b64_tr_b16 v[220:221], v237 offset:768
  ds_read_b64_tr_b16 v[222:223], v237 offset:1792
  v_mfma_f32_16x16x32_bf16 v[172:175], v[204:207], a[136:139], 0
  buffer_load_dwordx4 a[180:183], v225, s[36:39], s58 offen offset:2048 sc1
  v_mfma_f32_16x16x32_bf16 v[64:67], v[192:195], a[132:135], 0
  v_accvgpr_write_b32 a67, 0
  v_accvgpr_write_b32 a68, 0
  v_mfma_f32_16x16x32_bf16 v[68:71], v[196:199], a[132:135], 0
  v_accvgpr_write_b32 a69, 0
  v_mfma_f32_16x16x32_bf16 v[72:75], v[200:203], a[132:135], 0
  s_add_u32 m0, s48, 32768
  s_add_u32 s46, s54, 2097152
  v_accvgpr_write_b32 a70, 0
  v_accvgpr_write_b32 a71, 0
  v_mfma_f32_16x16x32_bf16 v[76:79], v[204:207], a[132:135], 0
  buffer_load_dwordx4 v248, s[40:43], s46 offen offset:0 nt lds
  v_mfma_f32_16x16x32_bf16 v[96:99], v[192:195], a[140:143], 0
  v_accvgpr_write_b32 a72, 0
  v_accvgpr_write_b32 a73, 0
  v_mfma_f32_16x16x32_bf16 v[100:103], v[196:199], a[140:143], 0
  v_accvgpr_write_b32 a74, 0
  v_mfma_f32_16x16x32_bf16 v[104:107], v[200:203], a[140:143], 0
  v_accvgpr_write_b32 a75, 0
  v_accvgpr_write_b32 a76, 0
  v_mfma_f32_16x16x32_bf16 v[108:111], v[204:207], a[140:143], 0
  s_waitcnt lgkmcnt(0)
  buffer_load_dwordx4 a[188:191], v225, s[36:39], s58 offen offset:3072 sc1
  v_mfma_f32_16x16x32_bf16 v[144:147], v[208:211], a[128:131], 0
  ds_read_b64_tr_b16 v[192:193], v236 offset:8192
  v_cvt_pk_bf16_f32 v0, v0, v1
  v_mfma_f32_16x16x32_bf16 v[148:151], v[212:215], a[128:131], 0
  ds_read_b64_tr_b16 v[194:195], v236 offset:9216
  v_cvt_pk_bf16_f32 v1, v2, v3
  v_mfma_f32_16x16x32_bf16 v[152:155], v[216:219], a[128:131], 0
  ds_read_b64_tr_b16 v[196:197], v237 offset:8192
  v_cvt_pk_bf16_f32 v2, v4, v5
  v_mfma_f32_16x16x32_bf16 v[156:159], v[220:223], a[128:131], 0
  ds_read_b64_tr_b16 v[198:199], v237 offset:9216
  v_cvt_pk_bf16_f32 v3, v6, v7
  v_mfma_f32_16x16x32_bf16 v[176:179], v[208:211], a[136:139], 0
  ds_read_b64_tr_b16 v[200:201], v236 offset:8448
  v_cvt_pk_bf16_f32 v8, v8, v9
  v_mfma_f32_16x16x32_bf16 v[180:183], v[212:215], a[136:139], 0
  ds_read_b64_tr_b16 v[202:203], v236 offset:9472
  v_cvt_pk_bf16_f32 v9, v10, v11
  v_mfma_f32_16x16x32_bf16 v[184:187], v[216:219], a[136:139], 0
  s_mov_b32 s58, 8192
  ds_read_b64_tr_b16 v[204:205], v237 offset:8448
  ds_read_b64_tr_b16 v[206:207], v237 offset:9472
  v_mfma_f32_16x16x32_bf16 v[188:191], v[220:223], a[136:139], 0
  buffer_load_dwordx4 a[128:131], v225, s[32:35], s58 offen offset:0 sc1
  v_mfma_f32_16x16x32_bf16 v[80:83], v[208:211], a[132:135], 0
  v_cvt_pk_bf16_f32 v10, v12, v13
  v_cvt_pk_bf16_f32 v11, v14, v15
  v_mfma_f32_16x16x32_bf16 v[84:87], v[212:215], a[132:135], 0
  buffer_store_dwordx4 v[0:3], v225, s[28:31], s55 offen offset:0 sc1
  v_mfma_f32_16x16x32_bf16 v[88:91], v[216:219], a[132:135], 0
  v_cvt_pk_bf16_f32 v16, v16, v17
  v_cvt_pk_bf16_f32 v17, v18, v19
  v_mfma_f32_16x16x32_bf16 v[92:95], v[220:223], a[132:135], 0
  buffer_load_dwordx4 v249, s[40:43], s46 offen offset:1024 nt lds
  v_mfma_f32_16x16x32_bf16 v[112:115], v[208:211], a[140:143], 0
  v_cvt_pk_bf16_f32 v18, v20, v21
  v_cvt_pk_bf16_f32 v19, v22, v23
  v_mfma_f32_16x16x32_bf16 v[116:119], v[212:215], a[140:143], 0
  v_cvt_pk_bf16_f32 v24, v24, v25
  v_mfma_f32_16x16x32_bf16 v[120:123], v[216:219], a[140:143], 0
  v_cvt_pk_bf16_f32 v25, v26, v27
  v_cvt_pk_bf16_f32 v26, v28, v29
  v_mfma_f32_16x16x32_bf16 v[124:127], v[220:223], a[140:143], 0
  s_waitcnt lgkmcnt(0)
  s_waitcnt vmcnt(16)
  buffer_load_dwordx4 a[136:139], v225, s[32:35], s58 offen offset:1024 sc1
  v_mfma_f32_16x16x32_bf16 v[128:131], v[192:195], a[144:147], v[128:131]
  ds_read_b64_tr_b16 v[208:209], v236 offset:8704
  v_cvt_pk_bf16_f32 v27, v30, v31
  v_mfma_f32_16x16x32_bf16 v[132:135], v[196:199], a[144:147], v[132:135]
  ds_read_b64_tr_b16 v[210:211], v236 offset:9728
  v_cvt_pk_bf16_f32 v32, v32, v33
  v_mfma_f32_16x16x32_bf16 v[136:139], v[200:203], a[144:147], v[136:139]
  ds_read_b64_tr_b16 v[212:213], v237 offset:8704
  v_cvt_pk_bf16_f32 v33, v34, v35
  v_mfma_f32_16x16x32_bf16 v[140:143], v[204:207], a[144:147], v[140:143]
  ds_read_b64_tr_b16 v[214:215], v237 offset:9728
  v_cvt_pk_bf16_f32 v34, v36, v37
  v_mfma_f32_16x16x32_bf16 v[160:163], v[192:195], a[152:155], v[160:163]
  ds_read_b64_tr_b16 v[216:217], v236 offset:8960
  v_cvt_pk_bf16_f32 v35, v38, v39
  v_mfma_f32_16x16x32_bf16 v[164:167], v[196:199], a[152:155], v[164:167]
  ds_read_b64_tr_b16 v[218:219], v236 offset:9984
  v_cvt_pk_bf16_f32 v40, v40, v41
  v_mfma_f32_16x16x32_bf16 v[168:171], v[200:203], a[152:155], v[168:171]
  ds_read_b64_tr_b16 v[220:221], v237 offset:8960
  ds_read_b64_tr_b16 v[222:223], v237 offset:9984
  v_mfma_f32_16x16x32_bf16 v[172:175], v[204:207], a[152:155], v[172:175]
  buffer_load_dwordx4 a[132:135], v225, s[36:39], s58 offen offset:0 sc1
  v_mfma_f32_16x16x32_bf16 v[64:67], v[192:195], a[148:151], v[64:67]
  v_cvt_pk_bf16_f32 v41, v42, v43
  v_cvt_pk_bf16_f32 v42, v44, v45
  v_mfma_f32_16x16x32_bf16 v[68:71], v[196:199], a[148:151], v[68:71]
  v_cvt_pk_bf16_f32 v43, v46, v47
  v_mfma_f32_16x16x32_bf16 v[72:75], v[200:203], a[148:151], v[72:75]
  v_cvt_pk_bf16_f32 v48, v48, v49
  v_cvt_pk_bf16_f32 v49, v50, v51
  v_mfma_f32_16x16x32_bf16 v[76:79], v[204:207], a[148:151], v[76:79]
  buffer_load_dwordx4 v250, s[40:43], s46 offen offset:2048 nt lds
  v_mfma_f32_16x16x32_bf16 v[96:99], v[192:195], a[156:159], v[96:99]
  v_cvt_pk_bf16_f32 v50, v52, v53
  v_cvt_pk_bf16_f32 v51, v54, v55
  v_mfma_f32_16x16x32_bf16 v[100:103], v[196:199], a[156:159], v[100:103]
  buffer_store_dwordx4 v[8:11], v225, s[28:31], s55 offen offset:1024 sc1
  v_mfma_f32_16x16x32_bf16 v[104:107], v[200:203], a[156:159], v[104:107]
  v_cvt_pk_bf16_f32 v56, v56, v57
  v_cvt_pk_bf16_f32 v57, v58, v59
  v_mfma_f32_16x16x32_bf16 v[108:111], v[204:207], a[156:159], v[108:111]
  s_waitcnt lgkmcnt(0)
  buffer_load_dwordx4 a[140:143], v225, s[36:39], s58 offen offset:1024 sc1
  v_mfma_f32_16x16x32_bf16 v[144:147], v[208:211], a[144:147], v[144:147]
  ds_read_b64_tr_b16 v[192:193], v236 offset:16384
  v_cvt_pk_bf16_f32 v58, v60, v61
  v_mfma_f32_16x16x32_bf16 v[148:151], v[212:215], a[144:147], v[148:151]
  ds_read_b64_tr_b16 v[194:195], v236 offset:17408
  v_cvt_pk_bf16_f32 v59, v62, v63
  v_mfma_f32_16x16x32_bf16 v[152:155], v[216:219], a[144:147], v[152:155]
  ds_read_b64_tr_b16 v[196:197], v237 offset:16384
  v_accvgpr_write_b32 a77, 0
  v_mfma_f32_16x16x32_bf16 v[156:159], v[220:223], a[144:147], v[156:159]
  ds_read_b64_tr_b16 v[198:199], v237 offset:17408
  v_accvgpr_write_b32 a78, 0
  v_mfma_f32_16x16x32_bf16 v[176:179], v[208:211], a[152:155], v[176:179]
  ds_read_b64_tr_b16 v[200:201], v236 offset:16640
  v_accvgpr_write_b32 a79, 0
  v_mfma_f32_16x16x32_bf16 v[180:183], v[212:215], a[152:155], v[180:183]
  ds_read_b64_tr_b16 v[202:203], v236 offset:17664
  v_accvgpr_write_b32 a80, 0
  v_mfma_f32_16x16x32_bf16 v[184:187], v[216:219], a[152:155], v[184:187]
  ds_read_b64_tr_b16 v[204:205], v237 offset:16640
  ds_read_b64_tr_b16 v[206:207], v237 offset:17664
  v_mfma_f32_16x16x32_bf16 v[188:191], v[220:223], a[152:155], v[188:191]
  buffer_load_dwordx4 a[144:147], v225, s[32:35], s58 offen offset:2048 sc1
  v_mfma_f32_16x16x32_bf16 v[80:83], v[208:211], a[148:151], v[80:83]
  v_accvgpr_write_b32 a81, 0
  v_accvgpr_write_b32 a82, 0
  v_mfma_f32_16x16x32_bf16 v[84:87], v[212:215], a[148:151], v[84:87]
  v_accvgpr_write_b32 a83, 0
  v_mfma_f32_16x16x32_bf16 v[88:91], v[216:219], a[148:151], v[88:91]
  v_accvgpr_write_b32 a84, 0
  v_accvgpr_write_b32 a85, 0
  v_mfma_f32_16x16x32_bf16 v[92:95], v[220:223], a[148:151], v[92:95]
  buffer_load_dwordx4 v251, s[40:43], s46 offen offset:3072 nt lds
  v_mfma_f32_16x16x32_bf16 v[112:115], v[208:211], a[156:159], v[112:115]
  v_accvgpr_write_b32 a86, 0
  v_accvgpr_write_b32 a87, 0
  v_mfma_f32_16x16x32_bf16 v[116:119], v[212:215], a[156:159], v[116:119]
  v_accvgpr_write_b32 a88, 0
  v_mfma_f32_16x16x32_bf16 v[120:123], v[216:219], a[156:159], v[120:123]
  v_accvgpr_write_b32 a89, 0
  v_accvgpr_write_b32 a90, 0
  v_mfma_f32_16x16x32_bf16 v[124:127], v[220:223], a[156:159], v[124:127]
  s_waitcnt lgkmcnt(0)
  s_waitcnt vmcnt(16)
  buffer_load_dwordx4 a[152:155], v225, s[32:35], s58 offen offset:3072 sc1
  v_mfma_f32_16x16x32_bf16 v[128:131], v[192:195], a[160:163], v[128:131]
  ds_read_b64_tr_b16 v[208:209], v236 offset:16896
  v_accvgpr_write_b32 a91, 0
  v_mfma_f32_16x16x32_bf16 v[132:135], v[196:199], a[160:163], v[132:135]
  ds_read_b64_tr_b16 v[210:211], v236 offset:17920
  v_accvgpr_write_b32 a92, 0
  v_mfma_f32_16x16x32_bf16 v[136:139], v[200:203], a[160:163], v[136:139]
  ds_read_b64_tr_b16 v[212:213], v237 offset:16896
  v_accvgpr_write_b32 a93, 0
  v_mfma_f32_16x16x32_bf16 v[140:143], v[204:207], a[160:163], v[140:143]
  ds_read_b64_tr_b16 v[214:215], v237 offset:17920
  v_accvgpr_write_b32 a94, 0
  v_mfma_f32_16x16x32_bf16 v[160:163], v[192:195], a[168:171], v[160:163]
  ds_read_b64_tr_b16 v[216:217], v236 offset:17152
  ds_read_b64_tr_b16 v[218:219], v236 offset:18176
  v_mfma_f32_16x16x32_bf16 v[164:167], v[196:199], a[168:171], v[164:167]
  buffer_store_dwordx4 v[16:19], v225, s[28:31], s55 offen offset:2048 sc1
  v_mfma_f32_16x16x32_bf16 v[168:171], v[200:203], a[168:171], v[168:171]
  ds_read_b64_tr_b16 v[220:221], v237 offset:17152
  ds_read_b64_tr_b16 v[222:223], v237 offset:18176
  v_mfma_f32_16x16x32_bf16 v[172:175], v[204:207], a[168:171], v[172:175]
  buffer_load_dwordx4 a[148:151], v225, s[36:39], s58 offen offset:2048 sc1
  v_mfma_f32_16x16x32_bf16 v[64:67], v[192:195], a[164:167], v[64:67]
  v_accvgpr_write_b32 a95, 0
  v_accvgpr_write_b32 a96, 0
  v_mfma_f32_16x16x32_bf16 v[68:71], v[196:199], a[164:167], v[68:71]
  v_accvgpr_write_b32 a97, 0
  v_mfma_f32_16x16x32_bf16 v[72:75], v[200:203], a[164:167], v[72:75]
  s_add_u32 m0, s48, 36864
  s_add_u32 s46, s54, 2228224
  v_accvgpr_write_b32 a98, 0
  v_accvgpr_write_b32 a99, 0
  v_mfma_f32_16x16x32_bf16 v[76:79], v[204:207], a[164:167], v[76:79]
  buffer_load_dwordx4 v248, s[40:43], s46 offen offset:0 nt lds
  v_mfma_f32_16x16x32_bf16 v[96:99], v[192:195], a[172:175], v[96:99]
  v_accvgpr_write_b32 a100, 0
  v_accvgpr_write_b32 a101, 0
  v_mfma_f32_16x16x32_bf16 v[100:103], v[196:199], a[172:175], v[100:103]
  v_accvgpr_write_b32 a102, 0
  v_mfma_f32_16x16x32_bf16 v[104:107], v[200:203], a[172:175], v[104:107]
  v_accvgpr_write_b32 a103, 0
  v_accvgpr_write_b32 a104, 0
  v_mfma_f32_16x16x32_bf16 v[108:111], v[204:207], a[172:175], v[108:111]
  s_waitcnt lgkmcnt(0)
  buffer_load_dwordx4 a[156:159], v225, s[36:39], s58 offen offset:3072 sc1
  v_mfma_f32_16x16x32_bf16 v[144:147], v[208:211], a[160:163], v[144:147]
  ds_read_b64_tr_b16 v[192:193], v236 offset:24576
  v_accvgpr_write_b32 a105, 0
  v_mfma_f32_16x16x32_bf16 v[148:151], v[212:215], a[160:163], v[148:151]
  ds_read_b64_tr_b16 v[194:195], v236 offset:25600
  v_accvgpr_write_b32 a106, 0
  v_mfma_f32_16x16x32_bf16 v[152:155], v[216:219], a[160:163], v[152:155]
  ds_read_b64_tr_b16 v[196:197], v237 offset:24576
  v_accvgpr_write_b32 a107, 0
  v_mfma_f32_16x16x32_bf16 v[156:159], v[220:223], a[160:163], v[156:159]
  ds_read_b64_tr_b16 v[198:199], v237 offset:25600
  v_accvgpr_write_b32 a108, 0
  v_mfma_f32_16x16x32_bf16 v[176:179], v[208:211], a[168:171], v[176:179]
  ds_read_b64_tr_b16 v[200:201], v236 offset:24832
  v_accvgpr_write_b32 a109, 0
  v_mfma_f32_16x16x32_bf16 v[180:183], v[212:215], a[168:171], v[180:183]
  ds_read_b64_tr_b16 v[202:203], v236 offset:25856
  v_accvgpr_write_b32 a110, 0
  v_mfma_f32_16x16x32_bf16 v[184:187], v[216:219], a[168:171], v[184:187]
  s_mov_b32 s58, 12288
  ds_read_b64_tr_b16 v[204:205], v237 offset:24832
  ds_read_b64_tr_b16 v[206:207], v237 offset:25856
  v_mfma_f32_16x16x32_bf16 v[188:191], v[220:223], a[168:171], v[188:191]
  buffer_load_dwordx4 a[160:163], v225, s[32:35], s58 offen offset:0 sc1
  v_mfma_f32_16x16x32_bf16 v[80:83], v[208:211], a[164:167], v[80:83]
  v_accvgpr_write_b32 a111, 0
  v_accvgpr_write_b32 a112, 0
  v_mfma_f32_16x16x32_bf16 v[84:87], v[212:215], a[164:167], v[84:87]
  v_accvgpr_write_b32 a113, 0
  v_mfma_f32_16x16x32_bf16 v[88:91], v[216:219], a[164:167], v[88:91]
  v_accvgpr_write_b32 a114, 0
  v_accvgpr_write_b32 a115, 0
  v_mfma_f32_16x16x32_bf16 v[92:95], v[220:223], a[164:167], v[92:95]
  buffer_load_dwordx4 v249, s[40:43], s46 offen offset:1024 nt lds
  v_mfma_f32_16x16x32_bf16 v[112:115], v[208:211], a[172:175], v[112:115]
  v_accvgpr_write_b32 a116, 0
  v_accvgpr_write_b32 a117, 0
  v_mfma_f32_16x16x32_bf16 v[116:119], v[212:215], a[172:175], v[116:119]
  buffer_store_dwordx4 v[24:27], v225, s[28:31], s55 offen offset:3072 sc1
  v_mfma_f32_16x16x32_bf16 v[120:123], v[216:219], a[172:175], v[120:123]
  v_accvgpr_write_b32 a118, 0
  v_accvgpr_write_b32 a119, 0
  v_mfma_f32_16x16x32_bf16 v[124:127], v[220:223], a[172:175], v[124:127]
  s_waitcnt lgkmcnt(0)
  s_waitcnt vmcnt(18)
  buffer_load_dwordx4 a[168:171], v225, s[32:35], s58 offen offset:1024 sc1
  v_mfma_f32_16x16x32_bf16 v[128:131], v[192:195], a[176:179], v[128:131]
  ds_read_b64_tr_b16 v[208:209], v236 offset:25088
  v_accvgpr_write_b32 a120, 0
  v_mfma_f32_16x16x32_bf16 v[132:135], v[196:199], a[176:179], v[132:135]
  ds_read_b64_tr_b16 v[210:211], v236 offset:26112
  v_accvgpr_write_b32 a121, 0
  v_mfma_f32_16x16x32_bf16 v[136:139], v[200:203], a[176:179], v[136:139]
  ds_read_b64_tr_b16 v[212:213], v237 offset:25088
  v_accvgpr_write_b32 a122, 0
  v_mfma_f32_16x16x32_bf16 v[140:143], v[204:207], a[176:179], v[140:143]
  ds_read_b64_tr_b16 v[214:215], v237 offset:26112
  v_accvgpr_write_b32 a123, 0
  v_mfma_f32_16x16x32_bf16 v[160:163], v[192:195], a[184:187], v[160:163]
  ds_read_b64_tr_b16 v[216:217], v236 offset:25344
  v_accvgpr_write_b32 a124, 0
  v_mfma_f32_16x16x32_bf16 v[164:167], v[196:199], a[184:187], v[164:167]
  ds_read_b64_tr_b16 v[218:219], v236 offset:26368
  v_accvgpr_write_b32 a125, 0
  v_mfma_f32_16x16x32_bf16 v[168:171], v[200:203], a[184:187], v[168:171]
  ds_read_b64_tr_b16 v[220:221], v237 offset:25344
  ds_read_b64_tr_b16 v[222:223], v237 offset:26368
  v_mfma_f32_16x16x32_bf16 v[172:175], v[204:207], a[184:187], v[172:175]
  buffer_load_dwordx4 a[164:167], v225, s[36:39], s58 offen offset:0 sc1
  v_mfma_f32_16x16x32_bf16 v[64:67], v[192:195], a[180:183], v[64:67]
  v_accvgpr_write_b32 a126, 0
  v_accvgpr_write_b32 a127, 0
  v_mfma_f32_16x16x32_bf16 v[68:71], v[196:199], a[180:183], v[68:71]
  v_mfma_f32_16x16x32_bf16 v[72:75], v[200:203], a[180:183], v[72:75]
  v_mfma_f32_16x16x32_bf16 v[76:79], v[204:207], a[180:183], v[76:79]
  buffer_load_dwordx4 v250, s[40:43], s46 offen offset:2048 nt lds
  v_mfma_f32_16x16x32_bf16 v[96:99], v[192:195], a[188:191], v[96:99]
  v_mfma_f32_16x16x32_bf16 v[100:103], v[196:199], a[188:191], v[100:103]
  v_mfma_f32_16x16x32_bf16 v[104:107], v[200:203], a[188:191], v[104:107]
  v_mfma_f32_16x16x32_bf16 v[108:111], v[204:207], a[188:191], v[108:111]
  s_waitcnt lgkmcnt(0)
  buffer_load_dwordx4 a[172:175], v225, s[36:39], s58 offen offset:1024 sc1
  v_mfma_f32_16x16x32_bf16 v[144:147], v[208:211], a[176:179], v[144:147]
  s_waitcnt vmcnt(26)
  s_barrier
  ds_read_b64_tr_b16 v[192:193], v238 offset:32768
  v_mfma_f32_16x16x32_bf16 v[148:151], v[212:215], a[176:179], v[148:151]
  ds_read_b64_tr_b16 v[194:195], v238 offset:33792
  v_mfma_f32_16x16x32_bf16 v[152:155], v[216:219], a[176:179], v[152:155]
  ds_read_b64_tr_b16 v[196:197], v239 offset:32768
  v_mfma_f32_16x16x32_bf16 v[156:159], v[220:223], a[176:179], v[156:159]
  ds_read_b64_tr_b16 v[198:199], v239 offset:33792
  v_mfma_f32_16x16x32_bf16 v[176:179], v[208:211], a[184:187], v[176:179]
  ds_read_b64_tr_b16 v[200:201], v238 offset:33024
  ds_read_b64_tr_b16 v[202:203], v238 offset:34048
  v_mfma_f32_16x16x32_bf16 v[180:183], v[212:215], a[184:187], v[180:183]
  buffer_store_dwordx4 v[32:35], v225, s[28:31], s57 offen offset:0 sc1
  v_mfma_f32_16x16x32_bf16 v[184:187], v[216:219], a[184:187], v[184:187]
  ds_read_b64_tr_b16 v[204:205], v239 offset:33024
  ds_read_b64_tr_b16 v[206:207], v239 offset:34048
  v_mfma_f32_16x16x32_bf16 v[188:191], v[220:223], a[184:187], v[188:191]
  buffer_load_dwordx4 a[176:179], v225, s[32:35], s58 offen offset:2048 sc1
  v_mfma_f32_16x16x32_bf16 v[80:83], v[208:211], a[180:183], v[80:83]
  v_mfma_f32_16x16x32_bf16 v[84:87], v[212:215], a[180:183], v[84:87]
  v_mfma_f32_16x16x32_bf16 v[88:91], v[216:219], a[180:183], v[88:91]
  v_mfma_f32_16x16x32_bf16 v[92:95], v[220:223], a[180:183], v[92:95]
  buffer_load_dwordx4 v251, s[40:43], s46 offen offset:3072 nt lds
  v_mfma_f32_16x16x32_bf16 v[112:115], v[208:211], a[188:191], v[112:115]
  v_mfma_f32_16x16x32_bf16 v[116:119], v[212:215], a[188:191], v[116:119]
  v_mfma_f32_16x16x32_bf16 v[120:123], v[216:219], a[188:191], v[120:123]
  v_mfma_f32_16x16x32_bf16 v[124:127], v[220:223], a[188:191], v[124:127]
  s_waitcnt lgkmcnt(0)
  s_waitcnt vmcnt(17)
  buffer_load_dwordx4 a[184:187], v225, s[32:35], s58 offen offset:3072 sc1
  v_mfma_f32_16x16x32_bf16 v[128:131], v[192:195], a[128:131], v[128:131]
  ds_read_b64_tr_b16 v[208:209], v238 offset:33280
  v_mfma_f32_16x16x32_bf16 v[132:135], v[196:199], a[128:131], v[132:135]
  ds_read_b64_tr_b16 v[210:211], v238 offset:34304
  v_mfma_f32_16x16x32_bf16 v[136:139], v[200:203], a[128:131], v[136:139]
  ds_read_b64_tr_b16 v[212:213], v239 offset:33280
  v_mfma_f32_16x16x32_bf16 v[140:143], v[204:207], a[128:131], v[140:143]
  ds_read_b64_tr_b16 v[214:215], v239 offset:34304
  v_mfma_f32_16x16x32_bf16 v[160:163], v[192:195], a[136:139], v[160:163]
  ds_read_b64_tr_b16 v[216:217], v238 offset:33536
  v_mfma_f32_16x16x32_bf16 v[164:167], v[196:199], a[136:139], v[164:167]
  ds_read_b64_tr_b16 v[218:219], v238 offset:34560
  v_mfma_f32_16x16x32_bf16 v[168:171], v[200:203], a[136:139], v[168:171]
  ds_read_b64_tr_b16 v[220:221], v239 offset:33536
  ds_read_b64_tr_b16 v[222:223], v239 offset:34560
  v_mfma_f32_16x16x32_bf16 v[172:175], v[204:207], a[136:139], v[172:175]
  buffer_load_dwordx4 a[180:183], v225, s[36:39], s58 offen offset:2048 sc1
  v_mfma_f32_16x16x32_bf16 v[64:67], v[192:195], a[132:135], v[64:67]
  v_mfma_f32_16x16x32_bf16 v[68:71], v[196:199], a[132:135], v[68:71]
  v_mfma_f32_16x16x32_bf16 v[72:75], v[200:203], a[132:135], v[72:75]
  s_add_u32 m0, s48, 131072
  s_add_u32 s46, s54, 3145728
  v_mfma_f32_16x16x32_bf16 v[76:79], v[204:207], a[132:135], v[76:79]
  buffer_load_dwordx4 v248, s[40:43], s46 offen offset:0 nt lds
  v_mfma_f32_16x16x32_bf16 v[96:99], v[192:195], a[140:143], v[96:99]
  v_mfma_f32_16x16x32_bf16 v[100:103], v[196:199], a[140:143], v[100:103]
  buffer_store_dwordx4 v[40:43], v225, s[28:31], s57 offen offset:1024 sc1
  v_mfma_f32_16x16x32_bf16 v[104:107], v[200:203], a[140:143], v[104:107]
  v_mfma_f32_16x16x32_bf16 v[108:111], v[204:207], a[140:143], v[108:111]
  s_waitcnt lgkmcnt(0)
  buffer_load_dwordx4 a[188:191], v225, s[36:39], s58 offen offset:3072 sc1
  v_mfma_f32_16x16x32_bf16 v[144:147], v[208:211], a[128:131], v[144:147]
  ds_read_b64_tr_b16 v[192:193], v238 offset:40960
  v_mfma_f32_16x16x32_bf16 v[148:151], v[212:215], a[128:131], v[148:151]
  ds_read_b64_tr_b16 v[194:195], v238 offset:41984
  v_mfma_f32_16x16x32_bf16 v[152:155], v[216:219], a[128:131], v[152:155]
  ds_read_b64_tr_b16 v[196:197], v239 offset:40960
  v_mfma_f32_16x16x32_bf16 v[156:159], v[220:223], a[128:131], v[156:159]
  ds_read_b64_tr_b16 v[198:199], v239 offset:41984
  v_mfma_f32_16x16x32_bf16 v[176:179], v[208:211], a[136:139], v[176:179]
  ds_read_b64_tr_b16 v[200:201], v238 offset:41216
  v_mfma_f32_16x16x32_bf16 v[180:183], v[212:215], a[136:139], v[180:183]
  ds_read_b64_tr_b16 v[202:203], v238 offset:42240
  v_mfma_f32_16x16x32_bf16 v[184:187], v[216:219], a[136:139], v[184:187]
  s_mov_b32 s58, 16384
  ds_read_b64_tr_b16 v[204:205], v239 offset:41216
  ds_read_b64_tr_b16 v[206:207], v239 offset:42240
  v_mfma_f32_16x16x32_bf16 v[188:191], v[220:223], a[136:139], v[188:191]
  buffer_load_dwordx4 a[128:131], v225, s[32:35], s58 offen offset:0 sc1
  v_mfma_f32_16x16x32_bf16 v[80:83], v[208:211], a[132:135], v[80:83]
  v_mfma_f32_16x16x32_bf16 v[84:87], v[212:215], a[132:135], v[84:87]
  v_mfma_f32_16x16x32_bf16 v[88:91], v[216:219], a[132:135], v[88:91]
  v_mfma_f32_16x16x32_bf16 v[92:95], v[220:223], a[132:135], v[92:95]
  buffer_load_dwordx4 v249, s[40:43], s46 offen offset:1024 nt lds
  v_mfma_f32_16x16x32_bf16 v[112:115], v[208:211], a[140:143], v[112:115]
  v_mfma_f32_16x16x32_bf16 v[116:119], v[212:215], a[140:143], v[116:119]
  v_mfma_f32_16x16x32_bf16 v[120:123], v[216:219], a[140:143], v[120:123]
  v_mfma_f32_16x16x32_bf16 v[124:127], v[220:223], a[140:143], v[124:127]
  s_waitcnt lgkmcnt(0)
  s_waitcnt vmcnt(17)
  buffer_load_dwordx4 a[136:139], v225, s[32:35], s58 offen offset:1024 sc1
  v_mfma_f32_16x16x32_bf16 v[128:131], v[192:195], a[144:147], v[128:131]
  ds_read_b64_tr_b16 v[208:209], v238 offset:41472
  v_mfma_f32_16x16x32_bf16 v[132:135], v[196:199], a[144:147], v[132:135]
  ds_read_b64_tr_b16 v[210:211], v238 offset:42496
  v_mfma_f32_16x16x32_bf16 v[136:139], v[200:203], a[144:147], v[136:139]
  ds_read_b64_tr_b16 v[212:213], v239 offset:41472
  v_mfma_f32_16x16x32_bf16 v[140:143], v[204:207], a[144:147], v[140:143]
  ds_read_b64_tr_b16 v[214:215], v239 offset:42496
  v_mfma_f32_16x16x32_bf16 v[160:163], v[192:195], a[152:155], v[160:163]
  ds_read_b64_tr_b16 v[216:217], v238 offset:41728
  ds_read_b64_tr_b16 v[218:219], v238 offset:42752
  v_mfma_f32_16x16x32_bf16 v[164:167], v[196:199], a[152:155], v[164:167]
  buffer_store_dwordx4 v[48:51], v225, s[28:31], s57 offen offset:2048 sc1
  v_mfma_f32_16x16x32_bf16 v[168:171], v[200:203], a[152:155], v[168:171]
  ds_read_b64_tr_b16 v[220:221], v239 offset:41728
  ds_read_b64_tr_b16 v[222:223], v239 offset:42752
  v_mfma_f32_16x16x32_bf16 v[172:175], v[204:207], a[152:155], v[172:175]
  buffer_load_dwordx4 a[132:135], v225, s[36:39], s58 offen offset:0 sc1
  v_mfma_f32_16x16x32_bf16 v[64:67], v[192:195], a[148:151], v[64:67]
  v_mfma_f32_16x16x32_bf16 v[68:71], v[196:199], a[148:151], v[68:71]
  v_mfma_f32_16x16x32_bf16 v[72:75], v[200:203], a[148:151], v[72:75]
  v_mfma_f32_16x16x32_bf16 v[76:79], v[204:207], a[148:151], v[76:79]
  buffer_load_dwordx4 v250, s[40:43], s46 offen offset:2048 nt lds
  v_mfma_f32_16x16x32_bf16 v[96:99], v[192:195], a[156:159], v[96:99]
  v_mfma_f32_16x16x32_bf16 v[100:103], v[196:199], a[156:159], v[100:103]
  v_mfma_f32_16x16x32_bf16 v[104:107], v[200:203], a[156:159], v[104:107]
  v_mfma_f32_16x16x32_bf16 v[108:111], v[204:207], a[156:159], v[108:111]
  s_waitcnt lgkmcnt(0)
  buffer_load_dwordx4 a[140:143], v225, s[36:39], s58 offen offset:1024 sc1
  v_mfma_f32_16x16x32_bf16 v[144:147], v[208:211], a[144:147], v[144:147]
  ds_read_b64_tr_b16 v[192:193], v238 offset:49152
  v_mfma_f32_16x16x32_bf16 v[148:151], v[212:215], a[144:147], v[148:151]
  ds_read_b64_tr_b16 v[194:195], v238 offset:50176
  v_mfma_f32_16x16x32_bf16 v[152:155], v[216:219], a[144:147], v[152:155]
  ds_read_b64_tr_b16 v[196:197], v239 offset:49152
  v_mfma_f32_16x16x32_bf16 v[156:159], v[220:223], a[144:147], v[156:159]
  ds_read_b64_tr_b16 v[198:199], v239 offset:50176
  v_mfma_f32_16x16x32_bf16 v[176:179], v[208:211], a[152:155], v[176:179]
  ds_read_b64_tr_b16 v[200:201], v238 offset:49408
  v_mfma_f32_16x16x32_bf16 v[180:183], v[212:215], a[152:155], v[180:183]
  ds_read_b64_tr_b16 v[202:203], v238 offset:50432
  v_mfma_f32_16x16x32_bf16 v[184:187], v[216:219], a[152:155], v[184:187]
  ds_read_b64_tr_b16 v[204:205], v239 offset:49408
  ds_read_b64_tr_b16 v[206:207], v239 offset:50432
  v_mfma_f32_16x16x32_bf16 v[188:191], v[220:223], a[152:155], v[188:191]
  buffer_load_dwordx4 a[144:147], v225, s[32:35], s58 offen offset:2048 sc1
  v_mfma_f32_16x16x32_bf16 v[80:83], v[208:211], a[148:151], v[80:83]
  v_mfma_f32_16x16x32_bf16 v[84:87], v[212:215], a[148:151], v[84:87]
  v_mfma_f32_16x16x32_bf16 v[88:91], v[216:219], a[148:151], v[88:91]
  v_mfma_f32_16x16x32_bf16 v[92:95], v[220:223], a[148:151], v[92:95]
  buffer_load_dwordx4 v251, s[40:43], s46 offen offset:3072 nt lds
  v_mfma_f32_16x16x32_bf16 v[112:115], v[208:211], a[156:159], v[112:115]
  v_mfma_f32_16x16x32_bf16 v[116:119], v[212:215], a[156:159], v[116:119]
  buffer_store_dwordx4 v[56:59], v225, s[28:31], s57 offen offset:3072 sc1
  v_mfma_f32_16x16x32_bf16 v[120:123], v[216:219], a[156:159], v[120:123]
  v_mfma_f32_16x16x32_bf16 v[124:127], v[220:223], a[156:159], v[124:127]
  s_waitcnt lgkmcnt(0)
  s_waitcnt vmcnt(18)
  buffer_load_dwordx4 a[152:155], v225, s[32:35], s58 offen offset:3072 sc1
  v_mfma_f32_16x16x32_bf16 v[128:131], v[192:195], a[160:163], v[128:131]
  ds_read_b64_tr_b16 v[208:209], v238 offset:49664
  v_mfma_f32_16x16x32_bf16 v[132:135], v[196:199], a[160:163], v[132:135]
  ds_read_b64_tr_b16 v[210:211], v238 offset:50688
  v_mfma_f32_16x16x32_bf16 v[136:139], v[200:203], a[160:163], v[136:139]
  ds_read_b64_tr_b16 v[212:213], v239 offset:49664
  v_mfma_f32_16x16x32_bf16 v[140:143], v[204:207], a[160:163], v[140:143]
  ds_read_b64_tr_b16 v[214:215], v239 offset:50688
  v_mfma_f32_16x16x32_bf16 v[160:163], v[192:195], a[168:171], v[160:163]
  ds_read_b64_tr_b16 v[216:217], v238 offset:49920
  v_mfma_f32_16x16x32_bf16 v[164:167], v[196:199], a[168:171], v[164:167]
  ds_read_b64_tr_b16 v[218:219], v238 offset:50944
  v_mfma_f32_16x16x32_bf16 v[168:171], v[200:203], a[168:171], v[168:171]
  ds_read_b64_tr_b16 v[220:221], v239 offset:49920
  ds_read_b64_tr_b16 v[222:223], v239 offset:50944
  v_mfma_f32_16x16x32_bf16 v[172:175], v[204:207], a[168:171], v[172:175]
  buffer_load_dwordx4 a[148:151], v225, s[36:39], s58 offen offset:2048 sc1
  v_mfma_f32_16x16x32_bf16 v[64:67], v[192:195], a[164:167], v[64:67]
  v_mfma_f32_16x16x32_bf16 v[68:71], v[196:199], a[164:167], v[68:71]
  v_mfma_f32_16x16x32_bf16 v[72:75], v[200:203], a[164:167], v[72:75]
  s_add_u32 m0, s48, 135168
  s_add_u32 s46, s54, 3276800
  v_mfma_f32_16x16x32_bf16 v[76:79], v[204:207], a[164:167], v[76:79]
  buffer_load_dwordx4 v248, s[40:43], s46 offen offset:0 nt lds
  v_mfma_f32_16x16x32_bf16 v[96:99], v[192:195], a[172:175], v[96:99]
  v_mfma_f32_16x16x32_bf16 v[100:103], v[196:199], a[172:175], v[100:103]
  v_mfma_f32_16x16x32_bf16 v[104:107], v[200:203], a[172:175], v[104:107]
  v_mfma_f32_16x16x32_bf16 v[108:111], v[204:207], a[172:175], v[108:111]
  s_waitcnt lgkmcnt(0)
  buffer_load_dwordx4 a[156:159], v225, s[36:39], s58 offen offset:3072 sc1
  v_mfma_f32_16x16x32_bf16 v[144:147], v[208:211], a[160:163], v[144:147]
  ds_read_b64_tr_b16 v[192:193], v238 offset:57344
  v_mfma_f32_16x16x32_bf16 v[148:151], v[212:215], a[160:163], v[148:151]
  ds_read_b64_tr_b16 v[194:195], v238 offset:58368
  v_mfma_f32_16x16x32_bf16 v[152:155], v[216:219], a[160:163], v[152:155]
  ds_read_b64_tr_b16 v[196:197], v239 offset:57344
  v_mfma_f32_16x16x32_bf16 v[156:159], v[220:223], a[160:163], v[156:159]
  ds_read_b64_tr_b16 v[198:199], v239 offset:58368
  v_mfma_f32_16x16x32_bf16 v[176:179], v[208:211], a[168:171], v[176:179]
  ds_read_b64_tr_b16 v[200:201], v238 offset:57600
  v_mfma_f32_16x16x32_bf16 v[180:183], v[212:215], a[168:171], v[180:183]
  ds_read_b64_tr_b16 v[202:203], v238 offset:58624
  v_mfma_f32_16x16x32_bf16 v[184:187], v[216:219], a[168:171], v[184:187]
  s_mov_b32 s58, 20480
  ds_read_b64_tr_b16 v[204:205], v239 offset:57600
  ds_read_b64_tr_b16 v[206:207], v239 offset:58624
  v_mfma_f32_16x16x32_bf16 v[188:191], v[220:223], a[168:171], v[188:191]
  buffer_load_dwordx4 a[160:163], v225, s[32:35], s58 offen offset:0 sc1
  v_mfma_f32_16x16x32_bf16 v[80:83], v[208:211], a[164:167], v[80:83]
  v_mfma_f32_16x16x32_bf16 v[84:87], v[212:215], a[164:167], v[84:87]
  v_mfma_f32_16x16x32_bf16 v[88:91], v[216:219], a[164:167], v[88:91]
  v_mfma_f32_16x16x32_bf16 v[92:95], v[220:223], a[164:167], v[92:95]
  buffer_load_dwordx4 v249, s[40:43], s46 offen offset:1024 nt lds
  v_mfma_f32_16x16x32_bf16 v[112:115], v[208:211], a[172:175], v[112:115]
  v_mfma_f32_16x16x32_bf16 v[116:119], v[212:215], a[172:175], v[116:119]
  v_mfma_f32_16x16x32_bf16 v[120:123], v[216:219], a[172:175], v[120:123]
  v_mfma_f32_16x16x32_bf16 v[124:127], v[220:223], a[172:175], v[124:127]
  s_waitcnt lgkmcnt(0)
  s_waitcnt vmcnt(16)
  buffer_load_dwordx4 a[168:171], v225, s[32:35], s58 offen offset:1024 sc1
  v_mfma_f32_16x16x32_bf16 v[128:131], v[192:195], a[176:179], v[128:131]
  ds_read_b64_tr_b16 v[208:209], v238 offset:57856
  v_mfma_f32_16x16x32_bf16 v[132:135], v[196:199], a[176:179], v[132:135]
  ds_read_b64_tr_b16 v[210:211], v238 offset:58880
  v_mfma_f32_16x16x32_bf16 v[136:139], v[200:203], a[176:179], v[136:139]
  ds_read_b64_tr_b16 v[212:213], v239 offset:57856
  v_mfma_f32_16x16x32_bf16 v[140:143], v[204:207], a[176:179], v[140:143]
  ds_read_b64_tr_b16 v[214:215], v239 offset:58880
  v_mfma_f32_16x16x32_bf16 v[160:163], v[192:195], a[184:187], v[160:163]
  ds_read_b64_tr_b16 v[216:217], v238 offset:58112
  v_mfma_f32_16x16x32_bf16 v[164:167], v[196:199], a[184:187], v[164:167]
  ds_read_b64_tr_b16 v[218:219], v238 offset:59136
  v_mfma_f32_16x16x32_bf16 v[168:171], v[200:203], a[184:187], v[168:171]
  ds_read_b64_tr_b16 v[220:221], v239 offset:58112
  ds_read_b64_tr_b16 v[222:223], v239 offset:59136
  v_mfma_f32_16x16x32_bf16 v[172:175], v[204:207], a[184:187], v[172:175]
  buffer_load_dwordx4 a[164:167], v225, s[36:39], s58 offen offset:0 sc1
  v_mfma_f32_16x16x32_bf16 v[64:67], v[192:195], a[180:183], v[64:67]
  v_mfma_f32_16x16x32_bf16 v[68:71], v[196:199], a[180:183], v[68:71]
  v_mfma_f32_16x16x32_bf16 v[72:75], v[200:203], a[180:183], v[72:75]
  v_mfma_f32_16x16x32_bf16 v[76:79], v[204:207], a[180:183], v[76:79]
  buffer_load_dwordx4 v250, s[40:43], s46 offen offset:2048 nt lds
  v_mfma_f32_16x16x32_bf16 v[96:99], v[192:195], a[188:191], v[96:99]
  v_mfma_f32_16x16x32_bf16 v[100:103], v[196:199], a[188:191], v[100:103]
  v_mfma_f32_16x16x32_bf16 v[104:107], v[200:203], a[188:191], v[104:107]
  v_mfma_f32_16x16x32_bf16 v[108:111], v[204:207], a[188:191], v[108:111]
  s_waitcnt lgkmcnt(0)
  buffer_load_dwordx4 a[172:175], v225, s[36:39], s58 offen offset:1024 sc1
  v_mfma_f32_16x16x32_bf16 v[144:147], v[208:211], a[176:179], v[144:147]
  s_waitcnt vmcnt(25)
  s_barrier
  ds_read_b64_tr_b16 v[192:193], v234 offset:32768
  s_mov_b32 s12, s98
  v_mfma_f32_16x16x32_bf16 v[148:151], v[212:215], a[176:179], v[148:151]
  ds_read_b64_tr_b16 v[194:195], v234 offset:33792
  s_mov_b32 s13, s99
  v_mfma_f32_16x16x32_bf16 v[152:155], v[216:219], a[176:179], v[152:155]
  ds_read_b64_tr_b16 v[196:197], v235 offset:32768
  s_and_b32 s14, s2, 4
  v_mfma_f32_16x16x32_bf16 v[156:159], v[220:223], a[176:179], v[156:159]
  ds_read_b64_tr_b16 v[198:199], v235 offset:33792
  s_lshl_b32 s14, s14, 2
  v_mfma_f32_16x16x32_bf16 v[176:179], v[208:211], a[184:187], v[176:179]
  ds_read_b64_tr_b16 v[200:201], v234 offset:33024
  s_bfe_u32 s16, s2, 0x30003
  v_mfma_f32_16x16x32_bf16 v[180:183], v[212:215], a[184:187], v[180:183]
  ds_read_b64_tr_b16 v[202:203], v234 offset:34048
  s_lshl_b32 s16, s16, 1
  v_mfma_f32_16x16x32_bf16 v[184:187], v[216:219], a[184:187], v[184:187]
  ds_read_b64_tr_b16 v[204:205], v235 offset:33024
  ds_read_b64_tr_b16 v[206:207], v235 offset:34048
  v_mfma_f32_16x16x32_bf16 v[188:191], v[220:223], a[184:187], v[188:191]
  buffer_load_dwordx4 a[176:179], v225, s[32:35], s58 offen offset:2048 sc1
  v_mfma_f32_16x16x32_bf16 v[80:83], v[208:211], a[180:183], v[80:83]
  s_add_u32 s14, s14, s16
  s_bfe_u32 s16, s2, 0x10001
  v_mfma_f32_16x16x32_bf16 v[84:87], v[212:215], a[180:183], v[84:87]
  s_add_u32 s14, s14, s16
  v_mfma_f32_16x16x32_bf16 v[88:91], v[216:219], a[180:183], v[88:91]
  s_and_b32 s15, s2, 1
  s_lshl_b32 s15, s15, 2
  v_mfma_f32_16x16x32_bf16 v[92:95], v[220:223], a[180:183], v[92:95]
  buffer_load_dwordx4 v251, s[40:43], s46 offen offset:3072 nt lds
  v_mfma_f32_16x16x32_bf16 v[112:115], v[208:211], a[188:191], v[112:115]
  s_lshr_b32 s16, s2, 6
  s_add_u32 s15, s15, s16
  v_mfma_f32_16x16x32_bf16 v[116:119], v[212:215], a[188:191], v[116:119]
  s_lshl_b32 s16, s14, 6
  v_mfma_f32_16x16x32_bf16 v[120:123], v[216:219], a[188:191], v[120:123]
  s_lshl_b32 s17, s3, 4
  s_add_u32 s16, s16, s17
  v_mfma_f32_16x16x32_bf16 v[124:127], v[220:223], a[188:191], v[124:127]
  s_waitcnt lgkmcnt(0)
  s_waitcnt vmcnt(15)
  buffer_load_dwordx4 a[184:187], v225, s[32:35], s58 offen offset:3072 sc1
  v_mfma_f32_16x16x32_bf16 v[128:131], v[192:195], a[128:131], v[128:131]
  ds_read_b64_tr_b16 v[208:209], v234 offset:33280
  s_mul_i32 s16, s16, 1280
  v_mfma_f32_16x16x32_bf16 v[132:135], v[196:199], a[128:131], v[132:135]
  ds_read_b64_tr_b16 v[210:211], v234 offset:34304
  s_mul_i32 s18, s15, 160
  v_mfma_f32_16x16x32_bf16 v[136:139], v[200:203], a[128:131], v[136:139]
  ds_read_b64_tr_b16 v[212:213], v235 offset:33280
  s_add_u32 s19, s16, s18
  v_mfma_f32_16x16x32_bf16 v[140:143], v[204:207], a[128:131], v[140:143]
  ds_read_b64_tr_b16 v[214:215], v235 offset:34304
  v_add_u32 v4, 0, v224
  v_mfma_f32_16x16x32_bf16 v[160:163], v[192:195], a[136:139], v[160:163]
  ds_read_b64_tr_b16 v[216:217], v234 offset:33536
  v_mul_u32_u24 v5, 6554, v4
  v_mfma_f32_16x16x32_bf16 v[164:167], v[196:199], a[136:139], v[164:167]
  ds_read_b64_tr_b16 v[218:219], v234 offset:34560
  v_lshrrev_b32 v5, 16, v5
  v_mfma_f32_16x16x32_bf16 v[168:171], v[200:203], a[136:139], v[168:171]
  ds_read_b64_tr_b16 v[220:221], v235 offset:33536
  ds_read_b64_tr_b16 v[222:223], v235 offset:34560
  v_mfma_f32_16x16x32_bf16 v[172:175], v[204:207], a[136:139], v[172:175]
  buffer_load_dwordx4 a[180:183], v225, s[36:39], s58 offen offset:2048 sc1
  v_mfma_f32_16x16x32_bf16 v[64:67], v[192:195], a[132:135], v[64:67]
  v_lshlrev_b32 v4, 4, v4
  v_mul_u32_u24 v5, 1120, v5
  v_mfma_f32_16x16x32_bf16 v[68:71], v[196:199], a[132:135], v[68:71]
  v_add_u32 v8, v4, v5
  v_mfma_f32_16x16x32_bf16 v[72:75], v[200:203], a[132:135], v[72:75]
  s_add_u32 m0, s48, 98304
  s_add_u32 s46, s54, 4194304
  v_add_u32 v4, 64, v224
  v_mul_u32_u24 v5, 6554, v4
  v_mfma_f32_16x16x32_bf16 v[76:79], v[204:207], a[132:135], v[76:79]
  buffer_load_dwordx4 v248, s[40:43], s46 offen offset:0 nt lds
  v_mfma_f32_16x16x32_bf16 v[96:99], v[192:195], a[140:143], v[96:99]
  v_lshrrev_b32 v5, 16, v5
  v_lshlrev_b32 v4, 4, v4
  v_mfma_f32_16x16x32_bf16 v[100:103], v[196:199], a[140:143], v[100:103]
  v_mul_u32_u24 v5, 1120, v5
  v_mfma_f32_16x16x32_bf16 v[104:107], v[200:203], a[140:143], v[104:107]
  v_add_u32 v9, v4, v5
  v_add_u32 v4, 128, v224
  v_mfma_f32_16x16x32_bf16 v[108:111], v[204:207], a[140:143], v[108:111]
  s_waitcnt lgkmcnt(0)
  buffer_load_dwordx4 a[188:191], v225, s[36:39], s58 offen offset:3072 sc1
  v_mfma_f32_16x16x32_bf16 v[144:147], v[208:211], a[128:131], v[144:147]
  ds_read_b64_tr_b16 v[192:193], v234 offset:40960
  v_mul_u32_u24 v5, 6554, v4
  v_mfma_f32_16x16x32_bf16 v[148:151], v[212:215], a[128:131], v[148:151]
  ds_read_b64_tr_b16 v[194:195], v234 offset:41984
  v_lshrrev_b32 v5, 16, v5
  v_mfma_f32_16x16x32_bf16 v[152:155], v[216:219], a[128:131], v[152:155]
  ds_read_b64_tr_b16 v[196:197], v235 offset:40960
  v_lshlrev_b32 v4, 4, v4
  v_mfma_f32_16x16x32_bf16 v[156:159], v[220:223], a[128:131], v[156:159]
  ds_read_b64_tr_b16 v[198:199], v235 offset:41984
  v_mul_u32_u24 v5, 1120, v5
  v_mfma_f32_16x16x32_bf16 v[176:179], v[208:211], a[136:139], v[176:179]
  ds_read_b64_tr_b16 v[200:201], v234 offset:41216
  v_add_u32 v10, v4, v5
  v_mfma_f32_16x16x32_bf16 v[180:183], v[212:215], a[136:139], v[180:183]
  ds_read_b64_tr_b16 v[202:203], v234 offset:42240
  v_lshrrev_b32 v4, 5, v224
  v_mfma_f32_16x16x32_bf16 v[184:187], v[216:219], a[136:139], v[184:187]
  s_mov_b32 s58, 24576
  ds_read_b64_tr_b16 v[204:205], v235 offset:41216
  ds_read_b64_tr_b16 v[206:207], v235 offset:42240
  v_mfma_f32_16x16x32_bf16 v[188:191], v[220:223], a[136:139], v[188:191]
  buffer_load_dwordx4 a[128:131], v225, s[32:35], s58 offen offset:0 sc1
  v_mfma_f32_16x16x32_bf16 v[80:83], v[208:211], a[132:135], v[80:83]
  v_lshl_add_u32 v10, v4, 28, v10
  v_add_u32 v8, s19, v8
  v_mfma_f32_16x16x32_bf16 v[84:87], v[212:215], a[132:135], v[84:87]
  v_add_u32 v9, s19, v9
  v_mfma_f32_16x16x32_bf16 v[88:91], v[216:219], a[132:135], v[88:91]
  v_add_u32 v10, s19, v10
  s_mov_b32 s98, 2621440
  v_mfma_f32_16x16x32_bf16 v[92:95], v[220:223], a[132:135], v[92:95]
  buffer_load_dwordx4 v249, s[40:43], s46 offen offset:1024 nt lds
  v_mfma_f32_16x16x32_bf16 v[112:115], v[208:211], a[140:143], v[112:115]
  s_mov_b32 s99, 0x20000
  s_lshl_b32 s16, s15, 5
  v_mfma_f32_16x16x32_bf16 v[116:119], v[212:215], a[140:143], v[116:119]
  s_add_u32 s16, s16, s14
  v_mfma_f32_16x16x32_bf16 v[120:123], v[216:219], a[140:143], v[120:123]
  s_lshl_b32 s16, s16, 2
  s_add_u32 s16, s16, s3
  v_mfma_f32_16x16x32_bf16 v[124:127], v[220:223], a[140:143], v[124:127]
  s_waitcnt lgkmcnt(0)
  s_waitcnt vmcnt(14)
  buffer_load_dwordx4 a[136:139], v225, s[32:35], s58 offen offset:1024 sc1
  v_mfma_f32_16x16x32_bf16 v[128:131], v[192:195], a[144:147], v[128:131]
  ds_read_b64_tr_b16 v[208:209], v234 offset:41472
  s_lshl_b32 s16, s16, 10
  v_mfma_f32_16x16x32_bf16 v[132:135], v[196:199], a[144:147], v[132:135]
  ds_read_b64_tr_b16 v[210:211], v234 offset:42496
  s_add_u32 s16, s16, 100663296
  v_mfma_f32_16x16x32_bf16 v[136:139], v[200:203], a[144:147], v[136:139]
  ds_read_b64_tr_b16 v[212:213], v235 offset:41472
  v_add_u32 v11, s16, v225
  v_mfma_f32_16x16x32_bf16 v[140:143], v[204:207], a[144:147], v[140:143]
  ds_read_b64_tr_b16 v[214:215], v235 offset:42496
  v_mov_b32 v12, -1
  v_mfma_f32_16x16x32_bf16 v[160:163], v[192:195], a[152:155], v[160:163]
  ds_read_b64_tr_b16 v[216:217], v234 offset:41728
  v_mov_b32 v13, -1
  v_mfma_f32_16x16x32_bf16 v[164:167], v[196:199], a[152:155], v[164:167]
  ds_read_b64_tr_b16 v[218:219], v234 offset:42752
  v_mov_b32 v14, -1
  v_mfma_f32_16x16x32_bf16 v[168:171], v[200:203], a[152:155], v[168:171]
  ds_read_b64_tr_b16 v[220:221], v235 offset:41728
  ds_read_b64_tr_b16 v[222:223], v235 offset:42752
  v_mfma_f32_16x16x32_bf16 v[172:175], v[204:207], a[152:155], v[172:175]
  buffer_load_dwordx4 a[132:135], v225, s[36:39], s58 offen offset:0 sc1
  v_mfma_f32_16x16x32_bf16 v[64:67], v[192:195], a[148:151], v[64:67]
  v_mov_b32 v15, -1
  v_mfma_f32_16x16x32_bf16 v[68:71], v[196:199], a[148:151], v[68:71]
  v_mfma_f32_16x16x32_bf16 v[72:75], v[200:203], a[148:151], v[72:75]
  v_mfma_f32_16x16x32_bf16 v[76:79], v[204:207], a[148:151], v[76:79]
  buffer_load_dwordx4 v250, s[40:43], s46 offen offset:2048 nt lds
  v_mfma_f32_16x16x32_bf16 v[96:99], v[192:195], a[156:159], v[96:99]
  v_mfma_f32_16x16x32_bf16 v[100:103], v[196:199], a[156:159], v[100:103]
  global_store_dwordx4 v11, v[12:15], s[4:5] sc1
  v_mfma_f32_16x16x32_bf16 v[104:107], v[200:203], a[156:159], v[104:107]
  v_mfma_f32_16x16x32_bf16 v[108:111], v[204:207], a[156:159], v[108:111]
  s_waitcnt lgkmcnt(0)
  buffer_load_dwordx4 a[140:143], v225, s[36:39], s58 offen offset:1024 sc1
  v_mfma_f32_16x16x32_bf16 v[144:147], v[208:211], a[144:147], v[144:147]
  ds_read_b64_tr_b16 v[192:193], v234 offset:49152
  v_mfma_f32_16x16x32_bf16 v[148:151], v[212:215], a[144:147], v[148:151]
  ds_read_b64_tr_b16 v[194:195], v234 offset:50176
  v_mfma_f32_16x16x32_bf16 v[152:155], v[216:219], a[144:147], v[152:155]
  ds_read_b64_tr_b16 v[196:197], v235 offset:49152
  v_mfma_f32_16x16x32_bf16 v[156:159], v[220:223], a[144:147], v[156:159]
  ds_read_b64_tr_b16 v[198:199], v235 offset:50176
  v_mfma_f32_16x16x32_bf16 v[176:179], v[208:211], a[152:155], v[176:179]
  ds_read_b64_tr_b16 v[200:201], v234 offset:49408
  v_mfma_f32_16x16x32_bf16 v[180:183], v[212:215], a[152:155], v[180:183]
  ds_read_b64_tr_b16 v[202:203], v234 offset:50432
  v_mfma_f32_16x16x32_bf16 v[184:187], v[216:219], a[152:155], v[184:187]
  ds_read_b64_tr_b16 v[204:205], v235 offset:49408
  ds_read_b64_tr_b16 v[206:207], v235 offset:50432
  v_mfma_f32_16x16x32_bf16 v[188:191], v[220:223], a[152:155], v[188:191]
  buffer_load_dwordx4 a[144:147], v225, s[32:35], s58 offen offset:2048 sc1
  v_mfma_f32_16x16x32_bf16 v[80:83], v[208:211], a[148:151], v[80:83]
  s_waitcnt vmcnt(23)
  s_barrier
  s_cmp_lg_u32 s3, 0
  s_cbranch_scc1 L_adaL_nopush_13
  s_lshl_b32 s44, s6, 10
  s_lshl_b32 s45, s7, 2
  s_add_u32 s44, s44, s45
  v_lshlrev_b32 v244, 15, v224
  v_mov_b32 v245, 1
  s_mov_b64 exec, 0xff
  buffer_store_dword v245, v244, s[8:11], s44 offen offset:384 sc1
  s_mov_b64 exec, -1
L_adaL_nopush_13:
  v_mfma_f32_16x16x32_bf16 v[84:87], v[212:215], a[148:151], v[84:87]
  v_mfma_f32_16x16x32_bf16 v[88:91], v[216:219], a[148:151], v[88:91]
  v_mfma_f32_16x16x32_bf16 v[92:95], v[220:223], a[148:151], v[92:95]
  buffer_load_dwordx4 v251, s[40:43], s46 offen offset:3072 nt lds
  v_mfma_f32_16x16x32_bf16 v[112:115], v[208:211], a[156:159], v[112:115]
  v_mfma_f32_16x16x32_bf16 v[116:119], v[212:215], a[156:159], v[116:119]
  v_mfma_f32_16x16x32_bf16 v[120:123], v[216:219], a[156:159], v[120:123]
  v_mfma_f32_16x16x32_bf16 v[124:127], v[220:223], a[156:159], v[124:127]
  s_waitcnt lgkmcnt(0)
  s_waitcnt vmcnt(15)
  buffer_load_dwordx4 a[152:155], v225, s[32:35], s58 offen offset:3072 sc1
  v_mfma_f32_16x16x32_bf16 v[128:131], v[192:195], a[160:163], v[128:131]
  ds_read_b64_tr_b16 v[208:209], v234 offset:49664
  v_mfma_f32_16x16x32_bf16 v[132:135], v[196:199], a[160:163], v[132:135]
  ds_read_b64_tr_b16 v[210:211], v234 offset:50688
  v_mfma_f32_16x16x32_bf16 v[136:139], v[200:203], a[160:163], v[136:139]
  ds_read_b64_tr_b16 v[212:213], v235 offset:49664
  v_mfma_f32_16x16x32_bf16 v[140:143], v[204:207], a[160:163], v[140:143]
  ds_read_b64_tr_b16 v[214:215], v235 offset:50688
  v_mfma_f32_16x16x32_bf16 v[160:163], v[192:195], a[168:171], v[160:163]
  ds_read_b64_tr_b16 v[216:217], v234 offset:49920
  v_mfma_f32_16x16x32_bf16 v[164:167], v[196:199], a[168:171], v[164:167]
  ds_read_b64_tr_b16 v[218:219], v234 offset:50944
  v_mfma_f32_16x16x32_bf16 v[168:171], v[200:203], a[168:171], v[168:171]
  ds_read_b64_tr_b16 v[220:221], v235 offset:49920
  ds_read_b64_tr_b16 v[222:223], v235 offset:50944
  v_mfma_f32_16x16x32_bf16 v[172:175], v[204:207], a[168:171], v[172:175]
  buffer_load_dwordx4 a[148:151], v225, s[36:39], s58 offen offset:2048 sc1
  v_mfma_f32_16x16x32_bf16 v[64:67], v[192:195], a[164:167], v[64:67]
  s_lshl_b32 s44, s6, 19
  s_add_u32 s45, s44, 67108864
  s_lshl_b32 s57, s7, 15
  s_sub_u32 s57, 524288, s57
  s_add_u32 s24, s4, s45
  s_addc_u32 s25, s5, 0
  s_mov_b32 s26, s57
  s_mov_b32 s27, 0x20000
  v_mfma_f32_16x16x32_bf16 v[68:71], v[196:199], a[164:167], v[68:71]
  v_mfma_f32_16x16x32_bf16 v[72:75], v[200:203], a[164:167], v[72:75]
  s_add_u32 m0, s48, 102400
  s_add_u32 s46, s54, 4325376
  v_mfma_f32_16x16x32_bf16 v[76:79], v[204:207], a[164:167], v[76:79]
  buffer_load_dwordx4 v248, s[40:43], s46 offen offset:0 nt lds
  v_mfma_f32_16x16x32_bf16 v[96:99], v[192:195], a[172:175], v[96:99]
  v_mfma_f32_16x16x32_bf16 v[100:103], v[196:199], a[172:175], v[100:103]
  v_mfma_f32_16x16x32_bf16 v[104:107], v[200:203], a[172:175], v[104:107]
  v_mfma_f32_16x16x32_bf16 v[108:111], v[204:207], a[172:175], v[108:111]
  s_waitcnt lgkmcnt(0)
  buffer_load_dwordx4 a[156:159], v225, s[36:39], s58 offen offset:3072 sc1
  v_mfma_f32_16x16x32_bf16 v[144:147], v[208:211], a[160:163], v[144:147]
  ds_read_b64_tr_b16 v[192:193], v234 offset:57344
  v_mfma_f32_16x16x32_bf16 v[148:151], v[212:215], a[160:163], v[148:151]
  ds_read_b64_tr_b16 v[194:195], v234 offset:58368
  v_mfma_f32_16x16x32_bf16 v[152:155], v[216:219], a[160:163], v[152:155]
  ds_read_b64_tr_b16 v[196:197], v235 offset:57344
  v_mfma_f32_16x16x32_bf16 v[156:159], v[220:223], a[160:163], v[156:159]
  ds_read_b64_tr_b16 v[198:199], v235 offset:58368
  v_mfma_f32_16x16x32_bf16 v[176:179], v[208:211], a[168:171], v[176:179]
  ds_read_b64_tr_b16 v[200:201], v234 offset:57600
  v_mfma_f32_16x16x32_bf16 v[180:183], v[212:215], a[168:171], v[180:183]
  ds_read_b64_tr_b16 v[202:203], v234 offset:58624
  v_mfma_f32_16x16x32_bf16 v[184:187], v[216:219], a[168:171], v[184:187]
  s_mov_b32 s58, 28672
  ds_read_b64_tr_b16 v[204:205], v235 offset:57600
  ds_read_b64_tr_b16 v[206:207], v235 offset:58624
  v_mfma_f32_16x16x32_bf16 v[188:191], v[220:223], a[168:171], v[188:191]
  buffer_load_dwordx4 a[160:163], v225, s[32:35], s58 offen offset:0 sc1
  v_mfma_f32_16x16x32_bf16 v[80:83], v[208:211], a[164:167], v[80:83]
  s_add_u32 s45, s44, 83886080
  s_add_u32 s28, s4, s45
  s_addc_u32 s29, s5, 0
  s_mov_b32 s30, s57
  s_mov_b32 s31, 0x20000
  v_mfma_f32_16x16x32_bf16 v[84:87], v[212:215], a[164:167], v[84:87]
  v_mfma_f32_16x16x32_bf16 v[88:91], v[216:219], a[164:167], v[88:91]
  v_mfma_f32_16x16x32_bf16 v[92:95], v[220:223], a[164:167], v[92:95]
  buffer_load_dwordx4 v249, s[40:43], s46 offen offset:1024 nt lds
  v_mfma_f32_16x16x32_bf16 v[112:115], v[208:211], a[172:175], v[112:115]
  v_mfma_f32_16x16x32_bf16 v[116:119], v[212:215], a[172:175], v[116:119]
  v_mfma_f32_16x16x32_bf16 v[120:123], v[216:219], a[172:175], v[120:123]
  v_mfma_f32_16x16x32_bf16 v[124:127], v[220:223], a[172:175], v[124:127]
  s_waitcnt lgkmcnt(0)
  s_waitcnt vmcnt(15)
  buffer_load_dwordx4 a[168:171], v225, s[32:35], s58 offen offset:1024 sc1
  v_mfma_f32_16x16x32_bf16 v[128:131], v[192:195], a[176:179], v[128:131]
  ds_read_b64_tr_b16 v[208:209], v234 offset:57856
  v_mfma_f32_16x16x32_bf16 v[132:135], v[196:199], a[176:179], v[132:135]
  ds_read_b64_tr_b16 v[210:211], v234 offset:58880
  v_mfma_f32_16x16x32_bf16 v[136:139], v[200:203], a[176:179], v[136:139]
  ds_read_b64_tr_b16 v[212:213], v235 offset:57856
  v_mfma_f32_16x16x32_bf16 v[140:143], v[204:207], a[176:179], v[140:143]
  ds_read_b64_tr_b16 v[214:215], v235 offset:58880
  v_mfma_f32_16x16x32_bf16 v[160:163], v[192:195], a[184:187], v[160:163]
  ds_read_b64_tr_b16 v[216:217], v234 offset:58112
  v_mfma_f32_16x16x32_bf16 v[164:167], v[196:199], a[184:187], v[164:167]
  ds_read_b64_tr_b16 v[218:219], v234 offset:59136
  v_mfma_f32_16x16x32_bf16 v[168:171], v[200:203], a[184:187], v[168:171]
  ds_read_b64_tr_b16 v[220:221], v235 offset:58112
  ds_read_b64_tr_b16 v[222:223], v235 offset:59136
  v_mfma_f32_16x16x32_bf16 v[172:175], v[204:207], a[184:187], v[172:175]
  buffer_load_dwordx4 a[164:167], v225, s[36:39], s58 offen offset:0 sc1
  v_mfma_f32_16x16x32_bf16 v[64:67], v[192:195], a[180:183], v[64:67]
  v_mfma_f32_16x16x32_bf16 v[68:71], v[196:199], a[180:183], v[68:71]
  v_mfma_f32_16x16x32_bf16 v[72:75], v[200:203], a[180:183], v[72:75]
  v_mfma_f32_16x16x32_bf16 v[76:79], v[204:207], a[180:183], v[76:79]
  buffer_load_dwordx4 v250, s[40:43], s46 offen offset:2048 nt lds
  v_mfma_f32_16x16x32_bf16 v[96:99], v[192:195], a[188:191], v[96:99]
  v_mfma_f32_16x16x32_bf16 v[100:103], v[196:199], a[188:191], v[100:103]
  v_mfma_f32_16x16x32_bf16 v[104:107], v[200:203], a[188:191], v[104:107]
  v_mfma_f32_16x16x32_bf16 v[108:111], v[204:207], a[188:191], v[108:111]
  s_waitcnt lgkmcnt(0)
  buffer_load_dwordx4 a[172:175], v225, s[36:39], s58 offen offset:1024 sc1
  v_mfma_f32_16x16x32_bf16 v[144:147], v[208:211], a[176:179], v[144:147]
  s_waitcnt vmcnt(23)
  s_barrier
  ds_read_b64_tr_b16 v[192:193], v236 offset:0
  v_mfma_f32_16x16x32_bf16 v[148:151], v[212:215], a[176:179], v[148:151]
  ds_read_b64_tr_b16 v[194:195], v236 offset:1024
  v_mfma_f32_16x16x32_bf16 v[152:155], v[216:219], a[176:179], v[152:155]
  ds_read_b64_tr_b16 v[196:197], v237 offset:0
  v_mfma_f32_16x16x32_bf16 v[156:159], v[220:223], a[176:179], v[156:159]
  ds_read_b64_tr_b16 v[198:199], v237 offset:1024
  v_mfma_f32_16x16x32_bf16 v[176:179], v[208:211], a[184:187], v[176:179]
  ds_read_b64_tr_b16 v[200:201], v236 offset:256
  v_mfma_f32_16x16x32_bf16 v[180:183], v[212:215], a[184:187], v[180:183]
  ds_read_b64_tr_b16 v[202:203], v236 offset:1280
  v_mfma_f32_16x16x32_bf16 v[184:187], v[216:219], a[184:187], v[184:187]
  ds_read_b64_tr_b16 v[204:205], v237 offset:256
  ds_read_b64_tr_b16 v[206:207], v237 offset:1280
  v_mfma_f32_16x16x32_bf16 v[188:191], v[220:223], a[184:187], v[188:191]
  buffer_load_dwordx4 a[176:179], v225, s[32:35], s58 offen offset:2048 sc1
  v_mfma_f32_16x16x32_bf16 v[80:83], v[208:211], a[180:183], v[80:83]
  v_mfma_f32_16x16x32_bf16 v[84:87], v[212:215], a[180:183], v[84:87]
  v_mfma_f32_16x16x32_bf16 v[88:91], v[216:219], a[180:183], v[88:91]
  v_mfma_f32_16x16x32_bf16 v[92:95], v[220:223], a[180:183], v[92:95]
  buffer_load_dwordx4 v251, s[40:43], s46 offen offset:3072 nt lds
  v_mfma_f32_16x16x32_bf16 v[112:115], v[208:211], a[188:191], v[112:115]
  v_mfma_f32_16x16x32_bf16 v[116:119], v[212:215], a[188:191], v[116:119]
  v_mfma_f32_16x16x32_bf16 v[120:123], v[216:219], a[188:191], v[120:123]
  v_mfma_f32_16x16x32_bf16 v[124:127], v[220:223], a[188:191], v[124:127]
  s_waitcnt lgkmcnt(0)
  s_waitcnt vmcnt(14)
  buffer_load_dwordx4 a[184:187], v225, s[32:35], s58 offen offset:3072 sc1
  v_mfma_f32_16x16x32_bf16 v[128:131], v[192:195], a[128:131], v[128:131]
  ds_read_b64_tr_b16 v[208:209], v236 offset:512
  v_mfma_f32_16x16x32_bf16 v[132:135], v[196:199], a[128:131], v[132:135]
  ds_read_b64_tr_b16 v[210:211], v236 offset:1536
  v_mfma_f32_16x16x32_bf16 v[136:139], v[200:203], a[128:131], v[136:139]
  ds_read_b64_tr_b16 v[212:213], v237 offset:512
  v_mfma_f32_16x16x32_bf16 v[140:143], v[204:207], a[128:131], v[140:143]
  ds_read_b64_tr_b16 v[214:215], v237 offset:1536
  v_mfma_f32_16x16x32_bf16 v[160:163], v[192:195], a[136:139], v[160:163]
  ds_read_b64_tr_b16 v[216:217], v236 offset:768
  v_mfma_f32_16x16x32_bf16 v[164:167], v[196:199], a[136:139], v[164:167]
  ds_read_b64_tr_b16 v[218:219], v236 offset:1792
  v_mfma_f32_16x16x32_bf16 v[168:171], v[200:203], a[136:139], v[168:171]
  ds_read_b64_tr_b16 v[220:221], v237 offset:768
  ds_read_b64_tr_b16 v[222:223], v237 offset:1792
  v_mfma_f32_16x16x32_bf16 v[172:175], v[204:207], a[136:139], v[172:175]
  buffer_load_dwordx4 a[180:183], v225, s[36:39], s58 offen offset:2048 sc1
  v_mfma_f32_16x16x32_bf16 v[64:67], v[192:195], a[132:135], v[64:67]
  v_mfma_f32_16x16x32_bf16 v[68:71], v[196:199], a[132:135], v[68:71]
  v_mfma_f32_16x16x32_bf16 v[72:75], v[200:203], a[132:135], v[72:75]
  v_mfma_f32_16x16x32_bf16 v[76:79], v[204:207], a[132:135], v[76:79]
  v_mfma_f32_16x16x32_bf16 v[96:99], v[192:195], a[140:143], v[96:99]
  v_mfma_f32_16x16x32_bf16 v[100:103], v[196:199], a[140:143], v[100:103]
  v_mfma_f32_16x16x32_bf16 v[104:107], v[200:203], a[140:143], v[104:107]
  v_mfma_f32_16x16x32_bf16 v[108:111], v[204:207], a[140:143], v[108:111]
  s_waitcnt lgkmcnt(0)
  buffer_load_dwordx4 a[188:191], v225, s[36:39], s58 offen offset:3072 sc1
  v_mfma_f32_16x16x32_bf16 v[144:147], v[208:211], a[128:131], v[144:147]
  ds_read_b64_tr_b16 v[192:193], v236 offset:8192
  s_cmp_eq_u32 s63, 16
  s_cselect_b32 s59, 8, s63
  s_cselect_b32 s63, 16, 8
  v_mfma_f32_16x16x32_bf16 v[148:151], v[212:215], a[128:131], v[148:151]
  ds_read_b64_tr_b16 v[194:195], v236 offset:9216
  v_bfe_u32 v240, v224, 1, 3
  v_mfma_f32_16x16x32_bf16 v[152:155], v[216:219], a[128:131], v[152:155]
  ds_read_b64_tr_b16 v[196:197], v237 offset:8192
  v_bfe_u32 v241, v224, 4, 1
  v_mfma_f32_16x16x32_bf16 v[156:159], v[220:223], a[128:131], v[156:159]
  ds_read_b64_tr_b16 v[198:199], v237 offset:9216
  v_mad_u32_u24 v240, v241, s59, v240
  v_mfma_f32_16x16x32_bf16 v[176:179], v[208:211], a[136:139], v[176:179]
  ds_read_b64_tr_b16 v[200:201], v236 offset:8448
  v_lshrrev_b32 v242, 5, v224
  v_mfma_f32_16x16x32_bf16 v[180:183], v[212:215], a[136:139], v[180:183]
  ds_read_b64_tr_b16 v[202:203], v236 offset:9472
  v_and_b32 v243, 1, v224
  v_mfma_f32_16x16x32_bf16 v[184:187], v[216:219], a[136:139], v[184:187]
  s_mov_b32 s58, 32768
  ds_read_b64_tr_b16 v[204:205], v237 offset:8448
  ds_read_b64_tr_b16 v[206:207], v237 offset:9472
  v_mfma_f32_16x16x32_bf16 v[188:191], v[220:223], a[136:139], v[188:191]
  buffer_load_dwordx4 a[128:131], v225, s[32:35], s58 offen offset:0 sc1
  v_mfma_f32_16x16x32_bf16 v[80:83], v[208:211], a[132:135], v[80:83]
  v_lshlrev_b32 v243, 4, v243
  v_mad_u32_u24 v253, v242, s63, v240
  v_mfma_f32_16x16x32_bf16 v[84:87], v[212:215], a[132:135], v[84:87]
  v_mad_u32_u24 v253, v253, s62, v243
  v_mfma_f32_16x16x32_bf16 v[88:91], v[216:219], a[132:135], v[88:91]
  v_lshrrev_b32 v252, 1, v224
  v_mul_u32_u24 v252, 1280, v252
  v_mfma_f32_16x16x32_bf16 v[92:95], v[220:223], a[132:135], v[92:95]
  v_add_u32 v252, v252, v243
  v_mfma_f32_16x16x32_bf16 v[112:115], v[208:211], a[140:143], v[112:115]
  s_lshr_b32 s60, s2, 4
  s_sub_u32 s60, 15, s60
  v_mfma_f32_16x16x32_bf16 v[116:119], v[212:215], a[140:143], v[116:119]
  s_lshl_b32 s60, s60, 6
  v_mfma_f32_16x16x32_bf16 v[120:123], v[216:219], a[140:143], v[120:123]
  s_and_b32 s61, s2, 7
  s_lshl_b32 s61, s61, 3
  v_mfma_f32_16x16x32_bf16 v[124:127], v[220:223], a[140:143], v[124:127]
  s_waitcnt lgkmcnt(0)
  s_waitcnt vmcnt(12)
  buffer_load_dwordx4 a[136:139], v225, s[32:35], s58 offen offset:1024 sc1
  v_mfma_f32_16x16x32_bf16 v[128:131], v[192:195], a[144:147], v[128:131]
  ds_read_b64_tr_b16 v[208:209], v236 offset:8704
  s_add_u32 s59, s60, s61
  v_mfma_f32_16x16x32_bf16 v[132:135], v[196:199], a[144:147], v[132:135]
  ds_read_b64_tr_b16 v[210:211], v236 offset:9728
  s_bfe_u32 s61, s2, 0x10003
  v_mfma_f32_16x16x32_bf16 v[136:139], v[200:203], a[144:147], v[136:139]
  ds_read_b64_tr_b16 v[212:213], v237 offset:8704
  s_lshl_b32 s61, s61, 2
  v_mfma_f32_16x16x32_bf16 v[140:143], v[204:207], a[144:147], v[140:143]
  ds_read_b64_tr_b16 v[214:215], v237 offset:9728
  s_add_u32 s59, s59, s61
  v_mfma_f32_16x16x32_bf16 v[160:163], v[192:195], a[152:155], v[160:163]
  ds_read_b64_tr_b16 v[216:217], v236 offset:8960
  s_add_u32 s59, s59, s3
  v_mfma_f32_16x16x32_bf16 v[164:167], v[196:199], a[152:155], v[164:167]
  ds_read_b64_tr_b16 v[218:219], v236 offset:9984
  s_mov_b32 s20, s100
  v_mfma_f32_16x16x32_bf16 v[168:171], v[200:203], a[152:155], v[168:171]
  ds_read_b64_tr_b16 v[220:221], v237 offset:8960
  ds_read_b64_tr_b16 v[222:223], v237 offset:9984
  v_mfma_f32_16x16x32_bf16 v[172:175], v[204:207], a[152:155], v[172:175]
  buffer_load_dwordx4 a[132:135], v225, s[36:39], s58 offen offset:0 sc1
  v_mfma_f32_16x16x32_bf16 v[64:67], v[192:195], a[148:151], v[64:67]
  s_mov_b32 s21, s101
  s_mov_b32 s14, 5242880
  v_mfma_f32_16x16x32_bf16 v[68:71], v[196:199], a[148:151], v[68:71]
  s_mov_b32 s15, 0x20000
  v_mfma_f32_16x16x32_bf16 v[72:75], v[200:203], a[148:151], v[72:75]
  s_mov_b32 s22, 8388608
  s_mov_b32 s23, 0x20000
  v_mfma_f32_16x16x32_bf16 v[76:79], v[204:207], a[148:151], v[76:79]
  s_lshr_b32 s60, s59, 3
  v_mfma_f32_16x16x32_bf16 v[96:99], v[192:195], a[156:159], v[96:99]
  s_and_b32 s61, s59, 7
  s_lshl_b32 s62, s61, 7
  v_mfma_f32_16x16x32_bf16 v[100:103], v[196:199], a[156:159], v[100:103]
  s_add_u32 s62, s62, s60
  v_mfma_f32_16x16x32_bf16 v[104:107], v[200:203], a[156:159], v[104:107]
  s_mul_i32 s62, s62, 5120
  s_add_u32 s62, s62, 23068672
  v_mfma_f32_16x16x32_bf16 v[108:111], v[204:207], a[156:159], v[108:111]
  s_waitcnt lgkmcnt(0)
  buffer_load_dwordx4 a[140:143], v225, s[36:39], s58 offen offset:1024 sc1
  v_mfma_f32_16x16x32_bf16 v[144:147], v[208:211], a[144:147], v[144:147]
  ds_read_b64_tr_b16 v[192:193], v236 offset:16384
  s_add_u32 s16, s4, s62
  s_addc_u32 s17, s5, 0
  s_mov_b32 s18, 5120
  s_mov_b32 s19, 0x20000
  v_mfma_f32_16x16x32_bf16 v[148:151], v[212:215], a[144:147], v[148:151]
  ds_read_b64_tr_b16 v[194:195], v236 offset:17408
  s_add_u32 s62, s7, 1
  v_mfma_f32_16x16x32_bf16 v[152:155], v[216:219], a[144:147], v[152:155]
  ds_read_b64_tr_b16 v[196:197], v237 offset:16384
  s_mul_i32 s62, s62, s7
  v_mfma_f32_16x16x32_bf16 v[156:159], v[220:223], a[144:147], v[156:159]
  ds_read_b64_tr_b16 v[198:199], v237 offset:17408
  s_cmp_ge_u32 s7, 6
  s_cselect_b32 s63, 2, 0
  v_mfma_f32_16x16x32_bf16 v[176:179], v[208:211], a[152:155], v[176:179]
  ds_read_b64_tr_b16 v[200:201], v236 offset:16640
  s_sub_u32 s62, s62, s63
  v_mfma_f32_16x16x32_bf16 v[180:183], v[212:215], a[152:155], v[180:183]
  ds_read_b64_tr_b16 v[202:203], v236 offset:17664
  s_cmp_eq_u32 s7, 7
  s_cselect_b32 s62, 52, s62
  v_mfma_f32_16x16x32_bf16 v[184:187], v[216:219], a[152:155], v[184:187]
  ds_read_b64_tr_b16 v[204:205], v237 offset:16640
  ds_read_b64_tr_b16 v[206:207], v237 offset:17664
  v_mfma_f32_16x16x32_bf16 v[188:191], v[220:223], a[152:155], v[188:191]
  buffer_load_dwordx4 a[144:147], v225, s[32:35], s58 offen offset:2048 sc1
  v_mfma_f32_16x16x32_bf16 v[80:83], v[208:211], a[148:151], v[80:83]
  s_lshl_b32 s51, s7, 5
  s_add_u32 s51, s51, s6
  s_lshl_b32 s51, s51, 10
  v_and_b32 v246, 7, v224
  v_lshl_add_u32 v246, v246, 2, s51
  buffer_load_dword v247, v246, s[8:11], 0 offen offset:384 sc1
  s_lshl_b32 s100, s7, 1
  s_add_u32 s100, s100, 2
  v_mfma_f32_16x16x32_bf16 v[84:87], v[212:215], a[148:151], v[84:87]
  s_min_u32 s100, s100, 10
  v_mfma_f32_16x16x32_bf16 v[88:91], v[216:219], a[148:151], v[88:91]
  s_add_u32 s100, s100, s63
  s_lshl_b32 s56, s6, 2
  v_mfma_f32_16x16x32_bf16 v[92:95], v[220:223], a[148:151], v[92:95]
  s_add_u32 s56, s56, s3
  v_mfma_f32_16x16x32_bf16 v[112:115], v[208:211], a[156:159], v[112:115]
  s_lshl_b32 s56, s56, 10
  s_add_u32 s56, s56, s62
  v_mfma_f32_16x16x32_bf16 v[116:119], v[212:215], a[156:159], v[116:119]
  s_lshl_b32 s56, s56, 6
  v_mfma_f32_16x16x32_bf16 v[120:123], v[216:219], a[156:159], v[120:123]
  s_lshl_b32 s63, s6, 6
  s_add_u32 s62, s62, s63
  v_mfma_f32_16x16x32_bf16 v[124:127], v[220:223], a[156:159], v[124:127]
  s_waitcnt lgkmcnt(0)
  s_waitcnt vmcnt(11)
  buffer_load_dwordx4 a[152:155], v225, s[32:35], s58 offen offset:3072 sc1
  v_mfma_f32_16x16x32_bf16 v[128:131], v[192:195], a[160:163], v[128:131]
  ds_read_b64_tr_b16 v[208:209], v236 offset:16896
  s_lshl_b32 s62, s62, 2
  v_mfma_f32_16x16x32_bf16 v[132:135], v[196:199], a[160:163], v[132:135]
  ds_read_b64_tr_b16 v[210:211], v236 offset:17920
  s_add_u32 s62, s62, s3
  v_mfma_f32_16x16x32_bf16 v[136:139], v[200:203], a[160:163], v[136:139]
  ds_read_b64_tr_b16 v[212:213], v237 offset:16896
  s_lshl_b32 s62, s62, 10
  v_mfma_f32_16x16x32_bf16 v[140:143], v[204:207], a[160:163], v[140:143]
  ds_read_b64_tr_b16 v[214:215], v237 offset:17920
  s_add_u32 s62, s62, 102760448
  v_mfma_f32_16x16x32_bf16 v[160:163], v[192:195], a[168:171], v[160:163]
  ds_read_b64_tr_b16 v[216:217], v236 offset:17152
  s_lshl_b32 s63, s100, 12
  v_mfma_f32_16x16x32_bf16 v[164:167], v[196:199], a[168:171], v[164:167]
  ds_read_b64_tr_b16 v[218:219], v236 offset:18176
  s_sub_u32 s63, s63, 3072
  v_mfma_f32_16x16x32_bf16 v[168:171], v[200:203], a[168:171], v[168:171]
  ds_read_b64_tr_b16 v[220:221], v237 offset:17152
  ds_read_b64_tr_b16 v[222:223], v237 offset:18176
  v_mfma_f32_16x16x32_bf16 v[172:175], v[204:207], a[168:171], v[172:175]
  buffer_load_dwordx4 a[148:151], v225, s[36:39], s58 offen offset:2048 sc1
  v_mfma_f32_16x16x32_bf16 v[64:67], v[192:195], a[164:167], v[64:67]
  s_add_u32 s52, s4, s62
  s_addc_u32 s53, s5, 0
  s_mov_b32 s54, s63
  s_mov_b32 s55, 0x20000
  s_lshl_b32 s100, s100, 6
  v_mfma_f32_16x16x32_bf16 v[68:71], v[196:199], a[164:167], v[68:71]
  s_add_u32 s100, s100, s56
  v_mfma_f32_16x16x32_bf16 v[72:75], v[200:203], a[164:167], v[72:75]
  s_mov_b32 s57, 0
  v_bfe_u32 v240, v224, 2, 1
  v_mfma_f32_16x16x32_bf16 v[76:79], v[204:207], a[164:167], v[76:79]
  v_and_b32 v241, 3, v224
  v_mfma_f32_16x16x32_bf16 v[96:99], v[192:195], a[172:175], v[96:99]
  v_lshl_add_u32 v240, v240, 3, v241
  v_bfe_u32 v241, v224, 3, 1
  v_mfma_f32_16x16x32_bf16 v[100:103], v[196:199], a[172:175], v[100:103]
  v_lshl_add_u32 v240, v241, 2, v240
  v_mfma_f32_16x16x32_bf16 v[104:107], v[200:203], a[172:175], v[104:107]
  v_lshrrev_b32 v241, 4, v224
  v_lshlrev_b32 v241, 4, v241
  v_mfma_f32_16x16x32_bf16 v[108:111], v[204:207], a[172:175], v[108:111]
  s_waitcnt lgkmcnt(0)
  buffer_load_dwordx4 a[156:159], v225, s[36:39], s58 offen offset:3072 sc1
  v_mfma_f32_16x16x32_bf16 v[144:147], v[208:211], a[160:163], v[144:147]
  ds_read_b64_tr_b16 v[192:193], v236 offset:24576
  v_lshl_add_u32 v255, v240, 12, v241
  v_mfma_f32_16x16x32_bf16 v[148:151], v[212:215], a[160:163], v[148:151]
  ds_read_b64_tr_b16 v[194:195], v236 offset:25600
  v_mfma_f32_16x16x32_bf16 v[152:155], v[216:219], a[160:163], v[152:155]
  ds_read_b64_tr_b16 v[196:197], v237 offset:24576
  v_mfma_f32_16x16x32_bf16 v[156:159], v[220:223], a[160:163], v[156:159]
  ds_read_b64_tr_b16 v[198:199], v237 offset:25600
  v_mfma_f32_16x16x32_bf16 v[176:179], v[208:211], a[168:171], v[176:179]
  ds_read_b64_tr_b16 v[200:201], v236 offset:24832
  v_mfma_f32_16x16x32_bf16 v[180:183], v[212:215], a[168:171], v[180:183]
  ds_read_b64_tr_b16 v[202:203], v236 offset:25856
  v_mfma_f32_16x16x32_bf16 v[184:187], v[216:219], a[168:171], v[184:187]
  s_mov_b32 s58, 36864
  ds_read_b64_tr_b16 v[204:205], v237 offset:24832
  ds_read_b64_tr_b16 v[206:207], v237 offset:25856
  v_mfma_f32_16x16x32_bf16 v[188:191], v[220:223], a[168:171], v[188:191]
  buffer_load_dwordx4 a[160:163], v225, s[32:35], s58 offen offset:0 sc1
  v_mfma_f32_16x16x32_bf16 v[80:83], v[208:211], a[164:167], v[80:83]
  v_mfma_f32_16x16x32_bf16 v[84:87], v[212:215], a[164:167], v[84:87]
  v_mfma_f32_16x16x32_bf16 v[88:91], v[216:219], a[164:167], v[88:91]
  v_mfma_f32_16x16x32_bf16 v[92:95], v[220:223], a[164:167], v[92:95]
  v_mfma_f32_16x16x32_bf16 v[112:115], v[208:211], a[172:175], v[112:115]
  v_mfma_f32_16x16x32_bf16 v[116:119], v[212:215], a[172:175], v[116:119]
  v_mfma_f32_16x16x32_bf16 v[120:123], v[216:219], a[172:175], v[120:123]
  v_mfma_f32_16x16x32_bf16 v[124:127], v[220:223], a[172:175], v[124:127]
  s_waitcnt lgkmcnt(0)
  s_waitcnt vmcnt(10)
  buffer_load_dwordx4 a[168:171], v225, s[32:35], s58 offen offset:1024 sc1
  v_mfma_f32_16x16x32_bf16 v[128:131], v[192:195], a[176:179], v[128:131]
  ds_read_b64_tr_b16 v[208:209], v236 offset:25088
  v_mfma_f32_16x16x32_bf16 v[132:135], v[196:199], a[176:179], v[132:135]
  ds_read_b64_tr_b16 v[210:211], v236 offset:26112
  v_mfma_f32_16x16x32_bf16 v[136:139], v[200:203], a[176:179], v[136:139]
  ds_read_b64_tr_b16 v[212:213], v237 offset:25088
  v_mfma_f32_16x16x32_bf16 v[140:143], v[204:207], a[176:179], v[140:143]
  ds_read_b64_tr_b16 v[214:215], v237 offset:26112
  v_mfma_f32_16x16x32_bf16 v[160:163], v[192:195], a[184:187], v[160:163]
  ds_read_b64_tr_b16 v[216:217], v236 offset:25344
  v_mfma_f32_16x16x32_bf16 v[164:167], v[196:199], a[184:187], v[164:167]
  ds_read_b64_tr_b16 v[218:219], v236 offset:26368
  v_mfma_f32_16x16x32_bf16 v[168:171], v[200:203], a[184:187], v[168:171]
  ds_read_b64_tr_b16 v[220:221], v237 offset:25344
  ds_read_b64_tr_b16 v[222:223], v237 offset:26368
  v_mfma_f32_16x16x32_bf16 v[172:175], v[204:207], a[184:187], v[172:175]
  buffer_load_dwordx4 a[164:167], v225, s[36:39], s58 offen offset:0 sc1
  v_mfma_f32_16x16x32_bf16 v[64:67], v[192:195], a[180:183], v[64:67]
  v_mfma_f32_16x16x32_bf16 v[68:71], v[196:199], a[180:183], v[68:71]
  v_mfma_f32_16x16x32_bf16 v[72:75], v[200:203], a[180:183], v[72:75]
  v_mfma_f32_16x16x32_bf16 v[76:79], v[204:207], a[180:183], v[76:79]
  v_mfma_f32_16x16x32_bf16 v[96:99], v[192:195], a[188:191], v[96:99]
  s_waitcnt vmcnt(6)
  v_cmp_eq_u32 vcc, 0, v247
  s_cbranch_vccnz L_adaL_spin_14
L_adaL_spun_15:
  v_mfma_f32_16x16x32_bf16 v[100:103], v[196:199], a[188:191], v[100:103]
  v_mfma_f32_16x16x32_bf16 v[104:107], v[200:203], a[188:191], v[104:107]
  v_mfma_f32_16x16x32_bf16 v[108:111], v[204:207], a[188:191], v[108:111]
  s_waitcnt lgkmcnt(0)
  buffer_load_dwordx4 a[172:175], v225, s[36:39], s58 offen offset:1024 sc1
  v_mfma_f32_16x16x32_bf16 v[144:147], v[208:211], a[176:179], v[144:147]
  s_waitcnt vmcnt(16)
  s_barrier
  s_add_u32 s46, s48, 0
  s_add_u32 m0, s46, 0
  s_nop 0
  ds_read_b64_tr_b16 v[192:193], v238 offset:32768
  ds_read_b64_tr_b16 v[194:195], v238 offset:33792
  v_mfma_f32_16x16x32_bf16 v[148:151], v[212:215], a[176:179], v[148:151]
  buffer_load_dwordx4 v225, s[24:27], s46 offen offset:0 sc1 lds
  v_mfma_f32_16x16x32_bf16 v[152:155], v[216:219], a[176:179], v[152:155]
  ds_read_b64_tr_b16 v[196:197], v239 offset:32768
  v_mfma_f32_16x16x32_bf16 v[156:159], v[220:223], a[176:179], v[156:159]
  ds_read_b64_tr_b16 v[198:199], v239 offset:33792
  v_mfma_f32_16x16x32_bf16 v[176:179], v[208:211], a[184:187], v[176:179]
  ds_read_b64_tr_b16 v[200:201], v238 offset:33024
  v_mfma_f32_16x16x32_bf16 v[180:183], v[212:215], a[184:187], v[180:183]
  ds_read_b64_tr_b16 v[202:203], v238 offset:34048
  v_mfma_f32_16x16x32_bf16 v[184:187], v[216:219], a[184:187], v[184:187]
  ds_read_b64_tr_b16 v[204:205], v239 offset:33024
  ds_read_b64_tr_b16 v[206:207], v239 offset:34048
  v_mfma_f32_16x16x32_bf16 v[188:191], v[220:223], a[184:187], v[188:191]
  buffer_load_dwordx4 a[176:179], v225, s[32:35], s58 offen offset:2048 sc1
  v_mfma_f32_16x16x32_bf16 v[80:83], v[208:211], a[180:183], v[80:83]
  v_mfma_f32_16x16x32_bf16 v[84:87], v[212:215], a[180:183], v[84:87]
  buffer_load_dwordx4 v225, s[24:27], s46 offen offset:1024 sc1 lds
  v_mfma_f32_16x16x32_bf16 v[88:91], v[216:219], a[180:183], v[88:91]
  v_mfma_f32_16x16x32_bf16 v[92:95], v[220:223], a[180:183], v[92:95]
  v_mfma_f32_16x16x32_bf16 v[112:115], v[208:211], a[188:191], v[112:115]
  v_mfma_f32_16x16x32_bf16 v[116:119], v[212:215], a[188:191], v[116:119]
  buffer_load_dwordx4 v225, s[24:27], s46 offen offset:2048 sc1 lds
  v_mfma_f32_16x16x32_bf16 v[120:123], v[216:219], a[188:191], v[120:123]
  v_mfma_f32_16x16x32_bf16 v[124:127], v[220:223], a[188:191], v[124:127]
  s_waitcnt lgkmcnt(0)
  s_waitcnt vmcnt(13)
  buffer_load_dwordx4 a[184:187], v225, s[32:35], s58 offen offset:3072 sc1
  v_mfma_f32_16x16x32_bf16 v[128:131], v[192:195], a[128:131], v[128:131]
  ds_read_b64_tr_b16 v[208:209], v238 offset:33280
  v_mfma_f32_16x16x32_bf16 v[132:135], v[196:199], a[128:131], v[132:135]
  ds_read_b64_tr_b16 v[210:211], v238 offset:34304
  v_mfma_f32_16x16x32_bf16 v[136:139], v[200:203], a[128:131], v[136:139]
  ds_read_b64_tr_b16 v[212:213], v239 offset:33280
  ds_read_b64_tr_b16 v[214:215], v239 offset:34304
  v_mfma_f32_16x16x32_bf16 v[140:143], v[204:207], a[128:131], v[140:143]
  buffer_load_dwordx4 v225, s[24:27], s46 offen offset:3072 sc1 lds
  v_mfma_f32_16x16x32_bf16 v[160:163], v[192:195], a[136:139], v[160:163]
  ds_read_b64_tr_b16 v[216:217], v238 offset:33536
  v_mfma_f32_16x16x32_bf16 v[164:167], v[196:199], a[136:139], v[164:167]
  ds_read_b64_tr_b16 v[218:219], v238 offset:34560
  v_mfma_f32_16x16x32_bf16 v[168:171], v[200:203], a[136:139], v[168:171]
  ds_read_b64_tr_b16 v[220:221], v239 offset:33536
  ds_read_b64_tr_b16 v[222:223], v239 offset:34560
  v_mfma_f32_16x16x32_bf16 v[172:175], v[204:207], a[136:139], v[172:175]
  buffer_load_dwordx4 a[180:183], v225, s[36:39], s58 offen offset:2048 sc1
  v_mfma_f32_16x16x32_bf16 v[64:67], v[192:195], a[132:135], v[64:67]
  s_add_u32 s46, s48, 4096
  s_add_u32 m0, s46, 0
  s_nop 0
  v_mfma_f32_16x16x32_bf16 v[68:71], v[196:199], a[132:135], v[68:71]
  buffer_load_dwordx4 v225, s[24:27], s46 offen offset:0 sc1 lds
  v_mfma_f32_16x16x32_bf16 v[72:75], v[200:203], a[132:135], v[72:75]
  v_mfma_f32_16x16x32_bf16 v[76:79], v[204:207], a[132:135], v[76:79]
  v_mfma_f32_16x16x32_bf16 v[96:99], v[192:195], a[140:143], v[96:99]
  v_mfma_f32_16x16x32_bf16 v[100:103], v[196:199], a[140:143], v[100:103]
  v_mfma_f32_16x16x32_bf16 v[104:107], v[200:203], a[140:143], v[104:107]
  v_mfma_f32_16x16x32_bf16 v[108:111], v[204:207], a[140:143], v[108:111]
  s_waitcnt lgkmcnt(0)
  buffer_load_dwordx4 a[188:191], v225, s[36:39], s58 offen offset:3072 sc1
  v_mfma_f32_16x16x32_bf16 v[144:147], v[208:211], a[128:131], v[144:147]
  ds_read_b64_tr_b16 v[192:193], v238 offset:40960
  ds_read_b64_tr_b16 v[194:195], v238 offset:41984
  v_mfma_f32_16x16x32_bf16 v[148:151], v[212:215], a[128:131], v[148:151]
  buffer_load_dwordx4 v225, s[24:27], s46 offen offset:1024 sc1 lds
  v_mfma_f32_16x16x32_bf16 v[152:155], v[216:219], a[128:131], v[152:155]
  ds_read_b64_tr_b16 v[196:197], v239 offset:40960
  s_mul_i32 s36, s60, 40960
  v_mfma_f32_16x16x32_bf16 v[156:159], v[220:223], a[128:131], v[156:159]
  ds_read_b64_tr_b16 v[198:199], v239 offset:41984
  s_mul_i32 s37, s61, 160
  v_mfma_f32_16x16x32_bf16 v[176:179], v[208:211], a[136:139], v[176:179]
  ds_read_b64_tr_b16 v[200:201], v238 offset:41216
  ds_read_b64_tr_b16 v[202:203], v238 offset:42240
  v_mfma_f32_16x16x32_bf16 v[180:183], v[212:215], a[136:139], v[180:183]
  buffer_load_dwordx4 v225, s[24:27], s46 offen offset:2048 sc1 lds
  v_mfma_f32_16x16x32_bf16 v[184:187], v[216:219], a[136:139], v[184:187]
  ds_read_b64_tr_b16 v[204:205], v239 offset:41216
  s_add_u32 s36, s36, s37
  v_mfma_f32_16x16x32_bf16 v[188:191], v[220:223], a[136:139], v[188:191]
  ds_read_b64_tr_b16 v[206:207], v239 offset:42240
  s_lshl_b32 s51, s3, 10
  v_mfma_f32_16x16x32_bf16 v[80:83], v[208:211], a[132:135], v[80:83]
  s_add_u32 s51, s51, 131072
  s_add_u32 s37, s36, 160
  v_mfma_f32_16x16x32_bf16 v[84:87], v[212:215], a[132:135], v[84:87]
  s_mov_b32 s38, 0
  v_mfma_f32_16x16x32_bf16 v[88:91], v[216:219], a[132:135], v[88:91]
  s_mov_b32 s39, 5242880
  v_lshl_add_u32 v254, v224, 3, s51
  v_mfma_f32_16x16x32_bf16 v[92:95], v[220:223], a[132:135], v[92:95]
  buffer_load_dwordx4 v225, s[24:27], s46 offen offset:3072 sc1 lds
  v_mfma_f32_16x16x32_bf16 v[112:115], v[208:211], a[140:143], v[112:115]
  s_mov_b32 s101, 0
  s_lshl_b32 s58, s7, 2
  s_sub_u32 s58, 18, s58
  s_max_i32 s58, s58, 11
  v_mfma_f32_16x16x32_bf16 v[116:119], v[212:215], a[140:143], v[116:119]
  v_mov_b32 v228, v225
  v_mfma_f32_16x16x32_bf16 v[120:123], v[216:219], a[140:143], v[120:123]
  s_add_u32 m0, s49, 143360
  v_add_u32 v229, 8192, v225
  v_add_u32 v230, 0x10000, v225
  v_mfma_f32_16x16x32_bf16 v[124:127], v[220:223], a[140:143], v[124:127]
  s_waitcnt lgkmcnt(0)
  s_waitcnt vmcnt(16)
  buffer_load_dwordx4 v8, s[96:99], 0 offen lds
  v_mfma_f32_16x16x32_bf16 v[128:131], v[192:195], a[144:147], v[128:131]
  ds_read_b64_tr_b16 v[208:209], v238 offset:41472
  s_lshl_b32 s62, s7, 2
  v_mfma_f32_16x16x32_bf16 v[132:135], v[196:199], a[144:147], v[132:135]
  ds_read_b64_tr_b16 v[210:211], v238 offset:42496
  s_add_u32 s62, s62, 4
  v_mfma_f32_16x16x32_bf16 v[136:139], v[200:203], a[144:147], v[136:139]
  s_add_u32 m0, s49, 144384
  ds_read_b64_tr_b16 v[212:213], v239 offset:41472
  ds_read_b64_tr_b16 v[214:215], v239 offset:42496
  v_mfma_f32_16x16x32_bf16 v[140:143], v[204:207], a[144:147], v[140:143]
  buffer_load_dwordx4 v9, s[96:99], 0 offen lds
  v_mfma_f32_16x16x32_bf16 v[160:163], v[192:195], a[152:155], v[160:163]
  ds_read_b64_tr_b16 v[216:217], v238 offset:41728
  s_mov_b32 s40, 0x4b800000
  v_mfma_f32_16x16x32_bf16 v[164:167], v[196:199], a[152:155], v[164:167]
  ds_read_b64_tr_b16 v[218:219], v238 offset:42752
  s_lshl_b32 s41, s3, 11
  v_mfma_f32_16x16x32_bf16 v[168:171], v[200:203], a[152:155], v[168:171]
  s_add_u32 m0, s49, 145408
  ds_read_b64_tr_b16 v[220:221], v239 offset:41728
  ds_read_b64_tr_b16 v[222:223], v239 offset:42752
  v_mfma_f32_16x16x32_bf16 v[172:175], v[204:207], a[152:155], v[172:175]
  buffer_load_dwordx4 v10, s[96:99], 0 offen lds
  v_mfma_f32_16x16x32_bf16 v[64:67], v[192:195], a[148:151], v[64:67]
  s_add_u32 s60, s41, 49152
  s_add_u32 s59, s41, 65536
  v_mfma_f32_16x16x32_bf16 v[68:71], v[196:199], a[148:151], v[68:71]
  v_lshrrev_b32 v243, 4, v224
  v_mfma_f32_16x16x32_bf16 v[72:75], v[200:203], a[148:151], v[72:75]
  s_mov_b32 m0, s51
  s_nop 0
  v_and_b32 v231, 15, v224
  v_lshlrev_b32 v242, 2, v243
  v_mfma_f32_16x16x32_bf16 v[76:79], v[204:207], a[148:151], v[76:79]
  buffer_load_dwordx4 v252, s[12:15], s36 offen lds
  v_mfma_f32_16x16x32_bf16 v[96:99], v[192:195], a[156:159], v[96:99]
  v_sub_u32 v231, v231, v242
  v_and_b32 v232, 0x33, v224
  v_mfma_f32_16x16x32_bf16 v[100:103], v[196:199], a[156:159], v[100:103]
  v_bfe_u32 v241, v224, 2, 1
  v_mfma_f32_16x16x32_bf16 v[104:107], v[200:203], a[156:159], v[104:107]
  s_add_u32 s46, s48, 0
  s_add_u32 m0, s46, 65536
  s_nop 0
  v_lshl_add_u32 v232, v241, 3, v232
  v_bfe_u32 v241, v224, 3, 1
  v_mfma_f32_16x16x32_bf16 v[108:111], v[204:207], a[156:159], v[108:111]
  s_waitcnt lgkmcnt(0)
  buffer_load_dwordx4 v225, s[28:31], s46 offen offset:0 sc1 lds
  v_mfma_f32_16x16x32_bf16 v[144:147], v[208:211], a[144:147], v[144:147]
  ds_read_b64_tr_b16 v[192:193], v238 offset:49152
  v_lshl_add_u32 v232, v241, 2, v232
  v_mfma_f32_16x16x32_bf16 v[148:151], v[212:215], a[144:147], v[148:151]
  ds_read_b64_tr_b16 v[194:195], v238 offset:50176
  v_lshlrev_b32 v232, 4, v232
  v_mfma_f32_16x16x32_bf16 v[152:155], v[216:219], a[144:147], v[152:155]
  ds_read_b64_tr_b16 v[196:197], v239 offset:49152
  s_min_u32 s63, s47, s58
  v_mfma_f32_16x16x32_bf16 v[156:159], v[220:223], a[144:147], v[156:159]
  ds_read_b64_tr_b16 v[198:199], v239 offset:50176
  s_lshr_b32 s45, s6, 3
  v_mfma_f32_16x16x32_bf16 v[176:179], v[208:211], a[152:155], v[176:179]
  ds_read_b64_tr_b16 v[200:201], v238 offset:49408
  ds_read_b64_tr_b16 v[202:203], v238 offset:50432
  v_mfma_f32_16x16x32_bf16 v[180:183], v[212:215], a[152:155], v[180:183]
  buffer_load_dwordx4 v225, s[28:31], s46 offen offset:1024 sc1 lds
  v_mfma_f32_16x16x32_bf16 v[184:187], v[216:219], a[152:155], v[184:187]
  ds_read_b64_tr_b16 v[204:205], v239 offset:49408
  s_mul_i32 s45, s45, 4096
  v_mfma_f32_16x16x32_bf16 v[188:191], v[220:223], a[152:155], v[188:191]
  ds_read_b64_tr_b16 v[206:207], v239 offset:50432
  s_lshl_b32 s44, s6, 14
  v_mfma_f32_16x16x32_bf16 v[80:83], v[208:211], a[148:151], v[80:83]
  s_add_u32 s44, s44, s45
  s_add_u32 s45, s44, 41943040
  v_mfma_f32_16x16x32_bf16 v[84:87], v[212:215], a[148:151], v[84:87]
  s_sub_u32 s44, 17301504, s44
  v_mfma_f32_16x16x32_bf16 v[88:91], v[216:219], a[148:151], v[88:91]
  s_add_u32 s32, s4, s45
  s_addc_u32 s33, s5, 0
  s_mov_b32 s34, s44
  s_mov_b32 s35, 0x20000
  s_sub_u32 s45, s2, 64
  s_cmp_ge_u32 s45, 40
  s_cbranch_scc1 L_adaL_nofin_17
  s_cmp_lg_u32 s3, 3
  s_cbranch_scc1 L_adaL_nofin_17
  s_lshl_b32 s44, s45, 10
  s_add_u32 s44, s44, 348160
  v_add_u32 v248, s44, v225
  global_load_dwordx4 a[224:227], v248, s[4:5] sc1
L_adaL_nofin_17:
  v_mfma_f32_16x16x32_bf16 v[92:95], v[220:223], a[148:151], v[92:95]
  buffer_load_dwordx4 v225, s[28:31], s46 offen offset:2048 sc1 lds
  v_mfma_f32_16x16x32_bf16 v[112:115], v[208:211], a[156:159], v[112:115]
  s_and_b32 s44, s2, 1
  v_mfma_f32_16x16x32_bf16 v[116:119], v[212:215], a[156:159], v[116:119]
  s_lshl_b32 s44, s44, 2
  v_mfma_f32_16x16x32_bf16 v[120:123], v[216:219], a[156:159], v[120:123]
  s_lshr_b32 s45, s2, 6
  s_add_u32 s44, s44, s45
  v_mfma_f32_16x16x32_bf16 v[124:127], v[220:223], a[156:159], v[124:127]
  s_waitcnt lgkmcnt(0)
  s_waitcnt vmcnt(19)
  v_add_u32 v226, 4096, v225
  v_mfma_f32_16x16x32_bf16 v[128:131], v[192:195], a[160:163], v[128:131]
  ds_read_b64_tr_b16 v[208:209], v238 offset:49664
  ds_read_b64_tr_b16 v[210:211], v238 offset:50688
  v_mfma_f32_16x16x32_bf16 v[132:135], v[196:199], a[160:163], v[132:135]
  buffer_load_dwordx4 v225, s[28:31], s46 offen offset:3072 sc1 lds
  v_mfma_f32_16x16x32_bf16 v[136:139], v[200:203], a[160:163], v[136:139]
  ds_read_b64_tr_b16 v[212:213], v239 offset:49664
  s_lshl_b32 s44, s44, 1
  v_mfma_f32_16x16x32_bf16 v[140:143], v[204:207], a[160:163], v[140:143]
  ds_read_b64_tr_b16 v[214:215], v239 offset:50688
  s_bfe_u32 s45, s2, 0x10001
  v_mfma_f32_16x16x32_bf16 v[160:163], v[192:195], a[168:171], v[160:163]
  ds_read_b64_tr_b16 v[216:217], v238 offset:49920
  s_add_u32 s44, s44, s45
  v_mfma_f32_16x16x32_bf16 v[164:167], v[196:199], a[168:171], v[164:167]
  ds_read_b64_tr_b16 v[218:219], v238 offset:50944
  s_lshl_b32 s44, s44, 2
  v_mfma_f32_16x16x32_bf16 v[168:171], v[200:203], a[168:171], v[168:171]
  s_add_u32 s46, s48, 4096
  s_add_u32 m0, s46, 65536
  s_nop 0
  ds_read_b64_tr_b16 v[220:221], v239 offset:49920
  ds_read_b64_tr_b16 v[222:223], v239 offset:50944
  v_mfma_f32_16x16x32_bf16 v[172:175], v[204:207], a[168:171], v[172:175]
  buffer_load_dwordx4 v225, s[28:31], s46 offen offset:0 sc1 lds
  v_mfma_f32_16x16x32_bf16 v[64:67], v[192:195], a[164:167], v[64:67]
  s_add_u32 s44, s44, s3
  s_mul_i32 s44, s44, 81920
  v_mfma_f32_16x16x32_bf16 v[68:71], v[196:199], a[164:167], v[68:71]
  s_add_u32 s44, s44, 23068672
  v_mfma_f32_16x16x32_bf16 v[72:75], v[200:203], a[164:167], v[72:75]
  s_add_u32 s96, s4, s44
  s_addc_u32 s97, s5, 0
  s_mov_b32 s98, 81920
  v_mfma_f32_16x16x32_bf16 v[76:79], v[204:207], a[164:167], v[76:79]
  s_mov_b32 s99, 0x20000
  v_mfma_f32_16x16x32_bf16 v[96:99], v[192:195], a[172:175], v[96:99]
  v_mfma_f32_16x16x32_bf16 v[100:103], v[196:199], a[172:175], v[100:103]
  buffer_load_dwordx4 v225, s[28:31], s46 offen offset:1024 sc1 lds
  v_mfma_f32_16x16x32_bf16 v[104:107], v[200:203], a[172:175], v[104:107]
  v_mfma_f32_16x16x32_bf16 v[108:111], v[204:207], a[172:175], v[108:111]
  s_waitcnt lgkmcnt(0)
  v_mfma_f32_16x16x32_bf16 v[144:147], v[208:211], a[160:163], v[144:147]
  ds_read_b64_tr_b16 v[192:193], v238 offset:57344
  v_mfma_f32_16x16x32_bf16 v[148:151], v[212:215], a[160:163], v[148:151]
  ds_read_b64_tr_b16 v[194:195], v238 offset:58368
  v_mfma_f32_16x16x32_bf16 v[152:155], v[216:219], a[160:163], v[152:155]
  ds_read_b64_tr_b16 v[196:197], v239 offset:57344
  ds_read_b64_tr_b16 v[198:199], v239 offset:58368
  v_mfma_f32_16x16x32_bf16 v[156:159], v[220:223], a[160:163], v[156:159]
  buffer_load_dwordx4 v225, s[28:31], s46 offen offset:2048 sc1 lds
  v_mfma_f32_16x16x32_bf16 v[176:179], v[208:211], a[168:171], v[176:179]
  ds_read_b64_tr_b16 v[200:201], v238 offset:57600
  v_mfma_f32_16x16x32_bf16 v[180:183], v[212:215], a[168:171], v[180:183]
  ds_read_b64_tr_b16 v[202:203], v238 offset:58624
  v_mfma_f32_16x16x32_bf16 v[184:187], v[216:219], a[168:171], v[184:187]
  ds_read_b64_tr_b16 v[204:205], v239 offset:57600
  v_mfma_f32_16x16x32_bf16 v[188:191], v[220:223], a[168:171], v[188:191]
  ds_read_b64_tr_b16 v[206:207], v239 offset:58624
  v_mfma_f32_16x16x32_bf16 v[80:83], v[208:211], a[164:167], v[80:83]
  v_mfma_f32_16x16x32_bf16 v[84:87], v[212:215], a[164:167], v[84:87]
  buffer_load_dwordx4 v225, s[28:31], s46 offen offset:3072 sc1 lds
  v_mfma_f32_16x16x32_bf16 v[88:91], v[216:219], a[164:167], v[88:91]
  v_mfma_f32_16x16x32_bf16 v[92:95], v[220:223], a[164:167], v[92:95]
  v_mfma_f32_16x16x32_bf16 v[112:115], v[208:211], a[172:175], v[112:115]
  v_mfma_f32_16x16x32_bf16 v[116:119], v[212:215], a[172:175], v[116:119]
  v_mfma_f32_16x16x32_bf16 v[120:123], v[216:219], a[172:175], v[120:123]
  v_mfma_f32_16x16x32_bf16 v[124:127], v[220:223], a[172:175], v[124:127]
  s_waitcnt lgkmcnt(0)
  s_waitcnt vmcnt(15)
  v_mfma_f32_16x16x32_bf16 v[128:131], v[192:195], a[176:179], v[128:131]
  ds_read_b64_tr_b16 v[208:209], v238 offset:57856
  v_mfma_f32_16x16x32_bf16 v[132:135], v[196:199], a[176:179], v[132:135]
  ds_read_b64_tr_b16 v[210:211], v238 offset:58880
  v_mfma_f32_16x16x32_bf16 v[136:139], v[200:203], a[176:179], v[136:139]
  ds_read_b64_tr_b16 v[212:213], v239 offset:57856
  v_mfma_f32_16x16x32_bf16 v[140:143], v[204:207], a[176:179], v[140:143]
  ds_read_b64_tr_b16 v[214:215], v239 offset:58880
  v_mfma_f32_16x16x32_bf16 v[160:163], v[192:195], a[184:187], v[160:163]
  ds_read_b64_tr_b16 v[216:217], v238 offset:58112
  v_mfma_f32_16x16x32_bf16 v[164:167], v[196:199], a[184:187], v[164:167]
  ds_read_b64_tr_b16 v[218:219], v238 offset:59136
  v_mfma_f32_16x16x32_bf16 v[168:171], v[200:203], a[184:187], v[168:171]
  ds_read_b64_tr_b16 v[220:221], v239 offset:58112
  v_mfma_f32_16x16x32_bf16 v[172:175], v[204:207], a[184:187], v[172:175]
  ds_read_b64_tr_b16 v[222:223], v239 offset:59136
  v_mfma_f32_16x16x32_bf16 v[64:67], v[192:195], a[180:183], v[64:67]
  v_mfma_f32_16x16x32_bf16 v[68:71], v[196:199], a[180:183], v[68:71]
  v_mfma_f32_16x16x32_bf16 v[72:75], v[200:203], a[180:183], v[72:75]
  v_mfma_f32_16x16x32_bf16 v[76:79], v[204:207], a[180:183], v[76:79]
  v_mfma_f32_16x16x32_bf16 v[96:99], v[192:195], a[188:191], v[96:99]
  v_mfma_f32_16x16x32_bf16 v[100:103], v[196:199], a[188:191], v[100:103]
  v_mfma_f32_16x16x32_bf16 v[104:107], v[200:203], a[188:191], v[104:107]
  v_mfma_f32_16x16x32_bf16 v[108:111], v[204:207], a[188:191], v[108:111]
  s_waitcnt lgkmcnt(0)
  v_mfma_f32_16x16x32_bf16 v[144:147], v[208:211], a[176:179], v[144:147]
  s_waitcnt vmcnt(12)
  s_barrier
  ds_read_b128 a[128:131], v228 offset:0
  v_mfma_f32_16x16x32_bf16 v[148:151], v[212:215], a[176:179], v[148:151]
  ds_read_b128 a[132:135], v228 offset:1024
  v_mfma_f32_16x16x32_bf16 v[152:155], v[216:219], a[176:179], v[152:155]
  s_add_u32 s46, s48, 32768
  s_add_u32 m0, s46, 0
  s_nop 0
  ds_read_b128 a[136:139], v228 offset:2048
  ds_read_b128 a[140:143], v228 offset:3072
  v_mfma_f32_16x16x32_bf16 v[156:159], v[220:223], a[176:179], v[156:159]
  buffer_load_dwordx4 v225, s[24:27], s46 offen offset:0 sc1 lds
  v_mfma_f32_16x16x32_bf16 v[176:179], v[208:211], a[184:187], v[176:179]
  ds_read_b128 a[144:147], v228 offset:4096
  ds_read_b128 a[148:151], v228 offset:5120
  v_mfma_f32_16x16x32_bf16 v[180:183], v[212:215], a[184:187], v[180:183]
  buffer_load_dwordx4 v225, s[24:27], s46 offen offset:1024 sc1 lds
  v_cvt_pk_bf16_f32 v128, v128, v129
  v_mfma_f32_16x16x32_bf16 v[184:187], v[216:219], a[184:187], v[184:187]
  ds_read_b128 a[152:155], v228 offset:6144
  v_cvt_pk_bf16_f32 v129, v130, v131
  v_mfma_f32_16x16x32_bf16 v[188:191], v[220:223], a[184:187], v[188:191]
  ds_read_b128 a[156:159], v228 offset:7168
  v_cvt_pk_bf16_f32 v130, v132, v133
  v_cvt_pk_bf16_f32 v131, v134, v135
  v_mfma_f32_16x16x32_bf16 v[80:83], v[208:211], a[180:183], v[80:83]
  v_cvt_pk_bf16_f32 v132, v136, v137
  v_cvt_pk_bf16_f32 v133, v138, v139
  v_mfma_f32_16x16x32_bf16 v[84:87], v[212:215], a[180:183], v[84:87]
  buffer_load_dwordx4 v225, s[24:27], s46 offen offset:2048 sc1 lds
  v_cvt_pk_bf16_f32 v134, v140, v141
  v_mfma_f32_16x16x32_bf16 v[88:91], v[216:219], a[180:183], v[88:91]
  v_cvt_pk_bf16_f32 v135, v142, v143
  v_cvt_pk_bf16_f32 v136, v144, v145
  v_mfma_f32_16x16x32_bf16 v[92:95], v[220:223], a[180:183], v[92:95]
  v_cvt_pk_bf16_f32 v137, v146, v147
  v_cvt_pk_bf16_f32 v138, v148, v149
  v_mfma_f32_16x16x32_bf16 v[112:115], v[208:211], a[188:191], v[112:115]
  v_cvt_pk_bf16_f32 v139, v150, v151
  v_cvt_pk_bf16_f32 v140, v152, v153
  v_mfma_f32_16x16x32_bf16 v[116:119], v[212:215], a[188:191], v[116:119]
  buffer_load_dwordx4 v225, s[24:27], s46 offen offset:3072 sc1 lds
  v_cvt_pk_bf16_f32 v141, v154, v155
  v_mfma_f32_16x16x32_bf16 v[120:123], v[216:219], a[188:191], v[120:123]
  v_cvt_pk_bf16_f32 v142, v156, v157
  v_cvt_pk_bf16_f32 v143, v158, v159
  v_mfma_f32_16x16x32_bf16 v[124:127], v[220:223], a[188:191], v[124:127]
  s_waitcnt lgkmcnt(0)
  v_cvt_pk_bf16_f32 v144, v160, v161
  v_cvt_pk_bf16_f32 v145, v162, v163
  v_mfma_f32_16x16x32_bf16 v[0:3], a[128:131], v[128:131], 0
  s_add_u32 s46, s48, 36864
  s_add_u32 m0, s46, 0
  s_nop 0
  v_cvt_pk_bf16_f32 v146, v164, v165
  v_cvt_pk_bf16_f32 v147, v166, v167
  v_cvt_pk_bf16_f32 v148, v168, v169
  v_mfma_f32_16x16x32_bf16 v[0:3], a[132:135], v[132:135], v[0:3]
  buffer_load_dwordx4 v225, s[24:27], s46 offen offset:0 sc1 lds
  v_cvt_pk_bf16_f32 v149, v170, v171
  v_mfma_f32_16x16x32_bf16 v[0:3], a[136:139], v[136:139], v[0:3]
  v_cvt_pk_bf16_f32 v150, v172, v173
  v_cvt_pk_bf16_f32 v151, v174, v175
  v_cvt_pk_bf16_f32 v152, v176, v177
  v_mfma_f32_16x16x32_bf16 v[0:3], a[140:143], v[140:143], v[0:3]
  v_cvt_pk_bf16_f32 v153, v178, v179
  v_cvt_pk_bf16_f32 v154, v180, v181
  v_mfma_f32_16x16x32_bf16 v[4:7], a[144:147], v[128:131], 0
  v_cvt_pk_bf16_f32 v155, v182, v183
  v_cvt_pk_bf16_f32 v156, v184, v185
  v_cvt_pk_bf16_f32 v157, v186, v187
  v_mfma_f32_16x16x32_bf16 v[4:7], a[148:151], v[132:135], v[4:7]
  buffer_load_dwordx4 v225, s[24:27], s46 offen offset:1024 sc1 lds
  v_cvt_pk_bf16_f32 v158, v188, v189
  v_mfma_f32_16x16x32_bf16 v[4:7], a[152:155], v[136:139], v[4:7]
  v_cvt_pk_bf16_f32 v159, v190, v191
  v_cvt_pk_bf16_f32 v160, v64, v65
  v_cvt_pk_bf16_f32 v161, v66, v67
  v_mfma_f32_16x16x32_bf16 v[4:7], a[156:159], v[140:143], v[4:7]
  buffer_load_dwordx4 v225, s[24:27], s46 offen offset:2048 sc1 lds
  v_cvt_pk_bf16_f32 v162, v68, v69
  v_mfma_f32_16x16x32_bf16 v[8:11], a[128:131], v[144:147], 0
  v_cvt_pk_bf16_f32 v163, v70, v71
  v_cvt_pk_bf16_f32 v164, v72, v73
  v_cvt_pk_bf16_f32 v165, v74, v75
  v_mfma_f32_16x16x32_bf16 v[8:11], a[132:135], v[148:151], v[8:11]
  v_cvt_pk_bf16_f32 v166, v76, v77
  v_cvt_pk_bf16_f32 v167, v78, v79
  v_mfma_f32_16x16x32_bf16 v[8:11], a[136:139], v[152:155], v[8:11]
  v_cvt_pk_bf16_f32 v168, v80, v81
  v_cvt_pk_bf16_f32 v169, v82, v83
  v_cvt_pk_bf16_f32 v170, v84, v85
  v_mfma_f32_16x16x32_bf16 v[8:11], a[140:143], v[156:159], v[8:11]
  buffer_load_dwordx4 v225, s[24:27], s46 offen offset:3072 sc1 lds
  v_cvt_pk_bf16_f32 v171, v86, v87
  v_mfma_f32_16x16x32_bf16 v[12:15], a[144:147], v[144:147], 0
  v_cvt_pk_bf16_f32 v172, v88, v89
  v_cvt_pk_bf16_f32 v173, v90, v91
  v_cvt_pk_bf16_f32 v174, v92, v93
  v_mfma_f32_16x16x32_bf16 v[12:15], a[148:151], v[148:151], v[12:15]
  v_cvt_pk_bf16_f32 v175, v94, v95
  v_cvt_pk_bf16_f32 v176, v96, v97
  v_mfma_f32_16x16x32_bf16 v[12:15], a[152:155], v[152:155], v[12:15]
  s_add_u32 s46, s49, 32768
  s_add_u32 m0, s46, 65536
  s_nop 0
  v_cvt_pk_bf16_f32 v177, v98, v99
  v_cvt_pk_bf16_f32 v178, v100, v101
  v_cvt_pk_bf16_f32 v179, v102, v103
  v_mfma_f32_16x16x32_bf16 v[12:15], a[156:159], v[156:159], v[12:15]
  buffer_load_dwordx4 v225, s[28:31], s46 offen offset:0 sc1 lds
  v_cvt_pk_bf16_f32 v180, v104, v105
  v_mfma_f32_16x16x32_bf16 v[16:19], a[128:131], v[160:163], 0
  v_cvt_pk_bf16_f32 v181, v106, v107
  v_cvt_pk_bf16_f32 v182, v108, v109
  v_cvt_pk_bf16_f32 v183, v110, v111
  v_mfma_f32_16x16x32_bf16 v[16:19], a[132:135], v[164:167], v[16:19]
  v_cvt_pk_bf16_f32 v184, v112, v113
  v_cvt_pk_bf16_f32 v185, v114, v115
  v_mfma_f32_16x16x32_bf16 v[16:19], a[136:139], v[168:171], v[16:19]
  v_cvt_pk_bf16_f32 v186, v116, v117
  v_cvt_pk_bf16_f32 v187, v118, v119
  v_cvt_pk_bf16_f32 v188, v120, v121
  v_mfma_f32_16x16x32_bf16 v[16:19], a[140:143], v[172:175], v[16:19]
  buffer_load_dwordx4 v225, s[28:31], s46 offen offset:1024 sc1 lds
  v_cvt_pk_bf16_f32 v189, v122, v123
  v_mfma_f32_16x16x32_bf16 v[20:23], a[144:147], v[160:163], 0
  v_cvt_pk_bf16_f32 v190, v124, v125
  v_cvt_pk_bf16_f32 v191, v126, v127
  v_mfma_f32_16x16x32_bf16 v[20:23], a[148:151], v[164:167], v[20:23]
  v_mfma_f32_16x16x32_bf16 v[20:23], a[152:155], v[168:171], v[20:23]
  s_cmp_lg_u32 s47, 0
  s_cbranch_scc1 L_adaL_nomask0_18
  v_add_u32 v240, s47, v231
  v_cvt_f32_i32 v240, v240
  v_add_f32 v240, 0.5, v240
  v_mul_f32 v240, 0x71800000, v240
  v_min_f32 v0, v0, v240
  v_min_f32 v12, v12, v240
  v_subrev_f32 v242, 0x71800000, v240
  v_min_f32 v1, v1, v242
  v_min_f32 v13, v13, v242
  v_subrev_f32 v243, 0x72000000, v240
  v_min_f32 v2, v2, v243
  v_min_f32 v14, v14, v243
  v_subrev_f32 v244, 0x72400000, v240
  v_min_f32 v3, v3, v244
  v_min_f32 v15, v15, v244
  v_subrev_f32 v241, 0x73800000, v240
  v_min_f32 v4, v4, v241
  v_subrev_f32 v242, 0x73880000, v240
  v_min_f32 v5, v5, v242
  v_subrev_f32 v243, 0x73900000, v240
  v_min_f32 v6, v6, v243
  v_subrev_f32 v244, 0x73980000, v240
  v_min_f32 v7, v7, v244
  v_subrev_f32 v241, 0xf3800000, v240
  v_min_f32 v8, v8, v241
  v_subrev_f32 v242, 0xf3700000, v240
  v_min_f32 v9, v9, v242
  v_subrev_f32 v243, 0xf3600000, v240
  v_min_f32 v10, v10, v243
  v_subrev_f32 v244, 0xf3500000, v240
  v_min_f32 v11, v11, v244
L_adaL_nomask0_18:
  v_max3_f32 v248, v0, v1, v2
  v_max3_f32 v248, v248, v3, v4
  v_mfma_f32_16x16x32_bf16 v[20:23], a[156:159], v[172:175], v[20:23]
  buffer_load_dwordx4 v225, s[28:31], s46 offen offset:2048 sc1 lds
  v_max3_f32 v248, v248, v5, v6
  v_mfma_f32_16x16x32_bf16 v[24:27], a[128:131], v[176:179], 0
  v_max_f32 v248, v248, v7
  v_max3_f32 v249, v8, v9, v10
  v_max3_f32 v249, v249, v11, v12
  v_mfma_f32_16x16x32_bf16 v[24:27], a[132:135], v[180:183], v[24:27]
  buffer_load_dwordx4 v225, s[28:31], s46 offen offset:3072 sc1 lds
  v_max3_f32 v249, v249, v13, v14
  v_mfma_f32_16x16x32_bf16 v[24:27], a[136:139], v[184:187], v[24:27]
  v_max_f32 v249, v249, v15
  v_mov_b32 v246, v248
  v_mov_b32 v247, v249
  v_mfma_f32_16x16x32_bf16 v[24:27], a[140:143], v[188:191], v[24:27]
  s_nop 1
  v_permlane16_swap_b32 v248, v246
  v_mfma_f32_16x16x32_bf16 v[28:31], a[144:147], v[176:179], 0
  s_add_u32 s36, s36, 32
  v_permlane16_swap_b32 v249, v247
  s_nop 1
  v_max_f32 v248, v248, v246
  v_mfma_f32_16x16x32_bf16 v[28:31], a[148:151], v[180:183], v[28:31]
  buffer_load_dwordx4 a[196:199], v255, s[20:23], s56 offen
  v_max_f32 v249, v249, v247
  v_mfma_f32_16x16x32_bf16 v[28:31], a[152:155], v[184:187], v[28:31]
  v_mov_b32 v246, v248
  v_mov_b32 v247, v249
  s_nop 1
  v_mfma_f32_16x16x32_bf16 v[28:31], a[156:159], v[188:191], v[28:31]
  v_permlane32_swap_b32 v248, v246
  v_permlane32_swap_b32 v249, v247
  s_waitcnt vmcnt(13)
  s_barrier
  ds_read_b128 a[128:131], v229 offset:0
  ds_read_b128 a[132:135], v229 offset:1024
  ds_read_b128 a[136:139], v229 offset:2048
  ds_read_b128 a[140:143], v229 offset:3072
  s_nop 1
  v_max_f32 v248, v248, v246
  v_max_f32 v249, v249, v247
  v_sub_f32 v0, v0, v248
  v_sub_f32 v1, v1, v248
  v_sub_f32 v2, v2, v248
  v_sub_f32 v3, v3, v248
  v_sub_f32 v4, v4, v248
  v_sub_f32 v5, v5, v248
  v_sub_f32 v6, v6, v248
  v_sub_f32 v7, v7, v248
  v_sub_f32 v8, v8, v249
  v_sub_f32 v9, v9, v249
  v_sub_f32 v10, v10, v249
  v_sub_f32 v11, v11, v249
  v_sub_f32 v12, v12, v249
  v_sub_f32 v13, v13, v249
  v_sub_f32 v14, v14, v249
  v_sub_f32 v15, v15, v249
  v_mov_b32 v216, 0x3f803f80
  v_mov_b32 v220, 0
  v_mov_b32 v217, 0x3f803f80
  v_mov_b32 v221, 0
  v_mov_b32 v218, 0x3f803f80
  v_mov_b32 v222, 0
  v_mov_b32 v219, 0x3f803f80
  v_mov_b32 v223, 0
  v_max3_f32 v250, v16, v17, v18
  v_max3_f32 v250, v250, v19, v20
  v_max3_f32 v250, v250, v21, v22
  v_max_f32 v250, v250, v23
  v_max3_f32 v251, v24, v25, v26
  v_max3_f32 v251, v251, v27, v28
  v_max3_f32 v251, v251, v29, v30
  v_max_f32 v251, v251, v31
  v_mov_b32 v246, v250
  v_mov_b32 v247, v251
  s_nop 1
  v_permlane16_swap_b32 v250, v246
  v_permlane16_swap_b32 v251, v247
  s_nop 1
  v_max_f32 v250, v250, v246
  v_max_f32 v251, v251, v247
  v_mov_b32 v246, v250
  v_mov_b32 v247, v251
  s_nop 1
  v_permlane32_swap_b32 v250, v246
  v_permlane32_swap_b32 v251, v247
  s_nop 1
  v_max_f32 v250, v250, v246
  v_max_f32 v251, v251, v247
  v_pk_add_f32 v[16:17], v[16:17], v[250:251] op_sel:[0,0] op_sel_hi:[1,0] neg_lo:[0,1] neg_hi:[0,1]
  v_pk_add_f32 v[18:19], v[18:19], v[250:251] op_sel:[0,0] op_sel_hi:[1,0] neg_lo:[0,1] neg_hi:[0,1]
  v_pk_add_f32 v[20:21], v[20:21], v[250:251] op_sel:[0,0] op_sel_hi:[1,0] neg_lo:[0,1] neg_hi:[0,1]
  v_pk_add_f32 v[22:23], v[22:23], v[250:251] op_sel:[0,0] op_sel_hi:[1,0] neg_lo:[0,1] neg_hi:[0,1]
  v_pk_add_f32 v[24:25], v[24:25], v[250:251] op_sel:[0,1] op_sel_hi:[1,1] neg_lo:[0,1] neg_hi:[0,1]
  v_pk_add_f32 v[26:27], v[26:27], v[250:251] op_sel:[0,1] op_sel_hi:[1,1] neg_lo:[0,1] neg_hi:[0,1]
  v_pk_add_f32 v[28:29], v[28:29], v[250:251] op_sel:[0,1] op_sel_hi:[1,1] neg_lo:[0,1] neg_hi:[0,1]
  v_pk_add_f32 v[30:31], v[30:31], v[250:251] op_sel:[0,1] op_sel_hi:[1,1] neg_lo:[0,1] neg_hi:[0,1]
  v_pk_mul_f32 v[64:65], v[248:249], -1.0 op_sel:[0,0] op_sel_hi:[0,0]
  v_pk_mul_f32 v[66:67], v[248:249], -1.0 op_sel:[0,0] op_sel_hi:[0,0]
  v_pk_mul_f32 v[68:69], v[248:249], -1.0 op_sel:[0,0] op_sel_hi:[0,0]
  v_pk_mul_f32 v[70:71], v[248:249], -1.0 op_sel:[0,0] op_sel_hi:[0,0]
  v_pk_mul_f32 v[72:73], v[248:249], -1.0 op_sel:[1,0] op_sel_hi:[1,0]
  v_pk_mul_f32 v[74:75], v[248:249], -1.0 op_sel:[1,0] op_sel_hi:[1,0]
  v_pk_mul_f32 v[76:77], v[248:249], -1.0 op_sel:[1,0] op_sel_hi:[1,0]
  v_pk_mul_f32 v[78:79], v[248:249], -1.0 op_sel:[1,0] op_sel_hi:[1,0]
  v_pk_mul_f32 v[80:81], v[250:251], -1.0 op_sel:[0,0] op_sel_hi:[0,0]
  v_pk_mul_f32 v[82:83], v[250:251], -1.0 op_sel:[0,0] op_sel_hi:[0,0]
  v_pk_mul_f32 v[84:85], v[250:251], -1.0 op_sel:[0,0] op_sel_hi:[0,0]
  v_pk_mul_f32 v[86:87], v[250:251], -1.0 op_sel:[0,0] op_sel_hi:[0,0]
  v_pk_mul_f32 v[88:89], v[250:251], -1.0 op_sel:[1,0] op_sel_hi:[1,0]
  v_pk_mul_f32 v[90:91], v[250:251], -1.0 op_sel:[1,0] op_sel_hi:[1,0]
  v_pk_mul_f32 v[92:93], v[250:251], -1.0 op_sel:[1,0] op_sel_hi:[1,0]
  v_pk_mul_f32 v[94:95], v[250:251], -1.0 op_sel:[1,0] op_sel_hi:[1,0]
  v_exp_f32 v192, v0
  v_exp_f32 v193, v1
  v_exp_f32 v194, v2
  v_cvt_pk_bf16_f32 v96, v192, v193
  v_exp_f32 v195, v3
  v_exp_f32 v196, v8
  v_cvt_pk_bf16_f32 v97, v194, v195
  v_exp_f32 v197, v9
  v_exp_f32 v198, v10
  v_cvt_pk_bf16_f32 v100, v196, v197
  v_exp_f32 v199, v11
  v_exp_f32 v192, v16
  v_cvt_pk_bf16_f32 v101, v198, v199
  v_exp_f32 v193, v17
  v_exp_f32 v194, v18
  v_cvt_pk_bf16_f32 v104, v192, v193
  v_exp_f32 v195, v19
  v_exp_f32 v196, v24
  v_cvt_pk_bf16_f32 v105, v194, v195
  v_exp_f32 v197, v25
  v_exp_f32 v198, v26
  v_cvt_pk_bf16_f32 v108, v196, v197
  v_exp_f32 v199, v27
  v_exp_f32 v192, v4
  v_cvt_pk_bf16_f32 v109, v198, v199
  v_exp_f32 v193, v5
  v_exp_f32 v194, v6
  v_cvt_pk_bf16_f32 v98, v192, v193
  v_exp_f32 v195, v7
  v_exp_f32 v196, v12
  v_cvt_pk_bf16_f32 v99, v194, v195
  v_exp_f32 v197, v13
  v_exp_f32 v198, v14
  v_cvt_pk_bf16_f32 v102, v196, v197
  v_exp_f32 v199, v15
  s_nop 0
  v_cvt_pk_bf16_f32 v103, v198, v199
  s_mov_b32 s61, 1
  s_waitcnt lgkmcnt(0)
  s_cmp_ge_u32 s61, s63
  s_cbranch_scc1 L_adaL_ev_24
.p2align 6
L_adaL_dual_20:
  v_mfma_f32_16x16x32_bf16 v[32:35], a[128:131], v[128:131], v[64:67]
  s_waitcnt lgkmcnt(0)
  v_add_u32 v228, 8192, v229
  v_and_b32 v228, 0xffff, v228
  v_mfma_f32_16x16x32_bf16 v[32:35], a[132:135], v[132:135], v[32:35]
  s_pack_ll_b32_b16 m0, s59, 0
  v_exp_f32 v192, v20
  v_mfma_f32_16x16x32_bf16 v[32:35], a[136:139], v[136:139], v[32:35]
  v_mfma_f32_16x16x32_bf16 v[32:35], a[140:143], v[140:143], v[32:35]
  s_add_u32 s56, s56, 64
  v_exp_f32 v193, v21
  v_mfma_f32_16x16x32_bf16 v[40:43], a[128:131], v[144:147], v[72:75]
  s_cmp_lt_u32 s36, s37
  ds_read_b128 a[144:147], v229 offset:4096
  v_cvt_pk_bf16_f32 v106, v192, v193
  v_mfma_f32_16x16x32_bf16 v[40:43], a[132:135], v[148:151], v[40:43]
  s_cselect_b32 s14, s39, 0
  v_exp_f32 v194, v22
  v_mfma_f32_16x16x32_bf16 v[40:43], a[136:139], v[152:155], v[40:43]
  buffer_load_dwordx4 v225, s[24:27], s59 offen offset:0 sc1 lds
  v_mfma_f32_16x16x32_bf16 v[40:43], a[140:143], v[156:159], v[40:43]
  v_exp_f32 v195, v23
  v_mfma_f32_16x16x32_bf16 v[48:51], a[128:131], v[160:163], v[80:83]
  ds_read_b128 a[148:151], v229 offset:5120
  v_cvt_pk_bf16_f32 v107, v194, v195
  v_mfma_f32_16x16x32_bf16 v[48:51], a[132:135], v[164:167], v[48:51]
  v_exp_f32 v196, v28
  v_mfma_f32_16x16x32_bf16 v[48:51], a[136:139], v[168:171], v[48:51]
  v_mfma_f32_16x16x32_bf16 v[48:51], a[140:143], v[172:175], v[48:51]
  v_exp_f32 v197, v29
  v_mfma_f32_16x16x32_bf16 v[56:59], a[128:131], v[176:179], v[88:91]
  ds_read_b128 a[152:155], v229 offset:6144
  v_cvt_pk_bf16_f32 v110, v196, v197
  v_mfma_f32_16x16x32_bf16 v[56:59], a[132:135], v[180:183], v[56:59]
  v_exp_f32 v198, v30
  v_mfma_f32_16x16x32_bf16 v[56:59], a[136:139], v[184:187], v[56:59]
  ds_read_b128 a[156:159], v229 offset:7168
  v_mfma_f32_16x16x32_bf16 v[56:59], a[140:143], v[188:191], v[56:59]
  s_waitcnt lgkmcnt(2)
  v_exp_f32 v199, v31
  v_mfma_f32_16x16x32_bf16 v[36:39], a[144:147], v[128:131], v[68:71]
  v_cvt_pk_bf16_f32 v111, v198, v199
  v_mfma_f32_16x16x32_bf16 v[36:39], a[148:151], v[132:135], v[36:39]
  v_exp_f32 v192, v32
  v_mfma_f32_16x16x32_bf16 v[200:203], v[216:219], v[96:99], 0
  v_mfma_f32_16x16x32_bf16 v[204:207], v[216:219], v[100:103], 0
  v_exp_f32 v193, v33
  v_mfma_f32_16x16x32_bf16 v[208:211], v[216:219], v[104:107], 0
  v_cvt_pk_bf16_f32 v112, v192, v193
  v_mfma_f32_16x16x32_bf16 v[212:215], v[216:219], v[108:111], 0
  s_waitcnt lgkmcnt(0)
  v_exp_f32 v194, v34
  v_mfma_f32_16x16x32_bf16 v[36:39], a[152:155], v[136:139], v[36:39]
  buffer_load_dwordx4 v225, s[24:27], s59 offen offset:1024 sc1 lds
  v_mfma_f32_16x16x32_bf16 v[36:39], a[156:159], v[140:143], v[36:39]
  s_add_u32 s59, s59, 8192
  v_exp_f32 v195, v35
  v_mfma_f32_16x16x32_bf16 v[44:47], a[144:147], v[144:147], v[76:79]
  s_pack_ll_b32_b16 m0, s60, 1
  v_cvt_pk_bf16_f32 v113, v194, v195
  v_mfma_f32_16x16x32_bf16 v[44:47], a[148:151], v[148:151], v[44:47]
  v_exp_f32 v196, v40
  v_mfma_f32_16x16x32_bf16 v[44:47], a[152:155], v[152:155], v[44:47]
  ds_read_b128 a[160:163], v230 offset:0
  v_max3_f32 v240, v200, v204, v208
  v_mfma_f32_16x16x32_bf16 v[44:47], a[156:159], v[156:159], v[44:47]
  v_exp_f32 v197, v41
  v_mfma_f32_16x16x32_bf16 v[52:55], a[144:147], v[160:163], v[84:87]
  v_cvt_pk_bf16_f32 v116, v196, v197
  v_max_f32 v240, v240, v212
  v_mfma_f32_16x16x32_bf16 v[52:55], a[148:151], v[164:167], v[52:55]
  v_exp_f32 v198, v42
  v_mfma_f32_16x16x32_bf16 v[52:55], a[152:155], v[168:171], v[52:55]
  ds_read_b128 a[164:167], v230 offset:1024
  v_cmp_nge_f32 vcc, s40, v240
  v_mfma_f32_16x16x32_bf16 v[52:55], a[156:159], v[172:175], v[52:55]
  v_exp_f32 v199, v43
  v_mfma_f32_16x16x32_bf16 v[60:63], a[144:147], v[176:179], v[92:95]
  v_cvt_pk_bf16_f32 v117, v198, v199
  v_mfma_f32_16x16x32_bf16 v[60:63], a[148:151], v[180:183], v[60:63]
  v_exp_f32 v192, v48
  v_mfma_f32_16x16x32_bf16 v[60:63], a[152:155], v[184:187], v[60:63]
  s_waitcnt lgkmcnt(1)
  ds_read_b128 a[168:171], v230 offset:2048
  v_mfma_f32_16x16x32_bf16 v[60:63], a[156:159], v[188:191], v[60:63]
  s_cbranch_vccnz L_adaL_fb_27
L_adaL_back_28:
  v_exp_f32 v193, v49
  v_mfma_f32_16x16x32_bf16 a[0:3], a[160:163], v[96:99], a[0:3]
  s_waitcnt vmcnt(8)
  s_barrier
  v_mfma_f32_16x16x32_bf16 a[32:35], a[160:163], v[100:103], a[32:35]
  ds_read_b64_tr_b16 a[192:193], v254
  v_cvt_pk_bf16_f32 v120, v192, v193
  v_mfma_f32_16x16x32_bf16 a[64:67], a[160:163], v[104:107], a[64:67]
  ds_read_b64_tr_b16 a[194:195], v254 offset:512
  ds_read_b128 a[172:175], v230 offset:3072
  v_mfma_f32_16x16x32_bf16 a[96:99], a[160:163], v[108:111], a[96:99]
  s_waitcnt lgkmcnt(4)
  v_exp_f32 v194, v50
  v_mfma_f32_16x16x32_bf16 a[4:7], a[164:167], v[96:99], a[4:7]
  s_add_u32 s61, s61, 1
  buffer_load_dwordx4 v225, s[28:31], s60 offen offset:0 sc1 lds
  v_mfma_f32_16x16x32_bf16 a[36:39], a[164:167], v[100:103], a[36:39]
  v_exp_f32 v195, v51
  v_mfma_f32_16x16x32_bf16 a[68:71], a[164:167], v[104:107], a[68:71]
  ds_read_b128 a[176:179], v230 offset:4096
  v_cvt_pk_bf16_f32 v121, v194, v195
  v_mfma_f32_16x16x32_bf16 a[100:103], a[164:167], v[108:111], a[100:103]
  s_waitcnt lgkmcnt(4)
  v_exp_f32 v196, v56
  v_mfma_f32_16x16x32_bf16 a[8:11], a[168:171], v[96:99], a[8:11]
  v_add_f32 v220, v220, v200
  v_add_f32 v221, v221, v204
  v_mfma_f32_16x16x32_bf16 a[40:43], a[168:171], v[100:103], a[40:43]
  v_exp_f32 v197, v57
  v_mfma_f32_16x16x32_bf16 a[72:75], a[168:171], v[104:107], a[72:75]
  ds_read_b128 a[180:183], v230 offset:5120
  v_cvt_pk_bf16_f32 v124, v196, v197
  v_mfma_f32_16x16x32_bf16 a[104:107], a[168:171], v[108:111], a[104:107]
  s_waitcnt lgkmcnt(2)
  v_exp_f32 v198, v58
  v_mfma_f32_16x16x32_bf16 a[12:15], a[172:175], v[96:99], a[12:15]
  buffer_store_dwordx4 a[192:195], v225, s[16:19], s38 offen sc1
  v_mfma_f32_16x16x32_bf16 a[44:47], a[172:175], v[100:103], a[44:47]
  s_add_u32 s38, s38, 1024
  v_exp_f32 v199, v59
  v_mfma_f32_16x16x32_bf16 a[76:79], a[172:175], v[104:107], a[76:79]
  ds_read_b128 a[184:187], v230 offset:6144
  v_cvt_pk_bf16_f32 v125, v198, v199
  v_mfma_f32_16x16x32_bf16 a[108:111], a[172:175], v[108:111], a[108:111]
  s_waitcnt lgkmcnt(2)
  v_exp_f32 v192, v36
  v_mfma_f32_16x16x32_bf16 a[16:19], a[176:179], v[96:99], a[16:19]
  v_add_f32 v222, v222, v208
  v_add_f32 v223, v223, v212
  v_mfma_f32_16x16x32_bf16 a[48:51], a[176:179], v[100:103], a[48:51]
  v_exp_f32 v193, v37
  v_mfma_f32_16x16x32_bf16 a[80:83], a[176:179], v[104:107], a[80:83]
  ds_read_b128 a[188:191], v230 offset:7168
  v_cvt_pk_bf16_f32 v114, v192, v193
  v_mfma_f32_16x16x32_bf16 a[112:115], a[176:179], v[108:111], a[112:115]
  s_waitcnt lgkmcnt(2)
  v_exp_f32 v194, v38
  v_mfma_f32_16x16x32_bf16 a[20:23], a[180:183], v[96:99], a[20:23]
  buffer_load_dwordx4 v225, s[28:31], s60 offen offset:1024 sc1 lds
  v_mfma_f32_16x16x32_bf16 a[52:55], a[180:183], v[100:103], a[52:55]
  s_mov_b32 m0, s51
  v_exp_f32 v195, v39
  v_mfma_f32_16x16x32_bf16 a[84:87], a[180:183], v[104:107], a[84:87]
  s_add_u32 s60, s60, 8192
  ds_read_b128 a[128:131], v228 offset:0
  v_cvt_pk_bf16_f32 v115, v194, v195
  v_mfma_f32_16x16x32_bf16 a[116:119], a[180:183], v[108:111], a[116:119]
  s_waitcnt lgkmcnt(2)
  v_exp_f32 v196, v44
  v_mfma_f32_16x16x32_bf16 a[24:27], a[184:187], v[96:99], a[24:27]
  ds_read_b128 a[132:135], v228 offset:1024
  ds_read_b128 a[136:139], v228 offset:2048
  v_mfma_f32_16x16x32_bf16 a[56:59], a[184:187], v[100:103], a[56:59]
  v_exp_f32 v197, v45
  v_mfma_f32_16x16x32_bf16 a[88:91], a[184:187], v[104:107], a[88:91]
  ds_read_b128 a[140:143], v228 offset:3072
  v_cvt_pk_bf16_f32 v118, v196, v197
  v_mfma_f32_16x16x32_bf16 a[120:123], a[184:187], v[108:111], a[120:123]
  s_waitcnt lgkmcnt(4)
  v_exp_f32 v198, v46
  v_mfma_f32_16x16x32_bf16 a[28:31], a[188:191], v[96:99], a[28:31]
  buffer_load_dwordx4 v252, s[12:15], s36 offen lds
  v_mfma_f32_16x16x32_bf16 a[60:63], a[188:191], v[100:103], a[60:63]
  s_waitcnt lgkmcnt(3)
  v_exp_f32 v199, v47
  v_mfma_f32_16x16x32_bf16 a[92:95], a[188:191], v[104:107], a[92:95]
  s_cmp_ge_u32 s61, s63
  v_cvt_pk_bf16_f32 v119, v198, v199
  v_add_u32 v230, 0x10000, v229
  v_mfma_f32_16x16x32_bf16 a[124:127], a[188:191], v[108:111], a[124:127]
  s_cbranch_scc1 L_adaL_ev_25
L_adaL_evb_26:
  v_mfma_f32_16x16x32_bf16 v[0:3], a[128:131], v[128:131], v[64:67]
  s_waitcnt lgkmcnt(0)
  v_add_u32 v229, 8192, v228
  v_and_b32 v229, 0xffff, v229
  v_mfma_f32_16x16x32_bf16 v[0:3], a[132:135], v[132:135], v[0:3]
  s_pack_ll_b32_b16 m0, s59, 0
  v_exp_f32 v192, v52
  v_mfma_f32_16x16x32_bf16 v[0:3], a[136:139], v[136:139], v[0:3]
  v_mfma_f32_16x16x32_bf16 v[0:3], a[140:143], v[140:143], v[0:3]
  s_add_u32 s36, s36, 32
  v_exp_f32 v193, v53
  v_mfma_f32_16x16x32_bf16 v[8:11], a[128:131], v[144:147], v[72:75]
  s_cmp_lt_u32 s56, s100
  ds_read_b128 a[144:147], v228 offset:4096
  v_cvt_pk_bf16_f32 v122, v192, v193
  v_mfma_f32_16x16x32_bf16 v[8:11], a[132:135], v[148:151], v[8:11]
  s_cselect_b32 s22, s22, 0
  v_exp_f32 v194, v54
  v_mfma_f32_16x16x32_bf16 v[8:11], a[136:139], v[152:155], v[8:11]
  buffer_load_dwordx4 v225, s[24:27], s59 offen offset:0 sc1 lds
  v_mfma_f32_16x16x32_bf16 v[8:11], a[140:143], v[156:159], v[8:11]
  v_exp_f32 v195, v55
  v_mfma_f32_16x16x32_bf16 v[16:19], a[128:131], v[160:163], v[80:83]
  ds_read_b128 a[148:151], v228 offset:5120
  v_cvt_pk_bf16_f32 v123, v194, v195
  v_mfma_f32_16x16x32_bf16 v[16:19], a[132:135], v[164:167], v[16:19]
  v_exp_f32 v196, v60
  v_mfma_f32_16x16x32_bf16 v[16:19], a[136:139], v[168:171], v[16:19]
  v_mfma_f32_16x16x32_bf16 v[16:19], a[140:143], v[172:175], v[16:19]
  v_exp_f32 v197, v61
  v_mfma_f32_16x16x32_bf16 v[24:27], a[128:131], v[176:179], v[88:91]
  ds_read_b128 a[152:155], v228 offset:6144
  v_cvt_pk_bf16_f32 v126, v196, v197
  v_mfma_f32_16x16x32_bf16 v[24:27], a[132:135], v[180:183], v[24:27]
  v_exp_f32 v198, v62
  v_mfma_f32_16x16x32_bf16 v[24:27], a[136:139], v[184:187], v[24:27]
  ds_read_b128 a[156:159], v228 offset:7168
  v_mfma_f32_16x16x32_bf16 v[24:27], a[140:143], v[188:191], v[24:27]
  s_waitcnt lgkmcnt(2)
  v_exp_f32 v199, v63
  v_mfma_f32_16x16x32_bf16 v[4:7], a[144:147], v[128:131], v[68:71]
  v_cvt_pk_bf16_f32 v127, v198, v199
  v_mfma_f32_16x16x32_bf16 v[4:7], a[148:151], v[132:135], v[4:7]
  v_exp_f32 v192, v0
  v_mfma_f32_16x16x32_bf16 v[200:203], v[216:219], v[112:115], 0
  v_mfma_f32_16x16x32_bf16 v[204:207], v[216:219], v[116:119], 0
  v_exp_f32 v193, v1
  v_mfma_f32_16x16x32_bf16 v[208:211], v[216:219], v[120:123], 0
  v_cvt_pk_bf16_f32 v96, v192, v193
  v_mfma_f32_16x16x32_bf16 v[212:215], v[216:219], v[124:127], 0
  s_waitcnt lgkmcnt(0)
  v_exp_f32 v194, v2
  v_mfma_f32_16x16x32_bf16 v[4:7], a[152:155], v[136:139], v[4:7]
  buffer_load_dwordx4 v225, s[24:27], s59 offen offset:1024 sc1 lds
  v_mfma_f32_16x16x32_bf16 v[4:7], a[156:159], v[140:143], v[4:7]
  s_add_u32 s59, s59, 8192
  v_exp_f32 v195, v3
  v_mfma_f32_16x16x32_bf16 v[12:15], a[144:147], v[144:147], v[76:79]
  s_pack_ll_b32_b16 m0, s60, 1
  v_cvt_pk_bf16_f32 v97, v194, v195
  v_mfma_f32_16x16x32_bf16 v[12:15], a[148:151], v[148:151], v[12:15]
  v_exp_f32 v196, v8
  v_mfma_f32_16x16x32_bf16 v[12:15], a[152:155], v[152:155], v[12:15]
  ds_read_b128 a[160:163], v230 offset:0
  v_max3_f32 v240, v200, v204, v208
  v_mfma_f32_16x16x32_bf16 v[12:15], a[156:159], v[156:159], v[12:15]
  v_exp_f32 v197, v9
  v_mfma_f32_16x16x32_bf16 v[20:23], a[144:147], v[160:163], v[84:87]
  v_cvt_pk_bf16_f32 v100, v196, v197
  v_max_f32 v240, v240, v212
  v_mfma_f32_16x16x32_bf16 v[20:23], a[148:151], v[164:167], v[20:23]
  v_exp_f32 v198, v10
  v_mfma_f32_16x16x32_bf16 v[20:23], a[152:155], v[168:171], v[20:23]
  ds_read_b128 a[164:167], v230 offset:1024
  v_cmp_nge_f32 vcc, s40, v240
  v_mfma_f32_16x16x32_bf16 v[20:23], a[156:159], v[172:175], v[20:23]
  v_exp_f32 v199, v11
  v_mfma_f32_16x16x32_bf16 v[28:31], a[144:147], v[176:179], v[92:95]
  v_cvt_pk_bf16_f32 v101, v198, v199
  v_mfma_f32_16x16x32_bf16 v[28:31], a[148:151], v[180:183], v[28:31]
  v_exp_f32 v192, v16
  v_mfma_f32_16x16x32_bf16 v[28:31], a[152:155], v[184:187], v[28:31]
  s_waitcnt lgkmcnt(1)
  ds_read_b128 a[168:171], v230 offset:2048
  v_mfma_f32_16x16x32_bf16 v[28:31], a[156:159], v[188:191], v[28:31]
  s_cbranch_vccnz L_adaL_fb_29
L_adaL_back_30:
  v_exp_f32 v193, v17
  v_mfma_f32_16x16x32_bf16 a[0:3], a[160:163], v[112:115], a[0:3]
  s_waitcnt vmcnt(8)
  s_barrier
  v_mfma_f32_16x16x32_bf16 a[32:35], a[160:163], v[116:119], a[32:35]
  v_cvt_pk_bf16_f32 v104, v192, v193
  v_add_f32 v220, v220, v200
  v_mfma_f32_16x16x32_bf16 a[64:67], a[160:163], v[120:123], a[64:67]
  ds_read_b128 a[172:175], v230 offset:3072
  v_add_f32 v221, v221, v204
  v_mfma_f32_16x16x32_bf16 a[96:99], a[160:163], v[124:127], a[96:99]
  s_waitcnt lgkmcnt(2)
  v_exp_f32 v194, v18
  v_mfma_f32_16x16x32_bf16 a[4:7], a[164:167], v[112:115], a[4:7]
  s_add_u32 s61, s61, 1
  buffer_load_dwordx4 v225, s[28:31], s60 offen offset:0 sc1 lds
  v_mfma_f32_16x16x32_bf16 a[36:39], a[164:167], v[116:119], a[36:39]
  v_exp_f32 v195, v19
  v_mfma_f32_16x16x32_bf16 a[68:71], a[164:167], v[120:123], a[68:71]
  ds_read_b128 a[176:179], v230 offset:4096
  v_cvt_pk_bf16_f32 v105, v194, v195
  v_mfma_f32_16x16x32_bf16 a[100:103], a[164:167], v[124:127], a[100:103]
  s_waitcnt lgkmcnt(2)
  v_exp_f32 v196, v24
  v_mfma_f32_16x16x32_bf16 a[8:11], a[168:171], v[112:115], a[8:11]
  v_add_f32 v222, v222, v208
  v_add_f32 v223, v223, v212
  v_mfma_f32_16x16x32_bf16 a[40:43], a[168:171], v[116:119], a[40:43]
  v_exp_f32 v197, v25
  v_mfma_f32_16x16x32_bf16 a[72:75], a[168:171], v[120:123], a[72:75]
  ds_read_b128 a[180:183], v230 offset:5120
  v_cvt_pk_bf16_f32 v108, v196, v197
  v_mfma_f32_16x16x32_bf16 a[104:107], a[168:171], v[124:127], a[104:107]
  s_waitcnt lgkmcnt(2)
  v_exp_f32 v198, v26
  v_mfma_f32_16x16x32_bf16 a[12:15], a[172:175], v[112:115], a[12:15]
  buffer_store_dwordx4 a[196:199], v225, s[52:55], s57 offen sc1
  v_mfma_f32_16x16x32_bf16 a[44:47], a[172:175], v[116:119], a[44:47]
  s_add_u32 s57, s57, 4096
  v_exp_f32 v199, v27
  v_mfma_f32_16x16x32_bf16 a[76:79], a[172:175], v[120:123], a[76:79]
  ds_read_b128 a[184:187], v230 offset:6144
  v_cvt_pk_bf16_f32 v109, v198, v199
  v_mfma_f32_16x16x32_bf16 a[108:111], a[172:175], v[124:127], a[108:111]
  s_waitcnt lgkmcnt(2)
  v_exp_f32 v192, v4
  v_mfma_f32_16x16x32_bf16 a[16:19], a[176:179], v[112:115], a[16:19]
  v_mfma_f32_16x16x32_bf16 a[48:51], a[176:179], v[116:119], a[48:51]
  v_exp_f32 v193, v5
  v_mfma_f32_16x16x32_bf16 a[80:83], a[176:179], v[120:123], a[80:83]
  ds_read_b128 a[188:191], v230 offset:7168
  v_cvt_pk_bf16_f32 v98, v192, v193
  v_mfma_f32_16x16x32_bf16 a[112:115], a[176:179], v[124:127], a[112:115]
  s_waitcnt lgkmcnt(2)
  v_exp_f32 v194, v6
  v_mfma_f32_16x16x32_bf16 a[20:23], a[180:183], v[112:115], a[20:23]
  buffer_load_dwordx4 v225, s[28:31], s60 offen offset:1024 sc1 lds
  v_mfma_f32_16x16x32_bf16 a[52:55], a[180:183], v[116:119], a[52:55]
  s_add_u32 s60, s60, 8192
  v_exp_f32 v195, v7
  v_mfma_f32_16x16x32_bf16 a[84:87], a[180:183], v[120:123], a[84:87]
  ds_read_b128 a[128:131], v229 offset:0
  v_cvt_pk_bf16_f32 v99, v194, v195
  v_mfma_f32_16x16x32_bf16 a[116:119], a[180:183], v[124:127], a[116:119]
  s_waitcnt lgkmcnt(2)
  v_exp_f32 v196, v12
  v_mfma_f32_16x16x32_bf16 a[24:27], a[184:187], v[112:115], a[24:27]
  ds_read_b128 a[132:135], v229 offset:1024
  ds_read_b128 a[136:139], v229 offset:2048
  v_mfma_f32_16x16x32_bf16 a[56:59], a[184:187], v[116:119], a[56:59]
  v_exp_f32 v197, v13
  v_mfma_f32_16x16x32_bf16 a[88:91], a[184:187], v[120:123], a[88:91]
  ds_read_b128 a[140:143], v229 offset:3072
  v_cvt_pk_bf16_f32 v102, v196, v197
  v_mfma_f32_16x16x32_bf16 a[120:123], a[184:187], v[124:127], a[120:123]
  s_waitcnt lgkmcnt(4)
  v_exp_f32 v198, v14
  v_mfma_f32_16x16x32_bf16 a[28:31], a[188:191], v[112:115], a[28:31]
  buffer_load_dwordx4 a[196:199], v255, s[20:23], s56 offen
  v_mfma_f32_16x16x32_bf16 a[60:63], a[188:191], v[116:119], a[60:63]
  s_waitcnt lgkmcnt(3)
  v_exp_f32 v199, v15
  v_mfma_f32_16x16x32_bf16 a[92:95], a[188:191], v[120:123], a[92:95]
  s_cmp_ge_u32 s61, s63
  v_cvt_pk_bf16_f32 v103, v198, v199
  v_add_u32 v230, 0x10000, v228
  v_mfma_f32_16x16x32_bf16 a[124:127], a[188:191], v[124:127], a[124:127]
  s_cbranch_scc0 L_adaL_dual_20
L_adaL_ev_24:
  s_sub_u32 s63, s47, 0
  s_cmp_lt_u32 s61, s63
  s_cbranch_scc1 L_adaL_mk_31
  s_sub_u32 s46, s47, s61
  s_lshl_b32 s46, s46, 5
  v_add_u32 v240, s46, v231
  v_cvt_f32_i32 v240, v240
  v_add_f32 v240, 0.5, v240
  v_mul_f32 v240, 0x71800000, v240
  v_min_f32 v64, v64, v240
  v_min_f32 v76, v76, v240
  v_subrev_f32 v242, 0x71800000, v240
  v_min_f32 v65, v65, v242
  v_min_f32 v77, v77, v242
  v_subrev_f32 v243, 0x72000000, v240
  v_min_f32 v66, v66, v243
  v_min_f32 v78, v78, v243
  v_subrev_f32 v244, 0x72400000, v240
  v_min_f32 v67, v67, v244
  v_min_f32 v79, v79, v244
  v_subrev_f32 v241, 0x73800000, v240
  v_min_f32 v68, v68, v241
  v_subrev_f32 v242, 0x73880000, v240
  v_min_f32 v69, v69, v242
  v_subrev_f32 v243, 0x73900000, v240
  v_min_f32 v70, v70, v243
  v_subrev_f32 v244, 0x73980000, v240
  v_min_f32 v71, v71, v244
  v_subrev_f32 v241, 0xf3800000, v240
  v_min_f32 v72, v72, v241
  v_subrev_f32 v242, 0xf3700000, v240
  v_min_f32 v73, v73, v242
  v_subrev_f32 v243, 0xf3600000, v240
  v_min_f32 v74, v74, v243
  v_subrev_f32 v244, 0xf3500000, v240
  v_min_f32 v75, v75, v244
L_adaL_mk_31:
  s_cmp_lt_u32 s61, s58
  s_cbranch_scc1 L_adaL_mk_32
  s_call_b64 s[42:43], L_adaL_ptr_19
L_adaL_mk_32:
  s_min_u32 s63, s63, s58
  s_branch L_adaL_dual_20
L_adaL_ev_25:
  s_cmp_eq_u32 s61, s62
  s_cbranch_scc1 L_adaL_trans_21
  s_sub_u32 s63, s47, 0
  s_cmp_lt_u32 s61, s63
  s_cbranch_scc1 L_adaL_mk_33
  s_sub_u32 s46, s47, s61
  s_lshl_b32 s46, s46, 5
  v_add_u32 v240, s46, v231
  v_cvt_f32_i32 v240, v240
  v_add_f32 v240, 0.5, v240
  v_mul_f32 v240, 0x71800000, v240
  v_min_f32 v64, v64, v240
  v_min_f32 v76, v76, v240
  v_subrev_f32 v242, 0x71800000, v240
  v_min_f32 v65, v65, v242
  v_min_f32 v77, v77, v242
  v_subrev_f32 v243, 0x72000000, v240
  v_min_f32 v66, v66, v243
  v_min_f32 v78, v78, v243
  v_subrev_f32 v244, 0x72400000, v240
  v_min_f32 v67, v67, v244
  v_min_f32 v79, v79, v244
  v_subrev_f32 v241, 0x73800000, v240
  v_min_f32 v68, v68, v241
  v_subrev_f32 v242, 0x73880000, v240
  v_min_f32 v69, v69, v242
  v_subrev_f32 v243, 0x73900000, v240
  v_min_f32 v70, v70, v243
  v_subrev_f32 v244, 0x73980000, v240
  v_min_f32 v71, v71, v244
  v_subrev_f32 v241, 0xf3800000, v240
  v_min_f32 v72, v72, v241
  v_subrev_f32 v242, 0xf3700000, v240
  v_min_f32 v73, v73, v242
  v_subrev_f32 v243, 0xf3600000, v240
  v_min_f32 v74, v74, v243
  v_subrev_f32 v244, 0xf3500000, v240
  v_min_f32 v75, v75, v244
L_adaL_mk_33:
  s_cmp_lt_u32 s61, s58
  s_cbranch_scc1 L_adaL_mk_34
  s_call_b64 s[42:43], L_adaL_ptr_19
L_adaL_mk_34:
  s_min_u32 s63, s63, s58
  s_branch L_adaL_evb_26
L_adaL_trans_21:
  ds_read_b128 a[144:147], v228 offset:4096
  ds_read_b128 a[148:151], v228 offset:5120
  v_mov_b32 v64, v80
  v_mov_b32 v65, v81
  v_mov_b32 v66, v82
  v_mov_b32 v67, v83
  v_mov_b32 v68, v84
  v_mov_b32 v69, v85
  v_mov_b32 v70, v86
  v_mov_b32 v71, v87
  v_mov_b32 v72, v88
  v_mov_b32 v73, v89
  v_mov_b32 v74, v90
  v_mov_b32 v75, v91
  v_mov_b32 v76, v92
  v_mov_b32 v77, v93
  v_mov_b32 v78, v94
  v_mov_b32 v79, v95
  s_sub_u32 s62, 60, s62
  s_sub_u32 s63, s50, 1
  s_cmp_lt_u32 s61, s63
  s_cbranch_scc1 L_adaL_mk_35
  s_sub_u32 s46, s50, s61
  s_lshl_b32 s46, s46, 5
  v_add_u32 v240, s46, v231
  v_cvt_f32_i32 v240, v240
  v_add_f32 v240, 0.5, v240
  v_mul_f32 v240, 0x71800000, v240
  v_min_f32 v64, v64, v240
  v_min_f32 v76, v76, v240
  v_subrev_f32 v242, 0x71800000, v240
  v_min_f32 v65, v65, v242
  v_min_f32 v77, v77, v242
  v_subrev_f32 v243, 0x72000000, v240
  v_min_f32 v66, v66, v243
  v_min_f32 v78, v78, v243
  v_subrev_f32 v244, 0x72400000, v240
  v_min_f32 v67, v67, v244
  v_min_f32 v79, v79, v244
  v_subrev_f32 v241, 0x73800000, v240
  v_min_f32 v68, v68, v241
  v_subrev_f32 v242, 0x73880000, v240
  v_min_f32 v69, v69, v242
  v_subrev_f32 v243, 0x73900000, v240
  v_min_f32 v70, v70, v243
  v_subrev_f32 v244, 0x73980000, v240
  v_min_f32 v71, v71, v244
  v_subrev_f32 v241, 0xf3800000, v240
  v_min_f32 v72, v72, v241
  v_subrev_f32 v242, 0xf3700000, v240
  v_min_f32 v73, v73, v242
  v_subrev_f32 v243, 0xf3600000, v240
  v_min_f32 v74, v74, v243
  v_subrev_f32 v244, 0xf3500000, v240
  v_min_f32 v75, v75, v244
  s_sub_u32 s46, s46, 32
  v_add_u32 v240, s46, v231
  v_cvt_f32_i32 v240, v240
  v_add_f32 v240, 0.5, v240
  v_mul_f32 v240, 0x71800000, v240
  v_min_f32 v80, v80, v240
  v_min_f32 v92, v92, v240
  v_subrev_f32 v242, 0x71800000, v240
  v_min_f32 v81, v81, v242
  v_min_f32 v93, v93, v242
  v_subrev_f32 v243, 0x72000000, v240
  v_min_f32 v82, v82, v243
  v_min_f32 v94, v94, v243
  v_subrev_f32 v244, 0x72400000, v240
  v_min_f32 v83, v83, v244
  v_min_f32 v95, v95, v244
  v_subrev_f32 v241, 0x73800000, v240
  v_min_f32 v84, v84, v241
  v_subrev_f32 v242, 0x73880000, v240
  v_min_f32 v85, v85, v242
  v_subrev_f32 v243, 0x73900000, v240
  v_min_f32 v86, v86, v243
  v_subrev_f32 v244, 0x73980000, v240
  v_min_f32 v87, v87, v244
  v_subrev_f32 v241, 0xf3800000, v240
  v_min_f32 v88, v88, v241
  v_subrev_f32 v242, 0xf3700000, v240
  v_min_f32 v89, v89, v242
  v_subrev_f32 v243, 0xf3600000, v240
  v_min_f32 v90, v90, v243
  v_subrev_f32 v244, 0xf3500000, v240
  v_min_f32 v91, v91, v244
L_adaL_mk_35:
  s_cmp_lt_u32 s61, s58
  s_cbranch_scc1 L_adaL_mk_36
  s_call_b64 s[42:43], L_adaL_ptr_19
L_adaL_mk_36:
  s_min_u32 s63, s63, s58
  s_min_u32 s63, s63, s62
  s_waitcnt lgkmcnt(0)
  s_cmp_eq_u32 s7, 7
  s_cbranch_scc1 L_adaL_g7_37
  v_mfma_f32_16x16x32_bf16 v[0:3], a[128:131], v[160:163], v[64:67]
  s_waitcnt lgkmcnt(2)
  ds_read_b128 a[152:155], v228 offset:6144
  v_add_u32 v229, 16384, v228
  v_mfma_f32_16x16x32_bf16 v[0:3], a[132:135], v[164:167], v[0:3]
  s_pack_ll_b32_b16 m0, s59, 0
  v_exp_f32 v192, v52
  v_mfma_f32_16x16x32_bf16 v[0:3], a[136:139], v[168:171], v[0:3]
  ds_read_b128 a[156:159], v228 offset:7168
  v_and_b32 v229, 0xffff, v229
  v_mfma_f32_16x16x32_bf16 v[0:3], a[140:143], v[172:175], v[0:3]
  s_add_u32 s36, s36, 32
  v_exp_f32 v193, v53
  v_mfma_f32_16x16x32_bf16 v[8:11], a[128:131], v[176:179], v[72:75]
  s_cmp_lt_u32 s56, s100
  ds_read_b128 a[160:163], v228 offset:8192
  v_cvt_pk_bf16_f32 v122, v192, v193
  v_mfma_f32_16x16x32_bf16 v[8:11], a[132:135], v[180:183], v[8:11]
  s_cselect_b32 s22, s22, 0
  v_exp_f32 v194, v54
  v_mfma_f32_16x16x32_bf16 v[8:11], a[136:139], v[184:187], v[8:11]
  buffer_load_dwordx4 v225, s[24:27], s59 offen offset:0 sc1 lds
  v_mfma_f32_16x16x32_bf16 v[8:11], a[140:143], v[188:191], v[8:11]
  s_waitcnt lgkmcnt(2)
  v_exp_f32 v195, v55
  v_mfma_f32_16x16x32_bf16 v[4:7], a[144:147], v[160:163], v[68:71]
  ds_read_b128 a[164:167], v228 offset:9216
  v_cvt_pk_bf16_f32 v123, v194, v195
  v_mfma_f32_16x16x32_bf16 v[4:7], a[148:151], v[164:167], v[4:7]
  v_exp_f32 v196, v60
  v_mfma_f32_16x16x32_bf16 v[4:7], a[152:155], v[168:171], v[4:7]
  s_waitcnt lgkmcnt(2)
  v_mfma_f32_16x16x32_bf16 v[4:7], a[156:159], v[172:175], v[4:7]
  v_exp_f32 v197, v61
  v_mfma_f32_16x16x32_bf16 v[12:15], a[144:147], v[176:179], v[76:79]
  ds_read_b128 a[168:171], v228 offset:10240
  v_cvt_pk_bf16_f32 v126, v196, v197
  v_mfma_f32_16x16x32_bf16 v[12:15], a[148:151], v[180:183], v[12:15]
  v_exp_f32 v198, v62
  v_mfma_f32_16x16x32_bf16 v[12:15], a[152:155], v[184:187], v[12:15]
  ds_read_b128 a[172:175], v228 offset:11264
  v_mfma_f32_16x16x32_bf16 v[12:15], a[156:159], v[188:191], v[12:15]
  s_waitcnt lgkmcnt(2)
  v_exp_f32 v199, v63
  v_mfma_f32_16x16x32_bf16 v[16:19], a[160:163], v[160:163], v[80:83]
  ds_read_b128 a[176:179], v228 offset:12288
  v_cvt_pk_bf16_f32 v127, v198, v199
  v_mfma_f32_16x16x32_bf16 v[16:19], a[164:167], v[164:167], v[16:19]
  v_exp_f32 v192, v0
  v_mfma_f32_16x16x32_bf16 v[200:203], v[216:219], v[112:115], 0
  ds_read_b128 a[180:183], v228 offset:13312
  ds_read_b128 a[184:187], v228 offset:14336
  v_mfma_f32_16x16x32_bf16 v[204:207], v[216:219], v[116:119], 0
  v_exp_f32 v193, v1
  v_mfma_f32_16x16x32_bf16 v[208:211], v[216:219], v[120:123], 0
  ds_read_b128 a[188:191], v228 offset:15360
  v_cvt_pk_bf16_f32 v96, v192, v193
  v_mfma_f32_16x16x32_bf16 v[212:215], v[216:219], v[124:127], 0
  s_waitcnt lgkmcnt(4)
  v_exp_f32 v194, v2
  v_mfma_f32_16x16x32_bf16 v[16:19], a[168:171], v[168:171], v[16:19]
  buffer_load_dwordx4 v225, s[24:27], s59 offen offset:1024 sc1 lds
  v_mfma_f32_16x16x32_bf16 v[16:19], a[172:175], v[172:175], v[16:19]
  s_add_u32 s59, s59, 8192
  v_exp_f32 v195, v3
  v_mfma_f32_16x16x32_bf16 v[24:27], a[160:163], v[176:179], v[88:91]
  s_pack_ll_b32_b16 m0, s60, 1
  v_cvt_pk_bf16_f32 v97, v194, v195
  v_mfma_f32_16x16x32_bf16 v[24:27], a[164:167], v[180:183], v[24:27]
  v_exp_f32 v196, v8
  v_mfma_f32_16x16x32_bf16 v[24:27], a[168:171], v[184:187], v[24:27]
  ds_read_b128 a[128:131], v230 offset:0
  v_max3_f32 v240, v200, v204, v208
  v_mfma_f32_16x16x32_bf16 v[24:27], a[172:175], v[188:191], v[24:27]
  s_waitcnt lgkmcnt(1)
  v_exp_f32 v197, v9
  v_mfma_f32_16x16x32_bf16 v[20:23], a[176:179], v[160:163], v[84:87]
  v_cvt_pk_bf16_f32 v100, v196, v197
  v_max_f32 v240, v240, v212
  v_mfma_f32_16x16x32_bf16 v[20:23], a[180:183], v[164:167], v[20:23]
  v_exp_f32 v198, v10
  v_mfma_f32_16x16x32_bf16 v[20:23], a[184:187], v[168:171], v[20:23]
  ds_read_b128 a[132:135], v230 offset:1024
  v_cmp_nge_f32 vcc, s40, v240
  v_mfma_f32_16x16x32_bf16 v[20:23], a[188:191], v[172:175], v[20:23]
  v_exp_f32 v199, v11
  v_mfma_f32_16x16x32_bf16 v[28:31], a[176:179], v[176:179], v[92:95]
  v_cvt_pk_bf16_f32 v101, v198, v199
  v_mfma_f32_16x16x32_bf16 v[28:31], a[180:183], v[180:183], v[28:31]
  v_exp_f32 v192, v4
  v_mfma_f32_16x16x32_bf16 v[28:31], a[184:187], v[184:187], v[28:31]
  s_waitcnt lgkmcnt(1)
  ds_read_b128 a[136:139], v230 offset:2048
  v_mfma_f32_16x16x32_bf16 v[28:31], a[188:191], v[188:191], v[28:31]
  s_cbranch_vccnz L_adaL_fb_39
L_adaL_back_40:
  v_exp_f32 v193, v5
  v_mfma_f32_16x16x32_bf16 a[0:3], a[128:131], v[112:115], a[0:3]
  s_waitcnt vmcnt(8)
  s_barrier
  v_mfma_f32_16x16x32_bf16 a[32:35], a[128:131], v[116:119], a[32:35]
  v_cvt_pk_bf16_f32 v98, v192, v193
  v_add_f32 v220, v220, v200
  v_mfma_f32_16x16x32_bf16 a[64:67], a[128:131], v[120:123], a[64:67]
  ds_read_b128 a[140:143], v230 offset:3072
  v_add_f32 v221, v221, v204
  v_mfma_f32_16x16x32_bf16 a[96:99], a[128:131], v[124:127], a[96:99]
  s_waitcnt lgkmcnt(2)
  v_exp_f32 v194, v6
  v_mfma_f32_16x16x32_bf16 a[4:7], a[132:135], v[112:115], a[4:7]
  s_add_u32 s61, s61, 2
  buffer_load_dwordx4 v225, s[28:31], s60 offen offset:0 sc1 lds
  v_mfma_f32_16x16x32_bf16 a[36:39], a[132:135], v[116:119], a[36:39]
  s_add_u32 s59, s59, s41
  v_exp_f32 v195, v7
  v_mfma_f32_16x16x32_bf16 a[68:71], a[132:135], v[120:123], a[68:71]
  ds_read_b128 a[144:147], v230 offset:4096
  v_cvt_pk_bf16_f32 v99, v194, v195
  v_mfma_f32_16x16x32_bf16 a[100:103], a[132:135], v[124:127], a[100:103]
  s_waitcnt lgkmcnt(2)
  v_exp_f32 v196, v12
  v_mfma_f32_16x16x32_bf16 a[8:11], a[136:139], v[112:115], a[8:11]
  v_add_f32 v222, v222, v208
  v_add_f32 v223, v223, v212
  v_mfma_f32_16x16x32_bf16 a[40:43], a[136:139], v[116:119], a[40:43]
  v_exp_f32 v197, v13
  v_mfma_f32_16x16x32_bf16 a[72:75], a[136:139], v[120:123], a[72:75]
  ds_read_b128 a[148:151], v230 offset:5120
  v_cvt_pk_bf16_f32 v102, v196, v197
  v_mfma_f32_16x16x32_bf16 a[104:107], a[136:139], v[124:127], a[104:107]
  s_waitcnt lgkmcnt(2)
  v_exp_f32 v198, v14
  v_mfma_f32_16x16x32_bf16 a[12:15], a[140:143], v[112:115], a[12:15]
  buffer_store_dwordx4 a[196:199], v225, s[52:55], s57 offen sc1
  v_mfma_f32_16x16x32_bf16 a[44:47], a[140:143], v[116:119], a[44:47]
  s_add_u32 s57, s57, 4096
  v_exp_f32 v199, v15
  v_mfma_f32_16x16x32_bf16 a[76:79], a[140:143], v[120:123], a[76:79]
  ds_read_b128 a[152:155], v230 offset:6144
  v_cvt_pk_bf16_f32 v103, v198, v199
  v_mfma_f32_16x16x32_bf16 a[108:111], a[140:143], v[124:127], a[108:111]
  s_waitcnt lgkmcnt(2)
  v_exp_f32 v192, v16
  v_mfma_f32_16x16x32_bf16 a[16:19], a[144:147], v[112:115], a[16:19]
  ds_read_b128 a[156:159], v230 offset:7168
  v_add_u32 v230, 0x10000, v228
  v_mfma_f32_16x16x32_bf16 a[48:51], a[144:147], v[116:119], a[48:51]
  v_exp_f32 v193, v17
  v_mfma_f32_16x16x32_bf16 a[80:83], a[144:147], v[120:123], a[80:83]
  ds_read_b128 a[128:131], v229 offset:0
  v_cvt_pk_bf16_f32 v104, v192, v193
  v_mfma_f32_16x16x32_bf16 a[112:115], a[144:147], v[124:127], a[112:115]
  s_waitcnt lgkmcnt(3)
  v_exp_f32 v194, v18
  v_mfma_f32_16x16x32_bf16 a[20:23], a[148:151], v[112:115], a[20:23]
  buffer_load_dwordx4 v225, s[28:31], s60 offen offset:1024 sc1 lds
  v_mfma_f32_16x16x32_bf16 a[52:55], a[148:151], v[116:119], a[52:55]
  s_add_u32 s60, s60, 8192
  v_exp_f32 v195, v19
  v_mfma_f32_16x16x32_bf16 a[84:87], a[148:151], v[120:123], a[84:87]
  ds_read_b128 a[132:135], v229 offset:1024
  v_cvt_pk_bf16_f32 v105, v194, v195
  v_mfma_f32_16x16x32_bf16 a[116:119], a[148:151], v[124:127], a[116:119]
  s_waitcnt lgkmcnt(3)
  v_exp_f32 v196, v24
  v_mfma_f32_16x16x32_bf16 a[24:27], a[152:155], v[112:115], a[24:27]
  ds_read_b128 a[136:139], v229 offset:2048
  ds_read_b128 a[140:143], v229 offset:3072
  v_mfma_f32_16x16x32_bf16 a[56:59], a[152:155], v[116:119], a[56:59]
  v_exp_f32 v197, v25
  v_mfma_f32_16x16x32_bf16 a[88:91], a[152:155], v[120:123], a[88:91]
  ds_read_b128 a[144:147], v229 offset:4096
  v_cvt_pk_bf16_f32 v108, v196, v197
  v_mfma_f32_16x16x32_bf16 a[120:123], a[152:155], v[124:127], a[120:123]
  s_waitcnt lgkmcnt(5)
  v_exp_f32 v198, v26
  v_mfma_f32_16x16x32_bf16 a[28:31], a[156:159], v[112:115], a[28:31]
  buffer_load_dwordx4 a[196:199], v255, s[20:23], s56 offen
  v_mfma_f32_16x16x32_bf16 a[60:63], a[156:159], v[116:119], a[60:63]
  s_waitcnt lgkmcnt(4)
  v_exp_f32 v199, v27
  v_mfma_f32_16x16x32_bf16 a[92:95], a[156:159], v[120:123], a[92:95]
  s_add_u32 s60, s60, s41
  ds_read_b128 a[148:151], v229 offset:5120
  v_cvt_pk_bf16_f32 v109, v198, v199
  v_mfma_f32_16x16x32_bf16 a[124:127], a[156:159], v[124:127], a[124:127]
  s_nop 7
  v_rcp_f32 v240, v220
  v_rcp_f32 v242, v221
  s_lshr_b32 s46, s47, 1
  s_mul_i32 s46, s46, 540672
  s_and_b32 s45, s47, 1
  s_lshl_b32 s45, s45, 11
  s_add_u32 s46, s46, s45
  v_accvgpr_read_b32 v128, a0
  v_accvgpr_read_b32 v129, a1
  v_accvgpr_read_b32 v130, a2
  v_accvgpr_read_b32 v131, a3
  v_accvgpr_read_b32 v132, a4
  v_accvgpr_read_b32 v133, a5
  v_accvgpr_read_b32 v134, a6
  v_accvgpr_read_b32 v135, a7
  v_pk_mul_f32 v[128:129], v[128:129], v[240:241] op_sel_hi:[1,0]
  v_pk_mul_f32 v[130:131], v[130:131], v[240:241] op_sel_hi:[1,0]
  v_pk_mul_f32 v[132:133], v[132:133], v[240:241] op_sel_hi:[1,0]
  v_pk_mul_f32 v[134:135], v[134:135], v[240:241] op_sel_hi:[1,0]
  v_cvt_pk_bf16_f32 v128, v128, v129
  v_cvt_pk_bf16_f32 v129, v130, v131
  v_cvt_pk_bf16_f32 v130, v132, v133
  v_cvt_pk_bf16_f32 v131, v134, v135
  buffer_store_dwordx4 v[128:131], v232, s[32:35], s46 offen offset:0 sc1
  v_accvgpr_read_b32 v136, a32
  v_accvgpr_read_b32 v137, a33
  v_accvgpr_read_b32 v138, a34
  v_accvgpr_read_b32 v139, a35
  v_accvgpr_read_b32 v140, a36
  v_accvgpr_read_b32 v141, a37
  v_accvgpr_read_b32 v142, a38
  v_accvgpr_read_b32 v143, a39
  v_pk_mul_f32 v[136:137], v[136:137], v[242:243] op_sel_hi:[1,0]
  v_pk_mul_f32 v[138:139], v[138:139], v[242:243] op_sel_hi:[1,0]
  v_pk_mul_f32 v[140:141], v[140:141], v[242:243] op_sel_hi:[1,0]
  v_pk_mul_f32 v[142:143], v[142:143], v[242:243] op_sel_hi:[1,0]
  v_cvt_pk_bf16_f32 v136, v136, v137
  v_cvt_pk_bf16_f32 v137, v138, v139
  v_cvt_pk_bf16_f32 v138, v140, v141
  v_cvt_pk_bf16_f32 v139, v142, v143
  buffer_store_dwordx4 v[136:139], v232, s[32:35], s46 offen offset:1024 sc1
  s_add_u32 s46, s46, 4096
  v_accvgpr_read_b32 v144, a8
  v_accvgpr_read_b32 v145, a9
  v_accvgpr_read_b32 v146, a10
  v_accvgpr_read_b32 v147, a11
  v_accvgpr_read_b32 v148, a12
  v_accvgpr_read_b32 v149, a13
  v_accvgpr_read_b32 v150, a14
  v_accvgpr_read_b32 v151, a15
  v_pk_mul_f32 v[144:145], v[144:145], v[240:241] op_sel_hi:[1,0]
  v_pk_mul_f32 v[146:147], v[146:147], v[240:241] op_sel_hi:[1,0]
  v_pk_mul_f32 v[148:149], v[148:149], v[240:241] op_sel_hi:[1,0]
  v_pk_mul_f32 v[150:151], v[150:151], v[240:241] op_sel_hi:[1,0]
  v_cvt_pk_bf16_f32 v144, v144, v145
  v_cvt_pk_bf16_f32 v145, v146, v147
  v_cvt_pk_bf16_f32 v146, v148, v149
  v_cvt_pk_bf16_f32 v147, v150, v151
  buffer_store_dwordx4 v[144:147], v232, s[32:35], s46 offen offset:0 sc1
  v_accvgpr_read_b32 v152, a40
  v_accvgpr_read_b32 v153, a41
  v_accvgpr_read_b32 v154, a42
  v_accvgpr_read_b32 v155, a43
  v_accvgpr_read_b32 v156, a44
  v_accvgpr_read_b32 v157, a45
  v_accvgpr_read_b32 v158, a46
  v_accvgpr_read_b32 v159, a47
  v_pk_mul_f32 v[152:153], v[152:153], v[242:243] op_sel_hi:[1,0]
  v_pk_mul_f32 v[154:155], v[154:155], v[242:243] op_sel_hi:[1,0]
  v_pk_mul_f32 v[156:157], v[156:157], v[242:243] op_sel_hi:[1,0]
  v_pk_mul_f32 v[158:159], v[158:159], v[242:243] op_sel_hi:[1,0]
  v_cvt_pk_bf16_f32 v152, v152, v153
  v_cvt_pk_bf16_f32 v153, v154, v155
  v_cvt_pk_bf16_f32 v154, v156, v157
  v_cvt_pk_bf16_f32 v155, v158, v159
  buffer_store_dwordx4 v[152:155], v232, s[32:35], s46 offen offset:1024 sc1
  s_add_u32 s46, s46, 4096
  v_accvgpr_read_b32 v128, a16
  v_accvgpr_read_b32 v129, a17
  v_accvgpr_read_b32 v130, a18
  v_accvgpr_read_b32 v131, a19
  v_accvgpr_read_b32 v132, a20
  v_accvgpr_read_b32 v133, a21
  v_accvgpr_read_b32 v134, a22
  v_accvgpr_read_b32 v135, a23
  v_pk_mul_f32 v[128:129], v[128:129], v[240:241] op_sel_hi:[1,0]
  v_pk_mul_f32 v[130:131], v[130:131], v[240:241] op_sel_hi:[1,0]
  v_pk_mul_f32 v[132:133], v[132:133], v[240:241] op_sel_hi:[1,0]
  v_pk_mul_f32 v[134:135], v[134:135], v[240:241] op_sel_hi:[1,0]
  v_cvt_pk_bf16_f32 v128, v128, v129
  v_cvt_pk_bf16_f32 v129, v130, v131
  v_cvt_pk_bf16_f32 v130, v132, v133
  v_cvt_pk_bf16_f32 v131, v134, v135
  buffer_store_dwordx4 v[128:131], v232, s[32:35], s46 offen offset:0 sc1
  v_accvgpr_read_b32 v136, a48
  v_accvgpr_read_b32 v137, a49
  v_accvgpr_read_b32 v138, a50
  v_accvgpr_read_b32 v139, a51
  v_accvgpr_read_b32 v140, a52
  v_accvgpr_read_b32 v141, a53
  v_accvgpr_read_b32 v142, a54
  v_accvgpr_read_b32 v143, a55
  v_pk_mul_f32 v[136:137], v[136:137], v[242:243] op_sel_hi:[1,0]
  v_pk_mul_f32 v[138:139], v[138:139], v[242:243] op_sel_hi:[1,0]
  v_pk_mul_f32 v[140:141], v[140:141], v[242:243] op_sel_hi:[1,0]
  v_pk_mul_f32 v[142:143], v[142:143], v[242:243] op_sel_hi:[1,0]
  v_cvt_pk_bf16_f32 v136, v136, v137
  v_cvt_pk_bf16_f32 v137, v138, v139
  v_cvt_pk_bf16_f32 v138, v140, v141
  v_cvt_pk_bf16_f32 v139, v142, v143
  buffer_store_dwordx4 v[136:139], v232, s[32:35], s46 offen offset:1024 sc1
  s_add_u32 s46, s46, 4096
  v_accvgpr_read_b32 v144, a24
  v_accvgpr_read_b32 v145, a25
  v_accvgpr_read_b32 v146, a26
  v_accvgpr_read_b32 v147, a27
  v_accvgpr_read_b32 v148, a28
  v_accvgpr_read_b32 v149, a29
  v_accvgpr_read_b32 v150, a30
  v_accvgpr_read_b32 v151, a31
  v_pk_mul_f32 v[144:145], v[144:145], v[240:241] op_sel_hi:[1,0]
  v_pk_mul_f32 v[146:147], v[146:147], v[240:241] op_sel_hi:[1,0]
  v_pk_mul_f32 v[148:149], v[148:149], v[240:241] op_sel_hi:[1,0]
  v_pk_mul_f32 v[150:151], v[150:151], v[240:241] op_sel_hi:[1,0]
  v_cvt_pk_bf16_f32 v144, v144, v145
  v_cvt_pk_bf16_f32 v145, v146, v147
  v_cvt_pk_bf16_f32 v146, v148, v149
  v_cvt_pk_bf16_f32 v147, v150, v151
  buffer_store_dwordx4 v[144:147], v232, s[32:35], s46 offen offset:0 sc1
  v_accvgpr_read_b32 v152, a56
  v_accvgpr_read_b32 v153, a57
  v_accvgpr_read_b32 v154, a58
  v_accvgpr_read_b32 v155, a59
  v_accvgpr_read_b32 v156, a60
  v_accvgpr_read_b32 v157, a61
  v_accvgpr_read_b32 v158, a62
  v_accvgpr_read_b32 v159, a63
  v_pk_mul_f32 v[152:153], v[152:153], v[242:243] op_sel_hi:[1,0]
  v_pk_mul_f32 v[154:155], v[154:155], v[242:243] op_sel_hi:[1,0]
  v_pk_mul_f32 v[156:157], v[156:157], v[242:243] op_sel_hi:[1,0]
  v_pk_mul_f32 v[158:159], v[158:159], v[242:243] op_sel_hi:[1,0]
  v_cvt_pk_bf16_f32 v152, v152, v153
  v_cvt_pk_bf16_f32 v153, v154, v155
  v_cvt_pk_bf16_f32 v154, v156, v157
  v_cvt_pk_bf16_f32 v155, v158, v159
  buffer_store_dwordx4 v[152:155], v232, s[32:35], s46 offen offset:1024 sc1
  s_add_u32 s46, s46, 4096
  s_cmp_ge_u32 s61, s63
  s_cbranch_scc1 L_adaL_ev_41
.p2align 6
L_adaL_single_22:
  v_mfma_f32_16x16x32_bf16 v[32:35], a[128:131], v[160:163], v[64:67]
  s_waitcnt lgkmcnt(2)
  ds_read_b128 a[152:155], v229 offset:6144
  v_add_u32 v228, 16384, v229
  v_and_b32 v228, 0xffff, v228
  v_mfma_f32_16x16x32_bf16 v[32:35], a[132:135], v[164:167], v[32:35]
  s_pack_ll_b32_b16 m0, s59, 0
  v_exp_f32 v192, v20
  v_mfma_f32_16x16x32_bf16 v[32:35], a[136:139], v[168:171], v[32:35]
  ds_read_b128 a[156:159], v229 offset:7168
  buffer_load_dwordx4 v225, s[24:27], s59 offen offset:0 sc1 lds
  v_mfma_f32_16x16x32_bf16 v[32:35], a[140:143], v[172:175], v[32:35]
  s_cmp_lt_u32 s36, s37
  v_exp_f32 v193, v21
  v_mfma_f32_16x16x32_bf16 v[40:43], a[128:131], v[176:179], v[72:75]
  s_cselect_b32 s14, s39, 0
  ds_read_b128 a[160:163], v229 offset:8192
  v_cvt_pk_bf16_f32 v106, v192, v193
  v_mfma_f32_16x16x32_bf16 v[40:43], a[132:135], v[180:183], v[40:43]
  v_exp_f32 v194, v22
  v_mfma_f32_16x16x32_bf16 v[40:43], a[136:139], v[184:187], v[40:43]
  ds_read_b128 a[164:167], v229 offset:9216
  ds_read_b128 a[168:171], v229 offset:10240
  v_mfma_f32_16x16x32_bf16 v[40:43], a[140:143], v[188:191], v[40:43]
  s_waitcnt lgkmcnt(4)
  v_exp_f32 v195, v23
  v_mfma_f32_16x16x32_bf16 v[36:39], a[144:147], v[160:163], v[68:71]
  ds_read_b128 a[172:175], v229 offset:11264
  v_cvt_pk_bf16_f32 v107, v194, v195
  v_mfma_f32_16x16x32_bf16 v[36:39], a[148:151], v[164:167], v[36:39]
  v_exp_f32 v196, v28
  v_mfma_f32_16x16x32_bf16 v[36:39], a[152:155], v[168:171], v[36:39]
  s_waitcnt lgkmcnt(4)
  ds_read_b128 a[176:179], v229 offset:12288
  buffer_load_dwordx4 v225, s[24:27], s59 offen offset:1024 sc1 lds
  v_mfma_f32_16x16x32_bf16 v[36:39], a[156:159], v[172:175], v[36:39]
  v_exp_f32 v197, v29
  v_mfma_f32_16x16x32_bf16 v[44:47], a[144:147], v[176:179], v[76:79]
  ds_read_b128 a[180:183], v229 offset:13312
  v_cvt_pk_bf16_f32 v110, v196, v197
  v_mfma_f32_16x16x32_bf16 v[44:47], a[148:151], v[180:183], v[44:47]
  v_exp_f32 v198, v30
  v_mfma_f32_16x16x32_bf16 v[44:47], a[152:155], v[184:187], v[44:47]
  ds_read_b128 a[184:187], v229 offset:14336
  ds_read_b128 a[188:191], v229 offset:15360
  v_mfma_f32_16x16x32_bf16 v[44:47], a[156:159], v[188:191], v[44:47]
  s_waitcnt lgkmcnt(6)
  v_exp_f32 v199, v31
  v_mfma_f32_16x16x32_bf16 v[48:51], a[160:163], v[160:163], v[80:83]
  ds_read_b128 a[128:131], v230 offset:0
  v_cvt_pk_bf16_f32 v111, v198, v199
  v_mfma_f32_16x16x32_bf16 v[48:51], a[164:167], v[164:167], v[48:51]
  v_exp_f32 v192, v32
  v_mfma_f32_16x16x32_bf16 v[208:211], v[216:219], v[96:99], 0
  buffer_load_dwordx4 v225, s[24:27], s59 offen offset:2048 sc1 lds
  v_mfma_f32_16x16x32_bf16 v[212:215], v[216:219], v[100:103], 0
  v_exp_f32 v193, v33
  v_mfma_f32_16x16x32_bf16 v[208:211], v[216:219], v[104:107], v[208:211]
  ds_read_b128 a[132:135], v230 offset:8192
  v_cvt_pk_bf16_f32 v112, v192, v193
  v_mfma_f32_16x16x32_bf16 v[212:215], v[216:219], v[108:111], v[212:215]
  s_waitcnt lgkmcnt(6)
  v_exp_f32 v194, v34
  v_mfma_f32_16x16x32_bf16 v[48:51], a[168:171], v[168:171], v[48:51]
  ds_read_b128 a[136:139], v230 offset:1024
  ds_read_b128 a[140:143], v230 offset:9216
  v_mfma_f32_16x16x32_bf16 v[48:51], a[172:175], v[172:175], v[48:51]
  v_exp_f32 v195, v35
  v_mfma_f32_16x16x32_bf16 v[56:59], a[160:163], v[176:179], v[88:91]
  ds_read_b128 a[144:147], v230 offset:2048
  v_cvt_pk_bf16_f32 v113, v194, v195
  v_mfma_f32_16x16x32_bf16 v[56:59], a[164:167], v[180:183], v[56:59]
  v_exp_f32 v196, v40
  v_mfma_f32_16x16x32_bf16 v[56:59], a[168:171], v[184:187], v[56:59]
  ds_read_b128 a[148:151], v230 offset:10240
  buffer_load_dwordx4 v225, s[24:27], s59 offen offset:3072 sc1 lds
  v_mfma_f32_16x16x32_bf16 v[56:59], a[172:175], v[188:191], v[56:59]
  s_waitcnt lgkmcnt(6)
  v_exp_f32 v197, v41
  v_mfma_f32_16x16x32_bf16 v[52:55], a[176:179], v[160:163], v[84:87]
  s_add_u32 s59, s59, 16384
  ds_read_b128 a[152:155], v230 offset:3072
  v_cvt_pk_bf16_f32 v116, v196, v197
  v_mfma_f32_16x16x32_bf16 v[52:55], a[180:183], v[164:167], v[52:55]
  s_pack_ll_b32_b16 m0, s60, 1
  v_exp_f32 v198, v42
  v_mfma_f32_16x16x32_bf16 v[52:55], a[184:187], v[168:171], v[52:55]
  ds_read_b128 a[156:159], v230 offset:11264
  v_max_f32 v240, v208, v212
  v_mfma_f32_16x16x32_bf16 v[52:55], a[188:191], v[172:175], v[52:55]
  v_exp_f32 v199, v43
  v_mfma_f32_16x16x32_bf16 v[60:63], a[176:179], v[176:179], v[92:95]
  ds_read_b128 a[160:163], v230 offset:4096
  v_cvt_pk_bf16_f32 v117, v198, v199
  v_mfma_f32_16x16x32_bf16 v[60:63], a[180:183], v[180:183], v[60:63]
  v_exp_f32 v192, v36
  v_mfma_f32_16x16x32_bf16 v[60:63], a[184:187], v[184:187], v[60:63]
  s_waitcnt lgkmcnt(7)
  ds_read_b128 a[164:167], v230 offset:12288
  v_cmp_nge_f32 vcc, s40, v240
  v_mfma_f32_16x16x32_bf16 v[60:63], a[188:191], v[188:191], v[60:63]
  s_cbranch_vccnz L_adaL_fb_44
L_adaL_back_45:
  v_exp_f32 v193, v37
  v_mfma_f32_16x16x32_bf16 a[64:67], a[128:131], v[96:99], a[64:67]
  s_waitcnt vmcnt(12)
  s_barrier
  v_mfma_f32_16x16x32_bf16 a[64:67], a[132:135], v[104:107], a[64:67]
  ds_read_b64_tr_b16 a[192:193], v254
  v_cvt_pk_bf16_f32 v114, v192, v193
  v_add_f32 v222, v222, v208
  v_mfma_f32_16x16x32_bf16 a[96:99], a[128:131], v[100:103], a[96:99]
  ds_read_b64_tr_b16 a[194:195], v254 offset:512
  ds_read_b128 a[168:171], v230 offset:5120
  v_add_f32 v223, v223, v212
  v_mfma_f32_16x16x32_bf16 a[96:99], a[132:135], v[108:111], a[96:99]
  s_waitcnt lgkmcnt(9)
  v_exp_f32 v194, v38
  v_mfma_f32_16x16x32_bf16 a[68:71], a[136:139], v[96:99], a[68:71]
  s_add_u32 s61, s61, 2
  ds_read_b128 a[172:175], v230 offset:13312
  buffer_load_dwordx4 v225, s[28:31], s60 offen offset:0 sc1 lds
  v_mfma_f32_16x16x32_bf16 a[68:71], a[140:143], v[104:107], a[68:71]
  v_exp_f32 v195, v39
  v_mfma_f32_16x16x32_bf16 a[100:103], a[136:139], v[100:103], a[100:103]
  ds_read_b128 a[176:179], v230 offset:6144
  v_cvt_pk_bf16_f32 v115, v194, v195
  v_mfma_f32_16x16x32_bf16 a[100:103], a[140:143], v[108:111], a[100:103]
  s_waitcnt lgkmcnt(9)
  v_exp_f32 v196, v44
  v_mfma_f32_16x16x32_bf16 a[72:75], a[144:147], v[96:99], a[72:75]
  buffer_load_dwordx4 v225, s[28:31], s60 offen offset:1024 sc1 lds
  v_mfma_f32_16x16x32_bf16 a[72:75], a[148:151], v[104:107], a[72:75]
  v_exp_f32 v197, v45
  v_mfma_f32_16x16x32_bf16 a[104:107], a[144:147], v[100:103], a[104:107]
  ds_read_b128 a[180:183], v230 offset:14336
  v_cvt_pk_bf16_f32 v118, v196, v197
  v_mfma_f32_16x16x32_bf16 a[104:107], a[148:151], v[108:111], a[104:107]
  s_waitcnt lgkmcnt(4)
  v_exp_f32 v198, v46
  v_mfma_f32_16x16x32_bf16 a[76:79], a[152:155], v[96:99], a[76:79]
  buffer_store_dwordx4 a[192:195], v225, s[16:19], s38 offen sc1
  v_mfma_f32_16x16x32_bf16 a[76:79], a[156:159], v[104:107], a[76:79]
  s_add_u32 s38, s38, 1024
  v_exp_f32 v199, v47
  v_mfma_f32_16x16x32_bf16 a[108:111], a[152:155], v[100:103], a[108:111]
  ds_read_b128 a[184:187], v230 offset:7168
  v_cvt_pk_bf16_f32 v119, v198, v199
  v_mfma_f32_16x16x32_bf16 a[108:111], a[156:159], v[108:111], a[108:111]
  v_exp_f32 v192, v48
  v_mfma_f32_16x16x32_bf16 a[80:83], a[160:163], v[96:99], a[80:83]
  ds_read_b128 a[188:191], v230 offset:15360
  ds_read_b128 a[128:131], v228 offset:0
  v_mfma_f32_16x16x32_bf16 a[80:83], a[164:167], v[104:107], a[80:83]
  v_exp_f32 v193, v49
  v_mfma_f32_16x16x32_bf16 a[112:115], a[160:163], v[100:103], a[112:115]
  ds_read_b128 a[132:135], v228 offset:1024
  v_cvt_pk_bf16_f32 v120, v192, v193
  v_mfma_f32_16x16x32_bf16 a[112:115], a[164:167], v[108:111], a[112:115]
  s_waitcnt lgkmcnt(6)
  v_exp_f32 v194, v50
  v_mfma_f32_16x16x32_bf16 a[84:87], a[168:171], v[96:99], a[84:87]
  buffer_load_dwordx4 v225, s[28:31], s60 offen offset:2048 sc1 lds
  v_mfma_f32_16x16x32_bf16 a[84:87], a[172:175], v[104:107], a[84:87]
  v_exp_f32 v195, v51
  v_mfma_f32_16x16x32_bf16 a[116:119], a[168:171], v[100:103], a[116:119]
  ds_read_b128 a[136:139], v228 offset:2048
  v_cvt_pk_bf16_f32 v121, v194, v195
  v_mfma_f32_16x16x32_bf16 a[116:119], a[172:175], v[108:111], a[116:119]
  s_waitcnt lgkmcnt(5)
  v_exp_f32 v196, v56
  v_mfma_f32_16x16x32_bf16 a[88:91], a[176:179], v[96:99], a[88:91]
  buffer_load_dwordx4 v225, s[28:31], s60 offen offset:3072 sc1 lds
  v_mfma_f32_16x16x32_bf16 a[88:91], a[180:183], v[104:107], a[88:91]
  s_mov_b32 m0, s51
  v_exp_f32 v197, v57
  v_mfma_f32_16x16x32_bf16 a[120:123], a[176:179], v[100:103], a[120:123]
  s_add_u32 s60, s60, 16384
  ds_read_b128 a[140:143], v228 offset:3072
  v_cvt_pk_bf16_f32 v124, v196, v197
  v_mfma_f32_16x16x32_bf16 a[120:123], a[180:183], v[108:111], a[120:123]
  s_waitcnt lgkmcnt(4)
  v_exp_f32 v198, v58
  v_mfma_f32_16x16x32_bf16 a[92:95], a[184:187], v[96:99], a[92:95]
  ds_read_b128 a[144:147], v228 offset:4096
  v_add_u32 v230, 0x10000, v229
  v_mfma_f32_16x16x32_bf16 a[92:95], a[188:191], v[104:107], a[92:95]
  s_waitcnt lgkmcnt(4)
  v_exp_f32 v199, v59
  v_mfma_f32_16x16x32_bf16 a[124:127], a[184:187], v[100:103], a[124:127]
  s_cmp_ge_u32 s61, s63
  ds_read_b128 a[148:151], v228 offset:5120
  v_cvt_pk_bf16_f32 v125, v198, v199
  v_mfma_f32_16x16x32_bf16 a[124:127], a[188:191], v[108:111], a[124:127]
  buffer_load_dwordx4 v252, s[12:15], s36 offen lds
  s_cbranch_scc1 L_adaL_ev_42
L_adaL_evb_43:
  v_mfma_f32_16x16x32_bf16 v[0:3], a[128:131], v[160:163], v[64:67]
  s_waitcnt lgkmcnt(2)
  ds_read_b128 a[152:155], v228 offset:6144
  v_add_u32 v229, 16384, v228
  v_mfma_f32_16x16x32_bf16 v[0:3], a[132:135], v[164:167], v[0:3]
  s_pack_ll_b32_b16 m0, s59, 0
  v_exp_f32 v192, v52
  v_mfma_f32_16x16x32_bf16 v[0:3], a[136:139], v[168:171], v[0:3]
  ds_read_b128 a[156:159], v228 offset:7168
  buffer_load_dwordx4 v225, s[24:27], s59 offen offset:0 sc1 lds
  v_mfma_f32_16x16x32_bf16 v[0:3], a[140:143], v[172:175], v[0:3]
  s_add_u32 s36, s36, 32
  v_exp_f32 v193, v53
  v_mfma_f32_16x16x32_bf16 v[8:11], a[128:131], v[176:179], v[72:75]
  v_cvt_pk_bf16_f32 v122, v192, v193
  v_and_b32 v229, 0xffff, v229
  v_mfma_f32_16x16x32_bf16 v[8:11], a[132:135], v[180:183], v[8:11]
  v_exp_f32 v194, v54
  v_mfma_f32_16x16x32_bf16 v[8:11], a[136:139], v[184:187], v[8:11]
  ds_read_b128 a[160:163], v228 offset:8192
  ds_read_b128 a[164:167], v228 offset:9216
  v_mfma_f32_16x16x32_bf16 v[8:11], a[140:143], v[188:191], v[8:11]
  s_waitcnt lgkmcnt(3)
  v_exp_f32 v195, v55
  v_mfma_f32_16x16x32_bf16 v[4:7], a[144:147], v[160:163], v[68:71]
  ds_read_b128 a[168:171], v228 offset:10240
  v_cvt_pk_bf16_f32 v123, v194, v195
  v_mfma_f32_16x16x32_bf16 v[4:7], a[148:151], v[164:167], v[4:7]
  v_exp_f32 v196, v60
  v_mfma_f32_16x16x32_bf16 v[4:7], a[152:155], v[168:171], v[4:7]
  s_waitcnt lgkmcnt(3)
  buffer_load_dwordx4 v225, s[24:27], s59 offen offset:1024 sc1 lds
  v_mfma_f32_16x16x32_bf16 v[4:7], a[156:159], v[172:175], v[4:7]
  v_exp_f32 v197, v61
  v_mfma_f32_16x16x32_bf16 v[12:15], a[144:147], v[176:179], v[76:79]
  ds_read_b128 a[172:175], v228 offset:11264
  v_cvt_pk_bf16_f32 v126, v196, v197
  v_mfma_f32_16x16x32_bf16 v[12:15], a[148:151], v[180:183], v[12:15]
  v_exp_f32 v198, v62
  v_mfma_f32_16x16x32_bf16 v[12:15], a[152:155], v[184:187], v[12:15]
  ds_read_b128 a[176:179], v228 offset:12288
  ds_read_b128 a[180:183], v228 offset:13312
  v_mfma_f32_16x16x32_bf16 v[12:15], a[156:159], v[188:191], v[12:15]
  s_waitcnt lgkmcnt(4)
  v_exp_f32 v199, v63
  v_mfma_f32_16x16x32_bf16 v[16:19], a[160:163], v[160:163], v[80:83]
  ds_read_b128 a[184:187], v228 offset:14336
  v_cvt_pk_bf16_f32 v127, v198, v199
  v_mfma_f32_16x16x32_bf16 v[16:19], a[164:167], v[164:167], v[16:19]
  v_exp_f32 v192, v0
  v_mfma_f32_16x16x32_bf16 v[208:211], v[216:219], v[112:115], 0
  buffer_load_dwordx4 v225, s[24:27], s59 offen offset:2048 sc1 lds
  v_mfma_f32_16x16x32_bf16 v[212:215], v[216:219], v[116:119], 0
  v_exp_f32 v193, v1
  v_mfma_f32_16x16x32_bf16 v[208:211], v[216:219], v[120:123], v[208:211]
  ds_read_b128 a[188:191], v228 offset:15360
  v_cvt_pk_bf16_f32 v96, v192, v193
  v_mfma_f32_16x16x32_bf16 v[212:215], v[216:219], v[124:127], v[212:215]
  s_waitcnt lgkmcnt(4)
  v_exp_f32 v194, v2
  v_mfma_f32_16x16x32_bf16 v[16:19], a[168:171], v[168:171], v[16:19]
  ds_read_b128 a[128:131], v230 offset:0
  ds_read_b128 a[132:135], v230 offset:8192
  v_mfma_f32_16x16x32_bf16 v[16:19], a[172:175], v[172:175], v[16:19]
  v_exp_f32 v195, v3
  v_mfma_f32_16x16x32_bf16 v[24:27], a[160:163], v[176:179], v[88:91]
  ds_read_b128 a[136:139], v230 offset:1024
  v_cvt_pk_bf16_f32 v97, v194, v195
  v_mfma_f32_16x16x32_bf16 v[24:27], a[164:167], v[180:183], v[24:27]
  v_exp_f32 v196, v8
  v_mfma_f32_16x16x32_bf16 v[24:27], a[168:171], v[184:187], v[24:27]
  buffer_load_dwordx4 v225, s[24:27], s59 offen offset:3072 sc1 lds
  v_mfma_f32_16x16x32_bf16 v[24:27], a[172:175], v[188:191], v[24:27]
  s_waitcnt lgkmcnt(3)
  v_exp_f32 v197, v9
  v_mfma_f32_16x16x32_bf16 v[20:23], a[176:179], v[160:163], v[84:87]
  s_add_u32 s59, s59, 16384
  ds_read_b128 a[140:143], v230 offset:9216
  v_cvt_pk_bf16_f32 v100, v196, v197
  v_mfma_f32_16x16x32_bf16 v[20:23], a[180:183], v[164:167], v[20:23]
  s_pack_ll_b32_b16 m0, s60, 1
  v_exp_f32 v198, v10
  v_mfma_f32_16x16x32_bf16 v[20:23], a[184:187], v[168:171], v[20:23]
  ds_read_b128 a[144:147], v230 offset:2048
  v_max_f32 v240, v208, v212
  v_mfma_f32_16x16x32_bf16 v[20:23], a[188:191], v[172:175], v[20:23]
  v_exp_f32 v199, v11
  v_mfma_f32_16x16x32_bf16 v[28:31], a[176:179], v[176:179], v[92:95]
  ds_read_b128 a[148:151], v230 offset:10240
  v_cvt_pk_bf16_f32 v101, v198, v199
  v_mfma_f32_16x16x32_bf16 v[28:31], a[180:183], v[180:183], v[28:31]
  v_exp_f32 v192, v4
  v_mfma_f32_16x16x32_bf16 v[28:31], a[184:187], v[184:187], v[28:31]
  s_waitcnt lgkmcnt(4)
  ds_read_b128 a[152:155], v230 offset:3072
  v_cmp_nge_f32 vcc, s40, v240
  v_mfma_f32_16x16x32_bf16 v[28:31], a[188:191], v[188:191], v[28:31]
  s_cbranch_vccnz L_adaL_fb_46
L_adaL_back_47:
  v_exp_f32 v193, v5
  v_mfma_f32_16x16x32_bf16 a[64:67], a[128:131], v[112:115], a[64:67]
  s_waitcnt vmcnt(14)
  s_barrier
  v_mfma_f32_16x16x32_bf16 a[64:67], a[132:135], v[120:123], a[64:67]
  v_cvt_pk_bf16_f32 v98, v192, v193
  v_add_f32 v222, v222, v208
  v_mfma_f32_16x16x32_bf16 a[96:99], a[128:131], v[116:119], a[96:99]
  ds_read_b128 a[156:159], v230 offset:11264
  ds_read_b128 a[160:163], v230 offset:4096
  v_mfma_f32_16x16x32_bf16 a[96:99], a[132:135], v[124:127], a[96:99]
  s_waitcnt lgkmcnt(5)
  v_exp_f32 v194, v6
  v_mfma_f32_16x16x32_bf16 a[68:71], a[136:139], v[112:115], a[68:71]
  s_add_u32 s61, s61, 2
  buffer_load_dwordx4 v225, s[28:31], s60 offen offset:0 sc1 lds
  v_mfma_f32_16x16x32_bf16 a[68:71], a[140:143], v[120:123], a[68:71]
  v_exp_f32 v195, v7
  v_mfma_f32_16x16x32_bf16 a[100:103], a[136:139], v[116:119], a[100:103]
  ds_read_b128 a[164:167], v230 offset:12288
  v_cvt_pk_bf16_f32 v99, v194, v195
  v_mfma_f32_16x16x32_bf16 a[100:103], a[140:143], v[124:127], a[100:103]
  s_waitcnt lgkmcnt(4)
  v_exp_f32 v196, v12
  v_mfma_f32_16x16x32_bf16 a[72:75], a[144:147], v[112:115], a[72:75]
  ds_read_b128 a[168:171], v230 offset:5120
  ds_read_b128 a[172:175], v230 offset:13312
  v_mfma_f32_16x16x32_bf16 a[72:75], a[148:151], v[120:123], a[72:75]
  v_exp_f32 v197, v13
  v_mfma_f32_16x16x32_bf16 a[104:107], a[144:147], v[116:119], a[104:107]
  ds_read_b128 a[176:179], v230 offset:6144
  v_cvt_pk_bf16_f32 v102, v196, v197
  v_mfma_f32_16x16x32_bf16 a[104:107], a[148:151], v[124:127], a[104:107]
  s_waitcnt lgkmcnt(5)
  v_exp_f32 v198, v14
  v_mfma_f32_16x16x32_bf16 a[76:79], a[152:155], v[112:115], a[76:79]
  buffer_load_dwordx4 v225, s[28:31], s60 offen offset:1024 sc1 lds
  v_mfma_f32_16x16x32_bf16 a[76:79], a[156:159], v[120:123], a[76:79]
  v_exp_f32 v199, v15
  v_mfma_f32_16x16x32_bf16 a[108:111], a[152:155], v[116:119], a[108:111]
  ds_read_b128 a[180:183], v230 offset:14336
  v_cvt_pk_bf16_f32 v103, v198, v199
  v_mfma_f32_16x16x32_bf16 a[108:111], a[156:159], v[124:127], a[108:111]
  s_waitcnt lgkmcnt(4)
  v_exp_f32 v192, v16
  v_mfma_f32_16x16x32_bf16 a[80:83], a[160:163], v[112:115], a[80:83]
  ds_read_b128 a[184:187], v230 offset:7168
  ds_read_b128 a[188:191], v230 offset:15360
  v_mfma_f32_16x16x32_bf16 a[80:83], a[164:167], v[120:123], a[80:83]
  v_exp_f32 v193, v17
  v_mfma_f32_16x16x32_bf16 a[112:115], a[160:163], v[116:119], a[112:115]
  ds_read_b128 a[128:131], v229 offset:0
  v_cvt_pk_bf16_f32 v104, v192, v193
  v_mfma_f32_16x16x32_bf16 a[112:115], a[164:167], v[124:127], a[112:115]
  s_waitcnt lgkmcnt(5)
  v_exp_f32 v194, v18
  v_mfma_f32_16x16x32_bf16 a[84:87], a[168:171], v[112:115], a[84:87]
  buffer_load_dwordx4 v225, s[28:31], s60 offen offset:2048 sc1 lds
  v_mfma_f32_16x16x32_bf16 a[84:87], a[172:175], v[120:123], a[84:87]
  v_exp_f32 v195, v19
  v_mfma_f32_16x16x32_bf16 a[116:119], a[168:171], v[116:119], a[116:119]
  ds_read_b128 a[132:135], v229 offset:1024
  v_cvt_pk_bf16_f32 v105, v194, v195
  v_mfma_f32_16x16x32_bf16 a[116:119], a[172:175], v[124:127], a[116:119]
  s_waitcnt lgkmcnt(4)
  v_exp_f32 v196, v24
  v_mfma_f32_16x16x32_bf16 a[88:91], a[176:179], v[112:115], a[88:91]
  ds_read_b128 a[136:139], v229 offset:2048
  ds_read_b128 a[140:143], v229 offset:3072
  v_mfma_f32_16x16x32_bf16 a[88:91], a[180:183], v[120:123], a[88:91]
  v_exp_f32 v197, v25
  v_mfma_f32_16x16x32_bf16 a[120:123], a[176:179], v[116:119], a[120:123]
  ds_read_b128 a[144:147], v229 offset:4096
  v_cvt_pk_bf16_f32 v108, v196, v197
  v_mfma_f32_16x16x32_bf16 a[120:123], a[180:183], v[124:127], a[120:123]
  s_waitcnt lgkmcnt(5)
  v_exp_f32 v198, v26
  v_mfma_f32_16x16x32_bf16 a[92:95], a[184:187], v[112:115], a[92:95]
  buffer_load_dwordx4 v225, s[28:31], s60 offen offset:3072 sc1 lds
  v_mfma_f32_16x16x32_bf16 a[92:95], a[188:191], v[120:123], a[92:95]
  s_waitcnt lgkmcnt(4)
  v_exp_f32 v199, v27
  v_mfma_f32_16x16x32_bf16 a[124:127], a[184:187], v[116:119], a[124:127]
  s_add_u32 s60, s60, 16384
  s_cmp_ge_u32 s61, s63
  ds_read_b128 a[148:151], v229 offset:5120
  v_cvt_pk_bf16_f32 v109, v198, v199
  v_mfma_f32_16x16x32_bf16 a[124:127], a[188:191], v[124:127], a[124:127]
  v_add_u32 v230, 0x10000, v228
  v_add_f32 v223, v223, v212
  s_cbranch_scc0 L_adaL_single_22
L_adaL_ev_41:
  s_sub_u32 s63, s50, 1
  s_cmp_lt_u32 s61, s63
  s_cbranch_scc1 L_adaL_mk_48
  s_sub_u32 s46, s50, s61
  s_lshl_b32 s46, s46, 5
  v_add_u32 v240, s46, v231
  v_cvt_f32_i32 v240, v240
  v_add_f32 v240, 0.5, v240
  v_mul_f32 v240, 0x71800000, v240
  v_min_f32 v64, v64, v240
  v_min_f32 v76, v76, v240
  v_subrev_f32 v242, 0x71800000, v240
  v_min_f32 v65, v65, v242
  v_min_f32 v77, v77, v242
  v_subrev_f32 v243, 0x72000000, v240
  v_min_f32 v66, v66, v243
  v_min_f32 v78, v78, v243
  v_subrev_f32 v244, 0x72400000, v240
  v_min_f32 v67, v67, v244
  v_min_f32 v79, v79, v244
  v_subrev_f32 v241, 0x73800000, v240
  v_min_f32 v68, v68, v241
  v_subrev_f32 v242, 0x73880000, v240
  v_min_f32 v69, v69, v242
  v_subrev_f32 v243, 0x73900000, v240
  v_min_f32 v70, v70, v243
  v_subrev_f32 v244, 0x73980000, v240
  v_min_f32 v71, v71, v244
  v_subrev_f32 v241, 0xf3800000, v240
  v_min_f32 v72, v72, v241
  v_subrev_f32 v242, 0xf3700000, v240
  v_min_f32 v73, v73, v242
  v_subrev_f32 v243, 0xf3600000, v240
  v_min_f32 v74, v74, v243
  v_subrev_f32 v244, 0xf3500000, v240
  v_min_f32 v75, v75, v244
  s_sub_u32 s46, s46, 32
  v_add_u32 v240, s46, v231
  v_cvt_f32_i32 v240, v240
  v_add_f32 v240, 0.5, v240
  v_mul_f32 v240, 0x71800000, v240
  v_min_f32 v80, v80, v240
  v_min_f32 v92, v92, v240
  v_subrev_f32 v242, 0x71800000, v240
  v_min_f32 v81, v81, v242
  v_min_f32 v93, v93, v242
  v_subrev_f32 v243, 0x72000000, v240
  v_min_f32 v82, v82, v243
  v_min_f32 v94, v94, v243
  v_subrev_f32 v244, 0x72400000, v240
  v_min_f32 v83, v83, v244
  v_min_f32 v95, v95, v244
  v_subrev_f32 v241, 0x73800000, v240
  v_min_f32 v84, v84, v241
  v_subrev_f32 v242, 0x73880000, v240
  v_min_f32 v85, v85, v242
  v_subrev_f32 v243, 0x73900000, v240
  v_min_f32 v86, v86, v243
  v_subrev_f32 v244, 0x73980000, v240
  v_min_f32 v87, v87, v244
  v_subrev_f32 v241, 0xf3800000, v240
  v_min_f32 v88, v88, v241
  v_subrev_f32 v242, 0xf3700000, v240
  v_min_f32 v89, v89, v242
  v_subrev_f32 v243, 0xf3600000, v240
  v_min_f32 v90, v90, v243
  v_subrev_f32 v244, 0xf3500000, v240
  v_min_f32 v91, v91, v244
L_adaL_mk_48:
  s_cmp_lt_u32 s61, s58
  s_cbranch_scc1 L_adaL_mk_49
  s_call_b64 s[42:43], L_adaL_ptr_19
L_adaL_mk_49:
  s_min_u32 s63, s63, s58
  s_min_u32 s63, s63, s62
  s_branch L_adaL_single_22
L_adaL_ev_42:
  s_cmp_eq_u32 s61, s62
  s_cbranch_scc1 L_adaL_final_23
  s_sub_u32 s63, s50, 1
  s_cmp_lt_u32 s61, s63
  s_cbranch_scc1 L_adaL_mk_50
  s_sub_u32 s46, s50, s61
  s_lshl_b32 s46, s46, 5
  v_add_u32 v240, s46, v231
  v_cvt_f32_i32 v240, v240
  v_add_f32 v240, 0.5, v240
  v_mul_f32 v240, 0x71800000, v240
  v_min_f32 v64, v64, v240
  v_min_f32 v76, v76, v240
  v_subrev_f32 v242, 0x71800000, v240
  v_min_f32 v65, v65, v242
  v_min_f32 v77, v77, v242
  v_subrev_f32 v243, 0x72000000, v240
  v_min_f32 v66, v66, v243
  v_min_f32 v78, v78, v243
  v_subrev_f32 v244, 0x72400000, v240
  v_min_f32 v67, v67, v244
  v_min_f32 v79, v79, v244
  v_subrev_f32 v241, 0x73800000, v240
  v_min_f32 v68, v68, v241
  v_subrev_f32 v242, 0x73880000, v240
  v_min_f32 v69, v69, v242
  v_subrev_f32 v243, 0x73900000, v240
  v_min_f32 v70, v70, v243
  v_subrev_f32 v244, 0x73980000, v240
  v_min_f32 v71, v71, v244
  v_subrev_f32 v241, 0xf3800000, v240
  v_min_f32 v72, v72, v241
  v_subrev_f32 v242, 0xf3700000, v240
  v_min_f32 v73, v73, v242
  v_subrev_f32 v243, 0xf3600000, v240
  v_min_f32 v74, v74, v243
  v_subrev_f32 v244, 0xf3500000, v240
  v_min_f32 v75, v75, v244
  s_sub_u32 s46, s46, 32
  v_add_u32 v240, s46, v231
  v_cvt_f32_i32 v240, v240
  v_add_f32 v240, 0.5, v240
  v_mul_f32 v240, 0x71800000, v240
  v_min_f32 v80, v80, v240
  v_min_f32 v92, v92, v240
  v_subrev_f32 v242, 0x71800000, v240
  v_min_f32 v81, v81, v242
  v_min_f32 v93, v93, v242
  v_subrev_f32 v243, 0x72000000, v240
  v_min_f32 v82, v82, v243
  v_min_f32 v94, v94, v243
  v_subrev_f32 v244, 0x72400000, v240
  v_min_f32 v83, v83, v244
  v_min_f32 v95, v95, v244
  v_subrev_f32 v241, 0x73800000, v240
  v_min_f32 v84, v84, v241
  v_subrev_f32 v242, 0x73880000, v240
  v_min_f32 v85, v85, v242
  v_subrev_f32 v243, 0x73900000, v240
  v_min_f32 v86, v86, v243
  v_subrev_f32 v244, 0x73980000, v240
  v_min_f32 v87, v87, v244
  v_subrev_f32 v241, 0xf3800000, v240
  v_min_f32 v88, v88, v241
  v_subrev_f32 v242, 0xf3700000, v240
  v_min_f32 v89, v89, v242
  v_subrev_f32 v243, 0xf3600000, v240
  v_min_f32 v90, v90, v243
  v_subrev_f32 v244, 0xf3500000, v240
  v_min_f32 v91, v91, v244
L_adaL_mk_50:
  s_cmp_lt_u32 s61, s58
  s_cbranch_scc1 L_adaL_mk_51
  s_call_b64 s[42:43], L_adaL_ptr_19
L_adaL_mk_51:
  s_min_u32 s63, s63, s58
  s_min_u32 s63, s63, s62
  s_branch L_adaL_evb_43
L_adaL_final_23:
  s_waitcnt vmcnt(8)
  v_cmp_gt_u32 vcc, 0x100, v239
  s_cbranch_vccz L_adaL_ptok_52
  s_mov_b32 s44, 400000
  v_mov_b32 v241, 0
L_adaL_ptagain_53:
  global_load_dword v239, v241, s[64:65] offset:64 sc1
  s_sub_u32 s44, s44, 1
  s_cbranch_scc1 L_adaL_ptok_52
  s_waitcnt vmcnt(0)
  v_cmp_gt_u32 vcc, 0x100, v239
  s_cbranch_vccnz L_adaL_ptagain_53
L_adaL_ptok_52:
  v_mfma_f32_16x16x32_bf16 v[0:3], a[128:131], v[160:163], v[64:67]
  s_waitcnt lgkmcnt(2)
  ds_read_b128 a[152:155], v228 offset:6144
  v_add_u32 v229, 16384, v228
  v_mfma_f32_16x16x32_bf16 v[0:3], a[132:135], v[164:167], v[0:3]
  s_pack_ll_b32_b16 m0, s59, 0
  v_exp_f32 v192, v52
  v_mfma_f32_16x16x32_bf16 v[0:3], a[136:139], v[168:171], v[0:3]
  ds_read_b128 a[156:159], v228 offset:7168
  buffer_load_dwordx4 v225, s[24:27], s59 offen offset:0 sc1 lds
  v_mfma_f32_16x16x32_bf16 v[0:3], a[140:143], v[172:175], v[0:3]
  v_exp_f32 v193, v53
  v_mfma_f32_16x16x32_bf16 v[8:11], a[128:131], v[176:179], v[72:75]
  ds_read_b128 a[160:163], v228 offset:8192
  v_cvt_pk_bf16_f32 v122, v192, v193
  v_mfma_f32_16x16x32_bf16 v[8:11], a[132:135], v[180:183], v[8:11]
  v_exp_f32 v194, v54
  v_mfma_f32_16x16x32_bf16 v[8:11], a[136:139], v[184:187], v[8:11]
  ds_read_b128 a[164:167], v228 offset:9216
  s_mov_b32 s54, 0
  buffer_load_dwordx4 a[192:195], v225, s[96:99], s54 offen offset:0 sc1
  v_mfma_f32_16x16x32_bf16 v[8:11], a[140:143], v[188:191], v[8:11]
  s_waitcnt lgkmcnt(3)
  v_exp_f32 v195, v55
  v_mfma_f32_16x16x32_bf16 v[4:7], a[144:147], v[160:163], v[68:71]
  ds_read_b128 a[168:171], v228 offset:10240
  v_cvt_pk_bf16_f32 v123, v194, v195
  v_mfma_f32_16x16x32_bf16 v[4:7], a[148:151], v[164:167], v[4:7]
  v_exp_f32 v196, v60
  v_mfma_f32_16x16x32_bf16 v[4:7], a[152:155], v[168:171], v[4:7]
  s_waitcnt lgkmcnt(3)
  ds_read_b128 a[172:175], v228 offset:11264
  buffer_load_dwordx4 v225, s[24:27], s59 offen offset:1024 sc1 lds
  v_mfma_f32_16x16x32_bf16 v[4:7], a[156:159], v[172:175], v[4:7]
  v_exp_f32 v197, v61
  v_mfma_f32_16x16x32_bf16 v[12:15], a[144:147], v[176:179], v[76:79]
  ds_read_b128 a[176:179], v228 offset:12288
  v_cvt_pk_bf16_f32 v126, v196, v197
  v_mfma_f32_16x16x32_bf16 v[12:15], a[148:151], v[180:183], v[12:15]
  v_exp_f32 v198, v62
  v_mfma_f32_16x16x32_bf16 v[12:15], a[152:155], v[184:187], v[12:15]
  ds_read_b128 a[180:183], v228 offset:13312
  buffer_load_dwordx4 a[196:199], v225, s[96:99], s54 offen offset:1024 sc1
  v_mfma_f32_16x16x32_bf16 v[12:15], a[156:159], v[188:191], v[12:15]
  s_waitcnt lgkmcnt(4)
  v_exp_f32 v199, v63
  v_mfma_f32_16x16x32_bf16 v[16:19], a[160:163], v[160:163], v[80:83]
  ds_read_b128 a[184:187], v228 offset:14336
  v_cvt_pk_bf16_f32 v127, v198, v199
  v_mfma_f32_16x16x32_bf16 v[16:19], a[164:167], v[164:167], v[16:19]
  v_exp_f32 v192, v0
  v_mfma_f32_16x16x32_bf16 v[208:211], v[216:219], v[112:115], 0
  ds_read_b128 a[188:191], v228 offset:15360
  buffer_load_dwordx4 v225, s[24:27], s59 offen offset:2048 sc1 lds
  v_mfma_f32_16x16x32_bf16 v[212:215], v[216:219], v[116:119], 0
  v_exp_f32 v193, v1
  v_mfma_f32_16x16x32_bf16 v[208:211], v[216:219], v[120:123], v[208:211]
  ds_read_b128 a[128:131], v230 offset:0
  v_cvt_pk_bf16_f32 v96, v192, v193
  v_mfma_f32_16x16x32_bf16 v[212:215], v[216:219], v[124:127], v[212:215]
  s_waitcnt lgkmcnt(5)
  v_exp_f32 v194, v2
  v_mfma_f32_16x16x32_bf16 v[16:19], a[168:171], v[168:171], v[16:19]
  ds_read_b128 a[132:135], v230 offset:8192
  buffer_load_dwordx4 a[200:203], v225, s[96:99], s54 offen offset:2048 sc1
  v_mfma_f32_16x16x32_bf16 v[16:19], a[172:175], v[172:175], v[16:19]
  v_exp_f32 v195, v3
  v_mfma_f32_16x16x32_bf16 v[24:27], a[160:163], v[176:179], v[88:91]
  ds_read_b128 a[136:139], v230 offset:1024
  v_cvt_pk_bf16_f32 v97, v194, v195
  v_mfma_f32_16x16x32_bf16 v[24:27], a[164:167], v[180:183], v[24:27]
  v_exp_f32 v196, v8
  v_mfma_f32_16x16x32_bf16 v[24:27], a[168:171], v[184:187], v[24:27]
  ds_read_b128 a[140:143], v230 offset:9216
  buffer_load_dwordx4 v225, s[24:27], s59 offen offset:3072 sc1 lds
  v_mfma_f32_16x16x32_bf16 v[24:27], a[172:175], v[188:191], v[24:27]
  s_waitcnt lgkmcnt(4)
  v_exp_f32 v197, v9
  v_mfma_f32_16x16x32_bf16 v[20:23], a[176:179], v[160:163], v[84:87]
  s_add_u32 s59, s59, 16384
  ds_read_b128 a[144:147], v230 offset:2048
  v_cvt_pk_bf16_f32 v100, v196, v197
  v_mfma_f32_16x16x32_bf16 v[20:23], a[180:183], v[164:167], v[20:23]
  s_pack_ll_b32_b16 m0, s60, 1
  v_exp_f32 v198, v10
  v_mfma_f32_16x16x32_bf16 v[20:23], a[184:187], v[168:171], v[20:23]
  ds_read_b128 a[148:151], v230 offset:10240
  v_max_f32 v240, v208, v212
  v_mfma_f32_16x16x32_bf16 v[20:23], a[188:191], v[172:175], v[20:23]
  v_exp_f32 v199, v11
  v_mfma_f32_16x16x32_bf16 v[28:31], a[176:179], v[176:179], v[92:95]
  ds_read_b128 a[152:155], v230 offset:3072
  v_cvt_pk_bf16_f32 v101, v198, v199
  v_mfma_f32_16x16x32_bf16 v[28:31], a[180:183], v[180:183], v[28:31]
  v_exp_f32 v192, v4
  v_mfma_f32_16x16x32_bf16 v[28:31], a[184:187], v[184:187], v[28:31]
  s_waitcnt lgkmcnt(5)
  ds_read_b128 a[156:159], v230 offset:11264
  v_cmp_nge_f32 vcc, s40, v240
  v_mfma_f32_16x16x32_bf16 v[28:31], a[188:191], v[188:191], v[28:31]
  s_cbranch_vccnz L_adaL_fb_54
L_adaL_back_55:
  v_exp_f32 v193, v5
  v_mfma_f32_16x16x32_bf16 a[64:67], a[128:131], v[112:115], a[64:67]
  s_waitcnt vmcnt(15)
  s_barrier
  v_mfma_f32_16x16x32_bf16 a[64:67], a[132:135], v[120:123], a[64:67]
  v_cvt_pk_bf16_f32 v98, v192, v193
  v_and_b32 v229, 0xffff, v229
  v_add_f32 v222, v222, v208
  v_mfma_f32_16x16x32_bf16 a[96:99], a[128:131], v[116:119], a[96:99]
  buffer_load_dwordx4 a[204:207], v225, s[96:99], s54 offen offset:3072 sc1
  v_mfma_f32_16x16x32_bf16 a[96:99], a[132:135], v[124:127], a[96:99]
  s_waitcnt lgkmcnt(4)
  v_exp_f32 v194, v6
  v_mfma_f32_16x16x32_bf16 a[68:71], a[136:139], v[112:115], a[68:71]
  ds_read_b128 a[160:163], v230 offset:4096
  buffer_load_dwordx4 v225, s[28:31], s60 offen offset:0 sc1 lds
  v_mfma_f32_16x16x32_bf16 a[68:71], a[140:143], v[120:123], a[68:71]
  v_exp_f32 v195, v7
  v_mfma_f32_16x16x32_bf16 a[100:103], a[136:139], v[116:119], a[100:103]
  ds_read_b128 a[164:167], v230 offset:12288
  v_cvt_pk_bf16_f32 v99, v194, v195
  v_add_f32 v223, v223, v212
  v_mfma_f32_16x16x32_bf16 a[100:103], a[140:143], v[124:127], a[100:103]
  s_waitcnt lgkmcnt(4)
  v_exp_f32 v196, v12
  v_mfma_f32_16x16x32_bf16 a[72:75], a[144:147], v[112:115], a[72:75]
  ds_read_b128 a[168:171], v230 offset:5120
  buffer_load_dwordx4 a[208:211], v226, s[96:99], s54 offen offset:0 sc1
  v_mfma_f32_16x16x32_bf16 a[72:75], a[148:151], v[120:123], a[72:75]
  v_exp_f32 v197, v13
  v_mfma_f32_16x16x32_bf16 a[104:107], a[144:147], v[116:119], a[104:107]
  ds_read_b128 a[172:175], v230 offset:13312
  v_cvt_pk_bf16_f32 v102, v196, v197
  v_mfma_f32_16x16x32_bf16 a[104:107], a[148:151], v[124:127], a[104:107]
  s_waitcnt lgkmcnt(4)
  v_exp_f32 v198, v14
  v_mfma_f32_16x16x32_bf16 a[76:79], a[152:155], v[112:115], a[76:79]
  ds_read_b128 a[176:179], v230 offset:6144
  buffer_load_dwordx4 v225, s[28:31], s60 offen offset:1024 sc1 lds
  v_mfma_f32_16x16x32_bf16 a[76:79], a[156:159], v[120:123], a[76:79]
  v_exp_f32 v199, v15
  v_mfma_f32_16x16x32_bf16 a[108:111], a[152:155], v[116:119], a[108:111]
  ds_read_b128 a[180:183], v230 offset:14336
  v_cvt_pk_bf16_f32 v103, v198, v199
  v_mfma_f32_16x16x32_bf16 a[108:111], a[156:159], v[124:127], a[108:111]
  s_waitcnt lgkmcnt(4)
  v_exp_f32 v192, v16
  v_mfma_f32_16x16x32_bf16 a[80:83], a[160:163], v[112:115], a[80:83]
  ds_read_b128 a[184:187], v230 offset:7168
  s_mov_b32 s54, 5120
  buffer_load_dwordx4 a[212:215], v225, s[96:99], s54 offen offset:0 sc1
  v_mfma_f32_16x16x32_bf16 a[80:83], a[164:167], v[120:123], a[80:83]
  v_exp_f32 v193, v17
  v_mfma_f32_16x16x32_bf16 a[112:115], a[160:163], v[116:119], a[112:115]
  ds_read_b128 a[188:191], v230 offset:15360
  v_cvt_pk_bf16_f32 v104, v192, v193
  v_add_u32 v230, 0x10000, v228
  v_mfma_f32_16x16x32_bf16 a[112:115], a[164:167], v[124:127], a[112:115]
  s_waitcnt lgkmcnt(4)
  v_exp_f32 v194, v18
  v_mfma_f32_16x16x32_bf16 a[84:87], a[168:171], v[112:115], a[84:87]
  ds_read_b128 a[128:131], v229 offset:0
  buffer_load_dwordx4 v225, s[28:31], s60 offen offset:2048 sc1 lds
  v_mfma_f32_16x16x32_bf16 a[84:87], a[172:175], v[120:123], a[84:87]
  v_exp_f32 v195, v19
  v_mfma_f32_16x16x32_bf16 a[116:119], a[168:171], v[116:119], a[116:119]
  ds_read_b128 a[132:135], v229 offset:1024
  v_cvt_pk_bf16_f32 v105, v194, v195
  v_mfma_f32_16x16x32_bf16 a[116:119], a[172:175], v[124:127], a[116:119]
  s_waitcnt lgkmcnt(4)
  v_exp_f32 v196, v24
  v_mfma_f32_16x16x32_bf16 a[88:91], a[176:179], v[112:115], a[88:91]
  ds_read_b128 a[136:139], v229 offset:2048
  buffer_load_dwordx4 a[216:219], v225, s[96:99], s54 offen offset:1024 sc1
  v_mfma_f32_16x16x32_bf16 a[88:91], a[180:183], v[120:123], a[88:91]
  v_exp_f32 v197, v25
  v_mfma_f32_16x16x32_bf16 a[120:123], a[176:179], v[116:119], a[120:123]
  ds_read_b128 a[140:143], v229 offset:3072
  v_cvt_pk_bf16_f32 v108, v196, v197
  v_mfma_f32_16x16x32_bf16 a[120:123], a[180:183], v[124:127], a[120:123]
  s_waitcnt lgkmcnt(4)
  v_exp_f32 v198, v26
  v_mfma_f32_16x16x32_bf16 a[92:95], a[184:187], v[112:115], a[92:95]
  ds_read_b128 a[144:147], v229 offset:4096
  buffer_load_dwordx4 v225, s[28:31], s60 offen offset:3072 sc1 lds
  v_mfma_f32_16x16x32_bf16 a[92:95], a[188:191], v[120:123], a[92:95]
  s_waitcnt lgkmcnt(4)
  v_exp_f32 v199, v27
  v_mfma_f32_16x16x32_bf16 a[124:127], a[184:187], v[116:119], a[124:127]
  s_add_u32 s60, s60, 16384
  s_add_u32 s61, s61, 2
  ds_read_b128 a[148:151], v229 offset:5120
  v_cvt_pk_bf16_f32 v109, v198, v199
  v_mfma_f32_16x16x32_bf16 a[124:127], a[188:191], v[124:127], a[124:127]
  buffer_load_dwordx4 a[220:223], v225, s[96:99], s54 offen offset:2048 sc1
  v_mfma_f32_16x16x32_bf16 v[32:35], a[128:131], v[160:163], v[64:67]
  s_waitcnt lgkmcnt(2)
  ds_read_b128 a[152:155], v229 offset:6144
  v_add_u32 v228, 16384, v229
  v_mfma_f32_16x16x32_bf16 v[32:35], a[132:135], v[164:167], v[32:35]
  v_exp_f32 v192, v20
  v_mfma_f32_16x16x32_bf16 v[32:35], a[136:139], v[168:171], v[32:35]
  ds_read_b128 a[156:159], v229 offset:7168
  buffer_load_dwordx4 a[224:227], v225, s[96:99], s54 offen offset:3072 sc1
  v_mfma_f32_16x16x32_bf16 v[32:35], a[140:143], v[172:175], v[32:35]
  v_exp_f32 v193, v21
  v_mfma_f32_16x16x32_bf16 v[40:43], a[128:131], v[176:179], v[72:75]
  ds_read_b128 a[160:163], v229 offset:8192
  v_cvt_pk_bf16_f32 v106, v192, v193
  v_mfma_f32_16x16x32_bf16 v[40:43], a[132:135], v[180:183], v[40:43]
  v_exp_f32 v194, v22
  v_mfma_f32_16x16x32_bf16 v[40:43], a[136:139], v[184:187], v[40:43]
  ds_read_b128 a[164:167], v229 offset:9216
  buffer_load_dwordx4 a[228:231], v226, s[96:99], s54 offen offset:0 sc1
  v_mfma_f32_16x16x32_bf16 v[40:43], a[140:143], v[188:191], v[40:43]
  s_waitcnt lgkmcnt(3)
  v_exp_f32 v195, v23
  v_mfma_f32_16x16x32_bf16 v[36:39], a[144:147], v[160:163], v[68:71]
  ds_read_b128 a[168:171], v229 offset:10240
  v_cvt_pk_bf16_f32 v107, v194, v195
  v_mfma_f32_16x16x32_bf16 v[36:39], a[148:151], v[164:167], v[36:39]
  v_exp_f32 v196, v28
  v_mfma_f32_16x16x32_bf16 v[36:39], a[152:155], v[168:171], v[36:39]
  s_waitcnt lgkmcnt(3)
  ds_read_b128 a[172:175], v229 offset:11264
  s_mov_b32 s54, 10240
  buffer_load_dwordx4 a[232:235], v225, s[96:99], s54 offen offset:0 sc1
  v_mfma_f32_16x16x32_bf16 v[36:39], a[156:159], v[172:175], v[36:39]
  v_exp_f32 v197, v29
  v_mfma_f32_16x16x32_bf16 v[44:47], a[144:147], v[176:179], v[76:79]
  ds_read_b128 a[176:179], v229 offset:12288
  v_cvt_pk_bf16_f32 v110, v196, v197
  v_mfma_f32_16x16x32_bf16 v[44:47], a[148:151], v[180:183], v[44:47]
  v_exp_f32 v198, v30
  v_mfma_f32_16x16x32_bf16 v[44:47], a[152:155], v[184:187], v[44:47]
  buffer_load_dwordx4 a[236:239], v225, s[96:99], s54 offen offset:1024 sc1
  v_mfma_f32_16x16x32_bf16 v[44:47], a[156:159], v[188:191], v[44:47]
  s_waitcnt lgkmcnt(3)
  v_exp_f32 v199, v31
  v_mfma_f32_16x16x32_bf16 v[48:51], a[160:163], v[160:163], v[80:83]
  ds_read_b128 a[180:183], v229 offset:13312
  v_cvt_pk_bf16_f32 v111, v198, v199
  v_mfma_f32_16x16x32_bf16 v[48:51], a[164:167], v[164:167], v[48:51]
  v_exp_f32 v192, v32
  v_mfma_f32_16x16x32_bf16 v[208:211], v[216:219], v[96:99], 0
  ds_read_b128 a[184:187], v229 offset:14336
  buffer_load_dwordx4 a[240:243], v225, s[96:99], s54 offen offset:2048 sc1
  v_mfma_f32_16x16x32_bf16 v[212:215], v[216:219], v[100:103], 0
  v_exp_f32 v193, v33
  v_mfma_f32_16x16x32_bf16 v[208:211], v[216:219], v[104:107], v[208:211]
  ds_read_b128 a[188:191], v229 offset:15360
  v_cvt_pk_bf16_f32 v112, v192, v193
  v_mfma_f32_16x16x32_bf16 v[212:215], v[216:219], v[108:111], v[212:215]
  s_waitcnt lgkmcnt(4)
  v_exp_f32 v194, v34
  v_mfma_f32_16x16x32_bf16 v[48:51], a[168:171], v[168:171], v[48:51]
  ds_read_b128 a[128:131], v230 offset:0
  buffer_load_dwordx4 a[244:247], v225, s[96:99], s54 offen offset:3072 sc1
  v_mfma_f32_16x16x32_bf16 v[48:51], a[172:175], v[172:175], v[48:51]
  v_exp_f32 v195, v35
  v_mfma_f32_16x16x32_bf16 v[56:59], a[160:163], v[176:179], v[88:91]
  ds_read_b128 a[132:135], v230 offset:8192
  v_cvt_pk_bf16_f32 v113, v194, v195
  v_mfma_f32_16x16x32_bf16 v[56:59], a[164:167], v[180:183], v[56:59]
  v_exp_f32 v196, v40
  v_mfma_f32_16x16x32_bf16 v[56:59], a[168:171], v[184:187], v[56:59]
  ds_read_b128 a[136:139], v230 offset:1024
  buffer_load_dwordx4 a[248:251], v226, s[96:99], s54 offen offset:0 sc1
  v_mfma_f32_16x16x32_bf16 v[56:59], a[172:175], v[188:191], v[56:59]
  s_waitcnt lgkmcnt(3)
  v_exp_f32 v197, v41
  v_mfma_f32_16x16x32_bf16 v[52:55], a[176:179], v[160:163], v[84:87]
  s_pack_ll_b32_b16 m0, s60, 1
  ds_read_b128 a[140:143], v230 offset:9216
  v_cvt_pk_bf16_f32 v116, v196, v197
  v_mfma_f32_16x16x32_bf16 v[52:55], a[180:183], v[164:167], v[52:55]
  v_exp_f32 v198, v42
  v_mfma_f32_16x16x32_bf16 v[52:55], a[184:187], v[168:171], v[52:55]
  ds_read_b128 a[144:147], v230 offset:2048
  v_max_f32 v240, v208, v212
  v_mfma_f32_16x16x32_bf16 v[52:55], a[188:191], v[172:175], v[52:55]
  v_exp_f32 v199, v43
  v_mfma_f32_16x16x32_bf16 v[60:63], a[176:179], v[176:179], v[92:95]
  ds_read_b128 a[148:151], v230 offset:10240
  v_cvt_pk_bf16_f32 v117, v198, v199
  v_mfma_f32_16x16x32_bf16 v[60:63], a[180:183], v[180:183], v[60:63]
  v_exp_f32 v192, v36
  v_mfma_f32_16x16x32_bf16 v[60:63], a[184:187], v[184:187], v[60:63]
  s_waitcnt lgkmcnt(4)
  ds_read_b128 a[152:155], v230 offset:3072
  v_cmp_nge_f32 vcc, s40, v240
  v_mfma_f32_16x16x32_bf16 v[60:63], a[188:191], v[188:191], v[60:63]
  s_cbranch_vccnz L_adaL_fb_56
L_adaL_back_57:
  v_exp_f32 v193, v37
  v_mfma_f32_16x16x32_bf16 a[64:67], a[128:131], v[96:99], a[64:67]
  s_waitcnt vmcnt(23)
  s_barrier
  v_mfma_f32_16x16x32_bf16 a[64:67], a[132:135], v[104:107], a[64:67]
  v_cvt_pk_bf16_f32 v114, v192, v193
  v_and_b32 v228, 0xffff, v228
  v_add_f32 v223, v223, v212
  v_mfma_f32_16x16x32_bf16 a[96:99], a[128:131], v[100:103], a[96:99]
  ds_read_b128 a[156:159], v230 offset:11264
  ds_read_b128 a[160:163], v230 offset:4096
  v_mfma_f32_16x16x32_bf16 a[96:99], a[132:135], v[108:111], a[96:99]
  s_waitcnt lgkmcnt(5)
  v_exp_f32 v194, v38
  v_mfma_f32_16x16x32_bf16 a[68:71], a[136:139], v[96:99], a[68:71]
  ds_read_b128 a[164:167], v230 offset:12288
  buffer_load_dwordx4 v225, s[28:31], s60 offen offset:0 sc1 lds
  v_mfma_f32_16x16x32_bf16 a[68:71], a[140:143], v[104:107], a[68:71]
  v_exp_f32 v195, v39
  v_mfma_f32_16x16x32_bf16 a[100:103], a[136:139], v[100:103], a[100:103]
  ds_read_b128 a[168:171], v230 offset:5120
  v_cvt_pk_bf16_f32 v115, v194, v195
  v_mfma_f32_16x16x32_bf16 a[100:103], a[140:143], v[108:111], a[100:103]
  s_waitcnt lgkmcnt(5)
  v_exp_f32 v196, v44
  v_mfma_f32_16x16x32_bf16 a[72:75], a[144:147], v[96:99], a[72:75]
  ds_read_b128 a[172:175], v230 offset:13312
  s_mov_b32 s54, 15360
  buffer_load_dwordx4 a[252:255], v225, s[96:99], s54 offen offset:0 sc1
  v_mfma_f32_16x16x32_bf16 a[72:75], a[148:151], v[104:107], a[72:75]
  v_exp_f32 v197, v45
  v_mfma_f32_16x16x32_bf16 a[104:107], a[144:147], v[100:103], a[104:107]
  ds_read_b128 a[176:179], v230 offset:6144
  v_cvt_pk_bf16_f32 v118, v196, v197
  v_mfma_f32_16x16x32_bf16 a[104:107], a[148:151], v[108:111], a[104:107]
  s_waitcnt lgkmcnt(5)
  v_exp_f32 v198, v46
  v_mfma_f32_16x16x32_bf16 a[76:79], a[152:155], v[96:99], a[76:79]
  ds_read_b128 a[180:183], v230 offset:14336
  buffer_load_dwordx4 v225, s[28:31], s60 offen offset:1024 sc1 lds
  v_mfma_f32_16x16x32_bf16 a[76:79], a[156:159], v[104:107], a[76:79]
  v_exp_f32 v199, v47
  v_mfma_f32_16x16x32_bf16 a[108:111], a[152:155], v[100:103], a[108:111]
  ds_read_b128 a[184:187], v230 offset:7168
  v_cvt_pk_bf16_f32 v119, v198, v199
  v_mfma_f32_16x16x32_bf16 a[108:111], a[156:159], v[108:111], a[108:111]
  s_waitcnt lgkmcnt(5)
  v_exp_f32 v192, v48
  v_mfma_f32_16x16x32_bf16 a[80:83], a[160:163], v[96:99], a[80:83]
  buffer_load_dwordx4 a[0:3], v225, s[96:99], s54 offen offset:1024 sc1
  v_mfma_f32_16x16x32_bf16 a[80:83], a[164:167], v[104:107], a[80:83]
  v_exp_f32 v193, v49
  v_mfma_f32_16x16x32_bf16 a[112:115], a[160:163], v[100:103], a[112:115]
  ds_read_b128 a[188:191], v230 offset:15360
  v_cvt_pk_bf16_f32 v120, v192, v193
  v_mfma_f32_16x16x32_bf16 a[112:115], a[164:167], v[108:111], a[112:115]
  s_waitcnt lgkmcnt(4)
  v_exp_f32 v194, v50
  v_mfma_f32_16x16x32_bf16 a[84:87], a[168:171], v[96:99], a[84:87]
  ds_read_b128 a[128:131], v228 offset:0
  buffer_load_dwordx4 v225, s[28:31], s60 offen offset:2048 sc1 lds
  v_mfma_f32_16x16x32_bf16 a[84:87], a[172:175], v[104:107], a[84:87]
  v_exp_f32 v195, v51
  v_mfma_f32_16x16x32_bf16 a[116:119], a[168:171], v[100:103], a[116:119]
  ds_read_b128 a[132:135], v228 offset:1024
  v_cvt_pk_bf16_f32 v121, v194, v195
  v_mfma_f32_16x16x32_bf16 a[116:119], a[172:175], v[108:111], a[116:119]
  s_waitcnt lgkmcnt(4)
  v_exp_f32 v196, v56
  v_mfma_f32_16x16x32_bf16 a[88:91], a[176:179], v[96:99], a[88:91]
  ds_read_b128 a[136:139], v228 offset:2048
  buffer_load_dwordx4 a[4:7], v225, s[96:99], s54 offen offset:2048 sc1
  v_mfma_f32_16x16x32_bf16 a[88:91], a[180:183], v[104:107], a[88:91]
  v_exp_f32 v197, v57
  v_mfma_f32_16x16x32_bf16 a[120:123], a[176:179], v[100:103], a[120:123]
  ds_read_b128 a[140:143], v228 offset:3072
  v_cvt_pk_bf16_f32 v124, v196, v197
  v_mfma_f32_16x16x32_bf16 a[120:123], a[180:183], v[108:111], a[120:123]
  s_waitcnt lgkmcnt(4)
  v_exp_f32 v198, v58
  v_mfma_f32_16x16x32_bf16 a[92:95], a[184:187], v[96:99], a[92:95]
  ds_read_b128 a[144:147], v228 offset:4096
  buffer_load_dwordx4 v225, s[28:31], s60 offen offset:3072 sc1 lds
  v_mfma_f32_16x16x32_bf16 a[92:95], a[188:191], v[104:107], a[92:95]
  s_waitcnt lgkmcnt(4)
  v_exp_f32 v199, v59
  v_mfma_f32_16x16x32_bf16 a[124:127], a[184:187], v[100:103], a[124:127]
  s_add_u32 s60, s60, 16384
  s_add_u32 s61, s61, 2
  ds_read_b128 a[148:151], v228 offset:5120
  v_cvt_pk_bf16_f32 v125, v198, v199
  v_mfma_f32_16x16x32_bf16 a[124:127], a[188:191], v[108:111], a[124:127]
  v_add_u32 v230, 0x10000, v229
  v_add_f32 v222, v222, v208
  s_sub_u32 s63, s50, 1
  s_cmp_lt_u32 s61, s63
  s_cbranch_scc1 L_adaL_mk_58
  s_sub_u32 s46, s50, s61
  s_lshl_b32 s46, s46, 5
  v_add_u32 v240, s46, v231
  v_cvt_f32_i32 v240, v240
  v_add_f32 v240, 0.5, v240
  v_mul_f32 v240, 0x71800000, v240
  v_min_f32 v64, v64, v240
  v_min_f32 v76, v76, v240
  v_subrev_f32 v242, 0x71800000, v240
  v_min_f32 v65, v65, v242
  v_min_f32 v77, v77, v242
  v_subrev_f32 v243, 0x72000000, v240
  v_min_f32 v66, v66, v243
  v_min_f32 v78, v78, v243
  v_subrev_f32 v244, 0x72400000, v240
  v_min_f32 v67, v67, v244
  v_min_f32 v79, v79, v244
  v_subrev_f32 v241, 0x73800000, v240
  v_min_f32 v68, v68, v241
  v_subrev_f32 v242, 0x73880000, v240
  v_min_f32 v69, v69, v242
  v_subrev_f32 v243, 0x73900000, v240
  v_min_f32 v70, v70, v243
  v_subrev_f32 v244, 0x73980000, v240
  v_min_f32 v71, v71, v244
  v_subrev_f32 v241, 0xf3800000, v240
  v_min_f32 v72, v72, v241
  v_subrev_f32 v242, 0xf3700000, v240
  v_min_f32 v73, v73, v242
  v_subrev_f32 v243, 0xf3600000, v240
  v_min_f32 v74, v74, v243
  v_subrev_f32 v244, 0xf3500000, v240
  v_min_f32 v75, v75, v244
  s_sub_u32 s46, s46, 32
  v_add_u32 v240, s46, v231
  v_cvt_f32_i32 v240, v240
  v_add_f32 v240, 0.5, v240
  v_mul_f32 v240, 0x71800000, v240
  v_min_f32 v80, v80, v240
  v_min_f32 v92, v92, v240
  v_subrev_f32 v242, 0x71800000, v240
  v_min_f32 v81, v81, v242
  v_min_f32 v93, v93, v242
  v_subrev_f32 v243, 0x72000000, v240
  v_min_f32 v82, v82, v243
  v_min_f32 v94, v94, v243
  v_subrev_f32 v244, 0x72400000, v240
  v_min_f32 v83, v83, v244
  v_min_f32 v95, v95, v244
  v_subrev_f32 v241, 0x73800000, v240
  v_min_f32 v84, v84, v241
  v_subrev_f32 v242, 0x73880000, v240
  v_min_f32 v85, v85, v242
  v_subrev_f32 v243, 0x73900000, v240
  v_min_f32 v86, v86, v243
  v_subrev_f32 v244, 0x73980000, v240
  v_min_f32 v87, v87, v244
  v_subrev_f32 v241, 0xf3800000, v240
  v_min_f32 v88, v88, v241
  v_subrev_f32 v242, 0xf3700000, v240
  v_min_f32 v89, v89, v242
  v_subrev_f32 v243, 0xf3600000, v240
  v_min_f32 v90, v90, v243
  v_subrev_f32 v244, 0xf3500000, v240
  v_min_f32 v91, v91, v244
L_adaL_mk_58:
  s_cmp_lt_u32 s61, s58
  s_cbranch_scc1 L_adaL_mk_59
  s_call_b64 s[42:43], L_adaL_ptr_19
L_adaL_mk_59:
  s_min_u32 s63, s63, s58
  s_min_u32 s63, s63, s62
  v_mfma_f32_16x16x32_bf16 v[0:3], a[128:131], v[160:163], v[64:67]
  s_waitcnt lgkmcnt(2)
  ds_read_b128 a[152:155], v228 offset:6144
  v_add_u32 v229, 16384, v228
  v_mfma_f32_16x16x32_bf16 v[0:3], a[132:135], v[164:167], v[0:3]
  v_exp_f32 v192, v52
  v_mfma_f32_16x16x32_bf16 v[0:3], a[136:139], v[168:171], v[0:3]
  ds_read_b128 a[156:159], v228 offset:7168
  buffer_load_dwordx4 a[32:35], v225, s[96:99], s54 offen offset:3072 sc1
  v_mfma_f32_16x16x32_bf16 v[0:3], a[140:143], v[172:175], v[0:3]
  v_exp_f32 v193, v53
  v_mfma_f32_16x16x32_bf16 v[8:11], a[128:131], v[176:179], v[72:75]
  ds_read_b128 a[160:163], v228 offset:8192
  v_cvt_pk_bf16_f32 v122, v192, v193
  v_mfma_f32_16x16x32_bf16 v[8:11], a[132:135], v[180:183], v[8:11]
  v_exp_f32 v194, v54
  v_mfma_f32_16x16x32_bf16 v[8:11], a[136:139], v[184:187], v[8:11]
  buffer_load_dwordx4 a[36:39], v226, s[96:99], s54 offen offset:0 sc1
  v_mfma_f32_16x16x32_bf16 v[8:11], a[140:143], v[188:191], v[8:11]
  s_waitcnt lgkmcnt(2)
  v_exp_f32 v195, v55
  v_mfma_f32_16x16x32_bf16 v[4:7], a[144:147], v[160:163], v[68:71]
  ds_read_b128 a[164:167], v228 offset:9216
  v_cvt_pk_bf16_f32 v123, v194, v195
  v_mfma_f32_16x16x32_bf16 v[4:7], a[148:151], v[164:167], v[4:7]
  v_exp_f32 v196, v60
  v_mfma_f32_16x16x32_bf16 v[4:7], a[152:155], v[168:171], v[4:7]
  s_waitcnt lgkmcnt(2)
  ds_read_b128 a[168:171], v228 offset:10240
  s_mov_b32 s54, 25600
  buffer_load_dwordx4 a[8:11], v225, s[96:99], s54 offen offset:0 sc1
  v_mfma_f32_16x16x32_bf16 v[4:7], a[156:159], v[172:175], v[4:7]
  v_exp_f32 v197, v61
  v_mfma_f32_16x16x32_bf16 v[12:15], a[144:147], v[176:179], v[76:79]
  ds_read_b128 a[172:175], v228 offset:11264
  v_cvt_pk_bf16_f32 v126, v196, v197
  v_mfma_f32_16x16x32_bf16 v[12:15], a[148:151], v[180:183], v[12:15]
  v_exp_f32 v198, v62
  v_mfma_f32_16x16x32_bf16 v[12:15], a[152:155], v[184:187], v[12:15]
  ds_read_b128 a[176:179], v228 offset:12288
  ds_read_b128 a[180:183], v228 offset:13312
  v_mfma_f32_16x16x32_bf16 v[12:15], a[156:159], v[188:191], v[12:15]
  s_waitcnt lgkmcnt(4)
  v_exp_f32 v199, v63
  v_mfma_f32_16x16x32_bf16 v[16:19], a[160:163], v[160:163], v[80:83]
  ds_read_b128 a[184:187], v228 offset:14336
  v_cvt_pk_bf16_f32 v127, v198, v199
  v_mfma_f32_16x16x32_bf16 v[16:19], a[164:167], v[164:167], v[16:19]
  v_exp_f32 v192, v0
  v_mfma_f32_16x16x32_bf16 v[208:211], v[216:219], v[112:115], 0
  ds_read_b128 a[188:191], v228 offset:15360
  buffer_load_dwordx4 a[12:15], v225, s[96:99], s54 offen offset:1024 sc1
  v_mfma_f32_16x16x32_bf16 v[212:215], v[216:219], v[116:119], 0
  v_exp_f32 v193, v1
  v_mfma_f32_16x16x32_bf16 v[208:211], v[216:219], v[120:123], v[208:211]
  ds_read_b128 a[128:131], v230 offset:0
  v_cvt_pk_bf16_f32 v96, v192, v193
  v_mfma_f32_16x16x32_bf16 v[212:215], v[216:219], v[124:127], v[212:215]
  s_waitcnt lgkmcnt(5)
  v_exp_f32 v194, v2
  v_mfma_f32_16x16x32_bf16 v[16:19], a[168:171], v[168:171], v[16:19]
  buffer_load_dwordx4 a[40:43], v225, s[96:99], s54 offen offset:2048 sc1
  v_mfma_f32_16x16x32_bf16 v[16:19], a[172:175], v[172:175], v[16:19]
  v_exp_f32 v195, v3
  v_mfma_f32_16x16x32_bf16 v[24:27], a[160:163], v[176:179], v[88:91]
  ds_read_b128 a[132:135], v230 offset:8192
  v_cvt_pk_bf16_f32 v97, v194, v195
  v_mfma_f32_16x16x32_bf16 v[24:27], a[164:167], v[180:183], v[24:27]
  v_exp_f32 v196, v8
  v_mfma_f32_16x16x32_bf16 v[24:27], a[168:171], v[184:187], v[24:27]
  ds_read_b128 a[136:139], v230 offset:1024
  buffer_load_dwordx4 a[44:47], v225, s[96:99], s54 offen offset:3072 sc1
  v_mfma_f32_16x16x32_bf16 v[24:27], a[172:175], v[188:191], v[24:27]
  s_waitcnt lgkmcnt(3)
  v_exp_f32 v197, v9
  v_mfma_f32_16x16x32_bf16 v[20:23], a[176:179], v[160:163], v[84:87]
  ds_read_b128 a[140:143], v230 offset:9216
  v_cvt_pk_bf16_f32 v100, v196, v197
  v_mfma_f32_16x16x32_bf16 v[20:23], a[180:183], v[164:167], v[20:23]
  v_exp_f32 v198, v10
  v_mfma_f32_16x16x32_bf16 v[20:23], a[184:187], v[168:171], v[20:23]
  ds_read_b128 a[144:147], v230 offset:2048
  v_max_f32 v240, v208, v212
  v_mfma_f32_16x16x32_bf16 v[20:23], a[188:191], v[172:175], v[20:23]
  v_exp_f32 v199, v11
  v_mfma_f32_16x16x32_bf16 v[28:31], a[176:179], v[176:179], v[92:95]
  ds_read_b128 a[148:151], v230 offset:10240
  v_cvt_pk_bf16_f32 v101, v198, v199
  v_mfma_f32_16x16x32_bf16 v[28:31], a[180:183], v[180:183], v[28:31]
  v_exp_f32 v192, v4
  v_mfma_f32_16x16x32_bf16 v[28:31], a[184:187], v[184:187], v[28:31]
  s_waitcnt lgkmcnt(4)
  ds_read_b128 a[152:155], v230 offset:3072
  v_cmp_nge_f32 vcc, s40, v240
  v_mfma_f32_16x16x32_bf16 v[28:31], a[188:191], v[188:191], v[28:31]
  s_cbranch_vccnz L_adaL_fb_60
L_adaL_back_61:
  v_exp_f32 v193, v5
  v_mfma_f32_16x16x32_bf16 a[64:67], a[128:131], v[112:115], a[64:67]
  s_waitcnt vmcnt(21)
  s_barrier
  v_mfma_f32_16x16x32_bf16 a[64:67], a[132:135], v[120:123], a[64:67]
  v_cvt_pk_bf16_f32 v98, v192, v193
  v_and_b32 v229, 0xffff, v229
  v_add_f32 v223, v223, v212
  v_mfma_f32_16x16x32_bf16 a[96:99], a[128:131], v[116:119], a[96:99]
  ds_read_b128 a[156:159], v230 offset:11264
  ds_read_b128 a[160:163], v230 offset:4096
  v_mfma_f32_16x16x32_bf16 a[96:99], a[132:135], v[124:127], a[96:99]
  s_waitcnt lgkmcnt(5)
  v_exp_f32 v194, v6
  v_mfma_f32_16x16x32_bf16 a[68:71], a[136:139], v[112:115], a[68:71]
  ds_read_b128 a[164:167], v230 offset:12288
  buffer_load_dwordx4 a[16:19], v226, s[96:99], s54 offen offset:0 sc1
  v_mfma_f32_16x16x32_bf16 a[68:71], a[140:143], v[120:123], a[68:71]
  v_exp_f32 v195, v7
  v_mfma_f32_16x16x32_bf16 a[100:103], a[136:139], v[116:119], a[100:103]
  ds_read_b128 a[168:171], v230 offset:5120
  v_cvt_pk_bf16_f32 v99, v194, v195
  v_mfma_f32_16x16x32_bf16 a[100:103], a[140:143], v[124:127], a[100:103]
  s_waitcnt lgkmcnt(5)
  v_exp_f32 v196, v12
  v_mfma_f32_16x16x32_bf16 a[72:75], a[144:147], v[112:115], a[72:75]
  s_mov_b32 s54, 30720
  buffer_load_dwordx4 a[20:23], v225, s[96:99], s54 offen offset:0 sc1
  v_mfma_f32_16x16x32_bf16 a[72:75], a[148:151], v[120:123], a[72:75]
  v_exp_f32 v197, v13
  v_mfma_f32_16x16x32_bf16 a[104:107], a[144:147], v[116:119], a[104:107]
  ds_read_b128 a[172:175], v230 offset:13312
  v_cvt_pk_bf16_f32 v102, v196, v197
  v_mfma_f32_16x16x32_bf16 a[104:107], a[148:151], v[124:127], a[104:107]
  s_waitcnt lgkmcnt(4)
  v_exp_f32 v198, v14
  v_mfma_f32_16x16x32_bf16 a[76:79], a[152:155], v[112:115], a[76:79]
  ds_read_b128 a[176:179], v230 offset:6144
  buffer_load_dwordx4 a[48:51], v225, s[96:99], s54 offen offset:1024 sc1
  v_mfma_f32_16x16x32_bf16 a[76:79], a[156:159], v[120:123], a[76:79]
  v_exp_f32 v199, v15
  v_mfma_f32_16x16x32_bf16 a[108:111], a[152:155], v[116:119], a[108:111]
  ds_read_b128 a[180:183], v230 offset:14336
  v_cvt_pk_bf16_f32 v103, v198, v199
  v_mfma_f32_16x16x32_bf16 a[108:111], a[156:159], v[124:127], a[108:111]
  s_waitcnt lgkmcnt(4)
  v_exp_f32 v192, v16
  v_mfma_f32_16x16x32_bf16 a[80:83], a[160:163], v[112:115], a[80:83]
  ds_read_b128 a[184:187], v230 offset:7168
  ds_read_b128 a[188:191], v230 offset:15360
  v_mfma_f32_16x16x32_bf16 a[80:83], a[164:167], v[120:123], a[80:83]
  v_exp_f32 v193, v17
  v_mfma_f32_16x16x32_bf16 a[112:115], a[160:163], v[116:119], a[112:115]
  ds_read_b128 a[128:131], v229 offset:0
  v_cvt_pk_bf16_f32 v104, v192, v193
  v_mfma_f32_16x16x32_bf16 a[112:115], a[164:167], v[124:127], a[112:115]
  s_waitcnt lgkmcnt(5)
  v_exp_f32 v194, v18
  v_mfma_f32_16x16x32_bf16 a[84:87], a[168:171], v[112:115], a[84:87]
  buffer_load_dwordx4 a[52:55], v225, s[96:99], s54 offen offset:2048 sc1
  v_mfma_f32_16x16x32_bf16 a[84:87], a[172:175], v[120:123], a[84:87]
  v_exp_f32 v195, v19
  v_mfma_f32_16x16x32_bf16 a[116:119], a[168:171], v[116:119], a[116:119]
  ds_read_b128 a[132:135], v229 offset:1024
  v_cvt_pk_bf16_f32 v105, v194, v195
  v_mfma_f32_16x16x32_bf16 a[116:119], a[172:175], v[124:127], a[116:119]
  s_waitcnt lgkmcnt(4)
  v_exp_f32 v196, v24
  v_mfma_f32_16x16x32_bf16 a[88:91], a[176:179], v[112:115], a[88:91]
  ds_read_b128 a[136:139], v229 offset:2048
  ds_read_b128 a[140:143], v229 offset:3072
  v_mfma_f32_16x16x32_bf16 a[88:91], a[180:183], v[120:123], a[88:91]
  v_exp_f32 v197, v25
  v_mfma_f32_16x16x32_bf16 a[120:123], a[176:179], v[116:119], a[120:123]
  ds_read_b128 a[144:147], v229 offset:4096
  v_cvt_pk_bf16_f32 v108, v196, v197
  v_mfma_f32_16x16x32_bf16 a[120:123], a[180:183], v[124:127], a[120:123]
  s_waitcnt lgkmcnt(5)
  v_exp_f32 v198, v26
  v_mfma_f32_16x16x32_bf16 a[92:95], a[184:187], v[112:115], a[92:95]
  buffer_load_dwordx4 a[24:27], v225, s[96:99], s54 offen offset:3072 sc1
  v_mfma_f32_16x16x32_bf16 a[92:95], a[188:191], v[120:123], a[92:95]
  s_waitcnt lgkmcnt(4)
  v_exp_f32 v199, v27
  v_mfma_f32_16x16x32_bf16 a[124:127], a[184:187], v[116:119], a[124:127]
  s_add_u32 s61, s61, 2
  ds_read_b128 a[148:151], v229 offset:5120
  v_cvt_pk_bf16_f32 v109, v198, v199
  v_mfma_f32_16x16x32_bf16 a[124:127], a[188:191], v[124:127], a[124:127]
  v_add_u32 v230, 0x10000, v228
  v_add_f32 v222, v222, v208
L_adaL_last_38:
  s_sub_u32 s63, s50, 1
  s_cmp_lt_u32 s61, s63
  s_cbranch_scc1 L_adaL_mk_62
  s_sub_u32 s46, s50, s61
  s_lshl_b32 s46, s46, 5
  v_add_u32 v240, s46, v231
  v_cvt_f32_i32 v240, v240
  v_add_f32 v240, 0.5, v240
  v_mul_f32 v240, 0x71800000, v240
  v_min_f32 v64, v64, v240
  v_min_f32 v76, v76, v240
  v_subrev_f32 v242, 0x71800000, v240
  v_min_f32 v65, v65, v242
  v_min_f32 v77, v77, v242
  v_subrev_f32 v243, 0x72000000, v240
  v_min_f32 v66, v66, v243
  v_min_f32 v78, v78, v243
  v_subrev_f32 v244, 0x72400000, v240
  v_min_f32 v67, v67, v244
  v_min_f32 v79, v79, v244
  v_subrev_f32 v241, 0x73800000, v240
  v_min_f32 v68, v68, v241
  v_subrev_f32 v242, 0x73880000, v240
  v_min_f32 v69, v69, v242
  v_subrev_f32 v243, 0x73900000, v240
  v_min_f32 v70, v70, v243
  v_subrev_f32 v244, 0x73980000, v240
  v_min_f32 v71, v71, v244
  v_subrev_f32 v241, 0xf3800000, v240
  v_min_f32 v72, v72, v241
  v_subrev_f32 v242, 0xf3700000, v240
  v_min_f32 v73, v73, v242
  v_subrev_f32 v243, 0xf3600000, v240
  v_min_f32 v74, v74, v243
  v_subrev_f32 v244, 0xf3500000, v240
  v_min_f32 v75, v75, v244
  s_sub_u32 s46, s46, 32
  v_add_u32 v240, s46, v231
  v_cvt_f32_i32 v240, v240
  v_add_f32 v240, 0.5, v240
  v_mul_f32 v240, 0x71800000, v240
  v_min_f32 v80, v80, v240
  v_min_f32 v92, v92, v240
  v_subrev_f32 v242, 0x71800000, v240
  v_min_f32 v81, v81, v242
  v_min_f32 v93, v93, v242
  v_subrev_f32 v243, 0x72000000, v240
  v_min_f32 v82, v82, v243
  v_min_f32 v94, v94, v243
  v_subrev_f32 v244, 0x72400000, v240
  v_min_f32 v83, v83, v244
  v_min_f32 v95, v95, v244
  v_subrev_f32 v241, 0x73800000, v240
  v_min_f32 v84, v84, v241
  v_subrev_f32 v242, 0x73880000, v240
  v_min_f32 v85, v85, v242
  v_subrev_f32 v243, 0x73900000, v240
  v_min_f32 v86, v86, v243
  v_subrev_f32 v244, 0x73980000, v240
  v_min_f32 v87, v87, v244
  v_subrev_f32 v241, 0xf3800000, v240
  v_min_f32 v88, v88, v241
  v_subrev_f32 v242, 0xf3700000, v240
  v_min_f32 v89, v89, v242
  v_subrev_f32 v243, 0xf3600000, v240
  v_min_f32 v90, v90, v243
  v_subrev_f32 v244, 0xf3500000, v240
  v_min_f32 v91, v91, v244
L_adaL_mk_62:
  s_cmp_lt_u32 s61, s58
  s_cbranch_scc1 L_adaL_mk_63
  s_call_b64 s[42:43], L_adaL_ptr_19
L_adaL_mk_63:
  s_min_u32 s63, s63, s58
  s_min_u32 s63, s63, s62
  v_mfma_f32_16x16x32_bf16 v[32:35], a[128:131], v[160:163], v[64:67]
  s_waitcnt lgkmcnt(2)
  ds_read_b128 a[152:155], v229 offset:6144
  v_add_u32 v228, 0x10000, v229
  v_mfma_f32_16x16x32_bf16 v[32:35], a[132:135], v[164:167], v[32:35]
  v_exp_f32 v192, v20
  v_mfma_f32_16x16x32_bf16 v[32:35], a[136:139], v[168:171], v[32:35]
  ds_read_b128 a[156:159], v229 offset:7168
  buffer_load_dwordx4 a[28:31], v226, s[96:99], s54 offen offset:0 sc1
  v_mfma_f32_16x16x32_bf16 v[32:35], a[140:143], v[172:175], v[32:35]
  v_exp_f32 v193, v21
  v_mfma_f32_16x16x32_bf16 v[40:43], a[128:131], v[176:179], v[72:75]
  ds_read_b128 a[160:163], v229 offset:8192
  v_cvt_pk_bf16_f32 v106, v192, v193
  v_mfma_f32_16x16x32_bf16 v[40:43], a[132:135], v[180:183], v[40:43]
  v_exp_f32 v194, v22
  v_mfma_f32_16x16x32_bf16 v[40:43], a[136:139], v[184:187], v[40:43]
  s_mov_b32 s54, 35840
  buffer_load_dwordx4 a[56:59], v225, s[96:99], s54 offen offset:0 sc1
  v_mfma_f32_16x16x32_bf16 v[40:43], a[140:143], v[188:191], v[40:43]
  s_waitcnt lgkmcnt(2)
  v_exp_f32 v195, v23
  v_mfma_f32_16x16x32_bf16 v[36:39], a[144:147], v[160:163], v[68:71]
  ds_read_b128 a[164:167], v229 offset:9216
  v_cvt_pk_bf16_f32 v107, v194, v195
  v_mfma_f32_16x16x32_bf16 v[36:39], a[148:151], v[164:167], v[36:39]
  v_exp_f32 v196, v28
  v_mfma_f32_16x16x32_bf16 v[36:39], a[152:155], v[168:171], v[36:39]
  s_waitcnt lgkmcnt(2)
  ds_read_b128 a[168:171], v229 offset:10240
  buffer_load_dwordx4 a[60:63], v225, s[96:99], s54 offen offset:1024 sc1
  v_mfma_f32_16x16x32_bf16 v[36:39], a[156:159], v[172:175], v[36:39]
  v_exp_f32 v197, v29
  v_mfma_f32_16x16x32_bf16 v[44:47], a[144:147], v[176:179], v[76:79]
  ds_read_b128 a[172:175], v229 offset:11264
  v_cvt_pk_bf16_f32 v110, v196, v197
  v_mfma_f32_16x16x32_bf16 v[44:47], a[148:151], v[180:183], v[44:47]
  v_exp_f32 v198, v30
  v_mfma_f32_16x16x32_bf16 v[44:47], a[152:155], v[184:187], v[44:47]
  ds_read_b128 a[176:179], v229 offset:12288
  ds_read_b128 a[180:183], v229 offset:13312
  v_mfma_f32_16x16x32_bf16 v[44:47], a[156:159], v[188:191], v[44:47]
  s_waitcnt lgkmcnt(4)
  v_exp_f32 v199, v31
  v_mfma_f32_16x16x32_bf16 v[48:51], a[160:163], v[160:163], v[80:83]
  ds_read_b128 a[184:187], v229 offset:14336
  v_cvt_pk_bf16_f32 v111, v198, v199
  v_mfma_f32_16x16x32_bf16 v[48:51], a[164:167], v[164:167], v[48:51]
  v_exp_f32 v192, v32
  v_mfma_f32_16x16x32_bf16 v[208:211], v[216:219], v[96:99], 0
  ds_read_b128 a[188:191], v229 offset:15360
  buffer_load_dwordx4 v[128:131], v225, s[96:99], s54 offen offset:2048 sc1
  v_mfma_f32_16x16x32_bf16 v[212:215], v[216:219], v[100:103], 0
  v_exp_f32 v193, v33
  v_mfma_f32_16x16x32_bf16 v[208:211], v[216:219], v[104:107], v[208:211]
  ds_read_b128 a[128:131], v230 offset:0
  v_cvt_pk_bf16_f32 v112, v192, v193
  v_mfma_f32_16x16x32_bf16 v[212:215], v[216:219], v[108:111], v[212:215]
  s_waitcnt lgkmcnt(5)
  v_exp_f32 v194, v34
  v_mfma_f32_16x16x32_bf16 v[48:51], a[168:171], v[168:171], v[48:51]
  buffer_load_dwordx4 v[132:135], v225, s[96:99], s54 offen offset:3072 sc1
  v_mfma_f32_16x16x32_bf16 v[48:51], a[172:175], v[172:175], v[48:51]
  v_exp_f32 v195, v35
  v_mfma_f32_16x16x32_bf16 v[56:59], a[160:163], v[176:179], v[88:91]
  ds_read_b128 a[132:135], v230 offset:8192
  v_cvt_pk_bf16_f32 v113, v194, v195
  v_mfma_f32_16x16x32_bf16 v[56:59], a[164:167], v[180:183], v[56:59]
  v_exp_f32 v196, v40
  v_mfma_f32_16x16x32_bf16 v[56:59], a[168:171], v[184:187], v[56:59]
  ds_read_b128 a[136:139], v230 offset:1024
  buffer_load_dwordx4 v[136:139], v226, s[96:99], s54 offen offset:0 sc1
  v_mfma_f32_16x16x32_bf16 v[56:59], a[172:175], v[188:191], v[56:59]
  s_waitcnt lgkmcnt(3)
  v_exp_f32 v197, v41
  v_mfma_f32_16x16x32_bf16 v[52:55], a[176:179], v[160:163], v[84:87]
  ds_read_b128 a[140:143], v230 offset:9216
  v_cvt_pk_bf16_f32 v116, v196, v197
  v_mfma_f32_16x16x32_bf16 v[52:55], a[180:183], v[164:167], v[52:55]
  v_exp_f32 v198, v42
  v_mfma_f32_16x16x32_bf16 v[52:55], a[184:187], v[168:171], v[52:55]
  ds_read_b128 a[144:147], v230 offset:2048
  v_max_f32 v240, v208, v212
  v_mfma_f32_16x16x32_bf16 v[52:55], a[188:191], v[172:175], v[52:55]
  v_exp_f32 v199, v43
  v_mfma_f32_16x16x32_bf16 v[60:63], a[176:179], v[176:179], v[92:95]
  ds_read_b128 a[148:151], v230 offset:10240
  v_cvt_pk_bf16_f32 v117, v198, v199
  v_mfma_f32_16x16x32_bf16 v[60:63], a[180:183], v[180:183], v[60:63]
  v_exp_f32 v192, v36
  v_mfma_f32_16x16x32_bf16 v[60:63], a[184:187], v[184:187], v[60:63]
  s_waitcnt lgkmcnt(4)
  ds_read_b128 a[152:155], v230 offset:3072
  v_cmp_nge_f32 vcc, s40, v240
  v_mfma_f32_16x16x32_bf16 v[60:63], a[188:191], v[188:191], v[60:63]
  s_cbranch_vccnz L_adaL_fb_64
L_adaL_back_65:
  v_exp_f32 v193, v37
  v_mfma_f32_16x16x32_bf16 a[64:67], a[128:131], v[96:99], a[64:67]
  s_waitcnt vmcnt(17)
  s_barrier
  v_mfma_f32_16x16x32_bf16 a[64:67], a[132:135], v[104:107], a[64:67]
  v_cvt_pk_bf16_f32 v114, v192, v193
  v_add_f32 v222, v222, v208
  v_mfma_f32_16x16x32_bf16 a[96:99], a[128:131], v[100:103], a[96:99]
  ds_read_b128 a[156:159], v230 offset:11264
  ds_read_b128 a[160:163], v230 offset:4096
  v_mfma_f32_16x16x32_bf16 a[96:99], a[132:135], v[108:111], a[96:99]
  s_waitcnt lgkmcnt(5)
  v_exp_f32 v194, v38
  v_mfma_f32_16x16x32_bf16 a[68:71], a[136:139], v[96:99], a[68:71]
  ds_read_b128 a[164:167], v230 offset:12288
  s_mov_b32 s54, 46080
  buffer_load_dwordx4 v[140:143], v225, s[96:99], s54 offen offset:0 sc1
  v_mfma_f32_16x16x32_bf16 a[68:71], a[140:143], v[104:107], a[68:71]
  v_exp_f32 v195, v39
  v_mfma_f32_16x16x32_bf16 a[100:103], a[136:139], v[100:103], a[100:103]
  ds_read_b128 a[168:171], v230 offset:5120
  v_cvt_pk_bf16_f32 v115, v194, v195
  v_mfma_f32_16x16x32_bf16 a[100:103], a[140:143], v[108:111], a[100:103]
  s_waitcnt lgkmcnt(5)
  v_exp_f32 v196, v44
  v_mfma_f32_16x16x32_bf16 a[72:75], a[144:147], v[96:99], a[72:75]
  buffer_load_dwordx4 v[144:147], v225, s[96:99], s54 offen offset:1024 sc1
  v_mfma_f32_16x16x32_bf16 a[72:75], a[148:151], v[104:107], a[72:75]
  v_exp_f32 v197, v45
  v_mfma_f32_16x16x32_bf16 a[104:107], a[144:147], v[100:103], a[104:107]
  ds_read_b128 a[172:175], v230 offset:13312
  v_cvt_pk_bf16_f32 v118, v196, v197
  v_mfma_f32_16x16x32_bf16 a[104:107], a[148:151], v[108:111], a[104:107]
  s_waitcnt lgkmcnt(4)
  v_exp_f32 v198, v46
  v_mfma_f32_16x16x32_bf16 a[76:79], a[152:155], v[96:99], a[76:79]
  ds_read_b128 a[176:179], v230 offset:6144
  buffer_load_dwordx4 v[148:151], v225, s[96:99], s54 offen offset:2048 sc1
  v_mfma_f32_16x16x32_bf16 a[76:79], a[156:159], v[104:107], a[76:79]
  v_exp_f32 v199, v47
  v_mfma_f32_16x16x32_bf16 a[108:111], a[152:155], v[100:103], a[108:111]
  ds_read_b128 a[180:183], v230 offset:14336
  v_cvt_pk_bf16_f32 v119, v198, v199
  v_mfma_f32_16x16x32_bf16 a[108:111], a[156:159], v[108:111], a[108:111]
  s_waitcnt lgkmcnt(4)
  v_exp_f32 v192, v48
  v_mfma_f32_16x16x32_bf16 a[80:83], a[160:163], v[96:99], a[80:83]
  ds_read_b128 a[184:187], v230 offset:7168
  ds_read_b128 a[188:191], v230 offset:15360
  v_mfma_f32_16x16x32_bf16 a[80:83], a[164:167], v[104:107], a[80:83]
  v_exp_f32 v193, v49
  v_mfma_f32_16x16x32_bf16 a[112:115], a[160:163], v[100:103], a[112:115]
  ds_read_b128 a[128:131], v228 offset:0
  v_cvt_pk_bf16_f32 v120, v192, v193
  v_mfma_f32_16x16x32_bf16 a[112:115], a[164:167], v[108:111], a[112:115]
  s_waitcnt lgkmcnt(5)
  v_exp_f32 v194, v50
  v_mfma_f32_16x16x32_bf16 a[84:87], a[168:171], v[96:99], a[84:87]
  buffer_load_dwordx4 v[152:155], v225, s[96:99], s54 offen offset:3072 sc1
  v_mfma_f32_16x16x32_bf16 a[84:87], a[172:175], v[104:107], a[84:87]
  v_exp_f32 v195, v51
  v_mfma_f32_16x16x32_bf16 a[116:119], a[168:171], v[100:103], a[116:119]
  ds_read_b128 a[132:135], v228 offset:8192
  v_cvt_pk_bf16_f32 v121, v194, v195
  v_mfma_f32_16x16x32_bf16 a[116:119], a[172:175], v[108:111], a[116:119]
  s_waitcnt lgkmcnt(4)
  v_exp_f32 v196, v56
  v_mfma_f32_16x16x32_bf16 a[88:91], a[176:179], v[96:99], a[88:91]
  ds_read_b128 a[136:139], v228 offset:1024
  ds_read_b128 a[140:143], v228 offset:9216
  v_mfma_f32_16x16x32_bf16 a[88:91], a[180:183], v[104:107], a[88:91]
  v_exp_f32 v197, v57
  v_mfma_f32_16x16x32_bf16 a[120:123], a[176:179], v[100:103], a[120:123]
  ds_read_b128 a[144:147], v228 offset:2048
  v_cvt_pk_bf16_f32 v124, v196, v197
  v_mfma_f32_16x16x32_bf16 a[120:123], a[180:183], v[108:111], a[120:123]
  s_waitcnt lgkmcnt(5)
  v_exp_f32 v198, v58
  v_mfma_f32_16x16x32_bf16 a[92:95], a[184:187], v[96:99], a[92:95]
  buffer_load_dwordx4 v[156:159], v226, s[96:99], s54 offen offset:0 sc1
  v_mfma_f32_16x16x32_bf16 a[92:95], a[188:191], v[104:107], a[92:95]
  s_waitcnt lgkmcnt(4)
  v_exp_f32 v199, v59
  v_mfma_f32_16x16x32_bf16 a[124:127], a[184:187], v[100:103], a[124:127]
  s_nop 0
  ds_read_b128 a[148:151], v228 offset:10240
  v_cvt_pk_bf16_f32 v125, v198, v199
  v_mfma_f32_16x16x32_bf16 a[124:127], a[188:191], v[108:111], a[124:127]
  v_add_u32 v230, 0x10000, v229
  v_add_f32 v223, v223, v212
  ds_read_b128 a[152:155], v230 offset:3072
  ds_read_b128 a[156:159], v230 offset:11264
  ds_read_b128 a[160:163], v230 offset:4096
  ds_read_b128 a[164:167], v230 offset:12288
  ds_read_b128 a[168:171], v230 offset:5120
  ds_read_b128 a[172:175], v230 offset:13312
  v_exp_f32 v192, v52
  v_exp_f32 v193, v53
  v_exp_f32 v194, v54
  v_cvt_pk_bf16_f32 v122, v192, v193
  v_exp_f32 v195, v55
  v_exp_f32 v196, v60
  s_mov_b32 s54, 51200
  buffer_load_dwordx4 v[160:163], v225, s[96:99], s54 offen offset:0 sc1
  v_cvt_pk_bf16_f32 v123, v194, v195
  v_exp_f32 v197, v61
  v_exp_f32 v198, v62
  v_cvt_pk_bf16_f32 v126, v196, v197
  v_exp_f32 v199, v63
  s_nop 0
  buffer_load_dwordx4 v[164:167], v225, s[96:99], s54 offen offset:1024 sc1
  v_cvt_pk_bf16_f32 v127, v198, v199
  s_waitcnt lgkmcnt(0)
  ds_read_b128 a[176:179], v230 offset:6144
  ds_read_b128 a[180:183], v230 offset:14336
  ds_read_b128 a[184:187], v230 offset:7168
  ds_read_b128 a[188:191], v230 offset:15360
  v_mfma_f32_16x16x32_bf16 v[208:211], v[216:219], v[112:115], 0
  v_mfma_f32_16x16x32_bf16 v[212:215], v[216:219], v[116:119], 0
  v_mfma_f32_16x16x32_bf16 v[208:211], v[216:219], v[120:123], v[208:211]
  v_mfma_f32_16x16x32_bf16 v[212:215], v[216:219], v[124:127], v[212:215]
  s_and_b32 s57, s2, 4
  s_lshl_b32 s57, s57, 2
  s_bfe_u32 s52, s2, 0x30003
  s_lshl_b32 s52, s52, 1
  s_add_u32 s57, s57, s52
  s_bfe_u32 s52, s2, 0x10001
  s_add_u32 s57, s57, s52
  s_and_b32 s58, s2, 1
  s_lshl_b32 s58, s58, 2
  s_lshr_b32 s52, s2, 6
  s_add_u32 s58, s58, s52
  v_max_f32 v240, v208, v212
  v_cmp_nge_f32 vcc, s40, v240
  s_cbranch_vccnz L_adaL_fb_66
L_adaL_back_67:
  v_mfma_f32_16x16x32_bf16 a[64:67], a[128:131], v[112:115], a[64:67]
  v_add_f32 v222, v222, v208
  v_add_f32 v223, v223, v212
  v_mfma_f32_16x16x32_bf16 a[64:67], a[132:135], v[120:123], a[64:67]
  buffer_load_dwordx4 v[168:171], v225, s[96:99], s54 offen offset:2048 sc1
  v_mfma_f32_16x16x32_bf16 a[96:99], a[128:131], v[116:119], a[96:99]
  v_rcp_f32 v240, v222
  v_rcp_f32 v242, v223
  v_mfma_f32_16x16x32_bf16 a[96:99], a[132:135], v[124:127], a[96:99]
  s_lshr_b32 s46, s50, 1
  s_mul_i32 s46, s46, 540672
  v_mfma_f32_16x16x32_bf16 a[68:71], a[136:139], v[112:115], a[68:71]
  s_and_b32 s45, s50, 1
  s_lshl_b32 s45, s45, 11
  v_mfma_f32_16x16x32_bf16 a[68:71], a[140:143], v[120:123], a[68:71]
  buffer_load_dwordx4 v[172:175], v225, s[96:99], s54 offen offset:3072 sc1
  v_mfma_f32_16x16x32_bf16 a[100:103], a[136:139], v[116:119], a[100:103]
  s_add_u32 s46, s46, s45
  s_lshl_b32 s44, s7, 1
  v_mfma_f32_16x16x32_bf16 a[100:103], a[140:143], v[124:127], a[100:103]
  v_mov_b32 v244, s44
  s_sub_u32 s44, 30, s44
  v_mfma_f32_16x16x32_bf16 a[72:75], a[144:147], v[112:115], a[72:75]
  v_mov_b32 v245, s44
  v_cmp_gt_u32 vcc, 16, v224
  v_mfma_f32_16x16x32_bf16 a[72:75], a[148:151], v[120:123], a[72:75]
  buffer_load_dwordx4 v[176:179], v226, s[96:99], s54 offen offset:0 sc1
  v_mfma_f32_16x16x32_bf16 a[104:107], a[144:147], v[116:119], a[104:107]
  v_bfe_u32 v246, v224, 3, 1
  v_and_b32 v247, 7, v224
  v_mfma_f32_16x16x32_bf16 a[104:107], a[148:151], v[124:127], a[104:107]
  v_cndmask_b32 v244, v245, v244, vcc
  v_add_u32 v244, v244, v246
  v_mfma_f32_16x16x32_bf16 a[76:79], a[152:155], v[112:115], a[76:79]
  v_lshl_add_u32 v244, v247, 5, v244
  v_lshlrev_b32 v244, 10, v244
  v_mfma_f32_16x16x32_bf16 a[76:79], a[156:159], v[120:123], a[76:79]
  s_mov_b32 s54, 56320
  buffer_load_dwordx4 v[180:183], v225, s[96:99], s54 offen offset:0 sc1
  v_mfma_f32_16x16x32_bf16 a[108:111], a[152:155], v[116:119], a[108:111]
  v_mov_b32 v245, 1
  s_lshl_b32 s44, s6, 2
  v_mfma_f32_16x16x32_bf16 a[108:111], a[156:159], v[124:127], a[108:111]
  v_accvgpr_read_b32 v0, a64
  v_accvgpr_read_b32 v1, a65
  v_mfma_f32_16x16x32_bf16 a[80:83], a[160:163], v[112:115], a[80:83]
  v_accvgpr_read_b32 v2, a66
  v_accvgpr_read_b32 v3, a67
  v_mfma_f32_16x16x32_bf16 a[80:83], a[164:167], v[120:123], a[80:83]
  buffer_load_dwordx4 v[184:187], v225, s[96:99], s54 offen offset:1024 sc1
  v_mfma_f32_16x16x32_bf16 a[112:115], a[160:163], v[116:119], a[112:115]
  v_accvgpr_read_b32 v4, a68
  v_accvgpr_read_b32 v5, a69
  v_mfma_f32_16x16x32_bf16 a[112:115], a[164:167], v[124:127], a[112:115]
  v_accvgpr_read_b32 v6, a70
  v_accvgpr_read_b32 v7, a71
  s_waitcnt lgkmcnt(0)
  v_mfma_f32_16x16x32_bf16 a[84:87], a[168:171], v[112:115], a[84:87]
  v_mul_f32 v0, v0, v240
  v_mul_f32 v1, v1, v240
  v_mfma_f32_16x16x32_bf16 a[84:87], a[172:175], v[120:123], a[84:87]
  buffer_load_dwordx4 v[188:191], v225, s[96:99], s54 offen offset:2048 sc1
  v_mfma_f32_16x16x32_bf16 a[116:119], a[168:171], v[116:119], a[116:119]
  v_mul_f32 v2, v2, v240
  v_mul_f32 v3, v3, v240
  v_mfma_f32_16x16x32_bf16 a[116:119], a[172:175], v[124:127], a[116:119]
  v_mul_f32 v4, v4, v240
  v_mul_f32 v5, v5, v240
  v_mfma_f32_16x16x32_bf16 a[88:91], a[176:179], v[112:115], a[88:91]
  v_mul_f32 v6, v6, v240
  v_mul_f32 v7, v7, v240
  v_mfma_f32_16x16x32_bf16 a[88:91], a[180:183], v[120:123], a[88:91]
  v_cvt_pk_bf16_f32 v0, v0, v1
  v_cvt_pk_bf16_f32 v1, v2, v3
  v_mfma_f32_16x16x32_bf16 a[120:123], a[176:179], v[116:119], a[120:123]
  v_cvt_pk_bf16_f32 v2, v4, v5
  v_cvt_pk_bf16_f32 v3, v6, v7
  v_mfma_f32_16x16x32_bf16 a[120:123], a[180:183], v[124:127], a[120:123]
  buffer_store_dwordx4 v[0:3], v232, s[32:35], s46 offen offset:0 sc1
  v_accvgpr_read_b32 v8, a96
  v_mfma_f32_16x16x32_bf16 a[92:95], a[184:187], v[112:115], a[92:95]
  v_accvgpr_read_b32 v9, a97
  v_accvgpr_read_b32 v10, a98
  v_mfma_f32_16x16x32_bf16 a[92:95], a[188:191], v[120:123], a[92:95]
  v_accvgpr_read_b32 v11, a99
  v_accvgpr_read_b32 v12, a100
  v_mfma_f32_16x16x32_bf16 a[124:127], a[184:187], v[116:119], a[124:127]
  v_accvgpr_read_b32 v13, a101
  v_accvgpr_read_b32 v14, a102
  v_mfma_f32_16x16x32_bf16 a[124:127], a[188:191], v[124:127], a[124:127]
  v_accvgpr_read_b32 v15, a103
  v_mul_f32 v8, v8, v242
  v_mul_f32 v9, v9, v242
  v_mul_f32 v10, v10, v242
  v_mul_f32 v11, v11, v242
  v_mul_f32 v12, v12, v242
  v_mul_f32 v13, v13, v242
  v_mul_f32 v14, v14, v242
  v_mul_f32 v15, v15, v242
  v_cvt_pk_bf16_f32 v8, v8, v9
  v_cvt_pk_bf16_f32 v9, v10, v11
  v_cvt_pk_bf16_f32 v10, v12, v13
  v_cvt_pk_bf16_f32 v11, v14, v15
  buffer_store_dwordx4 v[8:11], v232, s[32:35], s46 offen offset:1024 sc1
  s_add_u32 s46, s46, 4096
  v_accvgpr_read_b32 v16, a72
  v_accvgpr_read_b32 v17, a73
  v_accvgpr_read_b32 v18, a74
  v_accvgpr_read_b32 v19, a75
  v_accvgpr_read_b32 v20, a76
  v_accvgpr_read_b32 v21, a77
  v_accvgpr_read_b32 v22, a78
  v_accvgpr_read_b32 v23, a79
  v_pk_mul_f32 v[16:17], v[16:17], v[240:241] op_sel_hi:[1,0]
  v_pk_mul_f32 v[18:19], v[18:19], v[240:241] op_sel_hi:[1,0]
  v_pk_mul_f32 v[20:21], v[20:21], v[240:241] op_sel_hi:[1,0]
  buffer_load_dwordx4 a[128:131], v225, s[96:99], s54 offen offset:3072 sc1
  v_pk_mul_f32 v[22:23], v[22:23], v[240:241] op_sel_hi:[1,0]
  v_cvt_pk_bf16_f32 v16, v16, v17
  v_cvt_pk_bf16_f32 v17, v18, v19
  v_cvt_pk_bf16_f32 v18, v20, v21
  v_cvt_pk_bf16_f32 v19, v22, v23
  buffer_store_dwordx4 v[16:19], v232, s[32:35], s46 offen offset:0 sc1
  v_accvgpr_read_b32 v24, a104
  v_accvgpr_read_b32 v25, a105
  v_accvgpr_read_b32 v26, a106
  v_accvgpr_read_b32 v27, a107
  v_accvgpr_read_b32 v28, a108
  v_accvgpr_read_b32 v29, a109
  v_accvgpr_read_b32 v30, a110
  v_accvgpr_read_b32 v31, a111
  v_pk_mul_f32 v[24:25], v[24:25], v[242:243] op_sel_hi:[1,0]
  v_pk_mul_f32 v[26:27], v[26:27], v[242:243] op_sel_hi:[1,0]
  v_pk_mul_f32 v[28:29], v[28:29], v[242:243] op_sel_hi:[1,0]
  v_pk_mul_f32 v[30:31], v[30:31], v[242:243] op_sel_hi:[1,0]
  v_cvt_pk_bf16_f32 v24, v24, v25
  v_cvt_pk_bf16_f32 v25, v26, v27
  v_cvt_pk_bf16_f32 v26, v28, v29
  v_cvt_pk_bf16_f32 v27, v30, v31
  buffer_store_dwordx4 v[24:27], v232, s[32:35], s46 offen offset:1024 sc1
  s_add_u32 s46, s46, 4096
  buffer_load_dwordx4 a[132:135], v226, s[96:99], s54 offen offset:0 sc1
  v_accvgpr_read_b32 v0, a80
  v_accvgpr_read_b32 v1, a81
  v_accvgpr_read_b32 v2, a82
  v_accvgpr_read_b32 v3, a83
  v_accvgpr_read_b32 v4, a84
  v_accvgpr_read_b32 v5, a85
  v_accvgpr_read_b32 v6, a86
  v_accvgpr_read_b32 v7, a87
  v_pk_mul_f32 v[0:1], v[0:1], v[240:241] op_sel_hi:[1,0]
  v_pk_mul_f32 v[2:3], v[2:3], v[240:241] op_sel_hi:[1,0]
  v_pk_mul_f32 v[4:5], v[4:5], v[240:241] op_sel_hi:[1,0]
  v_pk_mul_f32 v[6:7], v[6:7], v[240:241] op_sel_hi:[1,0]
  v_cvt_pk_bf16_f32 v0, v0, v1
  v_cvt_pk_bf16_f32 v1, v2, v3
  v_cvt_pk_bf16_f32 v2, v4, v5
  v_cvt_pk_bf16_f32 v3, v6, v7
  buffer_store_dwordx4 v[0:3], v232, s[32:35], s46 offen offset:0 sc1
  v_accvgpr_read_b32 v8, a112
  v_accvgpr_read_b32 v9, a113
  v_accvgpr_read_b32 v10, a114
  v_accvgpr_read_b32 v11, a115
  v_accvgpr_read_b32 v12, a116
  v_accvgpr_read_b32 v13, a117
  v_accvgpr_read_b32 v14, a118
  s_mov_b32 s54, 61440
  buffer_load_dwordx4 a[136:139], v225, s[96:99], s54 offen offset:0 sc1
  v_accvgpr_read_b32 v15, a119
  v_pk_mul_f32 v[8:9], v[8:9], v[242:243] op_sel_hi:[1,0]
  v_pk_mul_f32 v[10:11], v[10:11], v[242:243] op_sel_hi:[1,0]
  v_pk_mul_f32 v[12:13], v[12:13], v[242:243] op_sel_hi:[1,0]
  v_pk_mul_f32 v[14:15], v[14:15], v[242:243] op_sel_hi:[1,0]
  v_cvt_pk_bf16_f32 v8, v8, v9
  v_cvt_pk_bf16_f32 v9, v10, v11
  v_cvt_pk_bf16_f32 v10, v12, v13
  v_cvt_pk_bf16_f32 v11, v14, v15
  buffer_store_dwordx4 v[8:11], v232, s[32:35], s46 offen offset:1024 sc1
  s_add_u32 s46, s46, 4096
  v_accvgpr_read_b32 v16, a88
  v_accvgpr_read_b32 v17, a89
  v_accvgpr_read_b32 v18, a90
  v_accvgpr_read_b32 v19, a91
  v_accvgpr_read_b32 v20, a92
  v_accvgpr_read_b32 v21, a93
  v_accvgpr_read_b32 v22, a94
  v_accvgpr_read_b32 v23, a95
  v_pk_mul_f32 v[16:17], v[16:17], v[240:241] op_sel_hi:[1,0]
  v_pk_mul_f32 v[18:19], v[18:19], v[240:241] op_sel_hi:[1,0]
  v_pk_mul_f32 v[20:21], v[20:21], v[240:241] op_sel_hi:[1,0]
  v_pk_mul_f32 v[22:23], v[22:23], v[240:241] op_sel_hi:[1,0]
  v_cvt_pk_bf16_f32 v16, v16, v17
  buffer_load_dwordx4 a[140:143], v225, s[96:99], s54 offen offset:1024 sc1
  v_cvt_pk_bf16_f32 v17, v18, v19
  v_cvt_pk_bf16_f32 v18, v20, v21
  v_cvt_pk_bf16_f32 v19, v22, v23
  buffer_store_dwordx4 v[16:19], v232, s[32:35], s46 offen offset:0 sc1
  v_accvgpr_read_b32 v24, a120
  v_accvgpr_read_b32 v25, a121
  v_accvgpr_read_b32 v26, a122
  v_accvgpr_read_b32 v27, a123
  v_accvgpr_read_b32 v28, a124
  v_accvgpr_read_b32 v29, a125
  v_accvgpr_read_b32 v30, a126
  v_accvgpr_read_b32 v31, a127
  v_pk_mul_f32 v[24:25], v[24:25], v[242:243] op_sel_hi:[1,0]
  v_pk_mul_f32 v[26:27], v[26:27], v[242:243] op_sel_hi:[1,0]
  v_pk_mul_f32 v[28:29], v[28:29], v[242:243] op_sel_hi:[1,0]
  v_pk_mul_f32 v[30:31], v[30:31], v[242:243] op_sel_hi:[1,0]
  v_cvt_pk_bf16_f32 v24, v24, v25
  v_cvt_pk_bf16_f32 v25, v26, v27
  v_cvt_pk_bf16_f32 v26, v28, v29
  v_cvt_pk_bf16_f32 v27, v30, v31
  buffer_store_dwordx4 v[24:27], v232, s[32:35], s46 offen offset:1024 sc1
  s_load_dwordx2 s[68:69], s[0:1], 72
  s_load_dwordx2 s[70:71], s[0:1], 104
  buffer_load_dwordx4 a[144:147], v225, s[96:99], s54 offen offset:2048 sc1
  buffer_load_dwordx4 a[148:151], v225, s[96:99], s54 offen offset:3072 sc1
  buffer_load_dwordx4 a[152:155], v226, s[96:99], s54 offen offset:0 sc1
  s_mov_b32 s54, 66560
  buffer_load_dwordx4 a[156:159], v225, s[96:99], s54 offen offset:0 sc1
  buffer_load_dwordx4 a[160:163], v225, s[96:99], s54 offen offset:1024 sc1
  buffer_load_dwordx4 a[164:167], v225, s[96:99], s54 offen offset:2048 sc1
  buffer_load_dwordx4 a[168:171], v225, s[96:99], s54 offen offset:3072 sc1
  buffer_load_dwordx4 a[172:175], v226, s[96:99], s54 offen offset:0 sc1
  s_mov_b32 s54, 71680
  buffer_load_dwordx4 a[176:179], v225, s[96:99], s54 offen offset:0 sc1
  buffer_load_dwordx4 a[180:183], v225, s[96:99], s54 offen offset:1024 sc1
  buffer_load_dwordx4 a[184:187], v225, s[96:99], s54 offen offset:2048 sc1
  buffer_load_dwordx4 a[188:191], v225, s[96:99], s54 offen offset:3072 sc1
  buffer_load_dwordx4 a[64:67], v226, s[96:99], s54 offen offset:0 sc1
  s_mov_b32 s54, 76800
  buffer_load_dwordx4 a[68:71], v225, s[96:99], s54 offen offset:0 sc1
  s_waitcnt vmcnt(14)
  s_waitcnt lgkmcnt(0)
  s_barrier
  s_cmp_lg_u32 s3, 0
  s_cbranch_scc1 L_adaL_nopush_68
  s_mov_b32 exec_hi, 0
  buffer_store_dword v245, v244, s[8:11], s44 offen offset:256 sc1
  s_mov_b64 exec, -1
L_adaL_nopush_68:
  s_mul_i32 s61, s3, 10240
  s_add_u32 s61, s61, 61440
  s_and_b32 s56, s57, 1
  s_and_b32 s52, s57, 30
  s_lshl_b32 s52, s52, 1
  s_add_u32 s52, s52, s56
  buffer_load_dwordx4 a[72:75], v225, s[96:99], s54 offen offset:1024 sc1
  s_lshl_b32 s52, s52, 1
  s_lshr_b32 s53, s3, 1
  s_add_u32 s52, s52, s53
  s_mul_i32 s52, s52, 135168
  buffer_load_dwordx4 a[76:79], v225, s[96:99], s54 offen offset:2048 sc1
  s_and_b32 s53, s3, 1
  s_lshl_b32 s53, s53, 16
  s_add_u32 s52, s52, s53
  s_add_u32 s52, s52, 41943040
  buffer_load_dwordx4 a[80:83], v225, s[96:99], s54 offen offset:3072 sc1
  s_add_u32 s53, s3, 0
  s_and_b32 s53, s53, 3
  s_mul_i32 s53, s53, 1024
  s_sub_u32 s18, 606208, s53
  buffer_load_dwordx4 a[84:87], v226, s[96:99], s54 offen offset:0 sc1
  s_add_u32 s53, s53, s52
  s_add_u32 s16, s4, s53
  s_addc_u32 s17, s5, 0
  s_mov_b32 s19, 0x20000
  s_add_u32 m0, s61, 0
  s_mov_b32 s54, 20480
  buffer_load_dwordx4 v225, s[96:99], s54 offen offset:0 sc1 lds
  s_add_u32 s53, s3, 1
  s_and_b32 s53, s53, 3
  s_mul_i32 s53, s53, 1024
  s_sub_u32 s22, 606208, s53
  buffer_load_dwordx4 v225, s[96:99], s54 offen offset:1024 sc1 lds
  s_add_u32 s53, s53, s52
  s_add_u32 s20, s4, s53
  s_addc_u32 s21, s5, 0
  s_mov_b32 s23, 0x20000
  buffer_load_dwordx4 v225, s[96:99], s54 offen offset:2048 sc1 lds
  s_add_u32 s53, s3, 2
  s_and_b32 s53, s53, 3
  s_mul_i32 s53, s53, 1024
  s_sub_u32 s26, 606208, s53
  buffer_load_dwordx4 v225, s[96:99], s54 offen offset:3072 sc1 lds
  s_add_u32 s53, s53, s52
  s_add_u32 s24, s4, s53
  s_addc_u32 s25, s5, 0
  s_mov_b32 s27, 0x20000
  s_add_u32 m0, s61, 4096
  s_mov_b32 s54, 24576
  buffer_load_dwordx4 v225, s[96:99], s54 offen offset:0 sc1 lds
  s_add_u32 s53, s3, 3
  s_and_b32 s53, s53, 3
  s_mul_i32 s53, s53, 1024
  s_sub_u32 s30, 606208, s53
  s_add_u32 m0, s61, 5120
  s_mov_b32 s54, 40960
  buffer_load_dwordx4 v225, s[96:99], s54 offen offset:0 sc1 lds
  s_add_u32 s53, s53, s52
  s_add_u32 s28, s4, s53
  s_addc_u32 s29, s5, 0
  s_mov_b32 s31, 0x20000
  buffer_load_dwordx4 v225, s[96:99], s54 offen offset:1024 sc1 lds
  s_lshl_b32 s63, s58, 5
  s_add_u32 s63, s63, s57
  s_lshl_b32 s63, s63, 10
  v_and_b32 v238, 31, v224
  buffer_load_dwordx4 v225, s[96:99], s54 offen offset:2048 sc1 lds
  v_lshlrev_b32 v238, 2, v238
  s_lshl_b32 s52, s56, 2
  s_add_u32 s52, s52, s3
  s_lshl_b32 s52, s52, 4
  buffer_load_dwordx4 v225, s[96:99], s54 offen offset:3072 sc1 lds
  s_mul_i32 s56, s56, 540672
  s_sub_u32 s101, 540672, s56
  s_add_u32 m0, s61, 9216
  s_mov_b32 s54, 45056
  buffer_load_dwordx4 v225, s[96:99], s54 offen offset:0 sc1 lds
  v_add_u32 v253, s61, v225
  s_add_u32 s40, s4, 32768
  s_addc_u32 s41, s5, 0
  s_mov_b32 s42, 7680
  s_mov_b32 s43, 0x20000
  s_lshl_b32 s52, s3, 12
  s_mul_i32 s62, s58, 160
  v_lshrrev_b32 v245, 4, v224
  v_and_b32 v244, 15, v224
  v_min_u32 v244, 9, v244
  v_mul_u32_u24 v246, 1280, v245
  v_lshl_add_u32 v244, v244, 4, v246
  s_add_u32 s52, s52, 146432
  s_mov_b32 m0, s52
  s_add_u32 s60, s62, 2560
  buffer_load_dwordx4 v244, s[40:43], s60 offen sc1 lds
  v_lshl_add_u32 v110, v245, 3, s52
  s_mov_b32 s36, s68
  s_mov_b32 s37, s69
  s_mov_b32 s38, 4096
  s_mov_b32 s39, 0x20000
  s_lshl_b32 s52, s57, 6
  s_lshl_b32 s53, s3, 4
  s_add_u32 s52, s52, s53
  v_bfe_u32 v246, v224, 2, 1
  v_and_b32 v247, 3, v224
  v_lshl_add_u32 v246, v246, 3, v247
  v_bfe_u32 v247, v224, 3, 1
  v_lshl_add_u32 v246, v247, 2, v246
  v_add_u32 v246, s52, v246
  v_lshlrev_b32 v246, 1, v246
  buffer_load_ushort v227, v246, s[36:39], 0 offen
  v_mov_b32 v255, 0
  global_load_dword v254, v255, s[64:65] offset:192 sc1
  s_lshr_b32 s72, s2, 3
  s_lshl_b32 s72, s72, 2
  s_add_u32 s72, s72, s3
  s_mul_i32 s72, s72, 2
  v_min_u32 v248, 1, v224
  v_add_u32 v248, s72, v248
  s_getpc_b64 s[72:73]
L_adaL_pc_69:
  s_add_u32 s72, s72, L_c4-L_adaL_pc_69
  s_addc_u32 s73, s73, 0
  v_lshlrev_b32 v248, 7, v248
  v_min_u32 v248, L_adaL_end-L_c4, v248
  v_mov_b32 v249, s73
  v_add_co_u32 v248, vcc, s72, v248
  s_nop 1
  v_addc_co_u32 v249, vcc, 0, v249, vcc
  global_load_dword v111, v[248:249], off
  s_and_b32 s52, s57, 2
  s_lshl_b32 s52, s52, 3
  s_lshr_b32 s100, s57, 1
  s_add_u32 s100, s100, s52
  s_and_b32 s52, s57, 1
  s_add_u32 s100, s100, s52
  s_cmp_ge_u32 s100, 7
  s_cselect_b32 s52, 8, 0
  s_cselect_b32 s53, 7, 0
  s_add_u32 s52, s52, s58
  s_sub_u32 s53, s100, s53
  s_mul_i32 s72, s52, 7
  s_add_u32 s72, s72, s53
  s_cmp_ge_u32 s100, 14
  s_cbranch_scc1 L_adaL_nouv_70
  s_lshl_b32 s52, s52, 2
  s_add_u32 s52, s52, s3
  s_mul_i32 s52, s52, 35
  s_add_u32 s52, s52, s53
  s_lshl_b32 s52, s52, 10
  s_add_u32 s52, s52, 28311552
  s_add_u32 s36, s4, s52
  s_addc_u32 s37, s5, 0
  s_mov_b32 s38, 29696
  s_mov_b32 s39, 0x20000
  s_lshl_b32 s52, s3, 10
  s_add_u32 m0, s52, 159744
  v_and_b32 v72, 31, v224
  v_min_u32 v72, 19, v72
  v_lshrrev_b32 v73, 5, v224
  v_mul_u32_u24 v73, 1280, v73
  v_lshl_add_u32 v72, v72, 4, v73
  s_mul_i32 s53, s3, 320
  s_add_u32 s53, s53, 3840
  buffer_load_dwordx4 v72, s[40:43], s53 offen sc1 lds
  s_movk_i32 s52, 0
  buffer_load_dwordx4 v[32:35], v225, s[36:39], s52 offen sc1
  s_movk_i32 s52, 7168
  buffer_load_dwordx4 v[36:39], v225, s[36:39], s52 offen sc1
  s_movk_i32 s52, 14336
  buffer_load_dwordx4 v[40:43], v225, s[36:39], s52 offen sc1
  s_movk_i32 s52, 21504
  buffer_load_dwordx4 v[44:47], v225, s[36:39], s52 offen sc1
  s_movk_i32 s52, 28672
  buffer_load_dwordx4 v[48:51], v225, s[36:39], s52 offen sc1
L_adaL_nouv_70:
  s_mov_b32 s59, 400000
L_adaL_poll_71:
  buffer_load_dword v239, v238, s[8:11], s63 offen offset:256 sc1
  s_sub_u32 s59, s59, 1
  s_cbranch_scc1 L_adaL_polled_72
  s_waitcnt vmcnt(0)
  v_cmp_gt_u32 vcc, 1, v239
  s_cbranch_vccnz L_adaL_poll_71
L_adaL_polled_72:
  s_add_u32 s55, s101, 0
  buffer_load_dwordx4 a[88:91], v225, s[16:19], s55 offen sc1
  buffer_load_dwordx4 a[92:95], v225, s[20:23], s55 offen sc1
  buffer_load_dwordx4 a[96:99], v225, s[24:27], s55 offen sc1
  buffer_load_dwordx4 a[100:103], v225, s[28:31], s55 offen sc1
  s_add_u32 s55, s101, 4096
  buffer_load_dwordx4 a[104:107], v225, s[16:19], s55 offen sc1
  buffer_load_dwordx4 a[108:111], v225, s[20:23], s55 offen sc1
  buffer_load_dwordx4 a[112:115], v225, s[24:27], s55 offen sc1
  buffer_load_dwordx4 a[116:119], v225, s[28:31], s55 offen sc1
  s_cmp_ge_u32 s100, 14
  s_cbranch_scc1 L_adaL_nouv_73
  s_lshl_b32 s52, s3, 10
  s_add_u32 s52, s52, 159744
  v_and_b32 v76, 1, v224
  v_xor_b32 v76, 1, v76
  v_lshl_add_u32 v76, v76, 9, s52
  v_lshrrev_b32 v77, 4, v224
  v_lshl_add_u32 v76, v77, 3, v76
  v_lshrrev_b32 v77, 5, v224
  v_mul_u32_u24 v77, 144, v77
  v_add_u32 v78, v77, v76
  ds_read_b64 v[52:53], v76 offset:0
  ds_read_b64 v[54:55], v76 offset:32
  ds_read_b64 v[56:57], v76 offset:64
  ds_read_b64 v[58:59], v76 offset:96
  ds_read_b64 v[60:61], v76 offset:160
  ds_read_b64 v[62:63], v76 offset:192
  ds_read_b64 v[64:65], v76 offset:224
  ds_read_b64 v[66:67], v76 offset:256
  ds_read_b64 v[68:69], v78 offset:128
  ds_read_b64 v[70:71], v78 offset:144
  v_lshl_add_u32 v77, v224, 3, s52
  s_waitcnt lgkmcnt(0)
  v_mfma_f32_16x16x32_bf16 v[72:75], v[52:55], v[32:35], 0
  v_mfma_f32_16x16x32_bf16 v[72:75], v[56:59], v[36:39], v[72:75]
  v_mfma_f32_16x16x32_bf16 v[72:75], v[60:63], v[40:43], v[72:75]
  v_mfma_f32_16x16x32_bf16 v[72:75], v[64:67], v[44:47], v[72:75]
  v_mfma_f32_16x16x32_bf16 v[72:75], v[68:71], v[48:51], v[72:75]
  s_nop 7
  ds_write_b64 v77, v[72:73]
  s_waitcnt lgkmcnt(0)
L_adaL_nouv_73:
  s_add_u32 s55, s101, 8192
  buffer_load_dwordx4 a[120:123], v225, s[16:19], s55 offen sc1
  buffer_load_dwordx4 a[124:127], v225, s[20:23], s55 offen sc1
  buffer_load_dwordx4 v[112:115], v225, s[24:27], s55 offen sc1
  buffer_load_dwordx4 v[116:119], v225, s[28:31], s55 offen sc1
  s_waitcnt vmcnt(11)
  v_mfma_f32_16x16x32_bf16 v[0:3], a[192:195], a[88:91], 0
  s_add_u32 s53, s3, 0
  s_waitcnt vmcnt(10)
  v_mfma_f32_16x16x32_bf16 v[20:23], a[192:195], a[92:95], 0
  s_and_b32 s53, s53, 3
  s_waitcnt vmcnt(9)
  v_mfma_f32_16x16x32_bf16 v[40:43], a[192:195], a[96:99], 0
  s_mul_i32 s53, s53, 15360
  s_waitcnt vmcnt(8)
  v_mfma_f32_16x16x32_bf16 v[60:63], a[192:195], a[100:103], 0
  v_add_u32 v240, s53, v225
  v_mfma_f32_16x16x32_bf16 v[4:7], a[196:199], a[88:91], 0
  s_add_u32 s55, s101, 12288
  buffer_load_dwordx4 v[120:123], v225, s[16:19], s55 offen sc1
  v_mfma_f32_16x16x32_bf16 v[24:27], a[196:199], a[92:95], 0
  s_add_u32 s53, s3, 1
  v_mfma_f32_16x16x32_bf16 v[44:47], a[196:199], a[96:99], 0
  s_and_b32 s53, s53, 3
  v_mfma_f32_16x16x32_bf16 v[64:67], a[196:199], a[100:103], 0
  s_mul_i32 s53, s53, 15360
  v_mfma_f32_16x16x32_bf16 v[8:11], a[200:203], a[88:91], 0
  v_add_u32 v241, s53, v225
  v_mfma_f32_16x16x32_bf16 v[28:31], a[200:203], a[92:95], 0
  buffer_load_dwordx4 v[124:127], v225, s[20:23], s55 offen sc1
  v_mfma_f32_16x16x32_bf16 v[48:51], a[200:203], a[96:99], 0
  s_add_u32 s53, s3, 2
  v_mfma_f32_16x16x32_bf16 v[68:71], a[200:203], a[100:103], 0
  s_and_b32 s53, s53, 3
  v_mfma_f32_16x16x32_bf16 v[12:15], a[204:207], a[88:91], 0
  s_mul_i32 s53, s53, 15360
  v_mfma_f32_16x16x32_bf16 v[32:35], a[204:207], a[92:95], 0
  v_add_u32 v242, s53, v225
  v_mfma_f32_16x16x32_bf16 v[52:55], a[204:207], a[96:99], 0
  buffer_load_dwordx4 v[192:195], v225, s[24:27], s55 offen sc1
  v_mfma_f32_16x16x32_bf16 v[72:75], a[204:207], a[100:103], 0
  s_add_u32 s53, s3, 3
  v_mfma_f32_16x16x32_bf16 v[16:19], a[208:211], a[88:91], 0
  s_and_b32 s53, s53, 3
  v_mfma_f32_16x16x32_bf16 v[36:39], a[208:211], a[92:95], 0
  s_mul_i32 s53, s53, 15360
  v_mfma_f32_16x16x32_bf16 v[56:59], a[208:211], a[96:99], 0
  v_add_u32 v243, s53, v225
  v_mfma_f32_16x16x32_bf16 v[76:79], a[208:211], a[100:103], 0
  buffer_load_dwordx4 a[88:91], v225, s[28:31], s55 offen sc1
  s_waitcnt vmcnt(11)
  v_mfma_f32_16x16x32_bf16 v[0:3], a[212:215], a[104:107], v[0:3]
  s_lshl_b32 s52, s3, 12
  s_waitcnt vmcnt(10)
  v_mfma_f32_16x16x32_bf16 v[20:23], a[212:215], a[108:111], v[20:23]
  s_add_u32 s52, s52, 143360
  s_waitcnt vmcnt(9)
  v_mfma_f32_16x16x32_bf16 v[40:43], a[212:215], a[112:115], v[40:43]
  v_bfe_u32 v250, v224, 2, 1
  s_waitcnt vmcnt(8)
  v_mfma_f32_16x16x32_bf16 v[60:63], a[212:215], a[116:119], v[60:63]
  v_and_b32 v244, 3, v224
  v_mfma_f32_16x16x32_bf16 v[4:7], a[216:219], a[104:107], v[4:7]
  s_add_u32 s55, s101, 16384
  buffer_load_dwordx4 a[92:95], v225, s[16:19], s55 offen sc1
  v_mfma_f32_16x16x32_bf16 v[24:27], a[216:219], a[108:111], v[24:27]
  v_lshl_add_u32 v250, v250, 3, v244
  v_mfma_f32_16x16x32_bf16 v[44:47], a[216:219], a[112:115], v[44:47]
  v_bfe_u32 v244, v224, 3, 1
  v_mfma_f32_16x16x32_bf16 v[64:67], a[216:219], a[116:119], v[64:67]
  v_lshl_add_u32 v250, v244, 2, v250
  v_mfma_f32_16x16x32_bf16 v[8:11], a[220:223], a[104:107], v[8:11]
  v_mul_u32_u24 v250, 160, v250
  v_mfma_f32_16x16x32_bf16 v[28:31], a[220:223], a[108:111], v[28:31]
  buffer_load_dwordx4 a[96:99], v225, s[20:23], s55 offen sc1
  v_mfma_f32_16x16x32_bf16 v[48:51], a[220:223], a[112:115], v[48:51]
  v_lshrrev_b32 v244, 4, v224
  v_mfma_f32_16x16x32_bf16 v[68:71], a[220:223], a[116:119], v[68:71]
  v_lshl_add_u32 v250, v244, 3, v250
  v_mfma_f32_16x16x32_bf16 v[12:15], a[224:227], a[104:107], v[12:15]
  v_add_u32 v250, s52, v250
  v_mfma_f32_16x16x32_bf16 v[32:35], a[224:227], a[108:111], v[32:35]
  s_mul_i32 s52, s58, 143360
  v_mfma_f32_16x16x32_bf16 v[52:55], a[224:227], a[112:115], v[52:55]
  buffer_load_dwordx4 a[100:103], v225, s[24:27], s55 offen sc1
  v_mfma_f32_16x16x32_bf16 v[72:75], a[224:227], a[116:119], v[72:75]
  s_add_u32 s52, s52, 28311552
  v_mfma_f32_16x16x32_bf16 v[16:19], a[228:231], a[104:107], v[16:19]
  s_add_u32 s32, s4, s52
  s_addc_u32 s33, s5, 0
  v_mfma_f32_16x16x32_bf16 v[36:39], a[228:231], a[108:111], v[36:39]
  s_mov_b32 s34, 1290240
  v_mfma_f32_16x16x32_bf16 v[56:59], a[228:231], a[112:115], v[56:59]
  s_mov_b32 s35, 0x20000
  v_mfma_f32_16x16x32_bf16 v[76:79], a[228:231], a[116:119], v[76:79]
  buffer_load_dwordx4 a[104:107], v225, s[28:31], s55 offen sc1
  s_waitcnt vmcnt(11)
  v_mfma_f32_16x16x32_bf16 v[0:3], a[232:235], a[120:123], v[0:3]
  s_lshl_b32 s52, s57, 2
  s_waitcnt vmcnt(10)
  v_mfma_f32_16x16x32_bf16 v[20:23], a[232:235], a[124:127], v[20:23]
  s_add_u32 s52, s52, s3
  s_waitcnt vmcnt(9)
  v_mfma_f32_16x16x32_bf16 v[40:43], a[232:235], v[112:115], v[40:43]
  s_lshl_b32 s52, s52, 16
  s_waitcnt vmcnt(8)
  v_mfma_f32_16x16x32_bf16 v[60:63], a[232:235], v[116:119], v[60:63]
  s_add_u32 s52, s52, 102760448
  v_mfma_f32_16x16x32_bf16 v[4:7], a[236:239], a[120:123], v[4:7]
  s_add_u32 s55, s101, 20480
  buffer_load_dwordx4 a[108:111], v225, s[16:19], s55 offen sc1
  v_mfma_f32_16x16x32_bf16 v[24:27], a[236:239], a[124:127], v[24:27]
  s_add_u32 s96, s4, s52
  s_addc_u32 s97, s5, 0
  v_mfma_f32_16x16x32_bf16 v[44:47], a[236:239], v[112:115], v[44:47]
  s_mov_b32 s98, 65536
  v_mfma_f32_16x16x32_bf16 v[64:67], a[236:239], v[116:119], v[64:67]
  s_mov_b32 s99, 0x20000
  v_mfma_f32_16x16x32_bf16 v[8:11], a[240:243], a[120:123], v[8:11]
  s_add_u32 s40, s3, 0
  v_mfma_f32_16x16x32_bf16 v[28:31], a[240:243], a[124:127], v[28:31]
  buffer_load_dwordx4 a[112:115], v225, s[20:23], s55 offen sc1
  v_mfma_f32_16x16x32_bf16 v[48:51], a[240:243], v[112:115], v[48:51]
  s_and_b32 s40, s40, 3
  v_mfma_f32_16x16x32_bf16 v[68:71], a[240:243], v[116:119], v[68:71]
  s_lshl_b32 s40, s40, 10
  v_mfma_f32_16x16x32_bf16 v[12:15], a[244:247], a[120:123], v[12:15]
  s_add_u32 s41, s3, 1
  v_mfma_f32_16x16x32_bf16 v[32:35], a[244:247], a[124:127], v[32:35]
  s_and_b32 s41, s41, 3
  v_mfma_f32_16x16x32_bf16 v[52:55], a[244:247], v[112:115], v[52:55]
  buffer_load_dwordx4 a[116:119], v225, s[24:27], s55 offen sc1
  v_mfma_f32_16x16x32_bf16 v[72:75], a[244:247], v[116:119], v[72:75]
  s_lshl_b32 s41, s41, 10
  v_mfma_f32_16x16x32_bf16 v[16:19], a[248:251], a[120:123], v[16:19]
  s_add_u32 s42, s3, 2
  v_mfma_f32_16x16x32_bf16 v[36:39], a[248:251], a[124:127], v[36:39]
  s_and_b32 s42, s42, 3
  v_mfma_f32_16x16x32_bf16 v[56:59], a[248:251], v[112:115], v[56:59]
  s_lshl_b32 s42, s42, 10
  v_mfma_f32_16x16x32_bf16 v[76:79], a[248:251], v[116:119], v[76:79]
  buffer_load_dwordx4 a[120:123], v225, s[28:31], s55 offen sc1
  ds_read_b128 a[124:127], v253 offset:0
  ds_read_b128 v[196:199], v253 offset:1024
  ds_read_b128 v[200:203], v253 offset:2048
  ds_read_b128 v[204:207], v253 offset:3072
  ds_read_b128 v[208:211], v253 offset:4096
  s_waitcnt vmcnt(11)
  v_mfma_f32_16x16x32_bf16 v[0:3], a[252:255], v[120:123], v[0:3]
  s_add_u32 s43, s3, 3
  s_waitcnt vmcnt(10)
  v_mfma_f32_16x16x32_bf16 v[20:23], a[252:255], v[124:127], v[20:23]
  s_and_b32 s43, s43, 3
  s_waitcnt vmcnt(9)
  v_mfma_f32_16x16x32_bf16 v[40:43], a[252:255], v[192:195], v[40:43]
  s_lshl_b32 s43, s43, 10
  s_waitcnt vmcnt(8)
  v_mfma_f32_16x16x32_bf16 v[60:63], a[252:255], a[88:91], v[60:63]
  s_add_u32 s48, s4, 100663296
  s_addc_u32 s49, s5, 0
  v_mfma_f32_16x16x32_bf16 v[4:7], a[0:3], v[120:123], v[4:7]
  v_mfma_f32_16x16x32_bf16 v[24:27], a[0:3], v[124:127], v[24:27]
  s_mov_b32 s50, 1048576
  v_mfma_f32_16x16x32_bf16 v[44:47], a[0:3], v[192:195], v[44:47]
  s_mov_b32 s51, 0x20000
  v_mfma_f32_16x16x32_bf16 v[64:67], a[0:3], a[88:91], v[64:67]
  s_lshl_b32 s52, s57, 2
  v_mfma_f32_16x16x32_bf16 v[8:11], a[4:7], v[120:123], v[8:11]
  s_add_u32 s52, s52, s3
  v_mfma_f32_16x16x32_bf16 v[28:31], a[4:7], v[124:127], v[28:31]
  v_mfma_f32_16x16x32_bf16 v[48:51], a[4:7], v[192:195], v[48:51]
  s_lshl_b32 s52, s52, 2
  v_mfma_f32_16x16x32_bf16 v[68:71], a[4:7], a[88:91], v[68:71]
  s_lshr_b32 s53, s58, 1
  v_mfma_f32_16x16x32_bf16 v[12:15], a[32:35], v[120:123], v[12:15]
  s_add_u32 s52, s52, s53
  v_mfma_f32_16x16x32_bf16 v[32:35], a[32:35], v[124:127], v[32:35]
  s_mul_i32 s52, s52, 5120
  v_mfma_f32_16x16x32_bf16 v[52:55], a[32:35], v[192:195], v[52:55]
  v_mfma_f32_16x16x32_bf16 v[72:75], a[32:35], a[88:91], v[72:75]
  s_and_b32 s53, s58, 1
  v_mfma_f32_16x16x32_bf16 v[16:19], a[36:39], v[120:123], v[16:19]
  s_mul_i32 s53, s53, 2048
  v_mfma_f32_16x16x32_bf16 v[36:39], a[36:39], v[124:127], v[36:39]
  s_add_u32 s52, s52, s53
  v_mfma_f32_16x16x32_bf16 v[56:59], a[36:39], v[192:195], v[56:59]
  s_add_u32 s52, s52, 4194304
  v_mfma_f32_16x16x32_bf16 v[76:79], a[36:39], a[88:91], v[76:79]
  s_add_u32 s55, s101, 24576
  buffer_load_dwordx4 a[88:91], v225, s[16:19], s55 offen sc1
  s_waitcnt lgkmcnt(4)
  s_waitcnt vmcnt(8)
  v_mfma_f32_16x16x32_bf16 v[0:3], a[124:127], a[92:95], v[0:3]
  s_sub_u32 s53, 5120, s53
  s_waitcnt vmcnt(7)
  v_mfma_f32_16x16x32_bf16 v[20:23], a[124:127], a[96:99], v[20:23]
  s_add_u32 s36, s4, s52
  s_addc_u32 s37, s5, 0
  s_waitcnt vmcnt(6)
  v_mfma_f32_16x16x32_bf16 v[40:43], a[124:127], a[100:103], v[40:43]
  s_mov_b32 s38, s53
  s_waitcnt vmcnt(5)
  v_mfma_f32_16x16x32_bf16 v[60:63], a[124:127], a[104:107], v[60:63]
  s_mov_b32 s39, 0x20000
  s_waitcnt lgkmcnt(3)
  v_mfma_f32_16x16x32_bf16 v[4:7], v[196:199], a[92:95], v[4:7]
  buffer_load_dwordx4 a[124:127], v225, s[20:23], s55 offen sc1
  v_mfma_f32_16x16x32_bf16 v[24:27], v[196:199], a[96:99], v[24:27]
  s_and_b32 s52, s58, 1
  v_mfma_f32_16x16x32_bf16 v[44:47], v[196:199], a[100:103], v[44:47]
  s_lshl_b32 s52, s52, 9
  v_mfma_f32_16x16x32_bf16 v[64:67], v[196:199], a[104:107], v[64:67]
  s_add_u32 s52, s52, s53
  s_waitcnt lgkmcnt(2)
  v_mfma_f32_16x16x32_bf16 v[8:11], v[200:203], a[92:95], v[8:11]
  s_sub_u32 s52, s52, 1024
  v_mfma_f32_16x16x32_bf16 v[28:31], v[200:203], a[96:99], v[28:31]
  buffer_load_dwordx4 v[212:215], v225, s[24:27], s55 offen sc1
  v_mfma_f32_16x16x32_bf16 v[48:51], v[200:203], a[100:103], v[48:51]
  v_and_b32 v111, 0x1f0, v225
  v_mfma_f32_16x16x32_bf16 v[68:71], v[200:203], a[104:107], v[68:71]
  v_add_u32 v111, s52, v111
  s_waitcnt lgkmcnt(1)
  v_mfma_f32_16x16x32_bf16 v[12:15], v[204:207], a[92:95], v[12:15]
  s_lshl_b32 s52, s57, 2
  v_mfma_f32_16x16x32_bf16 v[32:35], v[204:207], a[96:99], v[32:35]
  s_add_u32 s52, s52, s3
  v_mfma_f32_16x16x32_bf16 v[52:55], v[204:207], a[100:103], v[52:55]
  buffer_load_dwordx4 v[216:219], v225, s[28:31], s55 offen sc1
  v_mfma_f32_16x16x32_bf16 v[72:75], v[204:207], a[104:107], v[72:75]
  s_lshl_b32 s52, s52, 10
  s_waitcnt lgkmcnt(0)
  v_mfma_f32_16x16x32_bf16 v[16:19], v[208:211], a[92:95], v[16:19]
  s_add_u32 s52, s52, 65536
  v_mfma_f32_16x16x32_bf16 v[36:39], v[208:211], a[96:99], v[36:39]
  s_add_u32 s44, s4, s52
  s_addc_u32 s45, s5, 0
  v_mfma_f32_16x16x32_bf16 v[56:59], v[208:211], a[100:103], v[56:59]
  s_mov_b32 s46, 1024
  v_mfma_f32_16x16x32_bf16 v[76:79], v[208:211], a[104:107], v[76:79]
  s_add_u32 s55, s101, 28672
  buffer_load_dwordx4 a[92:95], v225, s[16:19], s55 offen sc1
  s_waitcnt vmcnt(8)
  v_mfma_f32_16x16x32_bf16 v[0:3], a[8:11], a[108:111], v[0:3]
  s_mov_b32 s47, 0x20000
  s_waitcnt vmcnt(7)
  v_mfma_f32_16x16x32_bf16 v[20:23], a[8:11], a[112:115], v[20:23]
  s_lshl_b32 s52, s58, 5
  s_waitcnt vmcnt(6)
  v_mfma_f32_16x16x32_bf16 v[40:43], a[8:11], a[116:119], v[40:43]
  s_and_b32 s53, s57, 30
  s_waitcnt vmcnt(5)
  v_mfma_f32_16x16x32_bf16 v[60:63], a[8:11], a[120:123], v[60:63]
  s_add_u32 s52, s52, s53
  v_mfma_f32_16x16x32_bf16 v[4:7], a[12:15], a[108:111], v[4:7]
  buffer_load_dwordx4 a[96:99], v225, s[20:23], s55 offen sc1
  v_mfma_f32_16x16x32_bf16 v[24:27], a[12:15], a[112:115], v[24:27]
  s_lshl_b32 s52, s52, 2
  v_mfma_f32_16x16x32_bf16 v[44:47], a[12:15], a[116:119], v[44:47]
  s_add_u32 s52, s52, s3
  v_mfma_f32_16x16x32_bf16 v[64:67], a[12:15], a[120:123], v[64:67]
  s_mul_i32 s52, s52, 5120
  v_mfma_f32_16x16x32_bf16 v[8:11], a[40:43], a[108:111], v[8:11]
  s_add_u32 s52, s52, 33554432
  v_mfma_f32_16x16x32_bf16 v[28:31], a[40:43], a[112:115], v[28:31]
  buffer_load_dwordx4 a[100:103], v225, s[24:27], s55 offen sc1
  v_mfma_f32_16x16x32_bf16 v[48:51], a[40:43], a[116:119], v[48:51]
  s_add_u32 s12, s4, s52
  s_addc_u32 s13, s5, 0
  v_mfma_f32_16x16x32_bf16 v[68:71], a[40:43], a[120:123], v[68:71]
  s_mov_b32 s14, 25600
  v_mfma_f32_16x16x32_bf16 v[12:15], a[44:47], a[108:111], v[12:15]
  s_mov_b32 s15, 0x20000
  v_mfma_f32_16x16x32_bf16 v[32:35], a[44:47], a[112:115], v[32:35]
  s_and_b32 s60, s57, 1
  v_mfma_f32_16x16x32_bf16 v[52:55], a[44:47], a[116:119], v[52:55]
  buffer_load_dwordx4 a[104:107], v225, s[28:31], s55 offen sc1
  v_mfma_f32_16x16x32_bf16 v[72:75], a[44:47], a[120:123], v[72:75]
  s_mul_i32 s60, s60, 20480
  v_mfma_f32_16x16x32_bf16 v[16:19], a[16:19], a[108:111], v[16:19]
  s_sub_u32 s73, 20480, s60
  v_mfma_f32_16x16x32_bf16 v[36:39], a[16:19], a[112:115], v[36:39]
  v_and_b32 v251, 15, v224
  v_mfma_f32_16x16x32_bf16 v[56:59], a[16:19], a[116:119], v[56:59]
  v_lshrrev_b32 v252, 5, v224
  v_mfma_f32_16x16x32_bf16 v[76:79], a[16:19], a[120:123], v[76:79]
  s_add_u32 s55, s101, 32768
  buffer_load_dwordx4 a[108:111], v225, s[16:19], s55 offen sc1
  s_waitcnt vmcnt(8)
  v_mfma_f32_16x16x32_bf16 v[0:3], a[20:23], a[88:91], v[0:3]
  v_lshlrev_b32 v251, 2, v251
  s_waitcnt vmcnt(7)
  v_mfma_f32_16x16x32_bf16 v[20:23], a[20:23], a[124:127], v[20:23]
  v_lshl_add_u32 v251, v252, 6, v251
  s_waitcnt vmcnt(6)
  v_mfma_f32_16x16x32_bf16 v[40:43], a[20:23], v[212:215], v[40:43]
  s_lshl_b32 s61, s58, 7
  s_waitcnt vmcnt(5)
  v_mfma_f32_16x16x32_bf16 v[60:63], a[20:23], v[216:219], v[60:63]
  v_mfma_f32_16x16x32_bf16 v[4:7], a[48:51], a[88:91], v[4:7]
  buffer_load_dwordx4 a[112:115], v225, s[20:23], s55 offen sc1
  v_mfma_f32_16x16x32_bf16 v[24:27], a[48:51], a[124:127], v[24:27]
  v_mfma_f32_16x16x32_bf16 v[44:47], a[48:51], v[212:215], v[44:47]
  v_mfma_f32_16x16x32_bf16 v[64:67], a[48:51], v[216:219], v[64:67]
  v_mfma_f32_16x16x32_bf16 v[8:11], a[52:55], a[88:91], v[8:11]
  v_mfma_f32_16x16x32_bf16 v[28:31], a[52:55], a[124:127], v[28:31]
  buffer_load_dwordx4 a[116:119], v225, s[24:27], s55 offen sc1
  v_mfma_f32_16x16x32_bf16 v[48:51], a[52:55], v[212:215], v[48:51]
  v_mfma_f32_16x16x32_bf16 v[68:71], a[52:55], v[216:219], v[68:71]
  v_mfma_f32_16x16x32_bf16 v[12:15], a[24:27], a[88:91], v[12:15]
  v_mfma_f32_16x16x32_bf16 v[32:35], a[24:27], a[124:127], v[32:35]
  v_mfma_f32_16x16x32_bf16 v[52:55], a[24:27], v[212:215], v[52:55]
  buffer_load_dwordx4 a[120:123], v225, s[28:31], s55 offen sc1
  v_mfma_f32_16x16x32_bf16 v[72:75], a[24:27], v[216:219], v[72:75]
  v_mfma_f32_16x16x32_bf16 v[16:19], a[28:31], a[88:91], v[16:19]
  v_mfma_f32_16x16x32_bf16 v[36:39], a[28:31], a[124:127], v[36:39]
  v_mfma_f32_16x16x32_bf16 v[56:59], a[28:31], v[212:215], v[56:59]
  v_mfma_f32_16x16x32_bf16 v[76:79], a[28:31], v[216:219], v[76:79]
  s_add_u32 s55, s101, 36864
  buffer_load_dwordx4 a[88:91], v225, s[16:19], s55 offen sc1
  ds_read_b128 a[124:127], v253 offset:5120
  ds_read_b128 v[220:223], v253 offset:6144
  ds_read_b128 v[112:115], v253 offset:7168
  ds_read_b128 v[116:119], v253 offset:8192
  ds_read_b128 v[120:123], v253 offset:9216
  s_waitcnt vmcnt(8)
  v_mfma_f32_16x16x32_bf16 v[0:3], a[56:59], a[92:95], v[0:3]
  s_waitcnt vmcnt(7)
  v_mfma_f32_16x16x32_bf16 v[20:23], a[56:59], a[96:99], v[20:23]
  s_waitcnt vmcnt(6)
  v_mfma_f32_16x16x32_bf16 v[40:43], a[56:59], a[100:103], v[40:43]
  s_waitcnt vmcnt(5)
  v_mfma_f32_16x16x32_bf16 v[60:63], a[56:59], a[104:107], v[60:63]
  buffer_load_dwordx4 v[124:127], v225, s[20:23], s55 offen sc1
  v_mfma_f32_16x16x32_bf16 v[4:7], a[60:63], a[92:95], v[4:7]
  v_mfma_f32_16x16x32_bf16 v[24:27], a[60:63], a[96:99], v[24:27]
  v_mfma_f32_16x16x32_bf16 v[44:47], a[60:63], a[100:103], v[44:47]
  v_mfma_f32_16x16x32_bf16 v[64:67], a[60:63], a[104:107], v[64:67]
  buffer_load_dwordx4 v[192:195], v225, s[24:27], s55 offen sc1
  v_mfma_f32_16x16x32_bf16 v[8:11], v[128:131], a[92:95], v[8:11]
  v_mfma_f32_16x16x32_bf16 v[28:31], v[128:131], a[96:99], v[28:31]
  v_mfma_f32_16x16x32_bf16 v[48:51], v[128:131], a[100:103], v[48:51]
  v_mfma_f32_16x16x32_bf16 v[68:71], v[128:131], a[104:107], v[68:71]
  buffer_load_dwordx4 v[196:199], v225, s[28:31], s55 offen sc1
  v_mfma_f32_16x16x32_bf16 v[12:15], v[132:135], a[92:95], v[12:15]
  v_mfma_f32_16x16x32_bf16 v[32:35], v[132:135], a[96:99], v[32:35]
  v_mfma_f32_16x16x32_bf16 v[52:55], v[132:135], a[100:103], v[52:55]
  v_mfma_f32_16x16x32_bf16 v[72:75], v[132:135], a[104:107], v[72:75]
  s_add_u32 s55, s101, 40960
  buffer_load_dwordx4 v[200:203], v225, s[16:19], s55 offen sc1
  v_mfma_f32_16x16x32_bf16 v[16:19], v[136:139], a[92:95], v[16:19]
  v_mfma_f32_16x16x32_bf16 v[36:39], v[136:139], a[96:99], v[36:39]
  v_mfma_f32_16x16x32_bf16 v[56:59], v[136:139], a[100:103], v[56:59]
  v_mfma_f32_16x16x32_bf16 v[76:79], v[136:139], a[104:107], v[76:79]
  buffer_load_dwordx4 a[92:95], v225, s[20:23], s55 offen sc1
  s_waitcnt lgkmcnt(4)
  s_waitcnt vmcnt(9)
  v_mfma_f32_16x16x32_bf16 v[0:3], a[124:127], a[108:111], v[0:3]
  s_waitcnt vmcnt(8)
  v_mfma_f32_16x16x32_bf16 v[20:23], a[124:127], a[112:115], v[20:23]
  s_waitcnt vmcnt(7)
  v_mfma_f32_16x16x32_bf16 v[40:43], a[124:127], a[116:119], v[40:43]
  s_waitcnt vmcnt(6)
  v_mfma_f32_16x16x32_bf16 v[60:63], a[124:127], a[120:123], v[60:63]
  buffer_load_dwordx4 a[96:99], v225, s[24:27], s55 offen sc1
  s_waitcnt lgkmcnt(3)
  v_mfma_f32_16x16x32_bf16 v[4:7], v[220:223], a[108:111], v[4:7]
  v_mfma_f32_16x16x32_bf16 v[24:27], v[220:223], a[112:115], v[24:27]
  v_mfma_f32_16x16x32_bf16 v[44:47], v[220:223], a[116:119], v[44:47]
  v_mfma_f32_16x16x32_bf16 v[64:67], v[220:223], a[120:123], v[64:67]
  buffer_load_dwordx4 a[100:103], v225, s[28:31], s55 offen sc1
  s_waitcnt lgkmcnt(2)
  v_mfma_f32_16x16x32_bf16 v[8:11], v[112:115], a[108:111], v[8:11]
  v_mfma_f32_16x16x32_bf16 v[28:31], v[112:115], a[112:115], v[28:31]
  v_mfma_f32_16x16x32_bf16 v[48:51], v[112:115], a[116:119], v[48:51]
  v_mfma_f32_16x16x32_bf16 v[68:71], v[112:115], a[120:123], v[68:71]
  s_add_u32 s55, s101, 45056
  buffer_load_dwordx4 a[104:107], v225, s[16:19], s55 offen sc1
  s_waitcnt lgkmcnt(1)
  v_mfma_f32_16x16x32_bf16 v[12:15], v[116:119], a[108:111], v[12:15]
  v_mfma_f32_16x16x32_bf16 v[32:35], v[116:119], a[112:115], v[32:35]
  v_mfma_f32_16x16x32_bf16 v[52:55], v[116:119], a[116:119], v[52:55]
  v_mfma_f32_16x16x32_bf16 v[72:75], v[116:119], a[120:123], v[72:75]
  buffer_load_dwordx4 a[124:127], v225, s[20:23], s55 offen sc1
  s_waitcnt lgkmcnt(0)
  v_mfma_f32_16x16x32_bf16 v[16:19], v[120:123], a[108:111], v[16:19]
  v_mfma_f32_16x16x32_bf16 v[36:39], v[120:123], a[112:115], v[36:39]
  v_mfma_f32_16x16x32_bf16 v[56:59], v[120:123], a[116:119], v[56:59]
  v_mfma_f32_16x16x32_bf16 v[76:79], v[120:123], a[120:123], v[76:79]
  buffer_load_dwordx4 a[108:111], v225, s[24:27], s55 offen sc1
  s_waitcnt vmcnt(10)
  v_mfma_f32_16x16x32_bf16 v[0:3], v[140:143], a[88:91], v[0:3]
  s_waitcnt vmcnt(9)
  v_mfma_f32_16x16x32_bf16 v[20:23], v[140:143], v[124:127], v[20:23]
  s_waitcnt vmcnt(8)
  v_mfma_f32_16x16x32_bf16 v[40:43], v[140:143], v[192:195], v[40:43]
  s_waitcnt vmcnt(7)
  v_mfma_f32_16x16x32_bf16 v[60:63], v[140:143], v[196:199], v[60:63]
  buffer_load_dwordx4 a[112:115], v225, s[28:31], s55 offen sc1
  v_mfma_f32_16x16x32_bf16 v[4:7], v[144:147], a[88:91], v[4:7]
  v_mfma_f32_16x16x32_bf16 v[24:27], v[144:147], v[124:127], v[24:27]
  v_mfma_f32_16x16x32_bf16 v[44:47], v[144:147], v[192:195], v[44:47]
  v_mfma_f32_16x16x32_bf16 v[64:67], v[144:147], v[196:199], v[64:67]
  s_add_u32 s55, s101, 49152
  buffer_load_dwordx4 a[116:119], v225, s[20:23], s55 offen sc1
  v_mfma_f32_16x16x32_bf16 v[8:11], v[148:151], a[88:91], v[8:11]
  v_mfma_f32_16x16x32_bf16 v[28:31], v[148:151], v[124:127], v[28:31]
  v_mfma_f32_16x16x32_bf16 v[48:51], v[148:151], v[192:195], v[48:51]
  v_mfma_f32_16x16x32_bf16 v[68:71], v[148:151], v[196:199], v[68:71]
  s_add_u32 s55, s101, 53248
  buffer_load_dwordx4 a[120:123], v225, s[20:23], s55 offen sc1
  v_mfma_f32_16x16x32_bf16 v[12:15], v[152:155], a[88:91], v[12:15]
  v_mfma_f32_16x16x32_bf16 v[32:35], v[152:155], v[124:127], v[32:35]
  v_mfma_f32_16x16x32_bf16 v[52:55], v[152:155], v[192:195], v[52:55]
  v_mfma_f32_16x16x32_bf16 v[72:75], v[152:155], v[196:199], v[72:75]
  s_add_u32 s55, s101, 57344
  buffer_load_dwordx4 v[204:207], v225, s[20:23], s55 offen sc1
  v_mfma_f32_16x16x32_bf16 v[16:19], v[156:159], a[88:91], v[16:19]
  v_mfma_f32_16x16x32_bf16 v[36:39], v[156:159], v[124:127], v[36:39]
  v_mfma_f32_16x16x32_bf16 v[56:59], v[156:159], v[192:195], v[56:59]
  v_mfma_f32_16x16x32_bf16 v[76:79], v[156:159], v[196:199], v[76:79]
  s_add_u32 s55, s101, 61440
  buffer_load_dwordx4 a[88:91], v225, s[20:23], s55 offen sc1
  s_waitcnt vmcnt(11)
  v_mfma_f32_16x16x32_bf16 v[0:3], v[160:163], v[200:203], v[0:3]
  s_waitcnt vmcnt(10)
  v_mfma_f32_16x16x32_bf16 v[20:23], v[160:163], a[92:95], v[20:23]
  s_waitcnt vmcnt(9)
  v_mfma_f32_16x16x32_bf16 v[40:43], v[160:163], a[96:99], v[40:43]
  s_waitcnt vmcnt(8)
  v_mfma_f32_16x16x32_bf16 v[60:63], v[160:163], a[100:103], v[60:63]
  s_add_u32 s55, s101, 49152
  buffer_load_dwordx4 v[208:211], v225, s[24:27], s55 offen sc1
  v_mfma_f32_16x16x32_bf16 v[4:7], v[164:167], v[200:203], v[4:7]
  v_mfma_f32_16x16x32_bf16 v[24:27], v[164:167], a[92:95], v[24:27]
  v_mfma_f32_16x16x32_bf16 v[44:47], v[164:167], a[96:99], v[44:47]
  v_mfma_f32_16x16x32_bf16 v[64:67], v[164:167], a[100:103], v[64:67]
  s_add_u32 s55, s101, 53248
  buffer_load_dwordx4 v[212:215], v225, s[24:27], s55 offen sc1
  v_mfma_f32_16x16x32_bf16 v[8:11], v[168:171], v[200:203], v[8:11]
  v_mfma_f32_16x16x32_bf16 v[28:31], v[168:171], a[92:95], v[28:31]
  v_mfma_f32_16x16x32_bf16 v[48:51], v[168:171], a[96:99], v[48:51]
  v_mfma_f32_16x16x32_bf16 v[68:71], v[168:171], a[100:103], v[68:71]
  s_add_u32 s55, s101, 57344
  buffer_load_dwordx4 v[216:219], v225, s[24:27], s55 offen sc1
  v_mfma_f32_16x16x32_bf16 v[12:15], v[172:175], v[200:203], v[12:15]
  v_mfma_f32_16x16x32_bf16 v[32:35], v[172:175], a[92:95], v[32:35]
  v_mfma_f32_16x16x32_bf16 v[52:55], v[172:175], a[96:99], v[52:55]
  v_mfma_f32_16x16x32_bf16 v[72:75], v[172:175], a[100:103], v[72:75]
  s_add_u32 s55, s101, 61440
  buffer_load_dwordx4 v[220:223], v225, s[24:27], s55 offen sc1
  v_mfma_f32_16x16x32_bf16 v[16:19], v[176:179], v[200:203], v[16:19]
  v_mfma_f32_16x16x32_bf16 v[36:39], v[176:179], a[92:95], v[36:39]
  v_mfma_f32_16x16x32_bf16 v[56:59], v[176:179], a[96:99], v[56:59]
  v_mfma_f32_16x16x32_bf16 v[76:79], v[176:179], a[100:103], v[76:79]
  s_add_u32 s55, s101, 49152
  buffer_load_dwordx4 a[92:95], v225, s[28:31], s55 offen sc1
  s_waitcnt vmcnt(12)
  v_mfma_f32_16x16x32_bf16 v[0:3], v[180:183], a[104:107], v[0:3]
  s_waitcnt vmcnt(11)
  v_mfma_f32_16x16x32_bf16 v[20:23], v[180:183], a[124:127], v[20:23]
  s_waitcnt vmcnt(10)
  v_mfma_f32_16x16x32_bf16 v[40:43], v[180:183], a[108:111], v[40:43]
  s_waitcnt vmcnt(9)
  v_mfma_f32_16x16x32_bf16 v[60:63], v[180:183], a[112:115], v[60:63]
  s_add_u32 s55, s101, 53248
  buffer_load_dwordx4 a[96:99], v225, s[28:31], s55 offen sc1
  v_mfma_f32_16x16x32_bf16 v[4:7], v[184:187], a[104:107], v[4:7]
  v_mfma_f32_16x16x32_bf16 v[24:27], v[184:187], a[124:127], v[24:27]
  v_mfma_f32_16x16x32_bf16 v[44:47], v[184:187], a[108:111], v[44:47]
  v_mfma_f32_16x16x32_bf16 v[64:67], v[184:187], a[112:115], v[64:67]
  s_add_u32 s55, s101, 57344
  buffer_load_dwordx4 a[100:103], v225, s[28:31], s55 offen sc1
  v_mfma_f32_16x16x32_bf16 v[8:11], v[188:191], a[104:107], v[8:11]
  v_mfma_f32_16x16x32_bf16 v[28:31], v[188:191], a[124:127], v[28:31]
  v_mfma_f32_16x16x32_bf16 v[48:51], v[188:191], a[108:111], v[48:51]
  v_mfma_f32_16x16x32_bf16 v[68:71], v[188:191], a[112:115], v[68:71]
  s_add_u32 s55, s101, 61440
  buffer_load_dwordx4 v[112:115], v225, s[28:31], s55 offen sc1
  v_mfma_f32_16x16x32_bf16 v[12:15], a[128:131], a[104:107], v[12:15]
  v_mfma_f32_16x16x32_bf16 v[32:35], a[128:131], a[124:127], v[32:35]
  v_mfma_f32_16x16x32_bf16 v[52:55], a[128:131], a[108:111], v[52:55]
  v_mfma_f32_16x16x32_bf16 v[72:75], a[128:131], a[112:115], v[72:75]
  s_add_u32 s55, s101, 49152
  buffer_load_dwordx4 v[116:119], v225, s[16:19], s55 offen sc1
  v_mfma_f32_16x16x32_bf16 v[16:19], a[132:135], a[104:107], v[16:19]
  v_mfma_f32_16x16x32_bf16 v[36:39], a[132:135], a[124:127], v[36:39]
  v_mfma_f32_16x16x32_bf16 v[56:59], a[132:135], a[108:111], v[56:59]
  v_mfma_f32_16x16x32_bf16 v[76:79], a[132:135], a[112:115], v[76:79]
  s_add_u32 s55, s101, 53248
  buffer_load_dwordx4 a[104:107], v225, s[16:19], s55 offen sc1
  s_waitcnt vmcnt(13)
  v_mfma_f32_16x16x32_bf16 v[20:23], a[136:139], a[116:119], v[20:23]
  v_mfma_f32_16x16x32_bf16 v[24:27], a[140:143], a[116:119], v[24:27]
  v_mfma_f32_16x16x32_bf16 v[28:31], a[144:147], a[116:119], v[28:31]
  v_mfma_f32_16x16x32_bf16 v[32:35], a[148:151], a[116:119], v[32:35]
  s_add_u32 s55, s101, 57344
  buffer_load_dwordx4 a[124:127], v225, s[16:19], s55 offen sc1
  v_mfma_f32_16x16x32_bf16 v[36:39], a[152:155], a[116:119], v[36:39]
  s_waitcnt vmcnt(13)
  v_mfma_f32_16x16x32_bf16 v[20:23], a[156:159], a[120:123], v[20:23]
  v_mfma_f32_16x16x32_bf16 v[24:27], a[160:163], a[120:123], v[24:27]
  v_mfma_f32_16x16x32_bf16 v[28:31], a[164:167], a[120:123], v[28:31]
  s_add_u32 s55, s101, 61440
  buffer_load_dwordx4 a[108:111], v225, s[16:19], s55 offen sc1
  v_mfma_f32_16x16x32_bf16 v[32:35], a[168:171], a[120:123], v[32:35]
  v_mfma_f32_16x16x32_bf16 v[36:39], a[172:175], a[120:123], v[36:39]
  s_waitcnt vmcnt(13)
  v_mfma_f32_16x16x32_bf16 v[20:23], a[176:179], v[204:207], v[20:23]
  v_mfma_f32_16x16x32_bf16 v[24:27], a[180:183], v[204:207], v[24:27]
  s_add_u32 s55, s56, 0
  buffer_load_dwordx4 a[112:115], v225, s[16:19], s55 offen sc1
  v_mfma_f32_16x16x32_bf16 v[28:31], a[184:187], v[204:207], v[28:31]
  v_mfma_f32_16x16x32_bf16 v[32:35], a[188:191], v[204:207], v[32:35]
  v_mfma_f32_16x16x32_bf16 v[36:39], a[64:67], v[204:207], v[36:39]
  s_waitcnt vmcnt(13)
  v_mfma_f32_16x16x32_bf16 v[20:23], a[68:71], a[88:91], v[20:23]
  buffer_load_dwordx4 a[116:119], v225, s[20:23], s55 offen sc1
  v_mfma_f32_16x16x32_bf16 v[24:27], a[72:75], a[88:91], v[24:27]
  v_mfma_f32_16x16x32_bf16 v[28:31], a[76:79], a[88:91], v[28:31]
  v_mfma_f32_16x16x32_bf16 v[32:35], a[80:83], a[88:91], v[32:35]
  v_mfma_f32_16x16x32_bf16 v[36:39], a[84:87], a[88:91], v[36:39]
  buffer_load_dwordx4 a[120:123], v225, s[24:27], s55 offen sc1
  s_waitcnt vmcnt(14)
  v_mfma_f32_16x16x32_bf16 v[40:43], a[136:139], v[208:211], v[40:43]
  s_waitcnt vmcnt(13)
  v_mfma_f32_16x16x32_bf16 v[40:43], a[156:159], v[212:215], v[40:43]
  s_waitcnt vmcnt(12)
  v_mfma_f32_16x16x32_bf16 v[40:43], a[176:179], v[216:219], v[40:43]
  s_waitcnt vmcnt(11)
  v_mfma_f32_16x16x32_bf16 v[40:43], a[68:71], v[220:223], v[40:43]
  buffer_load_dwordx4 a[88:91], v225, s[28:31], s55 offen sc1
  v_mfma_f32_16x16x32_bf16 v[44:47], a[140:143], v[208:211], v[44:47]
  ds_write_b128 v241, v[20:23] offset:0
  v_mfma_f32_16x16x32_bf16 v[44:47], a[160:163], v[212:215], v[44:47]
  v_mfma_f32_16x16x32_bf16 v[44:47], a[180:183], v[216:219], v[44:47]
  ds_write_b128 v241, v[24:27] offset:1024
  v_mfma_f32_16x16x32_bf16 v[44:47], a[72:75], v[220:223], v[44:47]
  s_add_u32 s55, s56, 4096
  buffer_load_dwordx4 v[120:123], v225, s[16:19], s55 offen sc1
  v_mfma_f32_16x16x32_bf16 v[48:51], a[144:147], v[208:211], v[48:51]
  v_mfma_f32_16x16x32_bf16 v[48:51], a[164:167], v[212:215], v[48:51]
  ds_write_b128 v241, v[28:31] offset:2048
  v_mfma_f32_16x16x32_bf16 v[48:51], a[184:187], v[216:219], v[48:51]
  v_mfma_f32_16x16x32_bf16 v[48:51], a[76:79], v[220:223], v[48:51]
  ds_write_b128 v241, v[32:35] offset:3072
  v_mfma_f32_16x16x32_bf16 v[52:55], a[148:151], v[208:211], v[52:55]
  buffer_load_dwordx4 v[124:127], v225, s[20:23], s55 offen sc1
  v_mfma_f32_16x16x32_bf16 v[52:55], a[168:171], v[212:215], v[52:55]
  ds_write_b128 v241, v[36:39] offset:4096
  v_mfma_f32_16x16x32_bf16 v[52:55], a[188:191], v[216:219], v[52:55]
  v_mfma_f32_16x16x32_bf16 v[52:55], a[80:83], v[220:223], v[52:55]
  buffer_load_dwordx4 v[192:195], v225, s[24:27], s55 offen sc1
  v_mfma_f32_16x16x32_bf16 v[56:59], a[152:155], v[208:211], v[56:59]
  v_mfma_f32_16x16x32_bf16 v[56:59], a[172:175], v[212:215], v[56:59]
  v_mfma_f32_16x16x32_bf16 v[56:59], a[64:67], v[216:219], v[56:59]
  v_mfma_f32_16x16x32_bf16 v[56:59], a[84:87], v[220:223], v[56:59]
  buffer_load_dwordx4 v[196:199], v225, s[28:31], s55 offen sc1
  s_waitcnt vmcnt(15)
  v_mfma_f32_16x16x32_bf16 v[60:63], a[136:139], a[92:95], v[60:63]
  s_waitcnt vmcnt(14)
  v_mfma_f32_16x16x32_bf16 v[60:63], a[156:159], a[96:99], v[60:63]
  s_waitcnt vmcnt(13)
  v_mfma_f32_16x16x32_bf16 v[60:63], a[176:179], a[100:103], v[60:63]
  s_waitcnt vmcnt(12)
  v_mfma_f32_16x16x32_bf16 v[60:63], a[68:71], v[112:115], v[60:63]
  s_add_u32 s55, s56, 8192
  buffer_load_dwordx4 v[200:203], v225, s[16:19], s55 offen sc1
  v_mfma_f32_16x16x32_bf16 v[64:67], a[140:143], a[92:95], v[64:67]
  ds_write_b128 v242, v[40:43] offset:5120
  v_mfma_f32_16x16x32_bf16 v[64:67], a[160:163], a[96:99], v[64:67]
  v_mfma_f32_16x16x32_bf16 v[64:67], a[180:183], a[100:103], v[64:67]
  ds_write_b128 v242, v[44:47] offset:6144
  v_mfma_f32_16x16x32_bf16 v[64:67], a[72:75], v[112:115], v[64:67]
  buffer_load_dwordx4 v[204:207], v225, s[20:23], s55 offen sc1
  v_mfma_f32_16x16x32_bf16 v[68:71], a[144:147], a[92:95], v[68:71]
  v_mfma_f32_16x16x32_bf16 v[68:71], a[164:167], a[96:99], v[68:71]
  ds_write_b128 v242, v[48:51] offset:7168
  v_mfma_f32_16x16x32_bf16 v[68:71], a[184:187], a[100:103], v[68:71]
  v_mfma_f32_16x16x32_bf16 v[68:71], a[76:79], v[112:115], v[68:71]
  ds_write_b128 v242, v[52:55] offset:8192
  v_mfma_f32_16x16x32_bf16 v[72:75], a[148:151], a[92:95], v[72:75]
  buffer_load_dwordx4 v[208:211], v225, s[24:27], s55 offen sc1
  v_mfma_f32_16x16x32_bf16 v[72:75], a[168:171], a[96:99], v[72:75]
  ds_write_b128 v242, v[56:59] offset:9216
  v_mfma_f32_16x16x32_bf16 v[72:75], a[188:191], a[100:103], v[72:75]
  v_mfma_f32_16x16x32_bf16 v[72:75], a[80:83], v[112:115], v[72:75]
  buffer_load_dwordx4 v[212:215], v225, s[28:31], s55 offen sc1
  v_mfma_f32_16x16x32_bf16 v[76:79], a[152:155], a[92:95], v[76:79]
  v_mfma_f32_16x16x32_bf16 v[76:79], a[172:175], a[96:99], v[76:79]
  v_mfma_f32_16x16x32_bf16 v[76:79], a[64:67], a[100:103], v[76:79]
  v_mfma_f32_16x16x32_bf16 v[76:79], a[84:87], v[112:115], v[76:79]
  s_add_u32 s55, s56, 12288
  buffer_load_dwordx4 a[92:95], v225, s[16:19], s55 offen sc1
  s_waitcnt vmcnt(16)
  v_mfma_f32_16x16x32_bf16 v[0:3], a[136:139], v[116:119], v[0:3]
  s_waitcnt vmcnt(15)
  v_mfma_f32_16x16x32_bf16 v[0:3], a[156:159], a[104:107], v[0:3]
  s_waitcnt vmcnt(14)
  v_mfma_f32_16x16x32_bf16 v[0:3], a[176:179], a[124:127], v[0:3]
  s_waitcnt lgkmcnt(0)
  s_barrier
  s_waitcnt vmcnt(13)
  v_mfma_f32_16x16x32_bf16 v[0:3], a[68:71], a[108:111], v[0:3]
  ds_write_b128 v243, v[60:63] offset:10240
  v_mfma_f32_16x16x32_bf16 v[4:7], a[140:143], v[116:119], v[4:7]
  ds_write_b128 v243, v[64:67] offset:11264
  v_mfma_f32_16x16x32_bf16 v[4:7], a[160:163], a[104:107], v[4:7]
  ds_write_b128 v243, v[68:71] offset:12288
  v_mfma_f32_16x16x32_bf16 v[4:7], a[180:183], a[124:127], v[4:7]
  ds_write_b128 v243, v[72:75] offset:13312
  v_mfma_f32_16x16x32_bf16 v[4:7], a[72:75], a[108:111], v[4:7]
  ds_write_b128 v243, v[76:79] offset:14336
  v_mfma_f32_16x16x32_bf16 v[8:11], a[144:147], v[116:119], v[8:11]
  ds_read_b128 v[20:23], v240 offset:0
  v_mfma_f32_16x16x32_bf16 v[8:11], a[164:167], a[104:107], v[8:11]
  ds_read_b128 v[24:27], v240 offset:1024
  v_mfma_f32_16x16x32_bf16 v[8:11], a[184:187], a[124:127], v[8:11]
  buffer_load_dwordx4 a[96:99], v225, s[20:23], s55 offen sc1
  v_mfma_f32_16x16x32_bf16 v[8:11], a[76:79], a[108:111], v[8:11]
  ds_read_b128 v[28:31], v240 offset:2048
  v_mfma_f32_16x16x32_bf16 v[12:15], a[148:151], v[116:119], v[12:15]
  ds_read_b128 v[32:35], v240 offset:3072
  v_mfma_f32_16x16x32_bf16 v[12:15], a[168:171], a[104:107], v[12:15]
  ds_read_b128 v[36:39], v240 offset:4096
  v_mfma_f32_16x16x32_bf16 v[12:15], a[188:191], a[124:127], v[12:15]
  ds_read_b128 v[40:43], v240 offset:5120
  v_mfma_f32_16x16x32_bf16 v[12:15], a[80:83], a[108:111], v[12:15]
  ds_read_b128 v[44:47], v240 offset:6144
  v_mfma_f32_16x16x32_bf16 v[16:19], a[152:155], v[116:119], v[16:19]
  ds_read_b128 v[48:51], v240 offset:7168
  v_mfma_f32_16x16x32_bf16 v[16:19], a[172:175], a[104:107], v[16:19]
  ds_read_b128 v[52:55], v240 offset:8192
  v_mfma_f32_16x16x32_bf16 v[16:19], a[64:67], a[124:127], v[16:19]
  ds_read_b128 v[56:59], v240 offset:9216
  v_mfma_f32_16x16x32_bf16 v[16:19], a[84:87], a[108:111], v[16:19]
  buffer_load_dwordx4 a[100:103], v225, s[24:27], s55 offen sc1
  s_waitcnt lgkmcnt(0)
  s_barrier
  ds_read_b128 v[60:63], v240 offset:10240
  ds_read_b128 v[64:67], v240 offset:11264
  ds_read_b128 v[68:71], v240 offset:12288
  ds_read_b128 v[72:75], v240 offset:13312
  ds_read_b128 v[76:79], v240 offset:14336
  v_pk_add_f32 v[0:1], v[0:1], v[20:21]
  v_pk_add_f32 v[2:3], v[2:3], v[22:23]
  v_pk_add_f32 v[4:5], v[4:5], v[24:25]
  v_pk_add_f32 v[6:7], v[6:7], v[26:27]
  v_pk_add_f32 v[8:9], v[8:9], v[28:29]
  buffer_load_dwordx4 a[104:107], v225, s[28:31], s55 offen sc1
  v_pk_add_f32 v[10:11], v[10:11], v[30:31]
  v_pk_add_f32 v[12:13], v[12:13], v[32:33]
  v_pk_add_f32 v[14:15], v[14:15], v[34:35]
  v_pk_add_f32 v[16:17], v[16:17], v[36:37]
  v_pk_add_f32 v[18:19], v[18:19], v[38:39]
  v_pk_add_f32 v[0:1], v[0:1], v[40:41]
  v_pk_add_f32 v[2:3], v[2:3], v[42:43]
  v_pk_add_f32 v[4:5], v[4:5], v[44:45]
  v_pk_add_f32 v[6:7], v[6:7], v[46:47]
  v_pk_add_f32 v[8:9], v[8:9], v[48:49]
  v_pk_add_f32 v[10:11], v[10:11], v[50:51]
  v_pk_add_f32 v[12:13], v[12:13], v[52:53]
  s_add_u32 s55, s56, 16384
  buffer_load_dwordx4 a[124:127], v225, s[16:19], s55 offen sc1
  v_pk_add_f32 v[14:15], v[14:15], v[54:55]
  v_pk_add_f32 v[16:17], v[16:17], v[56:57]
  v_pk_add_f32 v[18:19], v[18:19], v[58:59]
  s_waitcnt lgkmcnt(0)
  v_pk_add_f32 v[0:1], v[0:1], v[60:61]
  v_pk_add_f32 v[2:3], v[2:3], v[62:63]
  v_pk_add_f32 v[4:5], v[4:5], v[64:65]
  v_pk_add_f32 v[6:7], v[6:7], v[66:67]
  v_pk_add_f32 v[8:9], v[8:9], v[68:69]
  v_pk_add_f32 v[10:11], v[10:11], v[70:71]
  v_pk_add_f32 v[12:13], v[12:13], v[72:73]
  v_pk_add_f32 v[14:15], v[14:15], v[74:75]
  buffer_load_dwordx4 a[108:111], v225, s[20:23], s55 offen sc1
  v_pk_add_f32 v[16:17], v[16:17], v[76:77]
  v_pk_add_f32 v[18:19], v[18:19], v[78:79]
  s_cmp_ge_u32 s100, 14
  s_cbranch_scc1 L_adaL_nouv_74
  s_cmp_lg_u32 s3, 1
  s_cbranch_scc1 L_adaL_nouv_74
  v_and_b32 v20, 15, v224
  v_bfe_u32 v21, v224, 4, 1
  v_lshlrev_b32 v22, 3, v20
  v_lshl_add_u32 v22, v21, 2, v22
  v_add_u32 v22, 159744, v22
  ds_read_b32 v24, v22 offset:0
  ds_read_b32 v25, v22 offset:1024
  ds_read_b32 v26, v22 offset:2048
  ds_read_b32 v27, v22 offset:3072
  s_lshl_b32 s52, s72, 6
  s_add_u32 s52, s52, 16384
  v_mul_u32_u24 v21, 7168, v21
  v_lshl_add_u32 v20, v20, 2, v21
  v_add_u32 v20, s52, v20
  s_waitcnt lgkmcnt(0)
  v_add_f32 v24, v24, v25
  v_add_f32 v26, v26, v27
  v_add_f32 v24, v24, v26
  s_mov_b32 exec_hi, 0
  global_store_dword v20, v24, s[4:5] sc1
  s_mov_b64 exec, -1
L_adaL_nouv_74:
  buffer_store_dwordx4 v[0:3], v225, s[12:15], s73 offen offset:0 sc1
  buffer_store_dwordx4 v[4:7], v225, s[12:15], s73 offen offset:1024 sc1
  buffer_store_dwordx4 v[8:11], v225, s[12:15], s73 offen offset:2048 sc1
  buffer_store_dwordx4 v[12:15], v225, s[12:15], s73 offen offset:3072 sc1
  buffer_store_dwordx4 v[16:19], v226, s[12:15], s73 offen offset:0 sc1
  s_waitcnt vmcnt(22)
  v_mfma_f32_16x16x32_bf16 v[0:3], a[192:195], a[112:115], 0
  s_waitcnt vmcnt(21)
  v_mfma_f32_16x16x32_bf16 v[20:23], a[192:195], a[116:119], 0
  s_waitcnt vmcnt(20)
  v_mfma_f32_16x16x32_bf16 v[40:43], a[192:195], a[120:123], 0
  s_waitcnt vmcnt(19)
  v_mfma_f32_16x16x32_bf16 v[60:63], a[192:195], a[88:91], 0
  v_mfma_f32_16x16x32_bf16 v[4:7], a[196:199], a[112:115], 0
  buffer_load_dwordx4 a[192:195], v225, s[24:27], s55 offen sc1
  v_mfma_f32_16x16x32_bf16 v[24:27], a[196:199], a[116:119], 0
  v_mfma_f32_16x16x32_bf16 v[44:47], a[196:199], a[120:123], 0
  v_mfma_f32_16x16x32_bf16 v[64:67], a[196:199], a[88:91], 0
  v_mfma_f32_16x16x32_bf16 v[8:11], a[200:203], a[112:115], 0
  v_mfma_f32_16x16x32_bf16 v[28:31], a[200:203], a[116:119], 0
  buffer_load_dwordx4 a[196:199], v225, s[28:31], s55 offen sc1
  v_mfma_f32_16x16x32_bf16 v[48:51], a[200:203], a[120:123], 0
  v_mfma_f32_16x16x32_bf16 v[68:71], a[200:203], a[88:91], 0
  v_mfma_f32_16x16x32_bf16 v[12:15], a[204:207], a[112:115], 0
  v_mfma_f32_16x16x32_bf16 v[32:35], a[204:207], a[116:119], 0
  v_mfma_f32_16x16x32_bf16 v[52:55], a[204:207], a[120:123], 0
  s_add_u32 s55, s56, 20480
  buffer_load_dwordx4 a[200:203], v225, s[16:19], s55 offen sc1
  v_mfma_f32_16x16x32_bf16 v[72:75], a[204:207], a[88:91], 0
  v_mfma_f32_16x16x32_bf16 v[16:19], a[208:211], a[112:115], 0
  v_mfma_f32_16x16x32_bf16 v[36:39], a[208:211], a[116:119], 0
  v_mfma_f32_16x16x32_bf16 v[56:59], a[208:211], a[120:123], 0
  v_mfma_f32_16x16x32_bf16 v[76:79], a[208:211], a[88:91], 0
  buffer_load_dwordx4 a[204:207], v225, s[20:23], s55 offen sc1
  s_waitcnt vmcnt(22)
  v_mfma_f32_16x16x32_bf16 v[0:3], a[212:215], v[120:123], v[0:3]
  s_waitcnt vmcnt(21)
  v_mfma_f32_16x16x32_bf16 v[20:23], a[212:215], v[124:127], v[20:23]
  s_waitcnt vmcnt(20)
  v_mfma_f32_16x16x32_bf16 v[40:43], a[212:215], v[192:195], v[40:43]
  s_waitcnt vmcnt(19)
  v_mfma_f32_16x16x32_bf16 v[60:63], a[212:215], v[196:199], v[60:63]
  v_mfma_f32_16x16x32_bf16 v[4:7], a[216:219], v[120:123], v[4:7]
  buffer_load_dwordx4 a[112:115], v225, s[24:27], s55 offen sc1
  v_mfma_f32_16x16x32_bf16 v[24:27], a[216:219], v[124:127], v[24:27]
  v_mfma_f32_16x16x32_bf16 v[44:47], a[216:219], v[192:195], v[44:47]
  v_mfma_f32_16x16x32_bf16 v[64:67], a[216:219], v[196:199], v[64:67]
  v_mfma_f32_16x16x32_bf16 v[8:11], a[220:223], v[120:123], v[8:11]
  v_mfma_f32_16x16x32_bf16 v[28:31], a[220:223], v[124:127], v[28:31]
  buffer_load_dwordx4 a[116:119], v225, s[28:31], s55 offen sc1
  v_mfma_f32_16x16x32_bf16 v[48:51], a[220:223], v[192:195], v[48:51]
  v_mfma_f32_16x16x32_bf16 v[68:71], a[220:223], v[196:199], v[68:71]
  v_mfma_f32_16x16x32_bf16 v[12:15], a[224:227], v[120:123], v[12:15]
  v_mfma_f32_16x16x32_bf16 v[32:35], a[224:227], v[124:127], v[32:35]
  v_mfma_f32_16x16x32_bf16 v[52:55], a[224:227], v[192:195], v[52:55]
  s_add_u32 s55, s56, 24576
  buffer_load_dwordx4 a[120:123], v225, s[16:19], s55 offen sc1
  v_mfma_f32_16x16x32_bf16 v[72:75], a[224:227], v[196:199], v[72:75]
  v_mfma_f32_16x16x32_bf16 v[16:19], a[228:231], v[120:123], v[16:19]
  v_mfma_f32_16x16x32_bf16 v[36:39], a[228:231], v[124:127], v[36:39]
  v_mfma_f32_16x16x32_bf16 v[56:59], a[228:231], v[192:195], v[56:59]
  v_mfma_f32_16x16x32_bf16 v[76:79], a[228:231], v[196:199], v[76:79]
  buffer_load_dwordx4 a[88:91], v225, s[20:23], s55 offen sc1
  s_waitcnt vmcnt(22)
  v_mfma_f32_16x16x32_bf16 v[0:3], a[232:235], v[200:203], v[0:3]
  s_waitcnt vmcnt(21)
  v_mfma_f32_16x16x32_bf16 v[20:23], a[232:235], v[204:207], v[20:23]
  s_waitcnt vmcnt(20)
  v_mfma_f32_16x16x32_bf16 v[40:43], a[232:235], v[208:211], v[40:43]
  s_waitcnt vmcnt(19)
  v_mfma_f32_16x16x32_bf16 v[60:63], a[232:235], v[212:215], v[60:63]
  v_mfma_f32_16x16x32_bf16 v[4:7], a[236:239], v[200:203], v[4:7]
  buffer_load_dwordx4 a[208:211], v225, s[24:27], s55 offen sc1
  v_mfma_f32_16x16x32_bf16 v[24:27], a[236:239], v[204:207], v[24:27]
  v_mfma_f32_16x16x32_bf16 v[44:47], a[236:239], v[208:211], v[44:47]
  v_mfma_f32_16x16x32_bf16 v[64:67], a[236:239], v[212:215], v[64:67]
  v_mfma_f32_16x16x32_bf16 v[8:11], a[240:243], v[200:203], v[8:11]
  v_mfma_f32_16x16x32_bf16 v[28:31], a[240:243], v[204:207], v[28:31]
  buffer_load_dwordx4 a[212:215], v225, s[28:31], s55 offen sc1
  v_mfma_f32_16x16x32_bf16 v[48:51], a[240:243], v[208:211], v[48:51]
  v_mfma_f32_16x16x32_bf16 v[68:71], a[240:243], v[212:215], v[68:71]
  v_mfma_f32_16x16x32_bf16 v[12:15], a[244:247], v[200:203], v[12:15]
  v_mfma_f32_16x16x32_bf16 v[32:35], a[244:247], v[204:207], v[32:35]
  v_mfma_f32_16x16x32_bf16 v[52:55], a[244:247], v[208:211], v[52:55]
  s_add_u32 s55, s56, 28672
  buffer_load_dwordx4 a[216:219], v225, s[16:19], s55 offen sc1
  v_mfma_f32_16x16x32_bf16 v[72:75], a[244:247], v[212:215], v[72:75]
  v_mfma_f32_16x16x32_bf16 v[16:19], a[248:251], v[200:203], v[16:19]
  v_mfma_f32_16x16x32_bf16 v[36:39], a[248:251], v[204:207], v[36:39]
  v_mfma_f32_16x16x32_bf16 v[56:59], a[248:251], v[208:211], v[56:59]
  v_mfma_f32_16x16x32_bf16 v[76:79], a[248:251], v[212:215], v[76:79]
  buffer_load_dwordx4 a[220:223], v225, s[20:23], s55 offen sc1
  ds_read_b128 a[224:227], v253 offset:0
  ds_read_b128 a[228:231], v253 offset:1024
  ds_read_b128 a[232:235], v253 offset:2048
  ds_read_b128 a[236:239], v253 offset:3072
  ds_read_b128 a[240:243], v253 offset:4096
  s_waitcnt vmcnt(12)
  s_cmp_lg_u32 s3, 1
  s_cbranch_scc1 L_adaL_nopush_75
  s_cmp_ge_u32 s100, 14
  s_cbranch_scc1 L_adaL_nopush_75
  s_lshl_b32 s52, s58, 15
  s_lshl_b32 s53, s57, 2
  s_add_u32 s52, s52, s53
  s_add_u32 s52, s52, 128
  v_lshlrev_b32 v248, 10, v224
  s_mov_b32 exec_hi, 0
  v_mov_b32 v249, 1
  buffer_store_dword v249, v248, s[8:11], s52 offen sc1
  s_mov_b64 exec, -1
L_adaL_nopush_75:
  s_xor_b32 s52, s63, 1024
  s_lshl_b32 s53, s3, 2
  v_mov_b32 v249, s53
  v_mov_b32 v248, 1
  s_mov_b64 exec, 1
  buffer_store_dword v248, v249, s[8:11], s52 offen offset:640 sc1
  s_mov_b64 exec, -1
  s_barrier
  v_mfma_f32_16x16x32_bf16 v[0:3], a[252:255], a[92:95], v[0:3]
  v_mfma_f32_16x16x32_bf16 v[20:23], a[252:255], a[96:99], v[20:23]
  v_mfma_f32_16x16x32_bf16 v[40:43], a[252:255], a[100:103], v[40:43]
  v_mfma_f32_16x16x32_bf16 v[60:63], a[252:255], a[104:107], v[60:63]
  v_mfma_f32_16x16x32_bf16 v[4:7], a[0:3], a[92:95], v[4:7]
  buffer_load_dwordx4 a[244:247], v225, s[24:27], s55 offen sc1
  v_mfma_f32_16x16x32_bf16 v[24:27], a[0:3], a[96:99], v[24:27]
  v_mfma_f32_16x16x32_bf16 v[44:47], a[0:3], a[100:103], v[44:47]
  v_mfma_f32_16x16x32_bf16 v[64:67], a[0:3], a[104:107], v[64:67]
  v_mfma_f32_16x16x32_bf16 v[8:11], a[4:7], a[92:95], v[8:11]
  v_mfma_f32_16x16x32_bf16 v[28:31], a[4:7], a[96:99], v[28:31]
  buffer_load_dwordx4 a[248:251], v225, s[28:31], s55 offen sc1
  v_mfma_f32_16x16x32_bf16 v[48:51], a[4:7], a[100:103], v[48:51]
  v_mfma_f32_16x16x32_bf16 v[68:71], a[4:7], a[104:107], v[68:71]
  v_mfma_f32_16x16x32_bf16 v[12:15], a[32:35], a[92:95], v[12:15]
  v_mfma_f32_16x16x32_bf16 v[32:35], a[32:35], a[96:99], v[32:35]
  v_mfma_f32_16x16x32_bf16 v[52:55], a[32:35], a[100:103], v[52:55]
  s_add_u32 s55, s56, 32768
  buffer_load_dwordx4 a[252:255], v225, s[16:19], s55 offen sc1
  v_mfma_f32_16x16x32_bf16 v[72:75], a[32:35], a[104:107], v[72:75]
  v_mfma_f32_16x16x32_bf16 v[16:19], a[36:39], a[92:95], v[16:19]
  v_mfma_f32_16x16x32_bf16 v[36:39], a[36:39], a[96:99], v[36:39]
  v_mfma_f32_16x16x32_bf16 v[56:59], a[36:39], a[100:103], v[56:59]
  v_mfma_f32_16x16x32_bf16 v[76:79], a[36:39], a[104:107], v[76:79]
  buffer_load_dwordx4 a[0:3], v225, s[20:23], s55 offen sc1
  s_waitcnt lgkmcnt(4)
  v_mfma_f32_16x16x32_bf16 v[0:3], a[224:227], a[124:127], v[0:3]
  v_mfma_f32_16x16x32_bf16 v[20:23], a[224:227], a[108:111], v[20:23]
  s_waitcnt vmcnt(16)
  v_mfma_f32_16x16x32_bf16 v[40:43], a[224:227], a[192:195], v[40:43]
  s_waitcnt vmcnt(15)
  v_mfma_f32_16x16x32_bf16 v[60:63], a[224:227], a[196:199], v[60:63]
  s_waitcnt lgkmcnt(3)
  v_mfma_f32_16x16x32_bf16 v[4:7], a[228:231], a[124:127], v[4:7]
  buffer_load_dwordx4 a[4:7], v225, s[24:27], s55 offen sc1
  v_mfma_f32_16x16x32_bf16 v[24:27], a[228:231], a[108:111], v[24:27]
  v_mfma_f32_16x16x32_bf16 v[44:47], a[228:231], a[192:195], v[44:47]
  v_mfma_f32_16x16x32_bf16 v[64:67], a[228:231], a[196:199], v[64:67]
  s_waitcnt lgkmcnt(2)
  v_mfma_f32_16x16x32_bf16 v[8:11], a[232:235], a[124:127], v[8:11]
  v_mfma_f32_16x16x32_bf16 v[28:31], a[232:235], a[108:111], v[28:31]
  buffer_load_dwordx4 a[32:35], v225, s[28:31], s55 offen sc1
  v_mfma_f32_16x16x32_bf16 v[48:51], a[232:235], a[192:195], v[48:51]
  v_mfma_f32_16x16x32_bf16 v[68:71], a[232:235], a[196:199], v[68:71]
  s_waitcnt lgkmcnt(1)
  v_mfma_f32_16x16x32_bf16 v[12:15], a[236:239], a[124:127], v[12:15]
  v_mfma_f32_16x16x32_bf16 v[32:35], a[236:239], a[108:111], v[32:35]
  v_mfma_f32_16x16x32_bf16 v[52:55], a[236:239], a[192:195], v[52:55]
  s_add_u32 s55, s56, 36864
  buffer_load_dwordx4 a[92:95], v225, s[16:19], s55 offen sc1
  v_mfma_f32_16x16x32_bf16 v[72:75], a[236:239], a[196:199], v[72:75]
  s_waitcnt lgkmcnt(0)
  v_mfma_f32_16x16x32_bf16 v[16:19], a[240:243], a[124:127], v[16:19]
  v_mfma_f32_16x16x32_bf16 v[36:39], a[240:243], a[108:111], v[36:39]
  v_mfma_f32_16x16x32_bf16 v[56:59], a[240:243], a[192:195], v[56:59]
  v_mfma_f32_16x16x32_bf16 v[76:79], a[240:243], a[196:199], v[76:79]
  buffer_load_dwordx4 a[96:99], v225, s[20:23], s55 offen sc1
  s_waitcnt vmcnt(18)
  v_mfma_f32_16x16x32_bf16 v[0:3], a[8:11], a[200:203], v[0:3]
  s_waitcnt vmcnt(17)
  v_mfma_f32_16x16x32_bf16 v[20:23], a[8:11], a[204:207], v[20:23]
  s_waitcnt vmcnt(16)
  v_mfma_f32_16x16x32_bf16 v[40:43], a[8:11], a[112:115], v[40:43]
  s_waitcnt vmcnt(15)
  v_mfma_f32_16x16x32_bf16 v[60:63], a[8:11], a[116:119], v[60:63]
  v_mfma_f32_16x16x32_bf16 v[4:7], a[12:15], a[200:203], v[4:7]
  buffer_load_dwordx4 a[100:103], v225, s[24:27], s55 offen sc1
  v_mfma_f32_16x16x32_bf16 v[24:27], a[12:15], a[204:207], v[24:27]
  v_mfma_f32_16x16x32_bf16 v[44:47], a[12:15], a[112:115], v[44:47]
  v_mfma_f32_16x16x32_bf16 v[64:67], a[12:15], a[116:119], v[64:67]
  v_mfma_f32_16x16x32_bf16 v[8:11], a[40:43], a[200:203], v[8:11]
  v_mfma_f32_16x16x32_bf16 v[28:31], a[40:43], a[204:207], v[28:31]
  buffer_load_dwordx4 a[104:107], v225, s[28:31], s55 offen sc1
  v_mfma_f32_16x16x32_bf16 v[48:51], a[40:43], a[112:115], v[48:51]
  v_mfma_f32_16x16x32_bf16 v[68:71], a[40:43], a[116:119], v[68:71]
  v_mfma_f32_16x16x32_bf16 v[12:15], a[44:47], a[200:203], v[12:15]
  v_mfma_f32_16x16x32_bf16 v[32:35], a[44:47], a[204:207], v[32:35]
  v_mfma_f32_16x16x32_bf16 v[52:55], a[44:47], a[112:115], v[52:55]
  s_add_u32 s55, s56, 40960
  buffer_load_dwordx4 a[36:39], v225, s[16:19], s55 offen sc1
  v_mfma_f32_16x16x32_bf16 v[72:75], a[44:47], a[116:119], v[72:75]
  v_mfma_f32_16x16x32_bf16 v[16:19], a[16:19], a[200:203], v[16:19]
  v_mfma_f32_16x16x32_bf16 v[36:39], a[16:19], a[204:207], v[36:39]
  v_mfma_f32_16x16x32_bf16 v[56:59], a[16:19], a[112:115], v[56:59]
  v_mfma_f32_16x16x32_bf16 v[76:79], a[16:19], a[116:119], v[76:79]
  buffer_load_dwordx4 a[224:227], v225, s[20:23], s55 offen sc1
  ds_read_b64 v[100:101], v250 offset:0
  ds_read_b64 v[102:103], v250 offset:32
  ds_read_b64 v[104:105], v250 offset:64
  ds_read_b64 v[106:107], v250 offset:96
  ds_read_b64 v[108:109], v250 offset:128
  s_waitcnt vmcnt(18)
  v_mfma_f32_16x16x32_bf16 v[0:3], a[20:23], a[120:123], v[0:3]
  s_waitcnt vmcnt(17)
  v_mfma_f32_16x16x32_bf16 v[20:23], a[20:23], a[88:91], v[20:23]
  s_waitcnt vmcnt(16)
  v_mfma_f32_16x16x32_bf16 v[40:43], a[20:23], a[208:211], v[40:43]
  s_waitcnt vmcnt(15)
  v_mfma_f32_16x16x32_bf16 v[60:63], a[20:23], a[212:215], v[60:63]
  v_mfma_f32_16x16x32_bf16 v[4:7], a[48:51], a[120:123], v[4:7]
  buffer_load_dwordx4 a[228:231], v225, s[24:27], s55 offen sc1
  v_mfma_f32_16x16x32_bf16 v[24:27], a[48:51], a[88:91], v[24:27]
  v_mfma_f32_16x16x32_bf16 v[44:47], a[48:51], a[208:211], v[44:47]
  v_mfma_f32_16x16x32_bf16 v[64:67], a[48:51], a[212:215], v[64:67]
  v_mfma_f32_16x16x32_bf16 v[8:11], a[52:55], a[120:123], v[8:11]
  v_mfma_f32_16x16x32_bf16 v[28:31], a[52:55], a[88:91], v[28:31]
  buffer_load_dwordx4 a[232:235], v225, s[28:31], s55 offen sc1
  v_mfma_f32_16x16x32_bf16 v[48:51], a[52:55], a[208:211], v[48:51]
  v_mfma_f32_16x16x32_bf16 v[68:71], a[52:55], a[212:215], v[68:71]
  v_mfma_f32_16x16x32_bf16 v[12:15], a[24:27], a[120:123], v[12:15]
  v_mfma_f32_16x16x32_bf16 v[32:35], a[24:27], a[88:91], v[32:35]
  v_mfma_f32_16x16x32_bf16 v[52:55], a[24:27], a[208:211], v[52:55]
  s_add_u32 s55, s56, 45056
  buffer_load_dwordx4 a[236:239], v225, s[16:19], s55 offen sc1
  v_mfma_f32_16x16x32_bf16 v[72:75], a[24:27], a[212:215], v[72:75]
  v_mfma_f32_16x16x32_bf16 v[16:19], a[28:31], a[120:123], v[16:19]
  v_mfma_f32_16x16x32_bf16 v[36:39], a[28:31], a[88:91], v[36:39]
  v_mfma_f32_16x16x32_bf16 v[56:59], a[28:31], a[208:211], v[56:59]
  v_mfma_f32_16x16x32_bf16 v[76:79], a[28:31], a[212:215], v[76:79]
  buffer_load_dwordx4 a[124:127], v225, s[20:23], s55 offen sc1
  ds_read_b128 a[108:111], v253 offset:5120
  ds_read_b128 a[192:195], v253 offset:6144
  ds_read_b128 a[196:199], v253 offset:7168
  ds_read_b128 a[240:243], v253 offset:8192
  ds_read_b128 a[8:11], v253 offset:9216
  buffer_load_dword v248, v249, s[8:11], s63 offen offset:640 sc1
  s_waitcnt vmcnt(19)
  v_mfma_f32_16x16x32_bf16 v[0:3], a[56:59], a[216:219], v[0:3]
  s_waitcnt vmcnt(18)
  v_mfma_f32_16x16x32_bf16 v[20:23], a[56:59], a[220:223], v[20:23]
  s_waitcnt vmcnt(16)
  v_mfma_f32_16x16x32_bf16 v[40:43], a[56:59], a[244:247], v[40:43]
  s_waitcnt vmcnt(15)
  v_mfma_f32_16x16x32_bf16 v[60:63], a[56:59], a[248:251], v[60:63]
  v_mfma_f32_16x16x32_bf16 v[4:7], a[60:63], a[216:219], v[4:7]
  buffer_load_dwordx4 a[12:15], v225, s[24:27], s55 offen sc1
  v_mfma_f32_16x16x32_bf16 v[24:27], a[60:63], a[220:223], v[24:27]
  v_mfma_f32_16x16x32_bf16 v[44:47], a[60:63], a[244:247], v[44:47]
  v_mfma_f32_16x16x32_bf16 v[64:67], a[60:63], a[248:251], v[64:67]
  v_mfma_f32_16x16x32_bf16 v[8:11], v[128:131], a[216:219], v[8:11]
  v_mfma_f32_16x16x32_bf16 v[28:31], v[128:131], a[220:223], v[28:31]
  buffer_load_dwordx4 a[40:43], v225, s[28:31], s55 offen sc1
  v_mfma_f32_16x16x32_bf16 v[48:51], v[128:131], a[244:247], v[48:51]
  v_mfma_f32_16x16x32_bf16 v[68:71], v[128:131], a[248:251], v[68:71]
  v_mfma_f32_16x16x32_bf16 v[12:15], v[132:135], a[216:219], v[12:15]
  v_mfma_f32_16x16x32_bf16 v[32:35], v[132:135], a[220:223], v[32:35]
  v_mfma_f32_16x16x32_bf16 v[52:55], v[132:135], a[244:247], v[52:55]
  s_add_u32 s55, s56, 49152
  buffer_load_dwordx4 a[44:47], v225, s[20:23], s55 offen sc1
  v_mfma_f32_16x16x32_bf16 v[72:75], v[132:135], a[248:251], v[72:75]
  v_mfma_f32_16x16x32_bf16 v[16:19], v[136:139], a[216:219], v[16:19]
  v_mfma_f32_16x16x32_bf16 v[36:39], v[136:139], a[220:223], v[36:39]
  v_mfma_f32_16x16x32_bf16 v[56:59], v[136:139], a[244:247], v[56:59]
  v_mfma_f32_16x16x32_bf16 v[76:79], v[136:139], a[248:251], v[76:79]
  s_add_u32 s55, s56, 53248
  buffer_load_dwordx4 a[200:203], v225, s[20:23], s55 offen sc1
  ds_read_b64 v[80:81], v110 offset:0
  ds_read_b64 v[82:83], v110 offset:32
  ds_read_b64 v[84:85], v110 offset:64
  ds_read_b64 v[86:87], v110 offset:96
  ds_read_b64 v[88:89], v110 offset:128
  s_waitcnt lgkmcnt(9)
  s_waitcnt vmcnt(18)
  v_mfma_f32_16x16x32_bf16 v[0:3], a[108:111], a[252:255], v[0:3]
  s_waitcnt vmcnt(17)
  v_mfma_f32_16x16x32_bf16 v[20:23], a[108:111], a[0:3], v[20:23]
  s_waitcnt vmcnt(16)
  v_mfma_f32_16x16x32_bf16 v[40:43], a[108:111], a[4:7], v[40:43]
  s_waitcnt vmcnt(15)
  v_mfma_f32_16x16x32_bf16 v[60:63], a[108:111], a[32:35], v[60:63]
  s_waitcnt lgkmcnt(8)
  v_mfma_f32_16x16x32_bf16 v[4:7], a[192:195], a[252:255], v[4:7]
  s_add_u32 s55, s56, 57344
  buffer_load_dwordx4 a[204:207], v225, s[20:23], s55 offen sc1
  v_mfma_f32_16x16x32_bf16 v[24:27], a[192:195], a[0:3], v[24:27]
  v_mfma_f32_16x16x32_bf16 v[44:47], a[192:195], a[4:7], v[44:47]
  v_mfma_f32_16x16x32_bf16 v[64:67], a[192:195], a[32:35], v[64:67]
  s_waitcnt lgkmcnt(7)
  v_mfma_f32_16x16x32_bf16 v[8:11], a[196:199], a[252:255], v[8:11]
  v_mfma_f32_16x16x32_bf16 v[28:31], a[196:199], a[0:3], v[28:31]
  s_add_u32 s55, s56, 61440
  buffer_load_dwordx4 a[112:115], v225, s[20:23], s55 offen sc1
  v_mfma_f32_16x16x32_bf16 v[48:51], a[196:199], a[4:7], v[48:51]
  v_mfma_f32_16x16x32_bf16 v[68:71], a[196:199], a[32:35], v[68:71]
  s_waitcnt lgkmcnt(6)
  v_mfma_f32_16x16x32_bf16 v[12:15], a[240:243], a[252:255], v[12:15]
  v_mfma_f32_16x16x32_bf16 v[32:35], a[240:243], a[0:3], v[32:35]
  v_mfma_f32_16x16x32_bf16 v[52:55], a[240:243], a[4:7], v[52:55]
  s_add_u32 s55, s56, 49152
  buffer_load_dwordx4 a[116:119], v225, s[24:27], s55 offen sc1
  v_mfma_f32_16x16x32_bf16 v[72:75], a[240:243], a[32:35], v[72:75]
  s_waitcnt lgkmcnt(5)
  v_mfma_f32_16x16x32_bf16 v[16:19], a[8:11], a[252:255], v[16:19]
  v_mfma_f32_16x16x32_bf16 v[36:39], a[8:11], a[0:3], v[36:39]
  v_mfma_f32_16x16x32_bf16 v[56:59], a[8:11], a[4:7], v[56:59]
  v_mfma_f32_16x16x32_bf16 v[76:79], a[8:11], a[32:35], v[76:79]
  s_add_u32 s55, s56, 53248
  buffer_load_dwordx4 a[16:19], v225, s[24:27], s55 offen sc1
  ds_read_b64 v[90:91], v110 offset:512
  ds_read_b64 v[92:93], v110 offset:544
  ds_read_b64 v[94:95], v110 offset:576
  ds_read_b64 v[96:97], v110 offset:608
  ds_read_b64 v[98:99], v110 offset:640
  s_waitcnt vmcnt(18)
  v_mfma_f32_16x16x32_bf16 v[0:3], v[140:143], a[92:95], v[0:3]
  s_waitcnt vmcnt(17)
  v_mfma_f32_16x16x32_bf16 v[20:23], v[140:143], a[96:99], v[20:23]
  s_waitcnt vmcnt(16)
  v_mfma_f32_16x16x32_bf16 v[40:43], v[140:143], a[100:103], v[40:43]
  s_waitcnt vmcnt(15)
  v_mfma_f32_16x16x32_bf16 v[60:63], v[140:143], a[104:107], v[60:63]
  v_mfma_f32_16x16x32_bf16 v[4:7], v[144:147], a[92:95], v[4:7]
  s_add_u32 s55, s56, 57344
  buffer_load_dwordx4 a[20:23], v225, s[24:27], s55 offen sc1
  v_mfma_f32_16x16x32_bf16 v[24:27], v[144:147], a[96:99], v[24:27]
  v_mfma_f32_16x16x32_bf16 v[44:47], v[144:147], a[100:103], v[44:47]
  v_mfma_f32_16x16x32_bf16 v[64:67], v[144:147], a[104:107], v[64:67]
  v_mfma_f32_16x16x32_bf16 v[8:11], v[148:151], a[92:95], v[8:11]
  v_mfma_f32_16x16x32_bf16 v[28:31], v[148:151], a[96:99], v[28:31]
  s_add_u32 s55, s56, 61440
  buffer_load_dwordx4 a[48:51], v225, s[24:27], s55 offen sc1
  v_mfma_f32_16x16x32_bf16 v[48:51], v[148:151], a[100:103], v[48:51]
  v_mfma_f32_16x16x32_bf16 v[68:71], v[148:151], a[104:107], v[68:71]
  v_mfma_f32_16x16x32_bf16 v[12:15], v[152:155], a[92:95], v[12:15]
  v_mfma_f32_16x16x32_bf16 v[32:35], v[152:155], a[96:99], v[32:35]
  v_mfma_f32_16x16x32_bf16 v[52:55], v[152:155], a[100:103], v[52:55]
  s_add_u32 s55, s56, 49152
  buffer_load_dwordx4 a[52:55], v225, s[28:31], s55 offen sc1
  v_mfma_f32_16x16x32_bf16 v[72:75], v[152:155], a[104:107], v[72:75]
  v_mfma_f32_16x16x32_bf16 v[16:19], v[156:159], a[92:95], v[16:19]
  v_mfma_f32_16x16x32_bf16 v[36:39], v[156:159], a[96:99], v[36:39]
  v_mfma_f32_16x16x32_bf16 v[56:59], v[156:159], a[100:103], v[56:59]
  v_mfma_f32_16x16x32_bf16 v[76:79], v[156:159], a[104:107], v[76:79]
  s_add_u32 s55, s56, 53248
  buffer_load_dwordx4 a[24:27], v225, s[28:31], s55 offen sc1
  s_waitcnt vmcnt(12)
  v_cmp_gt_u32 vcc, 1, v248
  s_cbranch_vccz L_adaL_spok_77
  s_mov_b32 s59, 400000
L_adaL_sp_76:
  buffer_load_dword v248, v249, s[8:11], s63 offen offset:640 sc1
  s_sub_u32 s59, s59, 1
  s_cbranch_scc1 L_adaL_spok_77
  s_waitcnt vmcnt(0)
  v_cmp_gt_u32 vcc, 1, v248
  s_cbranch_vccnz L_adaL_sp_76
L_adaL_spok_77:
  v_mfma_f32_16x16x32_bf16 v[0:3], v[160:163], a[36:39], v[0:3]
  v_mfma_f32_16x16x32_bf16 v[20:23], v[160:163], a[224:227], v[20:23]
  v_mfma_f32_16x16x32_bf16 v[40:43], v[160:163], a[228:231], v[40:43]
  v_mfma_f32_16x16x32_bf16 v[60:63], v[160:163], a[232:235], v[60:63]
  v_mfma_f32_16x16x32_bf16 v[4:7], v[164:167], a[36:39], v[4:7]
  buffer_load_dwordx4 v[216:219], v225, s[12:15], s60 offen offset:0 sc1
  v_mfma_f32_16x16x32_bf16 v[24:27], v[164:167], a[224:227], v[24:27]
  v_mfma_f32_16x16x32_bf16 v[44:47], v[164:167], a[228:231], v[44:47]
  v_mfma_f32_16x16x32_bf16 v[64:67], v[164:167], a[232:235], v[64:67]
  v_mfma_f32_16x16x32_bf16 v[8:11], v[168:171], a[36:39], v[8:11]
  v_mfma_f32_16x16x32_bf16 v[28:31], v[168:171], a[224:227], v[28:31]
  buffer_load_dwordx4 v[220:223], v225, s[12:15], s60 offen offset:1024 sc1
  v_mfma_f32_16x16x32_bf16 v[48:51], v[168:171], a[228:231], v[48:51]
  v_mfma_f32_16x16x32_bf16 v[68:71], v[168:171], a[232:235], v[68:71]
  v_mfma_f32_16x16x32_bf16 v[12:15], v[172:175], a[36:39], v[12:15]
  v_mfma_f32_16x16x32_bf16 v[32:35], v[172:175], a[224:227], v[32:35]
  v_mfma_f32_16x16x32_bf16 v[52:55], v[172:175], a[228:231], v[52:55]
  buffer_load_dwordx4 v[112:115], v225, s[12:15], s60 offen offset:2048 sc1
  v_mfma_f32_16x16x32_bf16 v[72:75], v[172:175], a[232:235], v[72:75]
  v_mfma_f32_16x16x32_bf16 v[16:19], v[176:179], a[36:39], v[16:19]
  v_mfma_f32_16x16x32_bf16 v[36:39], v[176:179], a[224:227], v[36:39]
  v_mfma_f32_16x16x32_bf16 v[56:59], v[176:179], a[228:231], v[56:59]
  v_mfma_f32_16x16x32_bf16 v[76:79], v[176:179], a[232:235], v[76:79]
  buffer_load_dwordx4 v[116:119], v225, s[12:15], s60 offen offset:3072 sc1
  v_cmp_gt_u32 vcc, 0x100, v254
  s_cbranch_vccz L_adaL_spok_79
  s_mov_b32 s59, 400000
L_adaL_sp_78:
  global_load_dword v254, v255, s[64:65] offset:192 sc1
  s_sub_u32 s59, s59, 1
  s_cbranch_scc1 L_adaL_spok_79
  s_waitcnt vmcnt(0)
  v_cmp_gt_u32 vcc, 0x100, v254
  s_cbranch_vccnz L_adaL_sp_78
L_adaL_spok_79:
  v_mfma_f32_16x16x32_bf16 v[0:3], v[180:183], a[236:239], v[0:3]
  v_mfma_f32_16x16x32_bf16 v[20:23], v[180:183], a[124:127], v[20:23]
  s_waitcnt vmcnt(15)
  v_mfma_f32_16x16x32_bf16 v[40:43], v[180:183], a[12:15], v[40:43]
  s_waitcnt vmcnt(14)
  v_mfma_f32_16x16x32_bf16 v[60:63], v[180:183], a[40:43], v[60:63]
  v_mfma_f32_16x16x32_bf16 v[4:7], v[184:187], a[236:239], v[4:7]
  buffer_load_dwordx4 v[120:123], v226, s[12:15], s60 offen offset:0 sc1
  v_mfma_f32_16x16x32_bf16 v[24:27], v[184:187], a[124:127], v[24:27]
  v_mfma_f32_16x16x32_bf16 v[44:47], v[184:187], a[12:15], v[44:47]
  v_mfma_f32_16x16x32_bf16 v[64:67], v[184:187], a[40:43], v[64:67]
  v_mfma_f32_16x16x32_bf16 v[8:11], v[188:191], a[236:239], v[8:11]
  v_mfma_f32_16x16x32_bf16 v[28:31], v[188:191], a[124:127], v[28:31]
  s_add_u32 s55, s56, 57344
  buffer_load_dwordx4 a[120:123], v225, s[28:31], s55 offen sc1
  v_mfma_f32_16x16x32_bf16 v[48:51], v[188:191], a[12:15], v[48:51]
  v_mfma_f32_16x16x32_bf16 v[68:71], v[188:191], a[40:43], v[68:71]
  v_mfma_f32_16x16x32_bf16 v[12:15], a[128:131], a[236:239], v[12:15]
  v_mfma_f32_16x16x32_bf16 v[32:35], a[128:131], a[124:127], v[32:35]
  v_mfma_f32_16x16x32_bf16 v[52:55], a[128:131], a[12:15], v[52:55]
  s_add_u32 s55, s56, 61440
  buffer_load_dwordx4 a[88:91], v225, s[28:31], s55 offen sc1
  v_mfma_f32_16x16x32_bf16 v[72:75], a[128:131], a[40:43], v[72:75]
  v_mfma_f32_16x16x32_bf16 v[16:19], a[132:135], a[236:239], v[16:19]
  v_mfma_f32_16x16x32_bf16 v[36:39], a[132:135], a[124:127], v[36:39]
  v_mfma_f32_16x16x32_bf16 v[56:59], a[132:135], a[12:15], v[56:59]
  v_mfma_f32_16x16x32_bf16 v[76:79], a[132:135], a[40:43], v[76:79]
  s_add_u32 s55, s56, 49152
  buffer_load_dwordx4 a[208:211], v225, s[16:19], s55 offen sc1
  s_waitcnt vmcnt(17)
  v_mfma_f32_16x16x32_bf16 v[20:23], a[136:139], a[44:47], v[20:23]
  v_mfma_f32_16x16x32_bf16 v[24:27], a[140:143], a[44:47], v[24:27]
  v_mfma_f32_16x16x32_bf16 v[28:31], a[144:147], a[44:47], v[28:31]
  v_mfma_f32_16x16x32_bf16 v[32:35], a[148:151], a[44:47], v[32:35]
  v_mfma_f32_16x16x32_bf16 v[36:39], a[152:155], a[44:47], v[36:39]
  s_add_u32 s55, s56, 53248
  buffer_load_dwordx4 a[212:215], v225, s[16:19], s55 offen sc1
  s_waitcnt vmcnt(17)
  v_mfma_f32_16x16x32_bf16 v[20:23], a[156:159], a[200:203], v[20:23]
  v_mfma_f32_16x16x32_bf16 v[24:27], a[160:163], a[200:203], v[24:27]
  v_mfma_f32_16x16x32_bf16 v[28:31], a[164:167], a[200:203], v[28:31]
  v_mfma_f32_16x16x32_bf16 v[32:35], a[168:171], a[200:203], v[32:35]
  v_mfma_f32_16x16x32_bf16 v[36:39], a[172:175], a[200:203], v[36:39]
  s_add_u32 s55, s56, 57344
  buffer_load_dwordx4 a[28:31], v225, s[16:19], s55 offen sc1
  s_waitcnt vmcnt(17)
  v_mfma_f32_16x16x32_bf16 v[20:23], a[176:179], a[204:207], v[20:23]
  v_mfma_f32_16x16x32_bf16 v[24:27], a[180:183], a[204:207], v[24:27]
  v_mfma_f32_16x16x32_bf16 v[28:31], a[184:187], a[204:207], v[28:31]
  v_mfma_f32_16x16x32_bf16 v[32:35], a[188:191], a[204:207], v[32:35]
  v_mfma_f32_16x16x32_bf16 v[36:39], a[64:67], a[204:207], v[36:39]
  s_add_u32 s55, s56, 61440
  buffer_load_dwordx4 a[56:59], v225, s[16:19], s55 offen sc1
  s_waitcnt vmcnt(17)
  v_mfma_f32_16x16x32_bf16 v[20:23], a[68:71], a[112:115], v[20:23]
  v_mfma_f32_16x16x32_bf16 v[24:27], a[72:75], a[112:115], v[24:27]
  v_mfma_f32_16x16x32_bf16 v[28:31], a[76:79], a[112:115], v[28:31]
  v_mfma_f32_16x16x32_bf16 v[32:35], a[80:83], a[112:115], v[32:35]
  v_mfma_f32_16x16x32_bf16 v[36:39], a[84:87], a[112:115], v[36:39]
  s_mul_i32 s56, s3, 10240
  s_add_u32 m0, s56, 102400
  s_add_u32 s54, s56, 1249280
  buffer_load_dwordx4 v225, s[32:35], s54 offen sc1 lds
  s_waitcnt vmcnt(17)
  v_mfma_f32_16x16x32_bf16 v[40:43], a[136:139], a[116:119], v[40:43]
  s_waitcnt vmcnt(16)
  v_mfma_f32_16x16x32_bf16 v[40:43], a[156:159], a[16:19], v[40:43]
  s_waitcnt vmcnt(15)
  v_mfma_f32_16x16x32_bf16 v[40:43], a[176:179], a[20:23], v[40:43]
  s_waitcnt vmcnt(14)
  v_mfma_f32_16x16x32_bf16 v[40:43], a[68:71], a[48:51], v[40:43]
  v_mfma_f32_16x16x32_bf16 v[44:47], a[140:143], a[116:119], v[44:47]
  ds_write_b128 v241, v[20:23] offset:0
  v_mfma_f32_16x16x32_bf16 v[44:47], a[160:163], a[16:19], v[44:47]
  s_add_u32 m0, s56, 103424
  s_add_u32 s54, s56, 1250304
  buffer_load_dwordx4 v225, s[32:35], s54 offen sc1 lds
  v_mfma_f32_16x16x32_bf16 v[44:47], a[180:183], a[20:23], v[44:47]
  ds_write_b128 v241, v[24:27] offset:1024
  v_mfma_f32_16x16x32_bf16 v[44:47], a[72:75], a[48:51], v[44:47]
  v_mfma_f32_16x16x32_bf16 v[48:51], a[144:147], a[116:119], v[48:51]
  v_mfma_f32_16x16x32_bf16 v[48:51], a[164:167], a[16:19], v[48:51]
  ds_write_b128 v241, v[28:31] offset:2048
  v_mfma_f32_16x16x32_bf16 v[48:51], a[184:187], a[20:23], v[48:51]
  s_add_u32 m0, s56, 104448
  s_add_u32 s54, s56, 1251328
  buffer_load_dwordx4 v225, s[32:35], s54 offen sc1 lds
  v_mfma_f32_16x16x32_bf16 v[48:51], a[76:79], a[48:51], v[48:51]
  ds_write_b128 v241, v[32:35] offset:3072
  v_mfma_f32_16x16x32_bf16 v[52:55], a[148:151], a[116:119], v[52:55]
  v_mfma_f32_16x16x32_bf16 v[52:55], a[168:171], a[16:19], v[52:55]
  ds_write_b128 v241, v[36:39] offset:4096
  v_mfma_f32_16x16x32_bf16 v[52:55], a[188:191], a[20:23], v[52:55]
  s_add_u32 m0, s56, 105472
  s_add_u32 s54, s56, 1252352
  buffer_load_dwordx4 v225, s[32:35], s54 offen sc1 lds
  v_mfma_f32_16x16x32_bf16 v[52:55], a[80:83], a[48:51], v[52:55]
  v_mfma_f32_16x16x32_bf16 v[56:59], a[152:155], a[116:119], v[56:59]
  v_mfma_f32_16x16x32_bf16 v[56:59], a[172:175], a[16:19], v[56:59]
  v_mfma_f32_16x16x32_bf16 v[56:59], a[64:67], a[20:23], v[56:59]
  v_mfma_f32_16x16x32_bf16 v[56:59], a[84:87], a[48:51], v[56:59]
  s_add_u32 m0, s56, 106496
  s_add_u32 s54, s56, 1253376
  buffer_load_dwordx4 v225, s[32:35], s54 offen sc1 lds
  s_waitcnt vmcnt(17)
  v_mfma_f32_16x16x32_bf16 v[60:63], a[136:139], a[52:55], v[60:63]
  s_waitcnt vmcnt(16)
  v_mfma_f32_16x16x32_bf16 v[60:63], a[156:159], a[24:27], v[60:63]
  s_waitcnt vmcnt(10)
  v_mfma_f32_16x16x32_bf16 v[60:63], a[176:179], a[120:123], v[60:63]
  s_waitcnt vmcnt(9)
  v_mfma_f32_16x16x32_bf16 v[60:63], a[68:71], a[88:91], v[60:63]
  v_mfma_f32_16x16x32_bf16 v[64:67], a[140:143], a[52:55], v[64:67]
  ds_write_b128 v242, v[40:43] offset:5120
  v_mfma_f32_16x16x32_bf16 v[64:67], a[160:163], a[24:27], v[64:67]
  s_add_u32 m0, s56, 107520
  s_add_u32 s54, s56, 1254400
  buffer_load_dwordx4 v225, s[32:35], s54 offen sc1 lds
  v_mfma_f32_16x16x32_bf16 v[64:67], a[180:183], a[120:123], v[64:67]
  ds_write_b128 v242, v[44:47] offset:6144
  v_mfma_f32_16x16x32_bf16 v[64:67], a[72:75], a[88:91], v[64:67]
  v_mfma_f32_16x16x32_bf16 v[68:71], a[144:147], a[52:55], v[68:71]
  v_mfma_f32_16x16x32_bf16 v[68:71], a[164:167], a[24:27], v[68:71]
  ds_write_b128 v242, v[48:51] offset:7168
  v_mfma_f32_16x16x32_bf16 v[68:71], a[184:187], a[120:123], v[68:71]
  s_add_u32 m0, s56, 108544
  s_add_u32 s54, s56, 1255424
  buffer_load_dwordx4 v225, s[32:35], s54 offen sc1 lds
  v_mfma_f32_16x16x32_bf16 v[68:71], a[76:79], a[88:91], v[68:71]
  ds_write_b128 v242, v[52:55] offset:8192
  v_mfma_f32_16x16x32_bf16 v[72:75], a[148:151], a[52:55], v[72:75]
  v_mfma_f32_16x16x32_bf16 v[72:75], a[168:171], a[24:27], v[72:75]
  ds_write_b128 v242, v[56:59] offset:9216
  v_mfma_f32_16x16x32_bf16 v[72:75], a[188:191], a[120:123], v[72:75]
  s_add_u32 m0, s56, 109568
  s_add_u32 s54, s56, 1256448
  buffer_load_dwordx4 v225, s[32:35], s54 offen sc1 lds
  v_mfma_f32_16x16x32_bf16 v[72:75], a[80:83], a[88:91], v[72:75]
  v_mfma_f32_16x16x32_bf16 v[76:79], a[152:155], a[52:55], v[76:79]
  v_mfma_f32_16x16x32_bf16 v[76:79], a[172:175], a[24:27], v[76:79]
  v_mfma_f32_16x16x32_bf16 v[76:79], a[64:67], a[120:123], v[76:79]
  v_mfma_f32_16x16x32_bf16 v[76:79], a[84:87], a[88:91], v[76:79]
  s_add_u32 m0, s56, 110592
  s_add_u32 s54, s56, 1257472
  buffer_load_dwordx4 v225, s[32:35], s54 offen sc1 lds
  s_waitcnt vmcnt(12)
  v_mfma_f32_16x16x32_bf16 v[0:3], a[136:139], a[208:211], v[0:3]
  s_waitcnt vmcnt(11)
  v_mfma_f32_16x16x32_bf16 v[0:3], a[156:159], a[212:215], v[0:3]
  s_waitcnt vmcnt(10)
  v_mfma_f32_16x16x32_bf16 v[0:3], a[176:179], a[28:31], v[0:3]
  s_waitcnt lgkmcnt(0)
  s_barrier
  s_waitcnt vmcnt(9)
  v_mfma_f32_16x16x32_bf16 v[0:3], a[68:71], a[56:59], v[0:3]
  ds_write_b128 v243, v[60:63] offset:10240
  v_mfma_f32_16x16x32_bf16 v[4:7], a[140:143], a[208:211], v[4:7]
  ds_write_b128 v243, v[64:67] offset:11264
  v_mfma_f32_16x16x32_bf16 v[4:7], a[160:163], a[212:215], v[4:7]
  ds_write_b128 v243, v[68:71] offset:12288
  v_mfma_f32_16x16x32_bf16 v[4:7], a[180:183], a[28:31], v[4:7]
  ds_write_b128 v243, v[72:75] offset:13312
  v_mfma_f32_16x16x32_bf16 v[4:7], a[72:75], a[56:59], v[4:7]
  ds_write_b128 v243, v[76:79] offset:14336
  v_mfma_f32_16x16x32_bf16 v[8:11], a[144:147], a[208:211], v[8:11]
  ds_read_b128 v[20:23], v240 offset:0
  v_mfma_f32_16x16x32_bf16 v[8:11], a[164:167], a[212:215], v[8:11]
  ds_read_b128 v[24:27], v240 offset:1024
  v_mfma_f32_16x16x32_bf16 v[8:11], a[184:187], a[28:31], v[8:11]
  s_add_u32 m0, s56, 111616
  s_add_u32 s54, s56, 1258496
  buffer_load_dwordx4 v225, s[32:35], s54 offen sc1 lds
  v_mfma_f32_16x16x32_bf16 v[8:11], a[76:79], a[56:59], v[8:11]
  ds_read_b128 v[28:31], v240 offset:2048
  v_mfma_f32_16x16x32_bf16 v[12:15], a[148:151], a[208:211], v[12:15]
  ds_read_b128 v[32:35], v240 offset:3072
  v_mfma_f32_16x16x32_bf16 v[12:15], a[168:171], a[212:215], v[12:15]
  ds_read_b128 v[36:39], v240 offset:4096
  v_mfma_f32_16x16x32_bf16 v[12:15], a[188:191], a[28:31], v[12:15]
  ds_read_b128 v[40:43], v240 offset:5120
  v_mfma_f32_16x16x32_bf16 v[12:15], a[80:83], a[56:59], v[12:15]
  ds_read_b128 v[44:47], v240 offset:6144
  v_mfma_f32_16x16x32_bf16 v[16:19], a[152:155], a[208:211], v[16:19]
  ds_read_b128 v[48:51], v240 offset:7168
  v_mfma_f32_16x16x32_bf16 v[16:19], a[172:175], a[212:215], v[16:19]
  ds_read_b128 v[52:55], v240 offset:8192
  v_mfma_f32_16x16x32_bf16 v[16:19], a[64:67], a[28:31], v[16:19]
  ds_read_b128 v[56:59], v240 offset:9216
  v_mfma_f32_16x16x32_bf16 v[16:19], a[84:87], a[56:59], v[16:19]
  s_mul_i32 s56, s3, 10240
  s_add_u32 m0, s56, 61440
  s_add_u32 s54, s56, 1208320
  buffer_load_dwordx4 v225, s[32:35], s54 offen sc1 lds
L_c4:
  s_waitcnt lgkmcnt(0)
  s_barrier
  ds_read_b128 v[60:63], v240 offset:10240
  ds_read_b128 v[64:67], v240 offset:11264
  ds_read_b128 v[68:71], v240 offset:12288
  ds_read_b128 v[72:75], v240 offset:13312
  ds_read_b128 v[76:79], v240 offset:14336
  v_pk_add_f32 v[0:1], v[0:1], v[20:21]
  v_pk_add_f32 v[2:3], v[2:3], v[22:23]
  v_pk_add_f32 v[4:5], v[4:5], v[24:25]
  v_pk_add_f32 v[6:7], v[6:7], v[26:27]
  v_pk_add_f32 v[8:9], v[8:9], v[28:29]
  v_pk_add_f32 v[10:11], v[10:11], v[30:31]
  v_pk_add_f32 v[12:13], v[12:13], v[32:33]
  v_pk_add_f32 v[14:15], v[14:15], v[34:35]
  v_pk_add_f32 v[16:17], v[16:17], v[36:37]
  s_add_u32 m0, s56, 62464
  s_add_u32 s54, s56, 1209344
  buffer_load_dwordx4 v225, s[32:35], s54 offen sc1 lds
  v_pk_add_f32 v[18:19], v[18:19], v[38:39]
  v_pk_add_f32 v[0:1], v[0:1], v[40:41]
  v_pk_add_f32 v[2:3], v[2:3], v[42:43]
  v_pk_add_f32 v[4:5], v[4:5], v[44:45]
  v_pk_add_f32 v[6:7], v[6:7], v[46:47]
  v_pk_add_f32 v[8:9], v[8:9], v[48:49]
  v_pk_add_f32 v[10:11], v[10:11], v[50:51]
  v_pk_add_f32 v[12:13], v[12:13], v[52:53]
  v_pk_add_f32 v[14:15], v[14:15], v[54:55]
  v_pk_add_f32 v[16:17], v[16:17], v[56:57]
  v_pk_add_f32 v[18:19], v[18:19], v[58:59]
  v_pk_add_f32 v[0:1], v[0:1], v[216:217]
  v_pk_add_f32 v[2:3], v[2:3], v[218:219]
  v_pk_add_f32 v[4:5], v[4:5], v[220:221]
  v_pk_add_f32 v[6:7], v[6:7], v[222:223]
  v_pk_add_f32 v[8:9], v[8:9], v[112:113]
  s_add_u32 m0, s56, 63488
  s_add_u32 s54, s56, 1210368
  buffer_load_dwordx4 v225, s[32:35], s54 offen sc1 lds
  v_pk_add_f32 v[10:11], v[10:11], v[114:115]
  v_pk_add_f32 v[12:13], v[12:13], v[116:117]
  v_pk_add_f32 v[14:15], v[14:15], v[118:119]
  v_pk_add_f32 v[16:17], v[16:17], v[120:121]
  v_pk_add_f32 v[18:19], v[18:19], v[122:123]
  s_waitcnt lgkmcnt(0)
  v_pk_add_f32 v[0:1], v[0:1], v[60:61]
  v_pk_add_f32 v[2:3], v[2:3], v[62:63]
  v_pk_add_f32 v[4:5], v[4:5], v[64:65]
  v_pk_add_f32 v[6:7], v[6:7], v[66:67]
  v_pk_add_f32 v[8:9], v[8:9], v[68:69]
  v_pk_add_f32 v[10:11], v[10:11], v[70:71]
  v_pk_add_f32 v[12:13], v[12:13], v[72:73]
  v_pk_add_f32 v[14:15], v[14:15], v[74:75]
  v_pk_add_f32 v[16:17], v[16:17], v[76:77]
  v_pk_add_f32 v[18:19], v[18:19], v[78:79]
  s_add_u32 m0, s56, 64512
  s_add_u32 s54, s56, 1211392
  buffer_load_dwordx4 v225, s[32:35], s54 offen sc1 lds
  v_lshlrev_b32 v244, 16, v100
  v_and_b32 v245, 0xffff0000, v100
  v_lshlrev_b32 v246, 16, v80
  v_and_b32 v247, 0xffff0000, v80
  v_lshlrev_b32 v248, 16, v90
  v_and_b32 v249, 0xffff0000, v90
  v_pk_fma_f32 v[0:1], v[0:1], v[246:247], v[244:245]
  v_pk_mul_f32 v[248:249], v[0:1], v[248:249]
  v_cvt_pk_bf16_f32 v32, v248, v249
  v_lshlrev_b32 v244, 16, v101
  v_and_b32 v245, 0xffff0000, v101
  v_lshlrev_b32 v246, 16, v81
  v_and_b32 v247, 0xffff0000, v81
  v_lshlrev_b32 v248, 16, v91
  v_and_b32 v249, 0xffff0000, v91
  v_pk_fma_f32 v[2:3], v[2:3], v[246:247], v[244:245]
  s_add_u32 m0, s56, 65536
  s_add_u32 s54, s56, 1212416
  buffer_load_dwordx4 v225, s[32:35], s54 offen sc1 lds
  v_pk_mul_f32 v[248:249], v[2:3], v[248:249]
  v_cvt_pk_bf16_f32 v33, v248, v249
  v_lshlrev_b32 v244, 16, v102
  v_and_b32 v245, 0xffff0000, v102
  v_lshlrev_b32 v246, 16, v82
  v_and_b32 v247, 0xffff0000, v82
  v_lshlrev_b32 v248, 16, v92
  v_and_b32 v249, 0xffff0000, v92
  v_pk_fma_f32 v[4:5], v[4:5], v[246:247], v[244:245]
  v_pk_mul_f32 v[248:249], v[4:5], v[248:249]
  v_cvt_pk_bf16_f32 v34, v248, v249
  v_lshlrev_b32 v244, 16, v103
  v_and_b32 v245, 0xffff0000, v103
  v_lshlrev_b32 v246, 16, v83
  v_and_b32 v247, 0xffff0000, v83
  v_lshlrev_b32 v248, 16, v93
  s_add_u32 m0, s56, 66560
  s_add_u32 s54, s56, 1213440
  buffer_load_dwordx4 v225, s[32:35], s54 offen sc1 lds
  v_and_b32 v249, 0xffff0000, v93
  v_pk_fma_f32 v[6:7], v[6:7], v[246:247], v[244:245]
  v_pk_mul_f32 v[248:249], v[6:7], v[248:249]
  v_cvt_pk_bf16_f32 v35, v248, v249
  buffer_store_dwordx4 v[32:35], v225, s[36:39], 0 offen offset:0 sc1
  v_lshlrev_b32 v244, 16, v104
  v_and_b32 v245, 0xffff0000, v104
  v_lshlrev_b32 v246, 16, v84
  v_and_b32 v247, 0xffff0000, v84
  v_lshlrev_b32 v248, 16, v94
  v_and_b32 v249, 0xffff0000, v94
  v_pk_fma_f32 v[8:9], v[8:9], v[246:247], v[244:245]
  v_pk_mul_f32 v[248:249], v[8:9], v[248:249]
  v_cvt_pk_bf16_f32 v36, v248, v249
  v_lshlrev_b32 v244, 16, v105
  v_and_b32 v245, 0xffff0000, v105
  s_add_u32 m0, s56, 67584
  s_add_u32 s54, s56, 1214464
  buffer_load_dwordx4 v225, s[32:35], s54 offen sc1 lds
  v_lshlrev_b32 v246, 16, v85
  v_and_b32 v247, 0xffff0000, v85
  v_lshlrev_b32 v248, 16, v95
  v_and_b32 v249, 0xffff0000, v95
  v_pk_fma_f32 v[10:11], v[10:11], v[246:247], v[244:245]
  v_pk_mul_f32 v[248:249], v[10:11], v[248:249]
  v_cvt_pk_bf16_f32 v37, v248, v249
  v_lshlrev_b32 v244, 16, v106
  v_and_b32 v245, 0xffff0000, v106
  v_lshlrev_b32 v246, 16, v86
  v_and_b32 v247, 0xffff0000, v86
  v_lshlrev_b32 v248, 16, v96
  v_and_b32 v249, 0xffff0000, v96
  v_pk_fma_f32 v[12:13], v[12:13], v[246:247], v[244:245]
  v_pk_mul_f32 v[248:249], v[12:13], v[248:249]
  v_cvt_pk_bf16_f32 v38, v248, v249
  s_add_u32 m0, s56, 68608
  s_add_u32 s54, s56, 1215488
  buffer_load_dwordx4 v225, s[32:35], s54 offen sc1 lds
  v_lshlrev_b32 v244, 16, v107
  v_and_b32 v245, 0xffff0000, v107
  v_lshlrev_b32 v246, 16, v87
  v_and_b32 v247, 0xffff0000, v87
  v_lshlrev_b32 v248, 16, v97
  v_and_b32 v249, 0xffff0000, v97
  v_pk_fma_f32 v[14:15], v[14:15], v[246:247], v[244:245]
  v_pk_mul_f32 v[248:249], v[14:15], v[248:249]
  v_cvt_pk_bf16_f32 v39, v248, v249
  buffer_store_dwordx4 v[36:39], v225, s[36:39], 0 offen offset:1024 sc1
  v_lshlrev_b32 v244, 16, v108
  v_and_b32 v245, 0xffff0000, v108
  v_lshlrev_b32 v246, 16, v88
  v_and_b32 v247, 0xffff0000, v88
  v_lshlrev_b32 v248, 16, v98
  v_and_b32 v249, 0xffff0000, v98
  s_add_u32 m0, s56, 69632
  s_add_u32 s54, s56, 1216512
  buffer_load_dwordx4 v225, s[32:35], s54 offen sc1 lds
  v_pk_fma_f32 v[16:17], v[16:17], v[246:247], v[244:245]
  v_pk_mul_f32 v[248:249], v[16:17], v[248:249]
  v_cvt_pk_bf16_f32 v40, v248, v249
  v_lshlrev_b32 v244, 16, v109
  v_and_b32 v245, 0xffff0000, v109
  v_lshlrev_b32 v246, 16, v89
  v_and_b32 v247, 0xffff0000, v89
  v_lshlrev_b32 v248, 16, v99
  v_and_b32 v249, 0xffff0000, v99
  v_pk_fma_f32 v[18:19], v[18:19], v[246:247], v[244:245]
  v_pk_mul_f32 v[248:249], v[18:19], v[248:249]
  v_cvt_pk_bf16_f32 v41, v248, v249
  v_mov_b32 v42, v40
  v_mov_b32 v43, v41
  s_nop 0
  v_permlane32_swap_b32 v40, v42
  s_add_u32 m0, s56, 70656
  s_add_u32 s54, s56, 1217536
  buffer_load_dwordx4 v225, s[32:35], s54 offen sc1 lds
  v_permlane32_swap_b32 v41, v43
  buffer_store_dwordx4 v[40:43], v111, s[36:39], 0 offen sc1
  v_pk_mul_f32 v[46:47], v[0:1], v[0:1]
  v_pk_add_f32 v[44:45], v[0:1], v[2:3]
  v_pk_fma_f32 v[46:47], v[2:3], v[2:3], v[46:47]
  v_pk_add_f32 v[44:45], v[44:45], v[4:5]
  v_pk_fma_f32 v[46:47], v[4:5], v[4:5], v[46:47]
  v_pk_add_f32 v[44:45], v[44:45], v[6:7]
  v_pk_fma_f32 v[46:47], v[6:7], v[6:7], v[46:47]
  v_pk_add_f32 v[44:45], v[44:45], v[8:9]
  v_pk_fma_f32 v[46:47], v[8:9], v[8:9], v[46:47]
  v_pk_add_f32 v[44:45], v[44:45], v[10:11]
  v_pk_fma_f32 v[46:47], v[10:11], v[10:11], v[46:47]
  v_pk_add_f32 v[44:45], v[44:45], v[12:13]
  v_pk_fma_f32 v[46:47], v[12:13], v[12:13], v[46:47]
  v_pk_add_f32 v[44:45], v[44:45], v[14:15]
  s_mul_i32 s56, s3, 15360
  s_add_u32 m0, s56, 0
  s_add_u32 s54, s56, 1146880
  buffer_load_dwordx4 v225, s[32:35], s54 offen sc1 lds
  v_pk_fma_f32 v[46:47], v[14:15], v[14:15], v[46:47]
  v_pk_add_f32 v[44:45], v[44:45], v[16:17]
  v_pk_fma_f32 v[46:47], v[16:17], v[16:17], v[46:47]
  v_pk_add_f32 v[44:45], v[44:45], v[18:19]
  v_pk_fma_f32 v[46:47], v[18:19], v[18:19], v[46:47]
  v_add_f32 v44, v44, v45
  v_add_f32 v45, v46, v47
  v_cvt_pk_bf16_f32 v228, v0, v1
  v_cvt_pk_bf16_f32 v229, v2, v3
  v_permlane32_swap_b32 v44, v45
  v_cvt_pk_bf16_f32 v230, v4, v5
  v_cvt_pk_bf16_f32 v231, v6, v7
  v_add_f32 v44, v44, v45
  v_mov_b32 v45, v44
  v_cvt_pk_bf16_f32 v232, v8, v9
  v_cvt_pk_bf16_f32 v233, v10, v11
  s_add_u32 m0, s56, 1024
  s_add_u32 s54, s56, 1147904
  buffer_load_dwordx4 v225, s[32:35], s54 offen sc1 lds
  v_permlane16_swap_b32 v44, v45
  v_cvt_pk_bf16_f32 v234, v12, v13
  v_cvt_pk_bf16_f32 v235, v14, v15
  v_add_f32 v44, v44, v45
  buffer_store_dword v44, v251, s[44:47], s61 offen sc1
  s_lshl_b32 s63, s58, 5
  s_add_u32 s63, s63, s57
  s_lshl_b32 s63, s63, 10
  v_and_b32 v238, 7, v224
  v_lshlrev_b32 v238, 2, v238
  v_cmp_lt_u32 vcc, 31, v224
  s_add_u32 m0, s56, 2048
  s_add_u32 s54, s56, 1148928
  buffer_load_dwordx4 v225, s[32:35], s54 offen sc1 lds
  v_min_u32 v239, 57, v224
  v_and_b32 v239, 0x3d, v239
  v_lshlrev_b32 v239, 2, v239
  v_cndmask_b32 v238, v238, v239, vcc
  v_cvt_pk_bf16_f32 v236, v16, v17
  v_cvt_pk_bf16_f32 v237, v18, v19
  s_add_u32 m0, s56, 3072
  s_add_u32 s54, s56, 1149952
  buffer_load_dwordx4 v225, s[32:35], s54 offen sc1 lds
  v_add_u32 v241, 65536, v225
  v_add_u32 v242, 131072, v225
  s_lshl_b32 s52, s57, 2
  s_add_u32 s52, s52, s3
  s_mul_i32 s52, s52, 20480
  s_add_u32 s52, s52, 4194304
  s_add_u32 m0, s56, 4096
  s_add_u32 s54, s56, 1150976
  buffer_load_dwordx4 v225, s[32:35], s54 offen sc1 lds
  s_add_u32 s16, s4, s52
  s_addc_u32 s17, s5, 0
  s_mov_b32 s18, 20480
  s_mov_b32 s19, 0x20000
  s_mul_i32 s52, s58, 448
  s_add_u32 s52, s52, 16384
  s_add_u32 m0, s56, 5120
  s_add_u32 s54, s56, 1152000
  buffer_load_dwordx4 v225, s[32:35], s54 offen sc1 lds
  s_add_u32 s36, s4, s52
  s_addc_u32 s37, s5, 0
  s_mov_b32 s38, 11200
  s_mov_b32 s39, 0x20000
  v_and_b32 v244, 7, v224
  v_bfe_u32 v245, v224, 3, 1
  s_add_u32 m0, s56, 6144
  s_add_u32 s54, s56, 1153024
  buffer_load_dwordx4 v225, s[32:35], s54 offen sc1 lds
  v_lshrrev_b32 v246, 4, v224
  v_lshlrev_b32 v247, 6, v245
  v_lshl_add_u32 v247, v246, 4, v247
  v_lshl_add_u32 v254, v244, 7, v247
  v_lshl_add_u32 v255, v244, 17, v247
  v_and_b32 v244, 15, v224
  s_add_u32 m0, s56, 7168
  s_add_u32 s54, s56, 1154048
  buffer_load_dwordx4 v225, s[32:35], s54 offen sc1 lds
  v_lshlrev_b32 v244, 2, v244
  s_lshl_b32 s61, s3, 12
  s_add_u32 s61, s61, 143360
  v_add_u32 v244, s61, v244
  v_lshl_add_u32 v245, v246, 8, v244
  v_add_u32 v247, s61, v254
  s_add_u32 m0, s56, 8192
  s_add_u32 s54, s56, 1155072
  buffer_load_dwordx4 v225, s[32:35], s54 offen sc1 lds
  v_and_b32 v250, 31, v224
  v_min_u32 v250, 27, v250
  v_lshrrev_b32 v246, 5, v224
  v_mul_u32_u24 v246, 3584, v246
  v_lshl_add_u32 v246, v250, 4, v246
  s_waitcnt vmcnt(7)
  s_barrier
  s_cmp_lg_u32 s3, 0
  s_cbranch_scc1 L_adaL_nopush_80
  s_lshl_b32 s52, s57, 10
  s_lshl_b32 s53, s58, 2
  s_add_u32 s52, s52, s53
  v_lshlrev_b32 v248, 15, v224
  s_mov_b64 exec, 0xff
  v_mov_b32 v249, 1
  buffer_store_dword v249, v248, s[8:11], s52 offen sc1
  s_mov_b64 exec, -1
L_adaL_nopush_80:
  s_add_u32 m0, s56, 9216
  s_add_u32 s54, s56, 1156096
  buffer_load_dwordx4 v225, s[32:35], s54 offen sc1 lds
  s_add_u32 m0, s56, 10240
  s_add_u32 s54, s56, 1157120
  buffer_load_dwordx4 v225, s[32:35], s54 offen sc1 lds
  s_add_u32 m0, s56, 11264
  s_add_u32 s54, s56, 1158144
  buffer_load_dwordx4 v225, s[32:35], s54 offen sc1 lds
  s_add_u32 m0, s56, 12288
  s_add_u32 s54, s56, 1159168
  buffer_load_dwordx4 v225, s[32:35], s54 offen sc1 lds
  s_add_u32 m0, s56, 13312
  s_add_u32 s54, s56, 1160192
  buffer_load_dwordx4 v225, s[32:35], s54 offen sc1 lds
  s_add_u32 m0, s56, 14336
  s_add_u32 s54, s56, 1161216
  buffer_load_dwordx4 v225, s[32:35], s54 offen sc1 lds
  s_xor_b32 s55, s40, 0
  buffer_load_dwordx4 v[124:127], v225, s[96:99], s55 offen sc1
  s_xor_b32 s55, s41, 0
  buffer_load_dwordx4 v[192:195], v225, s[96:99], s55 offen sc1
  s_xor_b32 s55, s42, 0
  buffer_load_dwordx4 v[128:131], v225, s[96:99], s55 offen sc1
  s_xor_b32 s55, s43, 0
  buffer_load_dwordx4 v[132:135], v225, s[96:99], s55 offen sc1
  s_xor_b32 s55, s40, 4096
  buffer_load_dwordx4 v[136:139], v225, s[96:99], s55 offen sc1
  s_xor_b32 s55, s41, 4096
  buffer_load_dwordx4 v[140:143], v225, s[96:99], s55 offen sc1
  s_xor_b32 s55, s42, 4096
  buffer_load_dwordx4 v[144:147], v225, s[96:99], s55 offen sc1
  s_xor_b32 s55, s43, 4096
  buffer_load_dwordx4 v[148:151], v225, s[96:99], s55 offen sc1
  s_xor_b32 s55, s40, 8192
  buffer_load_dwordx4 v[152:155], v225, s[96:99], s55 offen sc1
  s_xor_b32 s55, s41, 8192
  buffer_load_dwordx4 v[156:159], v225, s[96:99], s55 offen sc1
  s_xor_b32 s55, s42, 8192
  buffer_load_dwordx4 v[160:163], v225, s[96:99], s55 offen sc1
  s_xor_b32 s55, s43, 8192
  buffer_load_dwordx4 v[164:167], v225, s[96:99], s55 offen sc1
  s_mov_b32 s59, 400000
L_adaL_poll_81:
  buffer_load_dword v239, v238, s[8:11], s63 offen offset:0 sc1
  s_sub_u32 s59, s59, 1
  s_cbranch_scc1 L_adaL_polled_82
  s_waitcnt vmcnt(0)
  v_cmp_gt_u32 vcc, 1, v239
  s_cbranch_vccnz L_adaL_poll_81
L_adaL_polled_82:
  s_movk_i32 s60, 0
  buffer_load_dwordx4 a[60:63], v225, s[16:19], s60 offen offset:0 sc1
  buffer_load_dwordx4 a[216:219], v225, s[16:19], s60 offen offset:1024 sc1
  buffer_load_dwordx4 a[220:223], v225, s[16:19], s60 offen offset:2048 sc1
  buffer_load_dwordx4 a[244:247], v225, s[16:19], s60 offen offset:3072 sc1
  s_movk_i32 s60, 4096
  buffer_load_dwordx4 a[248:251], v225, s[16:19], s60 offen offset:0 sc1
  buffer_load_dwordx4 a[108:111], v225, s[16:19], s60 offen offset:1024 sc1
  s_mov_b32 m0, s61
  s_nop 0
  buffer_load_dwordx4 v225, s[44:47], 0 offen sc1 lds
  buffer_load_dwordx4 a[192:195], v225, s[16:19], s60 offen offset:2048 sc1
  buffer_load_dwordx4 a[196:199], v225, s[16:19], s60 offen offset:3072 sc1
  s_barrier
  ds_read_b128 v[64:67], v225 offset:0
  ds_read_b128 v[68:71], v225 offset:1024
  ds_read_b128 v[72:75], v225 offset:2048
  ds_read_b128 v[76:79], v225 offset:3072
  ds_read_b128 v[80:83], v225 offset:4096
  ds_read_b128 v[84:87], v225 offset:5120
  ds_read_b128 v[88:91], v225 offset:6144
  ds_read_b128 v[92:95], v225 offset:7168
  s_waitcnt lgkmcnt(6)
  s_waitcnt vmcnt(8)
  v_mfma_f32_16x16x32_bf16 v[0:3], a[60:63], v[64:67], 0
  ds_read_b128 v[96:99], v225 offset:8192
  v_mfma_f32_16x16x32_bf16 v[4:7], a[60:63], v[68:71], 0
  s_waitcnt lgkmcnt(5)
  ds_read_b128 v[100:103], v225 offset:9216
  v_mfma_f32_16x16x32_bf16 v[8:11], a[60:63], v[72:75], 0
  ds_read_b128 v[64:67], v225 offset:10240
  v_mfma_f32_16x16x32_bf16 v[12:15], a[60:63], v[76:79], 0
  s_waitcnt lgkmcnt(5)
  ds_read_b128 v[68:71], v225 offset:11264
  v_mfma_f32_16x16x32_bf16 v[16:19], a[60:63], v[80:83], 0
  ds_read_b128 v[72:75], v225 offset:12288
  s_movk_i32 s60, 8192
  buffer_load_dwordx4 a[240:243], v225, s[16:19], s60 offen offset:0 sc1
  v_mfma_f32_16x16x32_bf16 v[20:23], a[60:63], v[84:87], 0
  s_waitcnt lgkmcnt(5)
  ds_read_b128 v[76:79], v225 offset:13312
  v_mfma_f32_16x16x32_bf16 v[24:27], a[60:63], v[88:91], 0
  ds_read_b128 v[80:83], v225 offset:14336
  s_waitcnt vmcnt(8)
  v_mfma_f32_16x16x32_bf16 v[0:3], a[216:219], v[92:95], v[0:3]
  s_waitcnt lgkmcnt(5)
  ds_read_b128 v[84:87], v225 offset:15360
  v_mfma_f32_16x16x32_bf16 v[4:7], a[216:219], v[96:99], v[4:7]
  ds_read_b128 v[88:91], v225 offset:16384
  v_mfma_f32_16x16x32_bf16 v[8:11], a[216:219], v[100:103], v[8:11]
  s_waitcnt lgkmcnt(5)
  ds_read_b128 v[92:95], v225 offset:17408
  buffer_load_dwordx4 a[252:255], v225, s[16:19], s60 offen offset:1024 sc1
  v_mfma_f32_16x16x32_bf16 v[12:15], a[216:219], v[64:67], v[12:15]
  ds_read_b128 v[96:99], v225 offset:18432
  v_mfma_f32_16x16x32_bf16 v[16:19], a[216:219], v[68:71], v[16:19]
  s_waitcnt lgkmcnt(5)
  ds_read_b128 v[100:103], v225 offset:19456
  v_mfma_f32_16x16x32_bf16 v[20:23], a[216:219], v[72:75], v[20:23]
  ds_read_b128 v[64:67], v225 offset:20480
  v_mfma_f32_16x16x32_bf16 v[24:27], a[216:219], v[76:79], v[24:27]
  s_waitcnt lgkmcnt(5)
  ds_read_b128 v[68:71], v225 offset:21504
  s_waitcnt vmcnt(8)
  v_mfma_f32_16x16x32_bf16 v[0:3], a[220:223], v[80:83], v[0:3]
  ds_read_b128 v[72:75], v225 offset:22528
  buffer_load_dwordx4 a[0:3], v225, s[16:19], s60 offen offset:2048 sc1
  v_mfma_f32_16x16x32_bf16 v[4:7], a[220:223], v[84:87], v[4:7]
  s_waitcnt lgkmcnt(5)
  ds_read_b128 v[76:79], v225 offset:23552
  v_mfma_f32_16x16x32_bf16 v[8:11], a[220:223], v[88:91], v[8:11]
  ds_read_b128 v[80:83], v225 offset:24576
  v_mfma_f32_16x16x32_bf16 v[12:15], a[220:223], v[92:95], v[12:15]
  s_waitcnt lgkmcnt(5)
  ds_read_b128 v[84:87], v225 offset:25600
  v_mfma_f32_16x16x32_bf16 v[16:19], a[220:223], v[96:99], v[16:19]
  ds_read_b128 v[88:91], v225 offset:26624
  v_mfma_f32_16x16x32_bf16 v[20:23], a[220:223], v[100:103], v[20:23]
  s_waitcnt lgkmcnt(5)
  ds_read_b128 v[92:95], v225 offset:27648
  buffer_load_dwordx4 a[4:7], v225, s[16:19], s60 offen offset:3072 sc1
  v_mfma_f32_16x16x32_bf16 v[24:27], a[220:223], v[64:67], v[24:27]
  ds_read_b128 v[96:99], v225 offset:28672
  s_waitcnt vmcnt(9)
  v_mfma_f32_16x16x32_bf16 v[0:3], a[244:247], v[68:71], v[0:3]
  s_waitcnt lgkmcnt(5)
  ds_read_b128 v[100:103], v225 offset:29696
  v_mfma_f32_16x16x32_bf16 v[4:7], a[244:247], v[72:75], v[4:7]
  ds_read_b128 v[64:67], v225 offset:30720
  v_mfma_f32_16x16x32_bf16 v[8:11], a[244:247], v[76:79], v[8:11]
  s_waitcnt lgkmcnt(5)
  ds_read_b128 v[68:71], v225 offset:31744
  v_mfma_f32_16x16x32_bf16 v[12:15], a[244:247], v[80:83], v[12:15]
  ds_read_b128 v[72:75], v225 offset:32768
  s_movk_i32 s60, 12288
  buffer_load_dwordx4 a[32:35], v225, s[16:19], s60 offen offset:0 sc1
  v_mfma_f32_16x16x32_bf16 v[16:19], a[244:247], v[84:87], v[16:19]
  s_waitcnt lgkmcnt(5)
  ds_read_b128 v[76:79], v225 offset:33792
  v_mfma_f32_16x16x32_bf16 v[20:23], a[244:247], v[88:91], v[20:23]
  ds_read_b128 v[80:83], v225 offset:34816
  v_mfma_f32_16x16x32_bf16 v[24:27], a[244:247], v[92:95], v[24:27]
  s_waitcnt lgkmcnt(5)
  ds_read_b128 v[84:87], v225 offset:35840
  s_waitcnt vmcnt(9)
  v_mfma_f32_16x16x32_bf16 v[0:3], a[248:251], v[96:99], v[0:3]
  ds_read_b128 v[88:91], v225 offset:36864
  v_mfma_f32_16x16x32_bf16 v[4:7], a[248:251], v[100:103], v[4:7]
  s_waitcnt lgkmcnt(5)
  ds_read_b128 v[92:95], v225 offset:37888
  buffer_load_dwordx4 a[8:11], v225, s[16:19], s60 offen offset:1024 sc1
  v_mfma_f32_16x16x32_bf16 v[8:11], a[248:251], v[64:67], v[8:11]
  ds_read_b128 v[96:99], v225 offset:38912
  v_mfma_f32_16x16x32_bf16 v[12:15], a[248:251], v[68:71], v[12:15]
  s_waitcnt lgkmcnt(5)
  ds_read_b128 v[100:103], v225 offset:39936
  v_mfma_f32_16x16x32_bf16 v[16:19], a[248:251], v[72:75], v[16:19]
  ds_read_b128 v[64:67], v225 offset:40960
  v_mfma_f32_16x16x32_bf16 v[20:23], a[248:251], v[76:79], v[20:23]
  s_waitcnt lgkmcnt(5)
  ds_read_b128 v[68:71], v225 offset:41984
  v_mfma_f32_16x16x32_bf16 v[24:27], a[248:251], v[80:83], v[24:27]
  ds_read_b128 v[72:75], v225 offset:43008
  s_add_u32 m0, s61, 1024
  s_movk_i32 s55, 6144
  buffer_load_dwordx4 v246, s[36:39], 0 offen sc1 lds
  s_waitcnt vmcnt(10)
  v_mfma_f32_16x16x32_bf16 v[0:3], a[108:111], v[84:87], v[0:3]
  s_waitcnt lgkmcnt(5)
  ds_read_b128 v[76:79], v225 offset:44032
  v_mfma_f32_16x16x32_bf16 v[4:7], a[108:111], v[88:91], v[4:7]
  ds_read_b128 v[80:83], v225 offset:45056
  v_mfma_f32_16x16x32_bf16 v[8:11], a[108:111], v[92:95], v[8:11]
  s_waitcnt lgkmcnt(5)
  ds_read_b128 v[84:87], v225 offset:46080
  v_mfma_f32_16x16x32_bf16 v[12:15], a[108:111], v[96:99], v[12:15]
  ds_read_b128 v[88:91], v225 offset:47104
  v_mfma_f32_16x16x32_bf16 v[16:19], a[108:111], v[100:103], v[16:19]
  s_waitcnt lgkmcnt(5)
  ds_read_b128 v[92:95], v225 offset:48128
  buffer_load_dwordx4 v246, s[36:39], s55 offen offset:1024 sc1 lds
  v_mfma_f32_16x16x32_bf16 v[20:23], a[108:111], v[64:67], v[20:23]
  ds_read_b128 v[96:99], v225 offset:49152
  v_mfma_f32_16x16x32_bf16 v[24:27], a[108:111], v[68:71], v[24:27]
  s_waitcnt lgkmcnt(5)
  ds_read_b128 v[100:103], v225 offset:50176
  s_waitcnt vmcnt(9)
  v_mfma_f32_16x16x32_bf16 v[0:3], a[192:195], v[72:75], v[0:3]
  ds_read_b128 v[64:67], v225 offset:51200
  v_mfma_f32_16x16x32_bf16 v[4:7], a[192:195], v[76:79], v[4:7]
  s_waitcnt lgkmcnt(5)
  ds_read_b128 v[68:71], v225 offset:52224
  v_mfma_f32_16x16x32_bf16 v[8:11], a[192:195], v[80:83], v[8:11]
  ds_read_b128 v[72:75], v225 offset:53248
  buffer_load_dwordx4 a[92:95], v225, s[16:19], s60 offen offset:2048 sc1
  v_mfma_f32_16x16x32_bf16 v[12:15], a[192:195], v[84:87], v[12:15]
  s_waitcnt lgkmcnt(5)
  ds_read_b128 v[76:79], v225 offset:54272
  ds_read_b128 v[28:31], v247
  v_mfma_f32_16x16x32_bf16 v[16:19], a[192:195], v[88:91], v[16:19]
  ds_read_b128 v[80:83], v225 offset:55296
  ds_read_b32 v250, v245 offset:0
  v_mfma_f32_16x16x32_bf16 v[20:23], a[192:195], v[92:95], v[20:23]
  s_waitcnt lgkmcnt(7)
  ds_read_b128 v[84:87], v225 offset:56320
  ds_read_b32 v251, v245 offset:64
  v_mfma_f32_16x16x32_bf16 v[24:27], a[192:195], v[96:99], v[24:27]
  ds_read_b128 v[88:91], v225 offset:57344
  ds_read_b32 v252, v245 offset:128
  s_waitcnt vmcnt(9)
  v_mfma_f32_16x16x32_bf16 v[0:3], a[196:199], v[100:103], v[0:3]
  s_waitcnt lgkmcnt(9)
  ds_read_b128 v[92:95], v225 offset:58368
  buffer_load_dwordx4 a[96:99], v225, s[16:19], s60 offen offset:3072 sc1
  v_mfma_f32_16x16x32_bf16 v[4:7], a[196:199], v[64:67], v[4:7]
  ds_read_b128 v[96:99], v225 offset:59392
  ds_read_b32 v253, v245 offset:192
  v_mfma_f32_16x16x32_bf16 v[8:11], a[196:199], v[68:71], v[8:11]
  s_waitcnt lgkmcnt(10)
  ds_read_b128 v[100:103], v225 offset:60416
  v_mfma_f32_16x16x32_bf16 v[12:15], a[196:199], v[72:75], v[12:15]
  ds_read_b128 v[64:67], v225 offset:61440
  v_mfma_f32_16x16x32_bf16 v[16:19], a[196:199], v[76:79], v[16:19]
  s_waitcnt lgkmcnt(8)
  ds_read_b128 v[68:71], v225 offset:62464
  v_mfma_f32_16x16x32_bf16 v[20:23], a[196:199], v[80:83], v[20:23]
  ds_read_b128 v[72:75], v225 offset:63488
  s_movk_i32 s60, 16384
  buffer_load_dwordx4 a[100:103], v225, s[16:19], s60 offen offset:0 sc1
  v_mfma_f32_16x16x32_bf16 v[24:27], a[196:199], v[84:87], v[24:27]
  s_waitcnt lgkmcnt(6)
  ds_read_b128 v[76:79], v225 offset:64512
  s_waitcnt vmcnt(10)
  v_mfma_f32_16x16x32_bf16 v[0:3], a[240:243], v[88:91], v[0:3]
  ds_read_b128 v[80:83], v241 offset:0
  v_mfma_f32_16x16x32_bf16 v[4:7], a[240:243], v[92:95], v[4:7]
  s_waitcnt lgkmcnt(5)
  ds_read_b128 v[84:87], v241 offset:1024
  v_mfma_f32_16x16x32_bf16 v[8:11], a[240:243], v[96:99], v[8:11]
  ds_read_b128 v[88:91], v241 offset:2048
  v_mfma_f32_16x16x32_bf16 v[12:15], a[240:243], v[100:103], v[12:15]
  s_waitcnt lgkmcnt(5)
  ds_read_b128 v[92:95], v241 offset:3072
  buffer_load_dwordx4 a[104:107], v225, s[16:19], s60 offen offset:1024 sc1
  v_mfma_f32_16x16x32_bf16 v[16:19], a[240:243], v[64:67], v[16:19]
  ds_read_b128 v[96:99], v241 offset:4096
  v_mfma_f32_16x16x32_bf16 v[20:23], a[240:243], v[68:71], v[20:23]
  s_waitcnt lgkmcnt(5)
  ds_read_b128 v[100:103], v241 offset:5120
  v_add_f32_dpp v28, v28, v28 quad_perm:[1,0,3,2] row_mask:0xf bank_mask:0xf
  v_mfma_f32_16x16x32_bf16 v[24:27], a[240:243], v[72:75], v[24:27]
  ds_read_b128 v[64:67], v241 offset:6144
  v_add_f32_dpp v29, v29, v29 quad_perm:[1,0,3,2] row_mask:0xf bank_mask:0xf
  s_waitcnt vmcnt(10)
  v_mfma_f32_16x16x32_bf16 v[0:3], a[252:255], v[76:79], v[0:3]
  s_waitcnt lgkmcnt(5)
  ds_read_b128 v[68:71], v241 offset:7168
  v_add_f32_dpp v30, v30, v30 quad_perm:[1,0,3,2] row_mask:0xf bank_mask:0xf
  v_mfma_f32_16x16x32_bf16 v[4:7], a[252:255], v[80:83], v[4:7]
  ds_read_b128 v[72:75], v241 offset:8192
  buffer_load_dwordx4 a[36:39], v225, s[16:19], s60 offen offset:2048 sc1
  v_mfma_f32_16x16x32_bf16 v[8:11], a[252:255], v[84:87], v[8:11]
  s_waitcnt lgkmcnt(5)
  ds_read_b128 v[76:79], v241 offset:9216
  v_add_f32_dpp v31, v31, v31 quad_perm:[1,0,3,2] row_mask:0xf bank_mask:0xf
  v_mfma_f32_16x16x32_bf16 v[12:15], a[252:255], v[88:91], v[12:15]
  ds_read_b128 v[80:83], v241 offset:10240
  v_add_f32_dpp v28, v28, v28 quad_perm:[2,3,0,1] row_mask:0xf bank_mask:0xf
  v_mfma_f32_16x16x32_bf16 v[16:19], a[252:255], v[92:95], v[16:19]
  s_waitcnt lgkmcnt(5)
  ds_read_b128 v[84:87], v241 offset:11264
  v_add_f32_dpp v29, v29, v29 quad_perm:[2,3,0,1] row_mask:0xf bank_mask:0xf
  v_mfma_f32_16x16x32_bf16 v[20:23], a[252:255], v[96:99], v[20:23]
  ds_read_b128 v[88:91], v241 offset:12288
  v_add_f32_dpp v30, v30, v30 quad_perm:[2,3,0,1] row_mask:0xf bank_mask:0xf
  v_mfma_f32_16x16x32_bf16 v[24:27], a[252:255], v[100:103], v[24:27]
  s_waitcnt lgkmcnt(5)
  ds_read_b128 v[92:95], v241 offset:13312
  buffer_load_dwordx4 a[224:227], v225, s[16:19], s60 offen offset:3072 sc1
  s_waitcnt vmcnt(11)
  v_mfma_f32_16x16x32_bf16 v[0:3], a[0:3], v[64:67], v[0:3]
  ds_read_b128 v[96:99], v241 offset:14336
  v_add_f32_dpp v31, v31, v31 quad_perm:[2,3,0,1] row_mask:0xf bank_mask:0xf
  v_mfma_f32_16x16x32_bf16 v[4:7], a[0:3], v[68:71], v[4:7]
  s_waitcnt lgkmcnt(5)
  ds_read_b128 v[100:103], v241 offset:15360
  v_add_f32_dpp v28, v28, v28 row_half_mirror row_mask:0xf bank_mask:0xf
  v_mfma_f32_16x16x32_bf16 v[8:11], a[0:3], v[72:75], v[8:11]
  ds_read_b128 v[64:67], v241 offset:16384
  v_add_f32_dpp v29, v29, v29 row_half_mirror row_mask:0xf bank_mask:0xf
  v_mfma_f32_16x16x32_bf16 v[12:15], a[0:3], v[76:79], v[12:15]
  s_waitcnt lgkmcnt(5)
  ds_read_b128 v[68:71], v241 offset:17408
  v_add_f32_dpp v30, v30, v30 row_half_mirror row_mask:0xf bank_mask:0xf
  v_mfma_f32_16x16x32_bf16 v[16:19], a[0:3], v[80:83], v[16:19]
  ds_read_b128 v[72:75], v241 offset:18432
  s_xor_b32 s55, s40, 12288
  buffer_load_dwordx4 v[168:171], v225, s[96:99], s55 offen sc1
  v_mfma_f32_16x16x32_bf16 v[20:23], a[0:3], v[84:87], v[20:23]
  s_waitcnt lgkmcnt(5)
  ds_read_b128 v[76:79], v241 offset:19456
  v_add_f32_dpp v31, v31, v31 row_half_mirror row_mask:0xf bank_mask:0xf
  v_mfma_f32_16x16x32_bf16 v[24:27], a[0:3], v[88:91], v[24:27]
  ds_read_b128 v[80:83], v241 offset:20480
  v_mov_b32 v32, v28
  s_waitcnt vmcnt(11)
  v_mfma_f32_16x16x32_bf16 v[0:3], a[4:7], v[92:95], v[0:3]
  s_waitcnt lgkmcnt(5)
  ds_read_b128 v[84:87], v241 offset:21504
  v_mov_b32 v33, v29
  v_mfma_f32_16x16x32_bf16 v[4:7], a[4:7], v[96:99], v[4:7]
  ds_read_b128 v[88:91], v241 offset:22528
  v_mov_b32 v34, v30
  v_mfma_f32_16x16x32_bf16 v[8:11], a[4:7], v[100:103], v[8:11]
  s_waitcnt lgkmcnt(5)
  ds_read_b128 v[92:95], v241 offset:23552
  s_xor_b32 s55, s41, 12288
  buffer_load_dwordx4 v[172:175], v225, s[96:99], s55 offen sc1
  v_mfma_f32_16x16x32_bf16 v[12:15], a[4:7], v[64:67], v[12:15]
  ds_read_b128 v[96:99], v241 offset:24576
  v_mov_b32 v35, v31
  v_mfma_f32_16x16x32_bf16 v[16:19], a[4:7], v[68:71], v[16:19]
  s_waitcnt lgkmcnt(5)
  ds_read_b128 v[100:103], v241 offset:25600
  v_mov_b32_dpp v32, v28 row_ror:8 row_mask:0xf bank_mask:0x3
  v_mfma_f32_16x16x32_bf16 v[20:23], a[4:7], v[72:75], v[20:23]
  ds_read_b128 v[64:67], v241 offset:26624
  v_mov_b32_dpp v33, v29 row_ror:8 row_mask:0xf bank_mask:0x3
  v_mfma_f32_16x16x32_bf16 v[24:27], a[4:7], v[76:79], v[24:27]
  s_waitcnt lgkmcnt(5)
  ds_read_b128 v[68:71], v241 offset:27648
  v_mov_b32_dpp v34, v30 row_ror:8 row_mask:0xf bank_mask:0x3
  s_waitcnt vmcnt(11)
  v_mfma_f32_16x16x32_bf16 v[0:3], a[32:35], v[80:83], v[0:3]
  ds_read_b128 v[72:75], v241 offset:28672
  s_xor_b32 s55, s42, 12288
  buffer_load_dwordx4 v[176:179], v225, s[96:99], s55 offen sc1
  v_mfma_f32_16x16x32_bf16 v[4:7], a[32:35], v[84:87], v[4:7]
  s_waitcnt lgkmcnt(5)
  ds_read_b128 v[76:79], v241 offset:29696
  v_mov_b32_dpp v35, v31 row_ror:8 row_mask:0xf bank_mask:0x3
  v_mfma_f32_16x16x32_bf16 v[8:11], a[32:35], v[88:91], v[8:11]
  ds_read_b128 v[80:83], v241 offset:30720
  v_mov_b32_dpp v28, v28 row_ror:8 row_mask:0xf bank_mask:0xc
  v_mfma_f32_16x16x32_bf16 v[12:15], a[32:35], v[92:95], v[12:15]
  s_waitcnt lgkmcnt(5)
  ds_read_b128 v[84:87], v241 offset:31744
  v_mov_b32_dpp v29, v29 row_ror:8 row_mask:0xf bank_mask:0xc
  v_mfma_f32_16x16x32_bf16 v[16:19], a[32:35], v[96:99], v[16:19]
  ds_read_b128 v[88:91], v241 offset:32768
  v_mov_b32_dpp v30, v30 row_ror:8 row_mask:0xf bank_mask:0xc
  v_mfma_f32_16x16x32_bf16 v[20:23], a[32:35], v[100:103], v[20:23]
  s_waitcnt lgkmcnt(5)
  ds_read_b128 v[92:95], v241 offset:33792
  s_xor_b32 s55, s43, 12288
  buffer_load_dwordx4 v[180:183], v225, s[96:99], s55 offen sc1
  v_mfma_f32_16x16x32_bf16 v[24:27], a[32:35], v[64:67], v[24:27]
  ds_read_b128 v[96:99], v241 offset:34816
  v_mov_b32_dpp v31, v31 row_ror:8 row_mask:0xf bank_mask:0xc
  s_waitcnt vmcnt(12)
  v_mfma_f32_16x16x32_bf16 v[0:3], a[8:11], v[68:71], v[0:3]
  s_waitcnt lgkmcnt(5)
  ds_read_b128 v[100:103], v241 offset:35840
  v_mul_f32 v28, 0x3acccccd, v28
  v_mfma_f32_16x16x32_bf16 v[4:7], a[8:11], v[72:75], v[4:7]
  ds_read_b128 v[64:67], v241 offset:36864
  v_mul_f32 v32, 0x3acccccd, v32
  v_mfma_f32_16x16x32_bf16 v[8:11], a[8:11], v[76:79], v[8:11]
  s_waitcnt lgkmcnt(5)
  ds_read_b128 v[68:71], v241 offset:37888
  v_mul_f32 v29, 0x3acccccd, v29
  v_mfma_f32_16x16x32_bf16 v[12:15], a[8:11], v[80:83], v[12:15]
  ds_read_b128 v[72:75], v241 offset:38912
  s_xor_b32 s55, s40, 16384
  buffer_load_dwordx4 v[184:187], v225, s[96:99], s55 offen sc1
  v_mfma_f32_16x16x32_bf16 v[16:19], a[8:11], v[84:87], v[16:19]
  s_waitcnt lgkmcnt(5)
  ds_read_b128 v[76:79], v241 offset:39936
  v_mul_f32 v33, 0x3acccccd, v33
  v_mfma_f32_16x16x32_bf16 v[20:23], a[8:11], v[88:91], v[20:23]
  ds_read_b128 v[80:83], v241 offset:40960
  v_mul_f32 v30, 0x3acccccd, v30
  v_mfma_f32_16x16x32_bf16 v[24:27], a[8:11], v[92:95], v[24:27]
  s_waitcnt lgkmcnt(5)
  ds_read_b128 v[84:87], v241 offset:41984
  v_mul_f32 v34, 0x3acccccd, v34
  s_waitcnt vmcnt(10)
  v_mfma_f32_16x16x32_bf16 v[0:3], a[92:95], v[96:99], v[0:3]
  ds_read_b128 v[88:91], v241 offset:43008
  v_mul_f32 v31, 0x3acccccd, v31
  v_mfma_f32_16x16x32_bf16 v[4:7], a[92:95], v[100:103], v[4:7]
  s_waitcnt lgkmcnt(5)
  ds_read_b128 v[92:95], v241 offset:44032
  s_xor_b32 s55, s41, 16384
  buffer_load_dwordx4 v[188:191], v225, s[96:99], s55 offen sc1
  v_mfma_f32_16x16x32_bf16 v[8:11], a[92:95], v[64:67], v[8:11]
  ds_read_b128 v[96:99], v241 offset:45056
  v_mul_f32 v35, 0x3acccccd, v35
  v_mfma_f32_16x16x32_bf16 v[12:15], a[92:95], v[68:71], v[12:15]
  s_waitcnt lgkmcnt(5)
  ds_read_b128 v[100:103], v241 offset:46080
  v_fma_f32 v32, -v28, v28, v32
  v_mfma_f32_16x16x32_bf16 v[16:19], a[92:95], v[72:75], v[16:19]
  ds_read_b128 v[64:67], v241 offset:47104
  v_max_f32 v32, 0, v32
  v_mfma_f32_16x16x32_bf16 v[20:23], a[92:95], v[76:79], v[20:23]
  s_waitcnt lgkmcnt(5)
  ds_read_b128 v[68:71], v241 offset:48128
  v_add_f32 v32, 0x3727c5ac, v32
  v_mfma_f32_16x16x32_bf16 v[24:27], a[92:95], v[80:83], v[24:27]
  ds_read_b128 v[72:75], v241 offset:49152
  s_xor_b32 s55, s42, 16384
  buffer_load_dwordx4 v[112:115], v225, s[96:99], s55 offen sc1
  s_waitcnt vmcnt(11)
  v_mfma_f32_16x16x32_bf16 v[0:3], a[96:99], v[84:87], v[0:3]
  s_waitcnt lgkmcnt(5)
  ds_read_b128 v[76:79], v241 offset:50176
  v_rsq_f32 v32, v32
  v_mfma_f32_16x16x32_bf16 v[4:7], a[96:99], v[88:91], v[4:7]
  ds_read_b128 v[80:83], v241 offset:51200
  v_fma_f32 v33, -v29, v29, v33
  v_mfma_f32_16x16x32_bf16 v[8:11], a[96:99], v[92:95], v[8:11]
  s_waitcnt lgkmcnt(5)
  ds_read_b128 v[84:87], v241 offset:52224
  v_max_f32 v33, 0, v33
  v_mfma_f32_16x16x32_bf16 v[12:15], a[96:99], v[96:99], v[12:15]
  ds_read_b128 v[88:91], v241 offset:53248
  v_add_f32 v33, 0x3727c5ac, v33
  v_mfma_f32_16x16x32_bf16 v[16:19], a[96:99], v[100:103], v[16:19]
  s_waitcnt lgkmcnt(5)
  ds_read_b128 v[92:95], v241 offset:54272
  s_xor_b32 s55, s43, 16384
  buffer_load_dwordx4 v[116:119], v225, s[96:99], s55 offen sc1
  v_mfma_f32_16x16x32_bf16 v[20:23], a[96:99], v[64:67], v[20:23]
  ds_read_b128 v[96:99], v241 offset:55296
  v_rsq_f32 v33, v33
  v_mfma_f32_16x16x32_bf16 v[24:27], a[96:99], v[68:71], v[24:27]
  s_waitcnt lgkmcnt(5)
  ds_read_b128 v[100:103], v241 offset:56320
  v_fma_f32 v34, -v30, v30, v34
  s_waitcnt vmcnt(11)
  v_mfma_f32_16x16x32_bf16 v[0:3], a[100:103], v[72:75], v[0:3]
  ds_read_b128 v[64:67], v241 offset:57344
  v_max_f32 v34, 0, v34
  v_mfma_f32_16x16x32_bf16 v[4:7], a[100:103], v[76:79], v[4:7]
  s_waitcnt lgkmcnt(5)
  ds_read_b128 v[68:71], v241 offset:58368
  v_add_f32 v34, 0x3727c5ac, v34
  v_mfma_f32_16x16x32_bf16 v[8:11], a[100:103], v[80:83], v[8:11]
  ds_read_b128 v[72:75], v241 offset:59392
  s_xor_b32 s55, s40, 20480
  buffer_load_dwordx4 v[120:123], v225, s[96:99], s55 offen sc1
  v_mfma_f32_16x16x32_bf16 v[12:15], a[100:103], v[84:87], v[12:15]
  s_waitcnt lgkmcnt(5)
  ds_read_b128 v[76:79], v241 offset:60416
  v_rsq_f32 v34, v34
  v_mfma_f32_16x16x32_bf16 v[16:19], a[100:103], v[88:91], v[16:19]
  ds_read_b128 v[80:83], v241 offset:61440
  v_fma_f32 v35, -v31, v31, v35
  v_mfma_f32_16x16x32_bf16 v[20:23], a[100:103], v[92:95], v[20:23]
  s_waitcnt lgkmcnt(5)
  ds_read_b128 v[84:87], v241 offset:62464
  v_max_f32 v35, 0, v35
  v_mfma_f32_16x16x32_bf16 v[24:27], a[100:103], v[96:99], v[24:27]
  ds_read_b128 v[88:91], v241 offset:63488
  v_add_f32 v35, 0x3727c5ac, v35
  s_waitcnt vmcnt(11)
  v_mfma_f32_16x16x32_bf16 v[0:3], a[104:107], v[100:103], v[0:3]
  s_waitcnt lgkmcnt(5)
  ds_read_b128 v[92:95], v241 offset:64512
  s_xor_b32 s55, s41, 20480
  buffer_load_dwordx4 a[228:231], v225, s[96:99], s55 offen sc1
  v_mfma_f32_16x16x32_bf16 v[4:7], a[104:107], v[64:67], v[4:7]
  ds_read_b128 v[96:99], v242 offset:0
  v_rsq_f32 v35, v35
  v_mfma_f32_16x16x32_bf16 v[8:11], a[104:107], v[68:71], v[8:11]
  s_waitcnt lgkmcnt(5)
  ds_read_b128 v[100:103], v242 offset:1024
  s_nop 0
  v_mfma_f32_16x16x32_bf16 v[12:15], a[104:107], v[72:75], v[12:15]
  ds_read_b128 v[64:67], v242 offset:2048
  ds_read_b32 v36, v244 offset:1536
  ds_read_b32 v44, v244 offset:2560
  v_mfma_f32_16x16x32_bf16 v[16:19], a[104:107], v[76:79], v[16:19]
  s_waitcnt lgkmcnt(7)
  ds_read_b128 v[68:71], v242 offset:3072
  ds_read_b32 v37, v244 offset:1600
  ds_read_b32 v45, v244 offset:2624
  v_mfma_f32_16x16x32_bf16 v[20:23], a[104:107], v[80:83], v[20:23]
  ds_read_b128 v[72:75], v242 offset:4096
  ds_read_b32 v38, v244 offset:1664
  ds_read_b32 v46, v244 offset:2688
  v_mfma_f32_16x16x32_bf16 v[24:27], a[104:107], v[84:87], v[24:27]
  s_waitcnt lgkmcnt(11)
  ds_read_b128 v[76:79], v242 offset:5120
  ds_read_b32 v39, v244 offset:1728
  ds_read_b32 v47, v244 offset:2752
  s_waitcnt vmcnt(11)
  v_mfma_f32_16x16x32_bf16 v[0:3], a[36:39], v[88:91], v[0:3]
  ds_read_b128 v[80:83], v242 offset:6144
  ds_read_b32 v40, v244 offset:1792
  ds_read_b32 v48, v244 offset:2816
  v_mfma_f32_16x16x32_bf16 v[4:7], a[36:39], v[92:95], v[4:7]
  s_waitcnt lgkmcnt(15)
  ds_read_b128 v[84:87], v242 offset:7168
  ds_read_b32 v41, v244 offset:1856
  ds_read_b32 v49, v244 offset:2880
  v_mfma_f32_16x16x32_bf16 v[8:11], a[36:39], v[96:99], v[8:11]
  ds_read_b128 v[88:91], v242 offset:8192
  ds_read_b32 v42, v244 offset:1920
  ds_read_b32 v50, v244 offset:2944
  v_mfma_f32_16x16x32_bf16 v[12:15], a[36:39], v[100:103], v[12:15]
  s_waitcnt lgkmcnt(15)
  ds_read_b128 v[92:95], v242 offset:9216
  v_mfma_f32_16x16x32_bf16 v[16:19], a[36:39], v[64:67], v[16:19]
  ds_read_b128 v[96:99], v242 offset:10240
  v_mfma_f32_16x16x32_bf16 v[20:23], a[36:39], v[68:71], v[20:23]
  s_waitcnt lgkmcnt(13)
  ds_read_b128 v[100:103], v242 offset:11264
  v_mfma_f32_16x16x32_bf16 v[24:27], a[36:39], v[72:75], v[24:27]
  s_waitcnt vmcnt(10)
  v_mfma_f32_16x16x32_bf16 v[0:3], a[224:227], v[76:79], v[0:3]
  s_waitcnt lgkmcnt(8)
  v_mfma_f32_16x16x32_bf16 v[4:7], a[224:227], v[80:83], v[4:7]
  v_mfma_f32_16x16x32_bf16 v[8:11], a[224:227], v[84:87], v[8:11]
  s_waitcnt lgkmcnt(2)
  v_mfma_f32_16x16x32_bf16 v[12:15], a[224:227], v[88:91], v[12:15]
  v_mfma_f32_16x16x32_bf16 v[16:19], a[224:227], v[92:95], v[16:19]
  s_waitcnt lgkmcnt(0)
  v_mfma_f32_16x16x32_bf16 v[20:23], a[224:227], v[96:99], v[20:23]
  v_mfma_f32_16x16x32_bf16 v[24:27], a[224:227], v[100:103], v[24:27]
  s_waitcnt lgkmcnt(0)
  s_barrier
  v_mov_b32 v108, 0xbdd2d3e8
  v_mov_b32 v109, 0xc0135761
  v_pk_fma_f32 v[0:1], v[28:29], v[36:37], v[0:1] op_sel:[0,0,0] op_sel_hi:[1,0,1] neg_lo:[1,0,0] neg_hi:[1,0,0]
  v_pk_fma_f32 v[2:3], v[30:31], v[36:37], v[2:3] op_sel:[0,0,0] op_sel_hi:[1,0,1] neg_lo:[1,0,0] neg_hi:[1,0,0]
  v_pk_fma_f32 v[4:5], v[28:29], v[36:37], v[4:5] op_sel:[0,1,0] op_sel_hi:[1,1,1] neg_lo:[1,0,0] neg_hi:[1,0,0]
  v_pk_fma_f32 v[6:7], v[30:31], v[36:37], v[6:7] op_sel:[0,1,0] op_sel_hi:[1,1,1] neg_lo:[1,0,0] neg_hi:[1,0,0]
  v_pk_fma_f32 v[8:9], v[28:29], v[38:39], v[8:9] op_sel:[0,0,0] op_sel_hi:[1,0,1] neg_lo:[1,0,0] neg_hi:[1,0,0]
  v_pk_fma_f32 v[10:11], v[30:31], v[38:39], v[10:11] op_sel:[0,0,0] op_sel_hi:[1,0,1] neg_lo:[1,0,0] neg_hi:[1,0,0]
  v_pk_fma_f32 v[12:13], v[28:29], v[38:39], v[12:13] op_sel:[0,1,0] op_sel_hi:[1,1,1] neg_lo:[1,0,0] neg_hi:[1,0,0]
  v_pk_fma_f32 v[14:15], v[30:31], v[38:39], v[14:15] op_sel:[0,1,0] op_sel_hi:[1,1,1] neg_lo:[1,0,0] neg_hi:[1,0,0]
  v_pk_fma_f32 v[16:17], v[28:29], v[40:41], v[16:17] op_sel:[0,0,0] op_sel_hi:[1,0,1] neg_lo:[1,0,0] neg_hi:[1,0,0]
  v_pk_fma_f32 v[18:19], v[30:31], v[40:41], v[18:19] op_sel:[0,0,0] op_sel_hi:[1,0,1] neg_lo:[1,0,0] neg_hi:[1,0,0]
  v_pk_fma_f32 v[20:21], v[28:29], v[40:41], v[20:21] op_sel:[0,1,0] op_sel_hi:[1,1,1] neg_lo:[1,0,0] neg_hi:[1,0,0]
  v_pk_fma_f32 v[22:23], v[30:31], v[40:41], v[22:23] op_sel:[0,1,0] op_sel_hi:[1,1,1] neg_lo:[1,0,0] neg_hi:[1,0,0]
  s_mul_i32 s56, s3, 35840
  s_add_u32 m0, s56, 0
  s_add_u32 s54, s56, 0
  buffer_load_dwordx4 v225, s[32:35], s54 offen sc1 lds
  v_pk_fma_f32 v[24:25], v[28:29], v[42:43], v[24:25] op_sel:[0,0,0] op_sel_hi:[1,0,1] neg_lo:[1,0,0] neg_hi:[1,0,0]
  v_pk_fma_f32 v[26:27], v[30:31], v[42:43], v[26:27] op_sel:[0,0,0] op_sel_hi:[1,0,1] neg_lo:[1,0,0] neg_hi:[1,0,0]
  v_pk_fma_f32 v[0:1], v[0:1], v[32:33], v[44:45] op_sel:[0,0,0] op_sel_hi:[1,1,0]
  v_pk_fma_f32 v[2:3], v[2:3], v[34:35], v[44:45] op_sel:[0,0,0] op_sel_hi:[1,1,0]
  v_pk_fma_f32 v[4:5], v[4:5], v[32:33], v[44:45] op_sel:[0,0,1] op_sel_hi:[1,1,1]
  v_pk_fma_f32 v[6:7], v[6:7], v[34:35], v[44:45] op_sel:[0,0,1] op_sel_hi:[1,1,1]
  v_pk_fma_f32 v[8:9], v[8:9], v[32:33], v[46:47] op_sel:[0,0,0] op_sel_hi:[1,1,0]
  v_pk_fma_f32 v[10:11], v[10:11], v[34:35], v[46:47] op_sel:[0,0,0] op_sel_hi:[1,1,0]
  v_pk_fma_f32 v[12:13], v[12:13], v[32:33], v[46:47] op_sel:[0,0,1] op_sel_hi:[1,1,1]
  v_pk_fma_f32 v[14:15], v[14:15], v[34:35], v[46:47] op_sel:[0,0,1] op_sel_hi:[1,1,1]
  v_pk_fma_f32 v[16:17], v[16:17], v[32:33], v[48:49] op_sel:[0,0,0] op_sel_hi:[1,1,0]
  v_pk_fma_f32 v[18:19], v[18:19], v[34:35], v[48:49] op_sel:[0,0,0] op_sel_hi:[1,1,0]
  v_pk_fma_f32 v[20:21], v[20:21], v[32:33], v[48:49] op_sel:[0,0,1] op_sel_hi:[1,1,1]
  v_pk_fma_f32 v[22:23], v[22:23], v[34:35], v[48:49] op_sel:[0,0,1] op_sel_hi:[1,1,1]
  s_add_u32 m0, s56, 1024
  s_add_u32 s54, s56, 1024
  buffer_load_dwordx4 v225, s[32:35], s54 offen sc1 lds
  v_pk_fma_f32 v[24:25], v[24:25], v[32:33], v[50:51] op_sel:[0,0,0] op_sel_hi:[1,1,0]
  v_pk_fma_f32 v[26:27], v[26:27], v[34:35], v[50:51] op_sel:[0,0,0] op_sel_hi:[1,1,0]
  v_pk_mul_f32 v[244:245], v[0:1], v[0:1]
  v_pk_mul_f32 v[246:247], v[2:3], v[2:3]
  v_pk_fma_f32 v[244:245], v[244:245], v[108:109], v[108:109] op_sel:[0,0,1] op_sel_hi:[1,0,1]
  v_pk_fma_f32 v[246:247], v[246:247], v[108:109], v[108:109] op_sel:[0,0,1] op_sel_hi:[1,0,1]
  v_pk_mul_f32 v[244:245], v[244:245], v[0:1]
  v_pk_mul_f32 v[246:247], v[246:247], v[2:3]
  v_exp_f32 v244, v244
  v_exp_f32 v245, v245
  v_exp_f32 v246, v246
  v_exp_f32 v247, v247
  v_pk_add_f32 v[244:245], v[244:245], 1.0 op_sel_hi:[1,0]
  v_pk_add_f32 v[246:247], v[246:247], 1.0 op_sel_hi:[1,0]
  s_add_u32 m0, s56, 2048
  s_add_u32 s54, s56, 2048
  buffer_load_dwordx4 v225, s[32:35], s54 offen sc1 lds
  v_rcp_f32 v244, v244
  v_rcp_f32 v245, v245
  v_rcp_f32 v246, v246
  v_rcp_f32 v247, v247
  v_pk_mul_f32 v[0:1], v[0:1], v[244:245]
  v_pk_mul_f32 v[2:3], v[2:3], v[246:247]
  v_pk_mul_f32 v[244:245], v[4:5], v[4:5]
  v_pk_mul_f32 v[246:247], v[6:7], v[6:7]
  v_pk_fma_f32 v[244:245], v[244:245], v[108:109], v[108:109] op_sel:[0,0,1] op_sel_hi:[1,0,1]
  v_pk_fma_f32 v[246:247], v[246:247], v[108:109], v[108:109] op_sel:[0,0,1] op_sel_hi:[1,0,1]
  v_pk_mul_f32 v[244:245], v[244:245], v[4:5]
  v_pk_mul_f32 v[246:247], v[246:247], v[6:7]
  v_exp_f32 v244, v244
  v_exp_f32 v245, v245
  s_add_u32 m0, s56, 3072
  s_add_u32 s54, s56, 3072
  buffer_load_dwordx4 v225, s[32:35], s54 offen sc1 lds
  v_exp_f32 v246, v246
  v_exp_f32 v247, v247
  v_pk_add_f32 v[244:245], v[244:245], 1.0 op_sel_hi:[1,0]
  v_pk_add_f32 v[246:247], v[246:247], 1.0 op_sel_hi:[1,0]
  v_rcp_f32 v244, v244
  v_rcp_f32 v245, v245
  v_rcp_f32 v246, v246
  v_rcp_f32 v247, v247
  v_pk_mul_f32 v[4:5], v[4:5], v[244:245]
  v_pk_mul_f32 v[6:7], v[6:7], v[246:247]
  v_pk_mul_f32 v[244:245], v[8:9], v[8:9]
  v_pk_mul_f32 v[246:247], v[10:11], v[10:11]
  v_pk_fma_f32 v[244:245], v[244:245], v[108:109], v[108:109] op_sel:[0,0,1] op_sel_hi:[1,0,1]
  v_pk_fma_f32 v[246:247], v[246:247], v[108:109], v[108:109] op_sel:[0,0,1] op_sel_hi:[1,0,1]
  s_add_u32 m0, s56, 4096
  s_add_u32 s54, s56, 4096
  buffer_load_dwordx4 v225, s[32:35], s54 offen sc1 lds
  v_pk_mul_f32 v[244:245], v[244:245], v[8:9]
  v_pk_mul_f32 v[246:247], v[246:247], v[10:11]
  v_exp_f32 v244, v244
  v_exp_f32 v245, v245
  v_exp_f32 v246, v246
  v_exp_f32 v247, v247
  v_pk_add_f32 v[244:245], v[244:245], 1.0 op_sel_hi:[1,0]
  v_pk_add_f32 v[246:247], v[246:247], 1.0 op_sel_hi:[1,0]
  v_rcp_f32 v244, v244
  v_rcp_f32 v245, v245
  v_rcp_f32 v246, v246
  v_rcp_f32 v247, v247
  v_pk_mul_f32 v[8:9], v[8:9], v[244:245]
  v_pk_mul_f32 v[10:11], v[10:11], v[246:247]
  s_add_u32 m0, s56, 5120
  s_add_u32 s54, s56, 5120
  buffer_load_dwordx4 v225, s[32:35], s54 offen sc1 lds
  v_pk_mul_f32 v[244:245], v[12:13], v[12:13]
  v_pk_mul_f32 v[246:247], v[14:15], v[14:15]
  v_pk_fma_f32 v[244:245], v[244:245], v[108:109], v[108:109] op_sel:[0,0,1] op_sel_hi:[1,0,1]
  v_pk_fma_f32 v[246:247], v[246:247], v[108:109], v[108:109] op_sel:[0,0,1] op_sel_hi:[1,0,1]
  v_pk_mul_f32 v[244:245], v[244:245], v[12:13]
  v_pk_mul_f32 v[246:247], v[246:247], v[14:15]
  v_exp_f32 v244, v244
  v_exp_f32 v245, v245
  v_exp_f32 v246, v246
  v_exp_f32 v247, v247
  v_pk_add_f32 v[244:245], v[244:245], 1.0 op_sel_hi:[1,0]
  v_pk_add_f32 v[246:247], v[246:247], 1.0 op_sel_hi:[1,0]
  v_rcp_f32 v244, v244
  v_rcp_f32 v245, v245
  s_add_u32 m0, s56, 6144
  s_add_u32 s54, s56, 6144
  buffer_load_dwordx4 v225, s[32:35], s54 offen sc1 lds
  v_rcp_f32 v246, v246
  v_rcp_f32 v247, v247
  v_pk_mul_f32 v[12:13], v[12:13], v[244:245]
  v_pk_mul_f32 v[14:15], v[14:15], v[246:247]
  v_pk_mul_f32 v[244:245], v[16:17], v[16:17]
  v_pk_mul_f32 v[246:247], v[18:19], v[18:19]
  v_pk_fma_f32 v[244:245], v[244:245], v[108:109], v[108:109] op_sel:[0,0,1] op_sel_hi:[1,0,1]
  v_pk_fma_f32 v[246:247], v[246:247], v[108:109], v[108:109] op_sel:[0,0,1] op_sel_hi:[1,0,1]
  v_pk_mul_f32 v[244:245], v[244:245], v[16:17]
  v_pk_mul_f32 v[246:247], v[246:247], v[18:19]
  v_exp_f32 v244, v244
  v_exp_f32 v245, v245
  v_exp_f32 v246, v246
  v_exp_f32 v247, v247
  s_add_u32 m0, s56, 7168
  s_add_u32 s54, s56, 7168
  buffer_load_dwordx4 v225, s[32:35], s54 offen sc1 lds
  v_pk_add_f32 v[244:245], v[244:245], 1.0 op_sel_hi:[1,0]
  v_pk_add_f32 v[246:247], v[246:247], 1.0 op_sel_hi:[1,0]
  v_rcp_f32 v244, v244
  v_rcp_f32 v245, v245
  v_rcp_f32 v246, v246
  v_rcp_f32 v247, v247
  v_pk_mul_f32 v[16:17], v[16:17], v[244:245]
  v_pk_mul_f32 v[18:19], v[18:19], v[246:247]
  v_pk_mul_f32 v[244:245], v[20:21], v[20:21]
  v_pk_mul_f32 v[246:247], v[22:23], v[22:23]
  v_pk_fma_f32 v[244:245], v[244:245], v[108:109], v[108:109] op_sel:[0,0,1] op_sel_hi:[1,0,1]
  v_pk_fma_f32 v[246:247], v[246:247], v[108:109], v[108:109] op_sel:[0,0,1] op_sel_hi:[1,0,1]
  v_pk_mul_f32 v[244:245], v[244:245], v[20:21]
  v_pk_mul_f32 v[246:247], v[246:247], v[22:23]
  s_add_u32 m0, s56, 8192
  s_add_u32 s54, s56, 8192
  buffer_load_dwordx4 v225, s[32:35], s54 offen sc1 lds
  v_exp_f32 v244, v244
  v_exp_f32 v245, v245
  v_exp_f32 v246, v246
  v_exp_f32 v247, v247
  v_pk_add_f32 v[244:245], v[244:245], 1.0 op_sel_hi:[1,0]
  v_pk_add_f32 v[246:247], v[246:247], 1.0 op_sel_hi:[1,0]
  v_rcp_f32 v244, v244
  v_rcp_f32 v245, v245
  v_rcp_f32 v246, v246
  v_rcp_f32 v247, v247
  v_pk_mul_f32 v[20:21], v[20:21], v[244:245]
  v_pk_mul_f32 v[22:23], v[22:23], v[246:247]
  v_pk_mul_f32 v[244:245], v[24:25], v[24:25]
  v_pk_mul_f32 v[246:247], v[26:27], v[26:27]
  s_add_u32 m0, s56, 9216
  s_add_u32 s54, s56, 9216
  buffer_load_dwordx4 v225, s[32:35], s54 offen sc1 lds
  v_pk_fma_f32 v[244:245], v[244:245], v[108:109], v[108:109] op_sel:[0,0,1] op_sel_hi:[1,0,1]
  v_pk_fma_f32 v[246:247], v[246:247], v[108:109], v[108:109] op_sel:[0,0,1] op_sel_hi:[1,0,1]
  v_pk_mul_f32 v[244:245], v[244:245], v[24:25]
  v_pk_mul_f32 v[246:247], v[246:247], v[26:27]
  v_exp_f32 v244, v244
  v_exp_f32 v245, v245
  v_exp_f32 v246, v246
  v_exp_f32 v247, v247
  v_pk_add_f32 v[244:245], v[244:245], 1.0 op_sel_hi:[1,0]
  v_pk_add_f32 v[246:247], v[246:247], 1.0 op_sel_hi:[1,0]
  v_rcp_f32 v244, v244
  v_rcp_f32 v245, v245
  v_rcp_f32 v246, v246
  v_rcp_f32 v247, v247
  s_add_u32 m0, s56, 10240
  s_add_u32 s54, s56, 10240
  buffer_load_dwordx4 v225, s[32:35], s54 offen sc1 lds
  v_pk_mul_f32 v[24:25], v[24:25], v[244:245]
  v_pk_mul_f32 v[26:27], v[26:27], v[246:247]
  v_pk_add_f32 v[56:57], v[0:1], v[4:5]
  v_pk_mul_f32 v[60:61], v[0:1], v[0:1]
  v_pk_add_f32 v[58:59], v[2:3], v[6:7]
  v_pk_mul_f32 v[62:63], v[2:3], v[2:3]
  v_pk_fma_f32 v[60:61], v[4:5], v[4:5], v[60:61]
  v_pk_fma_f32 v[62:63], v[6:7], v[6:7], v[62:63]
  v_pk_add_f32 v[56:57], v[56:57], v[8:9]
  v_pk_fma_f32 v[60:61], v[8:9], v[8:9], v[60:61]
  v_pk_add_f32 v[58:59], v[58:59], v[10:11]
  v_pk_fma_f32 v[62:63], v[10:11], v[10:11], v[62:63]
  v_pk_add_f32 v[56:57], v[56:57], v[12:13]
  v_pk_fma_f32 v[60:61], v[12:13], v[12:13], v[60:61]
  s_add_u32 m0, s56, 11264
  s_add_u32 s54, s56, 11264
  buffer_load_dwordx4 v225, s[32:35], s54 offen sc1 lds
  v_pk_add_f32 v[58:59], v[58:59], v[14:15]
  v_pk_fma_f32 v[62:63], v[14:15], v[14:15], v[62:63]
  v_pk_add_f32 v[56:57], v[56:57], v[16:17]
  v_pk_fma_f32 v[60:61], v[16:17], v[16:17], v[60:61]
  v_pk_add_f32 v[58:59], v[58:59], v[18:19]
  v_pk_fma_f32 v[62:63], v[18:19], v[18:19], v[62:63]
  v_pk_add_f32 v[56:57], v[56:57], v[20:21]
  v_pk_fma_f32 v[60:61], v[20:21], v[20:21], v[60:61]
  v_pk_add_f32 v[58:59], v[58:59], v[22:23]
  v_pk_fma_f32 v[62:63], v[22:23], v[22:23], v[62:63]
  v_pk_add_f32 v[56:57], v[56:57], v[24:25]
  v_pk_fma_f32 v[60:61], v[24:25], v[24:25], v[60:61]
  v_pk_add_f32 v[58:59], v[58:59], v[26:27]
  v_pk_fma_f32 v[62:63], v[26:27], v[26:27], v[62:63]
  s_add_u32 m0, s56, 12288
  s_add_u32 s54, s56, 12288
  buffer_load_dwordx4 v225, s[32:35], s54 offen sc1 lds
  s_lshl_b32 s52, s57, 2
  s_add_u32 s52, s52, s3
  v_add_f32_dpp v56, v56, v56 row_ror:8 row_mask:0xf bank_mask:0xf
  v_add_f32_dpp v57, v57, v57 row_ror:8 row_mask:0xf bank_mask:0xf
  v_add_f32_dpp v58, v58, v58 row_ror:8 row_mask:0xf bank_mask:0xf
  v_add_f32_dpp v59, v59, v59 row_ror:8 row_mask:0xf bank_mask:0xf
  v_add_f32_dpp v60, v60, v60 row_ror:8 row_mask:0xf bank_mask:0xf
  v_add_f32_dpp v61, v61, v61 row_ror:8 row_mask:0xf bank_mask:0xf
  v_add_f32_dpp v62, v62, v62 row_ror:8 row_mask:0xf bank_mask:0xf
  v_add_f32_dpp v63, v63, v63 row_ror:8 row_mask:0xf bank_mask:0xf
  v_mov_b32_dpp v56, v60 quad_perm:[0,1,2,3] row_mask:0xf bank_mask:0xc
  v_mov_b32_dpp v57, v61 quad_perm:[0,1,2,3] row_mask:0xf bank_mask:0xc
  v_mov_b32_dpp v58, v62 quad_perm:[0,1,2,3] row_mask:0xf bank_mask:0xc
  v_mov_b32_dpp v59, v63 quad_perm:[0,1,2,3] row_mask:0xf bank_mask:0xc
  s_add_u32 m0, s56, 13312
  s_add_u32 s54, s56, 13312
  buffer_load_dwordx4 v225, s[32:35], s54 offen sc1 lds
  v_add_f32_dpp v56, v56, v56 quad_perm:[1,0,3,2] row_mask:0xf bank_mask:0xf
  v_add_f32_dpp v57, v57, v57 quad_perm:[1,0,3,2] row_mask:0xf bank_mask:0xf
  v_add_f32_dpp v58, v58, v58 quad_perm:[1,0,3,2] row_mask:0xf bank_mask:0xf
  v_add_f32_dpp v59, v59, v59 quad_perm:[1,0,3,2] row_mask:0xf bank_mask:0xf
  v_add_f32_dpp v56, v56, v56 quad_perm:[2,3,0,1] row_mask:0xf bank_mask:0xf
  v_add_f32_dpp v57, v57, v57 quad_perm:[2,3,0,1] row_mask:0xf bank_mask:0xf
  v_add_f32_dpp v58, v58, v58 quad_perm:[2,3,0,1] row_mask:0xf bank_mask:0xf
  v_add_f32_dpp v59, v59, v59 quad_perm:[2,3,0,1] row_mask:0xf bank_mask:0xf
  v_add_f32_dpp v56, v56, v56 row_half_mirror row_mask:0xf bank_mask:0xf
  v_add_f32_dpp v57, v57, v57 row_half_mirror row_mask:0xf bank_mask:0xf
  v_add_f32_dpp v58, v58, v58 row_half_mirror row_mask:0xf bank_mask:0xf
  v_add_f32_dpp v59, v59, v59 row_half_mirror row_mask:0xf bank_mask:0xf
  s_lshl_b32 s52, s52, 10
  s_lshl_b32 s53, s58, 7
  s_add_u32 m0, s56, 14336
  s_add_u32 s54, s56, 14336
  buffer_load_dwordx4 v225, s[32:35], s54 offen sc1 lds
  s_add_u32 s53, s53, s52
  buffer_store_dwordx4 v[56:59], v255, s[48:51], s53 offen sc1
  s_lshl_b32 s53, s58, 17
  s_add_u32 s61, s53, s52
  s_lshl_b32 s52, s58, 6
  s_lshl_b32 s53, s57, 1
  s_add_u32 s52, s52, s53
  s_lshr_b32 s53, s3, 1
  s_add_u32 s52, s52, s53
  s_add_u32 m0, s56, 15360
  s_add_u32 s54, s56, 15360
  buffer_load_dwordx4 v225, s[32:35], s54 offen sc1 lds
  s_mul_i32 s52, s52, 7168
  s_add_u32 s52, s52, 14680064
  s_add_u32 s44, s4, s52
  s_addc_u32 s45, s5, 0
  s_mov_b32 s46, 7168
  s_add_u32 m0, s56, 16384
  s_add_u32 s54, s56, 16384
  buffer_load_dwordx4 v225, s[32:35], s54 offen sc1 lds
  s_mov_b32 s47, 0x20000
  s_lshl_b32 s52, s3, 12
  s_add_u32 s52, s52, 143360
  v_lshrrev_b32 v246, 4, v224
  v_lshl_add_u32 v246, v246, 4, s52
  s_add_u32 m0, s56, 17408
  s_add_u32 s54, s56, 17408
  buffer_load_dwordx4 v225, s[32:35], s54 offen sc1 lds
  v_add_f32 v250, v250, v252
  v_add_f32 v251, v251, v253
  v_mov_b32 v252, v250
  v_mov_b32 v253, v251
  s_nop 1
  s_add_u32 m0, s56, 18432
  s_add_u32 s54, s56, 18432
  buffer_load_dwordx4 v225, s[32:35], s54 offen sc1 lds
  v_permlane32_swap_b32 v250, v252
  v_permlane32_swap_b32 v251, v253
  s_nop 0
  v_add_f32 v250, v250, v252
  v_add_f32 v251, v251, v253
  s_add_u32 m0, s56, 19456
  s_add_u32 s54, s56, 19456
  buffer_load_dwordx4 v225, s[32:35], s54 offen sc1 lds
  v_mov_b32 v252, v250
  v_mov_b32 v253, v251
  s_nop 1
  v_permlane16_swap_b32 v250, v252
  v_permlane16_swap_b32 v251, v253
  s_add_u32 m0, s56, 20480
  s_add_u32 s54, s56, 20480
  buffer_load_dwordx4 v225, s[32:35], s54 offen sc1 lds
  s_nop 0
  v_add_f32 v250, v250, v252
  v_add_f32 v251, v251, v253
  v_mul_f32 v250, 0x3acccccd, v250
  v_mul_f32 v251, 0x3acccccd, v251
  s_add_u32 m0, s56, 21504
  s_add_u32 s54, s56, 21504
  buffer_load_dwordx4 v225, s[32:35], s54 offen sc1 lds
  v_fma_f32 v251, -v250, v250, v251
  v_max_f32 v251, 0, v251
  v_add_f32 v251, 0x3727c5ac, v251
  v_rsq_f32 v251, v251
  s_nop 0
  s_add_u32 m0, s56, 22528
  s_add_u32 s54, s56, 22528
  buffer_load_dwordx4 v225, s[32:35], s54 offen sc1 lds
  s_and_b32 s52, s3, 1
  s_lshl_b32 s52, s52, 9
  s_add_u32 s53, s52, 4096
  v_and_b32 v248, 0x1f0, v225
  v_lshrrev_b32 v249, 5, v224
  s_add_u32 m0, s56, 23552
  s_add_u32 s54, s56, 23552
  buffer_load_dwordx4 v225, s[32:35], s54 offen sc1 lds
  v_lshl_add_u32 v249, v249, 10, v248
  s_lshl_b32 s63, s58, 5
  s_add_u32 s63, s63, s57
  s_lshl_b32 s63, s63, 10
  v_and_b32 v238, 31, v224
  s_add_u32 m0, s56, 24576
  s_add_u32 s54, s56, 24576
  buffer_load_dwordx4 v225, s[32:35], s54 offen sc1 lds
  v_lshlrev_b32 v238, 2, v238
  s_add_u32 m0, s56, 25600
  s_add_u32 s54, s56, 25600
  buffer_load_dwordx4 v225, s[32:35], s54 offen sc1 lds
  s_add_u32 m0, s56, 26624
  s_add_u32 s54, s56, 26624
  buffer_load_dwordx4 v225, s[32:35], s54 offen sc1 lds
  s_add_u32 m0, s56, 27648
  s_add_u32 s54, s56, 27648
  buffer_load_dwordx4 v225, s[32:35], s54 offen sc1 lds
  s_add_u32 m0, s56, 28672
  s_add_u32 s54, s56, 28672
  buffer_load_dwordx4 v225, s[32:35], s54 offen sc1 lds
  buffer_load_dwordx4 v[56:59], v254, s[48:51], s61 offen sc1
  s_add_u32 m0, s56, 29696
  s_add_u32 s54, s56, 29696
  buffer_load_dwordx4 v225, s[32:35], s54 offen sc1 lds
  s_add_u32 m0, s56, 30720
  s_add_u32 s54, s56, 30720
  buffer_load_dwordx4 v225, s[32:35], s54 offen sc1 lds
  s_add_u32 m0, s56, 31744
  s_add_u32 s54, s56, 31744
  buffer_load_dwordx4 v225, s[32:35], s54 offen sc1 lds
  s_add_u32 m0, s56, 32768
  s_add_u32 s54, s56, 32768
  buffer_load_dwordx4 v225, s[32:35], s54 offen sc1 lds
  s_add_u32 m0, s56, 33792
  s_add_u32 s54, s56, 33792
  buffer_load_dwordx4 v225, s[32:35], s54 offen sc1 lds
  s_add_u32 m0, s56, 34816
  s_add_u32 s54, s56, 34816
  buffer_load_dwordx4 v225, s[32:35], s54 offen sc1 lds
  s_waitcnt vmcnt(6)
  v_max_u32 v244, v56, v57
  v_max3_u32 v244, v244, v58, v59
  v_cmp_eq_u32 vcc, -1, v244
  s_cbranch_vccz L_adaL_spolled_84
  s_mov_b32 s59, 400000
L_adaL_spoll_83:
  buffer_load_dwordx4 v[56:59], v254, s[48:51], s61 offen sc1
  s_sub_u32 s59, s59, 1
  s_cbranch_scc1 L_adaL_spolled_84
  s_waitcnt vmcnt(0)
  v_max_u32 v244, v56, v57
  v_max3_u32 v244, v244, v58, v59
  v_cmp_eq_u32 vcc, -1, v244
  s_cbranch_vccnz L_adaL_spoll_83
L_adaL_spolled_84:
  v_add_f32_dpp v56, v56, v56 quad_perm:[1,0,3,2] row_mask:0xf bank_mask:0xf
  v_add_f32_dpp v57, v57, v57 quad_perm:[1,0,3,2] row_mask:0xf bank_mask:0xf
  v_add_f32_dpp v58, v58, v58 quad_perm:[1,0,3,2] row_mask:0xf bank_mask:0xf
  v_add_f32_dpp v59, v59, v59 quad_perm:[1,0,3,2] row_mask:0xf bank_mask:0xf
  v_add_f32_dpp v56, v56, v56 quad_perm:[2,3,0,1] row_mask:0xf bank_mask:0xf
  v_add_f32_dpp v57, v57, v57 quad_perm:[2,3,0,1] row_mask:0xf bank_mask:0xf
  v_add_f32_dpp v58, v58, v58 quad_perm:[2,3,0,1] row_mask:0xf bank_mask:0xf
  v_add_f32_dpp v59, v59, v59 quad_perm:[2,3,0,1] row_mask:0xf bank_mask:0xf
  v_add_f32_dpp v56, v56, v56 row_half_mirror row_mask:0xf bank_mask:0xf
  v_add_f32_dpp v57, v57, v57 row_half_mirror row_mask:0xf bank_mask:0xf
  v_add_f32_dpp v58, v58, v58 row_half_mirror row_mask:0xf bank_mask:0xf
  v_add_f32_dpp v59, v59, v59 row_half_mirror row_mask:0xf bank_mask:0xf
  v_mov_b32 v60, v56
  v_mov_b32 v61, v57
  v_mov_b32 v62, v58
  v_mov_b32 v63, v59
  v_mov_b32_dpp v60, v56 row_ror:8 row_mask:0xf bank_mask:0x3
  v_mov_b32_dpp v61, v57 row_ror:8 row_mask:0xf bank_mask:0x3
  v_mov_b32_dpp v62, v58 row_ror:8 row_mask:0xf bank_mask:0x3
  v_mov_b32_dpp v63, v59 row_ror:8 row_mask:0xf bank_mask:0x3
  v_mov_b32_dpp v56, v56 row_ror:8 row_mask:0xf bank_mask:0xc
  v_mov_b32_dpp v57, v57 row_ror:8 row_mask:0xf bank_mask:0xc
  v_mov_b32_dpp v58, v58 row_ror:8 row_mask:0xf bank_mask:0xc
  v_mov_b32_dpp v59, v59 row_ror:8 row_mask:0xf bank_mask:0xc
  v_mul_f32 v56, 0x3a97b426, v56
  v_mul_f32 v60, 0x3a97b426, v60
  v_mul_f32 v57, 0x3a97b426, v57
  v_mul_f32 v61, 0x3a97b426, v61
  v_mul_f32 v58, 0x3a97b426, v58
  v_mul_f32 v62, 0x3a97b426, v62
  v_mul_f32 v59, 0x3a97b426, v59
  v_mul_f32 v63, 0x3a97b426, v63
  v_fma_f32 v60, -v56, v56, v60
  v_max_f32 v60, 0, v60
  v_add_f32 v60, 0x3727c5ac, v60
  v_rsq_f32 v60, v60
  v_fma_f32 v61, -v57, v57, v61
  v_max_f32 v61, 0, v61
  v_add_f32 v61, 0x3727c5ac, v61
  v_rsq_f32 v61, v61
  v_fma_f32 v62, -v58, v58, v62
  v_max_f32 v62, 0, v62
  v_add_f32 v62, 0x3727c5ac, v62
  v_rsq_f32 v62, v62
  v_fma_f32 v63, -v59, v59, v63
  v_max_f32 v63, 0, v63
  v_add_f32 v63, 0x3727c5ac, v63
  v_rsq_f32 v63, v63
  s_nop 0
  v_pk_mul_f32 v[56:57], v[56:57], v[60:61]
  v_pk_mul_f32 v[58:59], v[58:59], v[62:63]
  v_pk_fma_f32 v[0:1], v[0:1], v[60:61], v[56:57] neg_lo:[0,0,1] neg_hi:[0,0,1]
  v_pk_fma_f32 v[2:3], v[2:3], v[62:63], v[58:59] neg_lo:[0,0,1] neg_hi:[0,0,1]
  v_cvt_pk_bf16_f32 v64, v0, v1
  v_cvt_pk_bf16_f32 v65, v2, v3
  v_pk_fma_f32 v[4:5], v[4:5], v[60:61], v[56:57] neg_lo:[0,0,1] neg_hi:[0,0,1]
  v_pk_fma_f32 v[6:7], v[6:7], v[62:63], v[58:59] neg_lo:[0,0,1] neg_hi:[0,0,1]
  v_cvt_pk_bf16_f32 v66, v4, v5
  v_cvt_pk_bf16_f32 v67, v6, v7
  s_nop 1
  v_permlane32_swap_b32 v64, v66
  v_permlane32_swap_b32 v65, v67
  buffer_store_dwordx4 v[64:67], v249, s[44:47], s52 offen offset:0 sc1
  v_pk_fma_f32 v[8:9], v[8:9], v[60:61], v[56:57] neg_lo:[0,0,1] neg_hi:[0,0,1]
  v_pk_fma_f32 v[10:11], v[10:11], v[62:63], v[58:59] neg_lo:[0,0,1] neg_hi:[0,0,1]
  v_cvt_pk_bf16_f32 v68, v8, v9
  v_cvt_pk_bf16_f32 v69, v10, v11
  v_pk_fma_f32 v[12:13], v[12:13], v[60:61], v[56:57] neg_lo:[0,0,1] neg_hi:[0,0,1]
  v_pk_fma_f32 v[14:15], v[14:15], v[62:63], v[58:59] neg_lo:[0,0,1] neg_hi:[0,0,1]
  v_cvt_pk_bf16_f32 v70, v12, v13
  v_cvt_pk_bf16_f32 v71, v14, v15
  s_nop 1
  v_permlane32_swap_b32 v68, v70
  v_permlane32_swap_b32 v69, v71
  buffer_store_dwordx4 v[68:71], v249, s[44:47], s52 offen offset:2048 sc1
  v_pk_fma_f32 v[16:17], v[16:17], v[60:61], v[56:57] neg_lo:[0,0,1] neg_hi:[0,0,1]
  v_pk_fma_f32 v[18:19], v[18:19], v[62:63], v[58:59] neg_lo:[0,0,1] neg_hi:[0,0,1]
  v_cvt_pk_bf16_f32 v72, v16, v17
  v_cvt_pk_bf16_f32 v73, v18, v19
  v_pk_fma_f32 v[20:21], v[20:21], v[60:61], v[56:57] neg_lo:[0,0,1] neg_hi:[0,0,1]
  v_pk_fma_f32 v[22:23], v[22:23], v[62:63], v[58:59] neg_lo:[0,0,1] neg_hi:[0,0,1]
  v_cvt_pk_bf16_f32 v74, v20, v21
  v_cvt_pk_bf16_f32 v75, v22, v23
  s_nop 1
  v_permlane32_swap_b32 v72, v74
  v_permlane32_swap_b32 v73, v75
  buffer_store_dwordx4 v[72:75], v249, s[44:47], s53 offen offset:0 sc1
  v_pk_fma_f32 v[24:25], v[24:25], v[60:61], v[56:57] neg_lo:[0,0,1] neg_hi:[0,0,1]
  v_pk_fma_f32 v[26:27], v[26:27], v[62:63], v[58:59] neg_lo:[0,0,1] neg_hi:[0,0,1]
  v_cvt_pk_bf16_f32 v76, v24, v25
  v_cvt_pk_bf16_f32 v77, v26, v27
  v_mov_b32 v78, v76
  v_mov_b32 v79, v77
  s_nop 1
  v_permlane32_swap_b32 v76, v78
  v_permlane32_swap_b32 v77, v79
  buffer_store_dwordx4 v[76:79], v248, s[44:47], s53 offen offset:2048 sc1
  s_waitcnt vmcnt(4)
  s_barrier
  ds_read_b128 v[28:31], v225 offset:0
  ds_read_b128 v[32:35], v225 offset:1024
  ds_read_b128 v[36:39], v225 offset:2048
  ds_read_b128 v[40:43], v225 offset:3072
  ds_read_b128 v[44:47], v225 offset:4096
  ds_read_b128 v[48:51], v225 offset:5120
  ds_read_b128 v[52:55], v225 offset:6144
  s_waitcnt lgkmcnt(5)
  v_mfma_f32_16x16x32_bf16 v[196:199], v[28:31], a[60:63], 0
  ds_read_b128 v[56:59], v225 offset:7168
  v_mfma_f32_16x16x32_bf16 v[200:203], v[32:35], a[60:63], 0
  s_waitcnt lgkmcnt(4)
  ds_read_b128 v[60:63], v225 offset:8192
  v_mfma_f32_16x16x32_bf16 v[204:207], v[36:39], a[60:63], 0
  ds_read_b128 v[28:31], v225 offset:9216
  v_mfma_f32_16x16x32_bf16 v[208:211], v[40:43], a[60:63], 0
  s_waitcnt lgkmcnt(4)
  ds_read_b128 v[32:35], v225 offset:10240
  v_mfma_f32_16x16x32_bf16 v[212:215], v[44:47], a[60:63], 0
  ds_read_b128 v[36:39], v225 offset:11264
  s_xor_b32 s55, s42, 20480
  buffer_load_dwordx4 a[232:235], v225, s[96:99], s55 offen sc1
  v_mfma_f32_16x16x32_bf16 v[216:219], v[48:51], a[60:63], 0
  s_waitcnt lgkmcnt(4)
  ds_read_b128 v[40:43], v225 offset:12288
  v_mfma_f32_16x16x32_bf16 v[220:223], v[52:55], a[60:63], 0
  ds_read_b128 v[44:47], v225 offset:13312
  v_mfma_f32_16x16x32_bf16 v[196:199], v[56:59], a[216:219], v[196:199]
  s_waitcnt lgkmcnt(4)
  ds_read_b128 v[48:51], v225 offset:14336
  v_mfma_f32_16x16x32_bf16 v[200:203], v[60:63], a[216:219], v[200:203]
  ds_read_b128 v[52:55], v225 offset:15360
  v_mfma_f32_16x16x32_bf16 v[204:207], v[28:31], a[216:219], v[204:207]
  s_waitcnt lgkmcnt(4)
  ds_read_b128 v[56:59], v225 offset:16384
  s_xor_b32 s55, s43, 20480
  buffer_load_dwordx4 a[128:131], v225, s[96:99], s55 offen sc1
  v_mfma_f32_16x16x32_bf16 v[208:211], v[32:35], a[216:219], v[208:211]
  ds_read_b128 v[60:63], v225 offset:17408
  v_mfma_f32_16x16x32_bf16 v[212:215], v[36:39], a[216:219], v[212:215]
  s_waitcnt lgkmcnt(4)
  ds_read_b128 v[28:31], v225 offset:18432
  v_mfma_f32_16x16x32_bf16 v[216:219], v[40:43], a[216:219], v[216:219]
  ds_read_b128 v[32:35], v225 offset:19456
  v_mfma_f32_16x16x32_bf16 v[220:223], v[44:47], a[216:219], v[220:223]
  s_waitcnt lgkmcnt(4)
  ds_read_b128 v[36:39], v225 offset:20480
  v_mfma_f32_16x16x32_bf16 v[196:199], v[48:51], a[220:223], v[196:199]
  ds_read_b128 v[40:43], v225 offset:21504
  s_xor_b32 s55, s40, 24576
  buffer_load_dwordx4 a[236:239], v225, s[96:99], s55 offen sc1
  v_mfma_f32_16x16x32_bf16 v[200:203], v[52:55], a[220:223], v[200:203]
  s_waitcnt lgkmcnt(4)
  ds_read_b128 v[44:47], v225 offset:22528
  v_mfma_f32_16x16x32_bf16 v[204:207], v[56:59], a[220:223], v[204:207]
  ds_read_b128 v[48:51], v225 offset:23552
  v_mfma_f32_16x16x32_bf16 v[208:211], v[60:63], a[220:223], v[208:211]
  s_waitcnt lgkmcnt(4)
  ds_read_b128 v[52:55], v225 offset:24576
  v_mfma_f32_16x16x32_bf16 v[212:215], v[28:31], a[220:223], v[212:215]
  ds_read_b128 v[56:59], v225 offset:25600
  v_mfma_f32_16x16x32_bf16 v[216:219], v[32:35], a[220:223], v[216:219]
  s_waitcnt lgkmcnt(4)
  ds_read_b128 v[60:63], v225 offset:26624
  s_xor_b32 s55, s41, 24576
  buffer_load_dwordx4 a[124:127], v225, s[96:99], s55 offen sc1
  v_mfma_f32_16x16x32_bf16 v[220:223], v[36:39], a[220:223], v[220:223]
  ds_read_b128 v[28:31], v225 offset:27648
  v_mfma_f32_16x16x32_bf16 v[196:199], v[40:43], a[244:247], v[196:199]
  s_waitcnt lgkmcnt(4)
  ds_read_b128 v[32:35], v225 offset:28672
  v_mfma_f32_16x16x32_bf16 v[200:203], v[44:47], a[244:247], v[200:203]
  ds_read_b128 v[36:39], v225 offset:29696
  v_mfma_f32_16x16x32_bf16 v[204:207], v[48:51], a[244:247], v[204:207]
  s_waitcnt lgkmcnt(4)
  ds_read_b128 v[40:43], v225 offset:30720
  v_mfma_f32_16x16x32_bf16 v[208:211], v[52:55], a[244:247], v[208:211]
  ds_read_b128 v[44:47], v225 offset:31744
  s_xor_b32 s55, s42, 24576
  buffer_load_dwordx4 a[12:15], v225, s[96:99], s55 offen sc1
  v_mfma_f32_16x16x32_bf16 v[212:215], v[56:59], a[244:247], v[212:215]
  s_waitcnt lgkmcnt(4)
  ds_read_b128 v[48:51], v225 offset:32768
  v_mfma_f32_16x16x32_bf16 v[216:219], v[60:63], a[244:247], v[216:219]
  ds_read_b128 v[52:55], v225 offset:33792
  v_mfma_f32_16x16x32_bf16 v[220:223], v[28:31], a[244:247], v[220:223]
  s_waitcnt lgkmcnt(4)
  ds_read_b128 v[56:59], v225 offset:34816
  v_mfma_f32_16x16x32_bf16 v[196:199], v[32:35], a[248:251], v[196:199]
  ds_read_b128 v[60:63], v225 offset:35840
  v_mfma_f32_16x16x32_bf16 v[200:203], v[36:39], a[248:251], v[200:203]
  s_waitcnt lgkmcnt(4)
  ds_read_b128 v[28:31], v225 offset:36864
  s_xor_b32 s55, s43, 24576
  buffer_load_dwordx4 a[40:43], v225, s[96:99], s55 offen sc1
  v_mfma_f32_16x16x32_bf16 v[204:207], v[40:43], a[248:251], v[204:207]
  ds_read_b128 v[32:35], v225 offset:37888
  v_mfma_f32_16x16x32_bf16 v[208:211], v[44:47], a[248:251], v[208:211]
  s_waitcnt lgkmcnt(4)
  ds_read_b128 v[36:39], v225 offset:38912
  v_mfma_f32_16x16x32_bf16 v[212:215], v[48:51], a[248:251], v[212:215]
  ds_read_b128 v[40:43], v225 offset:39936
  v_mfma_f32_16x16x32_bf16 v[216:219], v[52:55], a[248:251], v[216:219]
  s_waitcnt lgkmcnt(4)
  ds_read_b128 v[44:47], v225 offset:40960
  v_mfma_f32_16x16x32_bf16 v[220:223], v[56:59], a[248:251], v[220:223]
  ds_read_b128 v[48:51], v225 offset:41984
  s_xor_b32 s55, s40, 28672
  buffer_load_dwordx4 a[132:135], v225, s[96:99], s55 offen sc1
  v_mfma_f32_16x16x32_bf16 v[196:199], v[60:63], a[108:111], v[196:199]
  s_waitcnt lgkmcnt(4)
  ds_read_b128 v[52:55], v225 offset:43008
  v_mfma_f32_16x16x32_bf16 v[200:203], v[28:31], a[108:111], v[200:203]
  ds_read_b128 v[56:59], v225 offset:44032
  v_mfma_f32_16x16x32_bf16 v[204:207], v[32:35], a[108:111], v[204:207]
  s_waitcnt lgkmcnt(4)
  ds_read_b128 v[60:63], v225 offset:45056
  v_mfma_f32_16x16x32_bf16 v[208:211], v[36:39], a[108:111], v[208:211]
  ds_read_b128 v[28:31], v225 offset:46080
  v_mfma_f32_16x16x32_bf16 v[212:215], v[40:43], a[108:111], v[212:215]
  s_waitcnt lgkmcnt(4)
  ds_read_b128 v[32:35], v225 offset:47104
  s_xor_b32 s55, s41, 28672
  buffer_load_dwordx4 a[44:47], v225, s[96:99], s55 offen sc1
  v_mfma_f32_16x16x32_bf16 v[216:219], v[44:47], a[108:111], v[216:219]
  ds_read_b128 v[36:39], v225 offset:48128
  v_mfma_f32_16x16x32_bf16 v[220:223], v[48:51], a[108:111], v[220:223]
  s_waitcnt lgkmcnt(4)
  ds_read_b128 v[40:43], v225 offset:49152
  s_waitcnt vmcnt(8)
  s_barrier
  s_cmp_lg_u32 s3, 0
  s_cbranch_scc1 L_adaL_nopush_85
  s_lshl_b32 s52, s58, 15
  s_lshl_b32 s53, s57, 2
  s_add_u32 s52, s52, s53
  s_add_u32 s52, s52, 128
  v_lshlrev_b32 v248, 10, v224
  s_mov_b32 exec_hi, 0
  v_mov_b32 v249, 2
  buffer_store_dword v249, v248, s[8:11], s52 offen sc1
  s_mov_b64 exec, -1
L_adaL_nopush_85:
  v_mfma_f32_16x16x32_bf16 v[196:199], v[52:55], a[192:195], v[196:199]
  ds_read_b128 v[44:47], v225 offset:50176
  v_mfma_f32_16x16x32_bf16 v[200:203], v[56:59], a[192:195], v[200:203]
  s_waitcnt lgkmcnt(4)
  ds_read_b128 v[48:51], v225 offset:51200
  v_mfma_f32_16x16x32_bf16 v[204:207], v[60:63], a[192:195], v[204:207]
  ds_read_b128 v[52:55], v225 offset:52224
  s_xor_b32 s55, s42, 28672
  buffer_load_dwordx4 a[200:203], v225, s[96:99], s55 offen sc1
  v_mfma_f32_16x16x32_bf16 v[208:211], v[28:31], a[192:195], v[208:211]
  s_waitcnt lgkmcnt(4)
  ds_read_b128 v[56:59], v225 offset:53248
  v_mfma_f32_16x16x32_bf16 v[212:215], v[32:35], a[192:195], v[212:215]
  ds_read_b128 v[60:63], v225 offset:54272
  v_mfma_f32_16x16x32_bf16 v[216:219], v[36:39], a[192:195], v[216:219]
  s_waitcnt lgkmcnt(4)
  ds_read_b128 v[28:31], v225 offset:55296
  v_mfma_f32_16x16x32_bf16 v[220:223], v[40:43], a[192:195], v[220:223]
  ds_read_b128 v[32:35], v225 offset:56320
  v_mfma_f32_16x16x32_bf16 v[196:199], v[44:47], a[196:199], v[196:199]
  s_waitcnt lgkmcnt(4)
  ds_read_b128 v[36:39], v225 offset:57344
  s_xor_b32 s55, s43, 28672
  buffer_load_dwordx4 a[204:207], v225, s[96:99], s55 offen sc1
  v_mfma_f32_16x16x32_bf16 v[200:203], v[48:51], a[196:199], v[200:203]
  ds_read_b128 v[40:43], v225 offset:58368
  v_mfma_f32_16x16x32_bf16 v[204:207], v[52:55], a[196:199], v[204:207]
  s_waitcnt lgkmcnt(4)
  ds_read_b128 v[44:47], v225 offset:59392
  v_mfma_f32_16x16x32_bf16 v[208:211], v[56:59], a[196:199], v[208:211]
  ds_read_b128 v[48:51], v225 offset:60416
  v_mfma_f32_16x16x32_bf16 v[212:215], v[60:63], a[196:199], v[212:215]
  s_waitcnt lgkmcnt(4)
  ds_read_b128 v[52:55], v225 offset:61440
  v_mfma_f32_16x16x32_bf16 v[216:219], v[28:31], a[196:199], v[216:219]
  ds_read_b128 v[56:59], v225 offset:62464
  s_xor_b32 s55, s40, 32768
  buffer_load_dwordx4 a[112:115], v225, s[96:99], s55 offen sc1
  v_mfma_f32_16x16x32_bf16 v[220:223], v[32:35], a[196:199], v[220:223]
  s_waitcnt lgkmcnt(4)
  ds_read_b128 v[60:63], v225 offset:63488
  v_mfma_f32_16x16x32_bf16 v[196:199], v[36:39], a[240:243], v[196:199]
  ds_read_b128 v[28:31], v225 offset:64512
  v_mfma_f32_16x16x32_bf16 v[200:203], v[40:43], a[240:243], v[200:203]
  s_waitcnt lgkmcnt(4)
  ds_read_b128 v[32:35], v241 offset:0
  v_mfma_f32_16x16x32_bf16 v[204:207], v[44:47], a[240:243], v[204:207]
  ds_read_b128 v[36:39], v241 offset:1024
  v_mfma_f32_16x16x32_bf16 v[208:211], v[48:51], a[240:243], v[208:211]
  s_waitcnt lgkmcnt(4)
  ds_read_b128 v[40:43], v241 offset:2048
  s_xor_b32 s55, s41, 32768
  buffer_load_dwordx4 a[116:119], v225, s[96:99], s55 offen sc1
  v_mfma_f32_16x16x32_bf16 v[212:215], v[52:55], a[240:243], v[212:215]
  ds_read_b128 v[44:47], v241 offset:3072
  v_mfma_f32_16x16x32_bf16 v[216:219], v[56:59], a[240:243], v[216:219]
  s_waitcnt lgkmcnt(4)
  ds_read_b128 v[48:51], v241 offset:4096
  v_mfma_f32_16x16x32_bf16 v[220:223], v[60:63], a[240:243], v[220:223]
  ds_read_b128 v[52:55], v241 offset:5120
  v_mfma_f32_16x16x32_bf16 v[196:199], v[28:31], a[252:255], v[196:199]
  s_waitcnt lgkmcnt(4)
  ds_read_b128 v[56:59], v241 offset:6144
  v_mfma_f32_16x16x32_bf16 v[200:203], v[32:35], a[252:255], v[200:203]
  ds_read_b128 v[60:63], v241 offset:7168
  s_xor_b32 s55, s42, 32768
  buffer_load_dwordx4 a[16:19], v225, s[96:99], s55 offen sc1
  v_mfma_f32_16x16x32_bf16 v[204:207], v[36:39], a[252:255], v[204:207]
  s_waitcnt lgkmcnt(4)
  ds_read_b128 v[28:31], v241 offset:8192
  v_mfma_f32_16x16x32_bf16 v[208:211], v[40:43], a[252:255], v[208:211]
  ds_read_b128 v[32:35], v241 offset:9216
  v_mfma_f32_16x16x32_bf16 v[212:215], v[44:47], a[252:255], v[212:215]
  s_waitcnt lgkmcnt(4)
  ds_read_b128 v[36:39], v241 offset:10240
  v_mfma_f32_16x16x32_bf16 v[216:219], v[48:51], a[252:255], v[216:219]
  ds_read_b128 v[40:43], v241 offset:11264
  v_mfma_f32_16x16x32_bf16 v[220:223], v[52:55], a[252:255], v[220:223]
  s_waitcnt lgkmcnt(4)
  ds_read_b128 v[44:47], v241 offset:12288
  s_xor_b32 s55, s43, 32768
  buffer_load_dwordx4 a[20:23], v225, s[96:99], s55 offen sc1
  v_mfma_f32_16x16x32_bf16 v[196:199], v[56:59], a[0:3], v[196:199]
  ds_read_b128 v[48:51], v241 offset:13312
  v_mfma_f32_16x16x32_bf16 v[200:203], v[60:63], a[0:3], v[200:203]
  s_waitcnt lgkmcnt(4)
  ds_read_b128 v[52:55], v241 offset:14336
  v_mfma_f32_16x16x32_bf16 v[204:207], v[28:31], a[0:3], v[204:207]
  ds_read_b128 v[56:59], v241 offset:15360
  v_mfma_f32_16x16x32_bf16 v[208:211], v[32:35], a[0:3], v[208:211]
  s_waitcnt lgkmcnt(4)
  ds_read_b128 v[60:63], v241 offset:16384
  v_mfma_f32_16x16x32_bf16 v[212:215], v[36:39], a[0:3], v[212:215]
  ds_read_b128 v[28:31], v241 offset:17408
  s_xor_b32 s55, s40, 36864
  buffer_load_dwordx4 a[48:51], v225, s[96:99], s55 offen sc1
  v_mfma_f32_16x16x32_bf16 v[216:219], v[40:43], a[0:3], v[216:219]
  s_waitcnt lgkmcnt(4)
  ds_read_b128 v[32:35], v241 offset:18432
  ds_read_b128 v[0:3], v246 offset:1024
  v_mfma_f32_16x16x32_bf16 v[220:223], v[44:47], a[0:3], v[220:223]
  ds_read_b128 v[36:39], v241 offset:19456
  ds_read_b128 v[4:7], v246 offset:1088
  v_mfma_f32_16x16x32_bf16 v[196:199], v[48:51], a[4:7], v[196:199]
  s_waitcnt lgkmcnt(6)
  ds_read_b128 v[40:43], v241 offset:20480
  ds_read_b128 v[8:11], v246 offset:1152
  v_mfma_f32_16x16x32_bf16 v[200:203], v[52:55], a[4:7], v[200:203]
  ds_read_b128 v[44:47], v241 offset:21504
  ds_read_b128 v[12:15], v246 offset:1216
  v_mfma_f32_16x16x32_bf16 v[204:207], v[56:59], a[4:7], v[204:207]
  s_waitcnt lgkmcnt(8)
  ds_read_b128 v[48:51], v241 offset:22528
  s_xor_b32 s55, s41, 36864
  buffer_load_dwordx4 a[52:55], v225, s[96:99], s55 offen sc1
  v_mfma_f32_16x16x32_bf16 v[208:211], v[60:63], a[4:7], v[208:211]
  ds_read_b128 v[52:55], v241 offset:23552
  ds_read_b128 v[16:19], v246 offset:1280
  v_mfma_f32_16x16x32_bf16 v[212:215], v[28:31], a[4:7], v[212:215]
  s_waitcnt lgkmcnt(8)
  ds_read_b128 v[56:59], v241 offset:24576
  ds_read_b128 v[20:23], v246 offset:1344
  v_mfma_f32_16x16x32_bf16 v[216:219], v[32:35], a[4:7], v[216:219]
  ds_read_b128 v[60:63], v241 offset:25600
  ds_read_b128 v[24:27], v246 offset:1408
  v_mfma_f32_16x16x32_bf16 v[220:223], v[36:39], a[4:7], v[220:223]
  s_waitcnt lgkmcnt(8)
  ds_read_b128 v[28:31], v241 offset:26624
  v_mfma_f32_16x16x32_bf16 v[196:199], v[40:43], a[32:35], v[196:199]
  ds_read_b128 v[32:35], v241 offset:27648
  s_xor_b32 s55, s42, 36864
  buffer_load_dwordx4 a[24:27], v225, s[96:99], s55 offen sc1
  v_mfma_f32_16x16x32_bf16 v[200:203], v[44:47], a[32:35], v[200:203]
  s_waitcnt lgkmcnt(7)
  ds_read_b128 v[36:39], v241 offset:28672
  v_mfma_f32_16x16x32_bf16 v[204:207], v[48:51], a[32:35], v[204:207]
  ds_read_b128 v[40:43], v241 offset:29696
  v_mfma_f32_16x16x32_bf16 v[208:211], v[52:55], a[32:35], v[208:211]
  s_waitcnt lgkmcnt(5)
  ds_read_b128 v[44:47], v241 offset:30720
  v_mfma_f32_16x16x32_bf16 v[212:215], v[56:59], a[32:35], v[212:215]
  ds_read_b128 v[48:51], v241 offset:31744
  v_mfma_f32_16x16x32_bf16 v[216:219], v[60:63], a[32:35], v[216:219]
  s_waitcnt lgkmcnt(4)
  ds_read_b128 v[52:55], v241 offset:32768
  s_xor_b32 s55, s43, 36864
  buffer_load_dwordx4 a[120:123], v225, s[96:99], s55 offen sc1
  v_mfma_f32_16x16x32_bf16 v[220:223], v[28:31], a[32:35], v[220:223]
  ds_read_b128 v[56:59], v241 offset:33792
  v_mfma_f32_16x16x32_bf16 v[196:199], v[32:35], a[8:11], v[196:199]
  s_waitcnt lgkmcnt(4)
  ds_read_b128 v[60:63], v241 offset:34816
  v_mfma_f32_16x16x32_bf16 v[200:203], v[36:39], a[8:11], v[200:203]
  ds_read_b128 v[28:31], v241 offset:35840
  v_mfma_f32_16x16x32_bf16 v[204:207], v[40:43], a[8:11], v[204:207]
  s_waitcnt lgkmcnt(4)
  ds_read_b128 v[32:35], v241 offset:36864
  v_mfma_f32_16x16x32_bf16 v[208:211], v[44:47], a[8:11], v[208:211]
  ds_read_b128 v[36:39], v241 offset:37888
  s_xor_b32 s55, s40, 40960
  buffer_load_dwordx4 a[88:91], v225, s[96:99], s55 offen sc1
  v_mfma_f32_16x16x32_bf16 v[212:215], v[48:51], a[8:11], v[212:215]
  s_waitcnt lgkmcnt(4)
  ds_read_b128 v[40:43], v241 offset:38912
  v_mfma_f32_16x16x32_bf16 v[216:219], v[52:55], a[8:11], v[216:219]
  ds_read_b128 v[44:47], v241 offset:39936
  v_mfma_f32_16x16x32_bf16 v[220:223], v[56:59], a[8:11], v[220:223]
  s_waitcnt lgkmcnt(4)
  ds_read_b128 v[48:51], v241 offset:40960
  v_mfma_f32_16x16x32_bf16 v[196:199], v[60:63], a[92:95], v[196:199]
  ds_read_b128 v[52:55], v241 offset:41984
  v_mfma_f32_16x16x32_bf16 v[200:203], v[28:31], a[92:95], v[200:203]
  s_waitcnt lgkmcnt(4)
  ds_read_b128 v[56:59], v241 offset:43008
  s_xor_b32 s55, s41, 40960
  buffer_load_dwordx4 a[136:139], v225, s[96:99], s55 offen sc1
  v_mfma_f32_16x16x32_bf16 v[204:207], v[32:35], a[92:95], v[204:207]
  ds_read_b128 v[60:63], v241 offset:44032
  v_mfma_f32_16x16x32_bf16 v[208:211], v[36:39], a[92:95], v[208:211]
  s_waitcnt lgkmcnt(4)
  ds_read_b128 v[28:31], v241 offset:45056
  v_mfma_f32_16x16x32_bf16 v[212:215], v[40:43], a[92:95], v[212:215]
  ds_read_b128 v[32:35], v241 offset:46080
  v_mfma_f32_16x16x32_bf16 v[216:219], v[44:47], a[92:95], v[216:219]
  s_waitcnt lgkmcnt(4)
  ds_read_b128 v[36:39], v241 offset:47104
  v_mfma_f32_16x16x32_bf16 v[220:223], v[48:51], a[92:95], v[220:223]
  ds_read_b128 v[40:43], v241 offset:48128
  s_xor_b32 s55, s42, 40960
  buffer_load_dwordx4 a[156:159], v225, s[96:99], s55 offen sc1
  v_mfma_f32_16x16x32_bf16 v[196:199], v[52:55], a[96:99], v[196:199]
  s_waitcnt lgkmcnt(4)
  ds_read_b128 v[44:47], v241 offset:49152
  v_mfma_f32_16x16x32_bf16 v[200:203], v[56:59], a[96:99], v[200:203]
  ds_read_b128 v[48:51], v241 offset:50176
  v_mfma_f32_16x16x32_bf16 v[204:207], v[60:63], a[96:99], v[204:207]
  s_waitcnt lgkmcnt(4)
  ds_read_b128 v[52:55], v241 offset:51200
  v_mfma_f32_16x16x32_bf16 v[208:211], v[28:31], a[96:99], v[208:211]
  ds_read_b128 v[56:59], v241 offset:52224
  v_mfma_f32_16x16x32_bf16 v[212:215], v[32:35], a[96:99], v[212:215]
  s_waitcnt lgkmcnt(4)
  ds_read_b128 v[60:63], v241 offset:53248
  s_xor_b32 s55, s43, 40960
  buffer_load_dwordx4 a[176:179], v225, s[96:99], s55 offen sc1
  v_mfma_f32_16x16x32_bf16 v[216:219], v[36:39], a[96:99], v[216:219]
  ds_read_b128 v[28:31], v241 offset:54272
  v_mfma_f32_16x16x32_bf16 v[220:223], v[40:43], a[96:99], v[220:223]
  s_waitcnt lgkmcnt(4)
  ds_read_b128 v[32:35], v241 offset:55296
  v_mfma_f32_16x16x32_bf16 v[196:199], v[44:47], a[100:103], v[196:199]
  ds_read_b128 v[36:39], v241 offset:56320
  v_mfma_f32_16x16x32_bf16 v[200:203], v[48:51], a[100:103], v[200:203]
  s_waitcnt lgkmcnt(4)
  ds_read_b128 v[40:43], v241 offset:57344
  v_mfma_f32_16x16x32_bf16 v[204:207], v[52:55], a[100:103], v[204:207]
  ds_read_b128 v[44:47], v241 offset:58368
  s_xor_b32 s55, s40, 45056
  buffer_load_dwordx4 a[68:71], v225, s[96:99], s55 offen sc1
  v_mfma_f32_16x16x32_bf16 v[208:211], v[56:59], a[100:103], v[208:211]
  s_waitcnt lgkmcnt(4)
  ds_read_b128 v[48:51], v241 offset:59392
  v_mfma_f32_16x16x32_bf16 v[212:215], v[60:63], a[100:103], v[212:215]
  ds_read_b128 v[52:55], v241 offset:60416
  v_mfma_f32_16x16x32_bf16 v[216:219], v[28:31], a[100:103], v[216:219]
  s_waitcnt lgkmcnt(4)
  ds_read_b128 v[56:59], v241 offset:61440
  v_mfma_f32_16x16x32_bf16 v[220:223], v[32:35], a[100:103], v[220:223]
  ds_read_b128 v[60:63], v241 offset:62464
  v_mfma_f32_16x16x32_bf16 v[196:199], v[36:39], a[104:107], v[196:199]
  s_waitcnt lgkmcnt(4)
  ds_read_b128 v[28:31], v241 offset:63488
  s_xor_b32 s55, s41, 45056
  buffer_load_dwordx4 a[140:143], v225, s[96:99], s55 offen sc1
  v_mfma_f32_16x16x32_bf16 v[200:203], v[40:43], a[104:107], v[200:203]
  ds_read_b128 v[32:35], v241 offset:64512
  v_mfma_f32_16x16x32_bf16 v[204:207], v[44:47], a[104:107], v[204:207]
  s_waitcnt lgkmcnt(4)
  ds_read_b128 v[36:39], v242 offset:0
  v_mfma_f32_16x16x32_bf16 v[208:211], v[48:51], a[104:107], v[208:211]
  ds_read_b128 v[40:43], v242 offset:1024
  v_mfma_f32_16x16x32_bf16 v[212:215], v[52:55], a[104:107], v[212:215]
  s_waitcnt lgkmcnt(4)
  ds_read_b128 v[44:47], v242 offset:2048
  v_mfma_f32_16x16x32_bf16 v[216:219], v[56:59], a[104:107], v[216:219]
  ds_read_b128 v[48:51], v242 offset:3072
  s_xor_b32 s55, s42, 45056
  buffer_load_dwordx4 a[160:163], v225, s[96:99], s55 offen sc1
  v_mfma_f32_16x16x32_bf16 v[220:223], v[60:63], a[104:107], v[220:223]
  s_waitcnt lgkmcnt(4)
  ds_read_b128 v[52:55], v242 offset:4096
  v_mfma_f32_16x16x32_bf16 v[196:199], v[28:31], a[36:39], v[196:199]
  ds_read_b128 v[56:59], v242 offset:5120
  v_mfma_f32_16x16x32_bf16 v[200:203], v[32:35], a[36:39], v[200:203]
  s_waitcnt lgkmcnt(4)
  ds_read_b128 v[60:63], v242 offset:6144
  v_mfma_f32_16x16x32_bf16 v[204:207], v[36:39], a[36:39], v[204:207]
  ds_read_b128 v[28:31], v242 offset:7168
  v_mfma_f32_16x16x32_bf16 v[208:211], v[40:43], a[36:39], v[208:211]
  s_waitcnt lgkmcnt(4)
  ds_read_b128 v[32:35], v242 offset:8192
  s_xor_b32 s55, s43, 45056
  buffer_load_dwordx4 a[180:183], v225, s[96:99], s55 offen sc1
  v_mfma_f32_16x16x32_bf16 v[212:215], v[44:47], a[36:39], v[212:215]
  ds_read_b128 v[36:39], v242 offset:9216
  v_mfma_f32_16x16x32_bf16 v[216:219], v[48:51], a[36:39], v[216:219]
  s_waitcnt lgkmcnt(4)
  ds_read_b128 v[40:43], v242 offset:10240
  v_mfma_f32_16x16x32_bf16 v[220:223], v[52:55], a[36:39], v[220:223]
  ds_read_b128 v[44:47], v242 offset:11264
  v_mfma_f32_16x16x32_bf16 v[196:199], v[56:59], a[224:227], v[196:199]
  s_waitcnt lgkmcnt(4)
  v_mfma_f32_16x16x32_bf16 v[200:203], v[60:63], a[224:227], v[200:203]
  s_xor_b32 s55, s40, 49152
  buffer_load_dwordx4 a[72:75], v225, s[96:99], s55 offen sc1
  v_mfma_f32_16x16x32_bf16 v[204:207], v[28:31], a[224:227], v[204:207]
  s_waitcnt lgkmcnt(2)
  v_mfma_f32_16x16x32_bf16 v[208:211], v[32:35], a[224:227], v[208:211]
  v_mfma_f32_16x16x32_bf16 v[212:215], v[36:39], a[224:227], v[212:215]
  s_waitcnt lgkmcnt(0)
  v_mfma_f32_16x16x32_bf16 v[216:219], v[40:43], a[224:227], v[216:219]
  v_mfma_f32_16x16x32_bf16 v[220:223], v[44:47], a[224:227], v[220:223]
  s_xor_b32 s55, s41, 49152
  buffer_load_dwordx4 a[144:147], v225, s[96:99], s55 offen sc1
  s_xor_b32 s55, s42, 49152
  buffer_load_dwordx4 a[164:167], v225, s[96:99], s55 offen sc1
  ds_read_b128 v[28:31], v246 offset:2048
  ds_read_b128 v[32:35], v246 offset:2112
  ds_read_b128 v[36:39], v246 offset:2176
  ds_read_b128 v[40:43], v246 offset:2240
  ds_read_b128 v[44:47], v246 offset:2304
  ds_read_b128 v[48:51], v246 offset:2368
  ds_read_b128 v[52:55], v246 offset:2432
  s_xor_b32 s55, s43, 49152
  buffer_load_dwordx4 a[184:187], v225, s[96:99], s55 offen sc1
  s_xor_b32 s55, s40, 53248
  buffer_load_dwordx4 a[76:79], v225, s[96:99], s55 offen sc1
  s_xor_b32 s55, s41, 53248
  buffer_load_dwordx4 a[148:151], v225, s[96:99], s55 offen sc1
  s_xor_b32 s55, s42, 53248
  buffer_load_dwordx4 a[168:171], v225, s[96:99], s55 offen sc1
  s_xor_b32 s55, s43, 53248
  buffer_load_dwordx4 a[188:191], v225, s[96:99], s55 offen sc1
  buffer_load_dword v239, v238, s[8:11], s63 offen offset:128 sc1
  v_pk_fma_f32 v[196:197], v[250:251], v[0:1], v[196:197] op_sel:[0,0,0] op_sel_hi:[0,1,1] neg_lo:[1,0,0] neg_hi:[1,0,0]
  v_pk_fma_f32 v[198:199], v[250:251], v[2:3], v[198:199] op_sel:[0,0,0] op_sel_hi:[0,1,1] neg_lo:[1,0,0] neg_hi:[1,0,0]
  v_pk_fma_f32 v[200:201], v[250:251], v[4:5], v[200:201] op_sel:[0,0,0] op_sel_hi:[0,1,1] neg_lo:[1,0,0] neg_hi:[1,0,0]
  v_pk_fma_f32 v[202:203], v[250:251], v[6:7], v[202:203] op_sel:[0,0,0] op_sel_hi:[0,1,1] neg_lo:[1,0,0] neg_hi:[1,0,0]
  v_pk_fma_f32 v[204:205], v[250:251], v[8:9], v[204:205] op_sel:[0,0,0] op_sel_hi:[0,1,1] neg_lo:[1,0,0] neg_hi:[1,0,0]
  v_pk_fma_f32 v[206:207], v[250:251], v[10:11], v[206:207] op_sel:[0,0,0] op_sel_hi:[0,1,1] neg_lo:[1,0,0] neg_hi:[1,0,0]
  v_pk_fma_f32 v[208:209], v[250:251], v[12:13], v[208:209] op_sel:[0,0,0] op_sel_hi:[0,1,1] neg_lo:[1,0,0] neg_hi:[1,0,0]
  v_pk_fma_f32 v[210:211], v[250:251], v[14:15], v[210:211] op_sel:[0,0,0] op_sel_hi:[0,1,1] neg_lo:[1,0,0] neg_hi:[1,0,0]
  v_pk_fma_f32 v[212:213], v[250:251], v[16:17], v[212:213] op_sel:[0,0,0] op_sel_hi:[0,1,1] neg_lo:[1,0,0] neg_hi:[1,0,0]
  v_pk_fma_f32 v[214:215], v[250:251], v[18:19], v[214:215] op_sel:[0,0,0] op_sel_hi:[0,1,1] neg_lo:[1,0,0] neg_hi:[1,0,0]
  v_pk_fma_f32 v[216:217], v[250:251], v[20:21], v[216:217] op_sel:[0,0,0] op_sel_hi:[0,1,1] neg_lo:[1,0,0] neg_hi:[1,0,0]
  v_pk_fma_f32 v[218:219], v[250:251], v[22:23], v[218:219] op_sel:[0,0,0] op_sel_hi:[0,1,1] neg_lo:[1,0,0] neg_hi:[1,0,0]
  v_pk_fma_f32 v[220:221], v[250:251], v[24:25], v[220:221] op_sel:[0,0,0] op_sel_hi:[0,1,1] neg_lo:[1,0,0] neg_hi:[1,0,0]
  v_pk_fma_f32 v[222:223], v[250:251], v[26:27], v[222:223] op_sel:[0,0,0] op_sel_hi:[0,1,1] neg_lo:[1,0,0] neg_hi:[1,0,0]
  s_waitcnt lgkmcnt(0)
  v_pk_fma_f32 v[196:197], v[196:197], v[250:251], v[28:29] op_sel:[0,1,0] op_sel_hi:[1,1,1]
  v_pk_fma_f32 v[198:199], v[198:199], v[250:251], v[30:31] op_sel:[0,1,0] op_sel_hi:[1,1,1]
  v_pk_fma_f32 v[200:201], v[200:201], v[250:251], v[32:33] op_sel:[0,1,0] op_sel_hi:[1,1,1]
  v_pk_fma_f32 v[202:203], v[202:203], v[250:251], v[34:35] op_sel:[0,1,0] op_sel_hi:[1,1,1]
  v_pk_fma_f32 v[204:205], v[204:205], v[250:251], v[36:37] op_sel:[0,1,0] op_sel_hi:[1,1,1]
  v_pk_fma_f32 v[206:207], v[206:207], v[250:251], v[38:39] op_sel:[0,1,0] op_sel_hi:[1,1,1]
  v_pk_fma_f32 v[208:209], v[208:209], v[250:251], v[40:41] op_sel:[0,1,0] op_sel_hi:[1,1,1]
  v_pk_fma_f32 v[210:211], v[210:211], v[250:251], v[42:43] op_sel:[0,1,0] op_sel_hi:[1,1,1]
  v_pk_fma_f32 v[212:213], v[212:213], v[250:251], v[44:45] op_sel:[0,1,0] op_sel_hi:[1,1,1]
  v_pk_fma_f32 v[214:215], v[214:215], v[250:251], v[46:47] op_sel:[0,1,0] op_sel_hi:[1,1,1]
  v_pk_fma_f32 v[216:217], v[216:217], v[250:251], v[48:49] op_sel:[0,1,0] op_sel_hi:[1,1,1]
  v_pk_fma_f32 v[218:219], v[218:219], v[250:251], v[50:51] op_sel:[0,1,0] op_sel_hi:[1,1,1]
  v_pk_fma_f32 v[220:221], v[220:221], v[250:251], v[52:53] op_sel:[0,1,0] op_sel_hi:[1,1,1]
  v_pk_fma_f32 v[222:223], v[222:223], v[250:251], v[54:55] op_sel:[0,1,0] op_sel_hi:[1,1,1]
  s_mul_i32 s52, s58, 458752
  s_mul_i32 s53, s3, 114688
  s_add_u32 s52, s52, s53
  s_add_u32 s52, s52, 14680064
  s_add_u32 s12, s4, s52
  s_addc_u32 s13, s5, 0
  s_mov_b32 s14, 114688
  s_mov_b32 s15, 0x20000
  v_pk_mul_f32 v[252:253], v[196:197], v[196:197]
  v_pk_mul_f32 v[254:255], v[198:199], v[198:199]
  v_pk_fma_f32 v[252:253], v[252:253], v[108:109], v[108:109] op_sel:[0,0,1] op_sel_hi:[1,0,1]
  v_pk_fma_f32 v[254:255], v[254:255], v[108:109], v[108:109] op_sel:[0,0,1] op_sel_hi:[1,0,1]
  v_pk_mul_f32 v[252:253], v[252:253], v[196:197]
  v_pk_mul_f32 v[254:255], v[254:255], v[198:199]
  v_exp_f32 v252, v252
  v_exp_f32 v253, v253
  v_exp_f32 v254, v254
  v_exp_f32 v255, v255
  v_pk_add_f32 v[252:253], v[252:253], 1.0 op_sel_hi:[1,0]
  v_pk_add_f32 v[254:255], v[254:255], 1.0 op_sel_hi:[1,0]
  v_rcp_f32 v252, v252
  v_rcp_f32 v253, v253
  v_rcp_f32 v254, v254
  v_rcp_f32 v255, v255
  v_pk_mul_f32 v[196:197], v[196:197], v[252:253]
  v_pk_mul_f32 v[198:199], v[198:199], v[254:255]
  v_pk_mul_f32 v[252:253], v[200:201], v[200:201]
  v_pk_mul_f32 v[254:255], v[202:203], v[202:203]
  v_pk_fma_f32 v[252:253], v[252:253], v[108:109], v[108:109] op_sel:[0,0,1] op_sel_hi:[1,0,1]
  v_pk_fma_f32 v[254:255], v[254:255], v[108:109], v[108:109] op_sel:[0,0,1] op_sel_hi:[1,0,1]
  v_pk_mul_f32 v[252:253], v[252:253], v[200:201]
  v_pk_mul_f32 v[254:255], v[254:255], v[202:203]
  v_exp_f32 v252, v252
  v_exp_f32 v253, v253
  v_exp_f32 v254, v254
  v_exp_f32 v255, v255
  v_pk_add_f32 v[252:253], v[252:253], 1.0 op_sel_hi:[1,0]
  v_pk_add_f32 v[254:255], v[254:255], 1.0 op_sel_hi:[1,0]
  v_rcp_f32 v252, v252
  v_rcp_f32 v253, v253
  v_rcp_f32 v254, v254
  v_rcp_f32 v255, v255
  v_pk_mul_f32 v[200:201], v[200:201], v[252:253]
  v_pk_mul_f32 v[202:203], v[202:203], v[254:255]
  v_mov_b32 v251, v108
  s_waitcnt vmcnt(0)
  v_cmp_gt_u32 vcc, 2, v239
  s_cbranch_vccz L_adaL_polled_87
  s_mov_b32 s59, 400000
L_adaL_poll_86:
  buffer_load_dword v239, v238, s[8:11], s63 offen offset:128 sc1
  s_sub_u32 s59, s59, 1
  s_cbranch_scc1 L_adaL_polled_87
  s_waitcnt vmcnt(0)
  v_cmp_gt_u32 vcc, 2, v239
  s_cbranch_vccnz L_adaL_poll_86
L_adaL_polled_87:
  s_mov_b32 s54, 0
  buffer_load_dwordx4 a[80:83], v225, s[12:15], s54 offen offset:0 sc1
  buffer_load_dwordx4 a[208:211], v225, s[12:15], s54 offen offset:1024 sc1
  buffer_load_dwordx4 a[152:155], v225, s[12:15], s54 offen offset:2048 sc1
  buffer_load_dwordx4 a[212:215], v225, s[12:15], s54 offen offset:3072 sc1
  buffer_load_dwordx4 a[172:175], v226, s[12:15], s54 offen offset:0 sc1
  buffer_load_dwordx4 a[28:31], v226, s[12:15], s54 offen offset:1024 sc1
  buffer_load_dwordx4 a[64:67], v226, s[12:15], s54 offen offset:2048 sc1
  s_mov_b32 s54, 7168
  buffer_load_dwordx4 a[56:59], v225, s[12:15], s54 offen offset:0 sc1
  buffer_load_dwordx4 a[84:87], v225, s[12:15], s54 offen offset:1024 sc1
  buffer_load_dwordx4 a[60:63], v225, s[12:15], s54 offen offset:2048 sc1
  buffer_load_dwordx4 a[216:219], v225, s[12:15], s54 offen offset:3072 sc1
  buffer_load_dwordx4 a[220:223], v226, s[12:15], s54 offen offset:0 sc1
  buffer_load_dwordx4 a[244:247], v226, s[12:15], s54 offen offset:1024 sc1
  buffer_load_dwordx4 a[248:251], v226, s[12:15], s54 offen offset:2048 sc1
  s_mov_b32 s54, 14336
  buffer_load_dwordx4 a[108:111], v225, s[12:15], s54 offen offset:0 sc1
  buffer_load_dwordx4 a[192:195], v225, s[12:15], s54 offen offset:1024 sc1
  s_waitcnt vmcnt(15)
  v_mfma_f32_16x16x32_bf16 v[0:3], a[80:83], v[124:127], 0
  s_add_u32 s53, s3, 0
  v_mfma_f32_16x16x32_bf16 v[28:31], a[80:83], v[192:195], 0
  s_and_b32 s53, s53, 3
  v_mfma_f32_16x16x32_bf16 v[56:59], a[80:83], v[128:131], 0
  s_mul_i32 s53, s53, 21504
  v_mfma_f32_16x16x32_bf16 v[84:87], a[80:83], v[132:135], 0
  buffer_load_dwordx4 a[196:199], v225, s[12:15], s54 offen offset:2048 sc1
  s_waitcnt vmcnt(15)
  v_mfma_f32_16x16x32_bf16 v[4:7], a[208:211], v[124:127], 0
  v_add_u32 v240, s53, v225
  v_mfma_f32_16x16x32_bf16 v[32:35], a[208:211], v[192:195], 0
  s_add_u32 s53, s3, 1
  v_mfma_f32_16x16x32_bf16 v[60:63], a[208:211], v[128:131], 0
  s_and_b32 s53, s53, 3
  v_mfma_f32_16x16x32_bf16 v[88:91], a[208:211], v[132:135], 0
  buffer_load_dwordx4 a[240:243], v225, s[12:15], s54 offen offset:3072 sc1
  s_waitcnt vmcnt(15)
  v_mfma_f32_16x16x32_bf16 v[8:11], a[152:155], v[124:127], 0
  s_mul_i32 s53, s53, 21504
  v_mfma_f32_16x16x32_bf16 v[36:39], a[152:155], v[192:195], 0
  v_add_u32 v241, s53, v225
  v_mfma_f32_16x16x32_bf16 v[64:67], a[152:155], v[128:131], 0
  s_add_u32 s53, s3, 2
  v_mfma_f32_16x16x32_bf16 v[92:95], a[152:155], v[132:135], 0
  buffer_load_dwordx4 a[252:255], v226, s[12:15], s54 offen offset:0 sc1
  s_waitcnt vmcnt(15)
  v_mfma_f32_16x16x32_bf16 v[12:15], a[212:215], v[124:127], 0
  s_and_b32 s53, s53, 3
  v_mfma_f32_16x16x32_bf16 v[40:43], a[212:215], v[192:195], 0
  s_mul_i32 s53, s53, 21504
  v_mfma_f32_16x16x32_bf16 v[68:71], a[212:215], v[128:131], 0
  v_add_u32 v242, s53, v225
  v_mfma_f32_16x16x32_bf16 v[96:99], a[212:215], v[132:135], 0
  buffer_load_dwordx4 a[0:3], v226, s[12:15], s54 offen offset:1024 sc1
  s_waitcnt vmcnt(15)
  v_mfma_f32_16x16x32_bf16 v[16:19], a[172:175], v[124:127], 0
  s_add_u32 s53, s3, 3
  v_mfma_f32_16x16x32_bf16 v[44:47], a[172:175], v[192:195], 0
  s_and_b32 s53, s53, 3
  v_mfma_f32_16x16x32_bf16 v[72:75], a[172:175], v[128:131], 0
  s_mul_i32 s53, s53, 21504
  v_mfma_f32_16x16x32_bf16 v[100:103], a[172:175], v[132:135], 0
  buffer_load_dwordx4 a[4:7], v226, s[12:15], s54 offen offset:2048 sc1
  s_waitcnt vmcnt(15)
  v_mfma_f32_16x16x32_bf16 v[20:23], a[28:31], v[124:127], 0
  v_add_u32 v243, s53, v225
  v_mfma_f32_16x16x32_bf16 v[48:51], a[28:31], v[192:195], 0
  s_mul_i32 s52, s58, 143360
  v_mfma_f32_16x16x32_bf16 v[76:79], a[28:31], v[128:131], 0
  s_add_u32 s52, s52, 31457280
  v_mfma_f32_16x16x32_bf16 v[104:107], a[28:31], v[132:135], 0
  s_mov_b32 s54, 21504
  buffer_load_dwordx4 a[32:35], v225, s[12:15], s54 offen offset:0 sc1
  s_waitcnt vmcnt(15)
  v_mfma_f32_16x16x32_bf16 v[24:27], a[64:67], v[124:127], 0
  s_add_u32 s32, s4, s52
  s_addc_u32 s33, s5, 0
  v_mfma_f32_16x16x32_bf16 v[52:55], a[64:67], v[192:195], 0
  s_mov_b32 s34, 143360
  v_mfma_f32_16x16x32_bf16 v[80:83], a[64:67], v[128:131], 0
  s_mov_b32 s35, 0x20000
  v_mfma_f32_16x16x32_bf16 v[108:111], a[64:67], v[132:135], 0
  buffer_load_dwordx4 a[8:11], v225, s[12:15], s54 offen offset:1024 sc1
  s_waitcnt vmcnt(15)
  v_mfma_f32_16x16x32_bf16 v[0:3], a[56:59], v[136:139], v[0:3]
  s_lshl_b32 s52, s57, 2
  v_mfma_f32_16x16x32_bf16 v[28:31], a[56:59], v[140:143], v[28:31]
  s_add_u32 s52, s52, s3
  v_mfma_f32_16x16x32_bf16 v[56:59], a[56:59], v[144:147], v[56:59]
  s_lshl_b32 s52, s52, 2
  v_mfma_f32_16x16x32_bf16 v[84:87], a[56:59], v[148:151], v[84:87]
  buffer_load_dwordx4 a[92:95], v225, s[12:15], s54 offen offset:2048 sc1
  s_waitcnt vmcnt(15)
  v_mfma_f32_16x16x32_bf16 v[4:7], a[84:87], v[136:139], v[4:7]
  s_lshr_b32 s53, s58, 1
  v_mfma_f32_16x16x32_bf16 v[32:35], a[84:87], v[140:143], v[32:35]
  s_add_u32 s52, s52, s53
  v_mfma_f32_16x16x32_bf16 v[60:63], a[84:87], v[144:147], v[60:63]
  s_mul_i32 s52, s52, 7168
  v_mfma_f32_16x16x32_bf16 v[88:91], a[84:87], v[148:151], v[88:91]
  buffer_load_dwordx4 a[96:99], v225, s[12:15], s54 offen offset:3072 sc1
  s_waitcnt vmcnt(15)
  v_mfma_f32_16x16x32_bf16 v[8:11], a[60:63], v[136:139], v[8:11]
  s_and_b32 s53, s58, 1
  v_mfma_f32_16x16x32_bf16 v[36:39], a[60:63], v[140:143], v[36:39]
  s_mul_i32 s53, s53, 3072
  v_mfma_f32_16x16x32_bf16 v[64:67], a[60:63], v[144:147], v[64:67]
  s_add_u32 s52, s52, s53
  v_mfma_f32_16x16x32_bf16 v[92:95], a[60:63], v[148:151], v[92:95]
  buffer_load_dwordx4 a[100:103], v226, s[12:15], s54 offen offset:0 sc1
  s_waitcnt vmcnt(15)
  v_mfma_f32_16x16x32_bf16 v[12:15], a[216:219], v[136:139], v[12:15]
  s_add_u32 s52, s52, 18874368
  v_mfma_f32_16x16x32_bf16 v[40:43], a[216:219], v[140:143], v[40:43]
  s_sub_u32 s53, 7168, s53
  v_mfma_f32_16x16x32_bf16 v[68:71], a[216:219], v[144:147], v[68:71]
  s_add_u32 s44, s4, s52
  s_addc_u32 s45, s5, 0
  v_mfma_f32_16x16x32_bf16 v[96:99], a[216:219], v[148:151], v[96:99]
  buffer_load_dwordx4 a[104:107], v226, s[12:15], s54 offen offset:1024 sc1
  s_waitcnt vmcnt(15)
  v_mfma_f32_16x16x32_bf16 v[16:19], a[220:223], v[136:139], v[16:19]
  s_mov_b32 s46, s53
  v_mfma_f32_16x16x32_bf16 v[44:47], a[220:223], v[140:143], v[44:47]
  s_mov_b32 s47, 0x20000
  v_mfma_f32_16x16x32_bf16 v[72:75], a[220:223], v[144:147], v[72:75]
  s_and_b32 s52, s58, 1
  v_mfma_f32_16x16x32_bf16 v[100:103], a[220:223], v[148:151], v[100:103]
  buffer_load_dwordx4 a[36:39], v226, s[12:15], s54 offen offset:2048 sc1
  s_waitcnt vmcnt(15)
  v_mfma_f32_16x16x32_bf16 v[20:23], a[244:247], v[136:139], v[20:23]
  s_lshl_b32 s52, s52, 9
  v_mfma_f32_16x16x32_bf16 v[48:51], a[244:247], v[140:143], v[48:51]
  s_add_u32 s52, s52, s53
  v_mfma_f32_16x16x32_bf16 v[76:79], a[244:247], v[144:147], v[76:79]
  s_sub_u32 s52, s52, 1024
  v_mfma_f32_16x16x32_bf16 v[104:107], a[244:247], v[148:151], v[104:107]
  s_mov_b32 s54, 28672
  buffer_load_dwordx4 a[224:227], v225, s[12:15], s54 offen offset:0 sc1
  s_waitcnt vmcnt(15)
  v_mfma_f32_16x16x32_bf16 v[24:27], a[248:251], v[136:139], v[24:27]
  v_and_b32 v246, 0x1f0, v225
  v_mfma_f32_16x16x32_bf16 v[52:55], a[248:251], v[140:143], v[52:55]
  v_add_u32 v246, s52, v246
  v_mfma_f32_16x16x32_bf16 v[80:83], a[248:251], v[144:147], v[80:83]
  s_lshl_b32 s52, s57, 2
  v_mfma_f32_16x16x32_bf16 v[108:111], a[248:251], v[148:151], v[108:111]
  buffer_load_dwordx4 a[80:83], v225, s[12:15], s54 offen offset:1024 sc1
  s_waitcnt vmcnt(15)
  v_mfma_f32_16x16x32_bf16 v[0:3], a[108:111], v[152:155], v[0:3]
  s_add_u32 s52, s52, s3
  v_mfma_f32_16x16x32_bf16 v[28:31], a[108:111], v[156:159], v[28:31]
  s_mul_i32 s52, s52, 28672
  v_mfma_f32_16x16x32_bf16 v[56:59], a[108:111], v[160:163], v[56:59]
  s_add_u32 s52, s52, 18874368
  v_mfma_f32_16x16x32_bf16 v[84:87], a[108:111], v[164:167], v[84:87]
  buffer_load_dwordx4 a[208:211], v225, s[12:15], s54 offen offset:2048 sc1
  s_waitcnt vmcnt(15)
  v_mfma_f32_16x16x32_bf16 v[4:7], a[192:195], v[152:155], v[4:7]
  s_add_u32 s16, s4, s52
  s_addc_u32 s17, s5, 0
  v_mfma_f32_16x16x32_bf16 v[32:35], a[192:195], v[156:159], v[32:35]
  s_mov_b32 s18, 28672
  v_mfma_f32_16x16x32_bf16 v[60:63], a[192:195], v[160:163], v[60:63]
  s_mov_b32 s19, 0x20000
  v_mfma_f32_16x16x32_bf16 v[88:91], a[192:195], v[164:167], v[88:91]
  buffer_load_dwordx4 a[152:155], v225, s[12:15], s54 offen offset:3072 sc1
  s_waitcnt vmcnt(15)
  v_mfma_f32_16x16x32_bf16 v[8:11], a[196:199], v[152:155], v[8:11]
  s_mov_b32 s36, s70
  v_mfma_f32_16x16x32_bf16 v[36:39], a[196:199], v[156:159], v[36:39]
  s_mov_b32 s37, s71
  v_mfma_f32_16x16x32_bf16 v[64:67], a[196:199], v[160:163], v[64:67]
  s_mov_b32 s38, 2621440
  v_mfma_f32_16x16x32_bf16 v[92:95], a[196:199], v[164:167], v[92:95]
  buffer_load_dwordx4 a[212:215], v226, s[12:15], s54 offen offset:0 sc1
  s_waitcnt vmcnt(15)
  v_mfma_f32_16x16x32_bf16 v[12:15], a[240:243], v[152:155], v[12:15]
  s_mov_b32 s39, 0x20000
  v_mfma_f32_16x16x32_bf16 v[40:43], a[240:243], v[156:159], v[40:43]
  s_lshl_b32 s63, s58, 5
  v_mfma_f32_16x16x32_bf16 v[68:71], a[240:243], v[160:163], v[68:71]
  s_add_u32 s63, s63, s57
  v_mfma_f32_16x16x32_bf16 v[96:99], a[240:243], v[164:167], v[96:99]
  buffer_load_dwordx4 a[172:175], v226, s[12:15], s54 offen offset:1024 sc1
  s_waitcnt vmcnt(15)
  v_mfma_f32_16x16x32_bf16 v[16:19], a[252:255], v[152:155], v[16:19]
  s_lshl_b32 s63, s63, 10
  v_mfma_f32_16x16x32_bf16 v[44:47], a[252:255], v[156:159], v[44:47]
  v_and_b32 v238, 7, v224
  v_mfma_f32_16x16x32_bf16 v[72:75], a[252:255], v[160:163], v[72:75]
  v_lshlrev_b32 v238, 2, v238
  v_mfma_f32_16x16x32_bf16 v[100:103], a[252:255], v[164:167], v[100:103]
  buffer_load_dwordx4 a[28:31], v226, s[12:15], s54 offen offset:2048 sc1
  s_waitcnt vmcnt(15)
  v_mfma_f32_16x16x32_bf16 v[20:23], a[0:3], v[152:155], v[20:23]
  v_lshlrev_b32 v244, 16, v227
  v_mfma_f32_16x16x32_bf16 v[48:51], a[0:3], v[156:159], v[48:51]
  v_mul_f32 v252, v204, v204
  v_mfma_f32_16x16x32_bf16 v[76:79], a[0:3], v[160:163], v[76:79]
  v_mul_f32 v253, v205, v205
  v_mfma_f32_16x16x32_bf16 v[104:107], a[0:3], v[164:167], v[104:107]
  s_mov_b32 s54, 35840
  buffer_load_dwordx4 a[64:67], v225, s[12:15], s54 offen offset:0 sc1
  s_waitcnt vmcnt(15)
  v_mfma_f32_16x16x32_bf16 v[24:27], a[4:7], v[152:155], v[24:27]
  v_mul_f32 v254, v206, v206
  v_mfma_f32_16x16x32_bf16 v[52:55], a[4:7], v[156:159], v[52:55]
  v_mul_f32 v255, v207, v207
  v_mfma_f32_16x16x32_bf16 v[80:83], a[4:7], v[160:163], v[80:83]
  v_fmaak_f32 v252, v252, v251, 0xc0135761
  v_mfma_f32_16x16x32_bf16 v[108:111], a[4:7], v[164:167], v[108:111]
  buffer_load_dwordx4 a[56:59], v225, s[12:15], s54 offen offset:1024 sc1
  s_barrier
  s_waitcnt vmcnt(15)
  v_mfma_f32_16x16x32_bf16 v[0:3], a[32:35], v[168:171], v[0:3]
  v_fmaak_f32 v253, v253, v251, 0xc0135761
  v_mfma_f32_16x16x32_bf16 v[28:31], a[32:35], v[172:175], v[28:31]
  v_fmaak_f32 v254, v254, v251, 0xc0135761
  v_mfma_f32_16x16x32_bf16 v[56:59], a[32:35], v[176:179], v[56:59]
  v_fmaak_f32 v255, v255, v251, 0xc0135761
  v_mfma_f32_16x16x32_bf16 v[84:87], a[32:35], v[180:183], v[84:87]
  buffer_load_dwordx4 a[84:87], v225, s[12:15], s54 offen offset:2048 sc1
  s_waitcnt vmcnt(15)
  v_mfma_f32_16x16x32_bf16 v[4:7], a[8:11], v[168:171], v[4:7]
  v_mul_f32 v252, v252, v204
  v_mfma_f32_16x16x32_bf16 v[32:35], a[8:11], v[172:175], v[32:35]
  v_mul_f32 v253, v253, v205
  v_mfma_f32_16x16x32_bf16 v[60:63], a[8:11], v[176:179], v[60:63]
  v_mul_f32 v254, v254, v206
  v_mfma_f32_16x16x32_bf16 v[88:91], a[8:11], v[180:183], v[88:91]
  buffer_load_dwordx4 a[60:63], v225, s[12:15], s54 offen offset:3072 sc1
  s_waitcnt vmcnt(15)
  v_mfma_f32_16x16x32_bf16 v[8:11], a[92:95], v[168:171], v[8:11]
  v_mul_f32 v255, v255, v207
  v_mfma_f32_16x16x32_bf16 v[36:39], a[92:95], v[172:175], v[36:39]
  v_exp_f32 v252, v252
  v_mfma_f32_16x16x32_bf16 v[64:67], a[92:95], v[176:179], v[64:67]
  v_exp_f32 v253, v253
  v_mfma_f32_16x16x32_bf16 v[92:95], a[92:95], v[180:183], v[92:95]
  buffer_load_dwordx4 a[216:219], v226, s[12:15], s54 offen offset:0 sc1
  s_waitcnt vmcnt(15)
  v_mfma_f32_16x16x32_bf16 v[12:15], a[96:99], v[168:171], v[12:15]
  v_exp_f32 v254, v254
  v_mfma_f32_16x16x32_bf16 v[40:43], a[96:99], v[172:175], v[40:43]
  v_exp_f32 v255, v255
  v_mfma_f32_16x16x32_bf16 v[68:71], a[96:99], v[176:179], v[68:71]
  v_add_f32 v252, 1.0, v252
  v_mfma_f32_16x16x32_bf16 v[96:99], a[96:99], v[180:183], v[96:99]
  buffer_load_dwordx4 a[220:223], v226, s[12:15], s54 offen offset:1024 sc1
  s_waitcnt vmcnt(15)
  v_mfma_f32_16x16x32_bf16 v[16:19], a[100:103], v[168:171], v[16:19]
  v_add_f32 v253, 1.0, v253
  v_mfma_f32_16x16x32_bf16 v[44:47], a[100:103], v[172:175], v[44:47]
  v_add_f32 v254, 1.0, v254
  v_mfma_f32_16x16x32_bf16 v[72:75], a[100:103], v[176:179], v[72:75]
  v_add_f32 v255, 1.0, v255
  v_mfma_f32_16x16x32_bf16 v[100:103], a[100:103], v[180:183], v[100:103]
  buffer_load_dwordx4 a[244:247], v226, s[12:15], s54 offen offset:2048 sc1
  s_waitcnt vmcnt(15)
  v_mfma_f32_16x16x32_bf16 v[20:23], a[104:107], v[168:171], v[20:23]
  v_rcp_f32 v252, v252
  v_mfma_f32_16x16x32_bf16 v[48:51], a[104:107], v[172:175], v[48:51]
  v_rcp_f32 v253, v253
  v_mfma_f32_16x16x32_bf16 v[76:79], a[104:107], v[176:179], v[76:79]
  v_rcp_f32 v254, v254
  v_mfma_f32_16x16x32_bf16 v[104:107], a[104:107], v[180:183], v[104:107]
  s_mov_b32 s54, 43008
  buffer_load_dwordx4 a[248:251], v225, s[12:15], s54 offen offset:0 sc1
  s_waitcnt vmcnt(15)
  v_mfma_f32_16x16x32_bf16 v[24:27], a[36:39], v[168:171], v[24:27]
  v_rcp_f32 v255, v255
  v_mfma_f32_16x16x32_bf16 v[52:55], a[36:39], v[172:175], v[52:55]
  v_mul_f32 v204, v204, v252
  v_mfma_f32_16x16x32_bf16 v[80:83], a[36:39], v[176:179], v[80:83]
  v_mul_f32 v205, v205, v253
  v_mfma_f32_16x16x32_bf16 v[108:111], a[36:39], v[180:183], v[108:111]
  buffer_load_dwordx4 a[108:111], v225, s[12:15], s54 offen offset:1024 sc1
  s_waitcnt vmcnt(15)
  v_mfma_f32_16x16x32_bf16 v[0:3], a[224:227], v[184:187], v[0:3]
  v_mul_f32 v206, v206, v254
  v_mfma_f32_16x16x32_bf16 v[28:31], a[224:227], v[188:191], v[28:31]
  v_mul_f32 v207, v207, v255
  v_mfma_f32_16x16x32_bf16 v[56:59], a[224:227], v[112:115], v[56:59]
  v_mul_f32 v252, v208, v208
  v_mfma_f32_16x16x32_bf16 v[84:87], a[224:227], v[116:119], v[84:87]
  buffer_load_dwordx4 a[192:195], v225, s[12:15], s54 offen offset:2048 sc1
  s_waitcnt vmcnt(15)
  v_mfma_f32_16x16x32_bf16 v[4:7], a[80:83], v[184:187], v[4:7]
  v_mul_f32 v253, v209, v209
  v_mfma_f32_16x16x32_bf16 v[32:35], a[80:83], v[188:191], v[32:35]
  v_mul_f32 v254, v210, v210
  v_mfma_f32_16x16x32_bf16 v[60:63], a[80:83], v[112:115], v[60:63]
  v_mul_f32 v255, v211, v211
  v_mfma_f32_16x16x32_bf16 v[88:91], a[80:83], v[116:119], v[88:91]
  buffer_load_dwordx4 a[196:199], v225, s[12:15], s54 offen offset:3072 sc1
  s_waitcnt vmcnt(15)
  v_mfma_f32_16x16x32_bf16 v[8:11], a[208:211], v[184:187], v[8:11]
  v_fmaak_f32 v252, v252, v251, 0xc0135761
  v_mfma_f32_16x16x32_bf16 v[36:39], a[208:211], v[188:191], v[36:39]
  v_fmaak_f32 v253, v253, v251, 0xc0135761
  v_mfma_f32_16x16x32_bf16 v[64:67], a[208:211], v[112:115], v[64:67]
  v_fmaak_f32 v254, v254, v251, 0xc0135761
  v_mfma_f32_16x16x32_bf16 v[92:95], a[208:211], v[116:119], v[92:95]
  buffer_load_dwordx4 a[240:243], v226, s[12:15], s54 offen offset:0 sc1
  s_waitcnt vmcnt(15)
  v_mfma_f32_16x16x32_bf16 v[12:15], a[152:155], v[184:187], v[12:15]
  v_fmaak_f32 v255, v255, v251, 0xc0135761
  v_mfma_f32_16x16x32_bf16 v[40:43], a[152:155], v[188:191], v[40:43]
  v_mul_f32 v252, v252, v208
  v_mfma_f32_16x16x32_bf16 v[68:71], a[152:155], v[112:115], v[68:71]
  v_mul_f32 v253, v253, v209
  v_mfma_f32_16x16x32_bf16 v[96:99], a[152:155], v[116:119], v[96:99]
  buffer_load_dwordx4 a[252:255], v226, s[12:15], s54 offen offset:1024 sc1
  s_waitcnt vmcnt(15)
  v_mfma_f32_16x16x32_bf16 v[16:19], a[212:215], v[184:187], v[16:19]
  v_mul_f32 v254, v254, v210
  v_mfma_f32_16x16x32_bf16 v[44:47], a[212:215], v[188:191], v[44:47]
  v_mul_f32 v255, v255, v211
  v_mfma_f32_16x16x32_bf16 v[72:75], a[212:215], v[112:115], v[72:75]
  v_exp_f32 v252, v252
  v_mfma_f32_16x16x32_bf16 v[100:103], a[212:215], v[116:119], v[100:103]
  buffer_load_dwordx4 a[0:3], v226, s[12:15], s54 offen offset:2048 sc1
  s_waitcnt vmcnt(15)
  v_mfma_f32_16x16x32_bf16 v[20:23], a[172:175], v[184:187], v[20:23]
  v_exp_f32 v253, v253
  v_mfma_f32_16x16x32_bf16 v[48:51], a[172:175], v[188:191], v[48:51]
  v_exp_f32 v254, v254
  v_mfma_f32_16x16x32_bf16 v[76:79], a[172:175], v[112:115], v[76:79]
  v_exp_f32 v255, v255
  v_mfma_f32_16x16x32_bf16 v[104:107], a[172:175], v[116:119], v[104:107]
  s_mov_b32 s54, 50176
  buffer_load_dwordx4 a[4:7], v225, s[12:15], s54 offen offset:0 sc1
  s_waitcnt vmcnt(15)
  v_mfma_f32_16x16x32_bf16 v[24:27], a[28:31], v[184:187], v[24:27]
  v_add_f32 v252, 1.0, v252
  v_mfma_f32_16x16x32_bf16 v[52:55], a[28:31], v[188:191], v[52:55]
  v_add_f32 v253, 1.0, v253
  v_mfma_f32_16x16x32_bf16 v[80:83], a[28:31], v[112:115], v[80:83]
  v_add_f32 v254, 1.0, v254
  v_mfma_f32_16x16x32_bf16 v[108:111], a[28:31], v[116:119], v[108:111]
  buffer_load_dwordx4 a[32:35], v225, s[12:15], s54 offen offset:1024 sc1
  s_waitcnt vmcnt(15)
  v_mfma_f32_16x16x32_bf16 v[0:3], a[64:67], v[120:123], v[0:3]
  v_add_f32 v255, 1.0, v255
  v_mfma_f32_16x16x32_bf16 v[28:31], a[64:67], a[228:231], v[28:31]
  v_rcp_f32 v252, v252
  v_mfma_f32_16x16x32_bf16 v[56:59], a[64:67], a[232:235], v[56:59]
  v_rcp_f32 v253, v253
  v_mfma_f32_16x16x32_bf16 v[84:87], a[64:67], a[128:131], v[84:87]
  buffer_load_dwordx4 a[8:11], v225, s[12:15], s54 offen offset:2048 sc1
  s_waitcnt vmcnt(15)
  v_mfma_f32_16x16x32_bf16 v[4:7], a[56:59], v[120:123], v[4:7]
  v_rcp_f32 v254, v254
  v_mfma_f32_16x16x32_bf16 v[32:35], a[56:59], a[228:231], v[32:35]
  v_rcp_f32 v255, v255
  v_mfma_f32_16x16x32_bf16 v[60:63], a[56:59], a[232:235], v[60:63]
  v_mul_f32 v208, v208, v252
  v_mfma_f32_16x16x32_bf16 v[88:91], a[56:59], a[128:131], v[88:91]
  buffer_load_dwordx4 a[92:95], v225, s[12:15], s54 offen offset:3072 sc1
  s_waitcnt vmcnt(15)
  v_mfma_f32_16x16x32_bf16 v[8:11], a[84:87], v[120:123], v[8:11]
  v_mul_f32 v209, v209, v253
  v_mfma_f32_16x16x32_bf16 v[36:39], a[84:87], a[228:231], v[36:39]
  v_mul_f32 v210, v210, v254
  v_mfma_f32_16x16x32_bf16 v[64:67], a[84:87], a[232:235], v[64:67]
  v_mul_f32 v211, v211, v255
  v_mfma_f32_16x16x32_bf16 v[92:95], a[84:87], a[128:131], v[92:95]
  buffer_load_dwordx4 a[96:99], v226, s[12:15], s54 offen offset:0 sc1
  s_waitcnt vmcnt(15)
  v_mfma_f32_16x16x32_bf16 v[12:15], a[60:63], v[120:123], v[12:15]
  v_mul_f32 v252, v212, v212
  v_mfma_f32_16x16x32_bf16 v[40:43], a[60:63], a[228:231], v[40:43]
  v_mul_f32 v253, v213, v213
  v_mfma_f32_16x16x32_bf16 v[68:71], a[60:63], a[232:235], v[68:71]
  v_mul_f32 v254, v214, v214
  v_mfma_f32_16x16x32_bf16 v[96:99], a[60:63], a[128:131], v[96:99]
  buffer_load_dwordx4 a[100:103], v226, s[12:15], s54 offen offset:1024 sc1
  s_waitcnt vmcnt(15)
  v_mfma_f32_16x16x32_bf16 v[16:19], a[216:219], v[120:123], v[16:19]
  v_mul_f32 v255, v215, v215
  v_mfma_f32_16x16x32_bf16 v[44:47], a[216:219], a[228:231], v[44:47]
  v_fmaak_f32 v252, v252, v251, 0xc0135761
  v_mfma_f32_16x16x32_bf16 v[72:75], a[216:219], a[232:235], v[72:75]
  v_fmaak_f32 v253, v253, v251, 0xc0135761
  v_mfma_f32_16x16x32_bf16 v[100:103], a[216:219], a[128:131], v[100:103]
  buffer_load_dwordx4 a[104:107], v226, s[12:15], s54 offen offset:2048 sc1
  s_waitcnt vmcnt(15)
  v_mfma_f32_16x16x32_bf16 v[20:23], a[220:223], v[120:123], v[20:23]
  v_fmaak_f32 v254, v254, v251, 0xc0135761
  v_mfma_f32_16x16x32_bf16 v[48:51], a[220:223], a[228:231], v[48:51]
  v_fmaak_f32 v255, v255, v251, 0xc0135761
  v_mfma_f32_16x16x32_bf16 v[76:79], a[220:223], a[232:235], v[76:79]
  v_mul_f32 v252, v252, v212
  v_mfma_f32_16x16x32_bf16 v[104:107], a[220:223], a[128:131], v[104:107]
  s_mov_b32 s54, 57344
  buffer_load_dwordx4 a[36:39], v225, s[12:15], s54 offen offset:0 sc1
  s_waitcnt vmcnt(15)
  v_mfma_f32_16x16x32_bf16 v[24:27], a[244:247], v[120:123], v[24:27]
  v_mul_f32 v253, v253, v213
  v_mfma_f32_16x16x32_bf16 v[52:55], a[244:247], a[228:231], v[52:55]
  v_mul_f32 v254, v254, v214
  v_mfma_f32_16x16x32_bf16 v[80:83], a[244:247], a[232:235], v[80:83]
  v_mul_f32 v255, v255, v215
  v_mfma_f32_16x16x32_bf16 v[108:111], a[244:247], a[128:131], v[108:111]
  buffer_load_dwordx4 a[224:227], v225, s[12:15], s54 offen offset:1024 sc1
  s_waitcnt vmcnt(15)
  v_mfma_f32_16x16x32_bf16 v[0:3], a[248:251], a[236:239], v[0:3]
  v_exp_f32 v252, v252
  v_mfma_f32_16x16x32_bf16 v[28:31], a[248:251], a[124:127], v[28:31]
  v_exp_f32 v253, v253
  v_mfma_f32_16x16x32_bf16 v[56:59], a[248:251], a[12:15], v[56:59]
  v_exp_f32 v254, v254
  v_mfma_f32_16x16x32_bf16 v[84:87], a[248:251], a[40:43], v[84:87]
  buffer_load_dwordx4 a[80:83], v225, s[12:15], s54 offen offset:2048 sc1
  s_waitcnt vmcnt(15)
  v_mfma_f32_16x16x32_bf16 v[4:7], a[108:111], a[236:239], v[4:7]
  v_exp_f32 v255, v255
  v_mfma_f32_16x16x32_bf16 v[32:35], a[108:111], a[124:127], v[32:35]
  v_add_f32 v252, 1.0, v252
  v_mfma_f32_16x16x32_bf16 v[60:63], a[108:111], a[12:15], v[60:63]
  v_add_f32 v253, 1.0, v253
  v_mfma_f32_16x16x32_bf16 v[88:91], a[108:111], a[40:43], v[88:91]
  buffer_load_dwordx4 a[208:211], v225, s[12:15], s54 offen offset:3072 sc1
  s_waitcnt vmcnt(15)
  v_mfma_f32_16x16x32_bf16 v[8:11], a[192:195], a[236:239], v[8:11]
  v_add_f32 v254, 1.0, v254
  v_mfma_f32_16x16x32_bf16 v[36:39], a[192:195], a[124:127], v[36:39]
  v_add_f32 v255, 1.0, v255
  v_mfma_f32_16x16x32_bf16 v[64:67], a[192:195], a[12:15], v[64:67]
  v_rcp_f32 v252, v252
  v_mfma_f32_16x16x32_bf16 v[92:95], a[192:195], a[40:43], v[92:95]
  buffer_load_dwordx4 a[152:155], v226, s[12:15], s54 offen offset:0 sc1
  s_waitcnt vmcnt(15)
  v_mfma_f32_16x16x32_bf16 v[12:15], a[196:199], a[236:239], v[12:15]
  v_rcp_f32 v253, v253
  v_mfma_f32_16x16x32_bf16 v[40:43], a[196:199], a[124:127], v[40:43]
  v_rcp_f32 v254, v254
  v_mfma_f32_16x16x32_bf16 v[68:71], a[196:199], a[12:15], v[68:71]
  v_rcp_f32 v255, v255
  v_mfma_f32_16x16x32_bf16 v[96:99], a[196:199], a[40:43], v[96:99]
  buffer_load_dwordx4 a[212:215], v226, s[12:15], s54 offen offset:1024 sc1
  s_waitcnt vmcnt(15)
  v_mfma_f32_16x16x32_bf16 v[16:19], a[240:243], a[236:239], v[16:19]
  v_mul_f32 v212, v212, v252
  v_mfma_f32_16x16x32_bf16 v[44:47], a[240:243], a[124:127], v[44:47]
  v_mul_f32 v213, v213, v253
  v_mfma_f32_16x16x32_bf16 v[72:75], a[240:243], a[12:15], v[72:75]
  v_mul_f32 v214, v214, v254
  v_mfma_f32_16x16x32_bf16 v[100:103], a[240:243], a[40:43], v[100:103]
  buffer_load_dwordx4 a[172:175], v226, s[12:15], s54 offen offset:2048 sc1
  s_waitcnt vmcnt(15)
  v_mfma_f32_16x16x32_bf16 v[20:23], a[252:255], a[236:239], v[20:23]
  v_mul_f32 v215, v215, v255
  v_mfma_f32_16x16x32_bf16 v[48:51], a[252:255], a[124:127], v[48:51]
  v_mul_f32 v252, v216, v216
  v_mfma_f32_16x16x32_bf16 v[76:79], a[252:255], a[12:15], v[76:79]
  v_mul_f32 v253, v217, v217
  v_mfma_f32_16x16x32_bf16 v[104:107], a[252:255], a[40:43], v[104:107]
  s_mov_b32 s54, 64512
  buffer_load_dwordx4 a[28:31], v225, s[12:15], s54 offen offset:0 sc1
  s_waitcnt vmcnt(15)
  v_mfma_f32_16x16x32_bf16 v[24:27], a[0:3], a[236:239], v[24:27]
  v_mul_f32 v254, v218, v218
  v_mfma_f32_16x16x32_bf16 v[52:55], a[0:3], a[124:127], v[52:55]
  v_mul_f32 v255, v219, v219
  v_mfma_f32_16x16x32_bf16 v[80:83], a[0:3], a[12:15], v[80:83]
  v_fmaak_f32 v252, v252, v251, 0xc0135761
  v_mfma_f32_16x16x32_bf16 v[108:111], a[0:3], a[40:43], v[108:111]
  buffer_load_dwordx4 a[64:67], v225, s[12:15], s54 offen offset:1024 sc1
  s_waitcnt vmcnt(15)
  v_mfma_f32_16x16x32_bf16 v[0:3], a[4:7], a[132:135], v[0:3]
  v_fmaak_f32 v253, v253, v251, 0xc0135761
  v_mfma_f32_16x16x32_bf16 v[28:31], a[4:7], a[44:47], v[28:31]
  v_fmaak_f32 v254, v254, v251, 0xc0135761
  v_mfma_f32_16x16x32_bf16 v[56:59], a[4:7], a[200:203], v[56:59]
  v_fmaak_f32 v255, v255, v251, 0xc0135761
  v_mfma_f32_16x16x32_bf16 v[84:87], a[4:7], a[204:207], v[84:87]
  buffer_load_dwordx4 a[56:59], v225, s[12:15], s54 offen offset:2048 sc1
  s_waitcnt vmcnt(15)
  v_mfma_f32_16x16x32_bf16 v[4:7], a[32:35], a[132:135], v[4:7]
  v_mul_f32 v252, v252, v216
  v_mfma_f32_16x16x32_bf16 v[32:35], a[32:35], a[44:47], v[32:35]
  v_mul_f32 v253, v253, v217
  v_mfma_f32_16x16x32_bf16 v[60:63], a[32:35], a[200:203], v[60:63]
  v_mul_f32 v254, v254, v218
  v_mfma_f32_16x16x32_bf16 v[88:91], a[32:35], a[204:207], v[88:91]
  buffer_load_dwordx4 a[84:87], v225, s[12:15], s54 offen offset:3072 sc1
  s_waitcnt vmcnt(15)
  v_mfma_f32_16x16x32_bf16 v[8:11], a[8:11], a[132:135], v[8:11]
  v_mul_f32 v255, v255, v219
  v_mfma_f32_16x16x32_bf16 v[36:39], a[8:11], a[44:47], v[36:39]
  v_exp_f32 v252, v252
  v_mfma_f32_16x16x32_bf16 v[64:67], a[8:11], a[200:203], v[64:67]
  v_exp_f32 v253, v253
  v_mfma_f32_16x16x32_bf16 v[92:95], a[8:11], a[204:207], v[92:95]
  buffer_load_dwordx4 a[60:63], v226, s[12:15], s54 offen offset:0 sc1
  s_waitcnt vmcnt(15)
  v_mfma_f32_16x16x32_bf16 v[12:15], a[92:95], a[132:135], v[12:15]
  v_exp_f32 v254, v254
  v_mfma_f32_16x16x32_bf16 v[40:43], a[92:95], a[44:47], v[40:43]
  v_exp_f32 v255, v255
  v_mfma_f32_16x16x32_bf16 v[68:71], a[92:95], a[200:203], v[68:71]
  v_add_f32 v252, 1.0, v252
  v_mfma_f32_16x16x32_bf16 v[96:99], a[92:95], a[204:207], v[96:99]
  buffer_load_dwordx4 a[216:219], v226, s[12:15], s54 offen offset:1024 sc1
  s_waitcnt vmcnt(15)
  v_mfma_f32_16x16x32_bf16 v[16:19], a[96:99], a[132:135], v[16:19]
  v_add_f32 v253, 1.0, v253
  v_mfma_f32_16x16x32_bf16 v[44:47], a[96:99], a[44:47], v[44:47]
  v_add_f32 v254, 1.0, v254
  v_mfma_f32_16x16x32_bf16 v[72:75], a[96:99], a[200:203], v[72:75]
  v_add_f32 v255, 1.0, v255
  v_mfma_f32_16x16x32_bf16 v[100:103], a[96:99], a[204:207], v[100:103]
  buffer_load_dwordx4 a[220:223], v226, s[12:15], s54 offen offset:2048 sc1
  s_waitcnt vmcnt(15)
  v_mfma_f32_16x16x32_bf16 v[20:23], a[100:103], a[132:135], v[20:23]
  v_rcp_f32 v252, v252
  v_mfma_f32_16x16x32_bf16 v[48:51], a[100:103], a[44:47], v[48:51]
  v_rcp_f32 v253, v253
  v_mfma_f32_16x16x32_bf16 v[76:79], a[100:103], a[200:203], v[76:79]
  v_rcp_f32 v254, v254
  v_mfma_f32_16x16x32_bf16 v[104:107], a[100:103], a[204:207], v[104:107]
  s_mov_b32 s54, 71680
  buffer_load_dwordx4 a[228:231], v225, s[12:15], s54 offen offset:0 sc1
  s_waitcnt vmcnt(15)
  v_mfma_f32_16x16x32_bf16 v[24:27], a[104:107], a[132:135], v[24:27]
  v_rcp_f32 v255, v255
  v_mfma_f32_16x16x32_bf16 v[52:55], a[104:107], a[44:47], v[52:55]
  v_mul_f32 v216, v216, v252
  v_mfma_f32_16x16x32_bf16 v[80:83], a[104:107], a[200:203], v[80:83]
  v_mul_f32 v217, v217, v253
  v_mfma_f32_16x16x32_bf16 v[108:111], a[104:107], a[204:207], v[108:111]
  buffer_load_dwordx4 a[232:235], v225, s[12:15], s54 offen offset:1024 sc1
  s_waitcnt vmcnt(15)
  v_mfma_f32_16x16x32_bf16 v[0:3], a[36:39], a[112:115], v[0:3]
  v_mul_f32 v218, v218, v254
  v_mfma_f32_16x16x32_bf16 v[28:31], a[36:39], a[116:119], v[28:31]
  v_mul_f32 v219, v219, v255
  v_mfma_f32_16x16x32_bf16 v[56:59], a[36:39], a[16:19], v[56:59]
  v_mul_f32 v252, v220, v220
  v_mfma_f32_16x16x32_bf16 v[84:87], a[36:39], a[20:23], v[84:87]
  buffer_load_dwordx4 a[128:131], v225, s[12:15], s54 offen offset:2048 sc1
  s_waitcnt vmcnt(15)
  v_mfma_f32_16x16x32_bf16 v[4:7], a[224:227], a[112:115], v[4:7]
  v_mul_f32 v253, v221, v221
  v_mfma_f32_16x16x32_bf16 v[32:35], a[224:227], a[116:119], v[32:35]
  v_mul_f32 v254, v222, v222
  v_mfma_f32_16x16x32_bf16 v[60:63], a[224:227], a[16:19], v[60:63]
  v_mul_f32 v255, v223, v223
  v_mfma_f32_16x16x32_bf16 v[88:91], a[224:227], a[20:23], v[88:91]
  buffer_load_dwordx4 a[244:247], v225, s[12:15], s54 offen offset:3072 sc1
  s_waitcnt vmcnt(15)
  v_mfma_f32_16x16x32_bf16 v[8:11], a[80:83], a[112:115], v[8:11]
  v_fmaak_f32 v252, v252, v251, 0xc0135761
  v_mfma_f32_16x16x32_bf16 v[36:39], a[80:83], a[116:119], v[36:39]
  v_fmaak_f32 v253, v253, v251, 0xc0135761
  v_mfma_f32_16x16x32_bf16 v[64:67], a[80:83], a[16:19], v[64:67]
  v_fmaak_f32 v254, v254, v251, 0xc0135761
  v_mfma_f32_16x16x32_bf16 v[92:95], a[80:83], a[20:23], v[92:95]
  buffer_load_dwordx4 a[248:251], v226, s[12:15], s54 offen offset:0 sc1
  s_waitcnt vmcnt(15)
  v_mfma_f32_16x16x32_bf16 v[12:15], a[208:211], a[112:115], v[12:15]
  v_fmaak_f32 v255, v255, v251, 0xc0135761
  v_mfma_f32_16x16x32_bf16 v[40:43], a[208:211], a[116:119], v[40:43]
  v_mul_f32 v252, v252, v220
  v_mfma_f32_16x16x32_bf16 v[68:71], a[208:211], a[16:19], v[68:71]
  v_mul_f32 v253, v253, v221
  v_mfma_f32_16x16x32_bf16 v[96:99], a[208:211], a[20:23], v[96:99]
  buffer_load_dwordx4 a[108:111], v226, s[12:15], s54 offen offset:1024 sc1
  s_waitcnt vmcnt(15)
  v_mfma_f32_16x16x32_bf16 v[16:19], a[152:155], a[112:115], v[16:19]
  v_mul_f32 v254, v254, v222
  v_mfma_f32_16x16x32_bf16 v[44:47], a[152:155], a[116:119], v[44:47]
  v_mul_f32 v255, v255, v223
  v_mfma_f32_16x16x32_bf16 v[72:75], a[152:155], a[16:19], v[72:75]
  v_exp_f32 v252, v252
  v_mfma_f32_16x16x32_bf16 v[100:103], a[152:155], a[20:23], v[100:103]
  buffer_load_dwordx4 a[192:195], v226, s[12:15], s54 offen offset:2048 sc1
  s_waitcnt vmcnt(15)
  v_mfma_f32_16x16x32_bf16 v[20:23], a[212:215], a[112:115], v[20:23]
  v_exp_f32 v253, v253
  v_mfma_f32_16x16x32_bf16 v[48:51], a[212:215], a[116:119], v[48:51]
  v_exp_f32 v254, v254
  v_mfma_f32_16x16x32_bf16 v[76:79], a[212:215], a[16:19], v[76:79]
  v_exp_f32 v255, v255
  v_mfma_f32_16x16x32_bf16 v[104:107], a[212:215], a[20:23], v[104:107]
  s_mov_b32 s54, 78848
  buffer_load_dwordx4 a[196:199], v225, s[12:15], s54 offen offset:0 sc1
  s_waitcnt vmcnt(15)
  v_mfma_f32_16x16x32_bf16 v[24:27], a[172:175], a[112:115], v[24:27]
  v_add_f32 v252, 1.0, v252
  v_mfma_f32_16x16x32_bf16 v[52:55], a[172:175], a[116:119], v[52:55]
  v_add_f32 v253, 1.0, v253
  v_mfma_f32_16x16x32_bf16 v[80:83], a[172:175], a[16:19], v[80:83]
  v_add_f32 v254, 1.0, v254
  v_mfma_f32_16x16x32_bf16 v[108:111], a[172:175], a[20:23], v[108:111]
  buffer_load_dwordx4 a[240:243], v225, s[12:15], s54 offen offset:1024 sc1
  s_waitcnt vmcnt(15)
  v_mfma_f32_16x16x32_bf16 v[0:3], a[28:31], a[48:51], v[0:3]
  v_add_f32 v255, 1.0, v255
  v_mfma_f32_16x16x32_bf16 v[28:31], a[28:31], a[52:55], v[28:31]
  v_rcp_f32 v252, v252
  v_mfma_f32_16x16x32_bf16 v[56:59], a[28:31], a[24:27], v[56:59]
  v_rcp_f32 v253, v253
  v_mfma_f32_16x16x32_bf16 v[84:87], a[28:31], a[120:123], v[84:87]
  buffer_load_dwordx4 a[252:255], v225, s[12:15], s54 offen offset:2048 sc1
  s_waitcnt vmcnt(15)
  v_mfma_f32_16x16x32_bf16 v[4:7], a[64:67], a[48:51], v[4:7]
  v_rcp_f32 v254, v254
  v_mfma_f32_16x16x32_bf16 v[32:35], a[64:67], a[52:55], v[32:35]
  v_rcp_f32 v255, v255
  v_mfma_f32_16x16x32_bf16 v[60:63], a[64:67], a[24:27], v[60:63]
  v_mul_f32 v220, v220, v252
  v_mfma_f32_16x16x32_bf16 v[88:91], a[64:67], a[120:123], v[88:91]
  buffer_load_dwordx4 a[236:239], v225, s[12:15], s54 offen offset:3072 sc1
  s_waitcnt vmcnt(15)
  v_mfma_f32_16x16x32_bf16 v[8:11], a[56:59], a[48:51], v[8:11]
  v_mul_f32 v221, v221, v253
  v_mfma_f32_16x16x32_bf16 v[36:39], a[56:59], a[52:55], v[36:39]
  v_mul_f32 v222, v222, v254
  v_mfma_f32_16x16x32_bf16 v[64:67], a[56:59], a[24:27], v[64:67]
  v_mul_f32 v223, v223, v255
  v_mfma_f32_16x16x32_bf16 v[92:95], a[56:59], a[120:123], v[92:95]
  buffer_load_dwordx4 a[124:127], v226, s[12:15], s54 offen offset:0 sc1
  s_waitcnt vmcnt(15)
  v_mfma_f32_16x16x32_bf16 v[12:15], a[84:87], a[48:51], v[12:15]
  v_mfma_f32_16x16x32_bf16 v[40:43], a[84:87], a[52:55], v[40:43]
  v_mfma_f32_16x16x32_bf16 v[68:71], a[84:87], a[24:27], v[68:71]
  v_mfma_f32_16x16x32_bf16 v[96:99], a[84:87], a[120:123], v[96:99]
  buffer_load_dwordx4 a[12:15], v226, s[12:15], s54 offen offset:1024 sc1
  s_waitcnt vmcnt(15)
  v_mfma_f32_16x16x32_bf16 v[16:19], a[60:63], a[48:51], v[16:19]
  v_mfma_f32_16x16x32_bf16 v[44:47], a[60:63], a[52:55], v[44:47]
  v_mfma_f32_16x16x32_bf16 v[72:75], a[60:63], a[24:27], v[72:75]
  v_mfma_f32_16x16x32_bf16 v[100:103], a[60:63], a[120:123], v[100:103]
  buffer_load_dwordx4 a[40:43], v226, s[12:15], s54 offen offset:2048 sc1
  s_waitcnt vmcnt(15)
  v_mfma_f32_16x16x32_bf16 v[20:23], a[216:219], a[48:51], v[20:23]
  v_mfma_f32_16x16x32_bf16 v[48:51], a[216:219], a[52:55], v[48:51]
  v_mfma_f32_16x16x32_bf16 v[76:79], a[216:219], a[24:27], v[76:79]
  v_mfma_f32_16x16x32_bf16 v[104:107], a[216:219], a[120:123], v[104:107]
  s_mov_b32 s54, 86016
  buffer_load_dwordx4 a[0:3], v225, s[12:15], s54 offen offset:0 sc1
  s_waitcnt vmcnt(15)
  v_mfma_f32_16x16x32_bf16 v[24:27], a[220:223], a[48:51], v[24:27]
  v_mfma_f32_16x16x32_bf16 v[52:55], a[220:223], a[52:55], v[52:55]
  v_mfma_f32_16x16x32_bf16 v[80:83], a[220:223], a[24:27], v[80:83]
  v_mfma_f32_16x16x32_bf16 v[108:111], a[220:223], a[120:123], v[108:111]
  buffer_load_dwordx4 a[4:7], v225, s[12:15], s54 offen offset:1024 sc1
  s_waitcnt vmcnt(15)
  v_mfma_f32_16x16x32_bf16 v[0:3], a[228:231], a[88:91], v[0:3]
  v_mfma_f32_16x16x32_bf16 v[28:31], a[228:231], a[136:139], v[28:31]
  v_mfma_f32_16x16x32_bf16 v[56:59], a[228:231], a[156:159], v[56:59]
  v_mfma_f32_16x16x32_bf16 v[84:87], a[228:231], a[176:179], v[84:87]
  buffer_load_dwordx4 a[32:35], v225, s[12:15], s54 offen offset:2048 sc1
  s_waitcnt vmcnt(15)
  v_mfma_f32_16x16x32_bf16 v[4:7], a[232:235], a[88:91], v[4:7]
  v_mfma_f32_16x16x32_bf16 v[32:35], a[232:235], a[136:139], v[32:35]
  v_mfma_f32_16x16x32_bf16 v[60:63], a[232:235], a[156:159], v[60:63]
  v_mfma_f32_16x16x32_bf16 v[88:91], a[232:235], a[176:179], v[88:91]
  buffer_load_dwordx4 a[8:11], v225, s[12:15], s54 offen offset:3072 sc1
  s_waitcnt vmcnt(15)
  v_mfma_f32_16x16x32_bf16 v[8:11], a[128:131], a[88:91], v[8:11]
  v_mfma_f32_16x16x32_bf16 v[36:39], a[128:131], a[136:139], v[36:39]
  v_mfma_f32_16x16x32_bf16 v[64:67], a[128:131], a[156:159], v[64:67]
  v_mfma_f32_16x16x32_bf16 v[92:95], a[128:131], a[176:179], v[92:95]
  buffer_load_dwordx4 a[92:95], v226, s[12:15], s54 offen offset:0 sc1
  s_waitcnt vmcnt(15)
  v_mfma_f32_16x16x32_bf16 v[12:15], a[244:247], a[88:91], v[12:15]
  v_mfma_f32_16x16x32_bf16 v[40:43], a[244:247], a[136:139], v[40:43]
  v_mfma_f32_16x16x32_bf16 v[68:71], a[244:247], a[156:159], v[68:71]
  v_mfma_f32_16x16x32_bf16 v[96:99], a[244:247], a[176:179], v[96:99]
  buffer_load_dwordx4 a[96:99], v226, s[12:15], s54 offen offset:1024 sc1
  s_waitcnt vmcnt(15)
  v_mfma_f32_16x16x32_bf16 v[16:19], a[248:251], a[88:91], v[16:19]
  v_mfma_f32_16x16x32_bf16 v[44:47], a[248:251], a[136:139], v[44:47]
  v_mfma_f32_16x16x32_bf16 v[72:75], a[248:251], a[156:159], v[72:75]
  v_mfma_f32_16x16x32_bf16 v[100:103], a[248:251], a[176:179], v[100:103]
  buffer_load_dwordx4 a[100:103], v226, s[12:15], s54 offen offset:2048 sc1
  s_waitcnt vmcnt(15)
  v_mfma_f32_16x16x32_bf16 v[20:23], a[108:111], a[88:91], v[20:23]
  v_mfma_f32_16x16x32_bf16 v[48:51], a[108:111], a[136:139], v[48:51]
  v_mfma_f32_16x16x32_bf16 v[76:79], a[108:111], a[156:159], v[76:79]
  v_mfma_f32_16x16x32_bf16 v[104:107], a[108:111], a[176:179], v[104:107]
  s_mov_b32 s54, 93184
  buffer_load_dwordx4 a[132:135], v225, s[12:15], s54 offen offset:0 sc1
  s_waitcnt vmcnt(15)
  v_mfma_f32_16x16x32_bf16 v[24:27], a[192:195], a[88:91], v[24:27]
  v_mfma_f32_16x16x32_bf16 v[52:55], a[192:195], a[136:139], v[52:55]
  v_mfma_f32_16x16x32_bf16 v[80:83], a[192:195], a[156:159], v[80:83]
  v_mfma_f32_16x16x32_bf16 v[108:111], a[192:195], a[176:179], v[108:111]
  buffer_load_dwordx4 a[44:47], v225, s[12:15], s54 offen offset:1024 sc1
  s_waitcnt vmcnt(15)
  v_mfma_f32_16x16x32_bf16 v[0:3], a[196:199], a[68:71], v[0:3]
  v_mfma_f32_16x16x32_bf16 v[28:31], a[196:199], a[140:143], v[28:31]
  v_mfma_f32_16x16x32_bf16 v[56:59], a[196:199], a[160:163], v[56:59]
  v_mfma_f32_16x16x32_bf16 v[84:87], a[196:199], a[180:183], v[84:87]
  buffer_load_dwordx4 a[200:203], v225, s[12:15], s54 offen offset:2048 sc1
  s_waitcnt vmcnt(15)
  v_mfma_f32_16x16x32_bf16 v[4:7], a[240:243], a[68:71], v[4:7]
  v_mfma_f32_16x16x32_bf16 v[32:35], a[240:243], a[140:143], v[32:35]
  v_mfma_f32_16x16x32_bf16 v[60:63], a[240:243], a[160:163], v[60:63]
  v_mfma_f32_16x16x32_bf16 v[88:91], a[240:243], a[180:183], v[88:91]
  buffer_load_dwordx4 a[204:207], v225, s[12:15], s54 offen offset:3072 sc1
  s_waitcnt vmcnt(15)
  v_mfma_f32_16x16x32_bf16 v[8:11], a[252:255], a[68:71], v[8:11]
  v_mfma_f32_16x16x32_bf16 v[36:39], a[252:255], a[140:143], v[36:39]
  v_mfma_f32_16x16x32_bf16 v[64:67], a[252:255], a[160:163], v[64:67]
  v_mfma_f32_16x16x32_bf16 v[92:95], a[252:255], a[180:183], v[92:95]
  buffer_load_dwordx4 a[104:107], v226, s[12:15], s54 offen offset:0 sc1
  s_waitcnt vmcnt(15)
  v_mfma_f32_16x16x32_bf16 v[12:15], a[236:239], a[68:71], v[12:15]
  v_mfma_f32_16x16x32_bf16 v[40:43], a[236:239], a[140:143], v[40:43]
  v_mfma_f32_16x16x32_bf16 v[68:71], a[236:239], a[160:163], v[68:71]
  v_mfma_f32_16x16x32_bf16 v[96:99], a[236:239], a[180:183], v[96:99]
  buffer_load_dwordx4 a[36:39], v226, s[12:15], s54 offen offset:1024 sc1
  s_waitcnt vmcnt(15)
  v_mfma_f32_16x16x32_bf16 v[16:19], a[124:127], a[68:71], v[16:19]
  v_mfma_f32_16x16x32_bf16 v[44:47], a[124:127], a[140:143], v[44:47]
  v_mfma_f32_16x16x32_bf16 v[72:75], a[124:127], a[160:163], v[72:75]
  v_mfma_f32_16x16x32_bf16 v[100:103], a[124:127], a[180:183], v[100:103]
  buffer_load_dwordx4 a[224:227], v226, s[12:15], s54 offen offset:2048 sc1
  s_waitcnt vmcnt(15)
  v_mfma_f32_16x16x32_bf16 v[20:23], a[12:15], a[68:71], v[20:23]
  v_mfma_f32_16x16x32_bf16 v[48:51], a[12:15], a[140:143], v[48:51]
  v_mfma_f32_16x16x32_bf16 v[76:79], a[12:15], a[160:163], v[76:79]
  v_mfma_f32_16x16x32_bf16 v[104:107], a[12:15], a[180:183], v[104:107]
  s_xor_b32 s55, s40, 57344
  buffer_load_dwordx4 v[124:127], v225, s[96:99], s55 offen sc1
  s_waitcnt vmcnt(15)
  v_mfma_f32_16x16x32_bf16 v[24:27], a[40:43], a[68:71], v[24:27]
  v_mfma_f32_16x16x32_bf16 v[52:55], a[40:43], a[140:143], v[52:55]
  v_mfma_f32_16x16x32_bf16 v[80:83], a[40:43], a[160:163], v[80:83]
  v_mfma_f32_16x16x32_bf16 v[108:111], a[40:43], a[180:183], v[108:111]
  s_xor_b32 s55, s41, 57344
  buffer_load_dwordx4 v[192:195], v225, s[96:99], s55 offen sc1
  s_waitcnt vmcnt(15)
  v_mfma_f32_16x16x32_bf16 v[0:3], a[0:3], a[72:75], v[0:3]
  v_mfma_f32_16x16x32_bf16 v[28:31], a[0:3], a[144:147], v[28:31]
  v_mfma_f32_16x16x32_bf16 v[56:59], a[0:3], a[164:167], v[56:59]
  s_xor_b32 s55, s42, 57344
  buffer_load_dwordx4 v[128:131], v225, s[96:99], s55 offen sc1
  v_mfma_f32_16x16x32_bf16 v[84:87], a[0:3], a[184:187], v[84:87]
  s_waitcnt vmcnt(15)
  v_mfma_f32_16x16x32_bf16 v[4:7], a[4:7], a[72:75], v[4:7]
  v_mfma_f32_16x16x32_bf16 v[32:35], a[4:7], a[144:147], v[32:35]
  s_xor_b32 s55, s43, 57344
  buffer_load_dwordx4 v[132:135], v225, s[96:99], s55 offen sc1
  v_mfma_f32_16x16x32_bf16 v[60:63], a[4:7], a[164:167], v[60:63]
  v_mfma_f32_16x16x32_bf16 v[88:91], a[4:7], a[184:187], v[88:91]
  s_mov_b32 s54, 100352
  buffer_load_dwordx4 a[80:83], v225, s[12:15], s54 offen offset:0 sc1
  s_waitcnt vmcnt(16)
  v_mfma_f32_16x16x32_bf16 v[8:11], a[32:35], a[72:75], v[8:11]
  v_mfma_f32_16x16x32_bf16 v[36:39], a[32:35], a[144:147], v[36:39]
  v_mfma_f32_16x16x32_bf16 v[64:67], a[32:35], a[164:167], v[64:67]
  buffer_load_dwordx4 a[208:211], v225, s[12:15], s54 offen offset:1024 sc1
  v_mfma_f32_16x16x32_bf16 v[92:95], a[32:35], a[184:187], v[92:95]
  s_waitcnt vmcnt(16)
  v_mfma_f32_16x16x32_bf16 v[12:15], a[8:11], a[72:75], v[12:15]
  buffer_load_dwordx4 a[152:155], v225, s[12:15], s54 offen offset:2048 sc1
  v_mfma_f32_16x16x32_bf16 v[40:43], a[8:11], a[144:147], v[40:43]
  v_mfma_f32_16x16x32_bf16 v[68:71], a[8:11], a[164:167], v[68:71]
  v_mfma_f32_16x16x32_bf16 v[96:99], a[8:11], a[184:187], v[96:99]
  buffer_load_dwordx4 a[212:215], v225, s[12:15], s54 offen offset:3072 sc1
  s_waitcnt vmcnt(17)
  v_mfma_f32_16x16x32_bf16 v[16:19], a[92:95], a[72:75], v[16:19]
  v_mfma_f32_16x16x32_bf16 v[44:47], a[92:95], a[144:147], v[44:47]
  buffer_load_dwordx4 a[112:115], v226, s[12:15], s54 offen offset:0 sc1
  v_mfma_f32_16x16x32_bf16 v[72:75], a[92:95], a[164:167], v[72:75]
  v_mfma_f32_16x16x32_bf16 v[100:103], a[92:95], a[184:187], v[100:103]
  s_waitcnt vmcnt(17)
  v_mfma_f32_16x16x32_bf16 v[20:23], a[96:99], a[72:75], v[20:23]
  buffer_load_dwordx4 a[116:119], v226, s[12:15], s54 offen offset:1024 sc1
  v_mfma_f32_16x16x32_bf16 v[48:51], a[96:99], a[144:147], v[48:51]
  v_mfma_f32_16x16x32_bf16 v[76:79], a[96:99], a[164:167], v[76:79]
  buffer_load_dwordx4 a[16:19], v226, s[12:15], s54 offen offset:2048 sc1
  v_mfma_f32_16x16x32_bf16 v[104:107], a[96:99], a[184:187], v[104:107]
  s_waitcnt vmcnt(18)
  v_mfma_f32_16x16x32_bf16 v[24:27], a[100:103], a[72:75], v[24:27]
  v_mfma_f32_16x16x32_bf16 v[52:55], a[100:103], a[144:147], v[52:55]
  s_xor_b32 s55, s40, 61440
  buffer_load_dwordx4 v[136:139], v225, s[96:99], s55 offen sc1
  v_mfma_f32_16x16x32_bf16 v[80:83], a[100:103], a[164:167], v[80:83]
  v_mfma_f32_16x16x32_bf16 v[108:111], a[100:103], a[184:187], v[108:111]
  s_xor_b32 s55, s41, 61440
  buffer_load_dwordx4 v[140:143], v225, s[96:99], s55 offen sc1
  s_waitcnt vmcnt(19)
  v_mfma_f32_16x16x32_bf16 v[28:31], a[132:135], a[148:151], v[28:31]
  s_waitcnt vmcnt(18)
  v_mfma_f32_16x16x32_bf16 v[32:35], a[44:47], a[148:151], v[32:35]
  s_xor_b32 s55, s42, 61440
  buffer_load_dwordx4 v[144:147], v225, s[96:99], s55 offen sc1
  s_waitcnt vmcnt(18)
  v_mfma_f32_16x16x32_bf16 v[36:39], a[200:203], a[148:151], v[36:39]
  s_xor_b32 s55, s43, 61440
  buffer_load_dwordx4 v[148:151], v225, s[96:99], s55 offen sc1
  s_waitcnt vmcnt(18)
  v_mfma_f32_16x16x32_bf16 v[40:43], a[204:207], a[148:151], v[40:43]
  s_mov_b32 s54, 107520
  buffer_load_dwordx4 a[20:23], v225, s[12:15], s54 offen offset:0 sc1
  s_waitcnt vmcnt(18)
  v_mfma_f32_16x16x32_bf16 v[44:47], a[104:107], a[148:151], v[44:47]
  buffer_load_dwordx4 a[172:175], v225, s[12:15], s54 offen offset:1024 sc1
  s_waitcnt vmcnt(18)
  v_mfma_f32_16x16x32_bf16 v[48:51], a[36:39], a[148:151], v[48:51]
  s_waitcnt vmcnt(17)
  v_mfma_f32_16x16x32_bf16 v[52:55], a[224:227], a[148:151], v[52:55]
  buffer_load_dwordx4 a[28:31], v225, s[12:15], s54 offen offset:2048 sc1
  s_waitcnt vmcnt(13)
  v_mfma_f32_16x16x32_bf16 v[28:31], a[80:83], v[192:195], v[28:31]
  buffer_load_dwordx4 a[64:67], v225, s[12:15], s54 offen offset:3072 sc1
  s_waitcnt vmcnt(13)
  v_mfma_f32_16x16x32_bf16 v[32:35], a[208:211], v[192:195], v[32:35]
  buffer_load_dwordx4 a[56:59], v226, s[12:15], s54 offen offset:0 sc1
  s_waitcnt vmcnt(13)
  v_mfma_f32_16x16x32_bf16 v[36:39], a[152:155], v[192:195], v[36:39]
  buffer_load_dwordx4 a[84:87], v226, s[12:15], s54 offen offset:1024 sc1
  s_waitcnt vmcnt(13)
  v_mfma_f32_16x16x32_bf16 v[40:43], a[212:215], v[192:195], v[40:43]
  s_waitcnt vmcnt(12)
  v_mfma_f32_16x16x32_bf16 v[44:47], a[112:115], v[192:195], v[44:47]
  buffer_load_dwordx4 a[60:63], v226, s[12:15], s54 offen offset:2048 sc1
  s_waitcnt vmcnt(12)
  v_mfma_f32_16x16x32_bf16 v[48:51], a[116:119], v[192:195], v[48:51]
  s_mul_i32 s56, s3, 14336
  s_add_u32 m0, s56, 86016
  s_add_u32 s54, s56, 86016
  buffer_load_dwordx4 v225, s[32:35], s54 offen sc1 lds
  s_waitcnt vmcnt(12)
  v_mfma_f32_16x16x32_bf16 v[52:55], a[16:19], v[192:195], v[52:55]
  s_add_u32 m0, s56, 87040
  s_add_u32 s54, s56, 87040
  buffer_load_dwordx4 v225, s[32:35], s54 offen sc1 lds
  s_waitcnt vmcnt(8)
  v_mfma_f32_16x16x32_bf16 v[28:31], a[20:23], v[140:143], v[28:31]
  s_add_u32 m0, s56, 88064
  s_add_u32 s54, s56, 88064
  buffer_load_dwordx4 v225, s[32:35], s54 offen sc1 lds
  s_waitcnt vmcnt(8)
  v_mfma_f32_16x16x32_bf16 v[32:35], a[172:175], v[140:143], v[32:35]
  s_waitcnt vmcnt(7)
  v_mfma_f32_16x16x32_bf16 v[36:39], a[28:31], v[140:143], v[36:39]
  s_add_u32 m0, s56, 89088
  s_add_u32 s54, s56, 89088
  buffer_load_dwordx4 v225, s[32:35], s54 offen sc1 lds
  s_waitcnt vmcnt(7)
  v_mfma_f32_16x16x32_bf16 v[40:43], a[64:67], v[140:143], v[40:43]
  s_add_u32 m0, s56, 90112
  s_add_u32 s54, s56, 90112
  buffer_load_dwordx4 v225, s[32:35], s54 offen sc1 lds
  s_waitcnt vmcnt(7)
  v_mfma_f32_16x16x32_bf16 v[44:47], a[56:59], v[140:143], v[44:47]
  s_add_u32 m0, s56, 91136
  s_add_u32 s54, s56, 91136
  buffer_load_dwordx4 v225, s[32:35], s54 offen sc1 lds
  s_waitcnt vmcnt(7)
  v_mfma_f32_16x16x32_bf16 v[48:51], a[84:87], v[140:143], v[48:51]
  s_add_u32 m0, s56, 92160
  s_add_u32 s54, s56, 92160
  buffer_load_dwordx4 v225, s[32:35], s54 offen sc1 lds
  s_waitcnt vmcnt(7)
  v_mfma_f32_16x16x32_bf16 v[52:55], a[60:63], v[140:143], v[52:55]
  s_add_u32 m0, s56, 93184
  s_add_u32 s54, s56, 93184
  buffer_load_dwordx4 v225, s[32:35], s54 offen sc1 lds
  v_mfma_f32_16x16x32_bf16 v[56:59], a[132:135], a[168:171], v[56:59]
  v_mfma_f32_16x16x32_bf16 v[56:59], a[80:83], v[128:131], v[56:59]
  v_mfma_f32_16x16x32_bf16 v[56:59], a[20:23], v[144:147], v[56:59]
  v_mfma_f32_16x16x32_bf16 v[60:63], a[44:47], a[168:171], v[60:63]
  ds_write_b128 v241, v[28:31] offset:0
  v_mfma_f32_16x16x32_bf16 v[60:63], a[208:211], v[128:131], v[60:63]
  v_mfma_f32_16x16x32_bf16 v[60:63], a[172:175], v[144:147], v[60:63]
  ds_write_b128 v241, v[32:35] offset:1024
  v_mfma_f32_16x16x32_bf16 v[64:67], a[200:203], a[168:171], v[64:67]
  v_mfma_f32_16x16x32_bf16 v[64:67], a[152:155], v[128:131], v[64:67]
  ds_write_b128 v241, v[36:39] offset:2048
  v_mfma_f32_16x16x32_bf16 v[64:67], a[28:31], v[144:147], v[64:67]
  v_mfma_f32_16x16x32_bf16 v[68:71], a[204:207], a[168:171], v[68:71]
  ds_write_b128 v241, v[40:43] offset:3072
  v_mfma_f32_16x16x32_bf16 v[68:71], a[212:215], v[128:131], v[68:71]
  v_mfma_f32_16x16x32_bf16 v[68:71], a[64:67], v[144:147], v[68:71]
  ds_write_b128 v241, v[44:47] offset:4096
  v_mfma_f32_16x16x32_bf16 v[72:75], a[104:107], a[168:171], v[72:75]
  v_mfma_f32_16x16x32_bf16 v[72:75], a[112:115], v[128:131], v[72:75]
  ds_write_b128 v241, v[48:51] offset:5120
  v_mfma_f32_16x16x32_bf16 v[72:75], a[56:59], v[144:147], v[72:75]
  ds_write_b128 v241, v[52:55] offset:6144
  v_mfma_f32_16x16x32_bf16 v[76:79], a[36:39], a[168:171], v[76:79]
  v_mfma_f32_16x16x32_bf16 v[76:79], a[116:119], v[128:131], v[76:79]
  v_mfma_f32_16x16x32_bf16 v[76:79], a[84:87], v[144:147], v[76:79]
  v_mfma_f32_16x16x32_bf16 v[80:83], a[224:227], a[168:171], v[80:83]
  v_mfma_f32_16x16x32_bf16 v[80:83], a[16:19], v[128:131], v[80:83]
  v_mfma_f32_16x16x32_bf16 v[80:83], a[60:63], v[144:147], v[80:83]
  v_mfma_f32_16x16x32_bf16 v[84:87], a[132:135], a[188:191], v[84:87]
  v_mfma_f32_16x16x32_bf16 v[84:87], a[80:83], v[132:135], v[84:87]
  v_mfma_f32_16x16x32_bf16 v[84:87], a[20:23], v[148:151], v[84:87]
  v_mfma_f32_16x16x32_bf16 v[88:91], a[44:47], a[188:191], v[88:91]
  ds_write_b128 v242, v[56:59] offset:7168
  v_mfma_f32_16x16x32_bf16 v[88:91], a[208:211], v[132:135], v[88:91]
  v_mfma_f32_16x16x32_bf16 v[88:91], a[172:175], v[148:151], v[88:91]
  ds_write_b128 v242, v[60:63] offset:8192
  v_mfma_f32_16x16x32_bf16 v[92:95], a[200:203], a[188:191], v[92:95]
  v_mfma_f32_16x16x32_bf16 v[92:95], a[152:155], v[132:135], v[92:95]
  ds_write_b128 v242, v[64:67] offset:9216
  v_mfma_f32_16x16x32_bf16 v[92:95], a[28:31], v[148:151], v[92:95]
  v_mfma_f32_16x16x32_bf16 v[96:99], a[204:207], a[188:191], v[96:99]
  ds_write_b128 v242, v[68:71] offset:10240
  v_mfma_f32_16x16x32_bf16 v[96:99], a[212:215], v[132:135], v[96:99]
  v_mfma_f32_16x16x32_bf16 v[96:99], a[64:67], v[148:151], v[96:99]
  ds_write_b128 v242, v[72:75] offset:11264
  v_mfma_f32_16x16x32_bf16 v[100:103], a[104:107], a[188:191], v[100:103]
  v_mfma_f32_16x16x32_bf16 v[100:103], a[112:115], v[132:135], v[100:103]
  ds_write_b128 v242, v[76:79] offset:12288
  v_mfma_f32_16x16x32_bf16 v[100:103], a[56:59], v[148:151], v[100:103]
  ds_write_b128 v242, v[80:83] offset:13312
  v_mfma_f32_16x16x32_bf16 v[104:107], a[36:39], a[188:191], v[104:107]
  v_mfma_f32_16x16x32_bf16 v[104:107], a[116:119], v[132:135], v[104:107]
  v_mfma_f32_16x16x32_bf16 v[104:107], a[84:87], v[148:151], v[104:107]
  v_mfma_f32_16x16x32_bf16 v[108:111], a[224:227], a[188:191], v[108:111]
  v_mfma_f32_16x16x32_bf16 v[108:111], a[16:19], v[132:135], v[108:111]
  v_mfma_f32_16x16x32_bf16 v[108:111], a[60:63], v[148:151], v[108:111]
  v_mfma_f32_16x16x32_bf16 v[0:3], a[132:135], a[76:79], v[0:3]
  v_mfma_f32_16x16x32_bf16 v[0:3], a[80:83], v[124:127], v[0:3]
  v_mfma_f32_16x16x32_bf16 v[0:3], a[20:23], v[136:139], v[0:3]
  s_waitcnt lgkmcnt(0)
  s_barrier
  ds_write_b128 v243, v[84:87] offset:14336
  v_mfma_f32_16x16x32_bf16 v[4:7], a[44:47], a[76:79], v[4:7]
  ds_write_b128 v243, v[88:91] offset:15360
  v_mfma_f32_16x16x32_bf16 v[4:7], a[208:211], v[124:127], v[4:7]
  ds_write_b128 v243, v[92:95] offset:16384
  v_mfma_f32_16x16x32_bf16 v[4:7], a[172:175], v[136:139], v[4:7]
  ds_write_b128 v243, v[96:99] offset:17408
  v_mfma_f32_16x16x32_bf16 v[8:11], a[200:203], a[76:79], v[8:11]
  ds_write_b128 v243, v[100:103] offset:18432
  v_mfma_f32_16x16x32_bf16 v[8:11], a[152:155], v[124:127], v[8:11]
  ds_write_b128 v243, v[104:107] offset:19456
  ds_write_b128 v243, v[108:111] offset:20480
  v_mfma_f32_16x16x32_bf16 v[8:11], a[28:31], v[136:139], v[8:11]
  ds_read_b128 v[28:31], v240 offset:0
  v_mfma_f32_16x16x32_bf16 v[12:15], a[204:207], a[76:79], v[12:15]
  ds_read_b128 v[32:35], v240 offset:1024
  v_mfma_f32_16x16x32_bf16 v[12:15], a[212:215], v[124:127], v[12:15]
  ds_read_b128 v[36:39], v240 offset:2048
  v_mfma_f32_16x16x32_bf16 v[12:15], a[64:67], v[136:139], v[12:15]
  ds_read_b128 v[40:43], v240 offset:3072
  v_mfma_f32_16x16x32_bf16 v[16:19], a[104:107], a[76:79], v[16:19]
  ds_read_b128 v[44:47], v240 offset:4096
  v_mfma_f32_16x16x32_bf16 v[16:19], a[112:115], v[124:127], v[16:19]
  ds_read_b128 v[48:51], v240 offset:5120
  ds_read_b128 v[52:55], v240 offset:6144
  v_mfma_f32_16x16x32_bf16 v[16:19], a[56:59], v[136:139], v[16:19]
  ds_read_b128 v[56:59], v240 offset:7168
  v_mfma_f32_16x16x32_bf16 v[20:23], a[36:39], a[76:79], v[20:23]
  ds_read_b128 v[60:63], v240 offset:8192
  v_mfma_f32_16x16x32_bf16 v[20:23], a[116:119], v[124:127], v[20:23]
  ds_read_b128 v[64:67], v240 offset:9216
  v_mfma_f32_16x16x32_bf16 v[20:23], a[84:87], v[136:139], v[20:23]
  ds_read_b128 v[68:71], v240 offset:10240
  v_mfma_f32_16x16x32_bf16 v[24:27], a[224:227], a[76:79], v[24:27]
  ds_read_b128 v[72:75], v240 offset:11264
  v_mfma_f32_16x16x32_bf16 v[24:27], a[16:19], v[124:127], v[24:27]
  ds_read_b128 v[76:79], v240 offset:12288
  ds_read_b128 v[80:83], v240 offset:13312
  v_mfma_f32_16x16x32_bf16 v[24:27], a[60:63], v[136:139], v[24:27]
  s_waitcnt lgkmcnt(0)
  s_barrier
  ds_read_b128 v[84:87], v240 offset:14336
  ds_read_b128 v[88:91], v240 offset:15360
  ds_read_b128 v[92:95], v240 offset:16384
  ds_read_b128 v[96:99], v240 offset:17408
  ds_read_b128 v[100:103], v240 offset:18432
  ds_read_b128 v[104:107], v240 offset:19456
  ds_read_b128 v[108:111], v240 offset:20480
  v_pk_add_f32 v[0:1], v[0:1], v[28:29]
  v_pk_add_f32 v[2:3], v[2:3], v[30:31]
  v_pk_add_f32 v[4:5], v[4:5], v[32:33]
  v_pk_add_f32 v[6:7], v[6:7], v[34:35]
  v_pk_add_f32 v[8:9], v[8:9], v[36:37]
  s_add_u32 m0, s56, 94208
  s_add_u32 s54, s56, 94208
  buffer_load_dwordx4 v225, s[32:35], s54 offen sc1 lds
  v_pk_add_f32 v[10:11], v[10:11], v[38:39]
  v_pk_add_f32 v[12:13], v[12:13], v[40:41]
  v_pk_add_f32 v[14:15], v[14:15], v[42:43]
  v_pk_add_f32 v[16:17], v[16:17], v[44:45]
  v_pk_add_f32 v[18:19], v[18:19], v[46:47]
  v_pk_add_f32 v[20:21], v[20:21], v[48:49]
  v_pk_add_f32 v[22:23], v[22:23], v[50:51]
  v_pk_add_f32 v[24:25], v[24:25], v[52:53]
  v_pk_add_f32 v[26:27], v[26:27], v[54:55]
  v_pk_add_f32 v[0:1], v[0:1], v[56:57]
  v_pk_add_f32 v[2:3], v[2:3], v[58:59]
  v_pk_add_f32 v[4:5], v[4:5], v[60:61]
  v_pk_add_f32 v[6:7], v[6:7], v[62:63]
  v_pk_add_f32 v[8:9], v[8:9], v[64:65]
  s_add_u32 m0, s56, 95232
  s_add_u32 s54, s56, 95232
  buffer_load_dwordx4 v225, s[32:35], s54 offen sc1 lds
  v_pk_add_f32 v[10:11], v[10:11], v[66:67]
  v_pk_add_f32 v[12:13], v[12:13], v[68:69]
  v_pk_add_f32 v[14:15], v[14:15], v[70:71]
  v_pk_add_f32 v[16:17], v[16:17], v[72:73]
  v_pk_add_f32 v[18:19], v[18:19], v[74:75]
  v_pk_add_f32 v[20:21], v[20:21], v[76:77]
  v_pk_add_f32 v[22:23], v[22:23], v[78:79]
  v_pk_add_f32 v[24:25], v[24:25], v[80:81]
  v_pk_add_f32 v[26:27], v[26:27], v[82:83]
  s_waitcnt lgkmcnt(0)
  v_pk_add_f32 v[0:1], v[0:1], v[84:85]
  v_pk_add_f32 v[2:3], v[2:3], v[86:87]
  v_pk_add_f32 v[4:5], v[4:5], v[88:89]
  v_pk_add_f32 v[6:7], v[6:7], v[90:91]
  s_add_u32 m0, s56, 96256
  s_add_u32 s54, s56, 96256
  buffer_load_dwordx4 v225, s[32:35], s54 offen sc1 lds
  v_pk_add_f32 v[8:9], v[8:9], v[92:93]
  v_pk_add_f32 v[10:11], v[10:11], v[94:95]
  v_pk_add_f32 v[12:13], v[12:13], v[96:97]
  v_pk_add_f32 v[14:15], v[14:15], v[98:99]
  v_pk_add_f32 v[16:17], v[16:17], v[100:101]
  v_pk_add_f32 v[18:19], v[18:19], v[102:103]
  v_pk_add_f32 v[20:21], v[20:21], v[104:105]
  v_pk_add_f32 v[22:23], v[22:23], v[106:107]
  v_pk_add_f32 v[24:25], v[24:25], v[108:109]
  v_pk_add_f32 v[26:27], v[26:27], v[110:111]
  v_pk_add_f32 v[0:1], v[0:1], v[244:245] op_sel_hi:[1,0]
  v_pk_mul_f32 v[0:1], v[0:1], v[196:197]
  v_cvt_pk_bf16_f32 v28, v0, v1
  v_pk_add_f32 v[2:3], v[2:3], v[244:245] op_sel_hi:[1,0]
  v_pk_mul_f32 v[2:3], v[2:3], v[198:199]
  v_cvt_pk_bf16_f32 v29, v2, v3
  v_pk_add_f32 v[4:5], v[4:5], v[244:245] op_sel_hi:[1,0]
  v_pk_mul_f32 v[4:5], v[4:5], v[200:201]
  v_cvt_pk_bf16_f32 v30, v4, v5
  v_pk_add_f32 v[6:7], v[6:7], v[244:245] op_sel_hi:[1,0]
  v_pk_mul_f32 v[6:7], v[6:7], v[202:203]
  v_cvt_pk_bf16_f32 v31, v6, v7
  buffer_store_dwordx4 v[28:31], v225, s[44:47], 0 offen offset:0 sc1
  v_pk_add_f32 v[8:9], v[8:9], v[244:245] op_sel_hi:[1,0]
  s_add_u32 m0, s56, 97280
  s_add_u32 s54, s56, 97280
  buffer_load_dwordx4 v225, s[32:35], s54 offen sc1 lds
  v_pk_mul_f32 v[8:9], v[8:9], v[204:205]
  v_cvt_pk_bf16_f32 v32, v8, v9
  v_pk_add_f32 v[10:11], v[10:11], v[244:245] op_sel_hi:[1,0]
  v_pk_mul_f32 v[10:11], v[10:11], v[206:207]
  v_cvt_pk_bf16_f32 v33, v10, v11
  v_pk_add_f32 v[12:13], v[12:13], v[244:245] op_sel_hi:[1,0]
  v_pk_mul_f32 v[12:13], v[12:13], v[208:209]
  v_cvt_pk_bf16_f32 v34, v12, v13
  v_pk_add_f32 v[14:15], v[14:15], v[244:245] op_sel_hi:[1,0]
  v_pk_mul_f32 v[14:15], v[14:15], v[210:211]
  v_cvt_pk_bf16_f32 v35, v14, v15
  buffer_store_dwordx4 v[32:35], v225, s[44:47], 0 offen offset:1024 sc1
  v_pk_add_f32 v[16:17], v[16:17], v[244:245] op_sel_hi:[1,0]
  v_pk_mul_f32 v[16:17], v[16:17], v[212:213]
  s_add_u32 m0, s56, 98304
  s_add_u32 s54, s56, 98304
  buffer_load_dwordx4 v225, s[32:35], s54 offen sc1 lds
  v_cvt_pk_bf16_f32 v36, v16, v17
  v_pk_add_f32 v[18:19], v[18:19], v[244:245] op_sel_hi:[1,0]
  v_pk_mul_f32 v[18:19], v[18:19], v[214:215]
  v_cvt_pk_bf16_f32 v37, v18, v19
  v_pk_add_f32 v[20:21], v[20:21], v[244:245] op_sel_hi:[1,0]
  v_pk_mul_f32 v[20:21], v[20:21], v[216:217]
  v_cvt_pk_bf16_f32 v38, v20, v21
  v_pk_add_f32 v[22:23], v[22:23], v[244:245] op_sel_hi:[1,0]
  v_pk_mul_f32 v[22:23], v[22:23], v[218:219]
  v_cvt_pk_bf16_f32 v39, v22, v23
  buffer_store_dwordx4 v[36:39], v225, s[44:47], 0 offen offset:2048 sc1
  v_pk_add_f32 v[24:25], v[24:25], v[244:245] op_sel_hi:[1,0]
  v_pk_mul_f32 v[24:25], v[24:25], v[220:221]
  v_cvt_pk_bf16_f32 v40, v24, v25
  s_add_u32 m0, s56, 99328
  s_add_u32 s54, s56, 99328
  buffer_load_dwordx4 v225, s[32:35], s54 offen sc1 lds
  v_pk_add_f32 v[26:27], v[26:27], v[244:245] op_sel_hi:[1,0]
  v_pk_mul_f32 v[26:27], v[26:27], v[222:223]
  v_cvt_pk_bf16_f32 v41, v26, v27
  v_mov_b32 v42, v40
  v_mov_b32 v43, v41
  s_nop 0
  v_permlane32_swap_b32 v40, v42
  v_permlane32_swap_b32 v41, v43
  buffer_store_dwordx4 v[40:43], v246, s[44:47], 0 offen sc1
  v_add_u32 v241, 65536, v225
  v_add_u32 v242, 131072, v225
  s_lshl_b32 s52, s57, 6
  s_lshl_b32 s53, s3, 4
  s_add_u32 s52, s52, s53
  s_mul_i32 s52, s52, 1280
  s_mul_i32 s62, s58, 160
  s_add_u32 s60, s52, s62
  v_add_u32 v244, 0, v224
  s_mul_i32 s56, s3, 21504
  s_add_u32 m0, s56, 0
  s_add_u32 s54, s56, 0
  buffer_load_dwordx4 v225, s[32:35], s54 offen sc1 lds
  v_mul_u32_u24 v245, 6554, v244
  v_lshrrev_b32 v245, 16, v245
  v_lshlrev_b32 v244, 4, v244
  v_mul_u32_u24 v245, 1120, v245
  v_add_u32 v107, v244, v245
  v_add_u32 v244, 64, v224
  v_mul_u32_u24 v245, 6554, v244
  v_lshrrev_b32 v245, 16, v245
  v_lshlrev_b32 v244, 4, v244
  s_add_u32 m0, s56, 1024
  s_add_u32 s54, s56, 1024
  buffer_load_dwordx4 v225, s[32:35], s54 offen sc1 lds
  v_mul_u32_u24 v245, 1120, v245
  v_add_u32 v108, v244, v245
  v_add_u32 v244, 128, v224
  v_mul_u32_u24 v245, 6554, v244
  v_lshrrev_b32 v245, 16, v245
  v_lshlrev_b32 v244, 4, v244
  v_mul_u32_u24 v245, 1120, v245
  v_add_u32 v109, v244, v245
  v_lshrrev_b32 v244, 5, v224
  s_add_u32 m0, s56, 2048
  s_add_u32 s54, s56, 2048
  buffer_load_dwordx4 v225, s[32:35], s54 offen sc1 lds
  v_lshl_add_u32 v109, v244, 28, v109
  s_lshl_b32 s52, s3, 12
  s_add_u32 s52, s52, 143360
  v_bfe_u32 v106, v224, 2, 1
  v_and_b32 v244, 3, v224
  v_lshl_add_u32 v106, v106, 3, v244
  v_bfe_u32 v244, v224, 3, 1
  v_lshl_add_u32 v106, v244, 2, v106
  v_mul_u32_u24 v106, 160, v106
  s_add_u32 m0, s56, 3072
  s_add_u32 s54, s56, 3072
  buffer_load_dwordx4 v225, s[32:35], s54 offen sc1 lds
  v_lshrrev_b32 v244, 4, v224
  v_lshl_add_u32 v106, v244, 3, v106
  v_add_u32 v106, s52, v106
  v_add_u32 v105, s52, v225
  s_mov_b32 s61, s60
  v_lshrrev_b32 v245, 4, v224
  v_lshl_add_u32 v245, v245, 3, s52
  ds_read_b64 v[80:81], v245 offset:3840
  ds_read_b64 v[82:83], v245 offset:3872
  s_add_u32 m0, s56, 4096
  s_add_u32 s54, s56, 4096
  buffer_load_dwordx4 v225, s[32:35], s54 offen sc1 lds
  ds_read_b64 v[84:85], v245 offset:3904
  ds_read_b64 v[86:87], v245 offset:3936
  ds_read_b64 v[88:89], v245 offset:3968
  s_waitcnt vmcnt(5)
  s_barrier
  s_cmp_lg_u32 s3, 0
  s_cbranch_scc1 L_adaL_nopush_88
  s_lshl_b32 s52, s57, 10
  s_lshl_b32 s53, s58, 2
  s_add_u32 s52, s52, s53
  v_lshlrev_b32 v248, 15, v224
  s_mov_b64 exec, 0xff
  v_mov_b32 v249, 1
  buffer_store_dword v249, v248, s[8:11], s52 offen offset:768 sc1
  s_mov_b64 exec, -1
L_adaL_nopush_88:
  s_add_u32 m0, s56, 5120
  s_add_u32 s54, s56, 5120
  buffer_load_dwordx4 v225, s[32:35], s54 offen sc1 lds
  s_add_u32 m0, s56, 6144
  s_add_u32 s54, s56, 6144
  buffer_load_dwordx4 v225, s[32:35], s54 offen sc1 lds
  s_add_u32 m0, s56, 7168
  s_add_u32 s54, s56, 7168
  buffer_load_dwordx4 v225, s[32:35], s54 offen sc1 lds
  s_add_u32 m0, s56, 8192
  s_add_u32 s54, s56, 8192
  buffer_load_dwordx4 v225, s[32:35], s54 offen sc1 lds
  s_add_u32 m0, s56, 9216
  s_add_u32 s54, s56, 9216
  buffer_load_dwordx4 v225, s[32:35], s54 offen sc1 lds
  s_add_u32 m0, s56, 10240
  s_add_u32 s54, s56, 10240
  buffer_load_dwordx4 v225, s[32:35], s54 offen sc1 lds
  s_add_u32 m0, s56, 11264
  s_add_u32 s54, s56, 11264
  buffer_load_dwordx4 v225, s[32:35], s54 offen sc1 lds
  s_add_u32 m0, s56, 12288
  s_add_u32 s54, s56, 12288
  buffer_load_dwordx4 v225, s[32:35], s54 offen sc1 lds
  s_add_u32 m0, s56, 13312
  s_add_u32 s54, s56, 13312
  buffer_load_dwordx4 v225, s[32:35], s54 offen sc1 lds
  s_add_u32 m0, s56, 14336
  s_add_u32 s54, s56, 14336
  buffer_load_dwordx4 v225, s[32:35], s54 offen sc1 lds
  s_add_u32 m0, s56, 15360
  s_add_u32 s54, s56, 15360
  buffer_load_dwordx4 v225, s[32:35], s54 offen sc1 lds
  s_add_u32 m0, s56, 16384
  s_add_u32 s54, s56, 16384
  buffer_load_dwordx4 v225, s[32:35], s54 offen sc1 lds
  s_add_u32 m0, s56, 17408
  s_add_u32 s54, s56, 17408
  buffer_load_dwordx4 v225, s[32:35], s54 offen sc1 lds
  s_add_u32 m0, s56, 18432
  s_add_u32 s54, s56, 18432
  buffer_load_dwordx4 v225, s[32:35], s54 offen sc1 lds
  s_add_u32 m0, s56, 19456
  s_add_u32 s54, s56, 19456
  buffer_load_dwordx4 v225, s[32:35], s54 offen sc1 lds
  s_add_u32 m0, s56, 20480
  s_add_u32 s54, s56, 20480
  buffer_load_dwordx4 v225, s[32:35], s54 offen sc1 lds
  s_mov_b32 s59, 400000
L_adaL_poll_89:
  buffer_load_dword v239, v238, s[8:11], s63 offen offset:768 sc1
  s_sub_u32 s59, s59, 1
  s_cbranch_scc1 L_adaL_polled_90
  s_waitcnt vmcnt(0)
  v_cmp_gt_u32 vcc, 1, v239
  s_cbranch_vccnz L_adaL_poll_89
L_adaL_polled_90:
  s_movk_i32 s60, 0
  buffer_load_dwordx4 a[216:219], v225, s[16:19], s60 offen offset:0 sc1
  buffer_load_dwordx4 a[48:51], v225, s[16:19], s60 offen offset:1024 sc1
  buffer_load_dwordx4 a[52:55], v225, s[16:19], s60 offen offset:2048 sc1
  buffer_load_dwordx4 a[24:27], v225, s[16:19], s60 offen offset:3072 sc1
  s_movk_i32 s60, 4096
  buffer_load_dwordx4 a[120:123], v225, s[16:19], s60 offen offset:0 sc1
  buffer_load_dwordx4 a[220:223], v225, s[16:19], s60 offen offset:1024 sc1
  buffer_load_dwordx4 a[228:231], v225, s[16:19], s60 offen offset:2048 sc1
  buffer_load_dwordx4 a[232:235], v225, s[16:19], s60 offen offset:3072 sc1
  s_movk_i32 s60, 8192
  buffer_load_dwordx4 a[128:131], v225, s[16:19], s60 offen offset:0 sc1
  buffer_load_dwordx4 a[244:247], v225, s[16:19], s60 offen offset:1024 sc1
  s_barrier
  ds_read_b128 v[32:35], v225 offset:0
  ds_read_b128 v[36:39], v225 offset:1024
  ds_read_b128 v[40:43], v225 offset:2048
  ds_read_b128 v[44:47], v225 offset:3072
  ds_read_b128 v[48:51], v225 offset:4096
  ds_read_b128 v[52:55], v225 offset:5120
  ds_read_b128 v[56:59], v225 offset:6144
  ds_read_b128 v[60:63], v225 offset:7168
  s_waitcnt lgkmcnt(6)
  s_waitcnt vmcnt(9)
  v_mfma_f32_16x16x32_bf16 v[0:3], v[32:35], a[216:219], 0
  ds_read_b128 v[64:67], v225 offset:8192
  v_mfma_f32_16x16x32_bf16 v[4:7], v[36:39], a[216:219], 0
  s_waitcnt lgkmcnt(5)
  ds_read_b128 v[68:71], v225 offset:9216
  v_mfma_f32_16x16x32_bf16 v[8:11], v[40:43], a[216:219], 0
  ds_read_b128 v[32:35], v225 offset:10240
  v_mfma_f32_16x16x32_bf16 v[12:15], v[44:47], a[216:219], 0
  s_waitcnt lgkmcnt(5)
  ds_read_b128 v[36:39], v225 offset:11264
  buffer_load_dwordx4 a[248:251], v225, s[16:19], s60 offen offset:2048 sc1
  v_mfma_f32_16x16x32_bf16 v[16:19], v[48:51], a[216:219], 0
  ds_read_b128 v[40:43], v225 offset:12288
  s_waitcnt vmcnt(9)
  v_mfma_f32_16x16x32_bf16 v[0:3], v[52:55], a[48:51], v[0:3]
  s_waitcnt lgkmcnt(5)
  ds_read_b128 v[44:47], v225 offset:13312
  v_mfma_f32_16x16x32_bf16 v[4:7], v[56:59], a[48:51], v[4:7]
  ds_read_b128 v[48:51], v225 offset:14336
  v_mfma_f32_16x16x32_bf16 v[8:11], v[60:63], a[48:51], v[8:11]
  s_waitcnt lgkmcnt(5)
  ds_read_b128 v[52:55], v225 offset:15360
  buffer_load_dwordx4 a[108:111], v225, s[16:19], s60 offen offset:3072 sc1
  v_mfma_f32_16x16x32_bf16 v[12:15], v[64:67], a[48:51], v[12:15]
  ds_read_b128 v[56:59], v225 offset:16384
  v_mfma_f32_16x16x32_bf16 v[16:19], v[68:71], a[48:51], v[16:19]
  s_waitcnt lgkmcnt(5)
  ds_read_b128 v[60:63], v225 offset:17408
  s_waitcnt vmcnt(9)
  v_mfma_f32_16x16x32_bf16 v[0:3], v[32:35], a[52:55], v[0:3]
  ds_read_b128 v[64:67], v225 offset:18432
  v_mfma_f32_16x16x32_bf16 v[4:7], v[36:39], a[52:55], v[4:7]
  s_waitcnt lgkmcnt(5)
  ds_read_b128 v[68:71], v225 offset:19456
  s_movk_i32 s60, 12288
  buffer_load_dwordx4 a[88:91], v225, s[16:19], s60 offen offset:0 sc1
  v_mfma_f32_16x16x32_bf16 v[8:11], v[40:43], a[52:55], v[8:11]
  ds_read_b128 v[32:35], v225 offset:20480
  v_mfma_f32_16x16x32_bf16 v[12:15], v[44:47], a[52:55], v[12:15]
  s_waitcnt lgkmcnt(5)
  ds_read_b128 v[36:39], v225 offset:21504
  v_mfma_f32_16x16x32_bf16 v[16:19], v[48:51], a[52:55], v[16:19]
  ds_read_b128 v[40:43], v225 offset:22528
  s_waitcnt vmcnt(9)
  v_mfma_f32_16x16x32_bf16 v[0:3], v[52:55], a[24:27], v[0:3]
  s_waitcnt lgkmcnt(5)
  ds_read_b128 v[44:47], v225 offset:23552
  buffer_load_dwordx4 a[136:139], v225, s[16:19], s60 offen offset:1024 sc1
  v_mfma_f32_16x16x32_bf16 v[4:7], v[56:59], a[24:27], v[4:7]
  ds_read_b128 v[48:51], v225 offset:24576
  v_mfma_f32_16x16x32_bf16 v[8:11], v[60:63], a[24:27], v[8:11]
  s_waitcnt lgkmcnt(5)
  ds_read_b128 v[52:55], v225 offset:25600
  v_mfma_f32_16x16x32_bf16 v[12:15], v[64:67], a[24:27], v[12:15]
  ds_read_b128 v[56:59], v225 offset:26624
  v_mfma_f32_16x16x32_bf16 v[16:19], v[68:71], a[24:27], v[16:19]
  s_waitcnt lgkmcnt(5)
  ds_read_b128 v[60:63], v225 offset:27648
  buffer_load_dwordx4 a[156:159], v225, s[16:19], s60 offen offset:2048 sc1
  s_waitcnt vmcnt(10)
  v_mfma_f32_16x16x32_bf16 v[0:3], v[32:35], a[120:123], v[0:3]
  ds_read_b128 v[64:67], v225 offset:28672
  v_mfma_f32_16x16x32_bf16 v[4:7], v[36:39], a[120:123], v[4:7]
  s_waitcnt lgkmcnt(5)
  ds_read_b128 v[68:71], v225 offset:29696
  v_mfma_f32_16x16x32_bf16 v[8:11], v[40:43], a[120:123], v[8:11]
  ds_read_b128 v[32:35], v225 offset:30720
  v_mfma_f32_16x16x32_bf16 v[12:15], v[44:47], a[120:123], v[12:15]
  s_waitcnt lgkmcnt(5)
  ds_read_b128 v[36:39], v225 offset:31744
  buffer_load_dwordx4 a[176:179], v225, s[16:19], s60 offen offset:3072 sc1
  v_mfma_f32_16x16x32_bf16 v[16:19], v[48:51], a[120:123], v[16:19]
  ds_read_b128 v[40:43], v225 offset:32768
  s_waitcnt vmcnt(10)
  v_mfma_f32_16x16x32_bf16 v[0:3], v[52:55], a[220:223], v[0:3]
  s_waitcnt lgkmcnt(5)
  ds_read_b128 v[44:47], v225 offset:33792
  v_mfma_f32_16x16x32_bf16 v[4:7], v[56:59], a[220:223], v[4:7]
  ds_read_b128 v[48:51], v225 offset:34816
  v_mfma_f32_16x16x32_bf16 v[8:11], v[60:63], a[220:223], v[8:11]
  s_waitcnt lgkmcnt(5)
  ds_read_b128 v[52:55], v225 offset:35840
  s_movk_i32 s60, 16384
  buffer_load_dwordx4 a[192:195], v225, s[16:19], s60 offen offset:0 sc1
  v_mfma_f32_16x16x32_bf16 v[12:15], v[64:67], a[220:223], v[12:15]
  ds_read_b128 v[56:59], v225 offset:36864
  v_mfma_f32_16x16x32_bf16 v[16:19], v[68:71], a[220:223], v[16:19]
  s_waitcnt lgkmcnt(5)
  ds_read_b128 v[60:63], v225 offset:37888
  s_waitcnt vmcnt(10)
  v_mfma_f32_16x16x32_bf16 v[0:3], v[32:35], a[228:231], v[0:3]
  ds_read_b128 v[64:67], v225 offset:38912
  v_mfma_f32_16x16x32_bf16 v[4:7], v[36:39], a[228:231], v[4:7]
  s_waitcnt lgkmcnt(5)
  ds_read_b128 v[68:71], v225 offset:39936
  buffer_load_dwordx4 a[196:199], v225, s[16:19], s60 offen offset:1024 sc1
  v_mfma_f32_16x16x32_bf16 v[8:11], v[40:43], a[228:231], v[8:11]
  ds_read_b128 v[32:35], v225 offset:40960
  v_mfma_f32_16x16x32_bf16 v[12:15], v[44:47], a[228:231], v[12:15]
  s_waitcnt lgkmcnt(5)
  ds_read_b128 v[36:39], v225 offset:41984
  v_mfma_f32_16x16x32_bf16 v[16:19], v[48:51], a[228:231], v[16:19]
  ds_read_b128 v[40:43], v225 offset:43008
  s_waitcnt vmcnt(10)
  v_mfma_f32_16x16x32_bf16 v[0:3], v[52:55], a[232:235], v[0:3]
  s_waitcnt lgkmcnt(5)
  ds_read_b128 v[44:47], v225 offset:44032
  buffer_load_dwordx4 a[240:243], v225, s[16:19], s60 offen offset:2048 sc1
  v_mfma_f32_16x16x32_bf16 v[4:7], v[56:59], a[232:235], v[4:7]
  ds_read_b128 v[48:51], v225 offset:45056
  v_mfma_f32_16x16x32_bf16 v[8:11], v[60:63], a[232:235], v[8:11]
  s_waitcnt lgkmcnt(5)
  ds_read_b128 v[52:55], v225 offset:46080
  v_mfma_f32_16x16x32_bf16 v[12:15], v[64:67], a[232:235], v[12:15]
  ds_read_b128 v[56:59], v225 offset:47104
  v_mfma_f32_16x16x32_bf16 v[16:19], v[68:71], a[232:235], v[16:19]
  s_waitcnt lgkmcnt(5)
  ds_read_b128 v[60:63], v225 offset:48128
  buffer_load_dwordx4 a[252:255], v225, s[16:19], s60 offen offset:3072 sc1
  s_waitcnt vmcnt(11)
  v_mfma_f32_16x16x32_bf16 v[0:3], v[32:35], a[128:131], v[0:3]
  ds_read_b128 v[64:67], v225 offset:49152
  v_mfma_f32_16x16x32_bf16 v[4:7], v[36:39], a[128:131], v[4:7]
  s_waitcnt lgkmcnt(5)
  ds_read_b128 v[68:71], v225 offset:50176
  v_mfma_f32_16x16x32_bf16 v[8:11], v[40:43], a[128:131], v[8:11]
  ds_read_b128 v[32:35], v225 offset:51200
  v_mfma_f32_16x16x32_bf16 v[12:15], v[44:47], a[128:131], v[12:15]
  s_waitcnt lgkmcnt(5)
  ds_read_b128 v[36:39], v225 offset:52224
  s_movk_i32 s60, 20480
  buffer_load_dwordx4 a[236:239], v225, s[16:19], s60 offen offset:0 sc1
  v_mfma_f32_16x16x32_bf16 v[16:19], v[48:51], a[128:131], v[16:19]
  ds_read_b128 v[40:43], v225 offset:53248
  s_waitcnt vmcnt(11)
  v_mfma_f32_16x16x32_bf16 v[0:3], v[52:55], a[244:247], v[0:3]
  s_waitcnt lgkmcnt(5)
  ds_read_b128 v[44:47], v225 offset:54272
  v_mfma_f32_16x16x32_bf16 v[4:7], v[56:59], a[244:247], v[4:7]
  ds_read_b128 v[48:51], v225 offset:55296
  v_mfma_f32_16x16x32_bf16 v[8:11], v[60:63], a[244:247], v[8:11]
  s_waitcnt lgkmcnt(5)
  ds_read_b128 v[52:55], v225 offset:56320
  buffer_load_dwordx4 a[124:127], v225, s[16:19], s60 offen offset:1024 sc1
  v_mfma_f32_16x16x32_bf16 v[12:15], v[64:67], a[244:247], v[12:15]
  ds_read_b128 v[56:59], v225 offset:57344
  v_mfma_f32_16x16x32_bf16 v[16:19], v[68:71], a[244:247], v[16:19]
  s_waitcnt lgkmcnt(5)
  ds_read_b128 v[60:63], v225 offset:58368
  s_waitcnt vmcnt(11)
  v_mfma_f32_16x16x32_bf16 v[0:3], v[32:35], a[248:251], v[0:3]
  ds_read_b128 v[64:67], v225 offset:59392
  v_mfma_f32_16x16x32_bf16 v[4:7], v[36:39], a[248:251], v[4:7]
  s_waitcnt lgkmcnt(5)
  ds_read_b128 v[68:71], v225 offset:60416
  buffer_load_dwordx4 a[12:15], v225, s[16:19], s60 offen offset:2048 sc1
  v_mfma_f32_16x16x32_bf16 v[8:11], v[40:43], a[248:251], v[8:11]
  ds_read_b128 v[32:35], v225 offset:61440
  v_mfma_f32_16x16x32_bf16 v[12:15], v[44:47], a[248:251], v[12:15]
  s_waitcnt lgkmcnt(5)
  ds_read_b128 v[36:39], v225 offset:62464
  v_mfma_f32_16x16x32_bf16 v[16:19], v[48:51], a[248:251], v[16:19]
  ds_read_b128 v[40:43], v225 offset:63488
  s_waitcnt vmcnt(11)
  v_mfma_f32_16x16x32_bf16 v[0:3], v[52:55], a[108:111], v[0:3]
  s_waitcnt lgkmcnt(5)
  ds_read_b128 v[44:47], v225 offset:64512
  buffer_load_dwordx4 a[68:71], v225, s[16:19], s60 offen offset:3072 sc1
  v_mfma_f32_16x16x32_bf16 v[4:7], v[56:59], a[108:111], v[4:7]
  ds_read_b128 v[48:51], v241 offset:0
  v_mfma_f32_16x16x32_bf16 v[8:11], v[60:63], a[108:111], v[8:11]
  s_waitcnt lgkmcnt(5)
  ds_read_b128 v[52:55], v241 offset:1024
  v_mfma_f32_16x16x32_bf16 v[12:15], v[64:67], a[108:111], v[12:15]
  ds_read_b128 v[56:59], v241 offset:2048
  v_mfma_f32_16x16x32_bf16 v[16:19], v[68:71], a[108:111], v[16:19]
  s_waitcnt lgkmcnt(5)
  ds_read_b128 v[60:63], v241 offset:3072
  s_movk_i32 s60, 24576
  buffer_load_dwordx4 a[140:143], v225, s[16:19], s60 offen offset:0 sc1
  s_waitcnt vmcnt(12)
  v_mfma_f32_16x16x32_bf16 v[0:3], v[32:35], a[88:91], v[0:3]
  ds_read_b128 v[64:67], v241 offset:4096
  v_mfma_f32_16x16x32_bf16 v[4:7], v[36:39], a[88:91], v[4:7]
  s_waitcnt lgkmcnt(5)
  ds_read_b128 v[68:71], v241 offset:5120
  v_mfma_f32_16x16x32_bf16 v[8:11], v[40:43], a[88:91], v[8:11]
  ds_read_b128 v[32:35], v241 offset:6144
  v_mfma_f32_16x16x32_bf16 v[12:15], v[44:47], a[88:91], v[12:15]
  s_waitcnt lgkmcnt(5)
  ds_read_b128 v[36:39], v241 offset:7168
  buffer_load_dwordx4 a[160:163], v225, s[16:19], s60 offen offset:1024 sc1
  v_mfma_f32_16x16x32_bf16 v[16:19], v[48:51], a[88:91], v[16:19]
  ds_read_b128 v[40:43], v241 offset:8192
  s_waitcnt vmcnt(12)
  v_mfma_f32_16x16x32_bf16 v[0:3], v[52:55], a[136:139], v[0:3]
  s_waitcnt lgkmcnt(5)
  ds_read_b128 v[44:47], v241 offset:9216
  v_mfma_f32_16x16x32_bf16 v[4:7], v[56:59], a[136:139], v[4:7]
  ds_read_b128 v[48:51], v241 offset:10240
  v_mfma_f32_16x16x32_bf16 v[8:11], v[60:63], a[136:139], v[8:11]
  s_waitcnt lgkmcnt(5)
  ds_read_b128 v[52:55], v241 offset:11264
  buffer_load_dwordx4 a[180:183], v225, s[16:19], s60 offen offset:2048 sc1
  v_mfma_f32_16x16x32_bf16 v[12:15], v[64:67], a[136:139], v[12:15]
  ds_read_b128 v[56:59], v241 offset:12288
  v_mfma_f32_16x16x32_bf16 v[16:19], v[68:71], a[136:139], v[16:19]
  s_waitcnt lgkmcnt(5)
  ds_read_b128 v[60:63], v241 offset:13312
  s_waitcnt vmcnt(12)
  v_mfma_f32_16x16x32_bf16 v[0:3], v[32:35], a[156:159], v[0:3]
  ds_read_b128 v[64:67], v241 offset:14336
  v_mfma_f32_16x16x32_bf16 v[4:7], v[36:39], a[156:159], v[4:7]
  s_waitcnt lgkmcnt(5)
  ds_read_b128 v[68:71], v241 offset:15360
  buffer_load_dwordx4 a[40:43], v225, s[16:19], s60 offen offset:3072 sc1
  v_mfma_f32_16x16x32_bf16 v[8:11], v[40:43], a[156:159], v[8:11]
  ds_read_b128 v[32:35], v241 offset:16384
  v_mfma_f32_16x16x32_bf16 v[12:15], v[44:47], a[156:159], v[12:15]
  s_waitcnt lgkmcnt(5)
  ds_read_b128 v[36:39], v241 offset:17408
  v_mfma_f32_16x16x32_bf16 v[16:19], v[48:51], a[156:159], v[16:19]
  ds_read_b128 v[40:43], v241 offset:18432
  s_waitcnt vmcnt(12)
  v_mfma_f32_16x16x32_bf16 v[0:3], v[52:55], a[176:179], v[0:3]
  s_waitcnt lgkmcnt(5)
  ds_read_b128 v[44:47], v241 offset:19456
  v_mfma_f32_16x16x32_bf16 v[4:7], v[56:59], a[176:179], v[4:7]
  ds_read_b128 v[48:51], v241 offset:20480
  v_mfma_f32_16x16x32_bf16 v[8:11], v[60:63], a[176:179], v[8:11]
  s_waitcnt lgkmcnt(5)
  ds_read_b128 v[52:55], v241 offset:21504
  v_mfma_f32_16x16x32_bf16 v[12:15], v[64:67], a[176:179], v[12:15]
  ds_read_b128 v[56:59], v241 offset:22528
  v_mfma_f32_16x16x32_bf16 v[16:19], v[68:71], a[176:179], v[16:19]
  s_waitcnt lgkmcnt(5)
  ds_read_b128 v[60:63], v241 offset:23552
  s_waitcnt vmcnt(11)
  v_mfma_f32_16x16x32_bf16 v[0:3], v[32:35], a[192:195], v[0:3]
  ds_read_b128 v[64:67], v241 offset:24576
  v_mfma_f32_16x16x32_bf16 v[4:7], v[36:39], a[192:195], v[4:7]
  s_waitcnt lgkmcnt(5)
  ds_read_b128 v[68:71], v241 offset:25600
  v_mfma_f32_16x16x32_bf16 v[8:11], v[40:43], a[192:195], v[8:11]
  ds_read_b128 v[32:35], v241 offset:26624
  v_mfma_f32_16x16x32_bf16 v[12:15], v[44:47], a[192:195], v[12:15]
  s_waitcnt lgkmcnt(5)
  ds_read_b128 v[36:39], v241 offset:27648
  v_mfma_f32_16x16x32_bf16 v[16:19], v[48:51], a[192:195], v[16:19]
  ds_read_b128 v[40:43], v241 offset:28672
  s_waitcnt vmcnt(10)
  v_mfma_f32_16x16x32_bf16 v[0:3], v[52:55], a[196:199], v[0:3]
  s_waitcnt lgkmcnt(5)
  ds_read_b128 v[44:47], v241 offset:29696
  v_mfma_f32_16x16x32_bf16 v[4:7], v[56:59], a[196:199], v[4:7]
  ds_read_b128 v[48:51], v241 offset:30720
  v_mfma_f32_16x16x32_bf16 v[8:11], v[60:63], a[196:199], v[8:11]
  s_waitcnt lgkmcnt(5)
  ds_read_b128 v[52:55], v241 offset:31744
  v_mfma_f32_16x16x32_bf16 v[12:15], v[64:67], a[196:199], v[12:15]
  ds_read_b128 v[56:59], v241 offset:32768
  v_mfma_f32_16x16x32_bf16 v[16:19], v[68:71], a[196:199], v[16:19]
  s_waitcnt lgkmcnt(5)
  ds_read_b128 v[60:63], v241 offset:33792
  s_waitcnt vmcnt(9)
  v_mfma_f32_16x16x32_bf16 v[0:3], v[32:35], a[240:243], v[0:3]
  ds_read_b128 v[64:67], v241 offset:34816
  v_mfma_f32_16x16x32_bf16 v[4:7], v[36:39], a[240:243], v[4:7]
  s_waitcnt lgkmcnt(5)
  ds_read_b128 v[68:71], v241 offset:35840
  v_mfma_f32_16x16x32_bf16 v[8:11], v[40:43], a[240:243], v[8:11]
  ds_read_b128 v[32:35], v241 offset:36864
  v_mfma_f32_16x16x32_bf16 v[12:15], v[44:47], a[240:243], v[12:15]
  s_waitcnt lgkmcnt(5)
  ds_read_b128 v[36:39], v241 offset:37888
  v_mfma_f32_16x16x32_bf16 v[16:19], v[48:51], a[240:243], v[16:19]
  ds_read_b128 v[40:43], v241 offset:38912
  s_waitcnt vmcnt(8)
  v_mfma_f32_16x16x32_bf16 v[0:3], v[52:55], a[252:255], v[0:3]
  s_waitcnt lgkmcnt(5)
  ds_read_b128 v[44:47], v241 offset:39936
  v_mfma_f32_16x16x32_bf16 v[4:7], v[56:59], a[252:255], v[4:7]
  ds_read_b128 v[48:51], v241 offset:40960
  v_mfma_f32_16x16x32_bf16 v[8:11], v[60:63], a[252:255], v[8:11]
  s_waitcnt lgkmcnt(5)
  ds_read_b128 v[52:55], v241 offset:41984
  v_mfma_f32_16x16x32_bf16 v[12:15], v[64:67], a[252:255], v[12:15]
  ds_read_b128 v[56:59], v241 offset:43008
  v_mfma_f32_16x16x32_bf16 v[16:19], v[68:71], a[252:255], v[16:19]
  s_waitcnt lgkmcnt(5)
  ds_read_b128 v[60:63], v241 offset:44032
  s_waitcnt vmcnt(7)
  v_mfma_f32_16x16x32_bf16 v[0:3], v[32:35], a[236:239], v[0:3]
  ds_read_b128 v[64:67], v241 offset:45056
  v_mfma_f32_16x16x32_bf16 v[4:7], v[36:39], a[236:239], v[4:7]
  s_waitcnt lgkmcnt(5)
  ds_read_b128 v[68:71], v241 offset:46080
  v_mfma_f32_16x16x32_bf16 v[8:11], v[40:43], a[236:239], v[8:11]
  ds_read_b128 v[32:35], v241 offset:47104
  v_mfma_f32_16x16x32_bf16 v[12:15], v[44:47], a[236:239], v[12:15]
  s_waitcnt lgkmcnt(5)
  ds_read_b128 v[36:39], v241 offset:48128
  v_mfma_f32_16x16x32_bf16 v[16:19], v[48:51], a[236:239], v[16:19]
  ds_read_b128 v[40:43], v241 offset:49152
  s_waitcnt vmcnt(6)
  v_mfma_f32_16x16x32_bf16 v[0:3], v[52:55], a[124:127], v[0:3]
  s_waitcnt lgkmcnt(5)
  ds_read_b128 v[44:47], v241 offset:50176
  v_mfma_f32_16x16x32_bf16 v[4:7], v[56:59], a[124:127], v[4:7]
  ds_read_b128 v[48:51], v241 offset:51200
  v_mfma_f32_16x16x32_bf16 v[8:11], v[60:63], a[124:127], v[8:11]
  s_waitcnt lgkmcnt(5)
  ds_read_b128 v[52:55], v241 offset:52224
  v_mfma_f32_16x16x32_bf16 v[12:15], v[64:67], a[124:127], v[12:15]
  ds_read_b128 v[56:59], v241 offset:53248
  v_mfma_f32_16x16x32_bf16 v[16:19], v[68:71], a[124:127], v[16:19]
  s_waitcnt lgkmcnt(5)
  ds_read_b128 v[60:63], v241 offset:54272
  s_waitcnt vmcnt(5)
  v_mfma_f32_16x16x32_bf16 v[0:3], v[32:35], a[12:15], v[0:3]
  ds_read_b128 v[64:67], v241 offset:55296
  v_mfma_f32_16x16x32_bf16 v[4:7], v[36:39], a[12:15], v[4:7]
  s_waitcnt lgkmcnt(5)
  ds_read_b128 v[68:71], v241 offset:56320
  v_mfma_f32_16x16x32_bf16 v[8:11], v[40:43], a[12:15], v[8:11]
  ds_read_b128 v[32:35], v241 offset:57344
  v_mfma_f32_16x16x32_bf16 v[12:15], v[44:47], a[12:15], v[12:15]
  s_waitcnt lgkmcnt(5)
  ds_read_b128 v[36:39], v241 offset:58368
  v_mfma_f32_16x16x32_bf16 v[16:19], v[48:51], a[12:15], v[16:19]
  ds_read_b128 v[40:43], v241 offset:59392
  s_waitcnt vmcnt(4)
  v_mfma_f32_16x16x32_bf16 v[0:3], v[52:55], a[68:71], v[0:3]
  s_waitcnt lgkmcnt(5)
  ds_read_b128 v[44:47], v241 offset:60416
  v_mfma_f32_16x16x32_bf16 v[4:7], v[56:59], a[68:71], v[4:7]
  ds_read_b128 v[48:51], v241 offset:61440
  v_mfma_f32_16x16x32_bf16 v[8:11], v[60:63], a[68:71], v[8:11]
  s_waitcnt lgkmcnt(5)
  ds_read_b128 v[52:55], v241 offset:62464
  v_mfma_f32_16x16x32_bf16 v[12:15], v[64:67], a[68:71], v[12:15]
  ds_read_b128 v[56:59], v241 offset:63488
  v_mfma_f32_16x16x32_bf16 v[16:19], v[68:71], a[68:71], v[16:19]
  s_waitcnt lgkmcnt(5)
  ds_read_b128 v[60:63], v241 offset:64512
  s_waitcnt vmcnt(3)
  v_mfma_f32_16x16x32_bf16 v[0:3], v[32:35], a[140:143], v[0:3]
  ds_read_b128 v[64:67], v242 offset:0
  v_mfma_f32_16x16x32_bf16 v[4:7], v[36:39], a[140:143], v[4:7]
  s_waitcnt lgkmcnt(5)
  ds_read_b128 v[68:71], v242 offset:1024
  v_mfma_f32_16x16x32_bf16 v[8:11], v[40:43], a[140:143], v[8:11]
  ds_read_b128 v[32:35], v242 offset:2048
  v_mfma_f32_16x16x32_bf16 v[12:15], v[44:47], a[140:143], v[12:15]
  s_waitcnt lgkmcnt(5)
  ds_read_b128 v[36:39], v242 offset:3072
  v_mfma_f32_16x16x32_bf16 v[16:19], v[48:51], a[140:143], v[16:19]
  ds_read_b128 v[40:43], v242 offset:4096
  s_waitcnt vmcnt(2)
  v_mfma_f32_16x16x32_bf16 v[0:3], v[52:55], a[160:163], v[0:3]
  s_waitcnt lgkmcnt(5)
  ds_read_b128 v[44:47], v242 offset:5120
  v_mfma_f32_16x16x32_bf16 v[4:7], v[56:59], a[160:163], v[4:7]
  ds_read_b128 v[48:51], v242 offset:6144
  v_mfma_f32_16x16x32_bf16 v[8:11], v[60:63], a[160:163], v[8:11]
  s_waitcnt lgkmcnt(5)
  ds_read_b128 v[52:55], v242 offset:7168
  v_mfma_f32_16x16x32_bf16 v[12:15], v[64:67], a[160:163], v[12:15]
  ds_read_b128 v[56:59], v242 offset:8192
  v_mfma_f32_16x16x32_bf16 v[16:19], v[68:71], a[160:163], v[16:19]
  s_waitcnt lgkmcnt(5)
  ds_read_b128 v[60:63], v242 offset:9216
  s_waitcnt vmcnt(1)
  v_mfma_f32_16x16x32_bf16 v[0:3], v[32:35], a[180:183], v[0:3]
  ds_read_b128 v[64:67], v242 offset:10240
  v_mfma_f32_16x16x32_bf16 v[4:7], v[36:39], a[180:183], v[4:7]
  s_waitcnt lgkmcnt(5)
  ds_read_b128 v[68:71], v242 offset:11264
  v_mfma_f32_16x16x32_bf16 v[8:11], v[40:43], a[180:183], v[8:11]
  v_mfma_f32_16x16x32_bf16 v[12:15], v[44:47], a[180:183], v[12:15]
  s_waitcnt lgkmcnt(4)
  v_mfma_f32_16x16x32_bf16 v[16:19], v[48:51], a[180:183], v[16:19]
  s_waitcnt vmcnt(0)
  v_mfma_f32_16x16x32_bf16 v[0:3], v[52:55], a[40:43], v[0:3]
  s_waitcnt lgkmcnt(2)
  v_mfma_f32_16x16x32_bf16 v[4:7], v[56:59], a[40:43], v[4:7]
  v_mfma_f32_16x16x32_bf16 v[8:11], v[60:63], a[40:43], v[8:11]
  s_waitcnt lgkmcnt(0)
  v_mfma_f32_16x16x32_bf16 v[12:15], v[64:67], a[40:43], v[12:15]
  v_mfma_f32_16x16x32_bf16 v[16:19], v[68:71], a[40:43], v[16:19]
  v_lshlrev_b32 v244, 16, v228
  v_and_b32 v245, 0xffff0000, v228
  v_lshlrev_b32 v246, 16, v80
  v_and_b32 v247, 0xffff0000, v80
  v_pk_fma_f32 v[0:1], v[0:1], v[246:247], v[244:245]
  v_cvt_pk_bf16_f32 v20, v0, v1
  v_lshlrev_b32 v244, 16, v229
  v_and_b32 v245, 0xffff0000, v229
  v_lshlrev_b32 v246, 16, v81
  v_and_b32 v247, 0xffff0000, v81
  v_pk_fma_f32 v[2:3], v[2:3], v[246:247], v[244:245]
  v_cvt_pk_bf16_f32 v21, v2, v3
  ds_write_b64 v106, v[20:21] offset:0
  v_lshlrev_b32 v244, 16, v230
  v_and_b32 v245, 0xffff0000, v230
  v_lshlrev_b32 v246, 16, v82
  v_and_b32 v247, 0xffff0000, v82
  v_pk_fma_f32 v[4:5], v[4:5], v[246:247], v[244:245]
  v_cvt_pk_bf16_f32 v22, v4, v5
  v_lshlrev_b32 v244, 16, v231
  v_and_b32 v245, 0xffff0000, v231
  v_lshlrev_b32 v246, 16, v83
  v_and_b32 v247, 0xffff0000, v83
  v_pk_fma_f32 v[6:7], v[6:7], v[246:247], v[244:245]
  v_cvt_pk_bf16_f32 v23, v6, v7
  ds_write_b64 v106, v[22:23] offset:32
  v_lshlrev_b32 v244, 16, v232
  v_and_b32 v245, 0xffff0000, v232
  v_lshlrev_b32 v246, 16, v84
  v_and_b32 v247, 0xffff0000, v84
  v_pk_fma_f32 v[8:9], v[8:9], v[246:247], v[244:245]
  v_cvt_pk_bf16_f32 v24, v8, v9
  v_lshlrev_b32 v244, 16, v233
  v_and_b32 v245, 0xffff0000, v233
  v_lshlrev_b32 v246, 16, v85
  v_and_b32 v247, 0xffff0000, v85
  v_pk_fma_f32 v[10:11], v[10:11], v[246:247], v[244:245]
  v_cvt_pk_bf16_f32 v25, v10, v11
  ds_write_b64 v106, v[24:25] offset:64
  v_lshlrev_b32 v244, 16, v234
  v_and_b32 v245, 0xffff0000, v234
  v_lshlrev_b32 v246, 16, v86
  v_and_b32 v247, 0xffff0000, v86
  v_pk_fma_f32 v[12:13], v[12:13], v[246:247], v[244:245]
  v_cvt_pk_bf16_f32 v26, v12, v13
  v_lshlrev_b32 v244, 16, v235
  v_and_b32 v245, 0xffff0000, v235
  v_lshlrev_b32 v246, 16, v87
  v_and_b32 v247, 0xffff0000, v87
  v_pk_fma_f32 v[14:15], v[14:15], v[246:247], v[244:245]
  v_cvt_pk_bf16_f32 v27, v14, v15
  ds_write_b64 v106, v[26:27] offset:96
  v_lshlrev_b32 v244, 16, v236
  v_and_b32 v245, 0xffff0000, v236
  v_lshlrev_b32 v246, 16, v88
  v_and_b32 v247, 0xffff0000, v88
  v_pk_fma_f32 v[16:17], v[16:17], v[246:247], v[244:245]
  v_cvt_pk_bf16_f32 v28, v16, v17
  v_lshlrev_b32 v244, 16, v237
  v_and_b32 v245, 0xffff0000, v237
  v_lshlrev_b32 v246, 16, v89
  v_and_b32 v247, 0xffff0000, v89
  v_pk_fma_f32 v[18:19], v[18:19], v[246:247], v[244:245]
  v_cvt_pk_bf16_f32 v29, v18, v19
  ds_write_b64 v106, v[28:29] offset:128
  ds_read_b128 v[32:35], v105 offset:0
  ds_read_b128 v[36:39], v105 offset:1024
  ds_read_b128 v[40:43], v105 offset:2048
  s_waitcnt lgkmcnt(2)
  buffer_store_dwordx4 v[32:35], v107, s[36:39], s61 offen
  s_waitcnt lgkmcnt(1)
  buffer_store_dwordx4 v[36:39], v108, s[36:39], s61 offen
  s_waitcnt lgkmcnt(0)
  buffer_store_dwordx4 v[40:43], v109, s[36:39], s61 offen
L_adaL_end:
  s_endpgm
L_adaL_spin_6:
  s_mov_b32 s59, 400000
L_adaL_again_8:
  buffer_load_dword v187, v186, s[36:39], 0 offen sc1
  s_sub_u32 s59, s59, 1
  s_cbranch_scc1 L_adaL_spun_7
  s_waitcnt vmcnt(0)
  v_cmp_gt_u32 vcc, 40, v187
  s_cbranch_vccnz L_adaL_again_8
  s_branch L_adaL_spun_7
L_adaL_spin_10:
  s_mov_b32 s51, 400000
L_adaL_again_12:
  buffer_load_dword v247, v246, s[8:11], 0 offen offset:512 sc1
  s_sub_u32 s51, s51, 1
  s_cbranch_scc1 L_adaL_spun_11
  s_waitcnt vmcnt(0)
  v_cmp_eq_u32 vcc, 0, v247
  s_cbranch_vccnz L_adaL_again_12
  s_branch L_adaL_spun_11
L_adaL_spin_14:
  s_mov_b32 s51, 400000
L_adaL_again_16:
  buffer_load_dword v247, v246, s[8:11], 0 offen offset:384 sc1
  s_sub_u32 s51, s51, 1
  s_cbranch_scc1 L_adaL_spun_15
  s_waitcnt vmcnt(0)
  v_cmp_eq_u32 vcc, 0, v247
  s_cbranch_vccnz L_adaL_again_16
  s_branch L_adaL_spun_15
L_adaL_ptr_19:
  v_mov_b32 v248, 0
  s_cmp_lg_u32 s101, 0
  s_cbranch_scc1 L_adaL_pt_91
  s_sub_u32 s45, s2, 64
  s_cmp_ge_u32 s45, 40
  s_cbranch_scc1 L_adaL_nofin_96
  s_cmp_lg_u32 s3, 3
  s_cbranch_scc1 L_adaL_nofin_96
  s_lshl_b32 s44, s45, 7
  s_add_u32 s44, s44, 35328
  v_accvgpr_read_b32 v248, a224
  v_accvgpr_read_b32 v249, a225
  v_accvgpr_read_b32 v250, a226
  v_accvgpr_read_b32 v251, a227
  s_sub_u32 s45, s45, 20
  s_cmp_lt_u32 s45, 10
  s_cselect_b32 s45, 1.0, 0
  v_add_f32 v248, v248, v249
  v_add_f32 v250, v250, v251
  v_add_f32 v248, v248, v250
  v_cvt_pk_bf16_f32 v248, v248, v248
  v_lshlrev_b32 v248, 16, v248
  v_add_f32 v248, s45, v248
  v_cvt_pk_bf16_f32 v248, v248, v248
  v_lshl_add_u32 v249, v224, 1, s44
  global_store_short v249, v248, s[4:5] sc1
L_adaL_nofin_96:
  s_mov_b32 s12, s66
  s_mov_b32 s13, s67
  s_mov_b32 s39, s68
  s_mov_b32 s36, s69
  s_mov_b32 s37, s70
  s_mov_b32 s16, s71
  s_mov_b32 s17, s72
  s_mov_b32 s18, s73
  s_movk_i32 s38, -1024
  v_mov_b32 v252, v253
  s_lshl_b32 s58, s7, 2
  s_sub_u32 s58, 40, s58
  s_max_i32 s58, s58, 22
  s_branch L_adaL_pt_95
L_adaL_pt_91:
  s_cmp_lg_u32 s101, 1
  s_cbranch_scc1 L_adaL_pt_92
  s_lshl_b32 s58, s7, 2
  s_sub_u32 s58, 52, s58
  s_max_i32 s58, s58, 28
  s_cmp_lg_u32 s3, 0
  s_cbranch_scc1 L_adaL_pt_95
  v_mov_b32 v249, 1
  s_mov_b64 exec, 1
  global_atomic_add v248, v249, s[64:65] offset:64 sc1
  s_mov_b64 exec, -1
  s_branch L_adaL_pt_95
L_adaL_pt_92:
  s_movk_i32 s58, 1000
  global_load_dword v239, v248, s[64:65] offset:64 sc1
  s_cmp_lg_u32 s3, 0
  s_cbranch_scc1 L_adaL_pt_95
  v_mov_b32 v249, 1
  s_mov_b64 exec, 1
  global_atomic_add v248, v249, s[64:65] offset:192 sc1
  s_mov_b64 exec, -1
L_adaL_pt_95:
  s_add_u32 s101, s101, 1
  s_setpc_b64 s[42:43]
L_adaL_g7_37:
  s_waitcnt vmcnt(8)
  v_cmp_gt_u32 vcc, 0x100, v239
  s_cbranch_vccz L_adaL_ptok_97
  s_mov_b32 s44, 400000
  v_mov_b32 v241, 0
L_adaL_ptagain_98:
  global_load_dword v239, v241, s[64:65] offset:64 sc1
  s_sub_u32 s44, s44, 1
  s_cbranch_scc1 L_adaL_ptok_97
  s_waitcnt vmcnt(0)
  v_cmp_gt_u32 vcc, 0x100, v239
  s_cbranch_vccnz L_adaL_ptagain_98
L_adaL_ptok_97:
  v_mfma_f32_16x16x32_bf16 v[0:3], a[128:131], v[160:163], v[64:67]
  s_waitcnt lgkmcnt(2)
  ds_read_b128 a[152:155], v228 offset:6144
  v_add_u32 v229, 16384, v228
  v_mfma_f32_16x16x32_bf16 v[0:3], a[132:135], v[164:167], v[0:3]
  v_exp_f32 v192, v52
  v_mfma_f32_16x16x32_bf16 v[0:3], a[136:139], v[168:171], v[0:3]
  ds_read_b128 a[156:159], v228 offset:7168
  s_mov_b32 s54, 0
  buffer_load_dwordx4 a[192:195], v225, s[96:99], s54 offen offset:0 sc1
  v_mfma_f32_16x16x32_bf16 v[0:3], a[140:143], v[172:175], v[0:3]
  v_exp_f32 v193, v53
  v_mfma_f32_16x16x32_bf16 v[8:11], a[128:131], v[176:179], v[72:75]
  ds_read_b128 a[160:163], v228 offset:8192
  v_cvt_pk_bf16_f32 v122, v192, v193
  v_mfma_f32_16x16x32_bf16 v[8:11], a[132:135], v[180:183], v[8:11]
  v_exp_f32 v194, v54
  v_mfma_f32_16x16x32_bf16 v[8:11], a[136:139], v[184:187], v[8:11]
  ds_read_b128 a[164:167], v228 offset:9216
  buffer_load_dwordx4 a[196:199], v225, s[96:99], s54 offen offset:1024 sc1
  v_mfma_f32_16x16x32_bf16 v[8:11], a[140:143], v[188:191], v[8:11]
  s_waitcnt lgkmcnt(3)
  v_exp_f32 v195, v55
  v_mfma_f32_16x16x32_bf16 v[4:7], a[144:147], v[160:163], v[68:71]
  ds_read_b128 a[168:171], v228 offset:10240
  v_cvt_pk_bf16_f32 v123, v194, v195
  v_mfma_f32_16x16x32_bf16 v[4:7], a[148:151], v[164:167], v[4:7]
  v_exp_f32 v196, v60
  v_mfma_f32_16x16x32_bf16 v[4:7], a[152:155], v[168:171], v[4:7]
  s_waitcnt lgkmcnt(3)
  ds_read_b128 a[172:175], v228 offset:11264
  buffer_load_dwordx4 a[200:203], v225, s[96:99], s54 offen offset:2048 sc1
  v_mfma_f32_16x16x32_bf16 v[4:7], a[156:159], v[172:175], v[4:7]
  v_exp_f32 v197, v61
  v_mfma_f32_16x16x32_bf16 v[12:15], a[144:147], v[176:179], v[76:79]
  ds_read_b128 a[176:179], v228 offset:12288
  v_cvt_pk_bf16_f32 v126, v196, v197
  v_mfma_f32_16x16x32_bf16 v[12:15], a[148:151], v[180:183], v[12:15]
  v_exp_f32 v198, v62
  v_mfma_f32_16x16x32_bf16 v[12:15], a[152:155], v[184:187], v[12:15]
  buffer_load_dwordx4 a[204:207], v225, s[96:99], s54 offen offset:3072 sc1
  v_mfma_f32_16x16x32_bf16 v[12:15], a[156:159], v[188:191], v[12:15]
  s_waitcnt lgkmcnt(3)
  v_exp_f32 v199, v63
  v_mfma_f32_16x16x32_bf16 v[16:19], a[160:163], v[160:163], v[80:83]
  ds_read_b128 a[180:183], v228 offset:13312
  v_cvt_pk_bf16_f32 v127, v198, v199
  v_mfma_f32_16x16x32_bf16 v[16:19], a[164:167], v[164:167], v[16:19]
  v_exp_f32 v192, v0
  v_mfma_f32_16x16x32_bf16 v[200:203], v[216:219], v[112:115], 0
  ds_read_b128 a[184:187], v228 offset:14336
  buffer_load_dwordx4 a[208:211], v226, s[96:99], s54 offen offset:0 sc1
  v_mfma_f32_16x16x32_bf16 v[204:207], v[216:219], v[116:119], 0
  v_exp_f32 v193, v1
  v_mfma_f32_16x16x32_bf16 v[208:211], v[216:219], v[120:123], 0
  ds_read_b128 a[188:191], v228 offset:15360
  v_cvt_pk_bf16_f32 v96, v192, v193
  v_mfma_f32_16x16x32_bf16 v[212:215], v[216:219], v[124:127], 0
  s_waitcnt lgkmcnt(4)
  v_exp_f32 v194, v2
  v_mfma_f32_16x16x32_bf16 v[16:19], a[168:171], v[168:171], v[16:19]
  s_mov_b32 s54, 5120
  buffer_load_dwordx4 a[212:215], v225, s[96:99], s54 offen offset:0 sc1
  v_mfma_f32_16x16x32_bf16 v[16:19], a[172:175], v[172:175], v[16:19]
  v_exp_f32 v195, v3
  v_mfma_f32_16x16x32_bf16 v[24:27], a[160:163], v[176:179], v[88:91]
  ds_read_b128 a[128:131], v230 offset:0
  v_cvt_pk_bf16_f32 v97, v194, v195
  v_mfma_f32_16x16x32_bf16 v[24:27], a[164:167], v[180:183], v[24:27]
  v_exp_f32 v196, v8
  v_mfma_f32_16x16x32_bf16 v[24:27], a[168:171], v[184:187], v[24:27]
  buffer_load_dwordx4 a[216:219], v225, s[96:99], s54 offen offset:1024 sc1
  v_mfma_f32_16x16x32_bf16 v[24:27], a[172:175], v[188:191], v[24:27]
  s_waitcnt lgkmcnt(1)
  v_exp_f32 v197, v9
  v_mfma_f32_16x16x32_bf16 v[20:23], a[176:179], v[160:163], v[84:87]
  v_cvt_pk_bf16_f32 v100, v196, v197
  v_max3_f32 v240, v200, v204, v208
  v_mfma_f32_16x16x32_bf16 v[20:23], a[180:183], v[164:167], v[20:23]
  v_exp_f32 v198, v10
  v_mfma_f32_16x16x32_bf16 v[20:23], a[184:187], v[168:171], v[20:23]
  ds_read_b128 a[132:135], v230 offset:1024
  v_max_f32 v240, v240, v212
  v_mfma_f32_16x16x32_bf16 v[20:23], a[188:191], v[172:175], v[20:23]
  v_exp_f32 v199, v11
  v_mfma_f32_16x16x32_bf16 v[28:31], a[176:179], v[176:179], v[92:95]
  ds_read_b128 a[136:139], v230 offset:2048
  v_cvt_pk_bf16_f32 v101, v198, v199
  v_mfma_f32_16x16x32_bf16 v[28:31], a[180:183], v[180:183], v[28:31]
  v_exp_f32 v192, v4
  v_mfma_f32_16x16x32_bf16 v[28:31], a[184:187], v[184:187], v[28:31]
  s_waitcnt lgkmcnt(2)
  ds_read_b128 a[140:143], v230 offset:3072
  v_cmp_nge_f32 vcc, s40, v240
  v_mfma_f32_16x16x32_bf16 v[28:31], a[188:191], v[188:191], v[28:31]
  s_cbranch_vccnz L_adaL_fb_99
L_adaL_back_100:
  v_exp_f32 v193, v5
  v_mfma_f32_16x16x32_bf16 a[0:3], a[128:131], v[112:115], a[0:3]
  s_waitcnt vmcnt(7)
  s_barrier
  v_mfma_f32_16x16x32_bf16 a[32:35], a[128:131], v[116:119], a[32:35]
  v_cvt_pk_bf16_f32 v98, v192, v193
  v_and_b32 v229, 0xffff, v229
  v_add_f32 v221, v221, v204
  v_mfma_f32_16x16x32_bf16 a[64:67], a[128:131], v[120:123], a[64:67]
  ds_read_b128 a[144:147], v230 offset:4096
  ds_read_b128 a[148:151], v230 offset:5120
  v_add_f32 v222, v222, v208
  v_mfma_f32_16x16x32_bf16 a[96:99], a[128:131], v[124:127], a[96:99]
  s_waitcnt lgkmcnt(4)
  v_exp_f32 v194, v6
  v_mfma_f32_16x16x32_bf16 a[4:7], a[132:135], v[112:115], a[4:7]
  buffer_load_dwordx4 a[220:223], v225, s[96:99], s54 offen offset:2048 sc1
  v_mfma_f32_16x16x32_bf16 a[36:39], a[132:135], v[116:119], a[36:39]
  v_exp_f32 v195, v7
  v_mfma_f32_16x16x32_bf16 a[68:71], a[132:135], v[120:123], a[68:71]
  ds_read_b128 a[152:155], v230 offset:6144
  v_cvt_pk_bf16_f32 v99, v194, v195
  v_add_f32 v223, v223, v212
  v_mfma_f32_16x16x32_bf16 a[100:103], a[132:135], v[124:127], a[100:103]
  s_waitcnt lgkmcnt(4)
  v_exp_f32 v196, v12
  v_mfma_f32_16x16x32_bf16 a[8:11], a[136:139], v[112:115], a[8:11]
  buffer_load_dwordx4 a[224:227], v225, s[96:99], s54 offen offset:3072 sc1
  v_mfma_f32_16x16x32_bf16 a[40:43], a[136:139], v[116:119], a[40:43]
  v_exp_f32 v197, v13
  v_mfma_f32_16x16x32_bf16 a[72:75], a[136:139], v[120:123], a[72:75]
  ds_read_b128 a[156:159], v230 offset:7168
  v_cvt_pk_bf16_f32 v102, v196, v197
  v_mfma_f32_16x16x32_bf16 a[104:107], a[136:139], v[124:127], a[104:107]
  s_waitcnt lgkmcnt(4)
  v_exp_f32 v198, v14
  v_mfma_f32_16x16x32_bf16 a[12:15], a[140:143], v[112:115], a[12:15]
  ds_read_b128 a[128:131], v229 offset:0
  buffer_load_dwordx4 a[228:231], v226, s[96:99], s54 offen offset:0 sc1
  v_mfma_f32_16x16x32_bf16 a[44:47], a[140:143], v[116:119], a[44:47]
  v_exp_f32 v199, v15
  v_mfma_f32_16x16x32_bf16 a[76:79], a[140:143], v[120:123], a[76:79]
  ds_read_b128 a[132:135], v229 offset:1024
  v_cvt_pk_bf16_f32 v103, v198, v199
  v_mfma_f32_16x16x32_bf16 a[108:111], a[140:143], v[124:127], a[108:111]
  s_waitcnt lgkmcnt(5)
  v_exp_f32 v192, v16
  v_mfma_f32_16x16x32_bf16 a[16:19], a[144:147], v[112:115], a[16:19]
  s_mov_b32 s54, 10240
  buffer_load_dwordx4 a[232:235], v225, s[96:99], s54 offen offset:0 sc1
  v_mfma_f32_16x16x32_bf16 a[48:51], a[144:147], v[116:119], a[48:51]
  v_exp_f32 v193, v17
  v_mfma_f32_16x16x32_bf16 a[80:83], a[144:147], v[120:123], a[80:83]
  ds_read_b128 a[136:139], v229 offset:2048
  v_cvt_pk_bf16_f32 v104, v192, v193
  v_mfma_f32_16x16x32_bf16 a[112:115], a[144:147], v[124:127], a[112:115]
  s_waitcnt lgkmcnt(5)
  v_exp_f32 v194, v18
  v_mfma_f32_16x16x32_bf16 a[20:23], a[148:151], v[112:115], a[20:23]
  buffer_load_dwordx4 a[236:239], v225, s[96:99], s54 offen offset:1024 sc1
  v_mfma_f32_16x16x32_bf16 a[52:55], a[148:151], v[116:119], a[52:55]
  v_exp_f32 v195, v19
  v_mfma_f32_16x16x32_bf16 a[84:87], a[148:151], v[120:123], a[84:87]
  ds_read_b128 a[140:143], v229 offset:3072
  v_cvt_pk_bf16_f32 v105, v194, v195
  v_mfma_f32_16x16x32_bf16 a[116:119], a[148:151], v[124:127], a[116:119]
  s_waitcnt lgkmcnt(5)
  v_exp_f32 v196, v24
  v_mfma_f32_16x16x32_bf16 a[24:27], a[152:155], v[112:115], a[24:27]
  buffer_load_dwordx4 a[240:243], v225, s[96:99], s54 offen offset:2048 sc1
  v_mfma_f32_16x16x32_bf16 a[56:59], a[152:155], v[116:119], a[56:59]
  v_exp_f32 v197, v25
  v_mfma_f32_16x16x32_bf16 a[88:91], a[152:155], v[120:123], a[88:91]
  ds_read_b128 a[144:147], v229 offset:4096
  v_cvt_pk_bf16_f32 v108, v196, v197
  v_mfma_f32_16x16x32_bf16 a[120:123], a[152:155], v[124:127], a[120:123]
  s_waitcnt lgkmcnt(5)
  v_exp_f32 v198, v26
  v_mfma_f32_16x16x32_bf16 a[28:31], a[156:159], v[112:115], a[28:31]
  buffer_load_dwordx4 a[244:247], v225, s[96:99], s54 offen offset:3072 sc1
  v_mfma_f32_16x16x32_bf16 a[60:63], a[156:159], v[116:119], a[60:63]
  s_waitcnt lgkmcnt(4)
  v_exp_f32 v199, v27
  v_mfma_f32_16x16x32_bf16 a[92:95], a[156:159], v[120:123], a[92:95]
  s_add_u32 s61, s61, 2
  ds_read_b128 a[148:151], v229 offset:5120
  v_cvt_pk_bf16_f32 v109, v198, v199
  v_mfma_f32_16x16x32_bf16 a[124:127], a[156:159], v[124:127], a[124:127]
  v_add_u32 v230, 0x10000, v228
  v_add_f32 v220, v220, v200
  s_nop 7
  v_rcp_f32 v240, v220
  v_rcp_f32 v242, v221
  s_lshr_b32 s46, s47, 1
  s_mul_i32 s46, s46, 540672
  s_and_b32 s45, s47, 1
  s_lshl_b32 s45, s45, 11
  s_add_u32 s46, s46, s45
  v_accvgpr_read_b32 v128, a0
  v_accvgpr_read_b32 v129, a1
  v_accvgpr_read_b32 v130, a2
  v_accvgpr_read_b32 v131, a3
  v_accvgpr_read_b32 v132, a4
  v_accvgpr_read_b32 v133, a5
  v_accvgpr_read_b32 v134, a6
  v_accvgpr_read_b32 v135, a7
  v_pk_mul_f32 v[128:129], v[128:129], v[240:241] op_sel_hi:[1,0]
  buffer_load_dwordx4 a[248:251], v226, s[96:99], s54 offen offset:0 sc1
  v_pk_mul_f32 v[130:131], v[130:131], v[240:241] op_sel_hi:[1,0]
  v_pk_mul_f32 v[132:133], v[132:133], v[240:241] op_sel_hi:[1,0]
  v_pk_mul_f32 v[134:135], v[134:135], v[240:241] op_sel_hi:[1,0]
  v_cvt_pk_bf16_f32 v128, v128, v129
  s_mov_b32 s54, 15360
  buffer_load_dwordx4 a[252:255], v225, s[96:99], s54 offen offset:0 sc1
  v_cvt_pk_bf16_f32 v129, v130, v131
  v_cvt_pk_bf16_f32 v130, v132, v133
  v_cvt_pk_bf16_f32 v131, v134, v135
  buffer_store_dwordx4 v[128:131], v232, s[32:35], s46 offen offset:0 sc1
  v_accvgpr_read_b32 v136, a32
  v_accvgpr_read_b32 v137, a33
  v_accvgpr_read_b32 v138, a34
  v_accvgpr_read_b32 v139, a35
  v_accvgpr_read_b32 v140, a36
  v_accvgpr_read_b32 v141, a37
  v_accvgpr_read_b32 v142, a38
  v_accvgpr_read_b32 v143, a39
  v_pk_mul_f32 v[136:137], v[136:137], v[242:243] op_sel_hi:[1,0]
  buffer_load_dwordx4 a[0:3], v225, s[96:99], s54 offen offset:1024 sc1
  v_pk_mul_f32 v[138:139], v[138:139], v[242:243] op_sel_hi:[1,0]
  v_pk_mul_f32 v[140:141], v[140:141], v[242:243] op_sel_hi:[1,0]
  v_pk_mul_f32 v[142:143], v[142:143], v[242:243] op_sel_hi:[1,0]
  v_cvt_pk_bf16_f32 v136, v136, v137
  buffer_load_dwordx4 a[4:7], v225, s[96:99], s54 offen offset:2048 sc1
  v_cvt_pk_bf16_f32 v137, v138, v139
  v_cvt_pk_bf16_f32 v138, v140, v141
  v_cvt_pk_bf16_f32 v139, v142, v143
  buffer_store_dwordx4 v[136:139], v232, s[32:35], s46 offen offset:1024 sc1
  s_add_u32 s46, s46, 4096
  v_accvgpr_read_b32 v144, a8
  v_accvgpr_read_b32 v145, a9
  v_accvgpr_read_b32 v146, a10
  v_accvgpr_read_b32 v147, a11
  v_accvgpr_read_b32 v148, a12
  v_accvgpr_read_b32 v149, a13
  v_accvgpr_read_b32 v150, a14
  v_accvgpr_read_b32 v151, a15
  v_pk_mul_f32 v[144:145], v[144:145], v[240:241] op_sel_hi:[1,0]
  buffer_load_dwordx4 a[32:35], v225, s[96:99], s54 offen offset:3072 sc1
  v_pk_mul_f32 v[146:147], v[146:147], v[240:241] op_sel_hi:[1,0]
  v_pk_mul_f32 v[148:149], v[148:149], v[240:241] op_sel_hi:[1,0]
  v_pk_mul_f32 v[150:151], v[150:151], v[240:241] op_sel_hi:[1,0]
  v_cvt_pk_bf16_f32 v144, v144, v145
  buffer_load_dwordx4 a[36:39], v226, s[96:99], s54 offen offset:0 sc1
  v_cvt_pk_bf16_f32 v145, v146, v147
  v_cvt_pk_bf16_f32 v146, v148, v149
  v_cvt_pk_bf16_f32 v147, v150, v151
  buffer_store_dwordx4 v[144:147], v232, s[32:35], s46 offen offset:0 sc1
  v_accvgpr_read_b32 v152, a40
  v_accvgpr_read_b32 v153, a41
  v_accvgpr_read_b32 v154, a42
  v_accvgpr_read_b32 v155, a43
  v_accvgpr_read_b32 v156, a44
  v_accvgpr_read_b32 v157, a45
  v_accvgpr_read_b32 v158, a46
  v_accvgpr_read_b32 v159, a47
  v_pk_mul_f32 v[152:153], v[152:153], v[242:243] op_sel_hi:[1,0]
  s_mov_b32 s54, 25600
  buffer_load_dwordx4 a[8:11], v225, s[96:99], s54 offen offset:0 sc1
  v_pk_mul_f32 v[154:155], v[154:155], v[242:243] op_sel_hi:[1,0]
  v_pk_mul_f32 v[156:157], v[156:157], v[242:243] op_sel_hi:[1,0]
  v_pk_mul_f32 v[158:159], v[158:159], v[242:243] op_sel_hi:[1,0]
  v_cvt_pk_bf16_f32 v152, v152, v153
  buffer_load_dwordx4 a[12:15], v225, s[96:99], s54 offen offset:1024 sc1
  v_cvt_pk_bf16_f32 v153, v154, v155
  v_cvt_pk_bf16_f32 v154, v156, v157
  v_cvt_pk_bf16_f32 v155, v158, v159
  buffer_store_dwordx4 v[152:155], v232, s[32:35], s46 offen offset:1024 sc1
  s_add_u32 s46, s46, 4096
  v_accvgpr_read_b32 v128, a16
  v_accvgpr_read_b32 v129, a17
  v_accvgpr_read_b32 v130, a18
  v_accvgpr_read_b32 v131, a19
  v_accvgpr_read_b32 v132, a20
  v_accvgpr_read_b32 v133, a21
  v_accvgpr_read_b32 v134, a22
  v_accvgpr_read_b32 v135, a23
  v_pk_mul_f32 v[128:129], v[128:129], v[240:241] op_sel_hi:[1,0]
  buffer_load_dwordx4 a[40:43], v225, s[96:99], s54 offen offset:2048 sc1
  v_pk_mul_f32 v[130:131], v[130:131], v[240:241] op_sel_hi:[1,0]
  v_pk_mul_f32 v[132:133], v[132:133], v[240:241] op_sel_hi:[1,0]
  v_pk_mul_f32 v[134:135], v[134:135], v[240:241] op_sel_hi:[1,0]
  v_cvt_pk_bf16_f32 v128, v128, v129
  buffer_load_dwordx4 a[44:47], v225, s[96:99], s54 offen offset:3072 sc1
  v_cvt_pk_bf16_f32 v129, v130, v131
  v_cvt_pk_bf16_f32 v130, v132, v133
  v_cvt_pk_bf16_f32 v131, v134, v135
  buffer_store_dwordx4 v[128:131], v232, s[32:35], s46 offen offset:0 sc1
  v_accvgpr_read_b32 v136, a48
  v_accvgpr_read_b32 v137, a49
  v_accvgpr_read_b32 v138, a50
  v_accvgpr_read_b32 v139, a51
  v_accvgpr_read_b32 v140, a52
  v_accvgpr_read_b32 v141, a53
  v_accvgpr_read_b32 v142, a54
  v_accvgpr_read_b32 v143, a55
  v_pk_mul_f32 v[136:137], v[136:137], v[242:243] op_sel_hi:[1,0]
  buffer_load_dwordx4 a[16:19], v226, s[96:99], s54 offen offset:0 sc1
  v_pk_mul_f32 v[138:139], v[138:139], v[242:243] op_sel_hi:[1,0]
  v_pk_mul_f32 v[140:141], v[140:141], v[242:243] op_sel_hi:[1,0]
  v_pk_mul_f32 v[142:143], v[142:143], v[242:243] op_sel_hi:[1,0]
  v_cvt_pk_bf16_f32 v136, v136, v137
  s_mov_b32 s54, 30720
  buffer_load_dwordx4 a[20:23], v225, s[96:99], s54 offen offset:0 sc1
  v_cvt_pk_bf16_f32 v137, v138, v139
  v_cvt_pk_bf16_f32 v138, v140, v141
  v_cvt_pk_bf16_f32 v139, v142, v143
  buffer_store_dwordx4 v[136:139], v232, s[32:35], s46 offen offset:1024 sc1
  s_add_u32 s46, s46, 4096
  v_accvgpr_read_b32 v144, a24
  v_accvgpr_read_b32 v145, a25
  v_accvgpr_read_b32 v146, a26
  v_accvgpr_read_b32 v147, a27
  v_accvgpr_read_b32 v148, a28
  v_accvgpr_read_b32 v149, a29
  v_accvgpr_read_b32 v150, a30
  v_accvgpr_read_b32 v151, a31
  v_pk_mul_f32 v[144:145], v[144:145], v[240:241] op_sel_hi:[1,0]
  buffer_load_dwordx4 a[48:51], v225, s[96:99], s54 offen offset:1024 sc1
  v_pk_mul_f32 v[146:147], v[146:147], v[240:241] op_sel_hi:[1,0]
  v_pk_mul_f32 v[148:149], v[148:149], v[240:241] op_sel_hi:[1,0]
  v_pk_mul_f32 v[150:151], v[150:151], v[240:241] op_sel_hi:[1,0]
  v_cvt_pk_bf16_f32 v144, v144, v145
  buffer_load_dwordx4 a[52:55], v225, s[96:99], s54 offen offset:2048 sc1
  v_cvt_pk_bf16_f32 v145, v146, v147
  v_cvt_pk_bf16_f32 v146, v148, v149
  v_cvt_pk_bf16_f32 v147, v150, v151
  buffer_store_dwordx4 v[144:147], v232, s[32:35], s46 offen offset:0 sc1
  v_accvgpr_read_b32 v152, a56
  v_accvgpr_read_b32 v153, a57
  v_accvgpr_read_b32 v154, a58
  v_accvgpr_read_b32 v155, a59
  v_accvgpr_read_b32 v156, a60
  v_accvgpr_read_b32 v157, a61
  v_accvgpr_read_b32 v158, a62
  v_accvgpr_read_b32 v159, a63
  v_pk_mul_f32 v[152:153], v[152:153], v[242:243] op_sel_hi:[1,0]
  buffer_load_dwordx4 a[24:27], v225, s[96:99], s54 offen offset:3072 sc1
  v_pk_mul_f32 v[154:155], v[154:155], v[242:243] op_sel_hi:[1,0]
  v_pk_mul_f32 v[156:157], v[156:157], v[242:243] op_sel_hi:[1,0]
  v_pk_mul_f32 v[158:159], v[158:159], v[242:243] op_sel_hi:[1,0]
  v_cvt_pk_bf16_f32 v152, v152, v153
  v_cvt_pk_bf16_f32 v153, v154, v155
  v_cvt_pk_bf16_f32 v154, v156, v157
  v_cvt_pk_bf16_f32 v155, v158, v159
  buffer_store_dwordx4 v[152:155], v232, s[32:35], s46 offen offset:1024 sc1
  s_add_u32 s46, s46, 4096
  s_branch L_adaL_last_38
L_c1:
L_adaL_fb_27:
  s_nop 15
  v_max3_f32 v240, v0, v1, v2
  v_max3_f32 v240, v240, v3, v4
  v_max3_f32 v240, v240, v5, v6
  v_max_f32 v240, v240, v7
  v_max3_f32 v241, v8, v9, v10
  v_max3_f32 v241, v241, v11, v12
  v_max3_f32 v241, v241, v13, v14
  v_max_f32 v241, v241, v15
  v_mov_b32 v248, v240
  v_mov_b32 v249, v241
  s_nop 1
  v_permlane16_swap_b32 v240, v248
  v_permlane16_swap_b32 v241, v249
  s_nop 1
  v_max_f32 v240, v240, v248
  v_max_f32 v241, v241, v249
  v_mov_b32 v248, v240
  v_mov_b32 v249, v241
  s_nop 1
  v_permlane32_swap_b32 v240, v248
  v_permlane32_swap_b32 v241, v249
  s_nop 1
  v_max_f32 v240, v240, v248
  v_max_f32 v241, v241, v249
  v_max3_f32 v242, v16, v17, v18
  v_max3_f32 v242, v242, v19, v20
  v_max3_f32 v242, v242, v21, v22
  v_max_f32 v242, v242, v23
  v_max3_f32 v243, v24, v25, v26
  v_max3_f32 v243, v243, v27, v28
  v_max3_f32 v243, v243, v29, v30
  v_max_f32 v243, v243, v31
  v_mov_b32 v248, v242
  v_mov_b32 v249, v243
  s_nop 1
  v_permlane16_swap_b32 v242, v248
  v_permlane16_swap_b32 v243, v249
  s_nop 1
  v_max_f32 v242, v242, v248
  v_max_f32 v243, v243, v249
  v_mov_b32 v248, v242
  v_mov_b32 v249, v243
  s_nop 1
  v_permlane32_swap_b32 v242, v248
  v_permlane32_swap_b32 v243, v249
  s_nop 1
  v_max_f32 v242, v242, v248
  v_max_f32 v243, v243, v249
  v_max_f32 v240, 0, v240
  v_max_f32 v241, 0, v241
  v_max_f32 v242, 0, v242
  v_max_f32 v243, 0, v243
  v_exp_f32 v244, -v240
  v_exp_f32 v245, -v241
  v_exp_f32 v246, -v242
  v_exp_f32 v247, -v243
  v_sub_f32 v0, v0, v240
  v_sub_f32 v1, v1, v240
  v_sub_f32 v2, v2, v240
  v_sub_f32 v3, v3, v240
  v_sub_f32 v4, v4, v240
  v_sub_f32 v5, v5, v240
  v_sub_f32 v6, v6, v240
  v_sub_f32 v7, v7, v240
  v_sub_f32 v8, v8, v241
  v_sub_f32 v9, v9, v241
  v_sub_f32 v10, v10, v241
  v_sub_f32 v11, v11, v241
  v_sub_f32 v12, v12, v241
  v_sub_f32 v13, v13, v241
  v_sub_f32 v14, v14, v241
  v_sub_f32 v15, v15, v241
  v_sub_f32 v16, v16, v242
  v_sub_f32 v17, v17, v242
  v_sub_f32 v18, v18, v242
  v_sub_f32 v19, v19, v242
  v_sub_f32 v20, v20, v242
  v_sub_f32 v21, v21, v242
  v_sub_f32 v22, v22, v242
  v_sub_f32 v23, v23, v242
  v_sub_f32 v24, v24, v243
  v_sub_f32 v25, v25, v243
  v_sub_f32 v26, v26, v243
  v_sub_f32 v27, v27, v243
  v_sub_f32 v28, v28, v243
  v_sub_f32 v29, v29, v243
  v_sub_f32 v30, v30, v243
  v_sub_f32 v31, v31, v243
  v_exp_f32 v192, v0
  v_exp_f32 v193, v1
  v_exp_f32 v194, v2
  v_cvt_pk_bf16_f32 v96, v192, v193
  v_exp_f32 v195, v3
  v_exp_f32 v196, v8
  v_cvt_pk_bf16_f32 v97, v194, v195
  v_exp_f32 v197, v9
  v_exp_f32 v198, v10
  v_cvt_pk_bf16_f32 v100, v196, v197
  v_exp_f32 v199, v11
  v_exp_f32 v192, v16
  v_cvt_pk_bf16_f32 v101, v198, v199
  v_exp_f32 v193, v17
  v_exp_f32 v194, v18
  v_cvt_pk_bf16_f32 v104, v192, v193
  v_exp_f32 v195, v19
  v_exp_f32 v196, v24
  v_cvt_pk_bf16_f32 v105, v194, v195
  v_exp_f32 v197, v25
  v_exp_f32 v198, v26
  v_cvt_pk_bf16_f32 v108, v196, v197
  v_exp_f32 v199, v27
  v_exp_f32 v192, v4
  v_cvt_pk_bf16_f32 v109, v198, v199
  v_exp_f32 v193, v5
  v_exp_f32 v194, v6
  v_cvt_pk_bf16_f32 v98, v192, v193
  v_exp_f32 v195, v7
  v_exp_f32 v196, v12
  v_cvt_pk_bf16_f32 v99, v194, v195
  v_exp_f32 v197, v13
  v_exp_f32 v198, v14
  v_cvt_pk_bf16_f32 v102, v196, v197
  v_exp_f32 v199, v15
  v_exp_f32 v192, v20
  v_cvt_pk_bf16_f32 v103, v198, v199
  v_exp_f32 v193, v21
  v_exp_f32 v194, v22
  v_cvt_pk_bf16_f32 v106, v192, v193
  v_exp_f32 v195, v23
  v_exp_f32 v196, v28
  v_cvt_pk_bf16_f32 v107, v194, v195
  v_exp_f32 v197, v29
  v_exp_f32 v198, v30
  v_cvt_pk_bf16_f32 v110, v196, v197
  v_exp_f32 v199, v31
  s_nop 0
  v_cvt_pk_bf16_f32 v111, v198, v199
  s_nop 1
  v_mfma_f32_16x16x32_bf16 v[200:203], v[216:219], v[96:99], 0
  v_mfma_f32_16x16x32_bf16 v[204:207], v[216:219], v[100:103], 0
  v_mfma_f32_16x16x32_bf16 v[208:211], v[216:219], v[104:107], 0
  v_mfma_f32_16x16x32_bf16 v[212:215], v[216:219], v[108:111], 0
  v_sub_f32 v32, v32, v240
  v_sub_f32 v64, v64, v240
  v_sub_f32 v33, v33, v240
  v_sub_f32 v65, v65, v240
  v_sub_f32 v34, v34, v240
  v_sub_f32 v66, v66, v240
  v_sub_f32 v35, v35, v240
  v_sub_f32 v67, v67, v240
  v_sub_f32 v36, v36, v240
  v_sub_f32 v68, v68, v240
  v_sub_f32 v37, v37, v240
  v_sub_f32 v69, v69, v240
  v_sub_f32 v38, v38, v240
  v_sub_f32 v70, v70, v240
  v_sub_f32 v39, v39, v240
  v_sub_f32 v71, v71, v240
  v_sub_f32 v40, v40, v241
  v_sub_f32 v72, v72, v241
  v_sub_f32 v41, v41, v241
  v_sub_f32 v73, v73, v241
  v_sub_f32 v42, v42, v241
  v_sub_f32 v74, v74, v241
  v_sub_f32 v43, v43, v241
  v_sub_f32 v75, v75, v241
  v_sub_f32 v44, v44, v241
  v_sub_f32 v76, v76, v241
  v_sub_f32 v45, v45, v241
  v_sub_f32 v77, v77, v241
  v_sub_f32 v46, v46, v241
  v_sub_f32 v78, v78, v241
  v_sub_f32 v47, v47, v241
  v_sub_f32 v79, v79, v241
  v_sub_f32 v48, v48, v242
  v_sub_f32 v80, v80, v242
  v_sub_f32 v49, v49, v242
  v_sub_f32 v81, v81, v242
  v_sub_f32 v50, v50, v242
  v_sub_f32 v82, v82, v242
  v_sub_f32 v51, v51, v242
  v_sub_f32 v83, v83, v242
  v_sub_f32 v52, v52, v242
  v_sub_f32 v84, v84, v242
  v_sub_f32 v53, v53, v242
  v_sub_f32 v85, v85, v242
  v_sub_f32 v54, v54, v242
  v_sub_f32 v86, v86, v242
  v_sub_f32 v55, v55, v242
  v_sub_f32 v87, v87, v242
  v_sub_f32 v56, v56, v243
  v_sub_f32 v88, v88, v243
  v_sub_f32 v57, v57, v243
  v_sub_f32 v89, v89, v243
  v_sub_f32 v58, v58, v243
  v_sub_f32 v90, v90, v243
  v_sub_f32 v59, v59, v243
  v_sub_f32 v91, v91, v243
  v_sub_f32 v60, v60, v243
  v_sub_f32 v92, v92, v243
  v_sub_f32 v61, v61, v243
  v_sub_f32 v93, v93, v243
  v_sub_f32 v62, v62, v243
  v_sub_f32 v94, v94, v243
  v_sub_f32 v63, v63, v243
  v_sub_f32 v95, v95, v243
  v_exp_f32 v192, v32
  v_exp_f32 v193, v33
  v_exp_f32 v194, v34
  v_cvt_pk_bf16_f32 v112, v192, v193
  v_exp_f32 v195, v35
  v_exp_f32 v196, v40
  v_cvt_pk_bf16_f32 v113, v194, v195
  v_exp_f32 v197, v41
  v_exp_f32 v198, v42
  v_cvt_pk_bf16_f32 v116, v196, v197
  v_exp_f32 v199, v43
  v_exp_f32 v192, v48
  v_cvt_pk_bf16_f32 v117, v198, v199
  v_mul_f32 v220, v220, v244
  v_accvgpr_read_b32 v248, a0
  v_accvgpr_read_b32 v249, a1
  v_mul_f32 v248, v248, v244
  v_mul_f32 v249, v249, v244
  v_accvgpr_write_b32 a0, v248
  v_accvgpr_write_b32 a1, v249
  v_accvgpr_read_b32 v248, a2
  v_accvgpr_read_b32 v249, a3
  v_mul_f32 v248, v248, v244
  v_mul_f32 v249, v249, v244
  v_accvgpr_write_b32 a2, v248
  v_accvgpr_write_b32 a3, v249
  v_accvgpr_read_b32 v248, a4
  v_accvgpr_read_b32 v249, a5
  v_mul_f32 v248, v248, v244
  v_mul_f32 v249, v249, v244
  v_accvgpr_write_b32 a4, v248
  v_accvgpr_write_b32 a5, v249
  v_accvgpr_read_b32 v248, a6
  v_accvgpr_read_b32 v249, a7
  v_mul_f32 v248, v248, v244
  v_mul_f32 v249, v249, v244
  v_accvgpr_write_b32 a6, v248
  v_accvgpr_write_b32 a7, v249
  v_accvgpr_read_b32 v248, a8
  v_accvgpr_read_b32 v249, a9
  v_mul_f32 v248, v248, v244
  v_mul_f32 v249, v249, v244
  v_accvgpr_write_b32 a8, v248
  v_accvgpr_write_b32 a9, v249
  v_accvgpr_read_b32 v248, a10
  v_accvgpr_read_b32 v249, a11
  v_mul_f32 v248, v248, v244
  v_mul_f32 v249, v249, v244
  v_accvgpr_write_b32 a10, v248
  v_accvgpr_write_b32 a11, v249
  v_accvgpr_read_b32 v248, a12
  v_accvgpr_read_b32 v249, a13
  v_mul_f32 v248, v248, v244
  v_mul_f32 v249, v249, v244
  v_accvgpr_write_b32 a12, v248
  v_accvgpr_write_b32 a13, v249
  v_accvgpr_read_b32 v248, a14
  v_accvgpr_read_b32 v249, a15
  v_mul_f32 v248, v248, v244
  v_mul_f32 v249, v249, v244
  v_accvgpr_write_b32 a14, v248
  v_accvgpr_write_b32 a15, v249
  v_accvgpr_read_b32 v248, a16
  v_accvgpr_read_b32 v249, a17
  v_mul_f32 v248, v248, v244
  v_mul_f32 v249, v249, v244
  v_accvgpr_write_b32 a16, v248
  v_accvgpr_write_b32 a17, v249
  v_accvgpr_read_b32 v248, a18
  v_accvgpr_read_b32 v249, a19
  v_mul_f32 v248, v248, v244
  v_mul_f32 v249, v249, v244
  v_accvgpr_write_b32 a18, v248
  v_accvgpr_write_b32 a19, v249
  v_accvgpr_read_b32 v248, a20
  v_accvgpr_read_b32 v249, a21
  v_mul_f32 v248, v248, v244
  v_mul_f32 v249, v249, v244
  v_accvgpr_write_b32 a20, v248
  v_accvgpr_write_b32 a21, v249
  v_accvgpr_read_b32 v248, a22
  v_accvgpr_read_b32 v249, a23
  v_mul_f32 v248, v248, v244
  v_mul_f32 v249, v249, v244
  v_accvgpr_write_b32 a22, v248
  v_accvgpr_write_b32 a23, v249
  v_accvgpr_read_b32 v248, a24
  v_accvgpr_read_b32 v249, a25
  v_mul_f32 v248, v248, v244
  v_mul_f32 v249, v249, v244
  v_accvgpr_write_b32 a24, v248
  v_accvgpr_write_b32 a25, v249
  v_accvgpr_read_b32 v248, a26
  v_accvgpr_read_b32 v249, a27
  v_mul_f32 v248, v248, v244
  v_mul_f32 v249, v249, v244
  v_accvgpr_write_b32 a26, v248
  v_accvgpr_write_b32 a27, v249
  v_accvgpr_read_b32 v248, a28
  v_accvgpr_read_b32 v249, a29
  v_mul_f32 v248, v248, v244
  v_mul_f32 v249, v249, v244
  v_accvgpr_write_b32 a28, v248
  v_accvgpr_write_b32 a29, v249
  v_accvgpr_read_b32 v248, a30
  v_accvgpr_read_b32 v249, a31
  v_mul_f32 v248, v248, v244
  v_mul_f32 v249, v249, v244
  v_accvgpr_write_b32 a30, v248
  v_accvgpr_write_b32 a31, v249
  v_mul_f32 v221, v221, v245
  v_accvgpr_read_b32 v248, a32
  v_accvgpr_read_b32 v249, a33
  v_mul_f32 v248, v248, v245
  v_mul_f32 v249, v249, v245
  v_accvgpr_write_b32 a32, v248
  v_accvgpr_write_b32 a33, v249
  v_accvgpr_read_b32 v248, a34
  v_accvgpr_read_b32 v249, a35
  v_mul_f32 v248, v248, v245
  v_mul_f32 v249, v249, v245
  v_accvgpr_write_b32 a34, v248
  v_accvgpr_write_b32 a35, v249
  v_accvgpr_read_b32 v248, a36
  v_accvgpr_read_b32 v249, a37
  v_mul_f32 v248, v248, v245
  v_mul_f32 v249, v249, v245
  v_accvgpr_write_b32 a36, v248
  v_accvgpr_write_b32 a37, v249
  v_accvgpr_read_b32 v248, a38
  v_accvgpr_read_b32 v249, a39
  v_mul_f32 v248, v248, v245
  v_mul_f32 v249, v249, v245
  v_accvgpr_write_b32 a38, v248
  v_accvgpr_write_b32 a39, v249
  v_accvgpr_read_b32 v248, a40
  v_accvgpr_read_b32 v249, a41
  v_mul_f32 v248, v248, v245
  v_mul_f32 v249, v249, v245
  v_accvgpr_write_b32 a40, v248
  v_accvgpr_write_b32 a41, v249
  v_accvgpr_read_b32 v248, a42
  v_accvgpr_read_b32 v249, a43
  v_mul_f32 v248, v248, v245
  v_mul_f32 v249, v249, v245
  v_accvgpr_write_b32 a42, v248
  v_accvgpr_write_b32 a43, v249
  v_accvgpr_read_b32 v248, a44
  v_accvgpr_read_b32 v249, a45
  v_mul_f32 v248, v248, v245
  v_mul_f32 v249, v249, v245
  v_accvgpr_write_b32 a44, v248
  v_accvgpr_write_b32 a45, v249
  v_accvgpr_read_b32 v248, a46
  v_accvgpr_read_b32 v249, a47
  v_mul_f32 v248, v248, v245
  v_mul_f32 v249, v249, v245
  v_accvgpr_write_b32 a46, v248
  v_accvgpr_write_b32 a47, v249
  v_accvgpr_read_b32 v248, a48
  v_accvgpr_read_b32 v249, a49
  v_mul_f32 v248, v248, v245
  v_mul_f32 v249, v249, v245
  v_accvgpr_write_b32 a48, v248
  v_accvgpr_write_b32 a49, v249
  v_accvgpr_read_b32 v248, a50
  v_accvgpr_read_b32 v249, a51
  v_mul_f32 v248, v248, v245
  v_mul_f32 v249, v249, v245
  v_accvgpr_write_b32 a50, v248
  v_accvgpr_write_b32 a51, v249
  v_accvgpr_read_b32 v248, a52
  v_accvgpr_read_b32 v249, a53
  v_mul_f32 v248, v248, v245
  v_mul_f32 v249, v249, v245
  v_accvgpr_write_b32 a52, v248
  v_accvgpr_write_b32 a53, v249
  v_accvgpr_read_b32 v248, a54
  v_accvgpr_read_b32 v249, a55
  v_mul_f32 v248, v248, v245
  v_mul_f32 v249, v249, v245
  v_accvgpr_write_b32 a54, v248
  v_accvgpr_write_b32 a55, v249
  v_accvgpr_read_b32 v248, a56
  v_accvgpr_read_b32 v249, a57
  v_mul_f32 v248, v248, v245
  v_mul_f32 v249, v249, v245
  v_accvgpr_write_b32 a56, v248
  v_accvgpr_write_b32 a57, v249
  v_accvgpr_read_b32 v248, a58
  v_accvgpr_read_b32 v249, a59
  v_mul_f32 v248, v248, v245
  v_mul_f32 v249, v249, v245
  v_accvgpr_write_b32 a58, v248
  v_accvgpr_write_b32 a59, v249
  v_accvgpr_read_b32 v248, a60
  v_accvgpr_read_b32 v249, a61
  v_mul_f32 v248, v248, v245
  v_mul_f32 v249, v249, v245
  v_accvgpr_write_b32 a60, v248
  v_accvgpr_write_b32 a61, v249
  v_accvgpr_read_b32 v248, a62
  v_accvgpr_read_b32 v249, a63
  v_mul_f32 v248, v248, v245
  v_mul_f32 v249, v249, v245
  v_accvgpr_write_b32 a62, v248
  v_accvgpr_write_b32 a63, v249
  v_mul_f32 v222, v222, v246
  v_accvgpr_read_b32 v248, a64
  v_accvgpr_read_b32 v249, a65
  v_mul_f32 v248, v248, v246
  v_mul_f32 v249, v249, v246
  v_accvgpr_write_b32 a64, v248
  v_accvgpr_write_b32 a65, v249
  v_accvgpr_read_b32 v248, a66
  v_accvgpr_read_b32 v249, a67
  v_mul_f32 v248, v248, v246
  v_mul_f32 v249, v249, v246
  v_accvgpr_write_b32 a66, v248
  v_accvgpr_write_b32 a67, v249
  v_accvgpr_read_b32 v248, a68
  v_accvgpr_read_b32 v249, a69
  v_mul_f32 v248, v248, v246
  v_mul_f32 v249, v249, v246
  v_accvgpr_write_b32 a68, v248
  v_accvgpr_write_b32 a69, v249
  v_accvgpr_read_b32 v248, a70
  v_accvgpr_read_b32 v249, a71
  v_mul_f32 v248, v248, v246
  v_mul_f32 v249, v249, v246
  v_accvgpr_write_b32 a70, v248
  v_accvgpr_write_b32 a71, v249
  v_accvgpr_read_b32 v248, a72
  v_accvgpr_read_b32 v249, a73
  v_mul_f32 v248, v248, v246
  v_mul_f32 v249, v249, v246
  v_accvgpr_write_b32 a72, v248
  v_accvgpr_write_b32 a73, v249
  v_accvgpr_read_b32 v248, a74
  v_accvgpr_read_b32 v249, a75
  v_mul_f32 v248, v248, v246
  v_mul_f32 v249, v249, v246
  v_accvgpr_write_b32 a74, v248
  v_accvgpr_write_b32 a75, v249
  v_accvgpr_read_b32 v248, a76
  v_accvgpr_read_b32 v249, a77
  v_mul_f32 v248, v248, v246
  v_mul_f32 v249, v249, v246
  v_accvgpr_write_b32 a76, v248
  v_accvgpr_write_b32 a77, v249
  v_accvgpr_read_b32 v248, a78
  v_accvgpr_read_b32 v249, a79
  v_mul_f32 v248, v248, v246
  v_mul_f32 v249, v249, v246
  v_accvgpr_write_b32 a78, v248
  v_accvgpr_write_b32 a79, v249
  v_accvgpr_read_b32 v248, a80
  v_accvgpr_read_b32 v249, a81
  v_mul_f32 v248, v248, v246
  v_mul_f32 v249, v249, v246
  v_accvgpr_write_b32 a80, v248
  v_accvgpr_write_b32 a81, v249
  v_accvgpr_read_b32 v248, a82
  v_accvgpr_read_b32 v249, a83
  v_mul_f32 v248, v248, v246
  v_mul_f32 v249, v249, v246
  v_accvgpr_write_b32 a82, v248
  v_accvgpr_write_b32 a83, v249
  v_accvgpr_read_b32 v248, a84
  v_accvgpr_read_b32 v249, a85
  v_mul_f32 v248, v248, v246
  v_mul_f32 v249, v249, v246
  v_accvgpr_write_b32 a84, v248
  v_accvgpr_write_b32 a85, v249
  v_accvgpr_read_b32 v248, a86
  v_accvgpr_read_b32 v249, a87
  v_mul_f32 v248, v248, v246
  v_mul_f32 v249, v249, v246
  v_accvgpr_write_b32 a86, v248
  v_accvgpr_write_b32 a87, v249
  v_accvgpr_read_b32 v248, a88
  v_accvgpr_read_b32 v249, a89
  v_mul_f32 v248, v248, v246
  v_mul_f32 v249, v249, v246
  v_accvgpr_write_b32 a88, v248
  v_accvgpr_write_b32 a89, v249
  v_accvgpr_read_b32 v248, a90
  v_accvgpr_read_b32 v249, a91
  v_mul_f32 v248, v248, v246
  v_mul_f32 v249, v249, v246
  v_accvgpr_write_b32 a90, v248
  v_accvgpr_write_b32 a91, v249
  v_accvgpr_read_b32 v248, a92
  v_accvgpr_read_b32 v249, a93
  v_mul_f32 v248, v248, v246
  v_mul_f32 v249, v249, v246
  v_accvgpr_write_b32 a92, v248
  v_accvgpr_write_b32 a93, v249
  v_accvgpr_read_b32 v248, a94
  v_accvgpr_read_b32 v249, a95
  v_mul_f32 v248, v248, v246
  v_mul_f32 v249, v249, v246
  v_accvgpr_write_b32 a94, v248
  v_accvgpr_write_b32 a95, v249
  v_mul_f32 v223, v223, v247
  v_accvgpr_read_b32 v248, a96
  v_accvgpr_read_b32 v249, a97
  v_mul_f32 v248, v248, v247
  v_mul_f32 v249, v249, v247
  v_accvgpr_write_b32 a96, v248
  v_accvgpr_write_b32 a97, v249
  v_accvgpr_read_b32 v248, a98
  v_accvgpr_read_b32 v249, a99
  v_mul_f32 v248, v248, v247
  v_mul_f32 v249, v249, v247
  v_accvgpr_write_b32 a98, v248
  v_accvgpr_write_b32 a99, v249
  v_accvgpr_read_b32 v248, a100
  v_accvgpr_read_b32 v249, a101
  v_mul_f32 v248, v248, v247
  v_mul_f32 v249, v249, v247
  v_accvgpr_write_b32 a100, v248
  v_accvgpr_write_b32 a101, v249
  v_accvgpr_read_b32 v248, a102
  v_accvgpr_read_b32 v249, a103
  v_mul_f32 v248, v248, v247
  v_mul_f32 v249, v249, v247
  v_accvgpr_write_b32 a102, v248
  v_accvgpr_write_b32 a103, v249
  v_accvgpr_read_b32 v248, a104
  v_accvgpr_read_b32 v249, a105
  v_mul_f32 v248, v248, v247
  v_mul_f32 v249, v249, v247
  v_accvgpr_write_b32 a104, v248
  v_accvgpr_write_b32 a105, v249
  v_accvgpr_read_b32 v248, a106
  v_accvgpr_read_b32 v249, a107
  v_mul_f32 v248, v248, v247
  v_mul_f32 v249, v249, v247
  v_accvgpr_write_b32 a106, v248
  v_accvgpr_write_b32 a107, v249
  v_accvgpr_read_b32 v248, a108
  v_accvgpr_read_b32 v249, a109
  v_mul_f32 v248, v248, v247
  v_mul_f32 v249, v249, v247
  v_accvgpr_write_b32 a108, v248
  v_accvgpr_write_b32 a109, v249
  v_accvgpr_read_b32 v248, a110
  v_accvgpr_read_b32 v249, a111
  v_mul_f32 v248, v248, v247
  v_mul_f32 v249, v249, v247
  v_accvgpr_write_b32 a110, v248
  v_accvgpr_write_b32 a111, v249
  v_accvgpr_read_b32 v248, a112
  v_accvgpr_read_b32 v249, a113
  v_mul_f32 v248, v248, v247
  v_mul_f32 v249, v249, v247
  v_accvgpr_write_b32 a112, v248
  v_accvgpr_write_b32 a113, v249
  v_accvgpr_read_b32 v248, a114
  v_accvgpr_read_b32 v249, a115
  v_mul_f32 v248, v248, v247
  v_mul_f32 v249, v249, v247
  v_accvgpr_write_b32 a114, v248
  v_accvgpr_write_b32 a115, v249
  v_accvgpr_read_b32 v248, a116
  v_accvgpr_read_b32 v249, a117
  v_mul_f32 v248, v248, v247
  v_mul_f32 v249, v249, v247
  v_accvgpr_write_b32 a116, v248
  v_accvgpr_write_b32 a117, v249
  v_accvgpr_read_b32 v248, a118
  v_accvgpr_read_b32 v249, a119
  v_mul_f32 v248, v248, v247
  v_mul_f32 v249, v249, v247
  v_accvgpr_write_b32 a118, v248
  v_accvgpr_write_b32 a119, v249
  v_accvgpr_read_b32 v248, a120
  v_accvgpr_read_b32 v249, a121
  v_mul_f32 v248, v248, v247
  v_mul_f32 v249, v249, v247
  v_accvgpr_write_b32 a120, v248
  v_accvgpr_write_b32 a121, v249
  v_accvgpr_read_b32 v248, a122
  v_accvgpr_read_b32 v249, a123
  v_mul_f32 v248, v248, v247
  v_mul_f32 v249, v249, v247
  v_accvgpr_write_b32 a122, v248
  v_accvgpr_write_b32 a123, v249
  v_accvgpr_read_b32 v248, a124
  v_accvgpr_read_b32 v249, a125
  v_mul_f32 v248, v248, v247
  v_mul_f32 v249, v249, v247
  v_accvgpr_write_b32 a124, v248
  v_accvgpr_write_b32 a125, v249
  v_accvgpr_read_b32 v248, a126
  v_accvgpr_read_b32 v249, a127
  v_mul_f32 v248, v248, v247
  v_mul_f32 v249, v249, v247
  v_accvgpr_write_b32 a126, v248
  v_accvgpr_write_b32 a127, v249
  s_nop 2
  s_branch L_adaL_back_28
L_adaL_fb_29:
  s_nop 15
  v_max3_f32 v240, v32, v33, v34
  v_max3_f32 v240, v240, v35, v36
  v_max3_f32 v240, v240, v37, v38
  v_max_f32 v240, v240, v39
  v_max3_f32 v241, v40, v41, v42
  v_max3_f32 v241, v241, v43, v44
  v_max3_f32 v241, v241, v45, v46
  v_max_f32 v241, v241, v47
  v_mov_b32 v248, v240
  v_mov_b32 v249, v241
  s_nop 1
  v_permlane16_swap_b32 v240, v248
  v_permlane16_swap_b32 v241, v249
  s_nop 1
  v_max_f32 v240, v240, v248
  v_max_f32 v241, v241, v249
  v_mov_b32 v248, v240
  v_mov_b32 v249, v241
  s_nop 1
  v_permlane32_swap_b32 v240, v248
  v_permlane32_swap_b32 v241, v249
  s_nop 1
  v_max_f32 v240, v240, v248
  v_max_f32 v241, v241, v249
  v_max3_f32 v242, v48, v49, v50
  v_max3_f32 v242, v242, v51, v52
  v_max3_f32 v242, v242, v53, v54
  v_max_f32 v242, v242, v55
  v_max3_f32 v243, v56, v57, v58
  v_max3_f32 v243, v243, v59, v60
  v_max3_f32 v243, v243, v61, v62
  v_max_f32 v243, v243, v63
  v_mov_b32 v248, v242
  v_mov_b32 v249, v243
  s_nop 1
  v_permlane16_swap_b32 v242, v248
  v_permlane16_swap_b32 v243, v249
  s_nop 1
  v_max_f32 v242, v242, v248
  v_max_f32 v243, v243, v249
  v_mov_b32 v248, v242
  v_mov_b32 v249, v243
  s_nop 1
  v_permlane32_swap_b32 v242, v248
  v_permlane32_swap_b32 v243, v249
  s_nop 1
  v_max_f32 v242, v242, v248
  v_max_f32 v243, v243, v249
  v_max_f32 v240, 0, v240
  v_max_f32 v241, 0, v241
  v_max_f32 v242, 0, v242
  v_max_f32 v243, 0, v243
  v_exp_f32 v244, -v240
  v_exp_f32 v245, -v241
  v_exp_f32 v246, -v242
  v_exp_f32 v247, -v243
  v_sub_f32 v32, v32, v240
  v_sub_f32 v33, v33, v240
  v_sub_f32 v34, v34, v240
  v_sub_f32 v35, v35, v240
  v_sub_f32 v36, v36, v240
  v_sub_f32 v37, v37, v240
  v_sub_f32 v38, v38, v240
  v_sub_f32 v39, v39, v240
  v_sub_f32 v40, v40, v241
  v_sub_f32 v41, v41, v241
  v_sub_f32 v42, v42, v241
  v_sub_f32 v43, v43, v241
  v_sub_f32 v44, v44, v241
  v_sub_f32 v45, v45, v241
  v_sub_f32 v46, v46, v241
  v_sub_f32 v47, v47, v241
  v_sub_f32 v48, v48, v242
  v_sub_f32 v49, v49, v242
  v_sub_f32 v50, v50, v242
  v_sub_f32 v51, v51, v242
  v_sub_f32 v52, v52, v242
  v_sub_f32 v53, v53, v242
  v_sub_f32 v54, v54, v242
  v_sub_f32 v55, v55, v242
  v_sub_f32 v56, v56, v243
  v_sub_f32 v57, v57, v243
  v_sub_f32 v58, v58, v243
  v_sub_f32 v59, v59, v243
  v_sub_f32 v60, v60, v243
  v_sub_f32 v61, v61, v243
  v_sub_f32 v62, v62, v243
  v_sub_f32 v63, v63, v243
  v_exp_f32 v192, v32
  v_exp_f32 v193, v33
  v_exp_f32 v194, v34
  v_cvt_pk_bf16_f32 v112, v192, v193
  v_exp_f32 v195, v35
  v_exp_f32 v196, v40
  v_cvt_pk_bf16_f32 v113, v194, v195
  v_exp_f32 v197, v41
  v_exp_f32 v198, v42
  v_cvt_pk_bf16_f32 v116, v196, v197
  v_exp_f32 v199, v43
  v_exp_f32 v192, v48
  v_cvt_pk_bf16_f32 v117, v198, v199
  v_exp_f32 v193, v49
  v_exp_f32 v194, v50
  v_cvt_pk_bf16_f32 v120, v192, v193
  v_exp_f32 v195, v51
  v_exp_f32 v196, v56
  v_cvt_pk_bf16_f32 v121, v194, v195
  v_exp_f32 v197, v57
  v_exp_f32 v198, v58
  v_cvt_pk_bf16_f32 v124, v196, v197
  v_exp_f32 v199, v59
  v_exp_f32 v192, v36
  v_cvt_pk_bf16_f32 v125, v198, v199
  v_exp_f32 v193, v37
  v_exp_f32 v194, v38
  v_cvt_pk_bf16_f32 v114, v192, v193
  v_exp_f32 v195, v39
  v_exp_f32 v196, v44
  v_cvt_pk_bf16_f32 v115, v194, v195
  v_exp_f32 v197, v45
  v_exp_f32 v198, v46
  v_cvt_pk_bf16_f32 v118, v196, v197
  v_exp_f32 v199, v47
  v_exp_f32 v192, v52
  v_cvt_pk_bf16_f32 v119, v198, v199
  v_exp_f32 v193, v53
  v_exp_f32 v194, v54
  v_cvt_pk_bf16_f32 v122, v192, v193
  v_exp_f32 v195, v55
  v_exp_f32 v196, v60
  v_cvt_pk_bf16_f32 v123, v194, v195
  v_exp_f32 v197, v61
  v_exp_f32 v198, v62
  v_cvt_pk_bf16_f32 v126, v196, v197
  v_exp_f32 v199, v63
  s_nop 0
  v_cvt_pk_bf16_f32 v127, v198, v199
  s_nop 1
  v_mfma_f32_16x16x32_bf16 v[200:203], v[216:219], v[112:115], 0
  v_mfma_f32_16x16x32_bf16 v[204:207], v[216:219], v[116:119], 0
  v_mfma_f32_16x16x32_bf16 v[208:211], v[216:219], v[120:123], 0
  v_mfma_f32_16x16x32_bf16 v[212:215], v[216:219], v[124:127], 0
  v_sub_f32 v0, v0, v240
  v_sub_f32 v64, v64, v240
  v_sub_f32 v1, v1, v240
  v_sub_f32 v65, v65, v240
  v_sub_f32 v2, v2, v240
  v_sub_f32 v66, v66, v240
  v_sub_f32 v3, v3, v240
  v_sub_f32 v67, v67, v240
  v_sub_f32 v4, v4, v240
  v_sub_f32 v68, v68, v240
  v_sub_f32 v5, v5, v240
  v_sub_f32 v69, v69, v240
  v_sub_f32 v6, v6, v240
  v_sub_f32 v70, v70, v240
  v_sub_f32 v7, v7, v240
  v_sub_f32 v71, v71, v240
  v_sub_f32 v8, v8, v241
  v_sub_f32 v72, v72, v241
  v_sub_f32 v9, v9, v241
  v_sub_f32 v73, v73, v241
  v_sub_f32 v10, v10, v241
  v_sub_f32 v74, v74, v241
  v_sub_f32 v11, v11, v241
  v_sub_f32 v75, v75, v241
  v_sub_f32 v12, v12, v241
  v_sub_f32 v76, v76, v241
  v_sub_f32 v13, v13, v241
  v_sub_f32 v77, v77, v241
  v_sub_f32 v14, v14, v241
  v_sub_f32 v78, v78, v241
  v_sub_f32 v15, v15, v241
  v_sub_f32 v79, v79, v241
  v_sub_f32 v16, v16, v242
  v_sub_f32 v80, v80, v242
  v_sub_f32 v17, v17, v242
  v_sub_f32 v81, v81, v242
  v_sub_f32 v18, v18, v242
  v_sub_f32 v82, v82, v242
  v_sub_f32 v19, v19, v242
  v_sub_f32 v83, v83, v242
  v_sub_f32 v20, v20, v242
  v_sub_f32 v84, v84, v242
  v_sub_f32 v21, v21, v242
  v_sub_f32 v85, v85, v242
  v_sub_f32 v22, v22, v242
  v_sub_f32 v86, v86, v242
  v_sub_f32 v23, v23, v242
  v_sub_f32 v87, v87, v242
  v_sub_f32 v24, v24, v243
  v_sub_f32 v88, v88, v243
  v_sub_f32 v25, v25, v243
  v_sub_f32 v89, v89, v243
  v_sub_f32 v26, v26, v243
  v_sub_f32 v90, v90, v243
  v_sub_f32 v27, v27, v243
  v_sub_f32 v91, v91, v243
  v_sub_f32 v28, v28, v243
  v_sub_f32 v92, v92, v243
  v_sub_f32 v29, v29, v243
  v_sub_f32 v93, v93, v243
  v_sub_f32 v30, v30, v243
  v_sub_f32 v94, v94, v243
  v_sub_f32 v31, v31, v243
  v_sub_f32 v95, v95, v243
  v_exp_f32 v192, v0
  v_exp_f32 v193, v1
  v_exp_f32 v194, v2
  v_cvt_pk_bf16_f32 v96, v192, v193
  v_exp_f32 v195, v3
  v_exp_f32 v196, v8
  v_cvt_pk_bf16_f32 v97, v194, v195
  v_exp_f32 v197, v9
  v_exp_f32 v198, v10
  v_cvt_pk_bf16_f32 v100, v196, v197
  v_exp_f32 v199, v11
  v_exp_f32 v192, v16
  v_cvt_pk_bf16_f32 v101, v198, v199
  v_mul_f32 v220, v220, v244
  v_accvgpr_read_b32 v248, a0
  v_accvgpr_read_b32 v249, a1
  v_mul_f32 v248, v248, v244
  v_mul_f32 v249, v249, v244
  v_accvgpr_write_b32 a0, v248
  v_accvgpr_write_b32 a1, v249
  v_accvgpr_read_b32 v248, a2
  v_accvgpr_read_b32 v249, a3
  v_mul_f32 v248, v248, v244
  v_mul_f32 v249, v249, v244
  v_accvgpr_write_b32 a2, v248
  v_accvgpr_write_b32 a3, v249
  v_accvgpr_read_b32 v248, a4
  v_accvgpr_read_b32 v249, a5
  v_mul_f32 v248, v248, v244
  v_mul_f32 v249, v249, v244
  v_accvgpr_write_b32 a4, v248
  v_accvgpr_write_b32 a5, v249
  v_accvgpr_read_b32 v248, a6
  v_accvgpr_read_b32 v249, a7
  v_mul_f32 v248, v248, v244
  v_mul_f32 v249, v249, v244
  v_accvgpr_write_b32 a6, v248
  v_accvgpr_write_b32 a7, v249
  v_accvgpr_read_b32 v248, a8
  v_accvgpr_read_b32 v249, a9
  v_mul_f32 v248, v248, v244
  v_mul_f32 v249, v249, v244
  v_accvgpr_write_b32 a8, v248
  v_accvgpr_write_b32 a9, v249
  v_accvgpr_read_b32 v248, a10
  v_accvgpr_read_b32 v249, a11
  v_mul_f32 v248, v248, v244
  v_mul_f32 v249, v249, v244
  v_accvgpr_write_b32 a10, v248
  v_accvgpr_write_b32 a11, v249
  v_accvgpr_read_b32 v248, a12
  v_accvgpr_read_b32 v249, a13
  v_mul_f32 v248, v248, v244
  v_mul_f32 v249, v249, v244
  v_accvgpr_write_b32 a12, v248
  v_accvgpr_write_b32 a13, v249
  v_accvgpr_read_b32 v248, a14
  v_accvgpr_read_b32 v249, a15
  v_mul_f32 v248, v248, v244
  v_mul_f32 v249, v249, v244
  v_accvgpr_write_b32 a14, v248
  v_accvgpr_write_b32 a15, v249
  v_accvgpr_read_b32 v248, a16
  v_accvgpr_read_b32 v249, a17
  v_mul_f32 v248, v248, v244
  v_mul_f32 v249, v249, v244
  v_accvgpr_write_b32 a16, v248
  v_accvgpr_write_b32 a17, v249
  v_accvgpr_read_b32 v248, a18
  v_accvgpr_read_b32 v249, a19
  v_mul_f32 v248, v248, v244
  v_mul_f32 v249, v249, v244
  v_accvgpr_write_b32 a18, v248
  v_accvgpr_write_b32 a19, v249
  v_accvgpr_read_b32 v248, a20
  v_accvgpr_read_b32 v249, a21
  v_mul_f32 v248, v248, v244
  v_mul_f32 v249, v249, v244
  v_accvgpr_write_b32 a20, v248
  v_accvgpr_write_b32 a21, v249
  v_accvgpr_read_b32 v248, a22
  v_accvgpr_read_b32 v249, a23
  v_mul_f32 v248, v248, v244
  v_mul_f32 v249, v249, v244
  v_accvgpr_write_b32 a22, v248
  v_accvgpr_write_b32 a23, v249
  v_accvgpr_read_b32 v248, a24
  v_accvgpr_read_b32 v249, a25
  v_mul_f32 v248, v248, v244
  v_mul_f32 v249, v249, v244
  v_accvgpr_write_b32 a24, v248
  v_accvgpr_write_b32 a25, v249
  v_accvgpr_read_b32 v248, a26
  v_accvgpr_read_b32 v249, a27
  v_mul_f32 v248, v248, v244
  v_mul_f32 v249, v249, v244
  v_accvgpr_write_b32 a26, v248
  v_accvgpr_write_b32 a27, v249
  v_accvgpr_read_b32 v248, a28
  v_accvgpr_read_b32 v249, a29
  v_mul_f32 v248, v248, v244
  v_mul_f32 v249, v249, v244
  v_accvgpr_write_b32 a28, v248
  v_accvgpr_write_b32 a29, v249
  v_accvgpr_read_b32 v248, a30
  v_accvgpr_read_b32 v249, a31
  v_mul_f32 v248, v248, v244
  v_mul_f32 v249, v249, v244
  v_accvgpr_write_b32 a30, v248
  v_accvgpr_write_b32 a31, v249
  v_mul_f32 v221, v221, v245
  v_accvgpr_read_b32 v248, a32
  v_accvgpr_read_b32 v249, a33
  v_mul_f32 v248, v248, v245
  v_mul_f32 v249, v249, v245
  v_accvgpr_write_b32 a32, v248
  v_accvgpr_write_b32 a33, v249
  v_accvgpr_read_b32 v248, a34
  v_accvgpr_read_b32 v249, a35
  v_mul_f32 v248, v248, v245
  v_mul_f32 v249, v249, v245
  v_accvgpr_write_b32 a34, v248
  v_accvgpr_write_b32 a35, v249
  v_accvgpr_read_b32 v248, a36
  v_accvgpr_read_b32 v249, a37
  v_mul_f32 v248, v248, v245
  v_mul_f32 v249, v249, v245
  v_accvgpr_write_b32 a36, v248
  v_accvgpr_write_b32 a37, v249
  v_accvgpr_read_b32 v248, a38
  v_accvgpr_read_b32 v249, a39
  v_mul_f32 v248, v248, v245
  v_mul_f32 v249, v249, v245
  v_accvgpr_write_b32 a38, v248
  v_accvgpr_write_b32 a39, v249
  v_accvgpr_read_b32 v248, a40
  v_accvgpr_read_b32 v249, a41
  v_mul_f32 v248, v248, v245
  v_mul_f32 v249, v249, v245
  v_accvgpr_write_b32 a40, v248
  v_accvgpr_write_b32 a41, v249
  v_accvgpr_read_b32 v248, a42
  v_accvgpr_read_b32 v249, a43
  v_mul_f32 v248, v248, v245
  v_mul_f32 v249, v249, v245
  v_accvgpr_write_b32 a42, v248
  v_accvgpr_write_b32 a43, v249
  v_accvgpr_read_b32 v248, a44
  v_accvgpr_read_b32 v249, a45
  v_mul_f32 v248, v248, v245
  v_mul_f32 v249, v249, v245
  v_accvgpr_write_b32 a44, v248
  v_accvgpr_write_b32 a45, v249
  v_accvgpr_read_b32 v248, a46
  v_accvgpr_read_b32 v249, a47
  v_mul_f32 v248, v248, v245
  v_mul_f32 v249, v249, v245
  v_accvgpr_write_b32 a46, v248
  v_accvgpr_write_b32 a47, v249
  v_accvgpr_read_b32 v248, a48
  v_accvgpr_read_b32 v249, a49
  v_mul_f32 v248, v248, v245
  v_mul_f32 v249, v249, v245
  v_accvgpr_write_b32 a48, v248
  v_accvgpr_write_b32 a49, v249
  v_accvgpr_read_b32 v248, a50
  v_accvgpr_read_b32 v249, a51
  v_mul_f32 v248, v248, v245
  v_mul_f32 v249, v249, v245
  v_accvgpr_write_b32 a50, v248
  v_accvgpr_write_b32 a51, v249
  v_accvgpr_read_b32 v248, a52
  v_accvgpr_read_b32 v249, a53
  v_mul_f32 v248, v248, v245
  v_mul_f32 v249, v249, v245
  v_accvgpr_write_b32 a52, v248
  v_accvgpr_write_b32 a53, v249
  v_accvgpr_read_b32 v248, a54
  v_accvgpr_read_b32 v249, a55
  v_mul_f32 v248, v248, v245
  v_mul_f32 v249, v249, v245
  v_accvgpr_write_b32 a54, v248
  v_accvgpr_write_b32 a55, v249
  v_accvgpr_read_b32 v248, a56
  v_accvgpr_read_b32 v249, a57
  v_mul_f32 v248, v248, v245
  v_mul_f32 v249, v249, v245
  v_accvgpr_write_b32 a56, v248
  v_accvgpr_write_b32 a57, v249
  v_accvgpr_read_b32 v248, a58
  v_accvgpr_read_b32 v249, a59
  v_mul_f32 v248, v248, v245
  v_mul_f32 v249, v249, v245
  v_accvgpr_write_b32 a58, v248
  v_accvgpr_write_b32 a59, v249
  v_accvgpr_read_b32 v248, a60
  v_accvgpr_read_b32 v249, a61
  v_mul_f32 v248, v248, v245
  v_mul_f32 v249, v249, v245
  v_accvgpr_write_b32 a60, v248
  v_accvgpr_write_b32 a61, v249
  v_accvgpr_read_b32 v248, a62
  v_accvgpr_read_b32 v249, a63
  v_mul_f32 v248, v248, v245
  v_mul_f32 v249, v249, v245
  v_accvgpr_write_b32 a62, v248
  v_accvgpr_write_b32 a63, v249
  v_mul_f32 v222, v222, v246
  v_accvgpr_read_b32 v248, a64
  v_accvgpr_read_b32 v249, a65
  v_mul_f32 v248, v248, v246
  v_mul_f32 v249, v249, v246
  v_accvgpr_write_b32 a64, v248
  v_accvgpr_write_b32 a65, v249
  v_accvgpr_read_b32 v248, a66
  v_accvgpr_read_b32 v249, a67
  v_mul_f32 v248, v248, v246
  v_mul_f32 v249, v249, v246
  v_accvgpr_write_b32 a66, v248
  v_accvgpr_write_b32 a67, v249
  v_accvgpr_read_b32 v248, a68
  v_accvgpr_read_b32 v249, a69
  v_mul_f32 v248, v248, v246
  v_mul_f32 v249, v249, v246
  v_accvgpr_write_b32 a68, v248
  v_accvgpr_write_b32 a69, v249
  v_accvgpr_read_b32 v248, a70
  v_accvgpr_read_b32 v249, a71
  v_mul_f32 v248, v248, v246
  v_mul_f32 v249, v249, v246
  v_accvgpr_write_b32 a70, v248
  v_accvgpr_write_b32 a71, v249
  v_accvgpr_read_b32 v248, a72
  v_accvgpr_read_b32 v249, a73
  v_mul_f32 v248, v248, v246
  v_mul_f32 v249, v249, v246
  v_accvgpr_write_b32 a72, v248
  v_accvgpr_write_b32 a73, v249
  v_accvgpr_read_b32 v248, a74
  v_accvgpr_read_b32 v249, a75
  v_mul_f32 v248, v248, v246
  v_mul_f32 v249, v249, v246
  v_accvgpr_write_b32 a74, v248
  v_accvgpr_write_b32 a75, v249
  v_accvgpr_read_b32 v248, a76
  v_accvgpr_read_b32 v249, a77
  v_mul_f32 v248, v248, v246
  v_mul_f32 v249, v249, v246
  v_accvgpr_write_b32 a76, v248
  v_accvgpr_write_b32 a77, v249
  v_accvgpr_read_b32 v248, a78
  v_accvgpr_read_b32 v249, a79
  v_mul_f32 v248, v248, v246
  v_mul_f32 v249, v249, v246
  v_accvgpr_write_b32 a78, v248
  v_accvgpr_write_b32 a79, v249
  v_accvgpr_read_b32 v248, a80
  v_accvgpr_read_b32 v249, a81
  v_mul_f32 v248, v248, v246
  v_mul_f32 v249, v249, v246
  v_accvgpr_write_b32 a80, v248
  v_accvgpr_write_b32 a81, v249
  v_accvgpr_read_b32 v248, a82
  v_accvgpr_read_b32 v249, a83
  v_mul_f32 v248, v248, v246
  v_mul_f32 v249, v249, v246
  v_accvgpr_write_b32 a82, v248
  v_accvgpr_write_b32 a83, v249
  v_accvgpr_read_b32 v248, a84
  v_accvgpr_read_b32 v249, a85
  v_mul_f32 v248, v248, v246
  v_mul_f32 v249, v249, v246
  v_accvgpr_write_b32 a84, v248
  v_accvgpr_write_b32 a85, v249
  v_accvgpr_read_b32 v248, a86
  v_accvgpr_read_b32 v249, a87
  v_mul_f32 v248, v248, v246
  v_mul_f32 v249, v249, v246
  v_accvgpr_write_b32 a86, v248
  v_accvgpr_write_b32 a87, v249
  v_accvgpr_read_b32 v248, a88
  v_accvgpr_read_b32 v249, a89
  v_mul_f32 v248, v248, v246
  v_mul_f32 v249, v249, v246
  v_accvgpr_write_b32 a88, v248
  v_accvgpr_write_b32 a89, v249
  v_accvgpr_read_b32 v248, a90
  v_accvgpr_read_b32 v249, a91
  v_mul_f32 v248, v248, v246
  v_mul_f32 v249, v249, v246
  v_accvgpr_write_b32 a90, v248
  v_accvgpr_write_b32 a91, v249
  v_accvgpr_read_b32 v248, a92
  v_accvgpr_read_b32 v249, a93
  v_mul_f32 v248, v248, v246
  v_mul_f32 v249, v249, v246
  v_accvgpr_write_b32 a92, v248
  v_accvgpr_write_b32 a93, v249
  v_accvgpr_read_b32 v248, a94
  v_accvgpr_read_b32 v249, a95
  v_mul_f32 v248, v248, v246
  v_mul_f32 v249, v249, v246
  v_accvgpr_write_b32 a94, v248
  v_accvgpr_write_b32 a95, v249
  v_mul_f32 v223, v223, v247
  v_accvgpr_read_b32 v248, a96
  v_accvgpr_read_b32 v249, a97
  v_mul_f32 v248, v248, v247
  v_mul_f32 v249, v249, v247
  v_accvgpr_write_b32 a96, v248
  v_accvgpr_write_b32 a97, v249
  v_accvgpr_read_b32 v248, a98
  v_accvgpr_read_b32 v249, a99
  v_mul_f32 v248, v248, v247
  v_mul_f32 v249, v249, v247
  v_accvgpr_write_b32 a98, v248
  v_accvgpr_write_b32 a99, v249
  v_accvgpr_read_b32 v248, a100
  v_accvgpr_read_b32 v249, a101
  v_mul_f32 v248, v248, v247
  v_mul_f32 v249, v249, v247
  v_accvgpr_write_b32 a100, v248
  v_accvgpr_write_b32 a101, v249
  v_accvgpr_read_b32 v248, a102
  v_accvgpr_read_b32 v249, a103
  v_mul_f32 v248, v248, v247
  v_mul_f32 v249, v249, v247
  v_accvgpr_write_b32 a102, v248
  v_accvgpr_write_b32 a103, v249
  v_accvgpr_read_b32 v248, a104
  v_accvgpr_read_b32 v249, a105
  v_mul_f32 v248, v248, v247
  v_mul_f32 v249, v249, v247
  v_accvgpr_write_b32 a104, v248
  v_accvgpr_write_b32 a105, v249
  v_accvgpr_read_b32 v248, a106
  v_accvgpr_read_b32 v249, a107
  v_mul_f32 v248, v248, v247
  v_mul_f32 v249, v249, v247
  v_accvgpr_write_b32 a106, v248
  v_accvgpr_write_b32 a107, v249
  v_accvgpr_read_b32 v248, a108
  v_accvgpr_read_b32 v249, a109
  v_mul_f32 v248, v248, v247
  v_mul_f32 v249, v249, v247
  v_accvgpr_write_b32 a108, v248
  v_accvgpr_write_b32 a109, v249
  v_accvgpr_read_b32 v248, a110
  v_accvgpr_read_b32 v249, a111
  v_mul_f32 v248, v248, v247
  v_mul_f32 v249, v249, v247
  v_accvgpr_write_b32 a110, v248
  v_accvgpr_write_b32 a111, v249
  v_accvgpr_read_b32 v248, a112
  v_accvgpr_read_b32 v249, a113
  v_mul_f32 v248, v248, v247
  v_mul_f32 v249, v249, v247
  v_accvgpr_write_b32 a112, v248
  v_accvgpr_write_b32 a113, v249
  v_accvgpr_read_b32 v248, a114
  v_accvgpr_read_b32 v249, a115
  v_mul_f32 v248, v248, v247
  v_mul_f32 v249, v249, v247
  v_accvgpr_write_b32 a114, v248
  v_accvgpr_write_b32 a115, v249
  v_accvgpr_read_b32 v248, a116
  v_accvgpr_read_b32 v249, a117
  v_mul_f32 v248, v248, v247
  v_mul_f32 v249, v249, v247
  v_accvgpr_write_b32 a116, v248
  v_accvgpr_write_b32 a117, v249
  v_accvgpr_read_b32 v248, a118
  v_accvgpr_read_b32 v249, a119
  v_mul_f32 v248, v248, v247
  v_mul_f32 v249, v249, v247
  v_accvgpr_write_b32 a118, v248
  v_accvgpr_write_b32 a119, v249
  v_accvgpr_read_b32 v248, a120
  v_accvgpr_read_b32 v249, a121
  v_mul_f32 v248, v248, v247
  v_mul_f32 v249, v249, v247
  v_accvgpr_write_b32 a120, v248
  v_accvgpr_write_b32 a121, v249
  v_accvgpr_read_b32 v248, a122
  v_accvgpr_read_b32 v249, a123
  v_mul_f32 v248, v248, v247
  v_mul_f32 v249, v249, v247
  v_accvgpr_write_b32 a122, v248
  v_accvgpr_write_b32 a123, v249
  v_accvgpr_read_b32 v248, a124
  v_accvgpr_read_b32 v249, a125
  v_mul_f32 v248, v248, v247
  v_mul_f32 v249, v249, v247
  v_accvgpr_write_b32 a124, v248
  v_accvgpr_write_b32 a125, v249
  v_accvgpr_read_b32 v248, a126
  v_accvgpr_read_b32 v249, a127
  v_mul_f32 v248, v248, v247
  v_mul_f32 v249, v249, v247
  v_accvgpr_write_b32 a126, v248
  v_accvgpr_write_b32 a127, v249
  s_nop 2
  s_branch L_adaL_back_30
L_adaL_fb_39:
  s_nop 15
  v_max3_f32 v240, v32, v33, v34
  v_max3_f32 v240, v240, v35, v36
  v_max3_f32 v240, v240, v37, v38
  v_max_f32 v240, v240, v39
  v_max3_f32 v241, v40, v41, v42
  v_max3_f32 v241, v241, v43, v44
  v_max3_f32 v241, v241, v45, v46
  v_max_f32 v241, v241, v47
  v_mov_b32 v248, v240
  v_mov_b32 v249, v241
  s_nop 1
  v_permlane16_swap_b32 v240, v248
  v_permlane16_swap_b32 v241, v249
  s_nop 1
  v_max_f32 v240, v240, v248
  v_max_f32 v241, v241, v249
  v_mov_b32 v248, v240
  v_mov_b32 v249, v241
  s_nop 1
  v_permlane32_swap_b32 v240, v248
  v_permlane32_swap_b32 v241, v249
  s_nop 1
  v_max_f32 v240, v240, v248
  v_max_f32 v241, v241, v249
  v_max3_f32 v242, v48, v49, v50
  v_max3_f32 v242, v242, v51, v52
  v_max3_f32 v242, v242, v53, v54
  v_max_f32 v242, v242, v55
  v_max3_f32 v243, v56, v57, v58
  v_max3_f32 v243, v243, v59, v60
  v_max3_f32 v243, v243, v61, v62
  v_max_f32 v243, v243, v63
  v_mov_b32 v248, v242
  v_mov_b32 v249, v243
  s_nop 1
  v_permlane16_swap_b32 v242, v248
  v_permlane16_swap_b32 v243, v249
  s_nop 1
  v_max_f32 v242, v242, v248
  v_max_f32 v243, v243, v249
  v_mov_b32 v248, v242
  v_mov_b32 v249, v243
  s_nop 1
  v_permlane32_swap_b32 v242, v248
  v_permlane32_swap_b32 v243, v249
  s_nop 1
  v_max_f32 v242, v242, v248
  v_max_f32 v243, v243, v249
  v_max_f32 v240, 0, v240
  v_max_f32 v241, 0, v241
  v_max_f32 v242, 0, v242
  v_max_f32 v243, 0, v243
  v_exp_f32 v244, -v240
  v_exp_f32 v245, -v241
  v_exp_f32 v246, -v242
  v_exp_f32 v247, -v243
  v_sub_f32 v32, v32, v240
  v_sub_f32 v33, v33, v240
  v_sub_f32 v34, v34, v240
  v_sub_f32 v35, v35, v240
  v_sub_f32 v36, v36, v240
  v_sub_f32 v37, v37, v240
  v_sub_f32 v38, v38, v240
  v_sub_f32 v39, v39, v240
  v_sub_f32 v40, v40, v241
  v_sub_f32 v41, v41, v241
  v_sub_f32 v42, v42, v241
  v_sub_f32 v43, v43, v241
  v_sub_f32 v44, v44, v241
  v_sub_f32 v45, v45, v241
  v_sub_f32 v46, v46, v241
  v_sub_f32 v47, v47, v241
  v_sub_f32 v48, v48, v242
  v_sub_f32 v49, v49, v242
  v_sub_f32 v50, v50, v242
  v_sub_f32 v51, v51, v242
  v_sub_f32 v52, v52, v242
  v_sub_f32 v53, v53, v242
  v_sub_f32 v54, v54, v242
  v_sub_f32 v55, v55, v242
  v_sub_f32 v56, v56, v243
  v_sub_f32 v57, v57, v243
  v_sub_f32 v58, v58, v243
  v_sub_f32 v59, v59, v243
  v_sub_f32 v60, v60, v243
  v_sub_f32 v61, v61, v243
  v_sub_f32 v62, v62, v243
  v_sub_f32 v63, v63, v243
  v_exp_f32 v192, v32
  v_exp_f32 v193, v33
  v_exp_f32 v194, v34
  v_cvt_pk_bf16_f32 v112, v192, v193
  v_exp_f32 v195, v35
  v_exp_f32 v196, v40
  v_cvt_pk_bf16_f32 v113, v194, v195
  v_exp_f32 v197, v41
  v_exp_f32 v198, v42
  v_cvt_pk_bf16_f32 v116, v196, v197
  v_exp_f32 v199, v43
  v_exp_f32 v192, v48
  v_cvt_pk_bf16_f32 v117, v198, v199
  v_exp_f32 v193, v49
  v_exp_f32 v194, v50
  v_cvt_pk_bf16_f32 v120, v192, v193
  v_exp_f32 v195, v51
  v_exp_f32 v196, v56
  v_cvt_pk_bf16_f32 v121, v194, v195
  v_exp_f32 v197, v57
  v_exp_f32 v198, v58
  v_cvt_pk_bf16_f32 v124, v196, v197
  v_exp_f32 v199, v59
  v_exp_f32 v192, v36
  v_cvt_pk_bf16_f32 v125, v198, v199
  v_exp_f32 v193, v37
  v_exp_f32 v194, v38
  v_cvt_pk_bf16_f32 v114, v192, v193
  v_exp_f32 v195, v39
  v_exp_f32 v196, v44
  v_cvt_pk_bf16_f32 v115, v194, v195
  v_exp_f32 v197, v45
  v_exp_f32 v198, v46
  v_cvt_pk_bf16_f32 v118, v196, v197
  v_exp_f32 v199, v47
  v_exp_f32 v192, v52
  v_cvt_pk_bf16_f32 v119, v198, v199
  v_exp_f32 v193, v53
  v_exp_f32 v194, v54
  v_cvt_pk_bf16_f32 v122, v192, v193
  v_exp_f32 v195, v55
  v_exp_f32 v196, v60
  v_cvt_pk_bf16_f32 v123, v194, v195
  v_exp_f32 v197, v61
  v_exp_f32 v198, v62
  v_cvt_pk_bf16_f32 v126, v196, v197
  v_exp_f32 v199, v63
  s_nop 0
  v_cvt_pk_bf16_f32 v127, v198, v199
  s_nop 1
  v_mfma_f32_16x16x32_bf16 v[200:203], v[216:219], v[112:115], 0
  v_mfma_f32_16x16x32_bf16 v[204:207], v[216:219], v[116:119], 0
  v_mfma_f32_16x16x32_bf16 v[208:211], v[216:219], v[120:123], 0
  v_mfma_f32_16x16x32_bf16 v[212:215], v[216:219], v[124:127], 0
  v_sub_f32 v0, v0, v242
  v_sub_f32 v64, v64, v242
  v_sub_f32 v1, v1, v242
  v_sub_f32 v65, v65, v242
  v_sub_f32 v2, v2, v242
  v_sub_f32 v66, v66, v242
  v_sub_f32 v3, v3, v242
  v_sub_f32 v67, v67, v242
  v_sub_f32 v4, v4, v242
  v_sub_f32 v68, v68, v242
  v_sub_f32 v5, v5, v242
  v_sub_f32 v69, v69, v242
  v_sub_f32 v6, v6, v242
  v_sub_f32 v70, v70, v242
  v_sub_f32 v7, v7, v242
  v_sub_f32 v71, v71, v242
  v_sub_f32 v8, v8, v243
  v_sub_f32 v72, v72, v243
  v_sub_f32 v9, v9, v243
  v_sub_f32 v73, v73, v243
  v_sub_f32 v10, v10, v243
  v_sub_f32 v74, v74, v243
  v_sub_f32 v11, v11, v243
  v_sub_f32 v75, v75, v243
  v_sub_f32 v12, v12, v243
  v_sub_f32 v76, v76, v243
  v_sub_f32 v13, v13, v243
  v_sub_f32 v77, v77, v243
  v_sub_f32 v14, v14, v243
  v_sub_f32 v78, v78, v243
  v_sub_f32 v15, v15, v243
  v_sub_f32 v79, v79, v243
  v_sub_f32 v16, v16, v242
  v_sub_f32 v80, v80, v242
  v_sub_f32 v17, v17, v242
  v_sub_f32 v81, v81, v242
  v_sub_f32 v18, v18, v242
  v_sub_f32 v82, v82, v242
  v_sub_f32 v19, v19, v242
  v_sub_f32 v83, v83, v242
  v_sub_f32 v20, v20, v242
  v_sub_f32 v84, v84, v242
  v_sub_f32 v21, v21, v242
  v_sub_f32 v85, v85, v242
  v_sub_f32 v22, v22, v242
  v_sub_f32 v86, v86, v242
  v_sub_f32 v23, v23, v242
  v_sub_f32 v87, v87, v242
  v_sub_f32 v24, v24, v243
  v_sub_f32 v88, v88, v243
  v_sub_f32 v25, v25, v243
  v_sub_f32 v89, v89, v243
  v_sub_f32 v26, v26, v243
  v_sub_f32 v90, v90, v243
  v_sub_f32 v27, v27, v243
  v_sub_f32 v91, v91, v243
  v_sub_f32 v28, v28, v243
  v_sub_f32 v92, v92, v243
  v_sub_f32 v29, v29, v243
  v_sub_f32 v93, v93, v243
  v_sub_f32 v30, v30, v243
  v_sub_f32 v94, v94, v243
  v_sub_f32 v31, v31, v243
  v_sub_f32 v95, v95, v243
  v_exp_f32 v192, v0
  v_exp_f32 v193, v1
  v_exp_f32 v194, v2
  v_cvt_pk_bf16_f32 v96, v192, v193
  v_exp_f32 v195, v3
  v_exp_f32 v196, v8
  v_cvt_pk_bf16_f32 v97, v194, v195
  v_exp_f32 v197, v9
  v_exp_f32 v198, v10
  v_cvt_pk_bf16_f32 v100, v196, v197
  v_exp_f32 v199, v11
  v_exp_f32 v192, v4
  v_cvt_pk_bf16_f32 v101, v198, v199
  v_mul_f32 v220, v220, v244
  v_accvgpr_read_b32 v248, a0
  v_accvgpr_read_b32 v249, a1
  v_mul_f32 v248, v248, v244
  v_mul_f32 v249, v249, v244
  v_accvgpr_write_b32 a0, v248
  v_accvgpr_write_b32 a1, v249
  v_accvgpr_read_b32 v248, a2
  v_accvgpr_read_b32 v249, a3
  v_mul_f32 v248, v248, v244
  v_mul_f32 v249, v249, v244
  v_accvgpr_write_b32 a2, v248
  v_accvgpr_write_b32 a3, v249
  v_accvgpr_read_b32 v248, a4
  v_accvgpr_read_b32 v249, a5
  v_mul_f32 v248, v248, v244
  v_mul_f32 v249, v249, v244
  v_accvgpr_write_b32 a4, v248
  v_accvgpr_write_b32 a5, v249
  v_accvgpr_read_b32 v248, a6
  v_accvgpr_read_b32 v249, a7
  v_mul_f32 v248, v248, v244
  v_mul_f32 v249, v249, v244
  v_accvgpr_write_b32 a6, v248
  v_accvgpr_write_b32 a7, v249
  v_accvgpr_read_b32 v248, a8
  v_accvgpr_read_b32 v249, a9
  v_mul_f32 v248, v248, v244
  v_mul_f32 v249, v249, v244
  v_accvgpr_write_b32 a8, v248
  v_accvgpr_write_b32 a9, v249
  v_accvgpr_read_b32 v248, a10
  v_accvgpr_read_b32 v249, a11
  v_mul_f32 v248, v248, v244
  v_mul_f32 v249, v249, v244
  v_accvgpr_write_b32 a10, v248
  v_accvgpr_write_b32 a11, v249
  v_accvgpr_read_b32 v248, a12
  v_accvgpr_read_b32 v249, a13
  v_mul_f32 v248, v248, v244
  v_mul_f32 v249, v249, v244
  v_accvgpr_write_b32 a12, v248
  v_accvgpr_write_b32 a13, v249
  v_accvgpr_read_b32 v248, a14
  v_accvgpr_read_b32 v249, a15
  v_mul_f32 v248, v248, v244
  v_mul_f32 v249, v249, v244
  v_accvgpr_write_b32 a14, v248
  v_accvgpr_write_b32 a15, v249
  v_accvgpr_read_b32 v248, a16
  v_accvgpr_read_b32 v249, a17
  v_mul_f32 v248, v248, v244
  v_mul_f32 v249, v249, v244
  v_accvgpr_write_b32 a16, v248
  v_accvgpr_write_b32 a17, v249
  v_accvgpr_read_b32 v248, a18
  v_accvgpr_read_b32 v249, a19
  v_mul_f32 v248, v248, v244
  v_mul_f32 v249, v249, v244
  v_accvgpr_write_b32 a18, v248
  v_accvgpr_write_b32 a19, v249
  v_accvgpr_read_b32 v248, a20
  v_accvgpr_read_b32 v249, a21
  v_mul_f32 v248, v248, v244
  v_mul_f32 v249, v249, v244
  v_accvgpr_write_b32 a20, v248
  v_accvgpr_write_b32 a21, v249
  v_accvgpr_read_b32 v248, a22
  v_accvgpr_read_b32 v249, a23
  v_mul_f32 v248, v248, v244
  v_mul_f32 v249, v249, v244
  v_accvgpr_write_b32 a22, v248
  v_accvgpr_write_b32 a23, v249
  v_accvgpr_read_b32 v248, a24
  v_accvgpr_read_b32 v249, a25
  v_mul_f32 v248, v248, v244
  v_mul_f32 v249, v249, v244
  v_accvgpr_write_b32 a24, v248
  v_accvgpr_write_b32 a25, v249
  v_accvgpr_read_b32 v248, a26
  v_accvgpr_read_b32 v249, a27
  v_mul_f32 v248, v248, v244
  v_mul_f32 v249, v249, v244
  v_accvgpr_write_b32 a26, v248
  v_accvgpr_write_b32 a27, v249
  v_accvgpr_read_b32 v248, a28
  v_accvgpr_read_b32 v249, a29
  v_mul_f32 v248, v248, v244
  v_mul_f32 v249, v249, v244
  v_accvgpr_write_b32 a28, v248
  v_accvgpr_write_b32 a29, v249
  v_accvgpr_read_b32 v248, a30
  v_accvgpr_read_b32 v249, a31
  v_mul_f32 v248, v248, v244
  v_mul_f32 v249, v249, v244
  v_accvgpr_write_b32 a30, v248
  v_accvgpr_write_b32 a31, v249
  v_mul_f32 v221, v221, v245
  v_accvgpr_read_b32 v248, a32
  v_accvgpr_read_b32 v249, a33
  v_mul_f32 v248, v248, v245
  v_mul_f32 v249, v249, v245
  v_accvgpr_write_b32 a32, v248
  v_accvgpr_write_b32 a33, v249
  v_accvgpr_read_b32 v248, a34
  v_accvgpr_read_b32 v249, a35
  v_mul_f32 v248, v248, v245
  v_mul_f32 v249, v249, v245
  v_accvgpr_write_b32 a34, v248
  v_accvgpr_write_b32 a35, v249
  v_accvgpr_read_b32 v248, a36
  v_accvgpr_read_b32 v249, a37
  v_mul_f32 v248, v248, v245
  v_mul_f32 v249, v249, v245
  v_accvgpr_write_b32 a36, v248
  v_accvgpr_write_b32 a37, v249
  v_accvgpr_read_b32 v248, a38
  v_accvgpr_read_b32 v249, a39
  v_mul_f32 v248, v248, v245
  v_mul_f32 v249, v249, v245
  v_accvgpr_write_b32 a38, v248
  v_accvgpr_write_b32 a39, v249
  v_accvgpr_read_b32 v248, a40
  v_accvgpr_read_b32 v249, a41
  v_mul_f32 v248, v248, v245
  v_mul_f32 v249, v249, v245
  v_accvgpr_write_b32 a40, v248
  v_accvgpr_write_b32 a41, v249
  v_accvgpr_read_b32 v248, a42
  v_accvgpr_read_b32 v249, a43
  v_mul_f32 v248, v248, v245
  v_mul_f32 v249, v249, v245
  v_accvgpr_write_b32 a42, v248
  v_accvgpr_write_b32 a43, v249
  v_accvgpr_read_b32 v248, a44
  v_accvgpr_read_b32 v249, a45
  v_mul_f32 v248, v248, v245
  v_mul_f32 v249, v249, v245
  v_accvgpr_write_b32 a44, v248
  v_accvgpr_write_b32 a45, v249
  v_accvgpr_read_b32 v248, a46
  v_accvgpr_read_b32 v249, a47
  v_mul_f32 v248, v248, v245
  v_mul_f32 v249, v249, v245
  v_accvgpr_write_b32 a46, v248
  v_accvgpr_write_b32 a47, v249
  v_accvgpr_read_b32 v248, a48
  v_accvgpr_read_b32 v249, a49
  v_mul_f32 v248, v248, v245
  v_mul_f32 v249, v249, v245
  v_accvgpr_write_b32 a48, v248
  v_accvgpr_write_b32 a49, v249
  v_accvgpr_read_b32 v248, a50
  v_accvgpr_read_b32 v249, a51
  v_mul_f32 v248, v248, v245
  v_mul_f32 v249, v249, v245
  v_accvgpr_write_b32 a50, v248
  v_accvgpr_write_b32 a51, v249
  v_accvgpr_read_b32 v248, a52
  v_accvgpr_read_b32 v249, a53
  v_mul_f32 v248, v248, v245
  v_mul_f32 v249, v249, v245
  v_accvgpr_write_b32 a52, v248
  v_accvgpr_write_b32 a53, v249
  v_accvgpr_read_b32 v248, a54
  v_accvgpr_read_b32 v249, a55
  v_mul_f32 v248, v248, v245
  v_mul_f32 v249, v249, v245
  v_accvgpr_write_b32 a54, v248
  v_accvgpr_write_b32 a55, v249
  v_accvgpr_read_b32 v248, a56
  v_accvgpr_read_b32 v249, a57
  v_mul_f32 v248, v248, v245
  v_mul_f32 v249, v249, v245
  v_accvgpr_write_b32 a56, v248
  v_accvgpr_write_b32 a57, v249
  v_accvgpr_read_b32 v248, a58
  v_accvgpr_read_b32 v249, a59
  v_mul_f32 v248, v248, v245
  v_mul_f32 v249, v249, v245
  v_accvgpr_write_b32 a58, v248
  v_accvgpr_write_b32 a59, v249
  v_accvgpr_read_b32 v248, a60
  v_accvgpr_read_b32 v249, a61
  v_mul_f32 v248, v248, v245
  v_mul_f32 v249, v249, v245
  v_accvgpr_write_b32 a60, v248
  v_accvgpr_write_b32 a61, v249
  v_accvgpr_read_b32 v248, a62
  v_accvgpr_read_b32 v249, a63
  v_mul_f32 v248, v248, v245
  v_mul_f32 v249, v249, v245
  v_accvgpr_write_b32 a62, v248
  v_accvgpr_write_b32 a63, v249
  v_mul_f32 v222, v222, v246
  v_accvgpr_read_b32 v248, a64
  v_accvgpr_read_b32 v249, a65
  v_mul_f32 v248, v248, v246
  v_mul_f32 v249, v249, v246
  v_accvgpr_write_b32 a64, v248
  v_accvgpr_write_b32 a65, v249
  v_accvgpr_read_b32 v248, a66
  v_accvgpr_read_b32 v249, a67
  v_mul_f32 v248, v248, v246
  v_mul_f32 v249, v249, v246
  v_accvgpr_write_b32 a66, v248
  v_accvgpr_write_b32 a67, v249
  v_accvgpr_read_b32 v248, a68
  v_accvgpr_read_b32 v249, a69
  v_mul_f32 v248, v248, v246
  v_mul_f32 v249, v249, v246
  v_accvgpr_write_b32 a68, v248
  v_accvgpr_write_b32 a69, v249
  v_accvgpr_read_b32 v248, a70
  v_accvgpr_read_b32 v249, a71
  v_mul_f32 v248, v248, v246
  v_mul_f32 v249, v249, v246
  v_accvgpr_write_b32 a70, v248
  v_accvgpr_write_b32 a71, v249
  v_accvgpr_read_b32 v248, a72
  v_accvgpr_read_b32 v249, a73
  v_mul_f32 v248, v248, v246
  v_mul_f32 v249, v249, v246
  v_accvgpr_write_b32 a72, v248
  v_accvgpr_write_b32 a73, v249
  v_accvgpr_read_b32 v248, a74
  v_accvgpr_read_b32 v249, a75
  v_mul_f32 v248, v248, v246
  v_mul_f32 v249, v249, v246
  v_accvgpr_write_b32 a74, v248
  v_accvgpr_write_b32 a75, v249
  v_accvgpr_read_b32 v248, a76
  v_accvgpr_read_b32 v249, a77
  v_mul_f32 v248, v248, v246
  v_mul_f32 v249, v249, v246
  v_accvgpr_write_b32 a76, v248
  v_accvgpr_write_b32 a77, v249
  v_accvgpr_read_b32 v248, a78
  v_accvgpr_read_b32 v249, a79
  v_mul_f32 v248, v248, v246
  v_mul_f32 v249, v249, v246
  v_accvgpr_write_b32 a78, v248
  v_accvgpr_write_b32 a79, v249
  v_accvgpr_read_b32 v248, a80
  v_accvgpr_read_b32 v249, a81
  v_mul_f32 v248, v248, v246
  v_mul_f32 v249, v249, v246
  v_accvgpr_write_b32 a80, v248
  v_accvgpr_write_b32 a81, v249
  v_accvgpr_read_b32 v248, a82
  v_accvgpr_read_b32 v249, a83
  v_mul_f32 v248, v248, v246
  v_mul_f32 v249, v249, v246
  v_accvgpr_write_b32 a82, v248
  v_accvgpr_write_b32 a83, v249
  v_accvgpr_read_b32 v248, a84
  v_accvgpr_read_b32 v249, a85
  v_mul_f32 v248, v248, v246
  v_mul_f32 v249, v249, v246
  v_accvgpr_write_b32 a84, v248
  v_accvgpr_write_b32 a85, v249
  v_accvgpr_read_b32 v248, a86
  v_accvgpr_read_b32 v249, a87
  v_mul_f32 v248, v248, v246
  v_mul_f32 v249, v249, v246
  v_accvgpr_write_b32 a86, v248
  v_accvgpr_write_b32 a87, v249
  v_accvgpr_read_b32 v248, a88
  v_accvgpr_read_b32 v249, a89
  v_mul_f32 v248, v248, v246
  v_mul_f32 v249, v249, v246
  v_accvgpr_write_b32 a88, v248
  v_accvgpr_write_b32 a89, v249
  v_accvgpr_read_b32 v248, a90
  v_accvgpr_read_b32 v249, a91
  v_mul_f32 v248, v248, v246
  v_mul_f32 v249, v249, v246
  v_accvgpr_write_b32 a90, v248
  v_accvgpr_write_b32 a91, v249
  v_accvgpr_read_b32 v248, a92
  v_accvgpr_read_b32 v249, a93
  v_mul_f32 v248, v248, v246
  v_mul_f32 v249, v249, v246
  v_accvgpr_write_b32 a92, v248
  v_accvgpr_write_b32 a93, v249
  v_accvgpr_read_b32 v248, a94
  v_accvgpr_read_b32 v249, a95
  v_mul_f32 v248, v248, v246
  v_mul_f32 v249, v249, v246
  v_accvgpr_write_b32 a94, v248
  v_accvgpr_write_b32 a95, v249
  v_mul_f32 v223, v223, v247
  v_accvgpr_read_b32 v248, a96
  v_accvgpr_read_b32 v249, a97
  v_mul_f32 v248, v248, v247
  v_mul_f32 v249, v249, v247
  v_accvgpr_write_b32 a96, v248
  v_accvgpr_write_b32 a97, v249
  v_accvgpr_read_b32 v248, a98
  v_accvgpr_read_b32 v249, a99
  v_mul_f32 v248, v248, v247
  v_mul_f32 v249, v249, v247
  v_accvgpr_write_b32 a98, v248
  v_accvgpr_write_b32 a99, v249
  v_accvgpr_read_b32 v248, a100
  v_accvgpr_read_b32 v249, a101
  v_mul_f32 v248, v248, v247
  v_mul_f32 v249, v249, v247
  v_accvgpr_write_b32 a100, v248
  v_accvgpr_write_b32 a101, v249
  v_accvgpr_read_b32 v248, a102
  v_accvgpr_read_b32 v249, a103
  v_mul_f32 v248, v248, v247
  v_mul_f32 v249, v249, v247
  v_accvgpr_write_b32 a102, v248
  v_accvgpr_write_b32 a103, v249
  v_accvgpr_read_b32 v248, a104
  v_accvgpr_read_b32 v249, a105
  v_mul_f32 v248, v248, v247
  v_mul_f32 v249, v249, v247
  v_accvgpr_write_b32 a104, v248
  v_accvgpr_write_b32 a105, v249
  v_accvgpr_read_b32 v248, a106
  v_accvgpr_read_b32 v249, a107
  v_mul_f32 v248, v248, v247
  v_mul_f32 v249, v249, v247
  v_accvgpr_write_b32 a106, v248
  v_accvgpr_write_b32 a107, v249
  v_accvgpr_read_b32 v248, a108
  v_accvgpr_read_b32 v249, a109
  v_mul_f32 v248, v248, v247
  v_mul_f32 v249, v249, v247
  v_accvgpr_write_b32 a108, v248
  v_accvgpr_write_b32 a109, v249
  v_accvgpr_read_b32 v248, a110
  v_accvgpr_read_b32 v249, a111
  v_mul_f32 v248, v248, v247
  v_mul_f32 v249, v249, v247
  v_accvgpr_write_b32 a110, v248
  v_accvgpr_write_b32 a111, v249
  v_accvgpr_read_b32 v248, a112
  v_accvgpr_read_b32 v249, a113
  v_mul_f32 v248, v248, v247
  v_mul_f32 v249, v249, v247
  v_accvgpr_write_b32 a112, v248
  v_accvgpr_write_b32 a113, v249
  v_accvgpr_read_b32 v248, a114
  v_accvgpr_read_b32 v249, a115
  v_mul_f32 v248, v248, v247
  v_mul_f32 v249, v249, v247
  v_accvgpr_write_b32 a114, v248
  v_accvgpr_write_b32 a115, v249
  v_accvgpr_read_b32 v248, a116
  v_accvgpr_read_b32 v249, a117
  v_mul_f32 v248, v248, v247
  v_mul_f32 v249, v249, v247
  v_accvgpr_write_b32 a116, v248
  v_accvgpr_write_b32 a117, v249
  v_accvgpr_read_b32 v248, a118
  v_accvgpr_read_b32 v249, a119
  v_mul_f32 v248, v248, v247
  v_mul_f32 v249, v249, v247
  v_accvgpr_write_b32 a118, v248
  v_accvgpr_write_b32 a119, v249
  v_accvgpr_read_b32 v248, a120
  v_accvgpr_read_b32 v249, a121
  v_mul_f32 v248, v248, v247
  v_mul_f32 v249, v249, v247
  v_accvgpr_write_b32 a120, v248
  v_accvgpr_write_b32 a121, v249
  v_accvgpr_read_b32 v248, a122
  v_accvgpr_read_b32 v249, a123
  v_mul_f32 v248, v248, v247
  v_mul_f32 v249, v249, v247
  v_accvgpr_write_b32 a122, v248
  v_accvgpr_write_b32 a123, v249
  v_accvgpr_read_b32 v248, a124
  v_accvgpr_read_b32 v249, a125
  v_mul_f32 v248, v248, v247
  v_mul_f32 v249, v249, v247
  v_accvgpr_write_b32 a124, v248
  v_accvgpr_write_b32 a125, v249
  v_accvgpr_read_b32 v248, a126
  v_accvgpr_read_b32 v249, a127
  v_mul_f32 v248, v248, v247
  v_mul_f32 v249, v249, v247
  v_accvgpr_write_b32 a126, v248
  v_accvgpr_write_b32 a127, v249
  s_nop 2
  s_branch L_adaL_back_40
L_adaL_fb_44:
  s_nop 15
  v_max3_f32 v240, v0, v1, v2
  v_max3_f32 v240, v240, v3, v4
  v_max3_f32 v240, v240, v5, v6
  v_max_f32 v240, v240, v7
  v_max3_f32 v241, v8, v9, v10
  v_max3_f32 v241, v241, v11, v12
  v_max3_f32 v241, v241, v13, v14
  v_max_f32 v241, v241, v15
  v_mov_b32 v248, v240
  v_mov_b32 v249, v241
  s_nop 1
  v_permlane16_swap_b32 v240, v248
  v_permlane16_swap_b32 v241, v249
  s_nop 1
  v_max_f32 v240, v240, v248
  v_max_f32 v241, v241, v249
  v_mov_b32 v248, v240
  v_mov_b32 v249, v241
  s_nop 1
  v_permlane32_swap_b32 v240, v248
  v_permlane32_swap_b32 v241, v249
  s_nop 1
  v_max_f32 v240, v240, v248
  v_max_f32 v241, v241, v249
  v_max3_f32 v242, v16, v17, v18
  v_max3_f32 v242, v242, v19, v20
  v_max3_f32 v242, v242, v21, v22
  v_max_f32 v242, v242, v23
  v_max3_f32 v243, v24, v25, v26
  v_max3_f32 v243, v243, v27, v28
  v_max3_f32 v243, v243, v29, v30
  v_max_f32 v243, v243, v31
  v_mov_b32 v248, v242
  v_mov_b32 v249, v243
  s_nop 1
  v_permlane16_swap_b32 v242, v248
  v_permlane16_swap_b32 v243, v249
  s_nop 1
  v_max_f32 v242, v242, v248
  v_max_f32 v243, v243, v249
  v_mov_b32 v248, v242
  v_mov_b32 v249, v243
  s_nop 1
  v_permlane32_swap_b32 v242, v248
  v_permlane32_swap_b32 v243, v249
  s_nop 1
  v_max_f32 v242, v242, v248
  v_max_f32 v243, v243, v249
  v_max_f32 v240, 0, v240
  v_max_f32 v241, 0, v241
  v_max_f32 v242, 0, v242
  v_max_f32 v243, 0, v243
  v_max_f32 v240, v240, v242
  v_mov_b32 v242, v240
  v_max_f32 v241, v241, v243
  v_mov_b32 v243, v241
  v_exp_f32 v244, -v240
  v_exp_f32 v245, -v241
  v_exp_f32 v246, -v242
  v_exp_f32 v247, -v243
  v_sub_f32 v0, v0, v240
  v_sub_f32 v1, v1, v240
  v_sub_f32 v2, v2, v240
  v_sub_f32 v3, v3, v240
  v_sub_f32 v4, v4, v240
  v_sub_f32 v5, v5, v240
  v_sub_f32 v6, v6, v240
  v_sub_f32 v7, v7, v240
  v_sub_f32 v8, v8, v241
  v_sub_f32 v9, v9, v241
  v_sub_f32 v10, v10, v241
  v_sub_f32 v11, v11, v241
  v_sub_f32 v12, v12, v241
  v_sub_f32 v13, v13, v241
  v_sub_f32 v14, v14, v241
  v_sub_f32 v15, v15, v241
  v_sub_f32 v16, v16, v242
  v_sub_f32 v17, v17, v242
  v_sub_f32 v18, v18, v242
  v_sub_f32 v19, v19, v242
  v_sub_f32 v20, v20, v242
  v_sub_f32 v21, v21, v242
  v_sub_f32 v22, v22, v242
  v_sub_f32 v23, v23, v242
  v_sub_f32 v24, v24, v243
  v_sub_f32 v25, v25, v243
  v_sub_f32 v26, v26, v243
  v_sub_f32 v27, v27, v243
  v_sub_f32 v28, v28, v243
  v_sub_f32 v29, v29, v243
  v_sub_f32 v30, v30, v243
  v_sub_f32 v31, v31, v243
  v_exp_f32 v192, v0
  v_exp_f32 v193, v1
  v_exp_f32 v194, v2
  v_cvt_pk_bf16_f32 v96, v192, v193
  v_exp_f32 v195, v3
  v_exp_f32 v196, v8
  v_cvt_pk_bf16_f32 v97, v194, v195
  v_exp_f32 v197, v9
  v_exp_f32 v198, v10
  v_cvt_pk_bf16_f32 v100, v196, v197
  v_exp_f32 v199, v11
  v_exp_f32 v192, v4
  v_cvt_pk_bf16_f32 v101, v198, v199
  v_exp_f32 v193, v5
  v_exp_f32 v194, v6
  v_cvt_pk_bf16_f32 v98, v192, v193
  v_exp_f32 v195, v7
  v_exp_f32 v196, v12
  v_cvt_pk_bf16_f32 v99, v194, v195
  v_exp_f32 v197, v13
  v_exp_f32 v198, v14
  v_cvt_pk_bf16_f32 v102, v196, v197
  v_exp_f32 v199, v15
  v_exp_f32 v192, v16
  v_cvt_pk_bf16_f32 v103, v198, v199
  v_exp_f32 v193, v17
  v_exp_f32 v194, v18
  v_cvt_pk_bf16_f32 v104, v192, v193
  v_exp_f32 v195, v19
  v_exp_f32 v196, v24
  v_cvt_pk_bf16_f32 v105, v194, v195
  v_exp_f32 v197, v25
  v_exp_f32 v198, v26
  v_cvt_pk_bf16_f32 v108, v196, v197
  v_exp_f32 v199, v27
  v_exp_f32 v192, v20
  v_cvt_pk_bf16_f32 v109, v198, v199
  v_exp_f32 v193, v21
  v_exp_f32 v194, v22
  v_cvt_pk_bf16_f32 v106, v192, v193
  v_exp_f32 v195, v23
  v_exp_f32 v196, v28
  v_cvt_pk_bf16_f32 v107, v194, v195
  v_exp_f32 v197, v29
  v_exp_f32 v198, v30
  v_cvt_pk_bf16_f32 v110, v196, v197
  v_exp_f32 v199, v31
  s_nop 0
  v_cvt_pk_bf16_f32 v111, v198, v199
  s_nop 1
  v_mfma_f32_16x16x32_bf16 v[208:211], v[216:219], v[96:99], 0
  v_mfma_f32_16x16x32_bf16 v[212:215], v[216:219], v[100:103], 0
  v_mfma_f32_16x16x32_bf16 v[208:211], v[216:219], v[104:107], v[208:211]
  v_mfma_f32_16x16x32_bf16 v[212:215], v[216:219], v[108:111], v[212:215]
  v_sub_f32 v32, v32, v242
  v_sub_f32 v64, v64, v242
  v_sub_f32 v33, v33, v242
  v_sub_f32 v65, v65, v242
  v_sub_f32 v34, v34, v242
  v_sub_f32 v66, v66, v242
  v_sub_f32 v35, v35, v242
  v_sub_f32 v67, v67, v242
  v_sub_f32 v36, v36, v242
  v_sub_f32 v68, v68, v242
  v_sub_f32 v37, v37, v242
  v_sub_f32 v69, v69, v242
  v_sub_f32 v38, v38, v242
  v_sub_f32 v70, v70, v242
  v_sub_f32 v39, v39, v242
  v_sub_f32 v71, v71, v242
  v_sub_f32 v40, v40, v243
  v_sub_f32 v72, v72, v243
  v_sub_f32 v41, v41, v243
  v_sub_f32 v73, v73, v243
  v_sub_f32 v42, v42, v243
  v_sub_f32 v74, v74, v243
  v_sub_f32 v43, v43, v243
  v_sub_f32 v75, v75, v243
  v_sub_f32 v44, v44, v243
  v_sub_f32 v76, v76, v243
  v_sub_f32 v45, v45, v243
  v_sub_f32 v77, v77, v243
  v_sub_f32 v46, v46, v243
  v_sub_f32 v78, v78, v243
  v_sub_f32 v47, v47, v243
  v_sub_f32 v79, v79, v243
  v_sub_f32 v48, v48, v242
  v_sub_f32 v80, v80, v242
  v_sub_f32 v49, v49, v242
  v_sub_f32 v81, v81, v242
  v_sub_f32 v50, v50, v242
  v_sub_f32 v82, v82, v242
  v_sub_f32 v51, v51, v242
  v_sub_f32 v83, v83, v242
  v_sub_f32 v52, v52, v242
  v_sub_f32 v84, v84, v242
  v_sub_f32 v53, v53, v242
  v_sub_f32 v85, v85, v242
  v_sub_f32 v54, v54, v242
  v_sub_f32 v86, v86, v242
  v_sub_f32 v55, v55, v242
  v_sub_f32 v87, v87, v242
  v_sub_f32 v56, v56, v243
  v_sub_f32 v88, v88, v243
  v_sub_f32 v57, v57, v243
  v_sub_f32 v89, v89, v243
  v_sub_f32 v58, v58, v243
  v_sub_f32 v90, v90, v243
  v_sub_f32 v59, v59, v243
  v_sub_f32 v91, v91, v243
  v_sub_f32 v60, v60, v243
  v_sub_f32 v92, v92, v243
  v_sub_f32 v61, v61, v243
  v_sub_f32 v93, v93, v243
  v_sub_f32 v62, v62, v243
  v_sub_f32 v94, v94, v243
  v_sub_f32 v63, v63, v243
  v_sub_f32 v95, v95, v243
  v_exp_f32 v192, v32
  v_exp_f32 v193, v33
  v_exp_f32 v194, v34
  v_cvt_pk_bf16_f32 v112, v192, v193
  v_exp_f32 v195, v35
  v_exp_f32 v196, v40
  v_cvt_pk_bf16_f32 v113, v194, v195
  v_exp_f32 v197, v41
  v_exp_f32 v198, v42
  v_cvt_pk_bf16_f32 v116, v196, v197
  v_exp_f32 v199, v43
  v_exp_f32 v192, v36
  v_cvt_pk_bf16_f32 v117, v198, v199
  v_mul_f32 v222, v222, v246
  v_accvgpr_read_b32 v248, a64
  v_accvgpr_read_b32 v249, a65
  v_mul_f32 v248, v248, v246
  v_mul_f32 v249, v249, v246
  v_accvgpr_write_b32 a64, v248
  v_accvgpr_write_b32 a65, v249
  v_accvgpr_read_b32 v248, a66
  v_accvgpr_read_b32 v249, a67
  v_mul_f32 v248, v248, v246
  v_mul_f32 v249, v249, v246
  v_accvgpr_write_b32 a66, v248
  v_accvgpr_write_b32 a67, v249
  v_accvgpr_read_b32 v248, a68
  v_accvgpr_read_b32 v249, a69
  v_mul_f32 v248, v248, v246
  v_mul_f32 v249, v249, v246
  v_accvgpr_write_b32 a68, v248
  v_accvgpr_write_b32 a69, v249
  v_accvgpr_read_b32 v248, a70
  v_accvgpr_read_b32 v249, a71
  v_mul_f32 v248, v248, v246
  v_mul_f32 v249, v249, v246
  v_accvgpr_write_b32 a70, v248
  v_accvgpr_write_b32 a71, v249
  v_accvgpr_read_b32 v248, a72
  v_accvgpr_read_b32 v249, a73
  v_mul_f32 v248, v248, v246
  v_mul_f32 v249, v249, v246
  v_accvgpr_write_b32 a72, v248
  v_accvgpr_write_b32 a73, v249
  v_accvgpr_read_b32 v248, a74
  v_accvgpr_read_b32 v249, a75
  v_mul_f32 v248, v248, v246
  v_mul_f32 v249, v249, v246
  v_accvgpr_write_b32 a74, v248
  v_accvgpr_write_b32 a75, v249
  v_accvgpr_read_b32 v248, a76
  v_accvgpr_read_b32 v249, a77
  v_mul_f32 v248, v248, v246
  v_mul_f32 v249, v249, v246
  v_accvgpr_write_b32 a76, v248
  v_accvgpr_write_b32 a77, v249
  v_accvgpr_read_b32 v248, a78
  v_accvgpr_read_b32 v249, a79
  v_mul_f32 v248, v248, v246
  v_mul_f32 v249, v249, v246
  v_accvgpr_write_b32 a78, v248
  v_accvgpr_write_b32 a79, v249
  v_accvgpr_read_b32 v248, a80
  v_accvgpr_read_b32 v249, a81
  v_mul_f32 v248, v248, v246
  v_mul_f32 v249, v249, v246
  v_accvgpr_write_b32 a80, v248
  v_accvgpr_write_b32 a81, v249
  v_accvgpr_read_b32 v248, a82
  v_accvgpr_read_b32 v249, a83
  v_mul_f32 v248, v248, v246
  v_mul_f32 v249, v249, v246
  v_accvgpr_write_b32 a82, v248
  v_accvgpr_write_b32 a83, v249
  v_accvgpr_read_b32 v248, a84
  v_accvgpr_read_b32 v249, a85
  v_mul_f32 v248, v248, v246
  v_mul_f32 v249, v249, v246
  v_accvgpr_write_b32 a84, v248
  v_accvgpr_write_b32 a85, v249
  v_accvgpr_read_b32 v248, a86
  v_accvgpr_read_b32 v249, a87
  v_mul_f32 v248, v248, v246
  v_mul_f32 v249, v249, v246
  v_accvgpr_write_b32 a86, v248
  v_accvgpr_write_b32 a87, v249
  v_accvgpr_read_b32 v248, a88
  v_accvgpr_read_b32 v249, a89
  v_mul_f32 v248, v248, v246
  v_mul_f32 v249, v249, v246
  v_accvgpr_write_b32 a88, v248
  v_accvgpr_write_b32 a89, v249
  v_accvgpr_read_b32 v248, a90
  v_accvgpr_read_b32 v249, a91
  v_mul_f32 v248, v248, v246
  v_mul_f32 v249, v249, v246
  v_accvgpr_write_b32 a90, v248
  v_accvgpr_write_b32 a91, v249
  v_accvgpr_read_b32 v248, a92
  v_accvgpr_read_b32 v249, a93
  v_mul_f32 v248, v248, v246
  v_mul_f32 v249, v249, v246
  v_accvgpr_write_b32 a92, v248
  v_accvgpr_write_b32 a93, v249
  v_accvgpr_read_b32 v248, a94
  v_accvgpr_read_b32 v249, a95
  v_mul_f32 v248, v248, v246
  v_mul_f32 v249, v249, v246
  v_accvgpr_write_b32 a94, v248
  v_accvgpr_write_b32 a95, v249
  v_mul_f32 v223, v223, v247
  v_accvgpr_read_b32 v248, a96
  v_accvgpr_read_b32 v249, a97
  v_mul_f32 v248, v248, v247
  v_mul_f32 v249, v249, v247
  v_accvgpr_write_b32 a96, v248
  v_accvgpr_write_b32 a97, v249
  v_accvgpr_read_b32 v248, a98
  v_accvgpr_read_b32 v249, a99
  v_mul_f32 v248, v248, v247
  v_mul_f32 v249, v249, v247
  v_accvgpr_write_b32 a98, v248
  v_accvgpr_write_b32 a99, v249
  v_accvgpr_read_b32 v248, a100
  v_accvgpr_read_b32 v249, a101
  v_mul_f32 v248, v248, v247
  v_mul_f32 v249, v249, v247
  v_accvgpr_write_b32 a100, v248
  v_accvgpr_write_b32 a101, v249
  v_accvgpr_read_b32 v248, a102
  v_accvgpr_read_b32 v249, a103
  v_mul_f32 v248, v248, v247
  v_mul_f32 v249, v249, v247
  v_accvgpr_write_b32 a102, v248
  v_accvgpr_write_b32 a103, v249
  v_accvgpr_read_b32 v248, a104
  v_accvgpr_read_b32 v249, a105
  v_mul_f32 v248, v248, v247
  v_mul_f32 v249, v249, v247
  v_accvgpr_write_b32 a104, v248
  v_accvgpr_write_b32 a105, v249
  v_accvgpr_read_b32 v248, a106
  v_accvgpr_read_b32 v249, a107
  v_mul_f32 v248, v248, v247
  v_mul_f32 v249, v249, v247
  v_accvgpr_write_b32 a106, v248
  v_accvgpr_write_b32 a107, v249
  v_accvgpr_read_b32 v248, a108
  v_accvgpr_read_b32 v249, a109
  v_mul_f32 v248, v248, v247
  v_mul_f32 v249, v249, v247
  v_accvgpr_write_b32 a108, v248
  v_accvgpr_write_b32 a109, v249
  v_accvgpr_read_b32 v248, a110
  v_accvgpr_read_b32 v249, a111
  v_mul_f32 v248, v248, v247
  v_mul_f32 v249, v249, v247
  v_accvgpr_write_b32 a110, v248
  v_accvgpr_write_b32 a111, v249
  v_accvgpr_read_b32 v248, a112
  v_accvgpr_read_b32 v249, a113
  v_mul_f32 v248, v248, v247
  v_mul_f32 v249, v249, v247
  v_accvgpr_write_b32 a112, v248
  v_accvgpr_write_b32 a113, v249
  v_accvgpr_read_b32 v248, a114
  v_accvgpr_read_b32 v249, a115
  v_mul_f32 v248, v248, v247
  v_mul_f32 v249, v249, v247
  v_accvgpr_write_b32 a114, v248
  v_accvgpr_write_b32 a115, v249
  v_accvgpr_read_b32 v248, a116
  v_accvgpr_read_b32 v249, a117
  v_mul_f32 v248, v248, v247
  v_mul_f32 v249, v249, v247
  v_accvgpr_write_b32 a116, v248
  v_accvgpr_write_b32 a117, v249
  v_accvgpr_read_b32 v248, a118
  v_accvgpr_read_b32 v249, a119
  v_mul_f32 v248, v248, v247
  v_mul_f32 v249, v249, v247
  v_accvgpr_write_b32 a118, v248
  v_accvgpr_write_b32 a119, v249
  v_accvgpr_read_b32 v248, a120
  v_accvgpr_read_b32 v249, a121
  v_mul_f32 v248, v248, v247
  v_mul_f32 v249, v249, v247
  v_accvgpr_write_b32 a120, v248
  v_accvgpr_write_b32 a121, v249
  v_accvgpr_read_b32 v248, a122
  v_accvgpr_read_b32 v249, a123
  v_mul_f32 v248, v248, v247
  v_mul_f32 v249, v249, v247
  v_accvgpr_write_b32 a122, v248
  v_accvgpr_write_b32 a123, v249
  v_accvgpr_read_b32 v248, a124
  v_accvgpr_read_b32 v249, a125
  v_mul_f32 v248, v248, v247
  v_mul_f32 v249, v249, v247
  v_accvgpr_write_b32 a124, v248
  v_accvgpr_write_b32 a125, v249
  v_accvgpr_read_b32 v248, a126
  v_accvgpr_read_b32 v249, a127
  v_mul_f32 v248, v248, v247
  v_mul_f32 v249, v249, v247
  v_accvgpr_write_b32 a126, v248
  v_accvgpr_write_b32 a127, v249
  s_nop 2
  s_branch L_adaL_back_45
L_adaL_fb_46:
  s_nop 15
  v_max3_f32 v240, v32, v33, v34
  v_max3_f32 v240, v240, v35, v36
  v_max3_f32 v240, v240, v37, v38
  v_max_f32 v240, v240, v39
  v_max3_f32 v241, v40, v41, v42
  v_max3_f32 v241, v241, v43, v44
  v_max3_f32 v241, v241, v45, v46
  v_max_f32 v241, v241, v47
  v_mov_b32 v248, v240
  v_mov_b32 v249, v241
  s_nop 1
  v_permlane16_swap_b32 v240, v248
  v_permlane16_swap_b32 v241, v249
  s_nop 1
  v_max_f32 v240, v240, v248
  v_max_f32 v241, v241, v249
  v_mov_b32 v248, v240
  v_mov_b32 v249, v241
  s_nop 1
  v_permlane32_swap_b32 v240, v248
  v_permlane32_swap_b32 v241, v249
  s_nop 1
  v_max_f32 v240, v240, v248
  v_max_f32 v241, v241, v249
  v_max3_f32 v242, v48, v49, v50
  v_max3_f32 v242, v242, v51, v52
  v_max3_f32 v242, v242, v53, v54
  v_max_f32 v242, v242, v55
  v_max3_f32 v243, v56, v57, v58
  v_max3_f32 v243, v243, v59, v60
  v_max3_f32 v243, v243, v61, v62
  v_max_f32 v243, v243, v63
  v_mov_b32 v248, v242
  v_mov_b32 v249, v243
  s_nop 1
  v_permlane16_swap_b32 v242, v248
  v_permlane16_swap_b32 v243, v249
  s_nop 1
  v_max_f32 v242, v242, v248
  v_max_f32 v243, v243, v249
  v_mov_b32 v248, v242
  v_mov_b32 v249, v243
  s_nop 1
  v_permlane32_swap_b32 v242, v248
  v_permlane32_swap_b32 v243, v249
  s_nop 1
  v_max_f32 v242, v242, v248
  v_max_f32 v243, v243, v249
  v_max_f32 v240, 0, v240
  v_max_f32 v241, 0, v241
  v_max_f32 v242, 0, v242
  v_max_f32 v243, 0, v243
  v_max_f32 v240, v240, v242
  v_mov_b32 v242, v240
  v_max_f32 v241, v241, v243
  v_mov_b32 v243, v241
  v_exp_f32 v244, -v240
  v_exp_f32 v245, -v241
  v_exp_f32 v246, -v242
  v_exp_f32 v247, -v243
  v_sub_f32 v32, v32, v240
  v_sub_f32 v33, v33, v240
  v_sub_f32 v34, v34, v240
  v_sub_f32 v35, v35, v240
  v_sub_f32 v36, v36, v240
  v_sub_f32 v37, v37, v240
  v_sub_f32 v38, v38, v240
  v_sub_f32 v39, v39, v240
  v_sub_f32 v40, v40, v241
  v_sub_f32 v41, v41, v241
  v_sub_f32 v42, v42, v241
  v_sub_f32 v43, v43, v241
  v_sub_f32 v44, v44, v241
  v_sub_f32 v45, v45, v241
  v_sub_f32 v46, v46, v241
  v_sub_f32 v47, v47, v241
  v_sub_f32 v48, v48, v242
  v_sub_f32 v49, v49, v242
  v_sub_f32 v50, v50, v242
  v_sub_f32 v51, v51, v242
  v_sub_f32 v52, v52, v242
  v_sub_f32 v53, v53, v242
  v_sub_f32 v54, v54, v242
  v_sub_f32 v55, v55, v242
  v_sub_f32 v56, v56, v243
  v_sub_f32 v57, v57, v243
  v_sub_f32 v58, v58, v243
  v_sub_f32 v59, v59, v243
  v_sub_f32 v60, v60, v243
  v_sub_f32 v61, v61, v243
  v_sub_f32 v62, v62, v243
  v_sub_f32 v63, v63, v243
  v_exp_f32 v192, v32
  v_exp_f32 v193, v33
  v_exp_f32 v194, v34
  v_cvt_pk_bf16_f32 v112, v192, v193
  v_exp_f32 v195, v35
  v_exp_f32 v196, v40
  v_cvt_pk_bf16_f32 v113, v194, v195
  v_exp_f32 v197, v41
  v_exp_f32 v198, v42
  v_cvt_pk_bf16_f32 v116, v196, v197
  v_exp_f32 v199, v43
  v_exp_f32 v192, v36
  v_cvt_pk_bf16_f32 v117, v198, v199
  v_exp_f32 v193, v37
  v_exp_f32 v194, v38
  v_cvt_pk_bf16_f32 v114, v192, v193
  v_exp_f32 v195, v39
  v_exp_f32 v196, v44
  v_cvt_pk_bf16_f32 v115, v194, v195
  v_exp_f32 v197, v45
  v_exp_f32 v198, v46
  v_cvt_pk_bf16_f32 v118, v196, v197
  v_exp_f32 v199, v47
  v_exp_f32 v192, v48
  v_cvt_pk_bf16_f32 v119, v198, v199
  v_exp_f32 v193, v49
  v_exp_f32 v194, v50
  v_cvt_pk_bf16_f32 v120, v192, v193
  v_exp_f32 v195, v51
  v_exp_f32 v196, v56
  v_cvt_pk_bf16_f32 v121, v194, v195
  v_exp_f32 v197, v57
  v_exp_f32 v198, v58
  v_cvt_pk_bf16_f32 v124, v196, v197
  v_exp_f32 v199, v59
  v_exp_f32 v192, v52
  v_cvt_pk_bf16_f32 v125, v198, v199
  v_exp_f32 v193, v53
  v_exp_f32 v194, v54
  v_cvt_pk_bf16_f32 v122, v192, v193
  v_exp_f32 v195, v55
  v_exp_f32 v196, v60
  v_cvt_pk_bf16_f32 v123, v194, v195
  v_exp_f32 v197, v61
  v_exp_f32 v198, v62
  v_cvt_pk_bf16_f32 v126, v196, v197
  v_exp_f32 v199, v63
  s_nop 0
  v_cvt_pk_bf16_f32 v127, v198, v199
  s_nop 1
  v_mfma_f32_16x16x32_bf16 v[208:211], v[216:219], v[112:115], 0
  v_mfma_f32_16x16x32_bf16 v[212:215], v[216:219], v[116:119], 0
  v_mfma_f32_16x16x32_bf16 v[208:211], v[216:219], v[120:123], v[208:211]
  v_mfma_f32_16x16x32_bf16 v[212:215], v[216:219], v[124:127], v[212:215]
  v_sub_f32 v0, v0, v242
  v_sub_f32 v64, v64, v242
  v_sub_f32 v1, v1, v242
  v_sub_f32 v65, v65, v242
  v_sub_f32 v2, v2, v242
  v_sub_f32 v66, v66, v242
  v_sub_f32 v3, v3, v242
  v_sub_f32 v67, v67, v242
  v_sub_f32 v4, v4, v242
  v_sub_f32 v68, v68, v242
  v_sub_f32 v5, v5, v242
  v_sub_f32 v69, v69, v242
  v_sub_f32 v6, v6, v242
  v_sub_f32 v70, v70, v242
  v_sub_f32 v7, v7, v242
  v_sub_f32 v71, v71, v242
  v_sub_f32 v8, v8, v243
  v_sub_f32 v72, v72, v243
  v_sub_f32 v9, v9, v243
  v_sub_f32 v73, v73, v243
  v_sub_f32 v10, v10, v243
  v_sub_f32 v74, v74, v243
  v_sub_f32 v11, v11, v243
  v_sub_f32 v75, v75, v243
  v_sub_f32 v12, v12, v243
  v_sub_f32 v76, v76, v243
  v_sub_f32 v13, v13, v243
  v_sub_f32 v77, v77, v243
  v_sub_f32 v14, v14, v243
  v_sub_f32 v78, v78, v243
  v_sub_f32 v15, v15, v243
  v_sub_f32 v79, v79, v243
  v_sub_f32 v16, v16, v242
  v_sub_f32 v80, v80, v242
  v_sub_f32 v17, v17, v242
  v_sub_f32 v81, v81, v242
  v_sub_f32 v18, v18, v242
  v_sub_f32 v82, v82, v242
  v_sub_f32 v19, v19, v242
  v_sub_f32 v83, v83, v242
  v_sub_f32 v20, v20, v242
  v_sub_f32 v84, v84, v242
  v_sub_f32 v21, v21, v242
  v_sub_f32 v85, v85, v242
  v_sub_f32 v22, v22, v242
  v_sub_f32 v86, v86, v242
  v_sub_f32 v23, v23, v242
  v_sub_f32 v87, v87, v242
  v_sub_f32 v24, v24, v243
  v_sub_f32 v88, v88, v243
  v_sub_f32 v25, v25, v243
  v_sub_f32 v89, v89, v243
  v_sub_f32 v26, v26, v243
  v_sub_f32 v90, v90, v243
  v_sub_f32 v27, v27, v243
  v_sub_f32 v91, v91, v243
  v_sub_f32 v28, v28, v243
  v_sub_f32 v92, v92, v243
  v_sub_f32 v29, v29, v243
  v_sub_f32 v93, v93, v243
  v_sub_f32 v30, v30, v243
  v_sub_f32 v94, v94, v243
  v_sub_f32 v31, v31, v243
  v_sub_f32 v95, v95, v243
  v_exp_f32 v192, v0
  v_exp_f32 v193, v1
  v_exp_f32 v194, v2
  v_cvt_pk_bf16_f32 v96, v192, v193
  v_exp_f32 v195, v3
  v_exp_f32 v196, v8
  v_cvt_pk_bf16_f32 v97, v194, v195
  v_exp_f32 v197, v9
  v_exp_f32 v198, v10
  v_cvt_pk_bf16_f32 v100, v196, v197
  v_exp_f32 v199, v11
  v_exp_f32 v192, v4
  v_cvt_pk_bf16_f32 v101, v198, v199
  v_mul_f32 v222, v222, v246
  v_accvgpr_read_b32 v248, a64
  v_accvgpr_read_b32 v249, a65
  v_mul_f32 v248, v248, v246
  v_mul_f32 v249, v249, v246
  v_accvgpr_write_b32 a64, v248
  v_accvgpr_write_b32 a65, v249
  v_accvgpr_read_b32 v248, a66
  v_accvgpr_read_b32 v249, a67
  v_mul_f32 v248, v248, v246
  v_mul_f32 v249, v249, v246
  v_accvgpr_write_b32 a66, v248
  v_accvgpr_write_b32 a67, v249
  v_accvgpr_read_b32 v248, a68
  v_accvgpr_read_b32 v249, a69
  v_mul_f32 v248, v248, v246
  v_mul_f32 v249, v249, v246
  v_accvgpr_write_b32 a68, v248
  v_accvgpr_write_b32 a69, v249
  v_accvgpr_read_b32 v248, a70
  v_accvgpr_read_b32 v249, a71
  v_mul_f32 v248, v248, v246
  v_mul_f32 v249, v249, v246
  v_accvgpr_write_b32 a70, v248
  v_accvgpr_write_b32 a71, v249
  v_accvgpr_read_b32 v248, a72
  v_accvgpr_read_b32 v249, a73
  v_mul_f32 v248, v248, v246
  v_mul_f32 v249, v249, v246
  v_accvgpr_write_b32 a72, v248
  v_accvgpr_write_b32 a73, v249
  v_accvgpr_read_b32 v248, a74
  v_accvgpr_read_b32 v249, a75
  v_mul_f32 v248, v248, v246
  v_mul_f32 v249, v249, v246
  v_accvgpr_write_b32 a74, v248
  v_accvgpr_write_b32 a75, v249
  v_accvgpr_read_b32 v248, a76
  v_accvgpr_read_b32 v249, a77
  v_mul_f32 v248, v248, v246
  v_mul_f32 v249, v249, v246
  v_accvgpr_write_b32 a76, v248
  v_accvgpr_write_b32 a77, v249
  v_accvgpr_read_b32 v248, a78
  v_accvgpr_read_b32 v249, a79
  v_mul_f32 v248, v248, v246
  v_mul_f32 v249, v249, v246
  v_accvgpr_write_b32 a78, v248
  v_accvgpr_write_b32 a79, v249
  v_accvgpr_read_b32 v248, a80
  v_accvgpr_read_b32 v249, a81
  v_mul_f32 v248, v248, v246
  v_mul_f32 v249, v249, v246
  v_accvgpr_write_b32 a80, v248
  v_accvgpr_write_b32 a81, v249
  v_accvgpr_read_b32 v248, a82
  v_accvgpr_read_b32 v249, a83
  v_mul_f32 v248, v248, v246
  v_mul_f32 v249, v249, v246
  v_accvgpr_write_b32 a82, v248
  v_accvgpr_write_b32 a83, v249
  v_accvgpr_read_b32 v248, a84
  v_accvgpr_read_b32 v249, a85
  v_mul_f32 v248, v248, v246
  v_mul_f32 v249, v249, v246
  v_accvgpr_write_b32 a84, v248
  v_accvgpr_write_b32 a85, v249
  v_accvgpr_read_b32 v248, a86
  v_accvgpr_read_b32 v249, a87
  v_mul_f32 v248, v248, v246
  v_mul_f32 v249, v249, v246
  v_accvgpr_write_b32 a86, v248
  v_accvgpr_write_b32 a87, v249
  v_accvgpr_read_b32 v248, a88
  v_accvgpr_read_b32 v249, a89
  v_mul_f32 v248, v248, v246
  v_mul_f32 v249, v249, v246
  v_accvgpr_write_b32 a88, v248
  v_accvgpr_write_b32 a89, v249
  v_accvgpr_read_b32 v248, a90
  v_accvgpr_read_b32 v249, a91
  v_mul_f32 v248, v248, v246
  v_mul_f32 v249, v249, v246
  v_accvgpr_write_b32 a90, v248
  v_accvgpr_write_b32 a91, v249
  v_accvgpr_read_b32 v248, a92
  v_accvgpr_read_b32 v249, a93
  v_mul_f32 v248, v248, v246
  v_mul_f32 v249, v249, v246
  v_accvgpr_write_b32 a92, v248
  v_accvgpr_write_b32 a93, v249
  v_accvgpr_read_b32 v248, a94
  v_accvgpr_read_b32 v249, a95
  v_mul_f32 v248, v248, v246
  v_mul_f32 v249, v249, v246
  v_accvgpr_write_b32 a94, v248
  v_accvgpr_write_b32 a95, v249
  v_mul_f32 v223, v223, v247
  v_accvgpr_read_b32 v248, a96
  v_accvgpr_read_b32 v249, a97
  v_mul_f32 v248, v248, v247
  v_mul_f32 v249, v249, v247
  v_accvgpr_write_b32 a96, v248
  v_accvgpr_write_b32 a97, v249
  v_accvgpr_read_b32 v248, a98
  v_accvgpr_read_b32 v249, a99
  v_mul_f32 v248, v248, v247
  v_mul_f32 v249, v249, v247
  v_accvgpr_write_b32 a98, v248
  v_accvgpr_write_b32 a99, v249
  v_accvgpr_read_b32 v248, a100
  v_accvgpr_read_b32 v249, a101
  v_mul_f32 v248, v248, v247
  v_mul_f32 v249, v249, v247
  v_accvgpr_write_b32 a100, v248
  v_accvgpr_write_b32 a101, v249
  v_accvgpr_read_b32 v248, a102
  v_accvgpr_read_b32 v249, a103
  v_mul_f32 v248, v248, v247
  v_mul_f32 v249, v249, v247
  v_accvgpr_write_b32 a102, v248
  v_accvgpr_write_b32 a103, v249
  v_accvgpr_read_b32 v248, a104
  v_accvgpr_read_b32 v249, a105
  v_mul_f32 v248, v248, v247
  v_mul_f32 v249, v249, v247
  v_accvgpr_write_b32 a104, v248
  v_accvgpr_write_b32 a105, v249
  v_accvgpr_read_b32 v248, a106
  v_accvgpr_read_b32 v249, a107
  v_mul_f32 v248, v248, v247
  v_mul_f32 v249, v249, v247
  v_accvgpr_write_b32 a106, v248
  v_accvgpr_write_b32 a107, v249
  v_accvgpr_read_b32 v248, a108
  v_accvgpr_read_b32 v249, a109
  v_mul_f32 v248, v248, v247
  v_mul_f32 v249, v249, v247
  v_accvgpr_write_b32 a108, v248
  v_accvgpr_write_b32 a109, v249
  v_accvgpr_read_b32 v248, a110
  v_accvgpr_read_b32 v249, a111
  v_mul_f32 v248, v248, v247
  v_mul_f32 v249, v249, v247
  v_accvgpr_write_b32 a110, v248
  v_accvgpr_write_b32 a111, v249
  v_accvgpr_read_b32 v248, a112
  v_accvgpr_read_b32 v249, a113
  v_mul_f32 v248, v248, v247
  v_mul_f32 v249, v249, v247
  v_accvgpr_write_b32 a112, v248
  v_accvgpr_write_b32 a113, v249
  v_accvgpr_read_b32 v248, a114
  v_accvgpr_read_b32 v249, a115
  v_mul_f32 v248, v248, v247
  v_mul_f32 v249, v249, v247
  v_accvgpr_write_b32 a114, v248
  v_accvgpr_write_b32 a115, v249
  v_accvgpr_read_b32 v248, a116
  v_accvgpr_read_b32 v249, a117
  v_mul_f32 v248, v248, v247
  v_mul_f32 v249, v249, v247
  v_accvgpr_write_b32 a116, v248
  v_accvgpr_write_b32 a117, v249
  v_accvgpr_read_b32 v248, a118
  v_accvgpr_read_b32 v249, a119
  v_mul_f32 v248, v248, v247
  v_mul_f32 v249, v249, v247
  v_accvgpr_write_b32 a118, v248
  v_accvgpr_write_b32 a119, v249
  v_accvgpr_read_b32 v248, a120
  v_accvgpr_read_b32 v249, a121
  v_mul_f32 v248, v248, v247
  v_mul_f32 v249, v249, v247
  v_accvgpr_write_b32 a120, v248
  v_accvgpr_write_b32 a121, v249
  v_accvgpr_read_b32 v248, a122
  v_accvgpr_read_b32 v249, a123
  v_mul_f32 v248, v248, v247
  v_mul_f32 v249, v249, v247
  v_accvgpr_write_b32 a122, v248
  v_accvgpr_write_b32 a123, v249
  v_accvgpr_read_b32 v248, a124
  v_accvgpr_read_b32 v249, a125
  v_mul_f32 v248, v248, v247
  v_mul_f32 v249, v249, v247
  v_accvgpr_write_b32 a124, v248
  v_accvgpr_write_b32 a125, v249
  v_accvgpr_read_b32 v248, a126
  v_accvgpr_read_b32 v249, a127
  v_mul_f32 v248, v248, v247
  v_mul_f32 v249, v249, v247
  v_accvgpr_write_b32 a126, v248
  v_accvgpr_write_b32 a127, v249
  s_nop 2
  s_branch L_adaL_back_47
L_adaL_fb_54:
  s_nop 15
  v_max3_f32 v240, v32, v33, v34
  v_max3_f32 v240, v240, v35, v36
  v_max3_f32 v240, v240, v37, v38
  v_max_f32 v240, v240, v39
  v_max3_f32 v241, v40, v41, v42
  v_max3_f32 v241, v241, v43, v44
  v_max3_f32 v241, v241, v45, v46
  v_max_f32 v241, v241, v47
  v_mov_b32 v248, v240
  v_mov_b32 v249, v241
  s_nop 1
  v_permlane16_swap_b32 v240, v248
  v_permlane16_swap_b32 v241, v249
  s_nop 1
  v_max_f32 v240, v240, v248
  v_max_f32 v241, v241, v249
  v_mov_b32 v248, v240
  v_mov_b32 v249, v241
  s_nop 1
  v_permlane32_swap_b32 v240, v248
  v_permlane32_swap_b32 v241, v249
  s_nop 1
  v_max_f32 v240, v240, v248
  v_max_f32 v241, v241, v249
  v_max3_f32 v242, v48, v49, v50
  v_max3_f32 v242, v242, v51, v52
  v_max3_f32 v242, v242, v53, v54
  v_max_f32 v242, v242, v55
  v_max3_f32 v243, v56, v57, v58
  v_max3_f32 v243, v243, v59, v60
  v_max3_f32 v243, v243, v61, v62
  v_max_f32 v243, v243, v63
  v_mov_b32 v248, v242
  v_mov_b32 v249, v243
  s_nop 1
  v_permlane16_swap_b32 v242, v248
  v_permlane16_swap_b32 v243, v249
  s_nop 1
  v_max_f32 v242, v242, v248
  v_max_f32 v243, v243, v249
  v_mov_b32 v248, v242
  v_mov_b32 v249, v243
  s_nop 1
  v_permlane32_swap_b32 v242, v248
  v_permlane32_swap_b32 v243, v249
  s_nop 1
  v_max_f32 v242, v242, v248
  v_max_f32 v243, v243, v249
  v_max_f32 v240, 0, v240
  v_max_f32 v241, 0, v241
  v_max_f32 v242, 0, v242
  v_max_f32 v243, 0, v243
  v_max_f32 v240, v240, v242
  v_mov_b32 v242, v240
  v_max_f32 v241, v241, v243
  v_mov_b32 v243, v241
  v_exp_f32 v244, -v240
  v_exp_f32 v245, -v241
  v_exp_f32 v246, -v242
  v_exp_f32 v247, -v243
  v_sub_f32 v32, v32, v240
  v_sub_f32 v33, v33, v240
  v_sub_f32 v34, v34, v240
  v_sub_f32 v35, v35, v240
  v_sub_f32 v36, v36, v240
  v_sub_f32 v37, v37, v240
  v_sub_f32 v38, v38, v240
  v_sub_f32 v39, v39, v240
  v_sub_f32 v40, v40, v241
  v_sub_f32 v41, v41, v241
  v_sub_f32 v42, v42, v241
  v_sub_f32 v43, v43, v241
  v_sub_f32 v44, v44, v241
  v_sub_f32 v45, v45, v241
  v_sub_f32 v46, v46, v241
  v_sub_f32 v47, v47, v241
  v_sub_f32 v48, v48, v242
  v_sub_f32 v49, v49, v242
  v_sub_f32 v50, v50, v242
  v_sub_f32 v51, v51, v242
  v_sub_f32 v52, v52, v242
  v_sub_f32 v53, v53, v242
  v_sub_f32 v54, v54, v242
  v_sub_f32 v55, v55, v242
  v_sub_f32 v56, v56, v243
  v_sub_f32 v57, v57, v243
  v_sub_f32 v58, v58, v243
  v_sub_f32 v59, v59, v243
  v_sub_f32 v60, v60, v243
  v_sub_f32 v61, v61, v243
  v_sub_f32 v62, v62, v243
  v_sub_f32 v63, v63, v243
  v_exp_f32 v192, v32
  v_exp_f32 v193, v33
  v_exp_f32 v194, v34
  v_cvt_pk_bf16_f32 v112, v192, v193
  v_exp_f32 v195, v35
  v_exp_f32 v196, v40
  v_cvt_pk_bf16_f32 v113, v194, v195
  v_exp_f32 v197, v41
  v_exp_f32 v198, v42
  v_cvt_pk_bf16_f32 v116, v196, v197
  v_exp_f32 v199, v43
  v_exp_f32 v192, v36
  v_cvt_pk_bf16_f32 v117, v198, v199
  v_exp_f32 v193, v37
  v_exp_f32 v194, v38
  v_cvt_pk_bf16_f32 v114, v192, v193
  v_exp_f32 v195, v39
  v_exp_f32 v196, v44
  v_cvt_pk_bf16_f32 v115, v194, v195
  v_exp_f32 v197, v45
  v_exp_f32 v198, v46
  v_cvt_pk_bf16_f32 v118, v196, v197
  v_exp_f32 v199, v47
  v_exp_f32 v192, v48
  v_cvt_pk_bf16_f32 v119, v198, v199
  v_exp_f32 v193, v49
  v_exp_f32 v194, v50
  v_cvt_pk_bf16_f32 v120, v192, v193
  v_exp_f32 v195, v51
  v_exp_f32 v196, v56
  v_cvt_pk_bf16_f32 v121, v194, v195
  v_exp_f32 v197, v57
  v_exp_f32 v198, v58
  v_cvt_pk_bf16_f32 v124, v196, v197
  v_exp_f32 v199, v59
  v_exp_f32 v192, v52
  v_cvt_pk_bf16_f32 v125, v198, v199
  v_exp_f32 v193, v53
  v_exp_f32 v194, v54
  v_cvt_pk_bf16_f32 v122, v192, v193
  v_exp_f32 v195, v55
  v_exp_f32 v196, v60
  v_cvt_pk_bf16_f32 v123, v194, v195
  v_exp_f32 v197, v61
  v_exp_f32 v198, v62
  v_cvt_pk_bf16_f32 v126, v196, v197
  v_exp_f32 v199, v63
  s_nop 0
  v_cvt_pk_bf16_f32 v127, v198, v199
  s_nop 1
  v_mfma_f32_16x16x32_bf16 v[208:211], v[216:219], v[112:115], 0
  v_mfma_f32_16x16x32_bf16 v[212:215], v[216:219], v[116:119], 0
  v_mfma_f32_16x16x32_bf16 v[208:211], v[216:219], v[120:123], v[208:211]
  v_mfma_f32_16x16x32_bf16 v[212:215], v[216:219], v[124:127], v[212:215]
  v_sub_f32 v0, v0, v242
  v_sub_f32 v64, v64, v242
  v_sub_f32 v1, v1, v242
  v_sub_f32 v65, v65, v242
  v_sub_f32 v2, v2, v242
  v_sub_f32 v66, v66, v242
  v_sub_f32 v3, v3, v242
  v_sub_f32 v67, v67, v242
  v_sub_f32 v4, v4, v242
  v_sub_f32 v68, v68, v242
  v_sub_f32 v5, v5, v242
  v_sub_f32 v69, v69, v242
  v_sub_f32 v6, v6, v242
  v_sub_f32 v70, v70, v242
  v_sub_f32 v7, v7, v242
  v_sub_f32 v71, v71, v242
  v_sub_f32 v8, v8, v243
  v_sub_f32 v72, v72, v243
  v_sub_f32 v9, v9, v243
  v_sub_f32 v73, v73, v243
  v_sub_f32 v10, v10, v243
  v_sub_f32 v74, v74, v243
  v_sub_f32 v11, v11, v243
  v_sub_f32 v75, v75, v243
  v_sub_f32 v12, v12, v243
  v_sub_f32 v76, v76, v243
  v_sub_f32 v13, v13, v243
  v_sub_f32 v77, v77, v243
  v_sub_f32 v14, v14, v243
  v_sub_f32 v78, v78, v243
  v_sub_f32 v15, v15, v243
  v_sub_f32 v79, v79, v243
  v_sub_f32 v16, v16, v242
  v_sub_f32 v80, v80, v242
  v_sub_f32 v17, v17, v242
  v_sub_f32 v81, v81, v242
  v_sub_f32 v18, v18, v242
  v_sub_f32 v82, v82, v242
  v_sub_f32 v19, v19, v242
  v_sub_f32 v83, v83, v242
  v_sub_f32 v20, v20, v242
  v_sub_f32 v84, v84, v242
  v_sub_f32 v21, v21, v242
  v_sub_f32 v85, v85, v242
  v_sub_f32 v22, v22, v242
  v_sub_f32 v86, v86, v242
  v_sub_f32 v23, v23, v242
  v_sub_f32 v87, v87, v242
  v_sub_f32 v24, v24, v243
  v_sub_f32 v88, v88, v243
  v_sub_f32 v25, v25, v243
  v_sub_f32 v89, v89, v243
  v_sub_f32 v26, v26, v243
  v_sub_f32 v90, v90, v243
  v_sub_f32 v27, v27, v243
  v_sub_f32 v91, v91, v243
  v_sub_f32 v28, v28, v243
  v_sub_f32 v92, v92, v243
  v_sub_f32 v29, v29, v243
  v_sub_f32 v93, v93, v243
  v_sub_f32 v30, v30, v243
  v_sub_f32 v94, v94, v243
  v_sub_f32 v31, v31, v243
  v_sub_f32 v95, v95, v243
  v_exp_f32 v192, v0
  v_exp_f32 v193, v1
  v_exp_f32 v194, v2
  v_cvt_pk_bf16_f32 v96, v192, v193
  v_exp_f32 v195, v3
  v_exp_f32 v196, v8
  v_cvt_pk_bf16_f32 v97, v194, v195
  v_exp_f32 v197, v9
  v_exp_f32 v198, v10
  v_cvt_pk_bf16_f32 v100, v196, v197
  v_exp_f32 v199, v11
  v_exp_f32 v192, v4
  v_cvt_pk_bf16_f32 v101, v198, v199
  v_mul_f32 v222, v222, v246
  v_accvgpr_read_b32 v248, a64
  v_accvgpr_read_b32 v249, a65
  v_mul_f32 v248, v248, v246
  v_mul_f32 v249, v249, v246
  v_accvgpr_write_b32 a64, v248
  v_accvgpr_write_b32 a65, v249
  v_accvgpr_read_b32 v248, a66
  v_accvgpr_read_b32 v249, a67
  v_mul_f32 v248, v248, v246
  v_mul_f32 v249, v249, v246
  v_accvgpr_write_b32 a66, v248
  v_accvgpr_write_b32 a67, v249
  v_accvgpr_read_b32 v248, a68
  v_accvgpr_read_b32 v249, a69
  v_mul_f32 v248, v248, v246
  v_mul_f32 v249, v249, v246
  v_accvgpr_write_b32 a68, v248
  v_accvgpr_write_b32 a69, v249
  v_accvgpr_read_b32 v248, a70
  v_accvgpr_read_b32 v249, a71
  v_mul_f32 v248, v248, v246
  v_mul_f32 v249, v249, v246
  v_accvgpr_write_b32 a70, v248
  v_accvgpr_write_b32 a71, v249
  v_accvgpr_read_b32 v248, a72
  v_accvgpr_read_b32 v249, a73
  v_mul_f32 v248, v248, v246
  v_mul_f32 v249, v249, v246
  v_accvgpr_write_b32 a72, v248
  v_accvgpr_write_b32 a73, v249
  v_accvgpr_read_b32 v248, a74
  v_accvgpr_read_b32 v249, a75
  v_mul_f32 v248, v248, v246
  v_mul_f32 v249, v249, v246
  v_accvgpr_write_b32 a74, v248
  v_accvgpr_write_b32 a75, v249
  v_accvgpr_read_b32 v248, a76
  v_accvgpr_read_b32 v249, a77
  v_mul_f32 v248, v248, v246
  v_mul_f32 v249, v249, v246
  v_accvgpr_write_b32 a76, v248
  v_accvgpr_write_b32 a77, v249
  v_accvgpr_read_b32 v248, a78
  v_accvgpr_read_b32 v249, a79
  v_mul_f32 v248, v248, v246
  v_mul_f32 v249, v249, v246
  v_accvgpr_write_b32 a78, v248
  v_accvgpr_write_b32 a79, v249
  v_accvgpr_read_b32 v248, a80
  v_accvgpr_read_b32 v249, a81
  v_mul_f32 v248, v248, v246
  v_mul_f32 v249, v249, v246
  v_accvgpr_write_b32 a80, v248
  v_accvgpr_write_b32 a81, v249
  v_accvgpr_read_b32 v248, a82
  v_accvgpr_read_b32 v249, a83
  v_mul_f32 v248, v248, v246
  v_mul_f32 v249, v249, v246
  v_accvgpr_write_b32 a82, v248
  v_accvgpr_write_b32 a83, v249
  v_accvgpr_read_b32 v248, a84
  v_accvgpr_read_b32 v249, a85
  v_mul_f32 v248, v248, v246
  v_mul_f32 v249, v249, v246
  v_accvgpr_write_b32 a84, v248
  v_accvgpr_write_b32 a85, v249
  v_accvgpr_read_b32 v248, a86
  v_accvgpr_read_b32 v249, a87
  v_mul_f32 v248, v248, v246
  v_mul_f32 v249, v249, v246
  v_accvgpr_write_b32 a86, v248
  v_accvgpr_write_b32 a87, v249
  v_accvgpr_read_b32 v248, a88
  v_accvgpr_read_b32 v249, a89
  v_mul_f32 v248, v248, v246
  v_mul_f32 v249, v249, v246
  v_accvgpr_write_b32 a88, v248
  v_accvgpr_write_b32 a89, v249
  v_accvgpr_read_b32 v248, a90
  v_accvgpr_read_b32 v249, a91
  v_mul_f32 v248, v248, v246
  v_mul_f32 v249, v249, v246
  v_accvgpr_write_b32 a90, v248
  v_accvgpr_write_b32 a91, v249
  v_accvgpr_read_b32 v248, a92
  v_accvgpr_read_b32 v249, a93
  v_mul_f32 v248, v248, v246
  v_mul_f32 v249, v249, v246
  v_accvgpr_write_b32 a92, v248
  v_accvgpr_write_b32 a93, v249
  v_accvgpr_read_b32 v248, a94
  v_accvgpr_read_b32 v249, a95
  v_mul_f32 v248, v248, v246
  v_mul_f32 v249, v249, v246
  v_accvgpr_write_b32 a94, v248
  v_accvgpr_write_b32 a95, v249
  v_mul_f32 v223, v223, v247
  v_accvgpr_read_b32 v248, a96
  v_accvgpr_read_b32 v249, a97
  v_mul_f32 v248, v248, v247
  v_mul_f32 v249, v249, v247
  v_accvgpr_write_b32 a96, v248
  v_accvgpr_write_b32 a97, v249
  v_accvgpr_read_b32 v248, a98
  v_accvgpr_read_b32 v249, a99
  v_mul_f32 v248, v248, v247
  v_mul_f32 v249, v249, v247
  v_accvgpr_write_b32 a98, v248
  v_accvgpr_write_b32 a99, v249
  v_accvgpr_read_b32 v248, a100
  v_accvgpr_read_b32 v249, a101
  v_mul_f32 v248, v248, v247
  v_mul_f32 v249, v249, v247
  v_accvgpr_write_b32 a100, v248
  v_accvgpr_write_b32 a101, v249
  v_accvgpr_read_b32 v248, a102
  v_accvgpr_read_b32 v249, a103
  v_mul_f32 v248, v248, v247
  v_mul_f32 v249, v249, v247
  v_accvgpr_write_b32 a102, v248
  v_accvgpr_write_b32 a103, v249
  v_accvgpr_read_b32 v248, a104
  v_accvgpr_read_b32 v249, a105
  v_mul_f32 v248, v248, v247
  v_mul_f32 v249, v249, v247
  v_accvgpr_write_b32 a104, v248
  v_accvgpr_write_b32 a105, v249
  v_accvgpr_read_b32 v248, a106
  v_accvgpr_read_b32 v249, a107
  v_mul_f32 v248, v248, v247
  v_mul_f32 v249, v249, v247
  v_accvgpr_write_b32 a106, v248
  v_accvgpr_write_b32 a107, v249
  v_accvgpr_read_b32 v248, a108
  v_accvgpr_read_b32 v249, a109
  v_mul_f32 v248, v248, v247
  v_mul_f32 v249, v249, v247
  v_accvgpr_write_b32 a108, v248
  v_accvgpr_write_b32 a109, v249
  v_accvgpr_read_b32 v248, a110
  v_accvgpr_read_b32 v249, a111
  v_mul_f32 v248, v248, v247
  v_mul_f32 v249, v249, v247
  v_accvgpr_write_b32 a110, v248
  v_accvgpr_write_b32 a111, v249
  v_accvgpr_read_b32 v248, a112
  v_accvgpr_read_b32 v249, a113
  v_mul_f32 v248, v248, v247
  v_mul_f32 v249, v249, v247
  v_accvgpr_write_b32 a112, v248
  v_accvgpr_write_b32 a113, v249
  v_accvgpr_read_b32 v248, a114
  v_accvgpr_read_b32 v249, a115
  v_mul_f32 v248, v248, v247
  v_mul_f32 v249, v249, v247
  v_accvgpr_write_b32 a114, v248
  v_accvgpr_write_b32 a115, v249
  v_accvgpr_read_b32 v248, a116
  v_accvgpr_read_b32 v249, a117
  v_mul_f32 v248, v248, v247
  v_mul_f32 v249, v249, v247
  v_accvgpr_write_b32 a116, v248
  v_accvgpr_write_b32 a117, v249
  v_accvgpr_read_b32 v248, a118
  v_accvgpr_read_b32 v249, a119
  v_mul_f32 v248, v248, v247
  v_mul_f32 v249, v249, v247
  v_accvgpr_write_b32 a118, v248
  v_accvgpr_write_b32 a119, v249
  v_accvgpr_read_b32 v248, a120
  v_accvgpr_read_b32 v249, a121
  v_mul_f32 v248, v248, v247
  v_mul_f32 v249, v249, v247
  v_accvgpr_write_b32 a120, v248
  v_accvgpr_write_b32 a121, v249
  v_accvgpr_read_b32 v248, a122
  v_accvgpr_read_b32 v249, a123
  v_mul_f32 v248, v248, v247
  v_mul_f32 v249, v249, v247
  v_accvgpr_write_b32 a122, v248
  v_accvgpr_write_b32 a123, v249
  v_accvgpr_read_b32 v248, a124
  v_accvgpr_read_b32 v249, a125
  v_mul_f32 v248, v248, v247
  v_mul_f32 v249, v249, v247
  v_accvgpr_write_b32 a124, v248
  v_accvgpr_write_b32 a125, v249
  v_accvgpr_read_b32 v248, a126
  v_accvgpr_read_b32 v249, a127
  v_mul_f32 v248, v248, v247
  v_mul_f32 v249, v249, v247
  v_accvgpr_write_b32 a126, v248
  v_accvgpr_write_b32 a127, v249
  s_nop 2
  s_branch L_adaL_back_55
L_adaL_fb_56:
  s_nop 15
  v_max3_f32 v240, v0, v1, v2
  v_max3_f32 v240, v240, v3, v4
  v_max3_f32 v240, v240, v5, v6
  v_max_f32 v240, v240, v7
  v_max3_f32 v241, v8, v9, v10
  v_max3_f32 v241, v241, v11, v12
  v_max3_f32 v241, v241, v13, v14
  v_max_f32 v241, v241, v15
  v_mov_b32 v248, v240
  v_mov_b32 v249, v241
  s_nop 1
  v_permlane16_swap_b32 v240, v248
  v_permlane16_swap_b32 v241, v249
  s_nop 1
  v_max_f32 v240, v240, v248
  v_max_f32 v241, v241, v249
  v_mov_b32 v248, v240
  v_mov_b32 v249, v241
  s_nop 1
  v_permlane32_swap_b32 v240, v248
  v_permlane32_swap_b32 v241, v249
  s_nop 1
  v_max_f32 v240, v240, v248
  v_max_f32 v241, v241, v249
  v_max3_f32 v242, v16, v17, v18
  v_max3_f32 v242, v242, v19, v20
  v_max3_f32 v242, v242, v21, v22
  v_max_f32 v242, v242, v23
  v_max3_f32 v243, v24, v25, v26
  v_max3_f32 v243, v243, v27, v28
  v_max3_f32 v243, v243, v29, v30
  v_max_f32 v243, v243, v31
  v_mov_b32 v248, v242
  v_mov_b32 v249, v243
  s_nop 1
  v_permlane16_swap_b32 v242, v248
  v_permlane16_swap_b32 v243, v249
  s_nop 1
  v_max_f32 v242, v242, v248
  v_max_f32 v243, v243, v249
  v_mov_b32 v248, v242
  v_mov_b32 v249, v243
  s_nop 1
  v_permlane32_swap_b32 v242, v248
  v_permlane32_swap_b32 v243, v249
  s_nop 1
  v_max_f32 v242, v242, v248
  v_max_f32 v243, v243, v249
  v_max_f32 v240, 0, v240
  v_max_f32 v241, 0, v241
  v_max_f32 v242, 0, v242
  v_max_f32 v243, 0, v243
  v_max_f32 v240, v240, v242
  v_mov_b32 v242, v240
  v_max_f32 v241, v241, v243
  v_mov_b32 v243, v241
  v_exp_f32 v244, -v240
  v_exp_f32 v245, -v241
  v_exp_f32 v246, -v242
  v_exp_f32 v247, -v243
  v_sub_f32 v0, v0, v240
  v_sub_f32 v1, v1, v240
  v_sub_f32 v2, v2, v240
  v_sub_f32 v3, v3, v240
  v_sub_f32 v4, v4, v240
  v_sub_f32 v5, v5, v240
  v_sub_f32 v6, v6, v240
  v_sub_f32 v7, v7, v240
  v_sub_f32 v8, v8, v241
  v_sub_f32 v9, v9, v241
  v_sub_f32 v10, v10, v241
  v_sub_f32 v11, v11, v241
  v_sub_f32 v12, v12, v241
  v_sub_f32 v13, v13, v241
  v_sub_f32 v14, v14, v241
  v_sub_f32 v15, v15, v241
  v_sub_f32 v16, v16, v242
  v_sub_f32 v17, v17, v242
  v_sub_f32 v18, v18, v242
  v_sub_f32 v19, v19, v242
  v_sub_f32 v20, v20, v242
  v_sub_f32 v21, v21, v242
  v_sub_f32 v22, v22, v242
  v_sub_f32 v23, v23, v242
  v_sub_f32 v24, v24, v243
  v_sub_f32 v25, v25, v243
  v_sub_f32 v26, v26, v243
  v_sub_f32 v27, v27, v243
  v_sub_f32 v28, v28, v243
  v_sub_f32 v29, v29, v243
  v_sub_f32 v30, v30, v243
  v_sub_f32 v31, v31, v243
  v_exp_f32 v192, v0
  v_exp_f32 v193, v1
  v_exp_f32 v194, v2
  v_cvt_pk_bf16_f32 v96, v192, v193
  v_exp_f32 v195, v3
  v_exp_f32 v196, v8
  v_cvt_pk_bf16_f32 v97, v194, v195
  v_exp_f32 v197, v9
  v_exp_f32 v198, v10
  v_cvt_pk_bf16_f32 v100, v196, v197
  v_exp_f32 v199, v11
  v_exp_f32 v192, v4
  v_cvt_pk_bf16_f32 v101, v198, v199
  v_exp_f32 v193, v5
  v_exp_f32 v194, v6
  v_cvt_pk_bf16_f32 v98, v192, v193
  v_exp_f32 v195, v7
  v_exp_f32 v196, v12
  v_cvt_pk_bf16_f32 v99, v194, v195
  v_exp_f32 v197, v13
  v_exp_f32 v198, v14
  v_cvt_pk_bf16_f32 v102, v196, v197
  v_exp_f32 v199, v15
  v_exp_f32 v192, v16
  v_cvt_pk_bf16_f32 v103, v198, v199
  v_exp_f32 v193, v17
  v_exp_f32 v194, v18
  v_cvt_pk_bf16_f32 v104, v192, v193
  v_exp_f32 v195, v19
  v_exp_f32 v196, v24
  v_cvt_pk_bf16_f32 v105, v194, v195
  v_exp_f32 v197, v25
  v_exp_f32 v198, v26
  v_cvt_pk_bf16_f32 v108, v196, v197
  v_exp_f32 v199, v27
  v_exp_f32 v192, v20
  v_cvt_pk_bf16_f32 v109, v198, v199
  v_exp_f32 v193, v21
  v_exp_f32 v194, v22
  v_cvt_pk_bf16_f32 v106, v192, v193
  v_exp_f32 v195, v23
  v_exp_f32 v196, v28
  v_cvt_pk_bf16_f32 v107, v194, v195
  v_exp_f32 v197, v29
  v_exp_f32 v198, v30
  v_cvt_pk_bf16_f32 v110, v196, v197
  v_exp_f32 v199, v31
  s_nop 0
  v_cvt_pk_bf16_f32 v111, v198, v199
  s_nop 1
  v_mfma_f32_16x16x32_bf16 v[208:211], v[216:219], v[96:99], 0
  v_mfma_f32_16x16x32_bf16 v[212:215], v[216:219], v[100:103], 0
  v_mfma_f32_16x16x32_bf16 v[208:211], v[216:219], v[104:107], v[208:211]
  v_mfma_f32_16x16x32_bf16 v[212:215], v[216:219], v[108:111], v[212:215]
  v_sub_f32 v32, v32, v242
  v_sub_f32 v64, v64, v242
  v_sub_f32 v33, v33, v242
  v_sub_f32 v65, v65, v242
  v_sub_f32 v34, v34, v242
  v_sub_f32 v66, v66, v242
  v_sub_f32 v35, v35, v242
  v_sub_f32 v67, v67, v242
  v_sub_f32 v36, v36, v242
  v_sub_f32 v68, v68, v242
  v_sub_f32 v37, v37, v242
  v_sub_f32 v69, v69, v242
  v_sub_f32 v38, v38, v242
  v_sub_f32 v70, v70, v242
  v_sub_f32 v39, v39, v242
  v_sub_f32 v71, v71, v242
  v_sub_f32 v40, v40, v243
  v_sub_f32 v72, v72, v243
  v_sub_f32 v41, v41, v243
  v_sub_f32 v73, v73, v243
  v_sub_f32 v42, v42, v243
  v_sub_f32 v74, v74, v243
  v_sub_f32 v43, v43, v243
  v_sub_f32 v75, v75, v243
  v_sub_f32 v44, v44, v243
  v_sub_f32 v76, v76, v243
  v_sub_f32 v45, v45, v243
  v_sub_f32 v77, v77, v243
  v_sub_f32 v46, v46, v243
  v_sub_f32 v78, v78, v243
  v_sub_f32 v47, v47, v243
  v_sub_f32 v79, v79, v243
  v_sub_f32 v48, v48, v242
  v_sub_f32 v80, v80, v242
  v_sub_f32 v49, v49, v242
  v_sub_f32 v81, v81, v242
  v_sub_f32 v50, v50, v242
  v_sub_f32 v82, v82, v242
  v_sub_f32 v51, v51, v242
  v_sub_f32 v83, v83, v242
  v_sub_f32 v52, v52, v242
  v_sub_f32 v84, v84, v242
  v_sub_f32 v53, v53, v242
  v_sub_f32 v85, v85, v242
  v_sub_f32 v54, v54, v242
  v_sub_f32 v86, v86, v242
  v_sub_f32 v55, v55, v242
  v_sub_f32 v87, v87, v242
  v_sub_f32 v56, v56, v243
  v_sub_f32 v88, v88, v243
  v_sub_f32 v57, v57, v243
  v_sub_f32 v89, v89, v243
  v_sub_f32 v58, v58, v243
  v_sub_f32 v90, v90, v243
  v_sub_f32 v59, v59, v243
  v_sub_f32 v91, v91, v243
  v_sub_f32 v60, v60, v243
  v_sub_f32 v92, v92, v243
  v_sub_f32 v61, v61, v243
  v_sub_f32 v93, v93, v243
  v_sub_f32 v62, v62, v243
  v_sub_f32 v94, v94, v243
  v_sub_f32 v63, v63, v243
  v_sub_f32 v95, v95, v243
  v_exp_f32 v192, v32
  v_exp_f32 v193, v33
  v_exp_f32 v194, v34
  v_cvt_pk_bf16_f32 v112, v192, v193
  v_exp_f32 v195, v35
  v_exp_f32 v196, v40
  v_cvt_pk_bf16_f32 v113, v194, v195
  v_exp_f32 v197, v41
  v_exp_f32 v198, v42
  v_cvt_pk_bf16_f32 v116, v196, v197
  v_exp_f32 v199, v43
  v_exp_f32 v192, v36
  v_cvt_pk_bf16_f32 v117, v198, v199
  v_mul_f32 v222, v222, v246
  v_accvgpr_read_b32 v248, a64
  v_accvgpr_read_b32 v249, a65
  v_mul_f32 v248, v248, v246
  v_mul_f32 v249, v249, v246
  v_accvgpr_write_b32 a64, v248
  v_accvgpr_write_b32 a65, v249
  v_accvgpr_read_b32 v248, a66
  v_accvgpr_read_b32 v249, a67
  v_mul_f32 v248, v248, v246
  v_mul_f32 v249, v249, v246
  v_accvgpr_write_b32 a66, v248
  v_accvgpr_write_b32 a67, v249
  v_accvgpr_read_b32 v248, a68
  v_accvgpr_read_b32 v249, a69
  v_mul_f32 v248, v248, v246
  v_mul_f32 v249, v249, v246
  v_accvgpr_write_b32 a68, v248
  v_accvgpr_write_b32 a69, v249
  v_accvgpr_read_b32 v248, a70
  v_accvgpr_read_b32 v249, a71
  v_mul_f32 v248, v248, v246
  v_mul_f32 v249, v249, v246
  v_accvgpr_write_b32 a70, v248
  v_accvgpr_write_b32 a71, v249
  v_accvgpr_read_b32 v248, a72
  v_accvgpr_read_b32 v249, a73
  v_mul_f32 v248, v248, v246
  v_mul_f32 v249, v249, v246
  v_accvgpr_write_b32 a72, v248
  v_accvgpr_write_b32 a73, v249
  v_accvgpr_read_b32 v248, a74
  v_accvgpr_read_b32 v249, a75
  v_mul_f32 v248, v248, v246
  v_mul_f32 v249, v249, v246
  v_accvgpr_write_b32 a74, v248
  v_accvgpr_write_b32 a75, v249
  v_accvgpr_read_b32 v248, a76
  v_accvgpr_read_b32 v249, a77
  v_mul_f32 v248, v248, v246
  v_mul_f32 v249, v249, v246
  v_accvgpr_write_b32 a76, v248
  v_accvgpr_write_b32 a77, v249
  v_accvgpr_read_b32 v248, a78
  v_accvgpr_read_b32 v249, a79
  v_mul_f32 v248, v248, v246
  v_mul_f32 v249, v249, v246
  v_accvgpr_write_b32 a78, v248
  v_accvgpr_write_b32 a79, v249
  v_accvgpr_read_b32 v248, a80
  v_accvgpr_read_b32 v249, a81
  v_mul_f32 v248, v248, v246
  v_mul_f32 v249, v249, v246
  v_accvgpr_write_b32 a80, v248
  v_accvgpr_write_b32 a81, v249
  v_accvgpr_read_b32 v248, a82
  v_accvgpr_read_b32 v249, a83
  v_mul_f32 v248, v248, v246
  v_mul_f32 v249, v249, v246
  v_accvgpr_write_b32 a82, v248
  v_accvgpr_write_b32 a83, v249
  v_accvgpr_read_b32 v248, a84
  v_accvgpr_read_b32 v249, a85
  v_mul_f32 v248, v248, v246
  v_mul_f32 v249, v249, v246
  v_accvgpr_write_b32 a84, v248
  v_accvgpr_write_b32 a85, v249
  v_accvgpr_read_b32 v248, a86
  v_accvgpr_read_b32 v249, a87
  v_mul_f32 v248, v248, v246
  v_mul_f32 v249, v249, v246
  v_accvgpr_write_b32 a86, v248
  v_accvgpr_write_b32 a87, v249
  v_accvgpr_read_b32 v248, a88
  v_accvgpr_read_b32 v249, a89
  v_mul_f32 v248, v248, v246
  v_mul_f32 v249, v249, v246
  v_accvgpr_write_b32 a88, v248
  v_accvgpr_write_b32 a89, v249
  v_accvgpr_read_b32 v248, a90
  v_accvgpr_read_b32 v249, a91
  v_mul_f32 v248, v248, v246
  v_mul_f32 v249, v249, v246
  v_accvgpr_write_b32 a90, v248
  v_accvgpr_write_b32 a91, v249
  v_accvgpr_read_b32 v248, a92
  v_accvgpr_read_b32 v249, a93
  v_mul_f32 v248, v248, v246
  v_mul_f32 v249, v249, v246
  v_accvgpr_write_b32 a92, v248
  v_accvgpr_write_b32 a93, v249
  v_accvgpr_read_b32 v248, a94
  v_accvgpr_read_b32 v249, a95
  v_mul_f32 v248, v248, v246
  v_mul_f32 v249, v249, v246
  v_accvgpr_write_b32 a94, v248
  v_accvgpr_write_b32 a95, v249
  v_mul_f32 v223, v223, v247
  v_accvgpr_read_b32 v248, a96
  v_accvgpr_read_b32 v249, a97
  v_mul_f32 v248, v248, v247
  v_mul_f32 v249, v249, v247
  v_accvgpr_write_b32 a96, v248
  v_accvgpr_write_b32 a97, v249
  v_accvgpr_read_b32 v248, a98
  v_accvgpr_read_b32 v249, a99
  v_mul_f32 v248, v248, v247
  v_mul_f32 v249, v249, v247
  v_accvgpr_write_b32 a98, v248
  v_accvgpr_write_b32 a99, v249
  v_accvgpr_read_b32 v248, a100
  v_accvgpr_read_b32 v249, a101
  v_mul_f32 v248, v248, v247
  v_mul_f32 v249, v249, v247
  v_accvgpr_write_b32 a100, v248
  v_accvgpr_write_b32 a101, v249
  v_accvgpr_read_b32 v248, a102
  v_accvgpr_read_b32 v249, a103
  v_mul_f32 v248, v248, v247
  v_mul_f32 v249, v249, v247
  v_accvgpr_write_b32 a102, v248
  v_accvgpr_write_b32 a103, v249
  v_accvgpr_read_b32 v248, a104
  v_accvgpr_read_b32 v249, a105
  v_mul_f32 v248, v248, v247
  v_mul_f32 v249, v249, v247
  v_accvgpr_write_b32 a104, v248
  v_accvgpr_write_b32 a105, v249
  v_accvgpr_read_b32 v248, a106
  v_accvgpr_read_b32 v249, a107
  v_mul_f32 v248, v248, v247
  v_mul_f32 v249, v249, v247
  v_accvgpr_write_b32 a106, v248
  v_accvgpr_write_b32 a107, v249
  v_accvgpr_read_b32 v248, a108
  v_accvgpr_read_b32 v249, a109
  v_mul_f32 v248, v248, v247
  v_mul_f32 v249, v249, v247
  v_accvgpr_write_b32 a108, v248
  v_accvgpr_write_b32 a109, v249
  v_accvgpr_read_b32 v248, a110
  v_accvgpr_read_b32 v249, a111
  v_mul_f32 v248, v248, v247
  v_mul_f32 v249, v249, v247
  v_accvgpr_write_b32 a110, v248
  v_accvgpr_write_b32 a111, v249
  v_accvgpr_read_b32 v248, a112
  v_accvgpr_read_b32 v249, a113
  v_mul_f32 v248, v248, v247
  v_mul_f32 v249, v249, v247
  v_accvgpr_write_b32 a112, v248
  v_accvgpr_write_b32 a113, v249
  v_accvgpr_read_b32 v248, a114
  v_accvgpr_read_b32 v249, a115
  v_mul_f32 v248, v248, v247
  v_mul_f32 v249, v249, v247
  v_accvgpr_write_b32 a114, v248
  v_accvgpr_write_b32 a115, v249
  v_accvgpr_read_b32 v248, a116
  v_accvgpr_read_b32 v249, a117
  v_mul_f32 v248, v248, v247
  v_mul_f32 v249, v249, v247
  v_accvgpr_write_b32 a116, v248
  v_accvgpr_write_b32 a117, v249
  v_accvgpr_read_b32 v248, a118
  v_accvgpr_read_b32 v249, a119
  v_mul_f32 v248, v248, v247
  v_mul_f32 v249, v249, v247
  v_accvgpr_write_b32 a118, v248
  v_accvgpr_write_b32 a119, v249
  v_accvgpr_read_b32 v248, a120
  v_accvgpr_read_b32 v249, a121
  v_mul_f32 v248, v248, v247
  v_mul_f32 v249, v249, v247
  v_accvgpr_write_b32 a120, v248
  v_accvgpr_write_b32 a121, v249
  v_accvgpr_read_b32 v248, a122
  v_accvgpr_read_b32 v249, a123
  v_mul_f32 v248, v248, v247
  v_mul_f32 v249, v249, v247
  v_accvgpr_write_b32 a122, v248
  v_accvgpr_write_b32 a123, v249
  v_accvgpr_read_b32 v248, a124
  v_accvgpr_read_b32 v249, a125
  v_mul_f32 v248, v248, v247
  v_mul_f32 v249, v249, v247
  v_accvgpr_write_b32 a124, v248
  v_accvgpr_write_b32 a125, v249
  v_accvgpr_read_b32 v248, a126
  v_accvgpr_read_b32 v249, a127
  v_mul_f32 v248, v248, v247
  v_mul_f32 v249, v249, v247
  v_accvgpr_write_b32 a126, v248
  v_accvgpr_write_b32 a127, v249
  s_nop 2
  s_branch L_adaL_back_57
L_adaL_fb_60:
  s_nop 15
  v_max3_f32 v240, v32, v33, v34
  v_max3_f32 v240, v240, v35, v36
  v_max3_f32 v240, v240, v37, v38
  v_max_f32 v240, v240, v39
  v_max3_f32 v241, v40, v41, v42
  v_max3_f32 v241, v241, v43, v44
  v_max3_f32 v241, v241, v45, v46
  v_max_f32 v241, v241, v47
  v_mov_b32 v248, v240
  v_mov_b32 v249, v241
  s_nop 1
  v_permlane16_swap_b32 v240, v248
  v_permlane16_swap_b32 v241, v249
  s_nop 1
  v_max_f32 v240, v240, v248
  v_max_f32 v241, v241, v249
  v_mov_b32 v248, v240
  v_mov_b32 v249, v241
  s_nop 1
  v_permlane32_swap_b32 v240, v248
  v_permlane32_swap_b32 v241, v249
  s_nop 1
  v_max_f32 v240, v240, v248
  v_max_f32 v241, v241, v249
  v_max3_f32 v242, v48, v49, v50
  v_max3_f32 v242, v242, v51, v52
  v_max3_f32 v242, v242, v53, v54
  v_max_f32 v242, v242, v55
  v_max3_f32 v243, v56, v57, v58
  v_max3_f32 v243, v243, v59, v60
  v_max3_f32 v243, v243, v61, v62
  v_max_f32 v243, v243, v63
  v_mov_b32 v248, v242
  v_mov_b32 v249, v243
  s_nop 1
  v_permlane16_swap_b32 v242, v248
  v_permlane16_swap_b32 v243, v249
  s_nop 1
  v_max_f32 v242, v242, v248
  v_max_f32 v243, v243, v249
  v_mov_b32 v248, v242
  v_mov_b32 v249, v243
  s_nop 1
  v_permlane32_swap_b32 v242, v248
  v_permlane32_swap_b32 v243, v249
  s_nop 1
  v_max_f32 v242, v242, v248
  v_max_f32 v243, v243, v249
  v_max_f32 v240, 0, v240
  v_max_f32 v241, 0, v241
  v_max_f32 v242, 0, v242
  v_max_f32 v243, 0, v243
  v_max_f32 v240, v240, v242
  v_mov_b32 v242, v240
  v_max_f32 v241, v241, v243
  v_mov_b32 v243, v241
  v_exp_f32 v244, -v240
  v_exp_f32 v245, -v241
  v_exp_f32 v246, -v242
  v_exp_f32 v247, -v243
  v_sub_f32 v32, v32, v240
  v_sub_f32 v33, v33, v240
  v_sub_f32 v34, v34, v240
  v_sub_f32 v35, v35, v240
  v_sub_f32 v36, v36, v240
  v_sub_f32 v37, v37, v240
  v_sub_f32 v38, v38, v240
  v_sub_f32 v39, v39, v240
  v_sub_f32 v40, v40, v241
  v_sub_f32 v41, v41, v241
  v_sub_f32 v42, v42, v241
  v_sub_f32 v43, v43, v241
  v_sub_f32 v44, v44, v241
  v_sub_f32 v45, v45, v241
  v_sub_f32 v46, v46, v241
  v_sub_f32 v47, v47, v241
  v_sub_f32 v48, v48, v242
  v_sub_f32 v49, v49, v242
  v_sub_f32 v50, v50, v242
  v_sub_f32 v51, v51, v242
  v_sub_f32 v52, v52, v242
  v_sub_f32 v53, v53, v242
  v_sub_f32 v54, v54, v242
  v_sub_f32 v55, v55, v242
  v_sub_f32 v56, v56, v243
  v_sub_f32 v57, v57, v243
  v_sub_f32 v58, v58, v243
  v_sub_f32 v59, v59, v243
  v_sub_f32 v60, v60, v243
  v_sub_f32 v61, v61, v243
  v_sub_f32 v62, v62, v243
  v_sub_f32 v63, v63, v243
  v_exp_f32 v192, v32
  v_exp_f32 v193, v33
  v_exp_f32 v194, v34
  v_cvt_pk_bf16_f32 v112, v192, v193
  v_exp_f32 v195, v35
  v_exp_f32 v196, v40
  v_cvt_pk_bf16_f32 v113, v194, v195
  v_exp_f32 v197, v41
  v_exp_f32 v198, v42
  v_cvt_pk_bf16_f32 v116, v196, v197
  v_exp_f32 v199, v43
  v_exp_f32 v192, v36
  v_cvt_pk_bf16_f32 v117, v198, v199
  v_exp_f32 v193, v37
  v_exp_f32 v194, v38
  v_cvt_pk_bf16_f32 v114, v192, v193
  v_exp_f32 v195, v39
  v_exp_f32 v196, v44
  v_cvt_pk_bf16_f32 v115, v194, v195
  v_exp_f32 v197, v45
  v_exp_f32 v198, v46
  v_cvt_pk_bf16_f32 v118, v196, v197
  v_exp_f32 v199, v47
  v_exp_f32 v192, v48
  v_cvt_pk_bf16_f32 v119, v198, v199
  v_exp_f32 v193, v49
  v_exp_f32 v194, v50
  v_cvt_pk_bf16_f32 v120, v192, v193
  v_exp_f32 v195, v51
  v_exp_f32 v196, v56
  v_cvt_pk_bf16_f32 v121, v194, v195
  v_exp_f32 v197, v57
  v_exp_f32 v198, v58
  v_cvt_pk_bf16_f32 v124, v196, v197
  v_exp_f32 v199, v59
  v_exp_f32 v192, v52
  v_cvt_pk_bf16_f32 v125, v198, v199
  v_exp_f32 v193, v53
  v_exp_f32 v194, v54
  v_cvt_pk_bf16_f32 v122, v192, v193
  v_exp_f32 v195, v55
  v_exp_f32 v196, v60
  v_cvt_pk_bf16_f32 v123, v194, v195
  v_exp_f32 v197, v61
  v_exp_f32 v198, v62
  v_cvt_pk_bf16_f32 v126, v196, v197
  v_exp_f32 v199, v63
  s_nop 0
  v_cvt_pk_bf16_f32 v127, v198, v199
  s_nop 1
  v_mfma_f32_16x16x32_bf16 v[208:211], v[216:219], v[112:115], 0
  v_mfma_f32_16x16x32_bf16 v[212:215], v[216:219], v[116:119], 0
  v_mfma_f32_16x16x32_bf16 v[208:211], v[216:219], v[120:123], v[208:211]
  v_mfma_f32_16x16x32_bf16 v[212:215], v[216:219], v[124:127], v[212:215]
  v_sub_f32 v0, v0, v242
  v_sub_f32 v64, v64, v242
  v_sub_f32 v1, v1, v242
  v_sub_f32 v65, v65, v242
  v_sub_f32 v2, v2, v242
  v_sub_f32 v66, v66, v242
  v_sub_f32 v3, v3, v242
  v_sub_f32 v67, v67, v242
  v_sub_f32 v4, v4, v242
  v_sub_f32 v68, v68, v242
  v_sub_f32 v5, v5, v242
  v_sub_f32 v69, v69, v242
  v_sub_f32 v6, v6, v242
  v_sub_f32 v70, v70, v242
  v_sub_f32 v7, v7, v242
  v_sub_f32 v71, v71, v242
  v_sub_f32 v8, v8, v243
  v_sub_f32 v72, v72, v243
  v_sub_f32 v9, v9, v243
  v_sub_f32 v73, v73, v243
  v_sub_f32 v10, v10, v243
  v_sub_f32 v74, v74, v243
  v_sub_f32 v11, v11, v243
  v_sub_f32 v75, v75, v243
  v_sub_f32 v12, v12, v243
  v_sub_f32 v76, v76, v243
  v_sub_f32 v13, v13, v243
  v_sub_f32 v77, v77, v243
  v_sub_f32 v14, v14, v243
  v_sub_f32 v78, v78, v243
  v_sub_f32 v15, v15, v243
  v_sub_f32 v79, v79, v243
  v_sub_f32 v16, v16, v242
  v_sub_f32 v80, v80, v242
  v_sub_f32 v17, v17, v242
  v_sub_f32 v81, v81, v242
  v_sub_f32 v18, v18, v242
  v_sub_f32 v82, v82, v242
  v_sub_f32 v19, v19, v242
  v_sub_f32 v83, v83, v242
  v_sub_f32 v20, v20, v242
  v_sub_f32 v84, v84, v242
  v_sub_f32 v21, v21, v242
  v_sub_f32 v85, v85, v242
  v_sub_f32 v22, v22, v242
  v_sub_f32 v86, v86, v242
  v_sub_f32 v23, v23, v242
  v_sub_f32 v87, v87, v242
  v_sub_f32 v24, v24, v243
  v_sub_f32 v88, v88, v243
  v_sub_f32 v25, v25, v243
  v_sub_f32 v89, v89, v243
  v_sub_f32 v26, v26, v243
  v_sub_f32 v90, v90, v243
  v_sub_f32 v27, v27, v243
  v_sub_f32 v91, v91, v243
  v_sub_f32 v28, v28, v243
  v_sub_f32 v92, v92, v243
  v_sub_f32 v29, v29, v243
  v_sub_f32 v93, v93, v243
  v_sub_f32 v30, v30, v243
  v_sub_f32 v94, v94, v243
  v_sub_f32 v31, v31, v243
  v_sub_f32 v95, v95, v243
  v_exp_f32 v192, v0
  v_exp_f32 v193, v1
  v_exp_f32 v194, v2
  v_cvt_pk_bf16_f32 v96, v192, v193
  v_exp_f32 v195, v3
  v_exp_f32 v196, v8
  v_cvt_pk_bf16_f32 v97, v194, v195
  v_exp_f32 v197, v9
  v_exp_f32 v198, v10
  v_cvt_pk_bf16_f32 v100, v196, v197
  v_exp_f32 v199, v11
  v_exp_f32 v192, v4
  v_cvt_pk_bf16_f32 v101, v198, v199
  v_mul_f32 v222, v222, v246
  v_accvgpr_read_b32 v248, a64
  v_accvgpr_read_b32 v249, a65
  v_mul_f32 v248, v248, v246
  v_mul_f32 v249, v249, v246
  v_accvgpr_write_b32 a64, v248
  v_accvgpr_write_b32 a65, v249
  v_accvgpr_read_b32 v248, a66
  v_accvgpr_read_b32 v249, a67
  v_mul_f32 v248, v248, v246
  v_mul_f32 v249, v249, v246
  v_accvgpr_write_b32 a66, v248
  v_accvgpr_write_b32 a67, v249
  v_accvgpr_read_b32 v248, a68
  v_accvgpr_read_b32 v249, a69
  v_mul_f32 v248, v248, v246
  v_mul_f32 v249, v249, v246
  v_accvgpr_write_b32 a68, v248
  v_accvgpr_write_b32 a69, v249
  v_accvgpr_read_b32 v248, a70
  v_accvgpr_read_b32 v249, a71
  v_mul_f32 v248, v248, v246
  v_mul_f32 v249, v249, v246
  v_accvgpr_write_b32 a70, v248
  v_accvgpr_write_b32 a71, v249
  v_accvgpr_read_b32 v248, a72
  v_accvgpr_read_b32 v249, a73
  v_mul_f32 v248, v248, v246
  v_mul_f32 v249, v249, v246
  v_accvgpr_write_b32 a72, v248
  v_accvgpr_write_b32 a73, v249
  v_accvgpr_read_b32 v248, a74
  v_accvgpr_read_b32 v249, a75
  v_mul_f32 v248, v248, v246
  v_mul_f32 v249, v249, v246
  v_accvgpr_write_b32 a74, v248
  v_accvgpr_write_b32 a75, v249
  v_accvgpr_read_b32 v248, a76
  v_accvgpr_read_b32 v249, a77
  v_mul_f32 v248, v248, v246
  v_mul_f32 v249, v249, v246
  v_accvgpr_write_b32 a76, v248
  v_accvgpr_write_b32 a77, v249
  v_accvgpr_read_b32 v248, a78
  v_accvgpr_read_b32 v249, a79
  v_mul_f32 v248, v248, v246
  v_mul_f32 v249, v249, v246
  v_accvgpr_write_b32 a78, v248
  v_accvgpr_write_b32 a79, v249
  v_accvgpr_read_b32 v248, a80
  v_accvgpr_read_b32 v249, a81
  v_mul_f32 v248, v248, v246
  v_mul_f32 v249, v249, v246
  v_accvgpr_write_b32 a80, v248
  v_accvgpr_write_b32 a81, v249
  v_accvgpr_read_b32 v248, a82
  v_accvgpr_read_b32 v249, a83
  v_mul_f32 v248, v248, v246
  v_mul_f32 v249, v249, v246
  v_accvgpr_write_b32 a82, v248
  v_accvgpr_write_b32 a83, v249
  v_accvgpr_read_b32 v248, a84
  v_accvgpr_read_b32 v249, a85
  v_mul_f32 v248, v248, v246
  v_mul_f32 v249, v249, v246
  v_accvgpr_write_b32 a84, v248
  v_accvgpr_write_b32 a85, v249
  v_accvgpr_read_b32 v248, a86
  v_accvgpr_read_b32 v249, a87
  v_mul_f32 v248, v248, v246
  v_mul_f32 v249, v249, v246
  v_accvgpr_write_b32 a86, v248
  v_accvgpr_write_b32 a87, v249
  v_accvgpr_read_b32 v248, a88
  v_accvgpr_read_b32 v249, a89
  v_mul_f32 v248, v248, v246
  v_mul_f32 v249, v249, v246
  v_accvgpr_write_b32 a88, v248
  v_accvgpr_write_b32 a89, v249
  v_accvgpr_read_b32 v248, a90
  v_accvgpr_read_b32 v249, a91
  v_mul_f32 v248, v248, v246
  v_mul_f32 v249, v249, v246
  v_accvgpr_write_b32 a90, v248
  v_accvgpr_write_b32 a91, v249
  v_accvgpr_read_b32 v248, a92
  v_accvgpr_read_b32 v249, a93
  v_mul_f32 v248, v248, v246
  v_mul_f32 v249, v249, v246
  v_accvgpr_write_b32 a92, v248
  v_accvgpr_write_b32 a93, v249
  v_accvgpr_read_b32 v248, a94
  v_accvgpr_read_b32 v249, a95
  v_mul_f32 v248, v248, v246
  v_mul_f32 v249, v249, v246
  v_accvgpr_write_b32 a94, v248
  v_accvgpr_write_b32 a95, v249
  v_mul_f32 v223, v223, v247
  v_accvgpr_read_b32 v248, a96
  v_accvgpr_read_b32 v249, a97
  v_mul_f32 v248, v248, v247
  v_mul_f32 v249, v249, v247
  v_accvgpr_write_b32 a96, v248
  v_accvgpr_write_b32 a97, v249
  v_accvgpr_read_b32 v248, a98
  v_accvgpr_read_b32 v249, a99
  v_mul_f32 v248, v248, v247
  v_mul_f32 v249, v249, v247
  v_accvgpr_write_b32 a98, v248
  v_accvgpr_write_b32 a99, v249
  v_accvgpr_read_b32 v248, a100
  v_accvgpr_read_b32 v249, a101
  v_mul_f32 v248, v248, v247
  v_mul_f32 v249, v249, v247
  v_accvgpr_write_b32 a100, v248
  v_accvgpr_write_b32 a101, v249
  v_accvgpr_read_b32 v248, a102
  v_accvgpr_read_b32 v249, a103
  v_mul_f32 v248, v248, v247
  v_mul_f32 v249, v249, v247
  v_accvgpr_write_b32 a102, v248
  v_accvgpr_write_b32 a103, v249
  v_accvgpr_read_b32 v248, a104
  v_accvgpr_read_b32 v249, a105
  v_mul_f32 v248, v248, v247
  v_mul_f32 v249, v249, v247
  v_accvgpr_write_b32 a104, v248
  v_accvgpr_write_b32 a105, v249
  v_accvgpr_read_b32 v248, a106
  v_accvgpr_read_b32 v249, a107
  v_mul_f32 v248, v248, v247
  v_mul_f32 v249, v249, v247
  v_accvgpr_write_b32 a106, v248
  v_accvgpr_write_b32 a107, v249
  v_accvgpr_read_b32 v248, a108
  v_accvgpr_read_b32 v249, a109
  v_mul_f32 v248, v248, v247
  v_mul_f32 v249, v249, v247
  v_accvgpr_write_b32 a108, v248
  v_accvgpr_write_b32 a109, v249
  v_accvgpr_read_b32 v248, a110
  v_accvgpr_read_b32 v249, a111
  v_mul_f32 v248, v248, v247
  v_mul_f32 v249, v249, v247
  v_accvgpr_write_b32 a110, v248
  v_accvgpr_write_b32 a111, v249
  v_accvgpr_read_b32 v248, a112
  v_accvgpr_read_b32 v249, a113
  v_mul_f32 v248, v248, v247
  v_mul_f32 v249, v249, v247
  v_accvgpr_write_b32 a112, v248
  v_accvgpr_write_b32 a113, v249
  v_accvgpr_read_b32 v248, a114
  v_accvgpr_read_b32 v249, a115
  v_mul_f32 v248, v248, v247
  v_mul_f32 v249, v249, v247
  v_accvgpr_write_b32 a114, v248
  v_accvgpr_write_b32 a115, v249
  v_accvgpr_read_b32 v248, a116
  v_accvgpr_read_b32 v249, a117
  v_mul_f32 v248, v248, v247
  v_mul_f32 v249, v249, v247
  v_accvgpr_write_b32 a116, v248
  v_accvgpr_write_b32 a117, v249
  v_accvgpr_read_b32 v248, a118
  v_accvgpr_read_b32 v249, a119
  v_mul_f32 v248, v248, v247
  v_mul_f32 v249, v249, v247
  v_accvgpr_write_b32 a118, v248
  v_accvgpr_write_b32 a119, v249
  v_accvgpr_read_b32 v248, a120
  v_accvgpr_read_b32 v249, a121
  v_mul_f32 v248, v248, v247
  v_mul_f32 v249, v249, v247
  v_accvgpr_write_b32 a120, v248
  v_accvgpr_write_b32 a121, v249
  v_accvgpr_read_b32 v248, a122
  v_accvgpr_read_b32 v249, a123
  v_mul_f32 v248, v248, v247
  v_mul_f32 v249, v249, v247
  v_accvgpr_write_b32 a122, v248
  v_accvgpr_write_b32 a123, v249
  v_accvgpr_read_b32 v248, a124
  v_accvgpr_read_b32 v249, a125
  v_mul_f32 v248, v248, v247
  v_mul_f32 v249, v249, v247
  v_accvgpr_write_b32 a124, v248
  v_accvgpr_write_b32 a125, v249
  v_accvgpr_read_b32 v248, a126
  v_accvgpr_read_b32 v249, a127
  v_mul_f32 v248, v248, v247
  v_mul_f32 v249, v249, v247
  v_accvgpr_write_b32 a126, v248
  v_accvgpr_write_b32 a127, v249
  s_nop 2
  s_branch L_adaL_back_61
L_adaL_fb_99:
  s_nop 15
  v_max3_f32 v240, v32, v33, v34
  v_max3_f32 v240, v240, v35, v36
  v_max3_f32 v240, v240, v37, v38
  v_max_f32 v240, v240, v39
  v_max3_f32 v241, v40, v41, v42
  v_max3_f32 v241, v241, v43, v44
  v_max3_f32 v241, v241, v45, v46
  v_max_f32 v241, v241, v47
  v_mov_b32 v248, v240
  v_mov_b32 v249, v241
  s_nop 1
  v_permlane16_swap_b32 v240, v248
  v_permlane16_swap_b32 v241, v249
  s_nop 1
  v_max_f32 v240, v240, v248
  v_max_f32 v241, v241, v249
  v_mov_b32 v248, v240
  v_mov_b32 v249, v241
  s_nop 1
  v_permlane32_swap_b32 v240, v248
  v_permlane32_swap_b32 v241, v249
  s_nop 1
  v_max_f32 v240, v240, v248
  v_max_f32 v241, v241, v249
  v_max3_f32 v242, v48, v49, v50
  v_max3_f32 v242, v242, v51, v52
  v_max3_f32 v242, v242, v53, v54
  v_max_f32 v242, v242, v55
  v_max3_f32 v243, v56, v57, v58
  v_max3_f32 v243, v243, v59, v60
  v_max3_f32 v243, v243, v61, v62
  v_max_f32 v243, v243, v63
  v_mov_b32 v248, v242
  v_mov_b32 v249, v243
  s_nop 1
  v_permlane16_swap_b32 v242, v248
  v_permlane16_swap_b32 v243, v249
  s_nop 1
  v_max_f32 v242, v242, v248
  v_max_f32 v243, v243, v249
  v_mov_b32 v248, v242
  v_mov_b32 v249, v243
  s_nop 1
  v_permlane32_swap_b32 v242, v248
  v_permlane32_swap_b32 v243, v249
  s_nop 1
  v_max_f32 v242, v242, v248
  v_max_f32 v243, v243, v249
  v_max_f32 v240, 0, v240
  v_max_f32 v241, 0, v241
  v_max_f32 v242, 0, v242
  v_max_f32 v243, 0, v243
  v_exp_f32 v244, -v240
  v_exp_f32 v245, -v241
  v_exp_f32 v246, -v242
  v_exp_f32 v247, -v243
  v_sub_f32 v32, v32, v240
  v_sub_f32 v33, v33, v240
  v_sub_f32 v34, v34, v240
  v_sub_f32 v35, v35, v240
  v_sub_f32 v36, v36, v240
  v_sub_f32 v37, v37, v240
  v_sub_f32 v38, v38, v240
  v_sub_f32 v39, v39, v240
  v_sub_f32 v40, v40, v241
  v_sub_f32 v41, v41, v241
  v_sub_f32 v42, v42, v241
  v_sub_f32 v43, v43, v241
  v_sub_f32 v44, v44, v241
  v_sub_f32 v45, v45, v241
  v_sub_f32 v46, v46, v241
  v_sub_f32 v47, v47, v241
  v_sub_f32 v48, v48, v242
  v_sub_f32 v49, v49, v242
  v_sub_f32 v50, v50, v242
  v_sub_f32 v51, v51, v242
  v_sub_f32 v52, v52, v242
  v_sub_f32 v53, v53, v242
  v_sub_f32 v54, v54, v242
  v_sub_f32 v55, v55, v242
  v_sub_f32 v56, v56, v243
  v_sub_f32 v57, v57, v243
  v_sub_f32 v58, v58, v243
  v_sub_f32 v59, v59, v243
  v_sub_f32 v60, v60, v243
  v_sub_f32 v61, v61, v243
  v_sub_f32 v62, v62, v243
  v_sub_f32 v63, v63, v243
  v_exp_f32 v192, v32
  v_exp_f32 v193, v33
  v_exp_f32 v194, v34
  v_cvt_pk_bf16_f32 v112, v192, v193
  v_exp_f32 v195, v35
  v_exp_f32 v196, v40
  v_cvt_pk_bf16_f32 v113, v194, v195
  v_exp_f32 v197, v41
  v_exp_f32 v198, v42
  v_cvt_pk_bf16_f32 v116, v196, v197
  v_exp_f32 v199, v43
  v_exp_f32 v192, v48
  v_cvt_pk_bf16_f32 v117, v198, v199
  v_exp_f32 v193, v49
  v_exp_f32 v194, v50
  v_cvt_pk_bf16_f32 v120, v192, v193
  v_exp_f32 v195, v51
  v_exp_f32 v196, v56
  v_cvt_pk_bf16_f32 v121, v194, v195
  v_exp_f32 v197, v57
  v_exp_f32 v198, v58
  v_cvt_pk_bf16_f32 v124, v196, v197
  v_exp_f32 v199, v59
  v_exp_f32 v192, v36
  v_cvt_pk_bf16_f32 v125, v198, v199
  v_exp_f32 v193, v37
  v_exp_f32 v194, v38
  v_cvt_pk_bf16_f32 v114, v192, v193
  v_exp_f32 v195, v39
  v_exp_f32 v196, v44
  v_cvt_pk_bf16_f32 v115, v194, v195
  v_exp_f32 v197, v45
  v_exp_f32 v198, v46
  v_cvt_pk_bf16_f32 v118, v196, v197
  v_exp_f32 v199, v47
  v_exp_f32 v192, v52
  v_cvt_pk_bf16_f32 v119, v198, v199
  v_exp_f32 v193, v53
  v_exp_f32 v194, v54
  v_cvt_pk_bf16_f32 v122, v192, v193
  v_exp_f32 v195, v55
  v_exp_f32 v196, v60
  v_cvt_pk_bf16_f32 v123, v194, v195
  v_exp_f32 v197, v61
  v_exp_f32 v198, v62
  v_cvt_pk_bf16_f32 v126, v196, v197
  v_exp_f32 v199, v63
  s_nop 0
  v_cvt_pk_bf16_f32 v127, v198, v199
  s_nop 1
  v_mfma_f32_16x16x32_bf16 v[200:203], v[216:219], v[112:115], 0
  v_mfma_f32_16x16x32_bf16 v[204:207], v[216:219], v[116:119], 0
  v_mfma_f32_16x16x32_bf16 v[208:211], v[216:219], v[120:123], 0
  v_mfma_f32_16x16x32_bf16 v[212:215], v[216:219], v[124:127], 0
  v_sub_f32 v0, v0, v242
  v_sub_f32 v64, v64, v242
  v_sub_f32 v1, v1, v242
  v_sub_f32 v65, v65, v242
  v_sub_f32 v2, v2, v242
  v_sub_f32 v66, v66, v242
  v_sub_f32 v3, v3, v242
  v_sub_f32 v67, v67, v242
  v_sub_f32 v4, v4, v242
  v_sub_f32 v68, v68, v242
  v_sub_f32 v5, v5, v242
  v_sub_f32 v69, v69, v242
  v_sub_f32 v6, v6, v242
  v_sub_f32 v70, v70, v242
  v_sub_f32 v7, v7, v242
  v_sub_f32 v71, v71, v242
  v_sub_f32 v8, v8, v243
  v_sub_f32 v72, v72, v243
  v_sub_f32 v9, v9, v243
  v_sub_f32 v73, v73, v243
  v_sub_f32 v10, v10, v243
  v_sub_f32 v74, v74, v243
  v_sub_f32 v11, v11, v243
  v_sub_f32 v75, v75, v243
  v_sub_f32 v12, v12, v243
  v_sub_f32 v76, v76, v243
  v_sub_f32 v13, v13, v243
  v_sub_f32 v77, v77, v243
  v_sub_f32 v14, v14, v243
  v_sub_f32 v78, v78, v243
  v_sub_f32 v15, v15, v243
  v_sub_f32 v79, v79, v243
  v_sub_f32 v16, v16, v242
  v_sub_f32 v80, v80, v242
  v_sub_f32 v17, v17, v242
  v_sub_f32 v81, v81, v242
  v_sub_f32 v18, v18, v242
  v_sub_f32 v82, v82, v242
  v_sub_f32 v19, v19, v242
  v_sub_f32 v83, v83, v242
  v_sub_f32 v20, v20, v242
  v_sub_f32 v84, v84, v242
  v_sub_f32 v21, v21, v242
  v_sub_f32 v85, v85, v242
  v_sub_f32 v22, v22, v242
  v_sub_f32 v86, v86, v242
  v_sub_f32 v23, v23, v242
  v_sub_f32 v87, v87, v242
  v_sub_f32 v24, v24, v243
  v_sub_f32 v88, v88, v243
  v_sub_f32 v25, v25, v243
  v_sub_f32 v89, v89, v243
  v_sub_f32 v26, v26, v243
  v_sub_f32 v90, v90, v243
  v_sub_f32 v27, v27, v243
  v_sub_f32 v91, v91, v243
  v_sub_f32 v28, v28, v243
  v_sub_f32 v92, v92, v243
  v_sub_f32 v29, v29, v243
  v_sub_f32 v93, v93, v243
  v_sub_f32 v30, v30, v243
  v_sub_f32 v94, v94, v243
  v_sub_f32 v31, v31, v243
  v_sub_f32 v95, v95, v243
  v_exp_f32 v192, v0
  v_exp_f32 v193, v1
  v_exp_f32 v194, v2
  v_cvt_pk_bf16_f32 v96, v192, v193
  v_exp_f32 v195, v3
  v_exp_f32 v196, v8
  v_cvt_pk_bf16_f32 v97, v194, v195
  v_exp_f32 v197, v9
  v_exp_f32 v198, v10
  v_cvt_pk_bf16_f32 v100, v196, v197
  v_exp_f32 v199, v11
  v_exp_f32 v192, v4
  v_cvt_pk_bf16_f32 v101, v198, v199
  v_mul_f32 v220, v220, v244
  v_accvgpr_read_b32 v248, a0
  v_accvgpr_read_b32 v249, a1
  v_mul_f32 v248, v248, v244
  v_mul_f32 v249, v249, v244
  v_accvgpr_write_b32 a0, v248
  v_accvgpr_write_b32 a1, v249
  v_accvgpr_read_b32 v248, a2
  v_accvgpr_read_b32 v249, a3
  v_mul_f32 v248, v248, v244
  v_mul_f32 v249, v249, v244
  v_accvgpr_write_b32 a2, v248
  v_accvgpr_write_b32 a3, v249
  v_accvgpr_read_b32 v248, a4
  v_accvgpr_read_b32 v249, a5
  v_mul_f32 v248, v248, v244
  v_mul_f32 v249, v249, v244
  v_accvgpr_write_b32 a4, v248
  v_accvgpr_write_b32 a5, v249
  v_accvgpr_read_b32 v248, a6
  v_accvgpr_read_b32 v249, a7
  v_mul_f32 v248, v248, v244
  v_mul_f32 v249, v249, v244
  v_accvgpr_write_b32 a6, v248
  v_accvgpr_write_b32 a7, v249
  v_accvgpr_read_b32 v248, a8
  v_accvgpr_read_b32 v249, a9
  v_mul_f32 v248, v248, v244
  v_mul_f32 v249, v249, v244
  v_accvgpr_write_b32 a8, v248
  v_accvgpr_write_b32 a9, v249
  v_accvgpr_read_b32 v248, a10
  v_accvgpr_read_b32 v249, a11
  v_mul_f32 v248, v248, v244
  v_mul_f32 v249, v249, v244
  v_accvgpr_write_b32 a10, v248
  v_accvgpr_write_b32 a11, v249
  v_accvgpr_read_b32 v248, a12
  v_accvgpr_read_b32 v249, a13
  v_mul_f32 v248, v248, v244
  v_mul_f32 v249, v249, v244
  v_accvgpr_write_b32 a12, v248
  v_accvgpr_write_b32 a13, v249
  v_accvgpr_read_b32 v248, a14
  v_accvgpr_read_b32 v249, a15
  v_mul_f32 v248, v248, v244
  v_mul_f32 v249, v249, v244
  v_accvgpr_write_b32 a14, v248
  v_accvgpr_write_b32 a15, v249
  v_accvgpr_read_b32 v248, a16
  v_accvgpr_read_b32 v249, a17
  v_mul_f32 v248, v248, v244
  v_mul_f32 v249, v249, v244
  v_accvgpr_write_b32 a16, v248
  v_accvgpr_write_b32 a17, v249
  v_accvgpr_read_b32 v248, a18
  v_accvgpr_read_b32 v249, a19
  v_mul_f32 v248, v248, v244
  v_mul_f32 v249, v249, v244
  v_accvgpr_write_b32 a18, v248
  v_accvgpr_write_b32 a19, v249
  v_accvgpr_read_b32 v248, a20
  v_accvgpr_read_b32 v249, a21
  v_mul_f32 v248, v248, v244
  v_mul_f32 v249, v249, v244
  v_accvgpr_write_b32 a20, v248
  v_accvgpr_write_b32 a21, v249
  v_accvgpr_read_b32 v248, a22
  v_accvgpr_read_b32 v249, a23
  v_mul_f32 v248, v248, v244
  v_mul_f32 v249, v249, v244
  v_accvgpr_write_b32 a22, v248
  v_accvgpr_write_b32 a23, v249
  v_accvgpr_read_b32 v248, a24
  v_accvgpr_read_b32 v249, a25
  v_mul_f32 v248, v248, v244
  v_mul_f32 v249, v249, v244
  v_accvgpr_write_b32 a24, v248
  v_accvgpr_write_b32 a25, v249
  v_accvgpr_read_b32 v248, a26
  v_accvgpr_read_b32 v249, a27
  v_mul_f32 v248, v248, v244
  v_mul_f32 v249, v249, v244
  v_accvgpr_write_b32 a26, v248
  v_accvgpr_write_b32 a27, v249
  v_accvgpr_read_b32 v248, a28
  v_accvgpr_read_b32 v249, a29
  v_mul_f32 v248, v248, v244
  v_mul_f32 v249, v249, v244
  v_accvgpr_write_b32 a28, v248
  v_accvgpr_write_b32 a29, v249
  v_accvgpr_read_b32 v248, a30
  v_accvgpr_read_b32 v249, a31
  v_mul_f32 v248, v248, v244
  v_mul_f32 v249, v249, v244
  v_accvgpr_write_b32 a30, v248
  v_accvgpr_write_b32 a31, v249
  v_mul_f32 v221, v221, v245
  v_accvgpr_read_b32 v248, a32
  v_accvgpr_read_b32 v249, a33
  v_mul_f32 v248, v248, v245
  v_mul_f32 v249, v249, v245
  v_accvgpr_write_b32 a32, v248
  v_accvgpr_write_b32 a33, v249
  v_accvgpr_read_b32 v248, a34
  v_accvgpr_read_b32 v249, a35
  v_mul_f32 v248, v248, v245
  v_mul_f32 v249, v249, v245
  v_accvgpr_write_b32 a34, v248
  v_accvgpr_write_b32 a35, v249
  v_accvgpr_read_b32 v248, a36
  v_accvgpr_read_b32 v249, a37
  v_mul_f32 v248, v248, v245
  v_mul_f32 v249, v249, v245
  v_accvgpr_write_b32 a36, v248
  v_accvgpr_write_b32 a37, v249
  v_accvgpr_read_b32 v248, a38
  v_accvgpr_read_b32 v249, a39
  v_mul_f32 v248, v248, v245
  v_mul_f32 v249, v249, v245
  v_accvgpr_write_b32 a38, v248
  v_accvgpr_write_b32 a39, v249
  v_accvgpr_read_b32 v248, a40
  v_accvgpr_read_b32 v249, a41
  v_mul_f32 v248, v248, v245
  v_mul_f32 v249, v249, v245
  v_accvgpr_write_b32 a40, v248
  v_accvgpr_write_b32 a41, v249
  v_accvgpr_read_b32 v248, a42
  v_accvgpr_read_b32 v249, a43
  v_mul_f32 v248, v248, v245
  v_mul_f32 v249, v249, v245
  v_accvgpr_write_b32 a42, v248
  v_accvgpr_write_b32 a43, v249
  v_accvgpr_read_b32 v248, a44
  v_accvgpr_read_b32 v249, a45
  v_mul_f32 v248, v248, v245
  v_mul_f32 v249, v249, v245
  v_accvgpr_write_b32 a44, v248
  v_accvgpr_write_b32 a45, v249
  v_accvgpr_read_b32 v248, a46
  v_accvgpr_read_b32 v249, a47
  v_mul_f32 v248, v248, v245
  v_mul_f32 v249, v249, v245
  v_accvgpr_write_b32 a46, v248
  v_accvgpr_write_b32 a47, v249
  v_accvgpr_read_b32 v248, a48
  v_accvgpr_read_b32 v249, a49
  v_mul_f32 v248, v248, v245
  v_mul_f32 v249, v249, v245
  v_accvgpr_write_b32 a48, v248
  v_accvgpr_write_b32 a49, v249
  v_accvgpr_read_b32 v248, a50
  v_accvgpr_read_b32 v249, a51
  v_mul_f32 v248, v248, v245
  v_mul_f32 v249, v249, v245
  v_accvgpr_write_b32 a50, v248
  v_accvgpr_write_b32 a51, v249
  v_accvgpr_read_b32 v248, a52
  v_accvgpr_read_b32 v249, a53
  v_mul_f32 v248, v248, v245
  v_mul_f32 v249, v249, v245
  v_accvgpr_write_b32 a52, v248
  v_accvgpr_write_b32 a53, v249
  v_accvgpr_read_b32 v248, a54
  v_accvgpr_read_b32 v249, a55
  v_mul_f32 v248, v248, v245
  v_mul_f32 v249, v249, v245
  v_accvgpr_write_b32 a54, v248
  v_accvgpr_write_b32 a55, v249
  v_accvgpr_read_b32 v248, a56
  v_accvgpr_read_b32 v249, a57
  v_mul_f32 v248, v248, v245
  v_mul_f32 v249, v249, v245
  v_accvgpr_write_b32 a56, v248
  v_accvgpr_write_b32 a57, v249
  v_accvgpr_read_b32 v248, a58
  v_accvgpr_read_b32 v249, a59
  v_mul_f32 v248, v248, v245
  v_mul_f32 v249, v249, v245
  v_accvgpr_write_b32 a58, v248
  v_accvgpr_write_b32 a59, v249
  v_accvgpr_read_b32 v248, a60
  v_accvgpr_read_b32 v249, a61
  v_mul_f32 v248, v248, v245
  v_mul_f32 v249, v249, v245
  v_accvgpr_write_b32 a60, v248
  v_accvgpr_write_b32 a61, v249
  v_accvgpr_read_b32 v248, a62
  v_accvgpr_read_b32 v249, a63
  v_mul_f32 v248, v248, v245
  v_mul_f32 v249, v249, v245
  v_accvgpr_write_b32 a62, v248
  v_accvgpr_write_b32 a63, v249
  v_mul_f32 v222, v222, v246
  v_accvgpr_read_b32 v248, a64
  v_accvgpr_read_b32 v249, a65
  v_mul_f32 v248, v248, v246
  v_mul_f32 v249, v249, v246
  v_accvgpr_write_b32 a64, v248
  v_accvgpr_write_b32 a65, v249
  v_accvgpr_read_b32 v248, a66
  v_accvgpr_read_b32 v249, a67
  v_mul_f32 v248, v248, v246
  v_mul_f32 v249, v249, v246
  v_accvgpr_write_b32 a66, v248
  v_accvgpr_write_b32 a67, v249
  v_accvgpr_read_b32 v248, a68
  v_accvgpr_read_b32 v249, a69
  v_mul_f32 v248, v248, v246
  v_mul_f32 v249, v249, v246
  v_accvgpr_write_b32 a68, v248
  v_accvgpr_write_b32 a69, v249
  v_accvgpr_read_b32 v248, a70
  v_accvgpr_read_b32 v249, a71
  v_mul_f32 v248, v248, v246
  v_mul_f32 v249, v249, v246
  v_accvgpr_write_b32 a70, v248
  v_accvgpr_write_b32 a71, v249
  v_accvgpr_read_b32 v248, a72
  v_accvgpr_read_b32 v249, a73
  v_mul_f32 v248, v248, v246
  v_mul_f32 v249, v249, v246
  v_accvgpr_write_b32 a72, v248
  v_accvgpr_write_b32 a73, v249
  v_accvgpr_read_b32 v248, a74
  v_accvgpr_read_b32 v249, a75
  v_mul_f32 v248, v248, v246
  v_mul_f32 v249, v249, v246
  v_accvgpr_write_b32 a74, v248
  v_accvgpr_write_b32 a75, v249
  v_accvgpr_read_b32 v248, a76
  v_accvgpr_read_b32 v249, a77
  v_mul_f32 v248, v248, v246
  v_mul_f32 v249, v249, v246
  v_accvgpr_write_b32 a76, v248
  v_accvgpr_write_b32 a77, v249
  v_accvgpr_read_b32 v248, a78
  v_accvgpr_read_b32 v249, a79
  v_mul_f32 v248, v248, v246
  v_mul_f32 v249, v249, v246
  v_accvgpr_write_b32 a78, v248
  v_accvgpr_write_b32 a79, v249
  v_accvgpr_read_b32 v248, a80
  v_accvgpr_read_b32 v249, a81
  v_mul_f32 v248, v248, v246
  v_mul_f32 v249, v249, v246
  v_accvgpr_write_b32 a80, v248
  v_accvgpr_write_b32 a81, v249
  v_accvgpr_read_b32 v248, a82
  v_accvgpr_read_b32 v249, a83
  v_mul_f32 v248, v248, v246
  v_mul_f32 v249, v249, v246
  v_accvgpr_write_b32 a82, v248
  v_accvgpr_write_b32 a83, v249
  v_accvgpr_read_b32 v248, a84
  v_accvgpr_read_b32 v249, a85
  v_mul_f32 v248, v248, v246
  v_mul_f32 v249, v249, v246
  v_accvgpr_write_b32 a84, v248
  v_accvgpr_write_b32 a85, v249
  v_accvgpr_read_b32 v248, a86
  v_accvgpr_read_b32 v249, a87
  v_mul_f32 v248, v248, v246
  v_mul_f32 v249, v249, v246
  v_accvgpr_write_b32 a86, v248
  v_accvgpr_write_b32 a87, v249
  v_accvgpr_read_b32 v248, a88
  v_accvgpr_read_b32 v249, a89
  v_mul_f32 v248, v248, v246
  v_mul_f32 v249, v249, v246
  v_accvgpr_write_b32 a88, v248
  v_accvgpr_write_b32 a89, v249
  v_accvgpr_read_b32 v248, a90
  v_accvgpr_read_b32 v249, a91
  v_mul_f32 v248, v248, v246
  v_mul_f32 v249, v249, v246
  v_accvgpr_write_b32 a90, v248
  v_accvgpr_write_b32 a91, v249
  v_accvgpr_read_b32 v248, a92
  v_accvgpr_read_b32 v249, a93
  v_mul_f32 v248, v248, v246
  v_mul_f32 v249, v249, v246
  v_accvgpr_write_b32 a92, v248
  v_accvgpr_write_b32 a93, v249
  v_accvgpr_read_b32 v248, a94
  v_accvgpr_read_b32 v249, a95
  v_mul_f32 v248, v248, v246
  v_mul_f32 v249, v249, v246
  v_accvgpr_write_b32 a94, v248
  v_accvgpr_write_b32 a95, v249
  v_mul_f32 v223, v223, v247
  v_accvgpr_read_b32 v248, a96
  v_accvgpr_read_b32 v249, a97
  v_mul_f32 v248, v248, v247
  v_mul_f32 v249, v249, v247
  v_accvgpr_write_b32 a96, v248
  v_accvgpr_write_b32 a97, v249
  v_accvgpr_read_b32 v248, a98
  v_accvgpr_read_b32 v249, a99
  v_mul_f32 v248, v248, v247
  v_mul_f32 v249, v249, v247
  v_accvgpr_write_b32 a98, v248
  v_accvgpr_write_b32 a99, v249
  v_accvgpr_read_b32 v248, a100
  v_accvgpr_read_b32 v249, a101
  v_mul_f32 v248, v248, v247
  v_mul_f32 v249, v249, v247
  v_accvgpr_write_b32 a100, v248
  v_accvgpr_write_b32 a101, v249
  v_accvgpr_read_b32 v248, a102
  v_accvgpr_read_b32 v249, a103
  v_mul_f32 v248, v248, v247
  v_mul_f32 v249, v249, v247
  v_accvgpr_write_b32 a102, v248
  v_accvgpr_write_b32 a103, v249
  v_accvgpr_read_b32 v248, a104
  v_accvgpr_read_b32 v249, a105
  v_mul_f32 v248, v248, v247
  v_mul_f32 v249, v249, v247
  v_accvgpr_write_b32 a104, v248
  v_accvgpr_write_b32 a105, v249
  v_accvgpr_read_b32 v248, a106
  v_accvgpr_read_b32 v249, a107
  v_mul_f32 v248, v248, v247
  v_mul_f32 v249, v249, v247
  v_accvgpr_write_b32 a106, v248
  v_accvgpr_write_b32 a107, v249
  v_accvgpr_read_b32 v248, a108
  v_accvgpr_read_b32 v249, a109
  v_mul_f32 v248, v248, v247
  v_mul_f32 v249, v249, v247
  v_accvgpr_write_b32 a108, v248
  v_accvgpr_write_b32 a109, v249
  v_accvgpr_read_b32 v248, a110
  v_accvgpr_read_b32 v249, a111
  v_mul_f32 v248, v248, v247
  v_mul_f32 v249, v249, v247
  v_accvgpr_write_b32 a110, v248
  v_accvgpr_write_b32 a111, v249
  v_accvgpr_read_b32 v248, a112
  v_accvgpr_read_b32 v249, a113
  v_mul_f32 v248, v248, v247
  v_mul_f32 v249, v249, v247
  v_accvgpr_write_b32 a112, v248
  v_accvgpr_write_b32 a113, v249
  v_accvgpr_read_b32 v248, a114
  v_accvgpr_read_b32 v249, a115
  v_mul_f32 v248, v248, v247
  v_mul_f32 v249, v249, v247
  v_accvgpr_write_b32 a114, v248
  v_accvgpr_write_b32 a115, v249
  v_accvgpr_read_b32 v248, a116
  v_accvgpr_read_b32 v249, a117
  v_mul_f32 v248, v248, v247
  v_mul_f32 v249, v249, v247
  v_accvgpr_write_b32 a116, v248
  v_accvgpr_write_b32 a117, v249
  v_accvgpr_read_b32 v248, a118
  v_accvgpr_read_b32 v249, a119
  v_mul_f32 v248, v248, v247
  v_mul_f32 v249, v249, v247
  v_accvgpr_write_b32 a118, v248
  v_accvgpr_write_b32 a119, v249
  v_accvgpr_read_b32 v248, a120
  v_accvgpr_read_b32 v249, a121
  v_mul_f32 v248, v248, v247
  v_mul_f32 v249, v249, v247
  v_accvgpr_write_b32 a120, v248
  v_accvgpr_write_b32 a121, v249
  v_accvgpr_read_b32 v248, a122
  v_accvgpr_read_b32 v249, a123
  v_mul_f32 v248, v248, v247
  v_mul_f32 v249, v249, v247
  v_accvgpr_write_b32 a122, v248
  v_accvgpr_write_b32 a123, v249
  v_accvgpr_read_b32 v248, a124
  v_accvgpr_read_b32 v249, a125
  v_mul_f32 v248, v248, v247
  v_mul_f32 v249, v249, v247
  v_accvgpr_write_b32 a124, v248
  v_accvgpr_write_b32 a125, v249
  v_accvgpr_read_b32 v248, a126
  v_accvgpr_read_b32 v249, a127
  v_mul_f32 v248, v248, v247
  v_mul_f32 v249, v249, v247
  v_accvgpr_write_b32 a126, v248
  v_accvgpr_write_b32 a127, v249
  s_nop 2
  s_branch L_adaL_back_100
L_adaL_fb_64:
  s_nop 15
  v_max3_f32 v240, v0, v1, v2
  v_max3_f32 v240, v240, v3, v4
  v_max3_f32 v240, v240, v5, v6
  v_max_f32 v240, v240, v7
  v_max3_f32 v241, v8, v9, v10
  v_max3_f32 v241, v241, v11, v12
  v_max3_f32 v241, v241, v13, v14
  v_max_f32 v241, v241, v15
  v_mov_b32 v248, v240
  v_mov_b32 v249, v241
  s_nop 1
  v_permlane16_swap_b32 v240, v248
  v_permlane16_swap_b32 v241, v249
  s_nop 1
  v_max_f32 v240, v240, v248
  v_max_f32 v241, v241, v249
  v_mov_b32 v248, v240
  v_mov_b32 v249, v241
  s_nop 1
  v_permlane32_swap_b32 v240, v248
  v_permlane32_swap_b32 v241, v249
  s_nop 1
  v_max_f32 v240, v240, v248
  v_max_f32 v241, v241, v249
  v_max3_f32 v242, v16, v17, v18
  v_max3_f32 v242, v242, v19, v20
  v_max3_f32 v242, v242, v21, v22
  v_max_f32 v242, v242, v23
  v_max3_f32 v243, v24, v25, v26
  v_max3_f32 v243, v243, v27, v28
  v_max3_f32 v243, v243, v29, v30
  v_max_f32 v243, v243, v31
  v_mov_b32 v248, v242
  v_mov_b32 v249, v243
  s_nop 1
  v_permlane16_swap_b32 v242, v248
  v_permlane16_swap_b32 v243, v249
  s_nop 1
  v_max_f32 v242, v242, v248
  v_max_f32 v243, v243, v249
  v_mov_b32 v248, v242
  v_mov_b32 v249, v243
  s_nop 1
  v_permlane32_swap_b32 v242, v248
  v_permlane32_swap_b32 v243, v249
  s_nop 1
  v_max_f32 v242, v242, v248
  v_max_f32 v243, v243, v249
  v_max_f32 v240, 0, v240
  v_max_f32 v241, 0, v241
  v_max_f32 v242, 0, v242
  v_max_f32 v243, 0, v243
  v_max_f32 v240, v240, v242
  v_mov_b32 v242, v240
  v_max_f32 v241, v241, v243
  v_mov_b32 v243, v241
  v_exp_f32 v244, -v240
  v_exp_f32 v245, -v241
  v_exp_f32 v246, -v242
  v_exp_f32 v247, -v243
  v_sub_f32 v0, v0, v240
  v_sub_f32 v1, v1, v240
  v_sub_f32 v2, v2, v240
  v_sub_f32 v3, v3, v240
  v_sub_f32 v4, v4, v240
  v_sub_f32 v5, v5, v240
  v_sub_f32 v6, v6, v240
  v_sub_f32 v7, v7, v240
  v_sub_f32 v8, v8, v241
  v_sub_f32 v9, v9, v241
  v_sub_f32 v10, v10, v241
  v_sub_f32 v11, v11, v241
  v_sub_f32 v12, v12, v241
  v_sub_f32 v13, v13, v241
  v_sub_f32 v14, v14, v241
  v_sub_f32 v15, v15, v241
  v_sub_f32 v16, v16, v242
  v_sub_f32 v17, v17, v242
  v_sub_f32 v18, v18, v242
  v_sub_f32 v19, v19, v242
  v_sub_f32 v20, v20, v242
  v_sub_f32 v21, v21, v242
  v_sub_f32 v22, v22, v242
  v_sub_f32 v23, v23, v242
  v_sub_f32 v24, v24, v243
  v_sub_f32 v25, v25, v243
  v_sub_f32 v26, v26, v243
  v_sub_f32 v27, v27, v243
  v_sub_f32 v28, v28, v243
  v_sub_f32 v29, v29, v243
  v_sub_f32 v30, v30, v243
  v_sub_f32 v31, v31, v243
  v_exp_f32 v192, v0
  v_exp_f32 v193, v1
  v_exp_f32 v194, v2
  v_cvt_pk_bf16_f32 v96, v192, v193
  v_exp_f32 v195, v3
  v_exp_f32 v196, v8
  v_cvt_pk_bf16_f32 v97, v194, v195
  v_exp_f32 v197, v9
  v_exp_f32 v198, v10
  v_cvt_pk_bf16_f32 v100, v196, v197
  v_exp_f32 v199, v11
  v_exp_f32 v192, v4
  v_cvt_pk_bf16_f32 v101, v198, v199
  v_exp_f32 v193, v5
  v_exp_f32 v194, v6
  v_cvt_pk_bf16_f32 v98, v192, v193
  v_exp_f32 v195, v7
  v_exp_f32 v196, v12
  v_cvt_pk_bf16_f32 v99, v194, v195
  v_exp_f32 v197, v13
  v_exp_f32 v198, v14
  v_cvt_pk_bf16_f32 v102, v196, v197
  v_exp_f32 v199, v15
  v_exp_f32 v192, v16
  v_cvt_pk_bf16_f32 v103, v198, v199
  v_exp_f32 v193, v17
  v_exp_f32 v194, v18
  v_cvt_pk_bf16_f32 v104, v192, v193
  v_exp_f32 v195, v19
  v_exp_f32 v196, v24
  v_cvt_pk_bf16_f32 v105, v194, v195
  v_exp_f32 v197, v25
  v_exp_f32 v198, v26
  v_cvt_pk_bf16_f32 v108, v196, v197
  v_exp_f32 v199, v27
  v_exp_f32 v192, v20
  v_cvt_pk_bf16_f32 v109, v198, v199
  v_exp_f32 v193, v21
  v_exp_f32 v194, v22
  v_cvt_pk_bf16_f32 v106, v192, v193
  v_exp_f32 v195, v23
  v_exp_f32 v196, v28
  v_cvt_pk_bf16_f32 v107, v194, v195
  v_exp_f32 v197, v29
  v_exp_f32 v198, v30
  v_cvt_pk_bf16_f32 v110, v196, v197
  v_exp_f32 v199, v31
  s_nop 0
  v_cvt_pk_bf16_f32 v111, v198, v199
  s_nop 1
  v_mfma_f32_16x16x32_bf16 v[208:211], v[216:219], v[96:99], 0
  v_mfma_f32_16x16x32_bf16 v[212:215], v[216:219], v[100:103], 0
  v_mfma_f32_16x16x32_bf16 v[208:211], v[216:219], v[104:107], v[208:211]
  v_mfma_f32_16x16x32_bf16 v[212:215], v[216:219], v[108:111], v[212:215]
  v_sub_f32 v32, v32, v242
  v_sub_f32 v64, v64, v242
  v_sub_f32 v33, v33, v242
  v_sub_f32 v65, v65, v242
  v_sub_f32 v34, v34, v242
  v_sub_f32 v66, v66, v242
  v_sub_f32 v35, v35, v242
  v_sub_f32 v67, v67, v242
  v_sub_f32 v36, v36, v242
  v_sub_f32 v68, v68, v242
  v_sub_f32 v37, v37, v242
  v_sub_f32 v69, v69, v242
  v_sub_f32 v38, v38, v242
  v_sub_f32 v70, v70, v242
  v_sub_f32 v39, v39, v242
  v_sub_f32 v71, v71, v242
  v_sub_f32 v40, v40, v243
  v_sub_f32 v72, v72, v243
  v_sub_f32 v41, v41, v243
  v_sub_f32 v73, v73, v243
  v_sub_f32 v42, v42, v243
  v_sub_f32 v74, v74, v243
  v_sub_f32 v43, v43, v243
  v_sub_f32 v75, v75, v243
  v_sub_f32 v44, v44, v243
  v_sub_f32 v76, v76, v243
  v_sub_f32 v45, v45, v243
  v_sub_f32 v77, v77, v243
  v_sub_f32 v46, v46, v243
  v_sub_f32 v78, v78, v243
  v_sub_f32 v47, v47, v243
  v_sub_f32 v79, v79, v243
  v_sub_f32 v48, v48, v242
  v_sub_f32 v80, v80, v242
  v_sub_f32 v49, v49, v242
  v_sub_f32 v81, v81, v242
  v_sub_f32 v50, v50, v242
  v_sub_f32 v82, v82, v242
  v_sub_f32 v51, v51, v242
  v_sub_f32 v83, v83, v242
  v_sub_f32 v52, v52, v242
  v_sub_f32 v84, v84, v242
  v_sub_f32 v53, v53, v242
  v_sub_f32 v85, v85, v242
  v_sub_f32 v54, v54, v242
  v_sub_f32 v86, v86, v242
  v_sub_f32 v55, v55, v242
  v_sub_f32 v87, v87, v242
  v_sub_f32 v56, v56, v243
  v_sub_f32 v88, v88, v243
  v_sub_f32 v57, v57, v243
  v_sub_f32 v89, v89, v243
  v_sub_f32 v58, v58, v243
  v_sub_f32 v90, v90, v243
  v_sub_f32 v59, v59, v243
  v_sub_f32 v91, v91, v243
  v_sub_f32 v60, v60, v243
  v_sub_f32 v92, v92, v243
  v_sub_f32 v61, v61, v243
  v_sub_f32 v93, v93, v243
  v_sub_f32 v62, v62, v243
  v_sub_f32 v94, v94, v243
  v_sub_f32 v63, v63, v243
  v_sub_f32 v95, v95, v243
  v_exp_f32 v192, v32
  v_exp_f32 v193, v33
  v_exp_f32 v194, v34
  v_cvt_pk_bf16_f32 v112, v192, v193
  v_exp_f32 v195, v35
  v_exp_f32 v196, v40
  v_cvt_pk_bf16_f32 v113, v194, v195
  v_exp_f32 v197, v41
  v_exp_f32 v198, v42
  v_cvt_pk_bf16_f32 v116, v196, v197
  v_exp_f32 v199, v43
  v_exp_f32 v192, v36
  v_cvt_pk_bf16_f32 v117, v198, v199
  v_mul_f32 v222, v222, v246
  v_accvgpr_read_b32 v248, a64
  v_accvgpr_read_b32 v249, a65
  v_mul_f32 v248, v248, v246
  v_mul_f32 v249, v249, v246
  v_accvgpr_write_b32 a64, v248
  v_accvgpr_write_b32 a65, v249
  v_accvgpr_read_b32 v248, a66
  v_accvgpr_read_b32 v249, a67
  v_mul_f32 v248, v248, v246
  v_mul_f32 v249, v249, v246
  v_accvgpr_write_b32 a66, v248
  v_accvgpr_write_b32 a67, v249
  v_accvgpr_read_b32 v248, a68
  v_accvgpr_read_b32 v249, a69
  v_mul_f32 v248, v248, v246
  v_mul_f32 v249, v249, v246
  v_accvgpr_write_b32 a68, v248
  v_accvgpr_write_b32 a69, v249
  v_accvgpr_read_b32 v248, a70
  v_accvgpr_read_b32 v249, a71
  v_mul_f32 v248, v248, v246
  v_mul_f32 v249, v249, v246
  v_accvgpr_write_b32 a70, v248
  v_accvgpr_write_b32 a71, v249
  v_accvgpr_read_b32 v248, a72
  v_accvgpr_read_b32 v249, a73
  v_mul_f32 v248, v248, v246
  v_mul_f32 v249, v249, v246
  v_accvgpr_write_b32 a72, v248
  v_accvgpr_write_b32 a73, v249
  v_accvgpr_read_b32 v248, a74
  v_accvgpr_read_b32 v249, a75
  v_mul_f32 v248, v248, v246
  v_mul_f32 v249, v249, v246
  v_accvgpr_write_b32 a74, v248
  v_accvgpr_write_b32 a75, v249
  v_accvgpr_read_b32 v248, a76
  v_accvgpr_read_b32 v249, a77
  v_mul_f32 v248, v248, v246
  v_mul_f32 v249, v249, v246
  v_accvgpr_write_b32 a76, v248
  v_accvgpr_write_b32 a77, v249
  v_accvgpr_read_b32 v248, a78
  v_accvgpr_read_b32 v249, a79
  v_mul_f32 v248, v248, v246
  v_mul_f32 v249, v249, v246
  v_accvgpr_write_b32 a78, v248
  v_accvgpr_write_b32 a79, v249
  v_accvgpr_read_b32 v248, a80
  v_accvgpr_read_b32 v249, a81
  v_mul_f32 v248, v248, v246
  v_mul_f32 v249, v249, v246
  v_accvgpr_write_b32 a80, v248
  v_accvgpr_write_b32 a81, v249
  v_accvgpr_read_b32 v248, a82
  v_accvgpr_read_b32 v249, a83
  v_mul_f32 v248, v248, v246
  v_mul_f32 v249, v249, v246
  v_accvgpr_write_b32 a82, v248
  v_accvgpr_write_b32 a83, v249
  v_accvgpr_read_b32 v248, a84
  v_accvgpr_read_b32 v249, a85
  v_mul_f32 v248, v248, v246
  v_mul_f32 v249, v249, v246
  v_accvgpr_write_b32 a84, v248
  v_accvgpr_write_b32 a85, v249
  v_accvgpr_read_b32 v248, a86
  v_accvgpr_read_b32 v249, a87
  v_mul_f32 v248, v248, v246
  v_mul_f32 v249, v249, v246
  v_accvgpr_write_b32 a86, v248
  v_accvgpr_write_b32 a87, v249
  v_accvgpr_read_b32 v248, a88
  v_accvgpr_read_b32 v249, a89
  v_mul_f32 v248, v248, v246
  v_mul_f32 v249, v249, v246
  v_accvgpr_write_b32 a88, v248
  v_accvgpr_write_b32 a89, v249
  v_accvgpr_read_b32 v248, a90
  v_accvgpr_read_b32 v249, a91
  v_mul_f32 v248, v248, v246
  v_mul_f32 v249, v249, v246
  v_accvgpr_write_b32 a90, v248
  v_accvgpr_write_b32 a91, v249
  v_accvgpr_read_b32 v248, a92
  v_accvgpr_read_b32 v249, a93
  v_mul_f32 v248, v248, v246
  v_mul_f32 v249, v249, v246
  v_accvgpr_write_b32 a92, v248
  v_accvgpr_write_b32 a93, v249
  v_accvgpr_read_b32 v248, a94
  v_accvgpr_read_b32 v249, a95
  v_mul_f32 v248, v248, v246
  v_mul_f32 v249, v249, v246
  v_accvgpr_write_b32 a94, v248
  v_accvgpr_write_b32 a95, v249
  v_mul_f32 v223, v223, v247
  v_accvgpr_read_b32 v248, a96
  v_accvgpr_read_b32 v249, a97
  v_mul_f32 v248, v248, v247
  v_mul_f32 v249, v249, v247
  v_accvgpr_write_b32 a96, v248
  v_accvgpr_write_b32 a97, v249
  v_accvgpr_read_b32 v248, a98
  v_accvgpr_read_b32 v249, a99
  v_mul_f32 v248, v248, v247
  v_mul_f32 v249, v249, v247
  v_accvgpr_write_b32 a98, v248
  v_accvgpr_write_b32 a99, v249
  v_accvgpr_read_b32 v248, a100
  v_accvgpr_read_b32 v249, a101
  v_mul_f32 v248, v248, v247
  v_mul_f32 v249, v249, v247
  v_accvgpr_write_b32 a100, v248
  v_accvgpr_write_b32 a101, v249
  v_accvgpr_read_b32 v248, a102
  v_accvgpr_read_b32 v249, a103
  v_mul_f32 v248, v248, v247
  v_mul_f32 v249, v249, v247
  v_accvgpr_write_b32 a102, v248
  v_accvgpr_write_b32 a103, v249
  v_accvgpr_read_b32 v248, a104
  v_accvgpr_read_b32 v249, a105
  v_mul_f32 v248, v248, v247
  v_mul_f32 v249, v249, v247
  v_accvgpr_write_b32 a104, v248
  v_accvgpr_write_b32 a105, v249
  v_accvgpr_read_b32 v248, a106
  v_accvgpr_read_b32 v249, a107
  v_mul_f32 v248, v248, v247
  v_mul_f32 v249, v249, v247
  v_accvgpr_write_b32 a106, v248
  v_accvgpr_write_b32 a107, v249
  v_accvgpr_read_b32 v248, a108
  v_accvgpr_read_b32 v249, a109
  v_mul_f32 v248, v248, v247
  v_mul_f32 v249, v249, v247
  v_accvgpr_write_b32 a108, v248
  v_accvgpr_write_b32 a109, v249
  v_accvgpr_read_b32 v248, a110
  v_accvgpr_read_b32 v249, a111
  v_mul_f32 v248, v248, v247
  v_mul_f32 v249, v249, v247
  v_accvgpr_write_b32 a110, v248
  v_accvgpr_write_b32 a111, v249
  v_accvgpr_read_b32 v248, a112
  v_accvgpr_read_b32 v249, a113
  v_mul_f32 v248, v248, v247
  v_mul_f32 v249, v249, v247
  v_accvgpr_write_b32 a112, v248
  v_accvgpr_write_b32 a113, v249
  v_accvgpr_read_b32 v248, a114
  v_accvgpr_read_b32 v249, a115
  v_mul_f32 v248, v248, v247
  v_mul_f32 v249, v249, v247
  v_accvgpr_write_b32 a114, v248
  v_accvgpr_write_b32 a115, v249
  v_accvgpr_read_b32 v248, a116
  v_accvgpr_read_b32 v249, a117
  v_mul_f32 v248, v248, v247
  v_mul_f32 v249, v249, v247
  v_accvgpr_write_b32 a116, v248
  v_accvgpr_write_b32 a117, v249
  v_accvgpr_read_b32 v248, a118
  v_accvgpr_read_b32 v249, a119
  v_mul_f32 v248, v248, v247
  v_mul_f32 v249, v249, v247
  v_accvgpr_write_b32 a118, v248
  v_accvgpr_write_b32 a119, v249
  v_accvgpr_read_b32 v248, a120
  v_accvgpr_read_b32 v249, a121
  v_mul_f32 v248, v248, v247
  v_mul_f32 v249, v249, v247
  v_accvgpr_write_b32 a120, v248
  v_accvgpr_write_b32 a121, v249
  v_accvgpr_read_b32 v248, a122
  v_accvgpr_read_b32 v249, a123
  v_mul_f32 v248, v248, v247
  v_mul_f32 v249, v249, v247
  v_accvgpr_write_b32 a122, v248
  v_accvgpr_write_b32 a123, v249
  v_accvgpr_read_b32 v248, a124
  v_accvgpr_read_b32 v249, a125
  v_mul_f32 v248, v248, v247
  v_mul_f32 v249, v249, v247
  v_accvgpr_write_b32 a124, v248
  v_accvgpr_write_b32 a125, v249
  v_accvgpr_read_b32 v248, a126
  v_accvgpr_read_b32 v249, a127
  v_mul_f32 v248, v248, v247
  v_mul_f32 v249, v249, v247
  v_accvgpr_write_b32 a126, v248
  v_accvgpr_write_b32 a127, v249
  s_nop 2
  s_branch L_adaL_back_65
L_adaL_fb_66:
  s_nop 15
  v_max3_f32 v240, v32, v33, v34
  v_max3_f32 v240, v240, v35, v36
  v_max3_f32 v240, v240, v37, v38
  v_max_f32 v240, v240, v39
  v_max3_f32 v241, v40, v41, v42
  v_max3_f32 v241, v241, v43, v44
  v_max3_f32 v241, v241, v45, v46
  v_max_f32 v241, v241, v47
  v_mov_b32 v248, v240
  v_mov_b32 v249, v241
  s_nop 1
  v_permlane16_swap_b32 v240, v248
  v_permlane16_swap_b32 v241, v249
  s_nop 1
  v_max_f32 v240, v240, v248
  v_max_f32 v241, v241, v249
  v_mov_b32 v248, v240
  v_mov_b32 v249, v241
  s_nop 1
  v_permlane32_swap_b32 v240, v248
  v_permlane32_swap_b32 v241, v249
  s_nop 1
  v_max_f32 v240, v240, v248
  v_max_f32 v241, v241, v249
  v_max3_f32 v242, v48, v49, v50
  v_max3_f32 v242, v242, v51, v52
  v_max3_f32 v242, v242, v53, v54
  v_max_f32 v242, v242, v55
  v_max3_f32 v243, v56, v57, v58
  v_max3_f32 v243, v243, v59, v60
  v_max3_f32 v243, v243, v61, v62
  v_max_f32 v243, v243, v63
  v_mov_b32 v248, v242
  v_mov_b32 v249, v243
  s_nop 1
  v_permlane16_swap_b32 v242, v248
  v_permlane16_swap_b32 v243, v249
  s_nop 1
  v_max_f32 v242, v242, v248
  v_max_f32 v243, v243, v249
  v_mov_b32 v248, v242
  v_mov_b32 v249, v243
  s_nop 1
  v_permlane32_swap_b32 v242, v248
  v_permlane32_swap_b32 v243, v249
  s_nop 1
  v_max_f32 v242, v242, v248
  v_max_f32 v243, v243, v249
  v_max_f32 v240, 0, v240
  v_max_f32 v241, 0, v241
  v_max_f32 v242, 0, v242
  v_max_f32 v243, 0, v243
  v_max_f32 v240, v240, v242
  v_mov_b32 v242, v240
  v_max_f32 v241, v241, v243
  v_mov_b32 v243, v241
  v_exp_f32 v244, -v240
  v_exp_f32 v245, -v241
  v_exp_f32 v246, -v242
  v_exp_f32 v247, -v243
  v_sub_f32 v32, v32, v240
  v_sub_f32 v33, v33, v240
  v_sub_f32 v34, v34, v240
  v_sub_f32 v35, v35, v240
  v_sub_f32 v36, v36, v240
  v_sub_f32 v37, v37, v240
  v_sub_f32 v38, v38, v240
  v_sub_f32 v39, v39, v240
  v_sub_f32 v40, v40, v241
  v_sub_f32 v41, v41, v241
  v_sub_f32 v42, v42, v241
  v_sub_f32 v43, v43, v241
  v_sub_f32 v44, v44, v241
  v_sub_f32 v45, v45, v241
  v_sub_f32 v46, v46, v241
  v_sub_f32 v47, v47, v241
  v_sub_f32 v48, v48, v242
  v_sub_f32 v49, v49, v242
  v_sub_f32 v50, v50, v242
  v_sub_f32 v51, v51, v242
  v_sub_f32 v52, v52, v242
  v_sub_f32 v53, v53, v242
  v_sub_f32 v54, v54, v242
  v_sub_f32 v55, v55, v242
  v_sub_f32 v56, v56, v243
  v_sub_f32 v57, v57, v243
  v_sub_f32 v58, v58, v243
  v_sub_f32 v59, v59, v243
  v_sub_f32 v60, v60, v243
  v_sub_f32 v61, v61, v243
  v_sub_f32 v62, v62, v243
  v_sub_f32 v63, v63, v243
  v_exp_f32 v192, v32
  v_exp_f32 v193, v33
  v_exp_f32 v194, v34
  v_cvt_pk_bf16_f32 v112, v192, v193
  v_exp_f32 v195, v35
  v_exp_f32 v196, v40
  v_cvt_pk_bf16_f32 v113, v194, v195
  v_exp_f32 v197, v41
  v_exp_f32 v198, v42
  v_cvt_pk_bf16_f32 v116, v196, v197
  v_exp_f32 v199, v43
  v_exp_f32 v192, v36
  v_cvt_pk_bf16_f32 v117, v198, v199
  v_exp_f32 v193, v37
  v_exp_f32 v194, v38
  v_cvt_pk_bf16_f32 v114, v192, v193
  v_exp_f32 v195, v39
  v_exp_f32 v196, v44
  v_cvt_pk_bf16_f32 v115, v194, v195
  v_exp_f32 v197, v45
  v_exp_f32 v198, v46
  v_cvt_pk_bf16_f32 v118, v196, v197
  v_exp_f32 v199, v47
  v_exp_f32 v192, v48
  v_cvt_pk_bf16_f32 v119, v198, v199
  v_exp_f32 v193, v49
  v_exp_f32 v194, v50
  v_cvt_pk_bf16_f32 v120, v192, v193
  v_exp_f32 v195, v51
  v_exp_f32 v196, v56
  v_cvt_pk_bf16_f32 v121, v194, v195
  v_exp_f32 v197, v57
  v_exp_f32 v198, v58
  v_cvt_pk_bf16_f32 v124, v196, v197
  v_exp_f32 v199, v59
  v_exp_f32 v192, v52
  v_cvt_pk_bf16_f32 v125, v198, v199
  v_exp_f32 v193, v53
  v_exp_f32 v194, v54
  v_cvt_pk_bf16_f32 v122, v192, v193
  v_exp_f32 v195, v55
  v_exp_f32 v196, v60
  v_cvt_pk_bf16_f32 v123, v194, v195
  v_exp_f32 v197, v61
  v_exp_f32 v198, v62
  v_cvt_pk_bf16_f32 v126, v196, v197
  v_exp_f32 v199, v63
  s_nop 0
  v_cvt_pk_bf16_f32 v127, v198, v199
  s_nop 1
  v_mfma_f32_16x16x32_bf16 v[208:211], v[216:219], v[112:115], 0
  v_mfma_f32_16x16x32_bf16 v[212:215], v[216:219], v[116:119], 0
  v_mfma_f32_16x16x32_bf16 v[208:211], v[216:219], v[120:123], v[208:211]
  v_mfma_f32_16x16x32_bf16 v[212:215], v[216:219], v[124:127], v[212:215]
  v_mul_f32 v222, v222, v246
  v_accvgpr_read_b32 v248, a64
  v_accvgpr_read_b32 v249, a65
  v_mul_f32 v248, v248, v246
  v_mul_f32 v249, v249, v246
  v_accvgpr_write_b32 a64, v248
  v_accvgpr_write_b32 a65, v249
  v_accvgpr_read_b32 v248, a66
  v_accvgpr_read_b32 v249, a67
  v_mul_f32 v248, v248, v246
  v_mul_f32 v249, v249, v246
  v_accvgpr_write_b32 a66, v248
  v_accvgpr_write_b32 a67, v249
  v_accvgpr_read_b32 v248, a68
  v_accvgpr_read_b32 v249, a69
  v_mul_f32 v248, v248, v246
  v_mul_f32 v249, v249, v246
  v_accvgpr_write_b32 a68, v248
  v_accvgpr_write_b32 a69, v249
  v_accvgpr_read_b32 v248, a70
  v_accvgpr_read_b32 v249, a71
  v_mul_f32 v248, v248, v246
  v_mul_f32 v249, v249, v246
  v_accvgpr_write_b32 a70, v248
  v_accvgpr_write_b32 a71, v249
  v_accvgpr_read_b32 v248, a72
  v_accvgpr_read_b32 v249, a73
  v_mul_f32 v248, v248, v246
  v_mul_f32 v249, v249, v246
  v_accvgpr_write_b32 a72, v248
  v_accvgpr_write_b32 a73, v249
  v_accvgpr_read_b32 v248, a74
  v_accvgpr_read_b32 v249, a75
  v_mul_f32 v248, v248, v246
  v_mul_f32 v249, v249, v246
  v_accvgpr_write_b32 a74, v248
  v_accvgpr_write_b32 a75, v249
  v_accvgpr_read_b32 v248, a76
  v_accvgpr_read_b32 v249, a77
  v_mul_f32 v248, v248, v246
  v_mul_f32 v249, v249, v246
  v_accvgpr_write_b32 a76, v248
  v_accvgpr_write_b32 a77, v249
  v_accvgpr_read_b32 v248, a78
  v_accvgpr_read_b32 v249, a79
  v_mul_f32 v248, v248, v246
  v_mul_f32 v249, v249, v246
  v_accvgpr_write_b32 a78, v248
  v_accvgpr_write_b32 a79, v249
  v_accvgpr_read_b32 v248, a80
  v_accvgpr_read_b32 v249, a81
  v_mul_f32 v248, v248, v246
  v_mul_f32 v249, v249, v246
  v_accvgpr_write_b32 a80, v248
  v_accvgpr_write_b32 a81, v249
  v_accvgpr_read_b32 v248, a82
  v_accvgpr_read_b32 v249, a83
  v_mul_f32 v248, v248, v246
  v_mul_f32 v249, v249, v246
  v_accvgpr_write_b32 a82, v248
  v_accvgpr_write_b32 a83, v249
  v_accvgpr_read_b32 v248, a84
  v_accvgpr_read_b32 v249, a85
  v_mul_f32 v248, v248, v246
  v_mul_f32 v249, v249, v246
  v_accvgpr_write_b32 a84, v248
  v_accvgpr_write_b32 a85, v249
  v_accvgpr_read_b32 v248, a86
  v_accvgpr_read_b32 v249, a87
  v_mul_f32 v248, v248, v246
  v_mul_f32 v249, v249, v246
  v_accvgpr_write_b32 a86, v248
  v_accvgpr_write_b32 a87, v249
  v_accvgpr_read_b32 v248, a88
  v_accvgpr_read_b32 v249, a89
  v_mul_f32 v248, v248, v246
  v_mul_f32 v249, v249, v246
  v_accvgpr_write_b32 a88, v248
  v_accvgpr_write_b32 a89, v249
  v_accvgpr_read_b32 v248, a90
  v_accvgpr_read_b32 v249, a91
  v_mul_f32 v248, v248, v246
  v_mul_f32 v249, v249, v246
  v_accvgpr_write_b32 a90, v248
  v_accvgpr_write_b32 a91, v249
  v_accvgpr_read_b32 v248, a92
  v_accvgpr_read_b32 v249, a93
  v_mul_f32 v248, v248, v246
  v_mul_f32 v249, v249, v246
  v_accvgpr_write_b32 a92, v248
  v_accvgpr_write_b32 a93, v249
  v_accvgpr_read_b32 v248, a94
  v_accvgpr_read_b32 v249, a95
  v_mul_f32 v248, v248, v246
  v_mul_f32 v249, v249, v246
  v_accvgpr_write_b32 a94, v248
  v_accvgpr_write_b32 a95, v249
  v_mul_f32 v223, v223, v247
  v_accvgpr_read_b32 v248, a96
  v_accvgpr_read_b32 v249, a97
  v_mul_f32 v248, v248, v247
  v_mul_f32 v249, v249, v247
  v_accvgpr_write_b32 a96, v248
  v_accvgpr_write_b32 a97, v249
  v_accvgpr_read_b32 v248, a98
  v_accvgpr_read_b32 v249, a99
  v_mul_f32 v248, v248, v247
  v_mul_f32 v249, v249, v247
  v_accvgpr_write_b32 a98, v248
  v_accvgpr_write_b32 a99, v249
  v_accvgpr_read_b32 v248, a100
  v_accvgpr_read_b32 v249, a101
  v_mul_f32 v248, v248, v247
  v_mul_f32 v249, v249, v247
  v_accvgpr_write_b32 a100, v248
  v_accvgpr_write_b32 a101, v249
  v_accvgpr_read_b32 v248, a102
  v_accvgpr_read_b32 v249, a103
  v_mul_f32 v248, v248, v247
  v_mul_f32 v249, v249, v247
  v_accvgpr_write_b32 a102, v248
  v_accvgpr_write_b32 a103, v249
  v_accvgpr_read_b32 v248, a104
  v_accvgpr_read_b32 v249, a105
  v_mul_f32 v248, v248, v247
  v_mul_f32 v249, v249, v247
  v_accvgpr_write_b32 a104, v248
  v_accvgpr_write_b32 a105, v249
  v_accvgpr_read_b32 v248, a106
  v_accvgpr_read_b32 v249, a107
  v_mul_f32 v248, v248, v247
  v_mul_f32 v249, v249, v247
  v_accvgpr_write_b32 a106, v248
  v_accvgpr_write_b32 a107, v249
  v_accvgpr_read_b32 v248, a108
  v_accvgpr_read_b32 v249, a109
  v_mul_f32 v248, v248, v247
  v_mul_f32 v249, v249, v247
  v_accvgpr_write_b32 a108, v248
  v_accvgpr_write_b32 a109, v249
  v_accvgpr_read_b32 v248, a110
  v_accvgpr_read_b32 v249, a111
  v_mul_f32 v248, v248, v247
  v_mul_f32 v249, v249, v247
  v_accvgpr_write_b32 a110, v248
  v_accvgpr_write_b32 a111, v249
  v_accvgpr_read_b32 v248, a112
  v_accvgpr_read_b32 v249, a113
  v_mul_f32 v248, v248, v247
  v_mul_f32 v249, v249, v247
  v_accvgpr_write_b32 a112, v248
  v_accvgpr_write_b32 a113, v249
  v_accvgpr_read_b32 v248, a114
  v_accvgpr_read_b32 v249, a115
  v_mul_f32 v248, v248, v247
  v_mul_f32 v249, v249, v247
  v_accvgpr_write_b32 a114, v248
  v_accvgpr_write_b32 a115, v249
  v_accvgpr_read_b32 v248, a116
  v_accvgpr_read_b32 v249, a117
  v_mul_f32 v248, v248, v247
  v_mul_f32 v249, v249, v247
  v_accvgpr_write_b32 a116, v248
  v_accvgpr_write_b32 a117, v249
  v_accvgpr_read_b32 v248, a118
  v_accvgpr_read_b32 v249, a119
  v_mul_f32 v248, v248, v247
  v_mul_f32 v249, v249, v247
  v_accvgpr_write_b32 a118, v248
  v_accvgpr_write_b32 a119, v249
  v_accvgpr_read_b32 v248, a120
  v_accvgpr_read_b32 v249, a121
  v_mul_f32 v248, v248, v247
  v_mul_f32 v249, v249, v247
  v_accvgpr_write_b32 a120, v248
  v_accvgpr_write_b32 a121, v249
  v_accvgpr_read_b32 v248, a122
  v_accvgpr_read_b32 v249, a123
  v_mul_f32 v248, v248, v247
  v_mul_f32 v249, v249, v247
  v_accvgpr_write_b32 a122, v248
  v_accvgpr_write_b32 a123, v249
  v_accvgpr_read_b32 v248, a124
  v_accvgpr_read_b32 v249, a125
  v_mul_f32 v248, v248, v247
  v_mul_f32 v249, v249, v247
  v_accvgpr_write_b32 a124, v248
  v_accvgpr_write_b32 a125, v249
  v_accvgpr_read_b32 v248, a126
  v_accvgpr_read_b32 v249, a127
  v_mul_f32 v248, v248, v247
  v_mul_f32 v249, v249, v247
  v_accvgpr_write_b32 a126, v248
  v_accvgpr_write_b32 a127, v249
  s_nop 2
  s_branch L_adaL_back_67
.section .rodata,"a"
.p2align 6
.amdhsa_kernel adaLN_cond__compressed_kv_cla__mixer_gmlp__prompt_kernel
  .amdhsa_next_free_vgpr 512
  .amdhsa_next_free_sgpr 102
  .amdhsa_accum_offset 256
  .amdhsa_group_segment_fixed_size 0
  .amdhsa_kernarg_size 128
  .amdhsa_user_sgpr_count 2
  .amdhsa_user_sgpr_kernarg_segment_ptr 1
  .amdhsa_system_sgpr_workgroup_id_x 1
.end_amdhsa_kernel
```
